```python
import torch

def _softmax(x, axis=-1):
    return torch.softmax(x, dim=axis)
def _gelu(x):
    return torch.nn.functional.gelu(x, approximate="tanh")
def _silu(x):
    return torch.nn.functional.silu(x)
def _sigmoid(x):
    return torch.sigmoid(x)
def _layernorm(x, axis=-1, eps=1e-5):
    m = x.mean(dim=axis, keepdim=True)
    v = x.var(dim=axis, keepdim=True, unbiased=False)
    return (x - m) / torch.sqrt(v + eps)
def _scatter_add(tgt, idx, src, axis=0):
    return tgt.clone().index_add_(axis, idx, src)
def _segment_sum(src, seg, n):
    out = torch.zeros((n,) + src.shape[1:], dtype=src.dtype)
    return out.index_add_(0, seg, src)
def _pad(x, pw):
    flat = tuple(v for pair in reversed(pw) for v in pair)
    return torch.nn.functional.pad(x, flat)

kernel_name = 'concat_heads__gqa_block_cached__compressed_kv_cla__decode'

def setup_inputs():

    _w = (lambda a: (lambda t: t.to(torch.bfloat16) if t.is_floating_point() else t)(torch.as_tensor(a)))
    def _A_setup():
        B, Sq, D = 2, 1, 512
        Hq, Hkv, Sk, Dh = 32, 32, 8192, 128
        assert Hq % Hkv == 0, (Hq, Hkv)
        return {
            "x": _w((lambda *s: torch.randn(*s, dtype=torch.bfloat16) * 1.6)(B, Sq, D)),
            "k_cache": _w((lambda *s: torch.randn(*s, dtype=torch.bfloat16) * 1.6)(B, Hkv, Sk, Dh)),
            "v_cache": _w((lambda *s: torch.randn(*s, dtype=torch.bfloat16) * 0.05)(B, Hkv, Sk, Dh)),
            "wq": _w((lambda *s: torch.randn(*s, dtype=torch.bfloat16) * 1.6)(D, Hq * Dh) * (D ** -0.5)),
            "wo": _w((lambda *s: torch.randn(*s, dtype=torch.bfloat16) * 0.05)(Hq * Dh, D) * ((Hq * Dh) ** -0.5)),
        }
    _A_in = _A_setup()

    def _B_setup():
        B, H, Sq, Sk, D, M = 2, 32, 1, 8192, 128, 512
        Dc = 4 * D
        return {
            "x": _w((lambda *s: torch.randn(*s, dtype=torch.bfloat16) * 3.2)(B, Sq, M)),
            "c_kv": _w((lambda *s: torch.randn(*s, dtype=torch.bfloat16) * 0.1)(B, Sk, Dc)),
            "w_q": _w((lambda *s: torch.randn(*s, dtype=torch.bfloat16) * 6.4)(M, H, D) * (M ** -0.5)),
            "w_uk": _w((lambda *s: torch.randn(*s, dtype=torch.bfloat16) * 6.4)(Dc, H, D) * (Dc ** -0.5)),
            "w_uv": _w((lambda *s: torch.randn(*s, dtype=torch.bfloat16) * 0.1)(Dc, H, D) * (Dc ** -0.5)),
            "w_o": _w((lambda *s: torch.randn(*s, dtype=torch.bfloat16) * 0.1)(H, D, M) * ((H * D) ** -0.5)),
        }
    _B_in = _B_setup()

    return {
        "A_x": _A_in["x"],
        "A_k_cache": _A_in["k_cache"],
        "A_v_cache": _A_in["v_cache"],
        "A_wq": _A_in["wq"],
        "A_wo": _A_in["wo"],
        "B_x": _B_in["x"],
        "B_c_kv": _B_in["c_kv"],
        "B_w_q": _B_in["w_q"],
        "B_w_uk": _B_in["w_uk"],
        "B_w_uv": _B_in["w_uv"],
        "B_w_o": _B_in["w_o"],
    }

def reference(A_x, A_k_cache, A_v_cache, A_wq, A_wo, B_x, B_c_kv, B_w_q, B_w_uk, B_w_uv, B_w_o):
    def _A_ref(x, k_cache, v_cache, wq, wo):
        B, Sq, D = x.shape
        Hq, Dh = 32, 128
        Hkv = k_cache.shape[1]
        rep = Hq // Hkv
        q = (lambda x, *d: x.permute(*d))((x @ wq).reshape(B, Sq, Hq, Dh), 0, 2, 1, 3)
        k = (lambda x, n, axis: torch.repeat_interleave(x, n, dim=axis))(k_cache, rep, axis=1)
        v = (lambda x, n, axis: torch.repeat_interleave(x, n, dim=axis))(v_cache, rep, axis=1)
        scores = torch.einsum("bhqd,bhkd->bhqk", q, k) * (Dh ** -0.5)
        p = _softmax(scores, axis=-1)
        o = torch.einsum("bhqk,bhkd->bhqd", p, v)
        return (lambda x, *d: x.permute(*d))(o, 0, 2, 1, 3).reshape(B, Sq, Hq * Dh) @ wo

    def _B_ref(x, c_kv, w_q, w_uk, w_uv, w_o):
        B, Sq, M = x.shape[0], x.shape[1], x.shape[2]
        Sk = c_kv.shape[1]
        H, D = w_q.shape[1], w_q.shape[2]
        q = torch.einsum("bqm,mhd->bhqd", x, w_q)
        k = torch.einsum("bkc,chd->bhkd", c_kv, w_uk)
        v = torch.einsum("bkc,chd->bhkd", c_kv, w_uv)
        scores = torch.einsum("bhqd,bhkd->bhqk", q, k) * (D ** -0.5)
        off = Sk - Sq
        qi = torch.arange(Sq)[:, None]
        kj = torch.arange(Sk)[None, :]
        cmask = kj <= (qi + off)
        scores = torch.where(cmask[None, None], scores, -1e9)
        p = _softmax(scores, axis=-1)
        ctx = torch.einsum("bhqk,bhkd->bhqd", p, v)
        return torch.einsum("bhqd,hdm->bqm", ctx, w_o)

    a = _A_ref(A_x, A_k_cache, A_v_cache, A_wq, A_wo)
    b = _B_ref(B_x, B_c_kv, B_w_q, B_w_uk, B_w_uv, B_w_o)
    return torch.concatenate([a, b], axis=-1)
```

```asm
; @launch grid=(256,1,1) block=(512,1,1) lds=153600
.amdgcn_target "amdgcn-amd-amdhsa--gfx950"
.text
.globl concat_heads__gqa_block_cached__compressed_kv_cla__decode_kernel
.p2align 8
.type concat_heads__gqa_block_cached__compressed_kv_cla__decode_kernel,@function
concat_heads__gqa_block_cached__compressed_kv_cla__decode_kernel:
s_cmp_ge_u32 s2, 256
s_cbranch_scc1 L_exit
s_load_dwordx16 s[4:19], s[0:1], 0
s_load_dwordx8 s[20:27], s[0:1], 64
s_load_dwordx4 s[28:31], s[0:1], 96
v_lshrrev_b32 v8, 6, v0
s_lshr_b32 s32, s2, 3
s_sub_u32 s33, s2, s32
s_and_b32 s33, s33, 7
v_readfirstlane_b32 s34, v8
v_and_b32 v1, 63, v0
v_and_b32 v2, 15, v0
v_bfe_u32 v3, v0, 4, 2
v_lshlrev_b32 v8, 4, v1
s_bfe_u32 s55, s32, 0x10004
s_lshl_b32 s55, s55, 26
s_lshl_b32 s35, s33, 3
s_add_u32 s35, s35, s34
s_bfe_u32 s63, s35, 0x10009
s_lshl_b32 s63, s63, 26
s_xor_b32 s37, s63, s55
s_bfe_u32 s63, s35, 0x90000
s_lshl_b32 s63, s63, 12
s_or_b32 s37, s37, s63
s_waitcnt lgkmcnt(0)
s_cmp_eq_u32 s33, 6
s_cbranch_scc1 L_roleW
s_cmp_eq_u32 s33, 7
s_cbranch_scc1 L_roleC
L_roleA:
s_lshl_b32 s62, s32, 21
s_add_u32 s40, s6, s62
s_addc_u32 s41, s7, 0
s_and_b32 s41, s41, 0xffff
s_mov_b32 s42, 0x4200000
s_mov_b32 s43, 0x20000
buffer_load_dwordx4 v[52:55], v8, s[40:43], s37 offen offset:0 nt
buffer_load_dwordx4 v[56:59], v8, s[40:43], s37 offen offset:1024 nt
buffer_load_dwordx4 v[60:63], v8, s[40:43], s37 offen offset:2048 nt
buffer_load_dwordx4 v[64:67], v8, s[40:43], s37 offen offset:3072 nt
s_add_u32 s44, s8, s62
s_addc_u32 s45, s9, 0
s_and_b32 s45, s45, 0xffff
s_mov_b32 s46, 0x4200000
s_mov_b32 s47, 0x20000
v_and_b32 v196, 1, v0
v_lshlrev_b32 v196, 4, v196
v_mov_b32 v197, 0xffff
v_lshlrev_b32 v196, v196, v197
v_bfe_u32 v197, v0, 1, 2
v_cmp_eq_u32 vcc, 0, v197
s_nop 1
v_cndmask_b32 v4, 0, v196, vcc
v_cmp_eq_u32 vcc, 1, v197
s_nop 1
v_cndmask_b32 v5, 0, v196, vcc
v_cmp_eq_u32 vcc, 2, v197
s_nop 1
v_cndmask_b32 v6, 0, v196, vcc
v_cmp_eq_u32 vcc, 3, v197
s_nop 1
v_cndmask_b32 v7, 0, v196, vcc
s_load_dword s58, s[30:31], 0x14000
s_lshl_b32 s62, s32, 13
s_add_u32 s62, s62, 0x61800
s_mov_b32 s66, 13
s_add_u32 s52, s30, s62
s_addc_u32 s53, s31, 0
v_mov_b32 v204, 0xff7fffff
v_mov_b32 v205, 0
v_mov_b32 v200, 0
v_mov_b32 v201, 0
v_mov_b32 v202, 0
v_mov_b32 v203, 0
v_mov_b32 v208, 0x3e0293ee
s_mov_b32 s56, 0
s_mov_b32 s54, 0
s_lshr_b32 s61, s55, 17
v_lshrrev_b32 v215, 1, v3
v_lshlrev_b32 v215, 9, v215
v_xor_b32 v215, s61, v215
v_lshl_add_u32 v215, v2, 5, v215
v_and_b32 v196, 1, v3
v_lshl_add_u32 v215, v196, 4, v215
s_lshl_b32 s62, s32, 10
s_add_u32 s62, s62, 0x18000
v_add_u32 v215, s62, v215
v_lshlrev_b32 v212, 5, v2
v_lshl_add_u32 v212, v3, 4, v212
s_mul_i32 s62, s34, 1056
v_add_u32 v212, s62, v212
s_lshl_b32 s62, s34, 3
v_mov_b32 v213, s62
v_and_b32 v196, 7, v1
v_lshrrev_b32 v197, 3, v1
v_add_u32 v197, s62, v197
v_lshlrev_b32 v197, 4, v197
v_mul_u32_u24 v214, 1056, v196
v_add_u32 v214, v214, v197
v_xor_b32 v218, s61, v197
s_lshl_b32 s62, s32, 3
s_add_u32 s62, s62, s33
s_lshl_b32 s62, s62, 10
s_add_u32 s62, s62, 0x60000
v_add_u32 v218, s62, v218
s_waitcnt vmcnt(3)
buffer_load_dwordx4 v[68:71], v8, s[44:47], s37 offen offset:0 nt
s_waitcnt vmcnt(3)
buffer_load_dwordx4 v[72:75], v8, s[44:47], s37 offen offset:1024 nt
s_waitcnt vmcnt(3)
buffer_load_dwordx4 v[76:79], v8, s[44:47], s37 offen offset:2048 nt
s_waitcnt vmcnt(3)
buffer_load_dwordx4 v[80:83], v8, s[44:47], s37 offen offset:3072 nt
s_waitcnt vmcnt(3)
s_add_u32 s35, s35, 48
s_bfe_u32 s63, s35, 0x10009
s_lshl_b32 s63, s63, 26
s_xor_b32 s37, s63, s55
s_bfe_u32 s63, s35, 0x90000
s_lshl_b32 s63, s63, 12
s_or_b32 s37, s37, s63
buffer_load_dwordx4 v[84:87], v8, s[40:43], s37 offen offset:0 nt
s_waitcnt vmcnt(3)
buffer_load_dwordx4 v[88:91], v8, s[40:43], s37 offen offset:1024 nt
s_waitcnt vmcnt(3)
buffer_load_dwordx4 v[92:95], v8, s[40:43], s37 offen offset:2048 nt
s_waitcnt vmcnt(3)
buffer_load_dwordx4 v[96:99], v8, s[40:43], s37 offen offset:3072 nt
s_waitcnt vmcnt(3)
buffer_load_dwordx4 v[100:103], v8, s[44:47], s37 offen offset:0 nt
s_waitcnt vmcnt(3)
buffer_load_dwordx4 v[104:107], v8, s[44:47], s37 offen offset:1024 nt
s_waitcnt vmcnt(3)
buffer_load_dwordx4 v[108:111], v8, s[44:47], s37 offen offset:2048 nt
s_waitcnt vmcnt(3)
buffer_load_dwordx4 v[112:115], v8, s[44:47], s37 offen offset:3072 nt
s_waitcnt vmcnt(3)
s_add_u32 s35, s35, 48
s_bfe_u32 s63, s35, 0x10009
s_lshl_b32 s63, s63, 26
s_xor_b32 s37, s63, s55
s_bfe_u32 s63, s35, 0x90000
s_lshl_b32 s63, s63, 12
s_or_b32 s37, s37, s63
buffer_load_dwordx4 v[116:119], v8, s[40:43], s37 offen offset:0 nt
s_waitcnt vmcnt(3)
buffer_load_dwordx4 v[120:123], v8, s[40:43], s37 offen offset:1024 nt
s_waitcnt vmcnt(3)
buffer_load_dwordx4 v[124:127], v8, s[40:43], s37 offen offset:2048 nt
s_waitcnt vmcnt(3)
buffer_load_dwordx4 v[128:131], v8, s[40:43], s37 offen offset:3072 nt
s_waitcnt vmcnt(3)
buffer_load_dwordx4 v[132:135], v8, s[44:47], s37 offen offset:0 nt
s_waitcnt vmcnt(3)
buffer_load_dwordx4 v[136:139], v8, s[44:47], s37 offen offset:1024 nt
s_waitcnt vmcnt(3)
buffer_load_dwordx4 v[140:143], v8, s[44:47], s37 offen offset:2048 nt
s_waitcnt vmcnt(3)
buffer_load_dwordx4 v[144:147], v8, s[44:47], s37 offen offset:3072 nt
s_waitcnt vmcnt(3)
s_add_u32 s35, s35, 48
s_bfe_u32 s63, s35, 0x10009
s_lshl_b32 s63, s63, 26
s_xor_b32 s37, s63, s55
s_bfe_u32 s63, s35, 0x90000
s_lshl_b32 s63, s63, 12
s_or_b32 s37, s37, s63
buffer_load_dwordx4 v[148:151], v8, s[40:43], s37 offen offset:0 nt
s_waitcnt vmcnt(3)
buffer_load_dwordx4 v[152:155], v8, s[40:43], s37 offen offset:1024 nt
s_waitcnt vmcnt(3)
buffer_load_dwordx4 v[156:159], v8, s[40:43], s37 offen offset:2048 nt
s_waitcnt vmcnt(3)
buffer_load_dwordx4 v[160:163], v8, s[40:43], s37 offen offset:3072 nt
s_waitcnt vmcnt(3)
buffer_load_dwordx4 v[164:167], v8, s[44:47], s37 offen offset:0 nt
s_waitcnt vmcnt(3)
buffer_load_dwordx4 v[168:171], v8, s[44:47], s37 offen offset:1024 nt
s_waitcnt vmcnt(3)
buffer_load_dwordx4 v[172:175], v8, s[44:47], s37 offen offset:2048 nt
s_waitcnt vmcnt(3)
buffer_load_dwordx4 v[176:179], v8, s[44:47], s37 offen offset:3072 nt
global_load_dwordx4 v[184:187], v215, s[30:31] sc1
s_waitcnt vmcnt(4)
s_add_u32 s35, s35, 48
s_bfe_u32 s63, s35, 0x10009
s_lshl_b32 s63, s63, 26
s_xor_b32 s37, s63, s55
s_bfe_u32 s63, s35, 0x90000
s_lshl_b32 s63, s63, 12
s_or_b32 s37, s37, s63
buffer_load_dwordx4 v[20:23], v8, s[40:43], s37 offen offset:0 nt
s_waitcnt vmcnt(4)
buffer_load_dwordx4 v[24:27], v8, s[40:43], s37 offen offset:1024 nt
s_waitcnt vmcnt(4)
buffer_load_dwordx4 v[28:31], v8, s[40:43], s37 offen offset:2048 nt
s_waitcnt vmcnt(4)
buffer_load_dwordx4 v[32:35], v8, s[40:43], s37 offen offset:3072 nt
s_waitcnt lgkmcnt(0)
s_add_u32 s58, s58, 0x9e3779b9
s_bfe_u32 s76, s58, 0x80000
s_bfe_u32 s77, s58, 0x80008
s_bfe_u32 s78, s58, 0x80010
s_bfe_u32 s79, s58, 0x80018
s_mov_b32 s64, 0
s_mov_b32 s60, 0x05040100
s_mov_b32 s61, 0x07060302
s_waitcnt vmcnt(4)
L_A_qchk:
v_perm_b32 v196, v185, v184, s60
v_perm_b32 v197, v187, v186, s60
v_xor_b32 v196, s58, v196
v_xor_b32 v197, s58, v197
v_or_b32 v196, v196, v197
v_cmp_ne_u32 vcc, 0, v196
s_add_u32 s64, s64, 1
s_cmp_eq_u64 vcc, 0
s_cbranch_scc1 L_A_qok
s_cmp_ge_u32 s64, 65536
s_cbranch_scc1 L_A_qok
global_load_dwordx4 v[184:187], v215, s[30:31] sc1
s_waitcnt vmcnt(0)
s_branch L_A_qchk
L_A_qok:
v_perm_b32 v196, v185, v184, s61
v_perm_b32 v197, v187, v186, s61
v_lshlrev_b32 v198, 2, v2
ds_bpermute_b32 v12, v198, v196 offset:0
ds_bpermute_b32 v13, v198, v197 offset:0
ds_bpermute_b32 v14, v198, v196 offset:64
ds_bpermute_b32 v15, v198, v197 offset:64
ds_bpermute_b32 v16, v198, v196 offset:128
ds_bpermute_b32 v17, v198, v197 offset:128
ds_bpermute_b32 v18, v198, v196 offset:192
ds_bpermute_b32 v19, v198, v197 offset:192
s_waitcnt lgkmcnt(0)
.p2align 6
L_A_loopb:
s_cmp_lt_u32 s54, 4
s_cbranch_scc1 L_A_back
L_A_backd:
s_lshr_b32 s62, s35, 9
s_cmp_lg_u32 s62, s56
s_cbranch_scc1 L_A_swb
L_A_swdb:
s_cmp_lt_u32 s54, s66
s_cbranch_scc1 L_A_nogb
s_mov_b32 s39, 1
s_atomic_add s39, s[52:53], 0 glc
L_A_nogb:
s_waitcnt vmcnt(3)
buffer_load_dwordx4 v[36:39], v8, s[44:47], s37 offen offset:0 nt
v_dot2_f32_bf16 v180, v20, v12, 0
v_dot2_f32_bf16 v180, v21, v13, v180
v_dot2_f32_bf16 v180, v22, v14, v180
v_dot2_f32_bf16 v180, v23, v15, v180
s_nop 2
v_add_f32_dpp v180, v180, v180 row_ror:8 row_mask:0xf bank_mask:0xf
s_nop 1
v_add_f32_dpp v180, v180, v180 row_ror:4 row_mask:0xf bank_mask:0xf
s_nop 1
v_add_f32_dpp v180, v180, v180 row_ror:2 row_mask:0xf bank_mask:0xf
s_nop 1
v_add_f32_dpp v180, v180, v180 row_ror:1 row_mask:0xf bank_mask:0xf
v_mul_f32 v180, v180, v208
s_waitcnt vmcnt(3)
buffer_load_dwordx4 v[40:43], v8, s[44:47], s37 offen offset:1024 nt
v_dot2_f32_bf16 v181, v24, v12, 0
v_dot2_f32_bf16 v181, v25, v13, v181
v_dot2_f32_bf16 v181, v26, v14, v181
v_dot2_f32_bf16 v181, v27, v15, v181
s_nop 2
v_add_f32_dpp v181, v181, v181 row_ror:8 row_mask:0xf bank_mask:0xf
s_nop 1
v_add_f32_dpp v181, v181, v181 row_ror:4 row_mask:0xf bank_mask:0xf
s_nop 1
v_add_f32_dpp v181, v181, v181 row_ror:2 row_mask:0xf bank_mask:0xf
s_nop 1
v_add_f32_dpp v181, v181, v181 row_ror:1 row_mask:0xf bank_mask:0xf
v_mul_f32 v181, v181, v208
s_waitcnt vmcnt(3)
buffer_load_dwordx4 v[44:47], v8, s[44:47], s37 offen offset:2048 nt
v_dot2_f32_bf16 v182, v28, v12, 0
v_dot2_f32_bf16 v182, v29, v13, v182
v_dot2_f32_bf16 v182, v30, v14, v182
v_dot2_f32_bf16 v182, v31, v15, v182
s_nop 2
v_add_f32_dpp v182, v182, v182 row_ror:8 row_mask:0xf bank_mask:0xf
s_nop 1
v_add_f32_dpp v182, v182, v182 row_ror:4 row_mask:0xf bank_mask:0xf
s_nop 1
v_add_f32_dpp v182, v182, v182 row_ror:2 row_mask:0xf bank_mask:0xf
s_nop 1
v_add_f32_dpp v182, v182, v182 row_ror:1 row_mask:0xf bank_mask:0xf
v_mul_f32 v182, v182, v208
s_waitcnt vmcnt(3)
buffer_load_dwordx4 v[48:51], v8, s[44:47], s37 offen offset:3072 nt
v_dot2_f32_bf16 v183, v32, v12, 0
v_dot2_f32_bf16 v183, v33, v13, v183
v_dot2_f32_bf16 v183, v34, v14, v183
v_dot2_f32_bf16 v183, v35, v15, v183
s_nop 2
v_add_f32_dpp v183, v183, v183 row_ror:8 row_mask:0xf bank_mask:0xf
s_nop 1
v_add_f32_dpp v183, v183, v183 row_ror:4 row_mask:0xf bank_mask:0xf
s_nop 1
v_add_f32_dpp v183, v183, v183 row_ror:2 row_mask:0xf bank_mask:0xf
s_nop 1
v_add_f32_dpp v183, v183, v183 row_ror:1 row_mask:0xf bank_mask:0xf
v_mul_f32 v183, v183, v208
v_max3_f32 v209, v180, v181, v182
v_max_f32 v209, v209, v183
v_cmp_gt_f32 vcc, v209, v204
s_nop 0
s_cmp_lg_u64 vcc, 0
s_cbranch_scc1 L_A_maxb
L_A_maxdb:
v_sub_f32 v180, v180, v204
v_sub_f32 v181, v181, v204
v_sub_f32 v182, v182, v204
v_sub_f32 v183, v183, v204
v_exp_f32 v180, v180
v_exp_f32 v181, v181
v_exp_f32 v182, v182
v_exp_f32 v183, v183
v_cvt_pk_bf16_f32 v210, v180, v180
v_add_f32 v205, v205, v180
v_and_b32 v184, v210, v4
v_and_b32 v185, v210, v5
v_and_b32 v186, v210, v6
v_and_b32 v187, v210, v7
s_add_u32 s36, s35, 48
s_cmp_lt_u32 s54, 13
s_cbranch_scc1 L_A_notb
s_waitcnt lgkmcnt(0)
s_add_u32 s39, s39, 1
s_min_u32 s39, s39, 1024
s_add_u32 s36, s39, 864
L_A_notb:
s_bfe_u32 s63, s36, 0x10009
s_lshl_b32 s63, s63, 26
s_xor_b32 s38, s63, s55
s_bfe_u32 s63, s36, 0x90000
s_lshl_b32 s63, s63, 12
s_or_b32 s38, s38, s63
s_cmp_lt_u32 s36, 1024
s_cselect_b32 s42, s42, 0
s_waitcnt vmcnt(3)
buffer_load_dwordx4 v[20:23], v8, s[40:43], s38 offen offset:0 nt
v_mfma_f32_16x16x32_bf16 v[200:203], v[184:187], v[36:39], v[200:203]
v_cvt_pk_bf16_f32 v211, v181, v181
v_add_f32 v205, v205, v181
v_and_b32 v188, v211, v4
v_and_b32 v189, v211, v5
v_and_b32 v190, v211, v6
v_and_b32 v191, v211, v7
s_waitcnt vmcnt(3)
buffer_load_dwordx4 v[24:27], v8, s[40:43], s38 offen offset:1024 nt
v_mfma_f32_16x16x32_bf16 v[200:203], v[188:191], v[40:43], v[200:203]
v_cvt_pk_bf16_f32 v210, v182, v182
v_add_f32 v205, v205, v182
v_and_b32 v192, v210, v4
v_and_b32 v193, v210, v5
v_and_b32 v194, v210, v6
v_and_b32 v195, v210, v7
s_waitcnt vmcnt(3)
buffer_load_dwordx4 v[28:31], v8, s[40:43], s38 offen offset:2048 nt
v_mfma_f32_16x16x32_bf16 v[200:203], v[192:195], v[44:47], v[200:203]
v_cvt_pk_bf16_f32 v211, v183, v183
v_add_f32 v205, v205, v183
v_and_b32 v196, v211, v4
v_and_b32 v197, v211, v5
v_and_b32 v198, v211, v6
v_and_b32 v199, v211, v7
s_waitcnt vmcnt(3)
buffer_load_dwordx4 v[32:35], v8, s[40:43], s38 offen offset:3072 nt
v_mfma_f32_16x16x32_bf16 v[200:203], v[196:199], v[48:51], v[200:203]
s_mov_b32 s35, s36
s_mov_b32 s37, s38
s_add_u32 s54, s54, 1
s_cmp_lt_u32 s35, 1024
s_cbranch_scc1 L_A_loopb
L_A_out:
v_add_f32_dpp v205, v205, v205 row_bcast:15 row_mask:0xa bank_mask:0xf
s_nop 1
v_add_f32_dpp v205, v205, v205 row_bcast:31 row_mask:0xc bank_mask:0xf
s_mov_b32 exec_lo, 0
s_brev_b32 exec_hi, 1
ds_write_b64 v213, v[204:205] offset:8512
s_mov_b32 exec_lo, -1
s_mov_b32 exec_hi, 0
ds_write_b128 v212, v[200:203] offset:512
s_mov_b64 exec, -1
s_waitcnt lgkmcnt(0)
s_barrier
ds_read_b128 v[184:187], v214 offset:0
v_and_b32 v196, 7, v1
s_lshr_b32 s62, s34, 2
s_lshl_b32 s62, s62, 6
v_lshl_add_u32 v196, v196, 3, s62
ds_read_b64 v[188:189], v196 offset:8448
s_waitcnt lgkmcnt(0)
v_mov_b32 v190, v188
s_nop 1
v_max_f32_dpp v190, v190, v190 quad_perm:[1,0,3,2] row_mask:0xf bank_mask:0xf
s_nop 1
v_max_f32_dpp v190, v190, v190 quad_perm:[2,3,0,1] row_mask:0xf bank_mask:0xf
s_nop 1
v_max_f32_dpp v190, v190, v190 row_half_mirror row_mask:0xf bank_mask:0xf
v_sub_f32 v188, v188, v190
v_exp_f32 v188, v188
v_mov_b32 v196, s58
v_mul_f32 v191, v189, v188
v_mul_f32 v184, v184, v188
v_mul_f32 v185, v185, v188
v_mul_f32 v186, v186, v188
v_mul_f32 v187, v187, v188
v_add_f32_dpp v191, v191, v191 quad_perm:[1,0,3,2] row_mask:0xf bank_mask:0xf
v_add_f32_dpp v184, v184, v184 quad_perm:[1,0,3,2] row_mask:0xf bank_mask:0xf
v_add_f32_dpp v185, v185, v185 quad_perm:[1,0,3,2] row_mask:0xf bank_mask:0xf
v_add_f32_dpp v186, v186, v186 quad_perm:[1,0,3,2] row_mask:0xf bank_mask:0xf
v_add_f32_dpp v187, v187, v187 quad_perm:[1,0,3,2] row_mask:0xf bank_mask:0xf
v_add_f32_dpp v191, v191, v191 quad_perm:[2,3,0,1] row_mask:0xf bank_mask:0xf
v_add_f32_dpp v184, v184, v184 quad_perm:[2,3,0,1] row_mask:0xf bank_mask:0xf
v_add_f32_dpp v185, v185, v185 quad_perm:[2,3,0,1] row_mask:0xf bank_mask:0xf
v_add_f32_dpp v186, v186, v186 quad_perm:[2,3,0,1] row_mask:0xf bank_mask:0xf
v_add_f32_dpp v187, v187, v187 quad_perm:[2,3,0,1] row_mask:0xf bank_mask:0xf
v_add_f32_dpp v191, v191, v191 row_half_mirror row_mask:0xf bank_mask:0xf
v_add_f32_dpp v184, v184, v184 row_half_mirror row_mask:0xf bank_mask:0xf
v_add_f32_dpp v185, v185, v185 row_half_mirror row_mask:0xf bank_mask:0xf
v_add_f32_dpp v186, v186, v186 row_half_mirror row_mask:0xf bank_mask:0xf
v_add_f32_dpp v187, v187, v187 row_half_mirror row_mask:0xf bank_mask:0xf
v_max_f32 v191, 0x00800000, v191
v_log_f32 v188, v191
v_rcp_f32 v191, v191
s_mov_b32 s62, 0x05010400
s_mov_b32 s63, 0x07030602
v_add_f32 v190, v190, v188
v_mul_f32 v184, v184, v191
v_mul_f32 v185, v185, v191
v_mul_f32 v186, v186, v191
v_mul_f32 v187, v187, v191
v_perm_b32 v188, v190, v196, s62
v_perm_b32 v189, v190, v196, s63
v_cvt_pk_bf16_f32 v184, v184, v185
v_cvt_pk_bf16_f32 v185, v186, v187
s_mov_b32 exec_lo, 0x01010101
s_mov_b32 exec_hi, 0x01010101
v_perm_b32 v192, v184, v188, s60
v_perm_b32 v193, v184, v188, s61
v_perm_b32 v194, v185, v189, s60
v_perm_b32 v195, v185, v189, s61
global_store_dwordx4 v218, v[192:195], s[30:31] sc1
s_endpgm
L_A_back:
s_cmp_lg_u32 s54, 0
s_cbranch_scc1 L_A_bk1
v_dot2_f32_bf16 v180, v52, v12, 0
v_dot2_f32_bf16 v180, v53, v13, v180
v_dot2_f32_bf16 v180, v54, v14, v180
v_dot2_f32_bf16 v180, v55, v15, v180
v_dot2_f32_bf16 v181, v56, v12, 0
v_dot2_f32_bf16 v181, v57, v13, v181
v_dot2_f32_bf16 v181, v58, v14, v181
v_dot2_f32_bf16 v181, v59, v15, v181
v_dot2_f32_bf16 v182, v60, v12, 0
v_dot2_f32_bf16 v182, v61, v13, v182
v_dot2_f32_bf16 v182, v62, v14, v182
v_dot2_f32_bf16 v182, v63, v15, v182
v_dot2_f32_bf16 v183, v64, v12, 0
v_dot2_f32_bf16 v183, v65, v13, v183
v_dot2_f32_bf16 v183, v66, v14, v183
v_dot2_f32_bf16 v183, v67, v15, v183
s_nop 1
v_add_f32_dpp v180, v180, v180 row_ror:8 row_mask:0xf bank_mask:0xf
v_add_f32_dpp v181, v181, v181 row_ror:8 row_mask:0xf bank_mask:0xf
v_add_f32_dpp v182, v182, v182 row_ror:8 row_mask:0xf bank_mask:0xf
v_add_f32_dpp v183, v183, v183 row_ror:8 row_mask:0xf bank_mask:0xf
v_add_f32_dpp v180, v180, v180 row_ror:4 row_mask:0xf bank_mask:0xf
v_add_f32_dpp v181, v181, v181 row_ror:4 row_mask:0xf bank_mask:0xf
v_add_f32_dpp v182, v182, v182 row_ror:4 row_mask:0xf bank_mask:0xf
v_add_f32_dpp v183, v183, v183 row_ror:4 row_mask:0xf bank_mask:0xf
v_add_f32_dpp v180, v180, v180 row_ror:2 row_mask:0xf bank_mask:0xf
v_add_f32_dpp v181, v181, v181 row_ror:2 row_mask:0xf bank_mask:0xf
v_add_f32_dpp v182, v182, v182 row_ror:2 row_mask:0xf bank_mask:0xf
v_add_f32_dpp v183, v183, v183 row_ror:2 row_mask:0xf bank_mask:0xf
v_add_f32_dpp v180, v180, v180 row_ror:1 row_mask:0xf bank_mask:0xf
v_add_f32_dpp v181, v181, v181 row_ror:1 row_mask:0xf bank_mask:0xf
v_add_f32_dpp v182, v182, v182 row_ror:1 row_mask:0xf bank_mask:0xf
v_add_f32_dpp v183, v183, v183 row_ror:1 row_mask:0xf bank_mask:0xf
v_mul_f32 v180, v180, v208
v_mul_f32 v181, v181, v208
v_mul_f32 v182, v182, v208
v_mul_f32 v183, v183, v208
v_max3_f32 v209, v180, v181, v182
v_max_f32 v209, v209, v183
v_cmp_gt_f32 vcc, v209, v204
s_nop 0
s_cmp_lg_u64 vcc, 0
s_cbranch_scc1 L_A_maxx0
L_A_maxdx0:
v_sub_f32 v180, v180, v204
v_sub_f32 v181, v181, v204
v_sub_f32 v182, v182, v204
v_sub_f32 v183, v183, v204
v_exp_f32 v180, v180
v_exp_f32 v181, v181
v_exp_f32 v182, v182
v_exp_f32 v183, v183
v_cvt_pk_bf16_f32 v210, v180, v180
v_add_f32 v205, v205, v180
v_and_b32 v184, v210, v4
v_and_b32 v185, v210, v5
v_and_b32 v186, v210, v6
v_and_b32 v187, v210, v7
v_cvt_pk_bf16_f32 v211, v181, v181
v_add_f32 v205, v205, v181
v_and_b32 v188, v211, v4
v_and_b32 v189, v211, v5
v_and_b32 v190, v211, v6
v_and_b32 v191, v211, v7
v_cvt_pk_bf16_f32 v210, v182, v182
v_add_f32 v205, v205, v182
v_and_b32 v192, v210, v4
v_and_b32 v193, v210, v5
v_and_b32 v194, v210, v6
v_and_b32 v195, v210, v7
v_cvt_pk_bf16_f32 v211, v183, v183
v_add_f32 v205, v205, v183
v_and_b32 v196, v211, v4
v_and_b32 v197, v211, v5
v_and_b32 v198, v211, v6
v_and_b32 v199, v211, v7
v_mfma_f32_16x16x32_bf16 v[200:203], v[184:187], v[68:71], v[200:203]
v_mfma_f32_16x16x32_bf16 v[200:203], v[188:191], v[72:75], v[200:203]
v_mfma_f32_16x16x32_bf16 v[200:203], v[192:195], v[76:79], v[200:203]
v_mfma_f32_16x16x32_bf16 v[200:203], v[196:199], v[80:83], v[200:203]
s_branch L_A_backd
L_A_bk1:
s_cmp_lg_u32 s54, 1
s_cbranch_scc1 L_A_bk2
v_dot2_f32_bf16 v180, v84, v12, 0
v_dot2_f32_bf16 v180, v85, v13, v180
v_dot2_f32_bf16 v180, v86, v14, v180
v_dot2_f32_bf16 v180, v87, v15, v180
v_dot2_f32_bf16 v181, v88, v12, 0
v_dot2_f32_bf16 v181, v89, v13, v181
v_dot2_f32_bf16 v181, v90, v14, v181
v_dot2_f32_bf16 v181, v91, v15, v181
v_dot2_f32_bf16 v182, v92, v12, 0
v_dot2_f32_bf16 v182, v93, v13, v182
v_dot2_f32_bf16 v182, v94, v14, v182
v_dot2_f32_bf16 v182, v95, v15, v182
v_dot2_f32_bf16 v183, v96, v12, 0
v_dot2_f32_bf16 v183, v97, v13, v183
v_dot2_f32_bf16 v183, v98, v14, v183
v_dot2_f32_bf16 v183, v99, v15, v183
s_nop 1
v_add_f32_dpp v180, v180, v180 row_ror:8 row_mask:0xf bank_mask:0xf
v_add_f32_dpp v181, v181, v181 row_ror:8 row_mask:0xf bank_mask:0xf
v_add_f32_dpp v182, v182, v182 row_ror:8 row_mask:0xf bank_mask:0xf
v_add_f32_dpp v183, v183, v183 row_ror:8 row_mask:0xf bank_mask:0xf
v_add_f32_dpp v180, v180, v180 row_ror:4 row_mask:0xf bank_mask:0xf
v_add_f32_dpp v181, v181, v181 row_ror:4 row_mask:0xf bank_mask:0xf
v_add_f32_dpp v182, v182, v182 row_ror:4 row_mask:0xf bank_mask:0xf
v_add_f32_dpp v183, v183, v183 row_ror:4 row_mask:0xf bank_mask:0xf
v_add_f32_dpp v180, v180, v180 row_ror:2 row_mask:0xf bank_mask:0xf
v_add_f32_dpp v181, v181, v181 row_ror:2 row_mask:0xf bank_mask:0xf
v_add_f32_dpp v182, v182, v182 row_ror:2 row_mask:0xf bank_mask:0xf
v_add_f32_dpp v183, v183, v183 row_ror:2 row_mask:0xf bank_mask:0xf
v_add_f32_dpp v180, v180, v180 row_ror:1 row_mask:0xf bank_mask:0xf
v_add_f32_dpp v181, v181, v181 row_ror:1 row_mask:0xf bank_mask:0xf
v_add_f32_dpp v182, v182, v182 row_ror:1 row_mask:0xf bank_mask:0xf
v_add_f32_dpp v183, v183, v183 row_ror:1 row_mask:0xf bank_mask:0xf
v_mul_f32 v180, v180, v208
v_mul_f32 v181, v181, v208
v_mul_f32 v182, v182, v208
v_mul_f32 v183, v183, v208
v_max3_f32 v209, v180, v181, v182
v_max_f32 v209, v209, v183
v_cmp_gt_f32 vcc, v209, v204
s_nop 0
s_cmp_lg_u64 vcc, 0
s_cbranch_scc1 L_A_maxx1
L_A_maxdx1:
v_sub_f32 v180, v180, v204
v_sub_f32 v181, v181, v204
v_sub_f32 v182, v182, v204
v_sub_f32 v183, v183, v204
v_exp_f32 v180, v180
v_exp_f32 v181, v181
v_exp_f32 v182, v182
v_exp_f32 v183, v183
v_cvt_pk_bf16_f32 v210, v180, v180
v_add_f32 v205, v205, v180
v_and_b32 v184, v210, v4
v_and_b32 v185, v210, v5
v_and_b32 v186, v210, v6
v_and_b32 v187, v210, v7
v_cvt_pk_bf16_f32 v211, v181, v181
v_add_f32 v205, v205, v181
v_and_b32 v188, v211, v4
v_and_b32 v189, v211, v5
v_and_b32 v190, v211, v6
v_and_b32 v191, v211, v7
v_cvt_pk_bf16_f32 v210, v182, v182
v_add_f32 v205, v205, v182
v_and_b32 v192, v210, v4
v_and_b32 v193, v210, v5
v_and_b32 v194, v210, v6
v_and_b32 v195, v210, v7
v_cvt_pk_bf16_f32 v211, v183, v183
v_add_f32 v205, v205, v183
v_and_b32 v196, v211, v4
v_and_b32 v197, v211, v5
v_and_b32 v198, v211, v6
v_and_b32 v199, v211, v7
v_mfma_f32_16x16x32_bf16 v[200:203], v[184:187], v[100:103], v[200:203]
v_mfma_f32_16x16x32_bf16 v[200:203], v[188:191], v[104:107], v[200:203]
v_mfma_f32_16x16x32_bf16 v[200:203], v[192:195], v[108:111], v[200:203]
v_mfma_f32_16x16x32_bf16 v[200:203], v[196:199], v[112:115], v[200:203]
s_branch L_A_backd
L_A_bk2:
s_cmp_lg_u32 s54, 2
s_cbranch_scc1 L_A_bk3
v_dot2_f32_bf16 v180, v116, v12, 0
v_dot2_f32_bf16 v180, v117, v13, v180
v_dot2_f32_bf16 v180, v118, v14, v180
v_dot2_f32_bf16 v180, v119, v15, v180
v_dot2_f32_bf16 v181, v120, v12, 0
v_dot2_f32_bf16 v181, v121, v13, v181
v_dot2_f32_bf16 v181, v122, v14, v181
v_dot2_f32_bf16 v181, v123, v15, v181
v_dot2_f32_bf16 v182, v124, v12, 0
v_dot2_f32_bf16 v182, v125, v13, v182
v_dot2_f32_bf16 v182, v126, v14, v182
v_dot2_f32_bf16 v182, v127, v15, v182
v_dot2_f32_bf16 v183, v128, v12, 0
v_dot2_f32_bf16 v183, v129, v13, v183
v_dot2_f32_bf16 v183, v130, v14, v183
v_dot2_f32_bf16 v183, v131, v15, v183
s_nop 1
v_add_f32_dpp v180, v180, v180 row_ror:8 row_mask:0xf bank_mask:0xf
v_add_f32_dpp v181, v181, v181 row_ror:8 row_mask:0xf bank_mask:0xf
v_add_f32_dpp v182, v182, v182 row_ror:8 row_mask:0xf bank_mask:0xf
v_add_f32_dpp v183, v183, v183 row_ror:8 row_mask:0xf bank_mask:0xf
v_add_f32_dpp v180, v180, v180 row_ror:4 row_mask:0xf bank_mask:0xf
v_add_f32_dpp v181, v181, v181 row_ror:4 row_mask:0xf bank_mask:0xf
v_add_f32_dpp v182, v182, v182 row_ror:4 row_mask:0xf bank_mask:0xf
v_add_f32_dpp v183, v183, v183 row_ror:4 row_mask:0xf bank_mask:0xf
v_add_f32_dpp v180, v180, v180 row_ror:2 row_mask:0xf bank_mask:0xf
v_add_f32_dpp v181, v181, v181 row_ror:2 row_mask:0xf bank_mask:0xf
v_add_f32_dpp v182, v182, v182 row_ror:2 row_mask:0xf bank_mask:0xf
v_add_f32_dpp v183, v183, v183 row_ror:2 row_mask:0xf bank_mask:0xf
v_add_f32_dpp v180, v180, v180 row_ror:1 row_mask:0xf bank_mask:0xf
v_add_f32_dpp v181, v181, v181 row_ror:1 row_mask:0xf bank_mask:0xf
v_add_f32_dpp v182, v182, v182 row_ror:1 row_mask:0xf bank_mask:0xf
v_add_f32_dpp v183, v183, v183 row_ror:1 row_mask:0xf bank_mask:0xf
v_mul_f32 v180, v180, v208
v_mul_f32 v181, v181, v208
v_mul_f32 v182, v182, v208
v_mul_f32 v183, v183, v208
v_max3_f32 v209, v180, v181, v182
v_max_f32 v209, v209, v183
v_cmp_gt_f32 vcc, v209, v204
s_nop 0
s_cmp_lg_u64 vcc, 0
s_cbranch_scc1 L_A_maxx2
L_A_maxdx2:
v_sub_f32 v180, v180, v204
v_sub_f32 v181, v181, v204
v_sub_f32 v182, v182, v204
v_sub_f32 v183, v183, v204
v_exp_f32 v180, v180
v_exp_f32 v181, v181
v_exp_f32 v182, v182
v_exp_f32 v183, v183
v_cvt_pk_bf16_f32 v210, v180, v180
v_add_f32 v205, v205, v180
v_and_b32 v184, v210, v4
v_and_b32 v185, v210, v5
v_and_b32 v186, v210, v6
v_and_b32 v187, v210, v7
v_cvt_pk_bf16_f32 v211, v181, v181
v_add_f32 v205, v205, v181
v_and_b32 v188, v211, v4
v_and_b32 v189, v211, v5
v_and_b32 v190, v211, v6
v_and_b32 v191, v211, v7
v_cvt_pk_bf16_f32 v210, v182, v182
v_add_f32 v205, v205, v182
v_and_b32 v192, v210, v4
v_and_b32 v193, v210, v5
v_and_b32 v194, v210, v6
v_and_b32 v195, v210, v7
v_cvt_pk_bf16_f32 v211, v183, v183
v_add_f32 v205, v205, v183
v_and_b32 v196, v211, v4
v_and_b32 v197, v211, v5
v_and_b32 v198, v211, v6
v_and_b32 v199, v211, v7
v_mfma_f32_16x16x32_bf16 v[200:203], v[184:187], v[132:135], v[200:203]
v_mfma_f32_16x16x32_bf16 v[200:203], v[188:191], v[136:139], v[200:203]
v_mfma_f32_16x16x32_bf16 v[200:203], v[192:195], v[140:143], v[200:203]
v_mfma_f32_16x16x32_bf16 v[200:203], v[196:199], v[144:147], v[200:203]
s_branch L_A_backd
L_A_bk3:
v_dot2_f32_bf16 v180, v148, v12, 0
v_dot2_f32_bf16 v180, v149, v13, v180
v_dot2_f32_bf16 v180, v150, v14, v180
v_dot2_f32_bf16 v180, v151, v15, v180
v_dot2_f32_bf16 v181, v152, v12, 0
v_dot2_f32_bf16 v181, v153, v13, v181
v_dot2_f32_bf16 v181, v154, v14, v181
v_dot2_f32_bf16 v181, v155, v15, v181
v_dot2_f32_bf16 v182, v156, v12, 0
v_dot2_f32_bf16 v182, v157, v13, v182
v_dot2_f32_bf16 v182, v158, v14, v182
v_dot2_f32_bf16 v182, v159, v15, v182
v_dot2_f32_bf16 v183, v160, v12, 0
v_dot2_f32_bf16 v183, v161, v13, v183
v_dot2_f32_bf16 v183, v162, v14, v183
v_dot2_f32_bf16 v183, v163, v15, v183
s_nop 1
v_add_f32_dpp v180, v180, v180 row_ror:8 row_mask:0xf bank_mask:0xf
v_add_f32_dpp v181, v181, v181 row_ror:8 row_mask:0xf bank_mask:0xf
v_add_f32_dpp v182, v182, v182 row_ror:8 row_mask:0xf bank_mask:0xf
v_add_f32_dpp v183, v183, v183 row_ror:8 row_mask:0xf bank_mask:0xf
v_add_f32_dpp v180, v180, v180 row_ror:4 row_mask:0xf bank_mask:0xf
v_add_f32_dpp v181, v181, v181 row_ror:4 row_mask:0xf bank_mask:0xf
v_add_f32_dpp v182, v182, v182 row_ror:4 row_mask:0xf bank_mask:0xf
v_add_f32_dpp v183, v183, v183 row_ror:4 row_mask:0xf bank_mask:0xf
v_add_f32_dpp v180, v180, v180 row_ror:2 row_mask:0xf bank_mask:0xf
v_add_f32_dpp v181, v181, v181 row_ror:2 row_mask:0xf bank_mask:0xf
v_add_f32_dpp v182, v182, v182 row_ror:2 row_mask:0xf bank_mask:0xf
v_add_f32_dpp v183, v183, v183 row_ror:2 row_mask:0xf bank_mask:0xf
v_add_f32_dpp v180, v180, v180 row_ror:1 row_mask:0xf bank_mask:0xf
v_add_f32_dpp v181, v181, v181 row_ror:1 row_mask:0xf bank_mask:0xf
v_add_f32_dpp v182, v182, v182 row_ror:1 row_mask:0xf bank_mask:0xf
v_add_f32_dpp v183, v183, v183 row_ror:1 row_mask:0xf bank_mask:0xf
v_mul_f32 v180, v180, v208
v_mul_f32 v181, v181, v208
v_mul_f32 v182, v182, v208
v_mul_f32 v183, v183, v208
v_max3_f32 v209, v180, v181, v182
v_max_f32 v209, v209, v183
v_cmp_gt_f32 vcc, v209, v204
s_nop 0
s_cmp_lg_u64 vcc, 0
s_cbranch_scc1 L_A_maxx3
L_A_maxdx3:
v_sub_f32 v180, v180, v204
v_sub_f32 v181, v181, v204
v_sub_f32 v182, v182, v204
v_sub_f32 v183, v183, v204
v_exp_f32 v180, v180
v_exp_f32 v181, v181
v_exp_f32 v182, v182
v_exp_f32 v183, v183
v_cvt_pk_bf16_f32 v210, v180, v180
v_add_f32 v205, v205, v180
v_and_b32 v184, v210, v4
v_and_b32 v185, v210, v5
v_and_b32 v186, v210, v6
v_and_b32 v187, v210, v7
v_cvt_pk_bf16_f32 v211, v181, v181
v_add_f32 v205, v205, v181
v_and_b32 v188, v211, v4
v_and_b32 v189, v211, v5
v_and_b32 v190, v211, v6
v_and_b32 v191, v211, v7
v_cvt_pk_bf16_f32 v210, v182, v182
v_add_f32 v205, v205, v182
v_and_b32 v192, v210, v4
v_and_b32 v193, v210, v5
v_and_b32 v194, v210, v6
v_and_b32 v195, v210, v7
v_cvt_pk_bf16_f32 v211, v183, v183
v_add_f32 v205, v205, v183
v_and_b32 v196, v211, v4
v_and_b32 v197, v211, v5
v_and_b32 v198, v211, v6
v_and_b32 v199, v211, v7
v_mfma_f32_16x16x32_bf16 v[200:203], v[184:187], v[164:167], v[200:203]
v_mfma_f32_16x16x32_bf16 v[200:203], v[188:191], v[168:171], v[200:203]
v_mfma_f32_16x16x32_bf16 v[200:203], v[192:195], v[172:175], v[200:203]
v_mfma_f32_16x16x32_bf16 v[200:203], v[196:199], v[176:179], v[200:203]
s_branch L_A_backd
L_A_swb:
s_nop 1
v_add_f32_dpp v205, v205, v205 row_bcast:15 row_mask:0xa bank_mask:0xf
s_nop 1
v_add_f32_dpp v205, v205, v205 row_bcast:31 row_mask:0xc bank_mask:0xf
s_mov_b32 exec_lo, 0
s_brev_b32 exec_hi, 1
ds_write_b64 v213, v[204:205] offset:8448
s_mov_b32 exec_lo, -1
s_mov_b32 exec_hi, 0
ds_write_b128 v212, v[200:203] offset:0
s_mov_b64 exec, -1
s_waitcnt lgkmcnt(0)
s_mov_b32 s56, 1
v_mov_b32 v204, 0xff7fffff
v_mov_b32 v205, 0
v_mov_b32 v200, 0
v_mov_b32 v12, v16
v_mov_b32 v201, 0
v_mov_b32 v13, v17
v_mov_b32 v202, 0
v_mov_b32 v14, v18
v_mov_b32 v203, 0
v_mov_b32 v15, v19
s_branch L_A_swdb
L_A_maxb:
v_max_f32_dpp v209, v209, v209 row_bcast:15 row_mask:0xa bank_mask:0xf
s_nop 1
v_max_f32_dpp v209, v209, v209 row_bcast:31 row_mask:0xc bank_mask:0xf
s_nop 0
v_readlane_b32 s62, v209, 63
s_nop 1
v_max_f32 v207, s62, v204
v_sub_f32 v206, v204, v207
v_exp_f32 v206, v206
v_mov_b32 v204, v207
v_mul_f32 v200, v200, v206
v_mul_f32 v201, v201, v206
v_mul_f32 v202, v202, v206
v_mul_f32 v203, v203, v206
v_mul_f32 v205, v205, v206
s_branch L_A_maxdb
L_A_maxx0:
v_max_f32_dpp v209, v209, v209 row_bcast:15 row_mask:0xa bank_mask:0xf
s_nop 1
v_max_f32_dpp v209, v209, v209 row_bcast:31 row_mask:0xc bank_mask:0xf
s_nop 0
v_readlane_b32 s62, v209, 63
s_nop 1
v_max_f32 v207, s62, v204
v_sub_f32 v206, v204, v207
v_exp_f32 v206, v206
v_mov_b32 v204, v207
v_mul_f32 v200, v200, v206
v_mul_f32 v201, v201, v206
v_mul_f32 v202, v202, v206
v_mul_f32 v203, v203, v206
v_mul_f32 v205, v205, v206
s_branch L_A_maxdx0
L_A_maxx1:
v_max_f32_dpp v209, v209, v209 row_bcast:15 row_mask:0xa bank_mask:0xf
s_nop 1
v_max_f32_dpp v209, v209, v209 row_bcast:31 row_mask:0xc bank_mask:0xf
s_nop 0
v_readlane_b32 s62, v209, 63
s_nop 1
v_max_f32 v207, s62, v204
v_sub_f32 v206, v204, v207
v_exp_f32 v206, v206
v_mov_b32 v204, v207
v_mul_f32 v200, v200, v206
v_mul_f32 v201, v201, v206
v_mul_f32 v202, v202, v206
v_mul_f32 v203, v203, v206
v_mul_f32 v205, v205, v206
s_branch L_A_maxdx1
L_A_maxx2:
v_max_f32_dpp v209, v209, v209 row_bcast:15 row_mask:0xa bank_mask:0xf
s_nop 1
v_max_f32_dpp v209, v209, v209 row_bcast:31 row_mask:0xc bank_mask:0xf
s_nop 0
v_readlane_b32 s62, v209, 63
s_nop 1
v_max_f32 v207, s62, v204
v_sub_f32 v206, v204, v207
v_exp_f32 v206, v206
v_mov_b32 v204, v207
v_mul_f32 v200, v200, v206
v_mul_f32 v201, v201, v206
v_mul_f32 v202, v202, v206
v_mul_f32 v203, v203, v206
v_mul_f32 v205, v205, v206
s_branch L_A_maxdx2
L_A_maxx3:
v_max_f32_dpp v209, v209, v209 row_bcast:15 row_mask:0xa bank_mask:0xf
s_nop 1
v_max_f32_dpp v209, v209, v209 row_bcast:31 row_mask:0xc bank_mask:0xf
s_nop 0
v_readlane_b32 s62, v209, 63
s_nop 1
v_max_f32 v207, s62, v204
v_sub_f32 v206, v204, v207
v_exp_f32 v206, v206
v_mov_b32 v204, v207
v_mul_f32 v200, v200, v206
v_mul_f32 v201, v201, v206
v_mul_f32 v202, v202, v206
v_mul_f32 v203, v203, v206
v_mul_f32 v205, v205, v206
s_branch L_A_maxdx3
L_roleW:
s_lshl_b32 s60, s32, 8
s_sub_u32 s61, 0x400000, s60
s_add_u32 s40, s18, s60
s_addc_u32 s41, s19, 0
s_and_b32 s41, s41, 0xffff
s_mov_b32 s42, s61
s_mov_b32 s43, 0x20000
s_add_u32 s44, s20, s60
s_addc_u32 s45, s21, 0
s_and_b32 s45, s45, 0xffff
s_mov_b32 s46, s61
s_mov_b32 s47, 0x20000
s_mov_b32 s48, s14
s_and_b32 s49, s15, 0xffff
s_mov_b32 s50, 0x800
s_mov_b32 s51, 0x20000
v_lshrrev_b32 v192, 3, v2
v_lshlrev_b32 v192, 10, v192
v_lshl_add_u32 v192, v3, 5, v192
s_lshl_b32 s62, s34, 7
v_add_u32 v192, s62, v192
s_mov_b32 s80, 0
buffer_load_dwordx4 v[12:15], v192, s[48:51], 0 offen
buffer_load_dwordx4 v[16:19], v192, s[48:51], 0 offen offset:16
v_lshlrev_b32 v9, 17, v3
v_lshl_add_u32 v9, v2, 4, v9
s_lshl_b32 s62, s34, 19
v_add_u32 v9, s62, v9
s_xor_b32 s62, s80, 0
buffer_load_dwordx4 v[64:67], v9, s[40:43], s62 offen nt
s_xor_b32 s62, s80, 8192
buffer_load_dwordx4 v[68:71], v9, s[40:43], s62 offen nt
s_xor_b32 s62, s80, 16384
buffer_load_dwordx4 v[72:75], v9, s[40:43], s62 offen nt
s_xor_b32 s62, s80, 24576
buffer_load_dwordx4 v[76:79], v9, s[40:43], s62 offen nt
s_xor_b32 s62, s80, 32768
buffer_load_dwordx4 v[80:83], v9, s[40:43], s62 offen nt
s_xor_b32 s62, s80, 40960
buffer_load_dwordx4 v[84:87], v9, s[40:43], s62 offen nt
s_xor_b32 s62, s80, 49152
buffer_load_dwordx4 v[88:91], v9, s[40:43], s62 offen nt
s_xor_b32 s62, s80, 57344
buffer_load_dwordx4 v[92:95], v9, s[40:43], s62 offen nt
s_xor_b32 s62, s80, 65536
buffer_load_dwordx4 v[96:99], v9, s[40:43], s62 offen nt
s_xor_b32 s62, s80, 73728
buffer_load_dwordx4 v[100:103], v9, s[40:43], s62 offen nt
s_xor_b32 s62, s80, 81920
buffer_load_dwordx4 v[104:107], v9, s[40:43], s62 offen nt
s_xor_b32 s62, s80, 90112
buffer_load_dwordx4 v[108:111], v9, s[40:43], s62 offen nt
s_xor_b32 s62, s80, 98304
buffer_load_dwordx4 v[112:115], v9, s[40:43], s62 offen nt
s_xor_b32 s62, s80, 106496
buffer_load_dwordx4 v[116:119], v9, s[40:43], s62 offen nt
s_xor_b32 s62, s80, 114688
buffer_load_dwordx4 v[120:123], v9, s[40:43], s62 offen nt
s_xor_b32 s62, s80, 122880
buffer_load_dwordx4 v[124:127], v9, s[40:43], s62 offen nt
v_mov_b32 v8, 0
s_mov_b32 s52, s30
s_and_b32 s53, s31, 0xffff
s_mov_b32 s54, 0x1000000
s_mov_b32 s55, 0x20000
s_load_dword s58, s[30:31], 0x14000
v_and_b32 v192, 1, v0
v_lshlrev_b32 v192, 4, v192
v_mov_b32 v193, 0xffff
v_lshlrev_b32 v192, v192, v193
v_bfe_u32 v193, v0, 1, 2
v_cmp_eq_u32 vcc, 0, v193
s_nop 1
v_cndmask_b32 v4, 0, v192, vcc
v_cmp_eq_u32 vcc, 1, v193
s_nop 1
v_cndmask_b32 v5, 0, v192, vcc
v_cmp_eq_u32 vcc, 2, v193
s_nop 1
v_cndmask_b32 v6, 0, v192, vcc
v_cmp_eq_u32 vcc, 3, v193
s_nop 1
v_cndmask_b32 v7, 0, v192, vcc
s_barrier
s_waitcnt vmcnt(16)
s_mov_b32 s60, 0x01000100
v_perm_b32 v192, v12, v12, s60
v_and_b32 v28, v192, v4
v_and_b32 v29, v192, v5
v_and_b32 v30, v192, v6
v_and_b32 v31, v192, v7
s_waitcnt vmcnt(15)
s_nop 0
v_mfma_f32_16x16x32_bf16 v[44:47], v[28:31], v[64:67], 0
s_xor_b32 s62, s80, 0
buffer_load_dwordx4 v[128:131], v9, s[44:47], s62 offen nt
s_mov_b32 s60, 0x03020302
v_perm_b32 v193, v12, v12, s60
v_and_b32 v32, v193, v4
v_and_b32 v33, v193, v5
v_and_b32 v34, v193, v6
v_and_b32 v35, v193, v7
s_waitcnt vmcnt(15)
s_nop 0
v_mfma_f32_16x16x32_bf16 v[44:47], v[32:35], v[68:71], v[44:47]
s_xor_b32 s62, s80, 8192
buffer_load_dwordx4 v[132:135], v9, s[44:47], s62 offen nt
s_mov_b32 s60, 0x01000100
v_perm_b32 v192, v13, v13, s60
v_and_b32 v28, v192, v4
v_and_b32 v29, v192, v5
v_and_b32 v30, v192, v6
v_and_b32 v31, v192, v7
s_waitcnt vmcnt(15)
s_nop 0
v_mfma_f32_16x16x32_bf16 v[44:47], v[28:31], v[72:75], v[44:47]
s_xor_b32 s62, s80, 16384
buffer_load_dwordx4 v[136:139], v9, s[44:47], s62 offen nt
s_mov_b32 s60, 0x03020302
v_perm_b32 v193, v13, v13, s60
v_and_b32 v32, v193, v4
v_and_b32 v33, v193, v5
v_and_b32 v34, v193, v6
v_and_b32 v35, v193, v7
s_waitcnt vmcnt(15)
s_nop 0
v_mfma_f32_16x16x32_bf16 v[44:47], v[32:35], v[76:79], v[44:47]
s_xor_b32 s62, s80, 24576
buffer_load_dwordx4 v[140:143], v9, s[44:47], s62 offen nt
s_mov_b32 s60, 0x01000100
v_perm_b32 v192, v14, v14, s60
v_and_b32 v28, v192, v4
v_and_b32 v29, v192, v5
v_and_b32 v30, v192, v6
v_and_b32 v31, v192, v7
s_waitcnt vmcnt(15)
s_nop 0
v_mfma_f32_16x16x32_bf16 v[44:47], v[28:31], v[80:83], v[44:47]
s_xor_b32 s62, s80, 32768
buffer_load_dwordx4 v[144:147], v9, s[44:47], s62 offen nt
s_mov_b32 s60, 0x03020302
v_perm_b32 v193, v14, v14, s60
v_and_b32 v32, v193, v4
v_and_b32 v33, v193, v5
v_and_b32 v34, v193, v6
v_and_b32 v35, v193, v7
s_waitcnt vmcnt(15)
s_nop 0
v_mfma_f32_16x16x32_bf16 v[44:47], v[32:35], v[84:87], v[44:47]
s_xor_b32 s62, s80, 40960
buffer_load_dwordx4 v[148:151], v9, s[44:47], s62 offen nt
s_mov_b32 s60, 0x01000100
v_perm_b32 v192, v15, v15, s60
v_and_b32 v28, v192, v4
v_and_b32 v29, v192, v5
v_and_b32 v30, v192, v6
v_and_b32 v31, v192, v7
s_waitcnt vmcnt(15)
s_nop 0
v_mfma_f32_16x16x32_bf16 v[44:47], v[28:31], v[88:91], v[44:47]
s_xor_b32 s62, s80, 49152
buffer_load_dwordx4 v[152:155], v9, s[44:47], s62 offen nt
s_mov_b32 s60, 0x03020302
v_perm_b32 v193, v15, v15, s60
v_and_b32 v32, v193, v4
v_and_b32 v33, v193, v5
v_and_b32 v34, v193, v6
v_and_b32 v35, v193, v7
s_waitcnt vmcnt(15)
s_nop 0
v_mfma_f32_16x16x32_bf16 v[44:47], v[32:35], v[92:95], v[44:47]
s_xor_b32 s62, s80, 57344
buffer_load_dwordx4 v[156:159], v9, s[44:47], s62 offen nt
s_mov_b32 s60, 0x01000100
v_perm_b32 v192, v16, v16, s60
v_and_b32 v28, v192, v4
v_and_b32 v29, v192, v5
v_and_b32 v30, v192, v6
v_and_b32 v31, v192, v7
s_waitcnt vmcnt(15)
s_nop 0
v_mfma_f32_16x16x32_bf16 v[44:47], v[28:31], v[96:99], v[44:47]
s_xor_b32 s62, s80, 65536
buffer_load_dwordx4 v[160:163], v9, s[44:47], s62 offen nt
s_mov_b32 s60, 0x03020302
v_perm_b32 v193, v16, v16, s60
v_and_b32 v32, v193, v4
v_and_b32 v33, v193, v5
v_and_b32 v34, v193, v6
v_and_b32 v35, v193, v7
s_waitcnt vmcnt(15)
s_nop 0
v_mfma_f32_16x16x32_bf16 v[44:47], v[32:35], v[100:103], v[44:47]
s_xor_b32 s62, s80, 73728
buffer_load_dwordx4 v[164:167], v9, s[44:47], s62 offen nt
s_mov_b32 s60, 0x01000100
v_perm_b32 v192, v17, v17, s60
v_and_b32 v28, v192, v4
v_and_b32 v29, v192, v5
v_and_b32 v30, v192, v6
v_and_b32 v31, v192, v7
s_waitcnt vmcnt(15)
s_nop 0
v_mfma_f32_16x16x32_bf16 v[44:47], v[28:31], v[104:107], v[44:47]
s_xor_b32 s62, s80, 81920
buffer_load_dwordx4 v[168:171], v9, s[44:47], s62 offen nt
s_mov_b32 s60, 0x03020302
v_perm_b32 v193, v17, v17, s60
v_and_b32 v32, v193, v4
v_and_b32 v33, v193, v5
v_and_b32 v34, v193, v6
v_and_b32 v35, v193, v7
s_waitcnt vmcnt(15)
s_nop 0
v_mfma_f32_16x16x32_bf16 v[44:47], v[32:35], v[108:111], v[44:47]
s_xor_b32 s62, s80, 90112
buffer_load_dwordx4 v[172:175], v9, s[44:47], s62 offen nt
s_mov_b32 s60, 0x01000100
v_perm_b32 v192, v18, v18, s60
v_and_b32 v28, v192, v4
v_and_b32 v29, v192, v5
v_and_b32 v30, v192, v6
v_and_b32 v31, v192, v7
s_waitcnt vmcnt(15)
s_nop 0
v_mfma_f32_16x16x32_bf16 v[44:47], v[28:31], v[112:115], v[44:47]
s_xor_b32 s62, s80, 98304
buffer_load_dwordx4 v[176:179], v9, s[44:47], s62 offen nt
s_mov_b32 s60, 0x03020302
v_perm_b32 v193, v18, v18, s60
v_and_b32 v32, v193, v4
v_and_b32 v33, v193, v5
v_and_b32 v34, v193, v6
v_and_b32 v35, v193, v7
s_waitcnt vmcnt(15)
s_nop 0
v_mfma_f32_16x16x32_bf16 v[44:47], v[32:35], v[116:119], v[44:47]
s_xor_b32 s62, s80, 106496
buffer_load_dwordx4 v[180:183], v9, s[44:47], s62 offen nt
s_mov_b32 s60, 0x01000100
v_perm_b32 v192, v19, v19, s60
v_and_b32 v28, v192, v4
v_and_b32 v29, v192, v5
v_and_b32 v30, v192, v6
v_and_b32 v31, v192, v7
s_waitcnt vmcnt(15)
s_nop 0
v_mfma_f32_16x16x32_bf16 v[44:47], v[28:31], v[120:123], v[44:47]
s_xor_b32 s62, s80, 114688
buffer_load_dwordx4 v[184:187], v9, s[44:47], s62 offen nt
s_mov_b32 s60, 0x03020302
v_perm_b32 v193, v19, v19, s60
v_and_b32 v32, v193, v4
v_and_b32 v33, v193, v5
v_and_b32 v34, v193, v6
v_and_b32 v35, v193, v7
s_waitcnt vmcnt(15)
s_nop 0
v_mfma_f32_16x16x32_bf16 v[44:47], v[32:35], v[124:127], v[44:47]
s_xor_b32 s62, s80, 122880
buffer_load_dwordx4 v[188:191], v9, s[44:47], s62 offen nt
v_lshrrev_b32 v192, 1, v3
v_lshlrev_b32 v192, 9, v192
v_lshl_add_u32 v192, v2, 5, v192
v_and_b32 v193, 1, v3
v_lshl_add_u32 v192, v193, 4, v192
s_lshl_b32 s63, s34, 10
v_add_u32 v192, s63, v192
s_nop 1
s_nop 5
ds_write_b128 v192, v[44:47] offset:0
s_waitcnt lgkmcnt(0)
s_barrier
s_cmp_ge_u32 s34, 4
s_cbranch_scc1 L_W_qskip
v_lshlrev_b32 v194, 2, v0
ds_read_b32 v196, v194 offset:0
ds_read_b32 v197, v194 offset:1024
ds_read_b32 v198, v194 offset:2048
ds_read_b32 v199, v194 offset:3072
ds_read_b32 v200, v194 offset:4096
ds_read_b32 v201, v194 offset:5120
ds_read_b32 v202, v194 offset:6144
ds_read_b32 v203, v194 offset:7168
s_waitcnt lgkmcnt(0)
v_add_f32 v196, v196, v197
v_add_f32 v196, v196, v198
v_add_f32 v196, v196, v199
v_add_f32 v196, v196, v200
v_add_f32 v196, v196, v201
v_add_f32 v196, v196, v202
v_add_f32 v196, v196, v203
v_cvt_pk_bf16_f32 v196, v196, v196
v_lshlrev_b32 v194, 1, v0
ds_write_b16 v194, v196 offset:8192
s_waitcnt lgkmcnt(0)
L_W_qskip:
s_barrier
v_lshlrev_b32 v194, 4, v2
ds_read_b128 v[20:23], v194 offset:8192
ds_read_b128 v[24:27], v194 offset:8448
v_mov_b32 v200, 0
v_mov_b32 v201, 0
s_lshr_b32 s62, s80, 13
v_xor_b32 v202, s62, v2
s_waitcnt lgkmcnt(0)
s_add_u32 s58, s58, 0x9e3779b9
s_bfe_u32 s76, s58, 0x80000
s_bfe_u32 s77, s58, 0x80008
s_bfe_u32 s78, s58, 0x80010
s_bfe_u32 s79, s58, 0x80018
s_waitcnt vmcnt(14)
v_dot2_f32_bf16 v60, v128, v20, 0
v_dot2_f32_bf16 v61, v128, v24, 0
v_dot2_f32_bf16 v62, v132, v20, 0
v_dot2_f32_bf16 v63, v132, v24, 0
v_dot2_f32_bf16 v60, v129, v21, v60
v_dot2_f32_bf16 v61, v129, v25, v61
v_dot2_f32_bf16 v62, v133, v21, v62
v_dot2_f32_bf16 v63, v133, v25, v63
v_dot2_f32_bf16 v60, v130, v22, v60
v_dot2_f32_bf16 v61, v130, v26, v61
v_dot2_f32_bf16 v62, v134, v22, v62
v_dot2_f32_bf16 v63, v134, v26, v63
v_dot2_f32_bf16 v60, v131, v23, v60
v_dot2_f32_bf16 v61, v131, v27, v61
v_dot2_f32_bf16 v62, v135, v23, v62
v_dot2_f32_bf16 v63, v135, v27, v63
v_add_f32_dpp v60, v60, v60 row_ror:8 row_mask:0xf bank_mask:0xf
v_add_f32_dpp v61, v61, v61 row_ror:8 row_mask:0xf bank_mask:0xf
v_add_f32_dpp v62, v62, v62 row_ror:8 row_mask:0xf bank_mask:0xf
v_add_f32_dpp v63, v63, v63 row_ror:8 row_mask:0xf bank_mask:0xf
v_add_f32_dpp v60, v60, v60 row_ror:4 row_mask:0xf bank_mask:0xf
v_add_f32_dpp v61, v61, v61 row_ror:4 row_mask:0xf bank_mask:0xf
v_add_f32_dpp v62, v62, v62 row_ror:4 row_mask:0xf bank_mask:0xf
v_add_f32_dpp v63, v63, v63 row_ror:4 row_mask:0xf bank_mask:0xf
v_add_f32_dpp v60, v60, v60 row_ror:2 row_mask:0xf bank_mask:0xf
v_add_f32_dpp v61, v61, v61 row_ror:2 row_mask:0xf bank_mask:0xf
v_add_f32_dpp v62, v62, v62 row_ror:2 row_mask:0xf bank_mask:0xf
v_add_f32_dpp v63, v63, v63 row_ror:2 row_mask:0xf bank_mask:0xf
v_add_f32_dpp v60, v60, v60 row_ror:1 row_mask:0xf bank_mask:0xf
v_add_f32_dpp v61, v61, v61 row_ror:1 row_mask:0xf bank_mask:0xf
v_add_f32_dpp v62, v62, v62 row_ror:1 row_mask:0xf bank_mask:0xf
v_add_f32_dpp v63, v63, v63 row_ror:1 row_mask:0xf bank_mask:0xf
v_cmp_eq_u32 vcc, 0, v202
s_nop 1
v_cndmask_b32 v200, v200, v60, vcc
v_cndmask_b32 v201, v201, v61, vcc
v_cmp_eq_u32 vcc, 1, v202
s_nop 1
v_cndmask_b32 v200, v200, v62, vcc
v_cndmask_b32 v201, v201, v63, vcc
s_waitcnt vmcnt(12)
v_dot2_f32_bf16 v60, v136, v20, 0
v_dot2_f32_bf16 v61, v136, v24, 0
v_dot2_f32_bf16 v62, v140, v20, 0
v_dot2_f32_bf16 v63, v140, v24, 0
v_dot2_f32_bf16 v60, v137, v21, v60
v_dot2_f32_bf16 v61, v137, v25, v61
v_dot2_f32_bf16 v62, v141, v21, v62
v_dot2_f32_bf16 v63, v141, v25, v63
v_dot2_f32_bf16 v60, v138, v22, v60
v_dot2_f32_bf16 v61, v138, v26, v61
v_dot2_f32_bf16 v62, v142, v22, v62
v_dot2_f32_bf16 v63, v142, v26, v63
v_dot2_f32_bf16 v60, v139, v23, v60
v_dot2_f32_bf16 v61, v139, v27, v61
v_dot2_f32_bf16 v62, v143, v23, v62
v_dot2_f32_bf16 v63, v143, v27, v63
v_add_f32_dpp v60, v60, v60 row_ror:8 row_mask:0xf bank_mask:0xf
v_add_f32_dpp v61, v61, v61 row_ror:8 row_mask:0xf bank_mask:0xf
v_add_f32_dpp v62, v62, v62 row_ror:8 row_mask:0xf bank_mask:0xf
v_add_f32_dpp v63, v63, v63 row_ror:8 row_mask:0xf bank_mask:0xf
v_add_f32_dpp v60, v60, v60 row_ror:4 row_mask:0xf bank_mask:0xf
v_add_f32_dpp v61, v61, v61 row_ror:4 row_mask:0xf bank_mask:0xf
v_add_f32_dpp v62, v62, v62 row_ror:4 row_mask:0xf bank_mask:0xf
v_add_f32_dpp v63, v63, v63 row_ror:4 row_mask:0xf bank_mask:0xf
v_add_f32_dpp v60, v60, v60 row_ror:2 row_mask:0xf bank_mask:0xf
v_add_f32_dpp v61, v61, v61 row_ror:2 row_mask:0xf bank_mask:0xf
v_add_f32_dpp v62, v62, v62 row_ror:2 row_mask:0xf bank_mask:0xf
v_add_f32_dpp v63, v63, v63 row_ror:2 row_mask:0xf bank_mask:0xf
v_add_f32_dpp v60, v60, v60 row_ror:1 row_mask:0xf bank_mask:0xf
v_add_f32_dpp v61, v61, v61 row_ror:1 row_mask:0xf bank_mask:0xf
v_add_f32_dpp v62, v62, v62 row_ror:1 row_mask:0xf bank_mask:0xf
v_add_f32_dpp v63, v63, v63 row_ror:1 row_mask:0xf bank_mask:0xf
v_cmp_eq_u32 vcc, 2, v202
s_nop 1
v_cndmask_b32 v200, v200, v60, vcc
v_cndmask_b32 v201, v201, v61, vcc
v_cmp_eq_u32 vcc, 3, v202
s_nop 1
v_cndmask_b32 v200, v200, v62, vcc
v_cndmask_b32 v201, v201, v63, vcc
s_waitcnt vmcnt(10)
v_dot2_f32_bf16 v60, v144, v20, 0
v_dot2_f32_bf16 v61, v144, v24, 0
v_dot2_f32_bf16 v62, v148, v20, 0
v_dot2_f32_bf16 v63, v148, v24, 0
v_dot2_f32_bf16 v60, v145, v21, v60
v_dot2_f32_bf16 v61, v145, v25, v61
v_dot2_f32_bf16 v62, v149, v21, v62
v_dot2_f32_bf16 v63, v149, v25, v63
v_dot2_f32_bf16 v60, v146, v22, v60
v_dot2_f32_bf16 v61, v146, v26, v61
v_dot2_f32_bf16 v62, v150, v22, v62
v_dot2_f32_bf16 v63, v150, v26, v63
v_dot2_f32_bf16 v60, v147, v23, v60
v_dot2_f32_bf16 v61, v147, v27, v61
v_dot2_f32_bf16 v62, v151, v23, v62
v_dot2_f32_bf16 v63, v151, v27, v63
v_add_f32_dpp v60, v60, v60 row_ror:8 row_mask:0xf bank_mask:0xf
v_add_f32_dpp v61, v61, v61 row_ror:8 row_mask:0xf bank_mask:0xf
v_add_f32_dpp v62, v62, v62 row_ror:8 row_mask:0xf bank_mask:0xf
v_add_f32_dpp v63, v63, v63 row_ror:8 row_mask:0xf bank_mask:0xf
v_add_f32_dpp v60, v60, v60 row_ror:4 row_mask:0xf bank_mask:0xf
v_add_f32_dpp v61, v61, v61 row_ror:4 row_mask:0xf bank_mask:0xf
v_add_f32_dpp v62, v62, v62 row_ror:4 row_mask:0xf bank_mask:0xf
v_add_f32_dpp v63, v63, v63 row_ror:4 row_mask:0xf bank_mask:0xf
v_add_f32_dpp v60, v60, v60 row_ror:2 row_mask:0xf bank_mask:0xf
v_add_f32_dpp v61, v61, v61 row_ror:2 row_mask:0xf bank_mask:0xf
v_add_f32_dpp v62, v62, v62 row_ror:2 row_mask:0xf bank_mask:0xf
v_add_f32_dpp v63, v63, v63 row_ror:2 row_mask:0xf bank_mask:0xf
v_add_f32_dpp v60, v60, v60 row_ror:1 row_mask:0xf bank_mask:0xf
v_add_f32_dpp v61, v61, v61 row_ror:1 row_mask:0xf bank_mask:0xf
v_add_f32_dpp v62, v62, v62 row_ror:1 row_mask:0xf bank_mask:0xf
v_add_f32_dpp v63, v63, v63 row_ror:1 row_mask:0xf bank_mask:0xf
v_cmp_eq_u32 vcc, 4, v202
s_nop 1
v_cndmask_b32 v200, v200, v60, vcc
v_cndmask_b32 v201, v201, v61, vcc
v_cmp_eq_u32 vcc, 5, v202
s_nop 1
v_cndmask_b32 v200, v200, v62, vcc
v_cndmask_b32 v201, v201, v63, vcc
s_waitcnt vmcnt(8)
v_dot2_f32_bf16 v60, v152, v20, 0
v_dot2_f32_bf16 v61, v152, v24, 0
v_dot2_f32_bf16 v62, v156, v20, 0
v_dot2_f32_bf16 v63, v156, v24, 0
v_dot2_f32_bf16 v60, v153, v21, v60
v_dot2_f32_bf16 v61, v153, v25, v61
v_dot2_f32_bf16 v62, v157, v21, v62
v_dot2_f32_bf16 v63, v157, v25, v63
v_dot2_f32_bf16 v60, v154, v22, v60
v_dot2_f32_bf16 v61, v154, v26, v61
v_dot2_f32_bf16 v62, v158, v22, v62
v_dot2_f32_bf16 v63, v158, v26, v63
v_dot2_f32_bf16 v60, v155, v23, v60
v_dot2_f32_bf16 v61, v155, v27, v61
v_dot2_f32_bf16 v62, v159, v23, v62
v_dot2_f32_bf16 v63, v159, v27, v63
v_add_f32_dpp v60, v60, v60 row_ror:8 row_mask:0xf bank_mask:0xf
v_add_f32_dpp v61, v61, v61 row_ror:8 row_mask:0xf bank_mask:0xf
v_add_f32_dpp v62, v62, v62 row_ror:8 row_mask:0xf bank_mask:0xf
v_add_f32_dpp v63, v63, v63 row_ror:8 row_mask:0xf bank_mask:0xf
v_add_f32_dpp v60, v60, v60 row_ror:4 row_mask:0xf bank_mask:0xf
v_add_f32_dpp v61, v61, v61 row_ror:4 row_mask:0xf bank_mask:0xf
v_add_f32_dpp v62, v62, v62 row_ror:4 row_mask:0xf bank_mask:0xf
v_add_f32_dpp v63, v63, v63 row_ror:4 row_mask:0xf bank_mask:0xf
v_add_f32_dpp v60, v60, v60 row_ror:2 row_mask:0xf bank_mask:0xf
v_add_f32_dpp v61, v61, v61 row_ror:2 row_mask:0xf bank_mask:0xf
v_add_f32_dpp v62, v62, v62 row_ror:2 row_mask:0xf bank_mask:0xf
v_add_f32_dpp v63, v63, v63 row_ror:2 row_mask:0xf bank_mask:0xf
v_add_f32_dpp v60, v60, v60 row_ror:1 row_mask:0xf bank_mask:0xf
v_add_f32_dpp v61, v61, v61 row_ror:1 row_mask:0xf bank_mask:0xf
v_add_f32_dpp v62, v62, v62 row_ror:1 row_mask:0xf bank_mask:0xf
v_add_f32_dpp v63, v63, v63 row_ror:1 row_mask:0xf bank_mask:0xf
v_cmp_eq_u32 vcc, 6, v202
s_nop 1
v_cndmask_b32 v200, v200, v60, vcc
v_cndmask_b32 v201, v201, v61, vcc
v_cmp_eq_u32 vcc, 7, v202
s_nop 1
v_cndmask_b32 v200, v200, v62, vcc
v_cndmask_b32 v201, v201, v63, vcc
s_waitcnt vmcnt(6)
v_dot2_f32_bf16 v60, v160, v20, 0
v_dot2_f32_bf16 v61, v160, v24, 0
v_dot2_f32_bf16 v62, v164, v20, 0
v_dot2_f32_bf16 v63, v164, v24, 0
v_dot2_f32_bf16 v60, v161, v21, v60
v_dot2_f32_bf16 v61, v161, v25, v61
v_dot2_f32_bf16 v62, v165, v21, v62
v_dot2_f32_bf16 v63, v165, v25, v63
v_dot2_f32_bf16 v60, v162, v22, v60
v_dot2_f32_bf16 v61, v162, v26, v61
v_dot2_f32_bf16 v62, v166, v22, v62
v_dot2_f32_bf16 v63, v166, v26, v63
v_dot2_f32_bf16 v60, v163, v23, v60
v_dot2_f32_bf16 v61, v163, v27, v61
v_dot2_f32_bf16 v62, v167, v23, v62
v_dot2_f32_bf16 v63, v167, v27, v63
v_add_f32_dpp v60, v60, v60 row_ror:8 row_mask:0xf bank_mask:0xf
v_add_f32_dpp v61, v61, v61 row_ror:8 row_mask:0xf bank_mask:0xf
v_add_f32_dpp v62, v62, v62 row_ror:8 row_mask:0xf bank_mask:0xf
v_add_f32_dpp v63, v63, v63 row_ror:8 row_mask:0xf bank_mask:0xf
v_add_f32_dpp v60, v60, v60 row_ror:4 row_mask:0xf bank_mask:0xf
v_add_f32_dpp v61, v61, v61 row_ror:4 row_mask:0xf bank_mask:0xf
v_add_f32_dpp v62, v62, v62 row_ror:4 row_mask:0xf bank_mask:0xf
v_add_f32_dpp v63, v63, v63 row_ror:4 row_mask:0xf bank_mask:0xf
v_add_f32_dpp v60, v60, v60 row_ror:2 row_mask:0xf bank_mask:0xf
v_add_f32_dpp v61, v61, v61 row_ror:2 row_mask:0xf bank_mask:0xf
v_add_f32_dpp v62, v62, v62 row_ror:2 row_mask:0xf bank_mask:0xf
v_add_f32_dpp v63, v63, v63 row_ror:2 row_mask:0xf bank_mask:0xf
v_add_f32_dpp v60, v60, v60 row_ror:1 row_mask:0xf bank_mask:0xf
v_add_f32_dpp v61, v61, v61 row_ror:1 row_mask:0xf bank_mask:0xf
v_add_f32_dpp v62, v62, v62 row_ror:1 row_mask:0xf bank_mask:0xf
v_add_f32_dpp v63, v63, v63 row_ror:1 row_mask:0xf bank_mask:0xf
v_cmp_eq_u32 vcc, 8, v202
s_nop 1
v_cndmask_b32 v200, v200, v60, vcc
v_cndmask_b32 v201, v201, v61, vcc
v_cmp_eq_u32 vcc, 9, v202
s_nop 1
v_cndmask_b32 v200, v200, v62, vcc
v_cndmask_b32 v201, v201, v63, vcc
s_waitcnt vmcnt(4)
v_dot2_f32_bf16 v60, v168, v20, 0
v_dot2_f32_bf16 v61, v168, v24, 0
v_dot2_f32_bf16 v62, v172, v20, 0
v_dot2_f32_bf16 v63, v172, v24, 0
v_dot2_f32_bf16 v60, v169, v21, v60
v_dot2_f32_bf16 v61, v169, v25, v61
v_dot2_f32_bf16 v62, v173, v21, v62
v_dot2_f32_bf16 v63, v173, v25, v63
v_dot2_f32_bf16 v60, v170, v22, v60
v_dot2_f32_bf16 v61, v170, v26, v61
v_dot2_f32_bf16 v62, v174, v22, v62
v_dot2_f32_bf16 v63, v174, v26, v63
v_dot2_f32_bf16 v60, v171, v23, v60
v_dot2_f32_bf16 v61, v171, v27, v61
v_dot2_f32_bf16 v62, v175, v23, v62
v_dot2_f32_bf16 v63, v175, v27, v63
v_add_f32_dpp v60, v60, v60 row_ror:8 row_mask:0xf bank_mask:0xf
v_add_f32_dpp v61, v61, v61 row_ror:8 row_mask:0xf bank_mask:0xf
v_add_f32_dpp v62, v62, v62 row_ror:8 row_mask:0xf bank_mask:0xf
v_add_f32_dpp v63, v63, v63 row_ror:8 row_mask:0xf bank_mask:0xf
v_add_f32_dpp v60, v60, v60 row_ror:4 row_mask:0xf bank_mask:0xf
v_add_f32_dpp v61, v61, v61 row_ror:4 row_mask:0xf bank_mask:0xf
v_add_f32_dpp v62, v62, v62 row_ror:4 row_mask:0xf bank_mask:0xf
v_add_f32_dpp v63, v63, v63 row_ror:4 row_mask:0xf bank_mask:0xf
v_add_f32_dpp v60, v60, v60 row_ror:2 row_mask:0xf bank_mask:0xf
v_add_f32_dpp v61, v61, v61 row_ror:2 row_mask:0xf bank_mask:0xf
v_add_f32_dpp v62, v62, v62 row_ror:2 row_mask:0xf bank_mask:0xf
v_add_f32_dpp v63, v63, v63 row_ror:2 row_mask:0xf bank_mask:0xf
v_add_f32_dpp v60, v60, v60 row_ror:1 row_mask:0xf bank_mask:0xf
v_add_f32_dpp v61, v61, v61 row_ror:1 row_mask:0xf bank_mask:0xf
v_add_f32_dpp v62, v62, v62 row_ror:1 row_mask:0xf bank_mask:0xf
v_add_f32_dpp v63, v63, v63 row_ror:1 row_mask:0xf bank_mask:0xf
v_cmp_eq_u32 vcc, 10, v202
s_nop 1
v_cndmask_b32 v200, v200, v60, vcc
v_cndmask_b32 v201, v201, v61, vcc
v_cmp_eq_u32 vcc, 11, v202
s_nop 1
v_cndmask_b32 v200, v200, v62, vcc
v_cndmask_b32 v201, v201, v63, vcc
s_waitcnt vmcnt(2)
v_dot2_f32_bf16 v60, v176, v20, 0
v_dot2_f32_bf16 v61, v176, v24, 0
v_dot2_f32_bf16 v62, v180, v20, 0
v_dot2_f32_bf16 v63, v180, v24, 0
v_dot2_f32_bf16 v60, v177, v21, v60
v_dot2_f32_bf16 v61, v177, v25, v61
v_dot2_f32_bf16 v62, v181, v21, v62
v_dot2_f32_bf16 v63, v181, v25, v63
v_dot2_f32_bf16 v60, v178, v22, v60
v_dot2_f32_bf16 v61, v178, v26, v61
v_dot2_f32_bf16 v62, v182, v22, v62
v_dot2_f32_bf16 v63, v182, v26, v63
v_dot2_f32_bf16 v60, v179, v23, v60
v_dot2_f32_bf16 v61, v179, v27, v61
v_dot2_f32_bf16 v62, v183, v23, v62
v_dot2_f32_bf16 v63, v183, v27, v63
v_add_f32_dpp v60, v60, v60 row_ror:8 row_mask:0xf bank_mask:0xf
v_add_f32_dpp v61, v61, v61 row_ror:8 row_mask:0xf bank_mask:0xf
v_add_f32_dpp v62, v62, v62 row_ror:8 row_mask:0xf bank_mask:0xf
v_add_f32_dpp v63, v63, v63 row_ror:8 row_mask:0xf bank_mask:0xf
v_add_f32_dpp v60, v60, v60 row_ror:4 row_mask:0xf bank_mask:0xf
v_add_f32_dpp v61, v61, v61 row_ror:4 row_mask:0xf bank_mask:0xf
v_add_f32_dpp v62, v62, v62 row_ror:4 row_mask:0xf bank_mask:0xf
v_add_f32_dpp v63, v63, v63 row_ror:4 row_mask:0xf bank_mask:0xf
v_add_f32_dpp v60, v60, v60 row_ror:2 row_mask:0xf bank_mask:0xf
v_add_f32_dpp v61, v61, v61 row_ror:2 row_mask:0xf bank_mask:0xf
v_add_f32_dpp v62, v62, v62 row_ror:2 row_mask:0xf bank_mask:0xf
v_add_f32_dpp v63, v63, v63 row_ror:2 row_mask:0xf bank_mask:0xf
v_add_f32_dpp v60, v60, v60 row_ror:1 row_mask:0xf bank_mask:0xf
v_add_f32_dpp v61, v61, v61 row_ror:1 row_mask:0xf bank_mask:0xf
v_add_f32_dpp v62, v62, v62 row_ror:1 row_mask:0xf bank_mask:0xf
v_add_f32_dpp v63, v63, v63 row_ror:1 row_mask:0xf bank_mask:0xf
v_cmp_eq_u32 vcc, 12, v202
s_nop 1
v_cndmask_b32 v200, v200, v60, vcc
v_cndmask_b32 v201, v201, v61, vcc
v_cmp_eq_u32 vcc, 13, v202
s_nop 1
v_cndmask_b32 v200, v200, v62, vcc
v_cndmask_b32 v201, v201, v63, vcc
s_waitcnt vmcnt(0)
v_dot2_f32_bf16 v60, v184, v20, 0
v_dot2_f32_bf16 v61, v184, v24, 0
v_dot2_f32_bf16 v62, v188, v20, 0
v_dot2_f32_bf16 v63, v188, v24, 0
v_dot2_f32_bf16 v60, v185, v21, v60
v_dot2_f32_bf16 v61, v185, v25, v61
v_dot2_f32_bf16 v62, v189, v21, v62
v_dot2_f32_bf16 v63, v189, v25, v63
v_dot2_f32_bf16 v60, v186, v22, v60
v_dot2_f32_bf16 v61, v186, v26, v61
v_dot2_f32_bf16 v62, v190, v22, v62
v_dot2_f32_bf16 v63, v190, v26, v63
v_dot2_f32_bf16 v60, v187, v23, v60
v_dot2_f32_bf16 v61, v187, v27, v61
v_dot2_f32_bf16 v62, v191, v23, v62
v_dot2_f32_bf16 v63, v191, v27, v63
v_add_f32_dpp v60, v60, v60 row_ror:8 row_mask:0xf bank_mask:0xf
v_add_f32_dpp v61, v61, v61 row_ror:8 row_mask:0xf bank_mask:0xf
v_add_f32_dpp v62, v62, v62 row_ror:8 row_mask:0xf bank_mask:0xf
v_add_f32_dpp v63, v63, v63 row_ror:8 row_mask:0xf bank_mask:0xf
v_add_f32_dpp v60, v60, v60 row_ror:4 row_mask:0xf bank_mask:0xf
v_add_f32_dpp v61, v61, v61 row_ror:4 row_mask:0xf bank_mask:0xf
v_add_f32_dpp v62, v62, v62 row_ror:4 row_mask:0xf bank_mask:0xf
v_add_f32_dpp v63, v63, v63 row_ror:4 row_mask:0xf bank_mask:0xf
v_add_f32_dpp v60, v60, v60 row_ror:2 row_mask:0xf bank_mask:0xf
v_add_f32_dpp v61, v61, v61 row_ror:2 row_mask:0xf bank_mask:0xf
v_add_f32_dpp v62, v62, v62 row_ror:2 row_mask:0xf bank_mask:0xf
v_add_f32_dpp v63, v63, v63 row_ror:2 row_mask:0xf bank_mask:0xf
v_add_f32_dpp v60, v60, v60 row_ror:1 row_mask:0xf bank_mask:0xf
v_add_f32_dpp v61, v61, v61 row_ror:1 row_mask:0xf bank_mask:0xf
v_add_f32_dpp v62, v62, v62 row_ror:1 row_mask:0xf bank_mask:0xf
v_add_f32_dpp v63, v63, v63 row_ror:1 row_mask:0xf bank_mask:0xf
v_cmp_eq_u32 vcc, 14, v202
s_nop 1
v_cndmask_b32 v200, v200, v60, vcc
v_cndmask_b32 v201, v201, v61, vcc
v_cmp_eq_u32 vcc, 15, v202
s_nop 1
v_cndmask_b32 v200, v200, v62, vcc
v_cndmask_b32 v201, v201, v63, vcc
v_cvt_pk_bf16_f32 v200, v200, v200
v_cvt_pk_bf16_f32 v201, v201, v201
v_lshlrev_b32 v192, 1, v0
ds_write_b16 v192, v200 offset:0
ds_write_b16 v192, v201 offset:1024
s_waitcnt lgkmcnt(0)
s_barrier
s_cmp_lg_u32 s34, 0
s_cbranch_scc1 L_W_q
v_lshlrev_b32 v192, 4, v1
ds_read_b128 v[20:23], v192 offset:0
ds_read_b128 v[24:27], v192 offset:1024
s_lshl_b32 s62, s32, 10
s_add_u32 s62, s62, 0x0
s_add_u32 s63, s62, 32768
s_waitcnt lgkmcnt(0)
buffer_store_dwordx4 v[20:23], v192, s[52:55], s62 offen sc1
buffer_store_dwordx4 v[24:27], v192, s[52:55], s63 offen sc1
s_lshl_b32 s62, s32, 7
s_add_u32 s62, s62, 0x15000
v_mov_b32 v192, s62
v_mov_b32 v193, s58
s_mov_b64 exec, 1
s_waitcnt vmcnt(0)
buffer_store_dword v193, v192, s[52:55], 0 offen sc1
s_mov_b64 exec, -1
L_W_q:
s_lshl_b32 s60, s32, 8
s_sub_u32 s61, 0x400000, s60
s_add_u32 s40, s22, s60
s_addc_u32 s41, s23, 0
s_and_b32 s41, s41, 0xffff
s_mov_b32 s42, s61
s_mov_b32 s43, 0x20000
s_lshl_b32 s60, s32, 17
s_mov_b32 s61, 0x20000
s_add_u32 s44, s24, s60
s_addc_u32 s45, s25, 0
s_and_b32 s45, s45, 0xffff
s_mov_b32 s46, s61
s_mov_b32 s47, 0x20000
v_lshlrev_b32 v10, 12, v3
v_lshl_add_u32 v10, v2, 4, v10
s_lshl_b32 s62, s34, 14
v_add_u32 v10, s62, v10
s_waitcnt vmcnt(1)
s_xor_b32 s62, s80, 0
buffer_load_dwordx4 v[64:67], v9, s[40:43], s62 offen nt
s_waitcnt vmcnt(1)
s_xor_b32 s62, s80, 8192
buffer_load_dwordx4 v[68:71], v9, s[40:43], s62 offen nt
s_waitcnt vmcnt(1)
s_xor_b32 s62, s80, 16384
buffer_load_dwordx4 v[72:75], v9, s[40:43], s62 offen nt
s_waitcnt vmcnt(1)
s_xor_b32 s62, s80, 24576
buffer_load_dwordx4 v[76:79], v9, s[40:43], s62 offen nt
s_waitcnt vmcnt(1)
s_xor_b32 s62, s80, 32768
buffer_load_dwordx4 v[80:83], v9, s[40:43], s62 offen nt
s_waitcnt vmcnt(1)
s_xor_b32 s62, s80, 40960
buffer_load_dwordx4 v[84:87], v9, s[40:43], s62 offen nt
s_waitcnt vmcnt(1)
s_xor_b32 s62, s80, 49152
buffer_load_dwordx4 v[88:91], v9, s[40:43], s62 offen nt
s_waitcnt vmcnt(1)
s_xor_b32 s62, s80, 57344
buffer_load_dwordx4 v[92:95], v9, s[40:43], s62 offen nt
s_waitcnt vmcnt(1)
s_xor_b32 s62, s80, 65536
buffer_load_dwordx4 v[96:99], v9, s[40:43], s62 offen nt
s_waitcnt vmcnt(1)
s_xor_b32 s62, s80, 73728
buffer_load_dwordx4 v[100:103], v9, s[40:43], s62 offen nt
s_waitcnt vmcnt(1)
s_xor_b32 s62, s80, 81920
buffer_load_dwordx4 v[104:107], v9, s[40:43], s62 offen nt
s_waitcnt vmcnt(1)
s_xor_b32 s62, s80, 90112
buffer_load_dwordx4 v[108:111], v9, s[40:43], s62 offen nt
s_waitcnt vmcnt(1)
s_xor_b32 s62, s80, 98304
buffer_load_dwordx4 v[112:115], v9, s[40:43], s62 offen nt
s_waitcnt vmcnt(1)
s_xor_b32 s62, s80, 106496
buffer_load_dwordx4 v[116:119], v9, s[40:43], s62 offen nt
s_waitcnt vmcnt(1)
s_xor_b32 s62, s80, 114688
buffer_load_dwordx4 v[120:123], v9, s[40:43], s62 offen nt
s_waitcnt vmcnt(1)
s_xor_b32 s62, s80, 122880
buffer_load_dwordx4 v[124:127], v9, s[40:43], s62 offen nt
s_waitcnt vmcnt(1)
buffer_load_dwordx4 v[128:131], v10, s[44:47], 0 offen offset:0 nt
s_waitcnt vmcnt(1)
buffer_load_dwordx4 v[132:135], v10, s[44:47], 0 offen offset:256 nt
s_waitcnt vmcnt(1)
buffer_load_dwordx4 v[136:139], v10, s[44:47], 0 offen offset:512 nt
s_waitcnt vmcnt(1)
buffer_load_dwordx4 v[140:143], v10, s[44:47], 0 offen offset:768 nt
s_waitcnt vmcnt(1)
buffer_load_dwordx4 v[144:147], v10, s[44:47], 0 offen offset:1024 nt
s_waitcnt vmcnt(1)
buffer_load_dwordx4 v[148:151], v10, s[44:47], 0 offen offset:1280 nt
s_waitcnt vmcnt(1)
buffer_load_dwordx4 v[152:155], v10, s[44:47], 0 offen offset:1536 nt
s_waitcnt vmcnt(1)
buffer_load_dwordx4 v[156:159], v10, s[44:47], 0 offen offset:1792 nt
s_waitcnt vmcnt(1)
buffer_load_dwordx4 v[160:163], v10, s[44:47], 0 offen offset:2048 nt
s_waitcnt vmcnt(1)
buffer_load_dwordx4 v[164:167], v10, s[44:47], 0 offen offset:2304 nt
s_waitcnt vmcnt(1)
buffer_load_dwordx4 v[168:171], v10, s[44:47], 0 offen offset:2560 nt
s_waitcnt vmcnt(1)
buffer_load_dwordx4 v[172:175], v10, s[44:47], 0 offen offset:2816 nt
s_waitcnt vmcnt(1)
buffer_load_dwordx4 v[176:179], v10, s[44:47], 0 offen offset:3072 nt
s_waitcnt vmcnt(1)
buffer_load_dwordx4 v[180:183], v10, s[44:47], 0 offen offset:3328 nt
s_waitcnt vmcnt(1)
buffer_load_dwordx4 v[184:187], v10, s[44:47], 0 offen offset:3584 nt
s_waitcnt vmcnt(1)
buffer_load_dwordx4 v[188:191], v10, s[44:47], 0 offen offset:3840 nt
s_waitcnt vmcnt(0)
v_bfe_u32 v9, v1, 2, 3
v_lshlrev_b32 v9, 11, v9
v_and_b32 v192, 3, v1
v_lshrrev_b32 v10, 5, v1
v_lshl_add_u32 v192, v10, 2, v192
v_lshl_add_u32 v9, v192, 4, v9
s_lshr_b32 s62, s32, 4
s_and_b32 s63, s32, 15
s_lshl_b32 s60, s62, 16
s_lshl_b32 s61, s63, 7
s_add_u32 s60, s60, s61
s_add_u32 s60, s60, 0x20000
v_add_u32 v9, s60, v9
s_lshl_b32 s60, s62, 11
s_lshl_b32 s61, s63, 6
s_add_u32 s60, s60, s61
s_add_u32 s60, s60, 1024
v_lshl_add_u32 v10, v192, 3, s60
s_lshl_b32 s63, s32, 4
s_add_u32 s63, s63, 0x10000
v_lshl_add_u32 v192, v1, 9, s63
s_cmp_lg_u32 s34, 0
s_cbranch_scc1 L_wf_Wc
s_lshl_b64 exec, 1, s32
s_mov_b32 s64, 0
L_pl_Wc1:
buffer_load_dwordx4 v[196:199], v192, s[52:55], 0 offen sc1
s_add_u32 s64, s64, 1
s_waitcnt vmcnt(0)
v_xor_b32 v196, s76, v196
v_xor_b32 v197, s77, v197
v_xor_b32 v198, s78, v198
v_xor_b32 v199, s79, v199
v_or_b32 v193, v196, v197
v_or3_b32 v193, v193, v198, v199
v_and_b32 v193, 0xff, v193
v_cmp_ne_u32 vcc, 0, v193
s_nop 0
s_cmp_eq_u64 vcc, 0
s_cbranch_scc1 L_pd_Wc1
s_mov_b64 exec, vcc
s_sleep 8
s_cmp_lt_u32 s64, 65536
s_cbranch_scc1 L_pl_Wc1
L_pd_Wc1:
s_mov_b32 exec_lo, -1
s_mov_b32 exec_hi, 0
s_mov_b32 s64, 0
L_pl_Wc2:
buffer_load_dwordx4 v[196:199], v192, s[52:55], 0 offen sc1
s_add_u32 s64, s64, 1
s_waitcnt vmcnt(0)
v_xor_b32 v196, s76, v196
v_xor_b32 v197, s77, v197
v_xor_b32 v198, s78, v198
v_xor_b32 v199, s79, v199
v_or_b32 v193, v196, v197
v_or3_b32 v193, v193, v198, v199
v_and_b32 v193, 0xff, v193
v_cmp_ne_u32 vcc, 0, v193
s_nop 0
s_cmp_eq_u64 vcc, 0
s_cbranch_scc1 L_pd_Wc2
s_mov_b64 exec, vcc
s_sleep 2
s_cmp_lt_u32 s64, 65536
s_cbranch_scc1 L_pl_Wc2
L_pd_Wc2:
s_mov_b64 exec, -1
L_wf_Wc:
s_barrier
s_lshr_b32 s35, s34, 2
s_and_b32 s36, s34, 3
s_lshl_b32 s62, s35, 13
s_add_u32 s63, s63, s62
v_lshl_add_u32 v192, v2, 9, s63
buffer_load_dwordx4 v[196:199], v192, s[52:55], 0 offen sc1
s_lshl_b32 s62, s35, 5
s_add_u32 s62, s62, s32
s_lshl_b32 s63, s62, 14
s_add_u32 s63, s63, 0x200000
s_lshl_b32 s64, s36, 12
s_add_u32 s63, s63, s64
v_lshl_add_u32 v193, v1, 4, s63
buffer_load_dwordx4 v[200:203], v193, s[52:55], 0 offen offset:0 sc1
buffer_load_dwordx4 v[204:207], v193, s[52:55], 0 offen offset:1024 sc1
buffer_load_dwordx4 v[208:211], v193, s[52:55], 0 offen offset:2048 sc1
buffer_load_dwordx4 v[212:215], v193, s[52:55], 0 offen offset:3072 sc1
s_mov_b32 s60, 0x07060302
s_waitcnt vmcnt(4)
v_perm_b32 v194, v196, v197, s60
v_perm_b32 v195, v198, v199, s60
v_mov_b32 v196, v194
s_nop 1
v_max_f32_dpp v196, v196, v196 row_ror:8 row_mask:0xf bank_mask:0xf
s_nop 1
v_max_f32_dpp v196, v196, v196 row_ror:4 row_mask:0xf bank_mask:0xf
s_nop 1
v_max_f32_dpp v196, v196, v196 row_ror:2 row_mask:0xf bank_mask:0xf
s_nop 1
v_max_f32_dpp v196, v196, v196 row_ror:1 row_mask:0xf bank_mask:0xf
v_sub_f32 v197, v194, v196
v_exp_f32 v197, v197
s_nop 0
v_mul_f32 v195, v195, v197
s_nop 1
v_add_f32_dpp v195, v195, v195 row_ror:8 row_mask:0xf bank_mask:0xf
s_nop 1
v_add_f32_dpp v195, v195, v195 row_ror:4 row_mask:0xf bank_mask:0xf
s_nop 1
v_add_f32_dpp v195, v195, v195 row_ror:2 row_mask:0xf bank_mask:0xf
s_nop 1
v_add_f32_dpp v195, v195, v195 row_ror:1 row_mask:0xf bank_mask:0xf
v_rcp_f32 v195, v195
s_nop 0
v_mul_f32 v197, v197, v195
s_lshl_b32 s64, s36, 2
s_add_u32 s65, s64, 0
v_readlane_b32 s66, v197, s65
s_add_u32 s65, s64, 1
v_readlane_b32 s67, v197, s65
s_add_u32 s65, s64, 2
v_readlane_b32 s68, v197, s65
s_add_u32 s65, s64, 3
v_readlane_b32 s69, v197, s65
s_waitcnt vmcnt(3)
v_lshlrev_b32 v216, 16, v200
v_and_b32 v217, 0xffff0000, v200
v_lshlrev_b32 v218, 16, v201
v_and_b32 v219, 0xffff0000, v201
v_lshlrev_b32 v220, 16, v202
v_and_b32 v221, 0xffff0000, v202
v_lshlrev_b32 v222, 16, v203
v_and_b32 v223, 0xffff0000, v203
v_mul_f32 v232, s66, v216
v_mul_f32 v233, s66, v217
v_mul_f32 v234, s66, v218
v_mul_f32 v235, s66, v219
v_mul_f32 v236, s66, v220
v_mul_f32 v237, s66, v221
v_mul_f32 v238, s66, v222
v_mul_f32 v239, s66, v223
s_waitcnt vmcnt(2)
v_lshlrev_b32 v216, 16, v204
v_and_b32 v217, 0xffff0000, v204
v_lshlrev_b32 v218, 16, v205
v_and_b32 v219, 0xffff0000, v205
v_lshlrev_b32 v220, 16, v206
v_and_b32 v221, 0xffff0000, v206
v_lshlrev_b32 v222, 16, v207
v_and_b32 v223, 0xffff0000, v207
v_fma_f32 v232, v216, s67, v232
v_fma_f32 v233, v217, s67, v233
v_fma_f32 v234, v218, s67, v234
v_fma_f32 v235, v219, s67, v235
v_fma_f32 v236, v220, s67, v236
v_fma_f32 v237, v221, s67, v237
v_fma_f32 v238, v222, s67, v238
v_fma_f32 v239, v223, s67, v239
s_waitcnt vmcnt(1)
v_lshlrev_b32 v216, 16, v208
v_and_b32 v217, 0xffff0000, v208
v_lshlrev_b32 v218, 16, v209
v_and_b32 v219, 0xffff0000, v209
v_lshlrev_b32 v220, 16, v210
v_and_b32 v221, 0xffff0000, v210
v_lshlrev_b32 v222, 16, v211
v_and_b32 v223, 0xffff0000, v211
v_fma_f32 v232, v216, s68, v232
v_fma_f32 v233, v217, s68, v233
v_fma_f32 v234, v218, s68, v234
v_fma_f32 v235, v219, s68, v235
v_fma_f32 v236, v220, s68, v236
v_fma_f32 v237, v221, s68, v237
v_fma_f32 v238, v222, s68, v238
v_fma_f32 v239, v223, s68, v239
s_waitcnt vmcnt(0)
v_lshlrev_b32 v216, 16, v212
v_and_b32 v217, 0xffff0000, v212
v_lshlrev_b32 v218, 16, v213
v_and_b32 v219, 0xffff0000, v213
v_lshlrev_b32 v220, 16, v214
v_and_b32 v221, 0xffff0000, v214
v_lshlrev_b32 v222, 16, v215
v_and_b32 v223, 0xffff0000, v215
v_fma_f32 v232, v216, s69, v232
v_fma_f32 v233, v217, s69, v233
v_fma_f32 v234, v218, s69, v234
v_fma_f32 v235, v219, s69, v235
v_fma_f32 v236, v220, s69, v236
v_fma_f32 v237, v221, s69, v237
v_fma_f32 v238, v222, s69, v238
v_fma_f32 v239, v223, s69, v239
s_lshl_b32 s62, s34, 11
v_lshl_add_u32 v192, v1, 5, s62
ds_write_b128 v192, v[232:235] offset:18432
ds_write_b128 v192, v[236:239] offset:18448
s_waitcnt lgkmcnt(0)
s_barrier
v_lshrrev_b32 v192, 3, v2
v_lshlrev_b32 v192, 13, v192
v_lshl_add_u32 v192, v3, 6, v192
s_lshl_b32 s62, s34, 8
s_lshr_b32 s63, s80, 11
s_add_u32 s62, s62, s63
v_add_u32 v192, s62, v192
v_xor_b32 v193, 16, v192
v_xor_b32 v194, 32, v192
v_xor_b32 v195, 48, v192
ds_read_b128 v[200:203], v192 offset:18432
ds_read_b128 v[204:207], v193 offset:18432
ds_read_b128 v[208:211], v194 offset:18432
ds_read_b128 v[212:215], v195 offset:18432
ds_read_b128 v[216:219], v192 offset:20480
ds_read_b128 v[220:223], v193 offset:20480
ds_read_b128 v[224:227], v194 offset:20480
ds_read_b128 v[228:231], v195 offset:20480
s_waitcnt lgkmcnt(0)
v_add_f32 v200, v200, v216
v_add_f32 v201, v201, v217
v_add_f32 v202, v202, v218
v_add_f32 v203, v203, v219
v_add_f32 v204, v204, v220
v_add_f32 v205, v205, v221
v_add_f32 v206, v206, v222
v_add_f32 v207, v207, v223
v_add_f32 v208, v208, v224
v_add_f32 v209, v209, v225
v_add_f32 v210, v210, v226
v_add_f32 v211, v211, v227
v_add_f32 v212, v212, v228
v_add_f32 v213, v213, v229
v_add_f32 v214, v214, v230
v_add_f32 v215, v215, v231
ds_read_b128 v[216:219], v192 offset:22528
ds_read_b128 v[220:223], v193 offset:22528
ds_read_b128 v[224:227], v194 offset:22528
ds_read_b128 v[228:231], v195 offset:22528
s_waitcnt lgkmcnt(0)
v_add_f32 v200, v200, v216
v_add_f32 v201, v201, v217
v_add_f32 v202, v202, v218
v_add_f32 v203, v203, v219
v_add_f32 v204, v204, v220
v_add_f32 v205, v205, v221
v_add_f32 v206, v206, v222
v_add_f32 v207, v207, v223
v_add_f32 v208, v208, v224
v_add_f32 v209, v209, v225
v_add_f32 v210, v210, v226
v_add_f32 v211, v211, v227
v_add_f32 v212, v212, v228
v_add_f32 v213, v213, v229
v_add_f32 v214, v214, v230
v_add_f32 v215, v215, v231
ds_read_b128 v[216:219], v192 offset:24576
ds_read_b128 v[220:223], v193 offset:24576
ds_read_b128 v[224:227], v194 offset:24576
ds_read_b128 v[228:231], v195 offset:24576
s_waitcnt lgkmcnt(0)
v_add_f32 v200, v200, v216
v_add_f32 v201, v201, v217
v_add_f32 v202, v202, v218
v_add_f32 v203, v203, v219
v_add_f32 v204, v204, v220
v_add_f32 v205, v205, v221
v_add_f32 v206, v206, v222
v_add_f32 v207, v207, v223
v_add_f32 v208, v208, v224
v_add_f32 v209, v209, v225
v_add_f32 v210, v210, v226
v_add_f32 v211, v211, v227
v_add_f32 v212, v212, v228
v_add_f32 v213, v213, v229
v_add_f32 v214, v214, v230
v_add_f32 v215, v215, v231
v_cvt_pk_bf16_f32 v12, v200, v201
v_cvt_pk_bf16_f32 v13, v202, v203
v_cvt_pk_bf16_f32 v14, v204, v205
v_cvt_pk_bf16_f32 v15, v206, v207
v_cvt_pk_bf16_f32 v16, v208, v209
v_cvt_pk_bf16_f32 v17, v210, v211
v_cvt_pk_bf16_f32 v18, v212, v213
v_cvt_pk_bf16_f32 v19, v214, v215
s_mov_b32 s60, 0x01000100
v_perm_b32 v192, v12, v12, s60
v_and_b32 v28, v192, v4
v_and_b32 v29, v192, v5
v_and_b32 v30, v192, v6
v_and_b32 v31, v192, v7
s_waitcnt vmcnt(63)
s_nop 0
v_mfma_f32_16x16x32_bf16 v[44:47], v[28:31], v[64:67], 0
s_mov_b32 s60, 0x03020302
v_perm_b32 v193, v12, v12, s60
v_and_b32 v32, v193, v4
v_and_b32 v33, v193, v5
v_and_b32 v34, v193, v6
v_and_b32 v35, v193, v7
s_waitcnt vmcnt(63)
s_nop 0
v_mfma_f32_16x16x32_bf16 v[44:47], v[32:35], v[68:71], v[44:47]
s_mov_b32 s60, 0x01000100
v_perm_b32 v192, v13, v13, s60
v_and_b32 v28, v192, v4
v_and_b32 v29, v192, v5
v_and_b32 v30, v192, v6
v_and_b32 v31, v192, v7
s_waitcnt vmcnt(63)
s_nop 0
v_mfma_f32_16x16x32_bf16 v[44:47], v[28:31], v[72:75], v[44:47]
s_mov_b32 s60, 0x03020302
v_perm_b32 v193, v13, v13, s60
v_and_b32 v32, v193, v4
v_and_b32 v33, v193, v5
v_and_b32 v34, v193, v6
v_and_b32 v35, v193, v7
s_waitcnt vmcnt(63)
s_nop 0
v_mfma_f32_16x16x32_bf16 v[44:47], v[32:35], v[76:79], v[44:47]
s_mov_b32 s60, 0x01000100
v_perm_b32 v192, v14, v14, s60
v_and_b32 v28, v192, v4
v_and_b32 v29, v192, v5
v_and_b32 v30, v192, v6
v_and_b32 v31, v192, v7
s_waitcnt vmcnt(63)
s_nop 0
v_mfma_f32_16x16x32_bf16 v[44:47], v[28:31], v[80:83], v[44:47]
s_mov_b32 s60, 0x03020302
v_perm_b32 v193, v14, v14, s60
v_and_b32 v32, v193, v4
v_and_b32 v33, v193, v5
v_and_b32 v34, v193, v6
v_and_b32 v35, v193, v7
s_waitcnt vmcnt(63)
s_nop 0
v_mfma_f32_16x16x32_bf16 v[44:47], v[32:35], v[84:87], v[44:47]
s_mov_b32 s60, 0x01000100
v_perm_b32 v192, v15, v15, s60
v_and_b32 v28, v192, v4
v_and_b32 v29, v192, v5
v_and_b32 v30, v192, v6
v_and_b32 v31, v192, v7
s_waitcnt vmcnt(63)
s_nop 0
v_mfma_f32_16x16x32_bf16 v[44:47], v[28:31], v[88:91], v[44:47]
s_mov_b32 s60, 0x03020302
v_perm_b32 v193, v15, v15, s60
v_and_b32 v32, v193, v4
v_and_b32 v33, v193, v5
v_and_b32 v34, v193, v6
v_and_b32 v35, v193, v7
s_waitcnt vmcnt(63)
s_nop 0
v_mfma_f32_16x16x32_bf16 v[44:47], v[32:35], v[92:95], v[44:47]
s_mov_b32 s60, 0x01000100
v_perm_b32 v192, v16, v16, s60
v_and_b32 v28, v192, v4
v_and_b32 v29, v192, v5
v_and_b32 v30, v192, v6
v_and_b32 v31, v192, v7
s_waitcnt vmcnt(63)
s_nop 0
v_mfma_f32_16x16x32_bf16 v[44:47], v[28:31], v[96:99], v[44:47]
s_mov_b32 s60, 0x03020302
v_perm_b32 v193, v16, v16, s60
v_and_b32 v32, v193, v4
v_and_b32 v33, v193, v5
v_and_b32 v34, v193, v6
v_and_b32 v35, v193, v7
s_waitcnt vmcnt(63)
s_nop 0
v_mfma_f32_16x16x32_bf16 v[44:47], v[32:35], v[100:103], v[44:47]
s_mov_b32 s60, 0x01000100
v_perm_b32 v192, v17, v17, s60
v_and_b32 v28, v192, v4
v_and_b32 v29, v192, v5
v_and_b32 v30, v192, v6
v_and_b32 v31, v192, v7
s_waitcnt vmcnt(63)
s_nop 0
v_mfma_f32_16x16x32_bf16 v[44:47], v[28:31], v[104:107], v[44:47]
s_mov_b32 s60, 0x03020302
v_perm_b32 v193, v17, v17, s60
v_and_b32 v32, v193, v4
v_and_b32 v33, v193, v5
v_and_b32 v34, v193, v6
v_and_b32 v35, v193, v7
s_waitcnt vmcnt(63)
s_nop 0
v_mfma_f32_16x16x32_bf16 v[44:47], v[32:35], v[108:111], v[44:47]
s_mov_b32 s60, 0x01000100
v_perm_b32 v192, v18, v18, s60
v_and_b32 v28, v192, v4
v_and_b32 v29, v192, v5
v_and_b32 v30, v192, v6
v_and_b32 v31, v192, v7
s_waitcnt vmcnt(63)
s_nop 0
v_mfma_f32_16x16x32_bf16 v[44:47], v[28:31], v[112:115], v[44:47]
s_mov_b32 s60, 0x03020302
v_perm_b32 v193, v18, v18, s60
v_and_b32 v32, v193, v4
v_and_b32 v33, v193, v5
v_and_b32 v34, v193, v6
v_and_b32 v35, v193, v7
s_waitcnt vmcnt(63)
s_nop 0
v_mfma_f32_16x16x32_bf16 v[44:47], v[32:35], v[116:119], v[44:47]
s_mov_b32 s60, 0x01000100
v_perm_b32 v192, v19, v19, s60
v_and_b32 v28, v192, v4
v_and_b32 v29, v192, v5
v_and_b32 v30, v192, v6
v_and_b32 v31, v192, v7
s_waitcnt vmcnt(63)
s_nop 0
v_mfma_f32_16x16x32_bf16 v[44:47], v[28:31], v[120:123], v[44:47]
s_mov_b32 s60, 0x03020302
v_perm_b32 v193, v19, v19, s60
v_and_b32 v32, v193, v4
v_and_b32 v33, v193, v5
v_and_b32 v34, v193, v6
v_and_b32 v35, v193, v7
s_waitcnt vmcnt(63)
s_nop 0
v_mfma_f32_16x16x32_bf16 v[44:47], v[32:35], v[124:127], v[44:47]
v_lshrrev_b32 v192, 1, v3
v_lshlrev_b32 v192, 9, v192
v_lshl_add_u32 v192, v2, 5, v192
v_and_b32 v193, 1, v3
v_lshl_add_u32 v192, v193, 4, v192
s_lshl_b32 s63, s34, 10
v_add_u32 v192, s63, v192
s_nop 1
s_nop 5
ds_write_b128 v192, v[44:47] offset:9216
s_waitcnt lgkmcnt(0)
s_barrier
v_lshrrev_b32 v192, 3, v2
v_lshlrev_b32 v192, 9, v192
v_lshl_add_u32 v192, v3, 4, v192
s_lshl_b32 s62, s34, 6
v_add_u32 v192, s62, v192
ds_read_b128 v[200:203], v192 offset:9216
ds_read_b128 v[204:207], v192 offset:10240
ds_read_b128 v[208:211], v192 offset:11264
ds_read_b128 v[212:215], v192 offset:12288
ds_read_b128 v[216:219], v192 offset:13312
ds_read_b128 v[220:223], v192 offset:14336
ds_read_b128 v[224:227], v192 offset:15360
ds_read_b128 v[228:231], v192 offset:16384
s_waitcnt lgkmcnt(6)
v_add_f32 v200, v200, v204
v_add_f32 v201, v201, v205
v_add_f32 v202, v202, v206
v_add_f32 v203, v203, v207
s_waitcnt lgkmcnt(5)
v_add_f32 v200, v200, v208
v_add_f32 v201, v201, v209
v_add_f32 v202, v202, v210
v_add_f32 v203, v203, v211
s_waitcnt lgkmcnt(4)
v_add_f32 v200, v200, v212
v_add_f32 v201, v201, v213
v_add_f32 v202, v202, v214
v_add_f32 v203, v203, v215
s_waitcnt lgkmcnt(3)
v_add_f32 v200, v200, v216
v_add_f32 v201, v201, v217
v_add_f32 v202, v202, v218
v_add_f32 v203, v203, v219
s_waitcnt lgkmcnt(2)
v_add_f32 v200, v200, v220
v_add_f32 v201, v201, v221
v_add_f32 v202, v202, v222
v_add_f32 v203, v203, v223
s_waitcnt lgkmcnt(1)
v_add_f32 v200, v200, v224
v_add_f32 v201, v201, v225
v_add_f32 v202, v202, v226
v_add_f32 v203, v203, v227
s_waitcnt lgkmcnt(0)
v_add_f32 v200, v200, v228
v_add_f32 v201, v201, v229
v_add_f32 v202, v202, v230
v_add_f32 v203, v203, v231
v_cvt_pk_bf16_f32 v60, v200, v200
v_cvt_pk_bf16_f32 v61, v201, v201
v_cvt_pk_bf16_f32 v62, v202, v202
v_cvt_pk_bf16_f32 v63, v203, v203
v_and_b32 v28, v60, v4
v_and_b32 v29, v60, v5
v_and_b32 v30, v60, v6
v_and_b32 v31, v60, v7
v_and_b32 v32, v61, v4
v_and_b32 v33, v61, v5
v_and_b32 v34, v61, v6
v_and_b32 v35, v61, v7
v_and_b32 v36, v62, v4
v_and_b32 v37, v62, v5
v_and_b32 v38, v62, v6
v_and_b32 v39, v62, v7
v_and_b32 v40, v63, v4
v_and_b32 v41, v63, v5
v_and_b32 v42, v63, v6
v_and_b32 v43, v63, v7
v_mfma_f32_16x16x32_bf16 v[44:47], v[28:31], v[128:131], 0
v_mfma_f32_16x16x32_bf16 v[48:51], v[28:31], v[132:135], 0
v_mfma_f32_16x16x32_bf16 v[52:55], v[28:31], v[136:139], 0
v_mfma_f32_16x16x32_bf16 v[56:59], v[28:31], v[140:143], 0
v_mfma_f32_16x16x32_bf16 v[44:47], v[32:35], v[144:147], v[44:47]
v_mfma_f32_16x16x32_bf16 v[48:51], v[32:35], v[148:151], v[48:51]
v_mfma_f32_16x16x32_bf16 v[52:55], v[32:35], v[152:155], v[52:55]
v_mfma_f32_16x16x32_bf16 v[56:59], v[32:35], v[156:159], v[56:59]
v_mfma_f32_16x16x32_bf16 v[44:47], v[36:39], v[160:163], v[44:47]
v_mfma_f32_16x16x32_bf16 v[48:51], v[36:39], v[164:167], v[48:51]
v_mfma_f32_16x16x32_bf16 v[52:55], v[36:39], v[168:171], v[52:55]
v_mfma_f32_16x16x32_bf16 v[56:59], v[36:39], v[172:175], v[56:59]
v_mfma_f32_16x16x32_bf16 v[44:47], v[40:43], v[176:179], v[44:47]
v_mfma_f32_16x16x32_bf16 v[48:51], v[40:43], v[180:183], v[48:51]
v_mfma_f32_16x16x32_bf16 v[52:55], v[40:43], v[184:187], v[52:55]
v_mfma_f32_16x16x32_bf16 v[56:59], v[40:43], v[188:191], v[56:59]
v_lshrrev_b32 v192, 1, v3
v_lshlrev_b32 v192, 11, v192
v_lshl_add_u32 v192, v2, 5, v192
v_and_b32 v193, 1, v3
v_lshl_add_u32 v192, v193, 4, v192
s_lshl_b32 s63, s34, 12
v_add_u32 v192, s63, v192
s_nop 1
ds_write_b128 v192, v[44:47] offset:18432
ds_write_b128 v192, v[48:51] offset:18944
ds_write_b128 v192, v[52:55] offset:19456
s_nop 5
ds_write_b128 v192, v[56:59] offset:19968
s_waitcnt lgkmcnt(0)
s_barrier
s_cmp_ge_u32 s34, 4
s_cbranch_scc1 L_W_yskip
v_lshlrev_b32 v192, 4, v0
ds_read_b128 v[200:203], v192 offset:18432
ds_read_b128 v[204:207], v192 offset:22528
ds_read_b128 v[208:211], v192 offset:26624
ds_read_b128 v[212:215], v192 offset:30720
ds_read_b128 v[216:219], v192 offset:34816
ds_read_b128 v[220:223], v192 offset:38912
ds_read_b128 v[224:227], v192 offset:43008
ds_read_b128 v[228:231], v192 offset:47104
v_bfe_u32 v193, v0, 7, 1
v_lshlrev_b32 v193, 16, v193
v_and_b32 v194, 127, v0
v_lshl_add_u32 v193, v194, 4, v193
s_lshl_b32 s63, s32, 11
s_add_u32 s63, s63, 0x20000
v_add_u32 v193, s63, v193
v_mov_b32 v194, 0xffffff00
s_waitcnt lgkmcnt(6)
v_add_f32 v200, v200, v204
v_add_f32 v201, v201, v205
v_add_f32 v202, v202, v206
v_add_f32 v203, v203, v207
s_waitcnt lgkmcnt(5)
v_add_f32 v200, v200, v208
v_add_f32 v201, v201, v209
v_add_f32 v202, v202, v210
v_add_f32 v203, v203, v211
s_waitcnt lgkmcnt(4)
v_add_f32 v200, v200, v212
v_add_f32 v201, v201, v213
v_add_f32 v202, v202, v214
v_add_f32 v203, v203, v215
s_waitcnt lgkmcnt(3)
v_add_f32 v200, v200, v216
v_add_f32 v201, v201, v217
v_add_f32 v202, v202, v218
v_add_f32 v203, v203, v219
s_waitcnt lgkmcnt(2)
v_add_f32 v200, v200, v220
v_add_f32 v201, v201, v221
v_add_f32 v202, v202, v222
v_add_f32 v203, v203, v223
s_waitcnt lgkmcnt(1)
v_add_f32 v200, v200, v224
v_add_f32 v201, v201, v225
v_add_f32 v202, v202, v226
v_add_f32 v203, v203, v227
s_waitcnt lgkmcnt(0)
v_add_f32 v200, v200, v228
v_add_f32 v201, v201, v229
v_add_f32 v202, v202, v230
v_add_f32 v203, v203, v231
v_add_u32 v200, 0x80, v200
v_add_u32 v201, 0x80, v201
v_add_u32 v202, 0x80, v202
v_add_u32 v203, 0x80, v203
v_and_or_b32 v200, v200, v194, s76
v_and_or_b32 v201, v201, v194, s77
v_and_or_b32 v202, v202, v194, s78
v_and_or_b32 v203, v203, v194, s79
buffer_store_dwordx4 v[200:203], v193, s[52:55], 0 offen sc1
L_W_yskip:
s_cmp_lg_u32 s34, 4
s_cbranch_scc1 L_W_end
s_mov_b32 s64, 0
s_mov_b32 s66, 0x4000
s_mov_b32 s67, 0x8000
s_mov_b32 s65, 0xc000
buffer_load_dwordx4 v[64:67], v9, s[52:55], 0 offen sc1
buffer_load_dwordx4 v[68:71], v9, s[52:55], s66 offen sc1
buffer_load_dwordx4 v[72:75], v9, s[52:55], s67 offen sc1
buffer_load_dwordx4 v[76:79], v9, s[52:55], s65 offen sc1
L_ps_Wf:
s_waitcnt vmcnt(3)
v_xor_b32 v80, s76, v64
v_xor_b32 v81, s77, v65
v_xor_b32 v82, s78, v66
v_xor_b32 v83, s79, v67
v_or_b32 v192, v80, v81
v_or3_b32 v192, v192, v82, v83
s_waitcnt vmcnt(2)
v_xor_b32 v84, s76, v68
v_xor_b32 v85, s77, v69
v_xor_b32 v86, s78, v70
v_xor_b32 v87, s79, v71
v_or3_b32 v192, v192, v84, v85
v_or3_b32 v192, v192, v86, v87
v_add_f32 v80, v80, v84
v_add_f32 v81, v81, v85
v_add_f32 v82, v82, v86
v_add_f32 v83, v83, v87
s_waitcnt vmcnt(1)
v_xor_b32 v84, s76, v72
v_xor_b32 v85, s77, v73
v_xor_b32 v86, s78, v74
v_xor_b32 v87, s79, v75
v_or3_b32 v192, v192, v84, v85
v_or3_b32 v192, v192, v86, v87
v_add_f32 v80, v80, v84
v_add_f32 v81, v81, v85
v_add_f32 v82, v82, v86
v_add_f32 v83, v83, v87
s_waitcnt vmcnt(0)
v_xor_b32 v84, s76, v76
v_xor_b32 v85, s77, v77
v_xor_b32 v86, s78, v78
v_xor_b32 v87, s79, v79
v_or3_b32 v192, v192, v84, v85
v_or3_b32 v192, v192, v86, v87
v_add_f32 v80, v80, v84
v_add_f32 v81, v81, v85
v_add_f32 v82, v82, v86
v_add_f32 v83, v83, v87
v_and_b32 v192, 0xff, v192
v_cmp_ne_u32 vcc, 0, v192
v_add_f32_dpp v80, v80, v80 row_ror:8 row_mask:0xf bank_mask:0xf
v_add_f32_dpp v81, v81, v81 row_ror:8 row_mask:0xf bank_mask:0xf
v_add_f32_dpp v82, v82, v82 row_ror:8 row_mask:0xf bank_mask:0xf
v_add_f32_dpp v83, v83, v83 row_ror:8 row_mask:0xf bank_mask:0xf
s_cmp_eq_u64 vcc, 0
s_cbranch_scc1 L_pe_Wf
s_sleep 2
buffer_load_dwordx4 v[64:67], v9, s[52:55], 0 offen sc1
buffer_load_dwordx4 v[68:71], v9, s[52:55], s66 offen sc1
buffer_load_dwordx4 v[72:75], v9, s[52:55], s67 offen sc1
buffer_load_dwordx4 v[76:79], v9, s[52:55], s65 offen sc1
s_add_u32 s64, s64, 1
s_cmp_lt_u32 s64, 65536
s_cbranch_scc1 L_ps_Wf
L_pe_Wf:
v_add_f32_dpp v80, v80, v80 row_ror:4 row_mask:0xf bank_mask:0xf
v_add_f32_dpp v81, v81, v81 row_ror:4 row_mask:0xf bank_mask:0xf
v_add_f32_dpp v82, v82, v82 row_ror:4 row_mask:0xf bank_mask:0xf
v_add_f32_dpp v83, v83, v83 row_ror:4 row_mask:0xf bank_mask:0xf
v_mov_b32 v192, v80
v_mov_b32 v193, v81
v_mov_b32 v194, v82
v_mov_b32 v195, v83
v_permlane16_swap_b32 v80, v192
v_permlane16_swap_b32 v81, v193
v_permlane16_swap_b32 v82, v194
v_permlane16_swap_b32 v83, v195
v_add_f32 v80, v80, v192
v_add_f32 v81, v81, v193
v_add_f32 v82, v82, v194
v_add_f32 v83, v83, v195
v_cvt_pk_bf16_f32 v80, v80, v81
v_cvt_pk_bf16_f32 v81, v82, v83
s_mov_b32 exec_lo, 15
s_mov_b32 exec_hi, 15
global_store_dwordx2 v10, v[80:81], s[26:27]
s_mov_b64 exec, -1
L_W_end:
s_endpgm
L_roleC:
s_lshl_b32 s60, s32, 8
s_sub_u32 s61, 0x400000, s60
s_add_u32 s68, s10, s60
s_addc_u32 s69, s11, 0
s_and_b32 s69, s69, 0xffff
s_mov_b32 s70, s61
s_mov_b32 s71, 0x20000
s_mov_b32 s72, s4
s_and_b32 s73, s5, 0xffff
s_mov_b32 s74, 0x800
s_mov_b32 s75, 0x20000
v_lshrrev_b32 v240, 3, v2
v_lshlrev_b32 v240, 10, v240
v_lshl_add_u32 v240, v3, 5, v240
s_lshl_b32 s62, s34, 7
v_add_u32 v240, s62, v240
s_mov_b32 s80, 0
buffer_load_dwordx4 v[32:35], v240, s[72:75], 0 offen
buffer_load_dwordx4 v[36:39], v240, s[72:75], 0 offen offset:16
v_lshlrev_b32 v9, 17, v3
v_lshl_add_u32 v9, v2, 4, v9
s_lshl_b32 s62, s34, 19
v_add_u32 v9, s62, v9
s_xor_b32 s62, s80, 0
buffer_load_dwordx4 v[128:131], v9, s[68:71], s62 offen nt
s_xor_b32 s62, s80, 8192
buffer_load_dwordx4 v[132:135], v9, s[68:71], s62 offen nt
s_xor_b32 s62, s80, 16384
buffer_load_dwordx4 v[136:139], v9, s[68:71], s62 offen nt
s_xor_b32 s62, s80, 24576
buffer_load_dwordx4 v[140:143], v9, s[68:71], s62 offen nt
s_xor_b32 s62, s80, 32768
buffer_load_dwordx4 v[144:147], v9, s[68:71], s62 offen nt
s_xor_b32 s62, s80, 40960
buffer_load_dwordx4 v[148:151], v9, s[68:71], s62 offen nt
s_xor_b32 s62, s80, 49152
buffer_load_dwordx4 v[152:155], v9, s[68:71], s62 offen nt
s_xor_b32 s62, s80, 57344
buffer_load_dwordx4 v[156:159], v9, s[68:71], s62 offen nt
s_xor_b32 s62, s80, 65536
buffer_load_dwordx4 v[160:163], v9, s[68:71], s62 offen nt
s_xor_b32 s62, s80, 73728
buffer_load_dwordx4 v[164:167], v9, s[68:71], s62 offen nt
s_xor_b32 s62, s80, 81920
buffer_load_dwordx4 v[168:171], v9, s[68:71], s62 offen nt
s_xor_b32 s62, s80, 90112
buffer_load_dwordx4 v[172:175], v9, s[68:71], s62 offen nt
s_xor_b32 s62, s80, 98304
buffer_load_dwordx4 v[176:179], v9, s[68:71], s62 offen nt
s_xor_b32 s62, s80, 106496
buffer_load_dwordx4 v[180:183], v9, s[68:71], s62 offen nt
s_xor_b32 s62, s80, 114688
buffer_load_dwordx4 v[184:187], v9, s[68:71], s62 offen nt
s_xor_b32 s62, s80, 122880
buffer_load_dwordx4 v[188:191], v9, s[68:71], s62 offen nt
s_load_dword s58, s[30:31], 0x14000
s_mov_b32 s44, s30
s_and_b32 s45, s31, 0xffff
s_mov_b32 s46, 0x1000000
s_mov_b32 s47, 0x20000
s_cmp_lg_u32 s34, 6
s_cbranch_scc1 L_C_ctr
v_mov_b32 v192, -1
s_lshl_b32 s62, s32, 13
s_add_u32 s62, s62, 0x61800
v_lshl_add_u32 v240, v1, 7, s62
s_mov_b64 exec, 1
buffer_store_dword v192, v240, s[44:47], 0 offen sc1
s_mov_b64 exec, -1
L_C_ctr:
v_and_b32 v242, 1, v0
v_lshlrev_b32 v242, 4, v242
v_mov_b32 v243, 0xffff
v_lshlrev_b32 v242, v242, v243
v_bfe_u32 v243, v0, 1, 2
v_cmp_eq_u32 vcc, 0, v243
s_nop 1
v_cndmask_b32 v4, 0, v242, vcc
v_cmp_eq_u32 vcc, 1, v243
s_nop 1
v_cndmask_b32 v5, 0, v242, vcc
v_cmp_eq_u32 vcc, 2, v243
s_nop 1
v_cndmask_b32 v6, 0, v242, vcc
v_cmp_eq_u32 vcc, 3, v243
s_nop 1
v_cndmask_b32 v7, 0, v242, vcc
v_mov_b32 v8, 0
s_lshr_b32 s35, s32, 4
s_lshr_b32 s36, s34, 1
s_and_b32 s37, s34, 1
s_lshr_b32 s60, s32, 0
s_lshl_b32 s60, s60, 19
s_mov_b32 s61, 0x80000
s_add_u32 s40, s16, s60
s_addc_u32 s41, s17, 0
s_and_b32 s41, s41, 0xffff
s_mov_b32 s42, s61
s_mov_b32 s43, 0x20000
v_lshrrev_b32 v242, 1, v3
v_lshlrev_b32 v242, 9, v242
v_lshl_add_u32 v242, v2, 5, v242
v_and_b32 v243, 1, v3
v_lshl_add_u32 v242, v243, 4, v242
s_lshl_b32 s63, s34, 10
v_add_u32 v242, s63, v242
v_add_u32 v242, 140288, v242
v_lshlrev_b32 v243, 4, v1
s_lshl_b32 s62, s32, 10
s_add_u32 s62, s62, 0x18000
v_add_u32 v244, s62, v243
v_add_u32 v243, 140288, v243
s_waitcnt vmcnt(16) lgkmcnt(0)
s_add_u32 s58, s58, 0x9e3779b9
s_bfe_u32 s76, s58, 0x80000
s_bfe_u32 s77, s58, 0x80008
s_bfe_u32 s78, s58, 0x80010
s_bfe_u32 s79, s58, 0x80018
v_mov_b32 v245, s58
s_mov_b32 s60, 0x01000100
v_perm_b32 v240, v32, v32, s60
v_and_b32 v40, v240, v4
v_and_b32 v41, v240, v5
v_and_b32 v42, v240, v6
v_and_b32 v43, v240, v7
s_waitcnt vmcnt(15)
s_nop 0
v_mfma_f32_16x16x32_bf16 v[48:51], v[40:43], v[128:131], 0
s_mov_b32 s60, 0x03020302
v_perm_b32 v241, v32, v32, s60
v_and_b32 v44, v241, v4
v_and_b32 v45, v241, v5
v_and_b32 v46, v241, v6
v_and_b32 v47, v241, v7
s_waitcnt vmcnt(14)
s_nop 0
v_mfma_f32_16x16x32_bf16 v[48:51], v[44:47], v[132:135], v[48:51]
s_mov_b32 s60, 0x01000100
v_perm_b32 v240, v33, v33, s60
v_and_b32 v40, v240, v4
v_and_b32 v41, v240, v5
v_and_b32 v42, v240, v6
v_and_b32 v43, v240, v7
s_waitcnt vmcnt(13)
s_nop 0
v_mfma_f32_16x16x32_bf16 v[48:51], v[40:43], v[136:139], v[48:51]
s_mov_b32 s60, 0x03020302
v_perm_b32 v241, v33, v33, s60
v_and_b32 v44, v241, v4
v_and_b32 v45, v241, v5
v_and_b32 v46, v241, v6
v_and_b32 v47, v241, v7
s_waitcnt vmcnt(12)
s_nop 0
v_mfma_f32_16x16x32_bf16 v[48:51], v[44:47], v[140:143], v[48:51]
s_mov_b32 s60, 0x01000100
v_perm_b32 v240, v34, v34, s60
v_and_b32 v40, v240, v4
v_and_b32 v41, v240, v5
v_and_b32 v42, v240, v6
v_and_b32 v43, v240, v7
s_waitcnt vmcnt(11)
s_nop 0
v_mfma_f32_16x16x32_bf16 v[48:51], v[40:43], v[144:147], v[48:51]
s_mov_b32 s60, 0x03020302
v_perm_b32 v241, v34, v34, s60
v_and_b32 v44, v241, v4
v_and_b32 v45, v241, v5
v_and_b32 v46, v241, v6
v_and_b32 v47, v241, v7
s_waitcnt vmcnt(10)
s_nop 0
v_mfma_f32_16x16x32_bf16 v[48:51], v[44:47], v[148:151], v[48:51]
s_mov_b32 s60, 0x01000100
v_perm_b32 v240, v35, v35, s60
v_and_b32 v40, v240, v4
v_and_b32 v41, v240, v5
v_and_b32 v42, v240, v6
v_and_b32 v43, v240, v7
s_waitcnt vmcnt(9)
s_nop 0
v_mfma_f32_16x16x32_bf16 v[48:51], v[40:43], v[152:155], v[48:51]
s_mov_b32 s60, 0x03020302
v_perm_b32 v241, v35, v35, s60
v_and_b32 v44, v241, v4
v_and_b32 v45, v241, v5
v_and_b32 v46, v241, v6
v_and_b32 v47, v241, v7
s_waitcnt vmcnt(8)
s_nop 0
v_mfma_f32_16x16x32_bf16 v[48:51], v[44:47], v[156:159], v[48:51]
s_mov_b32 s60, 0x01000100
v_perm_b32 v240, v36, v36, s60
v_and_b32 v40, v240, v4
v_and_b32 v41, v240, v5
v_and_b32 v42, v240, v6
v_and_b32 v43, v240, v7
s_waitcnt vmcnt(7)
s_nop 0
v_mfma_f32_16x16x32_bf16 v[48:51], v[40:43], v[160:163], v[48:51]
s_mov_b32 s60, 0x03020302
v_perm_b32 v241, v36, v36, s60
v_and_b32 v44, v241, v4
v_and_b32 v45, v241, v5
v_and_b32 v46, v241, v6
v_and_b32 v47, v241, v7
s_waitcnt vmcnt(6)
s_nop 0
v_mfma_f32_16x16x32_bf16 v[48:51], v[44:47], v[164:167], v[48:51]
s_mov_b32 s60, 0x01000100
v_perm_b32 v240, v37, v37, s60
v_and_b32 v40, v240, v4
v_and_b32 v41, v240, v5
v_and_b32 v42, v240, v6
v_and_b32 v43, v240, v7
s_waitcnt vmcnt(5)
s_nop 0
v_mfma_f32_16x16x32_bf16 v[48:51], v[40:43], v[168:171], v[48:51]
s_mov_b32 s60, 0x03020302
v_perm_b32 v241, v37, v37, s60
v_and_b32 v44, v241, v4
v_and_b32 v45, v241, v5
v_and_b32 v46, v241, v6
v_and_b32 v47, v241, v7
s_waitcnt vmcnt(4)
s_nop 0
v_mfma_f32_16x16x32_bf16 v[48:51], v[44:47], v[172:175], v[48:51]
s_mov_b32 s60, 0x01000100
v_perm_b32 v240, v38, v38, s60
v_and_b32 v40, v240, v4
v_and_b32 v41, v240, v5
v_and_b32 v42, v240, v6
v_and_b32 v43, v240, v7
s_waitcnt vmcnt(3)
s_nop 0
v_mfma_f32_16x16x32_bf16 v[48:51], v[40:43], v[176:179], v[48:51]
s_mov_b32 s60, 0x03020302
v_perm_b32 v241, v38, v38, s60
v_and_b32 v44, v241, v4
v_and_b32 v45, v241, v5
v_and_b32 v46, v241, v6
v_and_b32 v47, v241, v7
s_waitcnt vmcnt(2)
s_nop 0
v_mfma_f32_16x16x32_bf16 v[48:51], v[44:47], v[180:183], v[48:51]
s_mov_b32 s60, 0x01000100
v_perm_b32 v240, v39, v39, s60
v_and_b32 v40, v240, v4
v_and_b32 v41, v240, v5
v_and_b32 v42, v240, v6
v_and_b32 v43, v240, v7
s_waitcnt vmcnt(1)
s_nop 0
v_mfma_f32_16x16x32_bf16 v[48:51], v[40:43], v[184:187], v[48:51]
s_mov_b32 s60, 0x03020302
v_perm_b32 v241, v39, v39, s60
v_and_b32 v44, v241, v4
v_and_b32 v45, v241, v5
v_and_b32 v46, v241, v6
v_and_b32 v47, v241, v7
s_waitcnt vmcnt(0)
s_nop 0
v_mfma_f32_16x16x32_bf16 v[48:51], v[44:47], v[188:191], v[48:51]
s_nop 7
ds_write_b128 v242, v[48:51]
s_waitcnt lgkmcnt(0)
s_barrier
s_cmp_lg_u32 s34, 0
s_cbranch_scc1 L_C_qs
ds_read_b128 v[128:131], v243 offset:0
ds_read_b128 v[132:135], v243 offset:1024
ds_read_b128 v[136:139], v243 offset:2048
ds_read_b128 v[140:143], v243 offset:3072
ds_read_b128 v[144:147], v243 offset:4096
ds_read_b128 v[148:151], v243 offset:5120
ds_read_b128 v[152:155], v243 offset:6144
ds_read_b128 v[156:159], v243 offset:7168
s_mov_b32 s60, 0x05040100
s_mov_b32 s61, 0x07060302
s_waitcnt lgkmcnt(6)
v_add_f32 v128, v128, v132
v_add_f32 v129, v129, v133
v_add_f32 v130, v130, v134
v_add_f32 v131, v131, v135
s_waitcnt lgkmcnt(5)
v_add_f32 v128, v128, v136
v_add_f32 v129, v129, v137
v_add_f32 v130, v130, v138
v_add_f32 v131, v131, v139
s_waitcnt lgkmcnt(4)
v_add_f32 v128, v128, v140
v_add_f32 v129, v129, v141
v_add_f32 v130, v130, v142
v_add_f32 v131, v131, v143
s_waitcnt lgkmcnt(3)
v_add_f32 v128, v128, v144
v_add_f32 v129, v129, v145
v_add_f32 v130, v130, v146
v_add_f32 v131, v131, v147
s_waitcnt lgkmcnt(2)
v_add_f32 v128, v128, v148
v_add_f32 v129, v129, v149
v_add_f32 v130, v130, v150
v_add_f32 v131, v131, v151
s_waitcnt lgkmcnt(1)
v_add_f32 v128, v128, v152
v_add_f32 v129, v129, v153
v_add_f32 v130, v130, v154
v_add_f32 v131, v131, v155
s_waitcnt lgkmcnt(0)
v_add_f32 v128, v128, v156
v_add_f32 v129, v129, v157
v_add_f32 v130, v130, v158
v_add_f32 v131, v131, v159
v_cvt_pk_bf16_f32 v128, v128, v129
v_cvt_pk_bf16_f32 v129, v130, v131
v_perm_b32 v132, v128, v245, s60
v_perm_b32 v133, v128, v245, s61
v_perm_b32 v134, v129, v245, s60
v_perm_b32 v135, v129, v245, s61
buffer_store_dwordx4 v[132:135], v244, s[44:47], 0 offen sc1
L_C_qs:
v_lshlrev_b32 v9, 4, v1
s_mul_i32 s62, s34, 4096
v_add_u32 v9, s62, v9
s_mul_i32 s38, s34, 4224
s_and_b32 s54, s32, 3
s_lshl_b32 s54, s54, 17
s_mov_b32 s53, 0
s_lshl_b32 s60, s32, 17
s_mov_b32 s61, 0x20000
s_add_u32 s68, s12, s60
s_addc_u32 s69, s13, 0
s_and_b32 s69, s69, 0xffff
s_mov_b32 s70, s61
s_mov_b32 s71, 0x20000
s_add_u32 s50, s38, 5120
s_cmp_lt_u32 s53, 0x80000
s_cselect_b32 s40, s40, s68
s_cselect_b32 s41, s41, s69
s_cselect_b32 s42, s42, s70
s_cselect_b32 s54, s54, 0
s_and_b32 s49, s53, 0x70000
s_xor_b32 s49, s49, s54
s_add_u32 s51, s49, 32768
s_add_u32 s53, s53, 0x10000
s_add_u32 m0, s50, 0
s_nop 0
buffer_load_dwordx4 v9, s[40:43], s49 offen offset:0 nt lds
s_add_u32 m0, s50, 32
s_nop 0
buffer_load_dwordx4 v9, s[40:43], s49 offen offset:1024 nt lds
s_add_u32 m0, s50, 64
s_nop 0
buffer_load_dwordx4 v9, s[40:43], s49 offen offset:2048 nt lds
s_add_u32 m0, s50, 96
s_nop 0
buffer_load_dwordx4 v9, s[40:43], s49 offen offset:3072 nt lds
s_add_u32 m0, s50, 33792
s_nop 0
buffer_load_dwordx4 v9, s[40:43], s51 offen offset:0 nt lds
s_add_u32 m0, s50, 33824
s_nop 0
buffer_load_dwordx4 v9, s[40:43], s51 offen offset:1024 nt lds
s_add_u32 m0, s50, 33856
s_nop 0
buffer_load_dwordx4 v9, s[40:43], s51 offen offset:2048 nt lds
s_add_u32 m0, s50, 33888
s_nop 0
buffer_load_dwordx4 v9, s[40:43], s51 offen offset:3072 nt lds
s_add_u32 s50, s38, 72704
s_cmp_lt_u32 s53, 0x80000
s_cselect_b32 s40, s40, s68
s_cselect_b32 s41, s41, s69
s_cselect_b32 s42, s42, s70
s_cselect_b32 s54, s54, 0
s_and_b32 s49, s53, 0x70000
s_xor_b32 s49, s49, s54
s_add_u32 s51, s49, 32768
s_add_u32 s53, s53, 0x10000
s_add_u32 m0, s50, 0
s_nop 0
buffer_load_dwordx4 v9, s[40:43], s49 offen offset:0 nt lds
s_add_u32 m0, s50, 32
s_nop 0
buffer_load_dwordx4 v9, s[40:43], s49 offen offset:1024 nt lds
s_add_u32 m0, s50, 64
s_nop 0
buffer_load_dwordx4 v9, s[40:43], s49 offen offset:2048 nt lds
s_add_u32 m0, s50, 96
s_nop 0
buffer_load_dwordx4 v9, s[40:43], s49 offen offset:3072 nt lds
s_add_u32 m0, s50, 33792
s_nop 0
buffer_load_dwordx4 v9, s[40:43], s51 offen offset:0 nt lds
s_add_u32 m0, s50, 33824
s_nop 0
buffer_load_dwordx4 v9, s[40:43], s51 offen offset:1024 nt lds
s_add_u32 m0, s50, 33856
s_nop 0
buffer_load_dwordx4 v9, s[40:43], s51 offen offset:2048 nt lds
s_add_u32 m0, s50, 33888
s_nop 0
buffer_load_dwordx4 v9, s[40:43], s51 offen offset:3072 nt lds
s_cmp_lt_u32 s53, 0x80000
s_cselect_b32 s40, s40, s68
s_cselect_b32 s41, s41, s69
s_cselect_b32 s42, s42, s70
s_cselect_b32 s54, s54, 0
s_and_b32 s49, s53, 0x70000
s_xor_b32 s49, s49, s54
s_add_u32 s51, s49, 32768
s_add_u32 s53, s53, 0x10000
buffer_load_dwordx4 v[208:211], v9, s[40:43], s49 offen offset:0 nt
buffer_load_dwordx4 v[212:215], v9, s[40:43], s49 offen offset:1024 nt
buffer_load_dwordx4 v[216:219], v9, s[40:43], s49 offen offset:2048 nt
buffer_load_dwordx4 v[220:223], v9, s[40:43], s49 offen offset:3072 nt
buffer_load_dwordx4 v[224:227], v9, s[40:43], s51 offen offset:0 nt
buffer_load_dwordx4 v[228:231], v9, s[40:43], s51 offen offset:1024 nt
buffer_load_dwordx4 v[232:235], v9, s[40:43], s51 offen offset:2048 nt
buffer_load_dwordx4 v[236:239], v9, s[40:43], s51 offen offset:3072 nt
s_add_u32 s62, s38, 5120
v_lshl_add_u32 v22, v1, 4, s62
s_lshl_b32 s62, s36, 4
v_add_u32 v240, s62, v2
v_mul_u32_u24 v10, 1056, v240
v_lshl_add_u32 v10, v3, 4, v10
v_add_u32 v10, 5120, v10
v_lshrrev_b32 v240, 1, v3
v_lshlrev_b32 v240, 3, v240
v_lshrrev_b32 v241, 2, v2
v_add_u32 v240, v240, v241
v_mul_u32_u24 v11, 1056, v240
v_and_b32 v240, 1, v3
v_lshl_add_u32 v11, v240, 5, v11
v_and_b32 v240, 3, v2
v_lshl_add_u32 v11, v240, 3, v11
s_lshl_b32 s62, s34, 7
s_add_u32 s62, s62, 5120
v_add_u32 v11, s62, v11
s_lshl_b32 s62, s37, 4
v_add_u32 v240, s62, v2
v_mul_u32_u24 v12, 144, v240
v_lshl_add_u32 v12, v3, 3, v12
s_lshl_b32 s62, s36, 5
v_add_u32 v12, s62, v12
v_lshlrev_b32 v15, 4, v240
s_lshl_b32 s62, s36, 2
v_add_u32 v14, s62, v15
v_and_b32 v240, 31, v1
v_mul_u32_u24 v13, 144, v240
v_lshrrev_b32 v241, 5, v1
v_lshl_add_u32 v13, v241, 4, v13
v_lshlrev_b32 v16, 4, v240
v_mov_b32 v17, 0x3e0293ee
v_mov_b32 v18, 0xff800000
v_mov_b32 v19, 0xff800000
v_mov_b32 v20, 0
v_mov_b32 v96, 0
v_mov_b32 v97, 0
v_mov_b32 v98, 0
v_mov_b32 v99, 0
v_mov_b32 v100, 0
v_mov_b32 v101, 0
v_mov_b32 v102, 0
v_mov_b32 v103, 0
v_mov_b32 v104, 0
v_mov_b32 v105, 0
v_mov_b32 v106, 0
v_mov_b32 v107, 0
v_mov_b32 v108, 0
v_mov_b32 v109, 0
v_mov_b32 v110, 0
v_mov_b32 v111, 0
v_mov_b32 v112, 0
v_mov_b32 v113, 0
v_mov_b32 v114, 0
v_mov_b32 v115, 0
v_mov_b32 v116, 0
v_mov_b32 v117, 0
v_mov_b32 v118, 0
v_mov_b32 v119, 0
v_mov_b32 v120, 0
v_mov_b32 v121, 0
v_mov_b32 v122, 0
v_mov_b32 v123, 0
v_mov_b32 v124, 0
v_mov_b32 v125, 0
v_mov_b32 v126, 0
v_mov_b32 v127, 0
v_lshlrev_b32 v240, 7, v1
v_add_u32 v240, 0x15000, v240
s_cmp_lg_u32 s34, 0
s_cbranch_scc1 L_wf_Cq
s_lshl_b64 exec, 1, s32
s_mov_b32 s64, 0
L_pl_Cq1:
buffer_load_dword v241, v240, s[44:47], 0 offen sc1
s_add_u32 s64, s64, 1
s_waitcnt vmcnt(0)
v_cmp_ne_u32 vcc, s58, v241
s_nop 0
s_cmp_eq_u64 vcc, 0
s_cbranch_scc1 L_pd_Cq1
s_mov_b64 exec, vcc
s_sleep 8
s_cmp_lt_u32 s64, 65536
s_cbranch_scc1 L_pl_Cq1
L_pd_Cq1:
s_mov_b32 exec_lo, -1
s_mov_b32 exec_hi, 0
s_mov_b32 s64, 0
L_pl_Cq2:
buffer_load_dword v241, v240, s[44:47], 0 offen sc1
s_add_u32 s64, s64, 1
s_waitcnt vmcnt(0)
v_cmp_ne_u32 vcc, s58, v241
s_nop 0
s_cmp_eq_u64 vcc, 0
s_cbranch_scc1 L_pd_Cq2
s_mov_b64 exec, vcc
s_sleep 2
s_cmp_lt_u32 s64, 65536
s_cbranch_scc1 L_pl_Cq2
L_pd_Cq2:
s_mov_b64 exec, -1
L_wf_Cq:
s_barrier
s_lshl_b32 s62, s35, 5
s_lshl_b32 s63, s37, 4
s_add_u32 s62, s62, s63
v_add_u32 v240, s62, v2
v_lshlrev_b32 v240, 10, v240
v_lshl_add_u32 v240, v3, 4, v240
buffer_load_dwordx4 v[32:35], v240, s[44:47], 0 offen offset:0 sc1
buffer_load_dwordx4 v[36:39], v240, s[44:47], 0 offen offset:64 sc1
buffer_load_dwordx4 v[40:43], v240, s[44:47], 0 offen offset:128 sc1
buffer_load_dwordx4 v[44:47], v240, s[44:47], 0 offen offset:192 sc1
buffer_load_dwordx4 v[48:51], v240, s[44:47], 0 offen offset:256 sc1
buffer_load_dwordx4 v[52:55], v240, s[44:47], 0 offen offset:320 sc1
buffer_load_dwordx4 v[56:59], v240, s[44:47], 0 offen offset:384 sc1
buffer_load_dwordx4 v[60:63], v240, s[44:47], 0 offen offset:448 sc1
buffer_load_dwordx4 v[64:67], v240, s[44:47], 0 offen offset:512 sc1
buffer_load_dwordx4 v[68:71], v240, s[44:47], 0 offen offset:576 sc1
buffer_load_dwordx4 v[72:75], v240, s[44:47], 0 offen offset:640 sc1
buffer_load_dwordx4 v[76:79], v240, s[44:47], 0 offen offset:704 sc1
buffer_load_dwordx4 v[80:83], v240, s[44:47], 0 offen offset:768 sc1
buffer_load_dwordx4 v[84:87], v240, s[44:47], 0 offen offset:832 sc1
buffer_load_dwordx4 v[88:91], v240, s[44:47], 0 offen offset:896 sc1
buffer_load_dwordx4 v[92:95], v240, s[44:47], 0 offen offset:960 sc1
s_mov_b32 s39, 0
s_mov_b32 s48, 0
s_waitcnt vmcnt(0)
.p2align 6
L_C_loop:
s_waitcnt lgkmcnt(0)
s_barrier
s_mov_b32 s52, 1
s_cmp_eq_u32 s39, 0
s_cselect_b32 s52, 0, s52
s_sub_u32 s50, 67584, s48
v_add_u32 v23, s50, v22
s_cmp_eq_u32 s52, 0
s_cbranch_scc1 L_C_st0
s_cmp_lt_u32 s53, 0x80000
s_cselect_b32 s40, s40, s68
s_cselect_b32 s41, s41, s69
s_cselect_b32 s42, s42, s70
s_cselect_b32 s54, s54, 0
s_and_b32 s49, s53, 0x70000
s_xor_b32 s49, s49, s54
s_add_u32 s51, s49, 32768
s_add_u32 s53, s53, 0x10000
s_waitcnt vmcnt(7)
ds_write_b128 v23, v[208:211] offset:0
buffer_load_dwordx4 v[208:211], v9, s[40:43], s49 offen offset:0 nt
s_waitcnt vmcnt(7)
ds_write_b128 v23, v[212:215] offset:1056
buffer_load_dwordx4 v[212:215], v9, s[40:43], s49 offen offset:1024 nt
L_C_st0:
v_add_u32 v240, s48, v10
v_add_u32 v241, s48, v11
ds_read_b128 v[128:131], v240 offset:0
ds_read_b128 v[132:135], v240 offset:64
ds_read_b128 v[136:139], v240 offset:128
ds_read_b128 v[140:143], v240 offset:192
ds_read_b128 v[144:147], v240 offset:256
ds_read_b128 v[148:151], v240 offset:320
ds_read_b128 v[152:155], v240 offset:384
ds_read_b128 v[156:159], v240 offset:448
ds_read_b128 v[160:163], v240 offset:512
ds_read_b128 v[164:167], v240 offset:576
ds_read_b128 v[168:171], v240 offset:640
ds_read_b128 v[172:175], v240 offset:704
ds_read_b128 v[176:179], v240 offset:768
ds_read_b128 v[180:183], v240 offset:832
ds_read_b128 v[184:187], v240 offset:896
ds_read_b128 v[188:191], v240 offset:960
s_waitcnt lgkmcnt(15)
v_mfma_f32_16x16x32_bf16 v[28:31], v[128:131], v[32:35], 0
s_waitcnt lgkmcnt(14)
v_mfma_f32_16x16x32_bf16 v[28:31], v[132:135], v[36:39], v[28:31]
s_waitcnt lgkmcnt(13)
v_mfma_f32_16x16x32_bf16 v[28:31], v[136:139], v[40:43], v[28:31]
s_waitcnt lgkmcnt(12)
v_mfma_f32_16x16x32_bf16 v[28:31], v[140:143], v[44:47], v[28:31]
s_waitcnt lgkmcnt(11)
v_mfma_f32_16x16x32_bf16 v[28:31], v[144:147], v[48:51], v[28:31]
s_waitcnt lgkmcnt(10)
v_mfma_f32_16x16x32_bf16 v[28:31], v[148:151], v[52:55], v[28:31]
s_waitcnt lgkmcnt(9)
v_mfma_f32_16x16x32_bf16 v[28:31], v[152:155], v[56:59], v[28:31]
s_waitcnt lgkmcnt(8)
v_mfma_f32_16x16x32_bf16 v[28:31], v[156:159], v[60:63], v[28:31]
s_waitcnt lgkmcnt(7)
v_mfma_f32_16x16x32_bf16 v[28:31], v[160:163], v[64:67], v[28:31]
s_waitcnt lgkmcnt(6)
v_mfma_f32_16x16x32_bf16 v[28:31], v[164:167], v[68:71], v[28:31]
s_waitcnt lgkmcnt(5)
v_mfma_f32_16x16x32_bf16 v[28:31], v[168:171], v[72:75], v[28:31]
s_waitcnt lgkmcnt(4)
v_mfma_f32_16x16x32_bf16 v[28:31], v[172:175], v[76:79], v[28:31]
s_waitcnt lgkmcnt(3)
v_mfma_f32_16x16x32_bf16 v[28:31], v[176:179], v[80:83], v[28:31]
s_waitcnt lgkmcnt(2)
v_mfma_f32_16x16x32_bf16 v[28:31], v[180:183], v[84:87], v[28:31]
s_waitcnt lgkmcnt(1)
v_mfma_f32_16x16x32_bf16 v[28:31], v[184:187], v[88:91], v[28:31]
s_waitcnt lgkmcnt(0)
v_mfma_f32_16x16x32_bf16 v[28:31], v[188:191], v[92:95], v[28:31]
s_cmp_eq_u32 s52, 0
s_cbranch_scc1 L_C_st1
s_waitcnt vmcnt(7)
ds_write_b128 v23, v[216:219] offset:2112
buffer_load_dwordx4 v[216:219], v9, s[40:43], s49 offen offset:2048 nt
s_waitcnt vmcnt(7)
ds_write_b128 v23, v[220:223] offset:3168
buffer_load_dwordx4 v[220:223], v9, s[40:43], s49 offen offset:3072 nt
L_C_st1:
s_nop 7
v_mul_f32 v24, v28, v17
v_mul_f32 v25, v29, v17
v_mul_f32 v26, v30, v17
v_mul_f32 v27, v31, v17
v_max3_f32 v242, v24, v25, v26
v_max_f32 v242, v242, v27
v_mov_b32 v243, v242
s_nop 1
v_permlane16_swap_b32 v242, v243
s_nop 0
v_max_f32 v242, v242, v243
v_mov_b32 v243, v242
s_nop 1
v_permlane32_swap_b32 v242, v243
s_nop 0
v_max_f32 v242, v242, v243
s_mov_b64 exec, 0xffff
ds_write_b32 v14, v242 offset:0
s_mov_b64 exec, -1
s_waitcnt lgkmcnt(0)
s_barrier
ds_read_b128 v[192:195], v15 offset:0
ds_read_b128 v[196:199], v16 offset:0
s_waitcnt lgkmcnt(1)
v_max3_f32 v242, v192, v193, v194
v_max3_f32 v242, v242, v195, v18
v_sub_f32 v21, v18, v242
v_sub_f32 v24, v24, v242
v_sub_f32 v25, v25, v242
v_sub_f32 v26, v26, v242
v_sub_f32 v27, v27, v242
v_exp_f32 v21, v21
v_exp_f32 v24, v24
v_exp_f32 v25, v25
v_exp_f32 v26, v26
v_exp_f32 v27, v27
v_mov_b32 v18, v242
v_cvt_pk_bf16_f32 v244, v24, v25
v_cvt_pk_bf16_f32 v245, v26, v27
ds_write_b64 v12, v[244:245] offset:512
v_add_f32 v24, v24, v25
v_add_f32 v26, v26, v27
v_fma_f32 v20, v20, v21, v24
v_add_f32 v20, v20, v26
s_waitcnt lgkmcnt(1)
v_max3_f32 v242, v196, v197, v198
v_max3_f32 v242, v242, v199, v19
v_sub_f32 v21, v19, v242
v_exp_f32 v21, v21
v_mov_b32 v19, v242
v_mul_f32 v96, v96, v21
v_mul_f32 v97, v97, v21
v_mul_f32 v98, v98, v21
v_mul_f32 v99, v99, v21
v_mul_f32 v100, v100, v21
v_mul_f32 v101, v101, v21
v_mul_f32 v102, v102, v21
v_mul_f32 v103, v103, v21
v_mul_f32 v104, v104, v21
v_mul_f32 v105, v105, v21
v_mul_f32 v106, v106, v21
v_mul_f32 v107, v107, v21
v_mul_f32 v108, v108, v21
v_mul_f32 v109, v109, v21
v_mul_f32 v110, v110, v21
v_mul_f32 v111, v111, v21
v_mul_f32 v112, v112, v21
v_mul_f32 v113, v113, v21
v_mul_f32 v114, v114, v21
v_mul_f32 v115, v115, v21
v_mul_f32 v116, v116, v21
v_mul_f32 v117, v117, v21
v_mul_f32 v118, v118, v21
v_mul_f32 v119, v119, v21
v_mul_f32 v120, v120, v21
v_mul_f32 v121, v121, v21
v_mul_f32 v122, v122, v21
v_mul_f32 v123, v123, v21
v_mul_f32 v124, v124, v21
v_mul_f32 v125, v125, v21
v_mul_f32 v126, v126, v21
v_mul_f32 v127, v127, v21
s_cmp_eq_u32 s52, 0
s_cbranch_scc1 L_C_st2
s_waitcnt vmcnt(7)
ds_write_b128 v23, v[224:227] offset:33792
buffer_load_dwordx4 v[224:227], v9, s[40:43], s51 offen offset:0 nt
s_waitcnt vmcnt(7)
ds_write_b128 v23, v[228:231] offset:34848
buffer_load_dwordx4 v[228:231], v9, s[40:43], s51 offen offset:1024 nt
L_C_st2:
s_waitcnt lgkmcnt(0)
s_barrier
ds_read_b128 v[192:195], v13 offset:512
ds_read_b128 v[196:199], v13 offset:544
ds_read_b128 v[200:203], v13 offset:576
ds_read_b128 v[204:207], v13 offset:608
ds_read_b64_tr_b16 v[128:129], v241 offset:0
ds_read_b64_tr_b16 v[130:131], v241 offset:4224
ds_read_b64_tr_b16 v[132:133], v241 offset:64
ds_read_b64_tr_b16 v[134:135], v241 offset:4288
ds_read_b64_tr_b16 v[136:137], v241 offset:16896
ds_read_b64_tr_b16 v[138:139], v241 offset:21120
ds_read_b64_tr_b16 v[140:141], v241 offset:16960
ds_read_b64_tr_b16 v[142:143], v241 offset:21184
ds_read_b64_tr_b16 v[144:145], v241 offset:33792
ds_read_b64_tr_b16 v[146:147], v241 offset:38016
ds_read_b64_tr_b16 v[148:149], v241 offset:33856
ds_read_b64_tr_b16 v[150:151], v241 offset:38080
ds_read_b64_tr_b16 v[152:153], v241 offset:50688
ds_read_b64_tr_b16 v[154:155], v241 offset:54912
ds_read_b64_tr_b16 v[156:157], v241 offset:50752
ds_read_b64_tr_b16 v[158:159], v241 offset:54976
s_waitcnt lgkmcnt(12)
v_mfma_f32_32x32x16_bf16 v[96:111], v[128:131], v[192:195], v[96:111]
v_mfma_f32_32x32x16_bf16 v[112:127], v[132:135], v[192:195], v[112:127]
s_waitcnt lgkmcnt(8)
v_mfma_f32_32x32x16_bf16 v[96:111], v[136:139], v[196:199], v[96:111]
v_mfma_f32_32x32x16_bf16 v[112:127], v[140:143], v[196:199], v[112:127]
s_waitcnt lgkmcnt(4)
v_mfma_f32_32x32x16_bf16 v[96:111], v[144:147], v[200:203], v[96:111]
v_mfma_f32_32x32x16_bf16 v[112:127], v[148:151], v[200:203], v[112:127]
s_waitcnt lgkmcnt(0)
v_mfma_f32_32x32x16_bf16 v[96:111], v[152:155], v[204:207], v[96:111]
v_mfma_f32_32x32x16_bf16 v[112:127], v[156:159], v[204:207], v[112:127]
s_cmp_eq_u32 s52, 0
s_cbranch_scc1 L_C_st3
s_waitcnt vmcnt(7)
ds_write_b128 v23, v[232:235] offset:35904
buffer_load_dwordx4 v[232:235], v9, s[40:43], s51 offen offset:2048 nt
s_waitcnt vmcnt(7)
ds_write_b128 v23, v[236:239] offset:36960
buffer_load_dwordx4 v[236:239], v9, s[40:43], s51 offen offset:3072 nt
L_C_st3:
s_sub_u32 s48, 67584, s48
s_add_u32 s39, s39, 1
s_cmp_lt_u32 s39, 8
s_cbranch_scc1 L_C_loop
v_mov_b32 v243, v20
s_nop 1
v_permlane16_swap_b32 v20, v243
s_nop 0
v_add_f32 v20, v20, v243
v_mov_b32 v243, v20
s_nop 1
v_permlane32_swap_b32 v20, v243
s_nop 0
v_add_f32 v20, v20, v243
s_barrier
s_mov_b64 exec, 0xffff
ds_write_b32 v14, v20 offset:0
s_mov_b64 exec, -1
v_and_b32 v240, 31, v1
v_mul_u32_u24 v240, 2064, v240
v_lshrrev_b32 v241, 5, v1
v_lshl_add_u32 v240, v241, 4, v240
s_lshl_b32 s62, s34, 8
s_add_u32 s62, s62, 72704
v_add_u32 v240, s62, v240
s_nop 5
ds_write_b128 v240, v[96:99] offset:0
ds_write_b128 v240, v[100:103] offset:32
ds_write_b128 v240, v[104:107] offset:64
ds_write_b128 v240, v[108:111] offset:96
ds_write_b128 v240, v[112:115] offset:128
ds_write_b128 v240, v[116:119] offset:160
ds_write_b128 v240, v[120:123] offset:192
ds_write_b128 v240, v[124:127] offset:224
s_waitcnt lgkmcnt(0)
s_barrier
s_mul_i32 s62, s34, 8256
s_add_u32 s62, s62, 72704
v_lshl_add_u32 v240, v1, 5, s62
ds_read_b128 v[128:131], v240 offset:0
ds_read_b128 v[132:135], v240 offset:16
ds_read_b128 v[136:139], v240 offset:2064
ds_read_b128 v[140:143], v240 offset:2080
ds_read_b128 v[144:147], v240 offset:4128
ds_read_b128 v[148:151], v240 offset:4144
ds_read_b128 v[152:155], v240 offset:6192
ds_read_b128 v[156:159], v240 offset:6208
s_lshl_b32 s62, s35, 5
s_lshl_b32 s63, s34, 2
s_add_u32 s62, s62, s63
s_lshl_b32 s62, s62, 4
s_and_b32 s63, s32, 15
s_add_u32 s62, s62, s63
s_lshl_b32 s62, s62, 10
s_add_u32 s62, s62, 0x200000
v_lshl_add_u32 v241, v1, 4, s62
s_waitcnt lgkmcnt(6)
v_cvt_pk_bf16_f32 v160, v128, v129
v_cvt_pk_bf16_f32 v161, v130, v131
v_cvt_pk_bf16_f32 v162, v132, v133
v_cvt_pk_bf16_f32 v163, v134, v135
s_mov_b32 s63, 0
buffer_store_dwordx4 v[160:163], v241, s[44:47], s63 offen sc1
s_waitcnt lgkmcnt(4)
v_cvt_pk_bf16_f32 v164, v136, v137
v_cvt_pk_bf16_f32 v165, v138, v139
v_cvt_pk_bf16_f32 v166, v140, v141
v_cvt_pk_bf16_f32 v167, v142, v143
s_mov_b32 s63, 16384
buffer_store_dwordx4 v[164:167], v241, s[44:47], s63 offen sc1
s_waitcnt lgkmcnt(2)
v_cvt_pk_bf16_f32 v168, v144, v145
v_cvt_pk_bf16_f32 v169, v146, v147
v_cvt_pk_bf16_f32 v170, v148, v149
v_cvt_pk_bf16_f32 v171, v150, v151
s_mov_b32 s63, 32768
buffer_store_dwordx4 v[168:171], v241, s[44:47], s63 offen sc1
s_waitcnt lgkmcnt(0)
v_cvt_pk_bf16_f32 v172, v152, v153
v_cvt_pk_bf16_f32 v173, v154, v155
v_cvt_pk_bf16_f32 v174, v156, v157
v_cvt_pk_bf16_f32 v175, v158, v159
s_mov_b32 s63, 49152
buffer_store_dwordx4 v[172:175], v241, s[44:47], s63 offen sc1
ds_read_b128 v[192:195], v16 offset:0
s_lshl_b32 s63, s32, 9
s_add_u32 s63, s63, 0x10000
v_lshl_add_u32 v240, v1, 4, s63
v_mov_b32 v241, 0xffff0000
s_waitcnt lgkmcnt(0)
v_add_f32 v192, v192, v193
v_add_f32 v194, v194, v195
v_add_f32 v196, v192, v194
v_and_or_b32 v192, v19, v241, s76
v_lshl_or_b32 v193, v19, 16, s77
v_and_or_b32 v194, v196, v241, s78
v_lshl_or_b32 v195, v196, 16, s79
s_waitcnt vmcnt(0)
s_barrier
s_cmp_lg_u32 s34, 0
s_cbranch_scc1 L_C_nostat
s_mov_b32 exec_hi, 0
buffer_store_dwordx4 v[192:195], v240, s[44:47], 0 offen sc1
s_mov_b64 exec, -1
L_C_nostat:
L_C_tail:
v_add_u32 v23, 67584, v22
ds_write_b128 v23, v[208:211] offset:0
ds_write_b128 v23, v[212:215] offset:1056
ds_write_b128 v23, v[216:219] offset:2112
ds_write_b128 v23, v[220:223] offset:3168
ds_write_b128 v23, v[224:227] offset:33792
ds_write_b128 v23, v[228:231] offset:34848
ds_write_b128 v23, v[232:235] offset:35904
ds_write_b128 v23, v[236:239] offset:36960
v_lshrrev_b32 v240, 2, v2
v_lshl_add_u32 v240, v3, 3, v240
v_mul_u32_u24 v240, 1056, v240
v_and_b32 v241, 3, v2
v_lshl_add_u32 v240, v241, 3, v240
s_lshl_b32 s62, s34, 7
s_add_u32 s62, s62, 5120
v_add_u32 v240, s62, v240
s_waitcnt lgkmcnt(0)
s_barrier
ds_read_b64_tr_b16 v[32:33], v240 offset:0
ds_read_b64_tr_b16 v[34:35], v240 offset:4224
ds_read_b64_tr_b16 v[36:37], v240 offset:32
ds_read_b64_tr_b16 v[38:39], v240 offset:4256
ds_read_b64_tr_b16 v[40:41], v240 offset:64
ds_read_b64_tr_b16 v[42:43], v240 offset:4288
ds_read_b64_tr_b16 v[44:45], v240 offset:96
ds_read_b64_tr_b16 v[46:47], v240 offset:4320
s_waitcnt lgkmcnt(0)
v_add_u32 v240, 33792, v240
ds_read_b64_tr_b16 v[48:49], v240 offset:0
ds_read_b64_tr_b16 v[50:51], v240 offset:4224
ds_read_b64_tr_b16 v[52:53], v240 offset:32
ds_read_b64_tr_b16 v[54:55], v240 offset:4256
ds_read_b64_tr_b16 v[56:57], v240 offset:64
ds_read_b64_tr_b16 v[58:59], v240 offset:4288
ds_read_b64_tr_b16 v[60:61], v240 offset:96
ds_read_b64_tr_b16 v[62:63], v240 offset:4320
s_waitcnt lgkmcnt(0)
v_add_u32 v240, 33792, v240
ds_read_b64_tr_b16 v[64:65], v240 offset:0
ds_read_b64_tr_b16 v[66:67], v240 offset:4224
ds_read_b64_tr_b16 v[68:69], v240 offset:32
ds_read_b64_tr_b16 v[70:71], v240 offset:4256
ds_read_b64_tr_b16 v[72:73], v240 offset:64
ds_read_b64_tr_b16 v[74:75], v240 offset:4288
ds_read_b64_tr_b16 v[76:77], v240 offset:96
ds_read_b64_tr_b16 v[78:79], v240 offset:4320
s_waitcnt lgkmcnt(0)
v_add_u32 v240, 33792, v240
ds_read_b64_tr_b16 v[80:81], v240 offset:0
ds_read_b64_tr_b16 v[82:83], v240 offset:4224
ds_read_b64_tr_b16 v[84:85], v240 offset:32
ds_read_b64_tr_b16 v[86:87], v240 offset:4256
ds_read_b64_tr_b16 v[88:89], v240 offset:64
ds_read_b64_tr_b16 v[90:91], v240 offset:4288
ds_read_b64_tr_b16 v[92:93], v240 offset:96
ds_read_b64_tr_b16 v[94:95], v240 offset:4320
s_waitcnt lgkmcnt(0)
v_bfe_u32 v10, v1, 2, 3
v_lshlrev_b32 v10, 11, v10
v_and_b32 v241, 3, v1
v_lshrrev_b32 v11, 5, v1
v_lshl_add_u32 v241, v11, 2, v241
v_lshl_add_u32 v10, v241, 4, v10
s_lshr_b32 s62, s32, 4
s_and_b32 s63, s32, 15
s_lshl_b32 s60, s62, 16
s_lshl_b32 s61, s63, 7
s_add_u32 s60, s60, s61
s_add_u32 s60, s60, 0x40000
v_add_u32 v10, s60, v10
s_lshl_b32 s60, s62, 11
s_lshl_b32 s61, s63, 6
s_add_u32 s60, s60, s61
s_add_u32 s60, s60, 0
v_lshl_add_u32 v11, v241, 3, s60
v_and_b32 v9, 7, v2
v_lshlrev_b32 v9, 10, v9
v_lshrrev_b32 v241, 3, v2
v_lshl_add_u32 v9, v241, 9, v9
v_lshl_add_u32 v9, v3, 4, v9
s_lshl_b32 s62, s32, 13
s_add_u32 s62, s62, 0x60000
s_lshl_b32 s63, s34, 6
s_add_u32 s63, s63, s62
v_add_u32 v9, s63, v9
v_mul_u32_u24 v12, 272, v241
v_lshl_add_u32 v12, v3, 3, v12
s_lshl_b32 s62, s34, 5
v_add_u32 v12, s62, v12
v_and_b32 v241, 1, v2
v_mul_u32_u24 v13, 272, v241
v_lshl_add_u32 v13, v3, 4, v13
v_lshlrev_b32 v14, 16, v241
v_bfe_u32 v241, v2, 1, 2
v_lshl_add_u32 v14, v241, 6, v14
v_lshl_add_u32 v14, v3, 4, v14
s_lshl_b32 s62, s32, 11
s_lshl_b32 s63, s34, 8
s_add_u32 s62, s62, s63
s_add_u32 s62, s62, 0x40000
v_add_u32 v14, s62, v14
s_mov_b32 s82, 0xc0c0c0c
s_mov_b32 s83, 0xc0c0c0c
s_mov_b32 s84, 0x30303030
s_mov_b32 s85, 0x30303030
s_mov_b32 s86, 0xc0c0c0c0
s_mov_b32 s87, 0xc0c0c0c0
v_mov_b32 v15, 0xffffff00
s_mov_b32 s60, 0x0c0c0501
s_mov_b32 s61, 0x05010c0c
s_mov_b32 s53, 65536
s_branch L_C_merge
L_C_poll:
v_mov_b32 v96, 0
v_mov_b32 v97, 0
v_mov_b32 v98, 0x8000
v_mov_b32 v99, 0xff00
s_cmp_lg_u32 s34, 0
s_cbranch_scc1 L_C_gd
s_lshl_b32 s62, s32, 13
s_add_u32 s62, s62, 0x61800
v_mov_b32 v241, s62
s_mov_b64 exec, 1
s_mov_b32 s64, 0
L_pl_Cg:
buffer_load_dword v240, v241, s[44:47], 0 offen sc1
s_add_u32 s64, s64, 1
s_waitcnt vmcnt(0)
v_cmp_gt_i32 vcc, 143, v240
s_nop 0
s_cmp_eq_u64 vcc, 0
s_cbranch_scc1 L_pd_Cg
s_mov_b64 exec, vcc
s_sleep 2
s_cmp_lt_u32 s64, 65536
s_cbranch_scc1 L_pl_Cg
L_pd_Cg:
L_C_gd:
s_barrier
s_mov_b32 exec_lo, 0x3f3f3f3f
s_mov_b32 exec_hi, 0x3f3f3f3f
s_mov_b32 s64, 0
buffer_load_dwordx4 v[208:211], v9, s[44:47], 0 offen sc1
L_ps_Co:
s_waitcnt vmcnt(0)
v_xor_b32 v96, s76, v208
v_xor_b32 v97, s77, v209
v_xor_b32 v98, s78, v210
v_xor_b32 v99, s79, v211
v_or_b32 v240, v96, v97
v_or3_b32 v240, v240, v98, v99
v_and_b32 v240, 0xff, v240
v_cmp_ne_u32 vcc, 0, v240
s_cmp_eq_u64 vcc, 0
s_cbranch_scc1 L_pe_Co
buffer_load_dwordx4 v[208:211], v9, s[44:47], 0 offen sc1
s_add_u32 s64, s64, 1
s_cmp_lt_u32 s64, 65536
s_cbranch_scc1 L_ps_Co
L_pe_Co:
s_mov_b64 exec, -1
L_C_merge:
v_perm_b32 v100, v97, v96, s60
v_perm_b32 v101, v99, v98, s61
v_or_b32 v100, v100, v101
v_and_b32 v96, 0xffff0000, v96
v_and_b32 v97, 0xffff0000, v97
v_max_f32_dpp v101, v100, v100 quad_perm:[1,0,3,2] row_mask:0xf bank_mask:0xf
v_and_b32 v98, 0xffff0000, v98
v_and_b32 v99, 0xffff0000, v99
v_max_f32_dpp v101, v101, v101 quad_perm:[2,3,0,1] row_mask:0xf bank_mask:0xf
s_nop 1
v_max_f32_dpp v101, v101, v101 row_half_mirror row_mask:0xf bank_mask:0xf
v_sub_f32 v100, v100, v101
v_exp_f32 v100, v100
s_nop 0
v_mul_f32 v96, v96, v100
v_mul_f32 v97, v97, v100
v_mul_f32 v98, v98, v100
v_mul_f32 v99, v99, v100
v_add_f32_dpp v100, v100, v100 quad_perm:[1,0,3,2] row_mask:0xf bank_mask:0xf
v_add_f32_dpp v96, v96, v96 quad_perm:[1,0,3,2] row_mask:0xf bank_mask:0xf
v_add_f32_dpp v97, v97, v97 quad_perm:[1,0,3,2] row_mask:0xf bank_mask:0xf
v_add_f32_dpp v98, v98, v98 quad_perm:[1,0,3,2] row_mask:0xf bank_mask:0xf
v_add_f32_dpp v99, v99, v99 quad_perm:[1,0,3,2] row_mask:0xf bank_mask:0xf
v_add_f32_dpp v100, v100, v100 quad_perm:[2,3,0,1] row_mask:0xf bank_mask:0xf
v_add_f32_dpp v96, v96, v96 quad_perm:[2,3,0,1] row_mask:0xf bank_mask:0xf
v_add_f32_dpp v97, v97, v97 quad_perm:[2,3,0,1] row_mask:0xf bank_mask:0xf
v_add_f32_dpp v98, v98, v98 quad_perm:[2,3,0,1] row_mask:0xf bank_mask:0xf
v_add_f32_dpp v99, v99, v99 quad_perm:[2,3,0,1] row_mask:0xf bank_mask:0xf
v_add_f32_dpp v100, v100, v100 row_half_mirror row_mask:0xf bank_mask:0xf
v_add_f32_dpp v96, v96, v96 row_half_mirror row_mask:0xf bank_mask:0xf
v_add_f32_dpp v97, v97, v97 row_half_mirror row_mask:0xf bank_mask:0xf
v_add_f32_dpp v98, v98, v98 row_half_mirror row_mask:0xf bank_mask:0xf
v_add_f32_dpp v99, v99, v99 row_half_mirror row_mask:0xf bank_mask:0xf
v_rcp_f32 v100, v100
s_mov_b32 exec_lo, 0x01010101
s_mov_b32 exec_hi, 0x01010101
v_mul_f32 v96, v96, v100
v_mul_f32 v97, v97, v100
v_mul_f32 v98, v98, v100
v_mul_f32 v99, v99, v100
v_cvt_pk_bf16_f32 v96, v96, v97
v_cvt_pk_bf16_f32 v97, v98, v99
ds_write_b64 v12, v[96:97] offset:0
s_mov_b64 exec, -1
s_waitcnt lgkmcnt(0)
s_barrier
ds_read_b128 v[104:107], v13 offset:0
ds_read_b128 v[108:111], v13 offset:64
ds_read_b128 v[112:115], v13 offset:128
ds_read_b128 v[116:119], v13 offset:192
s_waitcnt lgkmcnt(3)
v_mfma_f32_16x16x32_bf16 v[128:131], v[32:35], v[104:107], 0
v_mfma_f32_16x16x32_bf16 v[132:135], v[36:39], v[104:107], 0
v_mfma_f32_16x16x32_bf16 v[136:139], v[40:43], v[104:107], 0
v_mfma_f32_16x16x32_bf16 v[140:143], v[44:47], v[104:107], 0
s_waitcnt lgkmcnt(2)
v_mfma_f32_16x16x32_bf16 v[128:131], v[48:51], v[108:111], v[128:131]
v_mfma_f32_16x16x32_bf16 v[132:135], v[52:55], v[108:111], v[132:135]
v_mfma_f32_16x16x32_bf16 v[136:139], v[56:59], v[108:111], v[136:139]
v_mfma_f32_16x16x32_bf16 v[140:143], v[60:63], v[108:111], v[140:143]
s_waitcnt lgkmcnt(1)
v_mfma_f32_16x16x32_bf16 v[128:131], v[64:67], v[112:115], v[128:131]
v_mfma_f32_16x16x32_bf16 v[132:135], v[68:71], v[112:115], v[132:135]
v_mfma_f32_16x16x32_bf16 v[136:139], v[72:75], v[112:115], v[136:139]
v_mfma_f32_16x16x32_bf16 v[140:143], v[76:79], v[112:115], v[140:143]
s_waitcnt lgkmcnt(0)
v_mfma_f32_16x16x32_bf16 v[128:131], v[80:83], v[116:119], v[128:131]
v_mfma_f32_16x16x32_bf16 v[132:135], v[84:87], v[116:119], v[132:135]
v_mfma_f32_16x16x32_bf16 v[136:139], v[88:91], v[116:119], v[136:139]
v_mfma_f32_16x16x32_bf16 v[140:143], v[92:95], v[116:119], v[140:143]
s_mov_b32 s64, s53
s_nop 4
v_cndmask_b32 v128, v128, v132, s[82:83]
v_cndmask_b32 v129, v129, v133, s[82:83]
v_cndmask_b32 v130, v130, v134, s[82:83]
v_cndmask_b32 v131, v131, v135, s[82:83]
v_cndmask_b32 v128, v128, v136, s[84:85]
v_cndmask_b32 v129, v129, v137, s[84:85]
v_cndmask_b32 v130, v130, v138, s[84:85]
v_cndmask_b32 v131, v131, v139, s[84:85]
v_cndmask_b32 v128, v128, v140, s[86:87]
v_cndmask_b32 v129, v129, v141, s[86:87]
v_cndmask_b32 v130, v130, v142, s[86:87]
v_cndmask_b32 v131, v131, v143, s[86:87]
v_add_u32 v128, 0x80, v128
v_add_u32 v129, 0x80, v129
v_add_u32 v130, 0x80, v130
v_add_u32 v131, 0x80, v131
v_and_or_b32 v128, v128, v15, s76
v_and_or_b32 v129, v129, v15, s77
v_and_or_b32 v130, v130, v15, s78
v_and_or_b32 v131, v131, v15, s79
s_cmp_lg_u32 s53, 0
s_cbranch_scc1 L_C_nost
s_mov_b32 exec_lo, 0x00ff00ff
s_mov_b32 exec_hi, 0x00ff00ff
buffer_store_dwordx4 v[128:131], v14, s[44:47], 0 offen sc1
s_mov_b64 exec, -1
L_C_nost:
s_cmp_lg_u32 s34, 4
s_cbranch_scc1 L_C_end
s_mov_b32 s66, 0x4000
s_mov_b32 s67, 0x8000
s_mov_b32 s65, 0xc000
buffer_load_dwordx4 v[144:147], v10, s[44:47], 0 offen sc1
buffer_load_dwordx4 v[148:151], v10, s[44:47], s66 offen sc1
buffer_load_dwordx4 v[152:155], v10, s[44:47], s67 offen sc1
buffer_load_dwordx4 v[156:159], v10, s[44:47], s65 offen sc1
s_sleep 6
buffer_load_dwordx4 v[160:163], v10, s[44:47], 0 offen sc1
buffer_load_dwordx4 v[164:167], v10, s[44:47], s66 offen sc1
buffer_load_dwordx4 v[168:171], v10, s[44:47], s67 offen sc1
buffer_load_dwordx4 v[172:175], v10, s[44:47], s65 offen sc1
s_sleep 6
buffer_load_dwordx4 v[176:179], v10, s[44:47], 0 offen sc1
buffer_load_dwordx4 v[180:183], v10, s[44:47], s66 offen sc1
buffer_load_dwordx4 v[184:187], v10, s[44:47], s67 offen sc1
buffer_load_dwordx4 v[188:191], v10, s[44:47], s65 offen sc1
L_ps_Cf:
s_waitcnt vmcnt(11)
v_xor_b32 v192, s76, v144
v_xor_b32 v193, s77, v145
v_xor_b32 v194, s78, v146
v_xor_b32 v195, s79, v147
v_or_b32 v240, v192, v193
v_or3_b32 v240, v240, v194, v195
s_waitcnt vmcnt(10)
v_xor_b32 v196, s76, v148
v_xor_b32 v197, s77, v149
v_xor_b32 v198, s78, v150
v_xor_b32 v199, s79, v151
v_or3_b32 v240, v240, v196, v197
v_or3_b32 v240, v240, v198, v199
v_add_f32 v192, v192, v196
v_add_f32 v193, v193, v197
v_add_f32 v194, v194, v198
v_add_f32 v195, v195, v199
s_waitcnt vmcnt(9)
v_xor_b32 v196, s76, v152
v_xor_b32 v197, s77, v153
v_xor_b32 v198, s78, v154
v_xor_b32 v199, s79, v155
v_or3_b32 v240, v240, v196, v197
v_or3_b32 v240, v240, v198, v199
v_add_f32 v192, v192, v196
v_add_f32 v193, v193, v197
v_add_f32 v194, v194, v198
v_add_f32 v195, v195, v199
s_waitcnt vmcnt(8)
v_xor_b32 v196, s76, v156
v_xor_b32 v197, s77, v157
v_xor_b32 v198, s78, v158
v_xor_b32 v199, s79, v159
v_or3_b32 v240, v240, v196, v197
v_or3_b32 v240, v240, v198, v199
v_add_f32 v192, v192, v196
v_add_f32 v193, v193, v197
v_add_f32 v194, v194, v198
v_add_f32 v195, v195, v199
v_and_b32 v240, 0xff, v240
v_cmp_ne_u32 vcc, 0, v240
v_add_f32_dpp v192, v192, v192 row_ror:8 row_mask:0xf bank_mask:0xf
v_add_f32_dpp v193, v193, v193 row_ror:8 row_mask:0xf bank_mask:0xf
v_add_f32_dpp v194, v194, v194 row_ror:8 row_mask:0xf bank_mask:0xf
v_add_f32_dpp v195, v195, v195 row_ror:8 row_mask:0xf bank_mask:0xf
s_cmp_eq_u64 vcc, 0
s_cbranch_scc1 L_pe_Cf
buffer_load_dwordx4 v[144:147], v10, s[44:47], 0 offen sc1
buffer_load_dwordx4 v[148:151], v10, s[44:47], s66 offen sc1
buffer_load_dwordx4 v[152:155], v10, s[44:47], s67 offen sc1
buffer_load_dwordx4 v[156:159], v10, s[44:47], s65 offen sc1
s_waitcnt vmcnt(11)
v_xor_b32 v192, s76, v160
v_xor_b32 v193, s77, v161
v_xor_b32 v194, s78, v162
v_xor_b32 v195, s79, v163
v_or_b32 v240, v192, v193
v_or3_b32 v240, v240, v194, v195
s_waitcnt vmcnt(10)
v_xor_b32 v196, s76, v164
v_xor_b32 v197, s77, v165
v_xor_b32 v198, s78, v166
v_xor_b32 v199, s79, v167
v_or3_b32 v240, v240, v196, v197
v_or3_b32 v240, v240, v198, v199
v_add_f32 v192, v192, v196
v_add_f32 v193, v193, v197
v_add_f32 v194, v194, v198
v_add_f32 v195, v195, v199
s_waitcnt vmcnt(9)
v_xor_b32 v196, s76, v168
v_xor_b32 v197, s77, v169
v_xor_b32 v198, s78, v170
v_xor_b32 v199, s79, v171
v_or3_b32 v240, v240, v196, v197
v_or3_b32 v240, v240, v198, v199
v_add_f32 v192, v192, v196
v_add_f32 v193, v193, v197
v_add_f32 v194, v194, v198
v_add_f32 v195, v195, v199
s_waitcnt vmcnt(8)
v_xor_b32 v196, s76, v172
v_xor_b32 v197, s77, v173
v_xor_b32 v198, s78, v174
v_xor_b32 v199, s79, v175
v_or3_b32 v240, v240, v196, v197
v_or3_b32 v240, v240, v198, v199
v_add_f32 v192, v192, v196
v_add_f32 v193, v193, v197
v_add_f32 v194, v194, v198
v_add_f32 v195, v195, v199
v_and_b32 v240, 0xff, v240
v_cmp_ne_u32 vcc, 0, v240
v_add_f32_dpp v192, v192, v192 row_ror:8 row_mask:0xf bank_mask:0xf
v_add_f32_dpp v193, v193, v193 row_ror:8 row_mask:0xf bank_mask:0xf
v_add_f32_dpp v194, v194, v194 row_ror:8 row_mask:0xf bank_mask:0xf
v_add_f32_dpp v195, v195, v195 row_ror:8 row_mask:0xf bank_mask:0xf
s_cmp_eq_u64 vcc, 0
s_cbranch_scc1 L_pe_Cf
buffer_load_dwordx4 v[160:163], v10, s[44:47], 0 offen sc1
buffer_load_dwordx4 v[164:167], v10, s[44:47], s66 offen sc1
buffer_load_dwordx4 v[168:171], v10, s[44:47], s67 offen sc1
buffer_load_dwordx4 v[172:175], v10, s[44:47], s65 offen sc1
s_waitcnt vmcnt(11)
v_xor_b32 v192, s76, v176
v_xor_b32 v193, s77, v177
v_xor_b32 v194, s78, v178
v_xor_b32 v195, s79, v179
v_or_b32 v240, v192, v193
v_or3_b32 v240, v240, v194, v195
s_waitcnt vmcnt(10)
v_xor_b32 v196, s76, v180
v_xor_b32 v197, s77, v181
v_xor_b32 v198, s78, v182
v_xor_b32 v199, s79, v183
v_or3_b32 v240, v240, v196, v197
v_or3_b32 v240, v240, v198, v199
v_add_f32 v192, v192, v196
v_add_f32 v193, v193, v197
v_add_f32 v194, v194, v198
v_add_f32 v195, v195, v199
s_waitcnt vmcnt(9)
v_xor_b32 v196, s76, v184
v_xor_b32 v197, s77, v185
v_xor_b32 v198, s78, v186
v_xor_b32 v199, s79, v187
v_or3_b32 v240, v240, v196, v197
v_or3_b32 v240, v240, v198, v199
v_add_f32 v192, v192, v196
v_add_f32 v193, v193, v197
v_add_f32 v194, v194, v198
v_add_f32 v195, v195, v199
s_waitcnt vmcnt(8)
v_xor_b32 v196, s76, v188
v_xor_b32 v197, s77, v189
v_xor_b32 v198, s78, v190
v_xor_b32 v199, s79, v191
v_or3_b32 v240, v240, v196, v197
v_or3_b32 v240, v240, v198, v199
v_add_f32 v192, v192, v196
v_add_f32 v193, v193, v197
v_add_f32 v194, v194, v198
v_add_f32 v195, v195, v199
v_and_b32 v240, 0xff, v240
v_cmp_ne_u32 vcc, 0, v240
v_add_f32_dpp v192, v192, v192 row_ror:8 row_mask:0xf bank_mask:0xf
v_add_f32_dpp v193, v193, v193 row_ror:8 row_mask:0xf bank_mask:0xf
v_add_f32_dpp v194, v194, v194 row_ror:8 row_mask:0xf bank_mask:0xf
v_add_f32_dpp v195, v195, v195 row_ror:8 row_mask:0xf bank_mask:0xf
s_cmp_eq_u64 vcc, 0
s_cbranch_scc1 L_pe_Cf
buffer_load_dwordx4 v[176:179], v10, s[44:47], 0 offen sc1
buffer_load_dwordx4 v[180:183], v10, s[44:47], s66 offen sc1
buffer_load_dwordx4 v[184:187], v10, s[44:47], s67 offen sc1
buffer_load_dwordx4 v[188:191], v10, s[44:47], s65 offen sc1
s_add_u32 s64, s64, 1
s_cmp_lt_u32 s64, 65536
s_cbranch_scc1 L_ps_Cf
L_pe_Cf:
v_add_f32_dpp v192, v192, v192 row_ror:4 row_mask:0xf bank_mask:0xf
v_add_f32_dpp v193, v193, v193 row_ror:4 row_mask:0xf bank_mask:0xf
v_add_f32_dpp v194, v194, v194 row_ror:4 row_mask:0xf bank_mask:0xf
v_add_f32_dpp v195, v195, v195 row_ror:4 row_mask:0xf bank_mask:0xf
v_mov_b32 v240, v192
v_mov_b32 v241, v193
v_mov_b32 v242, v194
v_mov_b32 v243, v195
v_permlane16_swap_b32 v192, v240
v_permlane16_swap_b32 v193, v241
v_permlane16_swap_b32 v194, v242
v_permlane16_swap_b32 v195, v243
v_add_f32 v192, v192, v240
v_add_f32 v193, v193, v241
v_add_f32 v194, v194, v242
v_add_f32 v195, v195, v243
v_cvt_pk_bf16_f32 v192, v192, v193
v_cvt_pk_bf16_f32 v193, v194, v195
s_cmp_lg_u32 s53, 0
s_cbranch_scc1 L_C_end
s_mov_b32 exec_lo, 15
s_mov_b32 exec_hi, 15
global_store_dwordx2 v11, v[192:193], s[26:27]
s_mov_b64 exec, -1
s_cmp_lg_u32 s32, 0
s_cbranch_scc1 L_C_end
v_mov_b32 v240, 0x14000
v_mov_b32 v241, s58
s_mov_b64 exec, 1
buffer_store_dword v241, v240, s[44:47], 0 offen sc1
L_C_end:
s_cmp_lg_u32 s53, 0
s_mov_b32 s53, 0
s_cbranch_scc1 L_C_poll
s_endpgm
L_exit:
s_endpgm
.section .rodata,"a"
.p2align 6
.amdhsa_kernel concat_heads__gqa_block_cached__compressed_kv_cla__decode_kernel
  .amdhsa_next_free_vgpr 256
  .amdhsa_next_free_sgpr 102
  .amdhsa_accum_offset 256
  .amdhsa_group_segment_fixed_size 0
  .amdhsa_kernarg_size 112
  .amdhsa_user_sgpr_count 2
  .amdhsa_user_sgpr_kernarg_segment_ptr 1
  .amdhsa_system_sgpr_workgroup_id_x 1
.end_amdhsa_kernel
```

```asm
; @launch grid=(256,1,1) block=(512,1,1) lds=157696
.amdgcn_target "amdgcn-amd-amdhsa--gfx950"
.text
.globl concat_heads__gqa_block_cached__compressed_kv_cla__decode_kernel
.p2align 8
.type concat_heads__gqa_block_cached__compressed_kv_cla__decode_kernel,@function
concat_heads__gqa_block_cached__compressed_kv_cla__decode_kernel:
s_cmp_ge_u32 s2, 256
s_cbranch_scc1 L_exit
s_load_dwordx16 s[4:19], s[0:1], 0
s_load_dwordx8 s[20:27], s[0:1], 64
s_load_dwordx4 s[28:31], s[0:1], 96
v_lshrrev_b32 v8, 6, v0
s_lshr_b32 s32, s2, 3
s_mov_b32 s60, 0x54321076
s_cmp_ge_u32 s2, 64
s_cselect_b32 s60, 0x54327610, s60
s_cmp_ge_u32 s2, 128
s_cselect_b32 s60, 0x54763210, s60
s_cmp_ge_u32 s2, 192
s_cselect_b32 s60, 0x76543210, s60
s_and_b32 s61, s32, 7
s_lshl_b32 s61, s61, 2
s_lshr_b32 s33, s60, s61
s_and_b32 s33, s33, 7
s_lshl_b32 s61, s33, 2
s_lshr_b32 s61, 0x50764321, s61
s_xor_b32 s61, s61, s2
s_lshr_b32 s60, s2, 6
s_xor_b32 s61, s61, s60
s_and_b32 s61, s61, 7
s_andn2_b32 s32, s32, 7
s_or_b32 s32, s32, s61
s_and_b32 s33, s33, 7
v_readfirstlane_b32 s34, v8
v_and_b32 v1, 63, v0
v_and_b32 v2, 15, v0
v_bfe_u32 v3, v0, 4, 2
v_lshlrev_b32 v8, 4, v1
s_bfe_u32 s55, s32, 0x10004
s_lshl_b32 s55, s55, 26
s_lshl_b32 s35, s33, 3
s_add_u32 s35, s35, s34
s_bfe_u32 s63, s35, 0x10009
s_lshl_b32 s63, s63, 26
s_xor_b32 s37, s63, s55
s_bfe_u32 s63, s35, 0x90000
s_lshl_b32 s63, s63, 12
s_or_b32 s37, s37, s63
s_waitcnt lgkmcnt(0)
s_cmp_eq_u32 s33, 6
s_cbranch_scc1 L_roleW
s_cmp_eq_u32 s33, 7
s_cbranch_scc1 L_roleC
L_roleA:
s_lshl_b32 s62, s32, 21
s_add_u32 s40, s6, s62
s_addc_u32 s41, s7, 0
s_and_b32 s41, s41, 0xffff
s_mov_b32 s42, 0x4200000
s_mov_b32 s43, 0x20000
s_mov_b32 s87, 0x20000
s_andn2_b32 s60, s32, 7
s_and_b32 s61, s2, 7
s_or_b32 s82, s60, s61
s_lshr_b32 s60, s2, 6
s_xor_b32 s82, s82, s60
s_xor_b32 s83, s82, 5
v_lshlrev_b32 v11, 4, v2
s_add_u32 s60, s33, 0x1
s_lshl3_add_u32 s60, s60, s34
s_lshl_b32 s60, s60, 17
s_lshl_b32 s61, s83, 8
s_add_u32 s60, s60, s61
s_mov_b64 s[84:85], s[10:11]
s_mov_b32 s86, 0x400000
s_mov_b32 s88, s60
s_mov_b32 s81, 13
s_add_u32 s60, s33, 0xfffffffe
s_lshl3_add_u32 s60, s60, s34
s_lshl_b32 s60, s60, 17
s_lshl_b32 s61, s82, 8
s_add_u32 s60, s60, s61
s_cmp_ge_u32 s33, 3
s_cselect_b64 s[84:85], s[18:19], s[84:85]
s_cselect_b32 s86, 0x400000, s86
s_cselect_b32 s88, s60, s88
s_cselect_b32 s81, 13, s81
s_and_b32 s85, s85, 0xffff
s_lshl_b32 s89, 4, s81
v_lshl_add_u32 v9, v3, s81, v11
buffer_load_dwordx4 v[20:23], v9, s[84:87], s88 offen
s_add_u32 s88, s88, s89
buffer_load_dwordx4 v[24:27], v9, s[84:87], s88 offen
s_add_u32 s88, s88, s89
buffer_load_dwordx4 v[28:31], v9, s[84:87], s88 offen
s_add_u32 s88, s88, s89
buffer_load_dwordx4 v[32:35], v9, s[84:87], s88 offen
s_add_u32 s60, s33, 0x0
s_lshl3_add_u32 s60, s60, s34
s_lshl_b32 s60, s60, 17
s_lshl_b32 s61, s82, 8
s_add_u32 s60, s60, s61
s_mov_b64 s[84:85], s[20:21]
s_mov_b32 s86, 0x400000
s_mov_b32 s88, s60
s_mov_b32 s81, 13
s_add_u32 s60, s33, 0xfffffffe
s_lshl3_add_u32 s60, s60, s34
s_lshl_b32 s60, s60, 12
s_and_b32 s61, s83, 3
s_lshl_b32 s61, s61, 17
s_xor_b32 s60, s60, s61
s_lshl_b32 s61, s83, 19
s_add_u32 s60, s60, s61
s_cmp_ge_u32 s33, 4
s_cselect_b64 s[84:85], s[16:17], s[84:85]
s_cselect_b32 s86, 0x1000000, s86
s_cselect_b32 s88, s60, s88
s_cselect_b32 s81, 8, s81
s_and_b32 s85, s85, 0xffff
s_lshl_b32 s89, 4, s81
v_lshl_add_u32 v10, v3, s81, v11
s_waitcnt vmcnt(3)
buffer_load_dwordx4 v[20:23], v10, s[84:87], s88 offen
s_add_u32 s88, s88, s89
s_waitcnt vmcnt(3)
buffer_load_dwordx4 v[24:27], v10, s[84:87], s88 offen
s_add_u32 s88, s88, s89
s_waitcnt vmcnt(3)
buffer_load_dwordx4 v[28:31], v10, s[84:87], s88 offen
s_add_u32 s88, s88, s89
s_waitcnt vmcnt(3)
buffer_load_dwordx4 v[32:35], v10, s[84:87], s88 offen
s_add_u32 s60, s33, 0x4
s_lshl3_add_u32 s60, s60, s34
s_lshl_b32 s60, s60, 12
s_and_b32 s61, s83, 3
s_lshl_b32 s61, s61, 17
s_xor_b32 s60, s60, s61
s_lshl_b32 s61, s83, 19
s_add_u32 s60, s60, s61
s_mov_b64 s[84:85], s[16:17]
s_mov_b32 s86, 0x1000000
s_mov_b32 s88, s60
s_mov_b32 s81, 8
s_add_u32 s60, s33, 0xfffffffe
s_lshl3_add_u32 s60, s60, s34
s_lshl_b32 s60, s60, 17
s_lshl_b32 s61, s82, 8
s_add_u32 s60, s60, s61
s_cmp_ge_u32 s33, 2
s_cselect_b64 s[84:85], s[22:23], s[84:85]
s_cselect_b32 s86, 0x400000, s86
s_cselect_b32 s88, s60, s88
s_cselect_b32 s81, 13, s81
s_and_b32 s85, s85, 0xffff
s_lshl_b32 s89, 4, s81
v_lshl_add_u32 v9, v3, s81, v11
s_waitcnt vmcnt(3)
buffer_load_dwordx4 v[20:23], v9, s[84:87], s88 offen
s_add_u32 s88, s88, s89
s_waitcnt vmcnt(3)
buffer_load_dwordx4 v[24:27], v9, s[84:87], s88 offen
s_add_u32 s88, s88, s89
s_waitcnt vmcnt(3)
buffer_load_dwordx4 v[28:31], v9, s[84:87], s88 offen
s_add_u32 s88, s88, s89
s_waitcnt vmcnt(3)
buffer_load_dwordx4 v[32:35], v9, s[84:87], s88 offen
s_add_u32 s60, s33, 0x0
s_lshl3_add_u32 s60, s60, s34
s_lshl_b32 s60, s60, 12
s_lshl_b32 s61, s82, 17
s_add_u32 s60, s60, s61
s_mov_b64 s[84:85], s[24:25]
s_mov_b32 s86, 0x400000
s_mov_b32 s88, s60
s_mov_b32 s81, 8
s_add_u32 s60, s33, 0x2
s_lshl3_add_u32 s60, s60, s34
s_lshl_b32 s60, s60, 12
s_and_b32 s61, s83, 3
s_lshl_b32 s61, s61, 17
s_xor_b32 s60, s60, s61
s_lshl_b32 s61, s83, 19
s_add_u32 s60, s60, s61
s_cmp_ge_u32 s33, 4
s_cselect_b64 s[84:85], s[16:17], s[84:85]
s_cselect_b32 s86, 0x1000000, s86
s_cselect_b32 s88, s60, s88
s_cselect_b32 s81, 8, s81
s_and_b32 s85, s85, 0xffff
s_lshl_b32 s89, 4, s81
v_lshl_add_u32 v10, v3, s81, v11
s_waitcnt vmcnt(3)
buffer_load_dwordx4 v[20:23], v10, s[84:87], s88 offen
s_add_u32 s88, s88, s89
s_waitcnt vmcnt(3)
buffer_load_dwordx4 v[24:27], v10, s[84:87], s88 offen
s_add_u32 s88, s88, s89
s_waitcnt vmcnt(3)
buffer_load_dwordx4 v[28:31], v10, s[84:87], s88 offen
s_add_u32 s88, s88, s89
s_waitcnt vmcnt(3)
buffer_load_dwordx4 v[32:35], v10, s[84:87], s88 offen
s_add_u32 s60, s33, 0x8
s_lshl3_add_u32 s60, s60, s34
s_lshl_b32 s60, s60, 12
s_and_b32 s61, s83, 3
s_lshl_b32 s61, s61, 17
s_xor_b32 s60, s60, s61
s_lshl_b32 s61, s83, 19
s_add_u32 s60, s60, s61
s_mov_b64 s[84:85], s[16:17]
s_mov_b32 s86, 0x1000000
s_mov_b32 s88, s60
s_mov_b32 s81, 8
s_and_b32 s85, s85, 0xffff
s_lshl_b32 s89, 4, s81
v_lshl_add_u32 v9, v3, s81, v11
s_waitcnt vmcnt(3)
buffer_load_dwordx4 v[20:23], v9, s[84:87], s88 offen
s_add_u32 s88, s88, s89
s_waitcnt vmcnt(3)
buffer_load_dwordx4 v[24:27], v9, s[84:87], s88 offen
s_add_u32 s88, s88, s89
s_waitcnt vmcnt(3)
buffer_load_dwordx4 v[28:31], v9, s[84:87], s88 offen
s_add_u32 s88, s88, s89
s_waitcnt vmcnt(3)
buffer_load_dwordx4 v[32:35], v9, s[84:87], s88 offen
s_add_u32 s60, s33, 0xe
s_lshl3_add_u32 s60, s60, s34
s_lshl_b32 s60, s60, 12
s_and_b32 s61, s83, 3
s_lshl_b32 s61, s61, 17
s_xor_b32 s60, s60, s61
s_lshl_b32 s61, s83, 19
s_add_u32 s60, s60, s61
s_mov_b64 s[84:85], s[16:17]
s_mov_b32 s86, 0x1000000
s_mov_b32 s88, s60
s_mov_b32 s81, 8
s_add_u32 s60, s33, 0xfffffffe
s_lshl3_add_u32 s60, s60, s34
s_lshl_b32 s60, s60, 12
s_lshl_b32 s61, s83, 17
s_add_u32 s60, s60, s61
s_cmp_ge_u32 s33, 2
s_cselect_b64 s[84:85], s[12:13], s[84:85]
s_cselect_b32 s86, 0x400000, s86
s_cselect_b32 s88, s60, s88
s_cselect_b32 s81, 8, s81
s_and_b32 s85, s85, 0xffff
s_lshl_b32 s89, 4, s81
v_lshl_add_u32 v10, v3, s81, v11
s_waitcnt vmcnt(3)
buffer_load_dwordx4 v[20:23], v10, s[84:87], s88 offen
s_add_u32 s88, s88, s89
s_waitcnt vmcnt(3)
buffer_load_dwordx4 v[24:27], v10, s[84:87], s88 offen
s_add_u32 s88, s88, s89
s_waitcnt vmcnt(3)
buffer_load_dwordx4 v[28:31], v10, s[84:87], s88 offen
s_add_u32 s88, s88, s89
s_waitcnt vmcnt(3)
buffer_load_dwordx4 v[32:35], v10, s[84:87], s88 offen
s_waitcnt vmcnt(3)
buffer_load_dwordx4 v[52:55], v8, s[40:43], s37 offen offset:0 nt
s_waitcnt vmcnt(3)
buffer_load_dwordx4 v[56:59], v8, s[40:43], s37 offen offset:1024 nt
s_waitcnt vmcnt(3)
buffer_load_dwordx4 v[60:63], v8, s[40:43], s37 offen offset:2048 nt
s_waitcnt vmcnt(3)
buffer_load_dwordx4 v[64:67], v8, s[40:43], s37 offen offset:3072 nt
s_add_u32 s44, s8, s62
s_addc_u32 s45, s9, 0
s_and_b32 s45, s45, 0xffff
s_mov_b32 s46, 0x4200000
s_mov_b32 s47, 0x20000
s_mov_b64 s[70:71], s[40:41]
s_mov_b64 s[72:73], s[44:45]
s_mov_b64 s[44:45], s[40:41]
s_mov_b32 s50, s35
s_mov_b32 s74, 0x00010001
s_mov_b32 s75, 0x00010001
s_mul_i32 s63, s34, 1216
s_add_u32 s63, s63, 8832
v_lshl_add_u32 v165, v3, 4, s63
v_add_u32 v164, 256, v165
v_mov_b32 v166, 0xff7fffff
v_mov_b32 v167, 0xff7fffff
v_and_b32 v132, 1, v0
v_lshlrev_b32 v132, 4, v132
v_mov_b32 v133, 0xffff
v_lshlrev_b32 v132, v132, v133
v_bfe_u32 v133, v0, 1, 2
v_cmp_eq_u32 vcc, 0, v133
s_nop 1
v_cndmask_b32 v4, 0, v132, vcc
v_cmp_eq_u32 vcc, 1, v133
s_nop 1
v_cndmask_b32 v5, 0, v132, vcc
v_cmp_eq_u32 vcc, 2, v133
s_nop 1
v_cndmask_b32 v6, 0, v132, vcc
v_cmp_eq_u32 vcc, 3, v133
s_nop 1
v_cndmask_b32 v7, 0, v132, vcc
s_load_dword s58, s[30:31], 0x14000
s_lshl_b32 s62, s32, 13
s_add_u32 s62, s62, 0x61800
s_mov_b32 s66, 16
s_add_u32 s52, s30, s62
s_addc_u32 s53, s31, 0
v_mov_b32 v140, 0xff7fffff
v_mov_b32 v141, 0
v_mov_b32 v136, 0
v_mov_b32 v137, 0
v_mov_b32 v138, 0
v_mov_b32 v139, 0
v_mov_b32 v144, 0x3e0293ee
s_mov_b32 s56, 0
s_mov_b32 s54, 0
s_lshr_b32 s61, s55, 17
v_lshrrev_b32 v151, 1, v3
v_lshlrev_b32 v151, 9, v151
v_xor_b32 v151, s61, v151
v_lshl_add_u32 v151, v2, 5, v151
v_and_b32 v132, 1, v3
v_lshl_add_u32 v151, v132, 4, v151
s_lshl_b32 s62, s32, 10
s_add_u32 s62, s62, 0x18000
v_add_u32 v151, s62, v151
v_lshlrev_b32 v148, 5, v2
v_lshl_add_u32 v148, v3, 4, v148
s_mul_i32 s62, s34, 1056
v_add_u32 v148, s62, v148
s_lshl_b32 s62, s34, 3
v_mov_b32 v149, s62
v_and_b32 v132, 7, v1
v_lshrrev_b32 v133, 3, v1
v_add_u32 v133, s62, v133
v_lshlrev_b32 v133, 4, v133
v_mul_u32_u24 v150, 1056, v132
v_add_u32 v150, v150, v133
v_xor_b32 v154, s61, v133
s_lshl_b32 s62, s32, 3
s_add_u32 s62, s62, s33
s_lshl_b32 s62, s62, 10
s_add_u32 s62, s62, 0x60000
v_add_u32 v154, s62, v154
s_cmp_eq_u32 s34, 7
s_cselect_b32 s67, 1, 0
s_cbranch_scc1 L_A_dry
L_A_dryd:
s_waitcnt vmcnt(3)
s_add_u32 s35, s35, 48
s_bfe_u32 s63, s35, 0x10009
s_lshl_b32 s63, s63, 26
s_xor_b32 s37, s63, s55
s_bfe_u32 s63, s35, 0x90000
s_lshl_b32 s63, s63, 12
s_or_b32 s37, s37, s63
buffer_load_dwordx4 v[68:71], v8, s[44:47], s37 offen offset:0 nt
s_waitcnt vmcnt(3)
buffer_load_dwordx4 v[72:75], v8, s[44:47], s37 offen offset:1024 nt
s_waitcnt vmcnt(3)
buffer_load_dwordx4 v[76:79], v8, s[44:47], s37 offen offset:2048 nt
s_waitcnt vmcnt(3)
buffer_load_dwordx4 v[80:83], v8, s[44:47], s37 offen offset:3072 nt
s_waitcnt vmcnt(3)
s_add_u32 s35, s35, 48
s_bfe_u32 s63, s35, 0x10009
s_lshl_b32 s63, s63, 26
s_xor_b32 s37, s63, s55
s_bfe_u32 s63, s35, 0x90000
s_lshl_b32 s63, s63, 12
s_or_b32 s37, s37, s63
buffer_load_dwordx4 v[84:87], v8, s[40:43], s37 offen offset:0 nt
s_waitcnt vmcnt(3)
buffer_load_dwordx4 v[88:91], v8, s[40:43], s37 offen offset:1024 nt
s_waitcnt vmcnt(3)
buffer_load_dwordx4 v[92:95], v8, s[40:43], s37 offen offset:2048 nt
s_waitcnt vmcnt(3)
buffer_load_dwordx4 v[96:99], v8, s[40:43], s37 offen offset:3072 nt
s_waitcnt vmcnt(3)
s_add_u32 s35, s35, 48
s_bfe_u32 s63, s35, 0x10009
s_lshl_b32 s63, s63, 26
s_xor_b32 s37, s63, s55
s_bfe_u32 s63, s35, 0x90000
s_lshl_b32 s63, s63, 12
s_or_b32 s37, s37, s63
buffer_load_dwordx4 v[100:103], v8, s[44:47], s37 offen offset:0 nt
s_waitcnt vmcnt(3)
buffer_load_dwordx4 v[104:107], v8, s[44:47], s37 offen offset:1024 nt
s_waitcnt vmcnt(3)
buffer_load_dwordx4 v[108:111], v8, s[44:47], s37 offen offset:2048 nt
s_waitcnt vmcnt(3)
buffer_load_dwordx4 v[112:115], v8, s[44:47], s37 offen offset:3072 nt
global_load_dwordx4 v[120:123], v151, s[30:31] sc1
s_waitcnt vmcnt(4)
s_add_u32 s35, s35, 48
s_bfe_u32 s63, s35, 0x10009
s_lshl_b32 s63, s63, 26
s_xor_b32 s37, s63, s55
s_bfe_u32 s63, s35, 0x90000
s_lshl_b32 s63, s63, 12
s_or_b32 s37, s37, s63
buffer_load_dwordx4 v[20:23], v8, s[40:43], s37 offen offset:0 nt
s_waitcnt vmcnt(4)
buffer_load_dwordx4 v[24:27], v8, s[40:43], s37 offen offset:1024 nt
s_waitcnt vmcnt(4)
buffer_load_dwordx4 v[28:31], v8, s[40:43], s37 offen offset:2048 nt
s_waitcnt vmcnt(4)
buffer_load_dwordx4 v[32:35], v8, s[40:43], s37 offen offset:3072 nt
s_waitcnt lgkmcnt(0)
s_add_u32 s58, s58, 0x9e3779b9
s_bfe_u32 s76, s58, 0x80000
s_bfe_u32 s77, s58, 0x80008
s_bfe_u32 s78, s58, 0x80010
s_bfe_u32 s79, s58, 0x80018
s_mov_b32 s64, 0
s_mov_b32 s60, 0x05040100
s_mov_b32 s61, 0x07060302
s_waitcnt vmcnt(4)
L_A_qchk:
v_perm_b32 v132, v121, v120, s60
v_perm_b32 v133, v123, v122, s60
v_xor_b32 v132, s58, v132
v_xor_b32 v133, s58, v133
v_or_b32 v132, v132, v133
v_cmp_ne_u32 vcc, 0, v132
s_add_u32 s64, s64, 1
s_cmp_eq_u64 vcc, 0
s_cbranch_scc1 L_A_qok
s_cmp_ge_u32 s64, 65536
s_cbranch_scc1 L_A_qok
global_load_dwordx4 v[120:123], v151, s[30:31] sc1
s_waitcnt vmcnt(0)
s_branch L_A_qchk
L_A_qok:
v_perm_b32 v132, v121, v120, s61
v_perm_b32 v133, v123, v122, s61
v_lshlrev_b32 v134, 2, v2
ds_bpermute_b32 v12, v134, v132 offset:0
ds_bpermute_b32 v13, v134, v133 offset:0
ds_bpermute_b32 v14, v134, v132 offset:64
ds_bpermute_b32 v15, v134, v133 offset:64
ds_bpermute_b32 v16, v134, v132 offset:128
ds_bpermute_b32 v17, v134, v133 offset:128
ds_bpermute_b32 v18, v134, v132 offset:192
ds_bpermute_b32 v19, v134, v133 offset:192
s_waitcnt lgkmcnt(0)
v_mov_b32 v160, v12
v_mov_b32 v161, v13
v_mov_b32 v162, v14
v_mov_b32 v163, v15
.p2align 6
L_A_loopa:
s_cmp_lt_u32 s54, 2
s_cbranch_scc1 L_A_back
L_A_backd:
s_add_u32 s49, s35, 48
s_bfe_u32 s63, s49, 0x10009
s_lshl_b32 s63, s63, 26
s_xor_b32 s48, s63, s55
s_bfe_u32 s63, s49, 0x90000
s_lshl_b32 s63, s63, 12
s_or_b32 s48, s48, s63
s_lshr_b32 s62, s35, 9
s_cmp_lg_u32 s62, s56
s_cbranch_scc1 L_A_swa
L_A_swda:
s_waitcnt vmcnt(3)
buffer_load_dwordx4 v[36:39], v8, s[44:47], s48 offen offset:0 nt
v_dot2_f32_bf16 v116, v20, v160, 0
v_dot2_f32_bf16 v116, v21, v161, v116
v_dot2_f32_bf16 v116, v22, v162, v116
v_dot2_f32_bf16 v116, v23, v163, v116
s_nop 2
v_add_f32_dpp v116, v116, v116 row_ror:8 row_mask:0xf bank_mask:0xf
s_nop 1
v_add_f32_dpp v116, v116, v116 row_ror:4 row_mask:0xf bank_mask:0xf
s_nop 1
v_add_f32_dpp v116, v116, v116 row_ror:2 row_mask:0xf bank_mask:0xf
s_nop 1
v_add_f32_dpp v116, v116, v116 row_ror:1 row_mask:0xf bank_mask:0xf
v_mul_f32 v116, v116, v144
s_waitcnt vmcnt(3)
buffer_load_dwordx4 v[40:43], v8, s[44:47], s48 offen offset:1024 nt
v_dot2_f32_bf16 v117, v24, v160, 0
v_dot2_f32_bf16 v117, v25, v161, v117
v_dot2_f32_bf16 v117, v26, v162, v117
v_dot2_f32_bf16 v117, v27, v163, v117
s_nop 2
v_add_f32_dpp v117, v117, v117 row_ror:8 row_mask:0xf bank_mask:0xf
s_nop 1
v_add_f32_dpp v117, v117, v117 row_ror:4 row_mask:0xf bank_mask:0xf
s_nop 1
v_add_f32_dpp v117, v117, v117 row_ror:2 row_mask:0xf bank_mask:0xf
s_nop 1
v_add_f32_dpp v117, v117, v117 row_ror:1 row_mask:0xf bank_mask:0xf
v_mul_f32 v117, v117, v144
s_waitcnt vmcnt(3)
buffer_load_dwordx4 v[44:47], v8, s[44:47], s48 offen offset:2048 nt
v_dot2_f32_bf16 v118, v28, v160, 0
v_dot2_f32_bf16 v118, v29, v161, v118
v_dot2_f32_bf16 v118, v30, v162, v118
v_dot2_f32_bf16 v118, v31, v163, v118
s_nop 2
v_add_f32_dpp v118, v118, v118 row_ror:8 row_mask:0xf bank_mask:0xf
s_nop 1
v_add_f32_dpp v118, v118, v118 row_ror:4 row_mask:0xf bank_mask:0xf
s_nop 1
v_add_f32_dpp v118, v118, v118 row_ror:2 row_mask:0xf bank_mask:0xf
s_nop 1
v_add_f32_dpp v118, v118, v118 row_ror:1 row_mask:0xf bank_mask:0xf
v_mul_f32 v118, v118, v144
s_waitcnt vmcnt(3)
buffer_load_dwordx4 v[48:51], v8, s[44:47], s48 offen offset:3072 nt
v_dot2_f32_bf16 v119, v32, v160, 0
v_dot2_f32_bf16 v119, v33, v161, v119
v_dot2_f32_bf16 v119, v34, v162, v119
v_dot2_f32_bf16 v119, v35, v163, v119
s_nop 2
v_add_f32_dpp v119, v119, v119 row_ror:8 row_mask:0xf bank_mask:0xf
s_nop 1
v_add_f32_dpp v119, v119, v119 row_ror:4 row_mask:0xf bank_mask:0xf
s_nop 1
v_add_f32_dpp v119, v119, v119 row_ror:2 row_mask:0xf bank_mask:0xf
s_nop 1
v_add_f32_dpp v119, v119, v119 row_ror:1 row_mask:0xf bank_mask:0xf
v_mul_f32 v119, v119, v144
s_mov_b64 exec, s[74:75]
ds_write_b128 v164, v[116:119] offset:0
s_mov_b64 exec, -1
v_max3_f32 v167, v167, v116, v117
v_max3_f32 v167, v167, v118, v119
s_lshr_b32 s62, s49, 9
s_cmp_lg_u32 s62, s56
s_cbranch_scc1 L_A_swa2
L_A_swda2:
s_add_u32 s36, s35, 96
s_cmp_eq_u32 s54, 6
s_cselect_b32 s36, s50, s36
s_cselect_b64 s[40:41], s[72:73], s[40:41]
s_bfe_u32 s63, s36, 0x10009
s_lshl_b32 s63, s63, 26
s_xor_b32 s38, s63, s55
s_bfe_u32 s63, s36, 0x90000
s_lshl_b32 s63, s63, 12
s_or_b32 s38, s38, s63
s_waitcnt vmcnt(3)
buffer_load_dwordx4 v[20:23], v8, s[40:43], s38 offen offset:0 nt
v_dot2_f32_bf16 v156, v36, v160, 0
v_dot2_f32_bf16 v156, v37, v161, v156
v_dot2_f32_bf16 v156, v38, v162, v156
v_dot2_f32_bf16 v156, v39, v163, v156
s_nop 2
v_add_f32_dpp v156, v156, v156 row_ror:8 row_mask:0xf bank_mask:0xf
s_nop 1
v_add_f32_dpp v156, v156, v156 row_ror:4 row_mask:0xf bank_mask:0xf
s_nop 1
v_add_f32_dpp v156, v156, v156 row_ror:2 row_mask:0xf bank_mask:0xf
s_nop 1
v_add_f32_dpp v156, v156, v156 row_ror:1 row_mask:0xf bank_mask:0xf
v_mul_f32 v156, v156, v144
s_waitcnt vmcnt(3)
buffer_load_dwordx4 v[24:27], v8, s[40:43], s38 offen offset:1024 nt
v_dot2_f32_bf16 v157, v40, v160, 0
v_dot2_f32_bf16 v157, v41, v161, v157
v_dot2_f32_bf16 v157, v42, v162, v157
v_dot2_f32_bf16 v157, v43, v163, v157
s_nop 2
v_add_f32_dpp v157, v157, v157 row_ror:8 row_mask:0xf bank_mask:0xf
s_nop 1
v_add_f32_dpp v157, v157, v157 row_ror:4 row_mask:0xf bank_mask:0xf
s_nop 1
v_add_f32_dpp v157, v157, v157 row_ror:2 row_mask:0xf bank_mask:0xf
s_nop 1
v_add_f32_dpp v157, v157, v157 row_ror:1 row_mask:0xf bank_mask:0xf
v_mul_f32 v157, v157, v144
s_waitcnt vmcnt(3)
buffer_load_dwordx4 v[28:31], v8, s[40:43], s38 offen offset:2048 nt
v_dot2_f32_bf16 v158, v44, v160, 0
v_dot2_f32_bf16 v158, v45, v161, v158
v_dot2_f32_bf16 v158, v46, v162, v158
v_dot2_f32_bf16 v158, v47, v163, v158
s_nop 2
v_add_f32_dpp v158, v158, v158 row_ror:8 row_mask:0xf bank_mask:0xf
s_nop 1
v_add_f32_dpp v158, v158, v158 row_ror:4 row_mask:0xf bank_mask:0xf
s_nop 1
v_add_f32_dpp v158, v158, v158 row_ror:2 row_mask:0xf bank_mask:0xf
s_nop 1
v_add_f32_dpp v158, v158, v158 row_ror:1 row_mask:0xf bank_mask:0xf
v_mul_f32 v158, v158, v144
s_waitcnt vmcnt(3)
buffer_load_dwordx4 v[32:35], v8, s[40:43], s38 offen offset:3072 nt
v_dot2_f32_bf16 v159, v48, v160, 0
v_dot2_f32_bf16 v159, v49, v161, v159
v_dot2_f32_bf16 v159, v50, v162, v159
v_dot2_f32_bf16 v159, v51, v163, v159
s_nop 2
v_add_f32_dpp v159, v159, v159 row_ror:8 row_mask:0xf bank_mask:0xf
s_nop 1
v_add_f32_dpp v159, v159, v159 row_ror:4 row_mask:0xf bank_mask:0xf
s_nop 1
v_add_f32_dpp v159, v159, v159 row_ror:2 row_mask:0xf bank_mask:0xf
s_nop 1
v_add_f32_dpp v159, v159, v159 row_ror:1 row_mask:0xf bank_mask:0xf
v_mul_f32 v159, v159, v144
s_mov_b64 exec, s[74:75]
ds_write_b128 v164, v[156:159] offset:64
s_mov_b64 exec, -1
v_max3_f32 v167, v167, v156, v157
v_max3_f32 v167, v167, v158, v159
v_add_u32 v164, 128, v164
s_mov_b32 s35, s36
s_mov_b32 s37, s38
s_add_u32 s54, s54, 1
s_cmp_lt_u32 s54, 7
s_cbranch_scc1 L_A_loopa
s_mov_b64 s[44:45], s[72:73]
s_mov_b32 s56, 0
v_mov_b32 v164, v165
ds_read_b128 v[116:119], v165
v_mov_b32 v145, v166
s_nop 1
v_permlane16_swap_b32 v166, v145
s_nop 0
v_max_f32 v166, v166, v145
v_mov_b32 v145, v166
s_nop 1
v_permlane32_swap_b32 v166, v145
s_nop 0
v_max_f32 v166, v166, v145
v_mov_b32 v145, v167
s_nop 1
v_permlane16_swap_b32 v167, v145
s_nop 0
v_max_f32 v167, v167, v145
v_mov_b32 v145, v167
s_nop 1
v_permlane32_swap_b32 v167, v145
s_nop 0
v_max_f32 v167, v167, v145
v_mov_b32 v140, v166
.p2align 6
L_A_loopc:
s_add_u32 s49, s35, 48
s_bfe_u32 s63, s49, 0x10009
s_lshl_b32 s63, s63, 26
s_xor_b32 s48, s63, s55
s_bfe_u32 s63, s49, 0x90000
s_lshl_b32 s63, s63, 12
s_or_b32 s48, s48, s63
s_lshr_b32 s62, s35, 9
s_cmp_lg_u32 s62, s56
s_cbranch_scc1 L_A_swc
L_A_swdc:
s_waitcnt lgkmcnt(0)
s_cmp_lt_u32 s54, s66
s_cbranch_scc1 L_A_nogc
s_mov_b32 s39, 1
s_atomic_add s39, s[52:53], 0 glc
L_A_nogc:
ds_read_b128 v[156:159], v164 offset:64
v_sub_f32 v116, v116, v140
v_sub_f32 v117, v117, v140
v_sub_f32 v118, v118, v140
v_sub_f32 v119, v119, v140
v_exp_f32 v116, v116
v_exp_f32 v117, v117
v_exp_f32 v118, v118
v_exp_f32 v119, v119
v_cvt_pk_bf16_f32 v146, v116, v116
v_add_f32 v141, v141, v116
v_and_b32 v120, v146, v4
v_and_b32 v121, v146, v5
v_and_b32 v122, v146, v6
v_and_b32 v123, v146, v7
s_waitcnt vmcnt(3)
buffer_load_dwordx4 v[36:39], v8, s[44:47], s48 offen offset:0 nt
v_mfma_f32_16x16x32_bf16 v[136:139], v[120:123], v[20:23], v[136:139]
v_cvt_pk_bf16_f32 v147, v117, v117
v_add_f32 v141, v141, v117
v_and_b32 v124, v147, v4
v_and_b32 v125, v147, v5
v_and_b32 v126, v147, v6
v_and_b32 v127, v147, v7
s_waitcnt vmcnt(3)
buffer_load_dwordx4 v[40:43], v8, s[44:47], s48 offen offset:1024 nt
v_mfma_f32_16x16x32_bf16 v[136:139], v[124:127], v[24:27], v[136:139]
v_cvt_pk_bf16_f32 v146, v118, v118
v_add_f32 v141, v141, v118
v_and_b32 v128, v146, v4
v_and_b32 v129, v146, v5
v_and_b32 v130, v146, v6
v_and_b32 v131, v146, v7
s_waitcnt vmcnt(3)
buffer_load_dwordx4 v[44:47], v8, s[44:47], s48 offen offset:2048 nt
v_mfma_f32_16x16x32_bf16 v[136:139], v[128:131], v[28:31], v[136:139]
v_cvt_pk_bf16_f32 v147, v119, v119
v_add_f32 v141, v141, v119
v_and_b32 v132, v147, v4
v_and_b32 v133, v147, v5
v_and_b32 v134, v147, v6
v_and_b32 v135, v147, v7
s_waitcnt vmcnt(3)
buffer_load_dwordx4 v[48:51], v8, s[44:47], s48 offen offset:3072 nt
v_mfma_f32_16x16x32_bf16 v[136:139], v[132:135], v[32:35], v[136:139]
s_lshr_b32 s62, s49, 9
s_cmp_lg_u32 s62, s56
s_cbranch_scc1 L_A_swc2
L_A_swdc2:
s_waitcnt lgkmcnt(0)
ds_read_b128 v[116:119], v164 offset:128
v_sub_f32 v156, v156, v140
v_sub_f32 v157, v157, v140
v_sub_f32 v158, v158, v140
v_sub_f32 v159, v159, v140
v_exp_f32 v156, v156
v_exp_f32 v157, v157
v_exp_f32 v158, v158
v_exp_f32 v159, v159
v_cvt_pk_bf16_f32 v146, v156, v156
v_add_f32 v141, v141, v156
v_and_b32 v120, v146, v4
v_and_b32 v121, v146, v5
v_and_b32 v122, v146, v6
v_and_b32 v123, v146, v7
s_add_u32 s36, s35, 96
s_cmp_eq_u32 s54, 15
s_cselect_b64 s[40:41], s[70:71], s[40:41]
s_cmp_lt_u32 s54, 16
s_cbranch_scc1 L_A_notc
s_waitcnt lgkmcnt(0)
s_add_u32 s39, s39, 1
s_cmp_eq_u32 s39, 39
s_cbranch_scc1 L_A_sigc
s_cmp_eq_u32 s39, 95
s_cbranch_scc1 L_A_sigc
L_A_sigdc:
s_min_u32 s39, s39, 1024
s_add_u32 s36, s39, 912
L_A_notc:
s_bfe_u32 s63, s36, 0x10009
s_lshl_b32 s63, s63, 26
s_xor_b32 s38, s63, s55
s_bfe_u32 s63, s36, 0x90000
s_lshl_b32 s63, s63, 12
s_or_b32 s38, s38, s63
s_cmp_lt_u32 s36, 1024
s_cselect_b32 s42, s42, 0
s_waitcnt vmcnt(3)
buffer_load_dwordx4 v[20:23], v8, s[40:43], s38 offen offset:0 nt
v_mfma_f32_16x16x32_bf16 v[136:139], v[120:123], v[36:39], v[136:139]
v_cvt_pk_bf16_f32 v147, v157, v157
v_add_f32 v141, v141, v157
v_and_b32 v124, v147, v4
v_and_b32 v125, v147, v5
v_and_b32 v126, v147, v6
v_and_b32 v127, v147, v7
s_waitcnt vmcnt(3)
buffer_load_dwordx4 v[24:27], v8, s[40:43], s38 offen offset:1024 nt
v_mfma_f32_16x16x32_bf16 v[136:139], v[124:127], v[40:43], v[136:139]
v_cvt_pk_bf16_f32 v146, v158, v158
v_add_f32 v141, v141, v158
v_and_b32 v128, v146, v4
v_and_b32 v129, v146, v5
v_and_b32 v130, v146, v6
v_and_b32 v131, v146, v7
s_waitcnt vmcnt(3)
buffer_load_dwordx4 v[28:31], v8, s[40:43], s38 offen offset:2048 nt
v_mfma_f32_16x16x32_bf16 v[136:139], v[128:131], v[44:47], v[136:139]
v_cvt_pk_bf16_f32 v147, v159, v159
v_add_f32 v141, v141, v159
v_and_b32 v132, v147, v4
v_and_b32 v133, v147, v5
v_and_b32 v134, v147, v6
v_and_b32 v135, v147, v7
s_waitcnt vmcnt(3)
buffer_load_dwordx4 v[32:35], v8, s[40:43], s38 offen offset:3072 nt
v_mfma_f32_16x16x32_bf16 v[136:139], v[132:135], v[48:51], v[136:139]
v_add_u32 v164, 128, v164
s_mov_b32 s35, s36
s_mov_b32 s37, s38
s_add_u32 s54, s54, 1
s_cmp_ge_u32 s35, 1024
s_cbranch_scc1 L_A_out
s_cmp_lt_u32 s54, 16
s_cbranch_scc1 L_A_loopc
s_waitcnt lgkmcnt(0)
.p2align 6
L_A_loopb:
s_cmp_lt_u32 s54, s66
s_cbranch_scc1 L_A_nogb
s_mov_b32 s39, 1
s_atomic_add s39, s[52:53], 0 glc
L_A_nogb:
s_waitcnt vmcnt(3)
buffer_load_dwordx4 v[36:39], v8, s[44:47], s37 offen offset:0 nt
v_dot2_f32_bf16 v116, v20, v160, 0
v_dot2_f32_bf16 v116, v21, v161, v116
v_dot2_f32_bf16 v116, v22, v162, v116
v_dot2_f32_bf16 v116, v23, v163, v116
s_nop 2
v_add_f32_dpp v116, v116, v116 row_ror:8 row_mask:0xf bank_mask:0xf
s_nop 1
v_add_f32_dpp v116, v116, v116 row_ror:4 row_mask:0xf bank_mask:0xf
s_nop 1
v_add_f32_dpp v116, v116, v116 row_ror:2 row_mask:0xf bank_mask:0xf
s_nop 1
v_add_f32_dpp v116, v116, v116 row_ror:1 row_mask:0xf bank_mask:0xf
v_mul_f32 v116, v116, v144
s_waitcnt vmcnt(3)
buffer_load_dwordx4 v[40:43], v8, s[44:47], s37 offen offset:1024 nt
v_dot2_f32_bf16 v117, v24, v160, 0
v_dot2_f32_bf16 v117, v25, v161, v117
v_dot2_f32_bf16 v117, v26, v162, v117
v_dot2_f32_bf16 v117, v27, v163, v117
s_nop 2
v_add_f32_dpp v117, v117, v117 row_ror:8 row_mask:0xf bank_mask:0xf
s_nop 1
v_add_f32_dpp v117, v117, v117 row_ror:4 row_mask:0xf bank_mask:0xf
s_nop 1
v_add_f32_dpp v117, v117, v117 row_ror:2 row_mask:0xf bank_mask:0xf
s_nop 1
v_add_f32_dpp v117, v117, v117 row_ror:1 row_mask:0xf bank_mask:0xf
v_mul_f32 v117, v117, v144
s_waitcnt vmcnt(3)
buffer_load_dwordx4 v[44:47], v8, s[44:47], s37 offen offset:2048 nt
v_dot2_f32_bf16 v118, v28, v160, 0
v_dot2_f32_bf16 v118, v29, v161, v118
v_dot2_f32_bf16 v118, v30, v162, v118
v_dot2_f32_bf16 v118, v31, v163, v118
s_nop 2
v_add_f32_dpp v118, v118, v118 row_ror:8 row_mask:0xf bank_mask:0xf
s_nop 1
v_add_f32_dpp v118, v118, v118 row_ror:4 row_mask:0xf bank_mask:0xf
s_nop 1
v_add_f32_dpp v118, v118, v118 row_ror:2 row_mask:0xf bank_mask:0xf
s_nop 1
v_add_f32_dpp v118, v118, v118 row_ror:1 row_mask:0xf bank_mask:0xf
v_mul_f32 v118, v118, v144
s_waitcnt vmcnt(3)
buffer_load_dwordx4 v[48:51], v8, s[44:47], s37 offen offset:3072 nt
v_dot2_f32_bf16 v119, v32, v160, 0
v_dot2_f32_bf16 v119, v33, v161, v119
v_dot2_f32_bf16 v119, v34, v162, v119
v_dot2_f32_bf16 v119, v35, v163, v119
s_nop 2
v_add_f32_dpp v119, v119, v119 row_ror:8 row_mask:0xf bank_mask:0xf
s_nop 1
v_add_f32_dpp v119, v119, v119 row_ror:4 row_mask:0xf bank_mask:0xf
s_nop 1
v_add_f32_dpp v119, v119, v119 row_ror:2 row_mask:0xf bank_mask:0xf
s_nop 1
v_add_f32_dpp v119, v119, v119 row_ror:1 row_mask:0xf bank_mask:0xf
v_mul_f32 v119, v119, v144
v_max3_f32 v145, v116, v117, v118
v_max_f32 v145, v145, v119
v_cmp_gt_f32 vcc, v145, v140
s_nop 0
s_cmp_lg_u64 vcc, 0
s_cbranch_scc1 L_A_maxb
L_A_maxdb:
v_sub_f32 v116, v116, v140
v_sub_f32 v117, v117, v140
v_sub_f32 v118, v118, v140
v_sub_f32 v119, v119, v140
v_exp_f32 v116, v116
v_exp_f32 v117, v117
v_exp_f32 v118, v118
v_exp_f32 v119, v119
v_cvt_pk_bf16_f32 v146, v116, v116
v_add_f32 v141, v141, v116
v_and_b32 v120, v146, v4
v_and_b32 v121, v146, v5
v_and_b32 v122, v146, v6
v_and_b32 v123, v146, v7
s_add_u32 s36, s35, 48
s_cmp_lt_u32 s54, 16
s_cbranch_scc1 L_A_notb
s_waitcnt lgkmcnt(0)
s_add_u32 s39, s39, 1
s_cmp_eq_u32 s39, 39
s_cbranch_scc1 L_A_sigb
s_cmp_eq_u32 s39, 95
s_cbranch_scc1 L_A_sigb
L_A_sigdb:
s_min_u32 s39, s39, 1024
s_add_u32 s36, s39, 912
L_A_notb:
s_bfe_u32 s63, s36, 0x10009
s_lshl_b32 s63, s63, 26
s_xor_b32 s38, s63, s55
s_bfe_u32 s63, s36, 0x90000
s_lshl_b32 s63, s63, 12
s_or_b32 s38, s38, s63
s_cmp_lt_u32 s36, 1024
s_cselect_b32 s42, s42, 0
s_waitcnt vmcnt(3)
buffer_load_dwordx4 v[20:23], v8, s[40:43], s38 offen offset:0 nt
v_mfma_f32_16x16x32_bf16 v[136:139], v[120:123], v[36:39], v[136:139]
v_cvt_pk_bf16_f32 v147, v117, v117
v_add_f32 v141, v141, v117
v_and_b32 v124, v147, v4
v_and_b32 v125, v147, v5
v_and_b32 v126, v147, v6
v_and_b32 v127, v147, v7
s_waitcnt vmcnt(3)
buffer_load_dwordx4 v[24:27], v8, s[40:43], s38 offen offset:1024 nt
v_mfma_f32_16x16x32_bf16 v[136:139], v[124:127], v[40:43], v[136:139]
v_cvt_pk_bf16_f32 v146, v118, v118
v_add_f32 v141, v141, v118
v_and_b32 v128, v146, v4
v_and_b32 v129, v146, v5
v_and_b32 v130, v146, v6
v_and_b32 v131, v146, v7
s_waitcnt vmcnt(3)
buffer_load_dwordx4 v[28:31], v8, s[40:43], s38 offen offset:2048 nt
v_mfma_f32_16x16x32_bf16 v[136:139], v[128:131], v[44:47], v[136:139]
v_cvt_pk_bf16_f32 v147, v119, v119
v_add_f32 v141, v141, v119
v_and_b32 v132, v147, v4
v_and_b32 v133, v147, v5
v_and_b32 v134, v147, v6
v_and_b32 v135, v147, v7
s_waitcnt vmcnt(3)
buffer_load_dwordx4 v[32:35], v8, s[40:43], s38 offen offset:3072 nt
v_mfma_f32_16x16x32_bf16 v[136:139], v[132:135], v[48:51], v[136:139]
s_mov_b32 s35, s36
s_mov_b32 s37, s38
s_add_u32 s54, s54, 1
s_cmp_lt_u32 s35, 1024
s_cbranch_scc1 L_A_loopb
L_A_dry:
L_A_out:
v_add_f32_dpp v141, v141, v141 row_bcast:15 row_mask:0xa bank_mask:0xf
s_nop 1
v_add_f32_dpp v141, v141, v141 row_bcast:31 row_mask:0xc bank_mask:0xf
s_mov_b32 exec_lo, 0
s_brev_b32 exec_hi, 1
ds_write_b64 v149, v[140:141] offset:8512
s_mov_b32 exec_lo, -1
s_mov_b32 exec_hi, 0
ds_write_b128 v148, v[136:139] offset:512
s_mov_b64 exec, -1
s_waitcnt lgkmcnt(0)
s_cmp_lg_u32 s67, 0
s_cbranch_scc1 L_A_nobar
s_barrier
L_A_nobar:
ds_read_b128 v[120:123], v150 offset:0
v_and_b32 v132, 7, v1
s_lshr_b32 s62, s34, 2
s_lshl_b32 s62, s62, 6
v_lshl_add_u32 v132, v132, 3, s62
ds_read_b64 v[124:125], v132 offset:8448
s_waitcnt lgkmcnt(0)
v_mov_b32 v126, v124
s_nop 1
v_max_f32_dpp v126, v126, v126 quad_perm:[1,0,3,2] row_mask:0xf bank_mask:0xf
s_nop 1
v_max_f32_dpp v126, v126, v126 quad_perm:[2,3,0,1] row_mask:0xf bank_mask:0xf
s_nop 1
v_max_f32_dpp v126, v126, v126 row_half_mirror row_mask:0xf bank_mask:0xf
v_sub_f32 v124, v124, v126
v_exp_f32 v124, v124
v_mov_b32 v132, s58
v_mul_f32 v127, v125, v124
v_mul_f32 v120, v120, v124
v_mul_f32 v121, v121, v124
v_mul_f32 v122, v122, v124
v_mul_f32 v123, v123, v124
v_add_f32_dpp v127, v127, v127 quad_perm:[1,0,3,2] row_mask:0xf bank_mask:0xf
v_add_f32_dpp v120, v120, v120 quad_perm:[1,0,3,2] row_mask:0xf bank_mask:0xf
v_add_f32_dpp v121, v121, v121 quad_perm:[1,0,3,2] row_mask:0xf bank_mask:0xf
v_add_f32_dpp v122, v122, v122 quad_perm:[1,0,3,2] row_mask:0xf bank_mask:0xf
v_add_f32_dpp v123, v123, v123 quad_perm:[1,0,3,2] row_mask:0xf bank_mask:0xf
v_add_f32_dpp v127, v127, v127 quad_perm:[2,3,0,1] row_mask:0xf bank_mask:0xf
v_add_f32_dpp v120, v120, v120 quad_perm:[2,3,0,1] row_mask:0xf bank_mask:0xf
v_add_f32_dpp v121, v121, v121 quad_perm:[2,3,0,1] row_mask:0xf bank_mask:0xf
v_add_f32_dpp v122, v122, v122 quad_perm:[2,3,0,1] row_mask:0xf bank_mask:0xf
v_add_f32_dpp v123, v123, v123 quad_perm:[2,3,0,1] row_mask:0xf bank_mask:0xf
v_add_f32_dpp v127, v127, v127 row_half_mirror row_mask:0xf bank_mask:0xf
v_add_f32_dpp v120, v120, v120 row_half_mirror row_mask:0xf bank_mask:0xf
v_add_f32_dpp v121, v121, v121 row_half_mirror row_mask:0xf bank_mask:0xf
v_add_f32_dpp v122, v122, v122 row_half_mirror row_mask:0xf bank_mask:0xf
v_add_f32_dpp v123, v123, v123 row_half_mirror row_mask:0xf bank_mask:0xf
v_max_f32 v127, 0x00800000, v127
v_log_f32 v124, v127
v_rcp_f32 v127, v127
s_mov_b32 s62, 0x05010400
s_mov_b32 s63, 0x07030602
v_add_f32 v126, v126, v124
v_mul_f32 v120, v120, v127
v_mul_f32 v121, v121, v127
v_mul_f32 v122, v122, v127
v_mul_f32 v123, v123, v127
v_perm_b32 v124, v126, v132, s62
v_perm_b32 v125, v126, v132, s63
v_cvt_pk_bf16_f32 v120, v120, v121
v_cvt_pk_bf16_f32 v121, v122, v123
s_mov_b32 exec_lo, 0x01010101
s_mov_b32 exec_hi, 0x01010101
v_perm_b32 v128, v120, v124, s60
v_perm_b32 v129, v120, v124, s61
v_perm_b32 v130, v121, v125, s60
v_perm_b32 v131, v121, v125, s61
s_cmp_lg_u32 s67, 0
s_cbranch_scc1 L_A_dryr
global_store_dwordx4 v154, v[128:131], s[30:31] sc1
s_endpgm
L_A_dryr:
s_mov_b64 exec, -1
s_mov_b32 s67, 0
v_mov_b32 v140, 0xff7fffff
v_mov_b32 v141, 0
v_mov_b32 v136, 0
v_mov_b32 v137, 0
v_mov_b32 v138, 0
v_mov_b32 v139, 0
s_branch L_A_dryd
L_A_back:
s_cmp_lg_u32 s54, 0
s_cbranch_scc1 L_A_bk1
v_dot2_f32_bf16 v116, v52, v12, 0
v_dot2_f32_bf16 v116, v53, v13, v116
v_dot2_f32_bf16 v116, v54, v14, v116
v_dot2_f32_bf16 v116, v55, v15, v116
v_dot2_f32_bf16 v117, v56, v12, 0
v_dot2_f32_bf16 v117, v57, v13, v117
v_dot2_f32_bf16 v117, v58, v14, v117
v_dot2_f32_bf16 v117, v59, v15, v117
v_dot2_f32_bf16 v118, v60, v12, 0
v_dot2_f32_bf16 v118, v61, v13, v118
v_dot2_f32_bf16 v118, v62, v14, v118
v_dot2_f32_bf16 v118, v63, v15, v118
v_dot2_f32_bf16 v119, v64, v12, 0
v_dot2_f32_bf16 v119, v65, v13, v119
v_dot2_f32_bf16 v119, v66, v14, v119
v_dot2_f32_bf16 v119, v67, v15, v119
s_nop 1
v_add_f32_dpp v116, v116, v116 row_ror:8 row_mask:0xf bank_mask:0xf
v_add_f32_dpp v117, v117, v117 row_ror:8 row_mask:0xf bank_mask:0xf
v_add_f32_dpp v118, v118, v118 row_ror:8 row_mask:0xf bank_mask:0xf
v_add_f32_dpp v119, v119, v119 row_ror:8 row_mask:0xf bank_mask:0xf
v_add_f32_dpp v116, v116, v116 row_ror:4 row_mask:0xf bank_mask:0xf
v_add_f32_dpp v117, v117, v117 row_ror:4 row_mask:0xf bank_mask:0xf
v_add_f32_dpp v118, v118, v118 row_ror:4 row_mask:0xf bank_mask:0xf
v_add_f32_dpp v119, v119, v119 row_ror:4 row_mask:0xf bank_mask:0xf
v_add_f32_dpp v116, v116, v116 row_ror:2 row_mask:0xf bank_mask:0xf
v_add_f32_dpp v117, v117, v117 row_ror:2 row_mask:0xf bank_mask:0xf
v_add_f32_dpp v118, v118, v118 row_ror:2 row_mask:0xf bank_mask:0xf
v_add_f32_dpp v119, v119, v119 row_ror:2 row_mask:0xf bank_mask:0xf
v_add_f32_dpp v116, v116, v116 row_ror:1 row_mask:0xf bank_mask:0xf
v_add_f32_dpp v117, v117, v117 row_ror:1 row_mask:0xf bank_mask:0xf
v_add_f32_dpp v118, v118, v118 row_ror:1 row_mask:0xf bank_mask:0xf
v_add_f32_dpp v119, v119, v119 row_ror:1 row_mask:0xf bank_mask:0xf
v_mul_f32 v116, v116, v144
v_mul_f32 v117, v117, v144
v_mul_f32 v118, v118, v144
v_mul_f32 v119, v119, v144
s_mov_b64 exec, s[74:75]
ds_write_b128 v165, v[116:119] offset:0
s_mov_b64 exec, -1
v_max3_f32 v166, v166, v116, v117
v_max3_f32 v166, v166, v118, v119
v_dot2_f32_bf16 v156, v68, v12, 0
v_dot2_f32_bf16 v156, v69, v13, v156
v_dot2_f32_bf16 v156, v70, v14, v156
v_dot2_f32_bf16 v156, v71, v15, v156
v_dot2_f32_bf16 v157, v72, v12, 0
v_dot2_f32_bf16 v157, v73, v13, v157
v_dot2_f32_bf16 v157, v74, v14, v157
v_dot2_f32_bf16 v157, v75, v15, v157
v_dot2_f32_bf16 v158, v76, v12, 0
v_dot2_f32_bf16 v158, v77, v13, v158
v_dot2_f32_bf16 v158, v78, v14, v158
v_dot2_f32_bf16 v158, v79, v15, v158
v_dot2_f32_bf16 v159, v80, v12, 0
v_dot2_f32_bf16 v159, v81, v13, v159
v_dot2_f32_bf16 v159, v82, v14, v159
v_dot2_f32_bf16 v159, v83, v15, v159
s_nop 1
v_add_f32_dpp v156, v156, v156 row_ror:8 row_mask:0xf bank_mask:0xf
v_add_f32_dpp v157, v157, v157 row_ror:8 row_mask:0xf bank_mask:0xf
v_add_f32_dpp v158, v158, v158 row_ror:8 row_mask:0xf bank_mask:0xf
v_add_f32_dpp v159, v159, v159 row_ror:8 row_mask:0xf bank_mask:0xf
v_add_f32_dpp v156, v156, v156 row_ror:4 row_mask:0xf bank_mask:0xf
v_add_f32_dpp v157, v157, v157 row_ror:4 row_mask:0xf bank_mask:0xf
v_add_f32_dpp v158, v158, v158 row_ror:4 row_mask:0xf bank_mask:0xf
v_add_f32_dpp v159, v159, v159 row_ror:4 row_mask:0xf bank_mask:0xf
v_add_f32_dpp v156, v156, v156 row_ror:2 row_mask:0xf bank_mask:0xf
v_add_f32_dpp v157, v157, v157 row_ror:2 row_mask:0xf bank_mask:0xf
v_add_f32_dpp v158, v158, v158 row_ror:2 row_mask:0xf bank_mask:0xf
v_add_f32_dpp v159, v159, v159 row_ror:2 row_mask:0xf bank_mask:0xf
v_add_f32_dpp v156, v156, v156 row_ror:1 row_mask:0xf bank_mask:0xf
v_add_f32_dpp v157, v157, v157 row_ror:1 row_mask:0xf bank_mask:0xf
v_add_f32_dpp v158, v158, v158 row_ror:1 row_mask:0xf bank_mask:0xf
v_add_f32_dpp v159, v159, v159 row_ror:1 row_mask:0xf bank_mask:0xf
v_mul_f32 v156, v156, v144
v_mul_f32 v157, v157, v144
v_mul_f32 v158, v158, v144
v_mul_f32 v159, v159, v144
s_mov_b64 exec, s[74:75]
ds_write_b128 v165, v[156:159] offset:64
s_mov_b64 exec, -1
v_max3_f32 v166, v166, v156, v157
v_max3_f32 v166, v166, v158, v159
s_branch L_A_backd
L_A_bk1:
v_dot2_f32_bf16 v116, v84, v12, 0
v_dot2_f32_bf16 v116, v85, v13, v116
v_dot2_f32_bf16 v116, v86, v14, v116
v_dot2_f32_bf16 v116, v87, v15, v116
v_dot2_f32_bf16 v117, v88, v12, 0
v_dot2_f32_bf16 v117, v89, v13, v117
v_dot2_f32_bf16 v117, v90, v14, v117
v_dot2_f32_bf16 v117, v91, v15, v117
v_dot2_f32_bf16 v118, v92, v12, 0
v_dot2_f32_bf16 v118, v93, v13, v118
v_dot2_f32_bf16 v118, v94, v14, v118
v_dot2_f32_bf16 v118, v95, v15, v118
v_dot2_f32_bf16 v119, v96, v12, 0
v_dot2_f32_bf16 v119, v97, v13, v119
v_dot2_f32_bf16 v119, v98, v14, v119
v_dot2_f32_bf16 v119, v99, v15, v119
s_nop 1
v_add_f32_dpp v116, v116, v116 row_ror:8 row_mask:0xf bank_mask:0xf
v_add_f32_dpp v117, v117, v117 row_ror:8 row_mask:0xf bank_mask:0xf
v_add_f32_dpp v118, v118, v118 row_ror:8 row_mask:0xf bank_mask:0xf
v_add_f32_dpp v119, v119, v119 row_ror:8 row_mask:0xf bank_mask:0xf
v_add_f32_dpp v116, v116, v116 row_ror:4 row_mask:0xf bank_mask:0xf
v_add_f32_dpp v117, v117, v117 row_ror:4 row_mask:0xf bank_mask:0xf
v_add_f32_dpp v118, v118, v118 row_ror:4 row_mask:0xf bank_mask:0xf
v_add_f32_dpp v119, v119, v119 row_ror:4 row_mask:0xf bank_mask:0xf
v_add_f32_dpp v116, v116, v116 row_ror:2 row_mask:0xf bank_mask:0xf
v_add_f32_dpp v117, v117, v117 row_ror:2 row_mask:0xf bank_mask:0xf
v_add_f32_dpp v118, v118, v118 row_ror:2 row_mask:0xf bank_mask:0xf
v_add_f32_dpp v119, v119, v119 row_ror:2 row_mask:0xf bank_mask:0xf
v_add_f32_dpp v116, v116, v116 row_ror:1 row_mask:0xf bank_mask:0xf
v_add_f32_dpp v117, v117, v117 row_ror:1 row_mask:0xf bank_mask:0xf
v_add_f32_dpp v118, v118, v118 row_ror:1 row_mask:0xf bank_mask:0xf
v_add_f32_dpp v119, v119, v119 row_ror:1 row_mask:0xf bank_mask:0xf
v_mul_f32 v116, v116, v144
v_mul_f32 v117, v117, v144
v_mul_f32 v118, v118, v144
v_mul_f32 v119, v119, v144
s_mov_b64 exec, s[74:75]
ds_write_b128 v165, v[116:119] offset:128
s_mov_b64 exec, -1
v_max3_f32 v166, v166, v116, v117
v_max3_f32 v166, v166, v118, v119
v_dot2_f32_bf16 v156, v100, v12, 0
v_dot2_f32_bf16 v156, v101, v13, v156
v_dot2_f32_bf16 v156, v102, v14, v156
v_dot2_f32_bf16 v156, v103, v15, v156
v_dot2_f32_bf16 v157, v104, v12, 0
v_dot2_f32_bf16 v157, v105, v13, v157
v_dot2_f32_bf16 v157, v106, v14, v157
v_dot2_f32_bf16 v157, v107, v15, v157
v_dot2_f32_bf16 v158, v108, v12, 0
v_dot2_f32_bf16 v158, v109, v13, v158
v_dot2_f32_bf16 v158, v110, v14, v158
v_dot2_f32_bf16 v158, v111, v15, v158
v_dot2_f32_bf16 v159, v112, v12, 0
v_dot2_f32_bf16 v159, v113, v13, v159
v_dot2_f32_bf16 v159, v114, v14, v159
v_dot2_f32_bf16 v159, v115, v15, v159
s_nop 1
v_add_f32_dpp v156, v156, v156 row_ror:8 row_mask:0xf bank_mask:0xf
v_add_f32_dpp v157, v157, v157 row_ror:8 row_mask:0xf bank_mask:0xf
v_add_f32_dpp v158, v158, v158 row_ror:8 row_mask:0xf bank_mask:0xf
v_add_f32_dpp v159, v159, v159 row_ror:8 row_mask:0xf bank_mask:0xf
v_add_f32_dpp v156, v156, v156 row_ror:4 row_mask:0xf bank_mask:0xf
v_add_f32_dpp v157, v157, v157 row_ror:4 row_mask:0xf bank_mask:0xf
v_add_f32_dpp v158, v158, v158 row_ror:4 row_mask:0xf bank_mask:0xf
v_add_f32_dpp v159, v159, v159 row_ror:4 row_mask:0xf bank_mask:0xf
v_add_f32_dpp v156, v156, v156 row_ror:2 row_mask:0xf bank_mask:0xf
v_add_f32_dpp v157, v157, v157 row_ror:2 row_mask:0xf bank_mask:0xf
v_add_f32_dpp v158, v158, v158 row_ror:2 row_mask:0xf bank_mask:0xf
v_add_f32_dpp v159, v159, v159 row_ror:2 row_mask:0xf bank_mask:0xf
v_add_f32_dpp v156, v156, v156 row_ror:1 row_mask:0xf bank_mask:0xf
v_add_f32_dpp v157, v157, v157 row_ror:1 row_mask:0xf bank_mask:0xf
v_add_f32_dpp v158, v158, v158 row_ror:1 row_mask:0xf bank_mask:0xf
v_add_f32_dpp v159, v159, v159 row_ror:1 row_mask:0xf bank_mask:0xf
v_mul_f32 v156, v156, v144
v_mul_f32 v157, v157, v144
v_mul_f32 v158, v158, v144
v_mul_f32 v159, v159, v144
s_mov_b64 exec, s[74:75]
ds_write_b128 v165, v[156:159] offset:192
s_mov_b64 exec, -1
v_max3_f32 v166, v166, v156, v157
v_max3_f32 v166, v166, v158, v159
s_branch L_A_backd
L_A_swa:
s_mov_b32 s56, 1
v_max_f32 v166, v166, v167
v_mov_b32 v167, 0xff7fffff
v_mov_b32 v160, v16
v_mov_b32 v161, v17
v_mov_b32 v162, v18
v_mov_b32 v163, v19
s_branch L_A_swda
L_A_swa2:
s_mov_b32 s56, 1
v_max_f32 v166, v166, v167
v_mov_b32 v167, 0xff7fffff
v_mov_b32 v160, v16
v_mov_b32 v161, v17
v_mov_b32 v162, v18
v_mov_b32 v163, v19
s_branch L_A_swda2
L_A_swc:
s_mov_b32 s56, 1
s_nop 3
v_add_f32_dpp v141, v141, v141 row_bcast:15 row_mask:0xa bank_mask:0xf
s_nop 1
v_add_f32_dpp v141, v141, v141 row_bcast:31 row_mask:0xc bank_mask:0xf
s_mov_b32 exec_lo, 0
s_brev_b32 exec_hi, 1
ds_write_b64 v149, v[140:141] offset:8448
s_mov_b32 exec_lo, -1
s_mov_b32 exec_hi, 0
ds_write_b128 v148, v[136:139] offset:0
s_mov_b64 exec, -1
s_waitcnt lgkmcnt(0)
v_mov_b32 v140, v167
v_mov_b32 v141, 0
v_mov_b32 v136, 0
v_mov_b32 v137, 0
v_mov_b32 v138, 0
v_mov_b32 v139, 0
s_branch L_A_swdc
L_A_swc2:
s_mov_b32 s56, 1
s_nop 3
v_add_f32_dpp v141, v141, v141 row_bcast:15 row_mask:0xa bank_mask:0xf
s_nop 1
v_add_f32_dpp v141, v141, v141 row_bcast:31 row_mask:0xc bank_mask:0xf
s_mov_b32 exec_lo, 0
s_brev_b32 exec_hi, 1
ds_write_b64 v149, v[140:141] offset:8448
s_mov_b32 exec_lo, -1
s_mov_b32 exec_hi, 0
ds_write_b128 v148, v[136:139] offset:0
s_mov_b64 exec, -1
s_waitcnt lgkmcnt(0)
v_mov_b32 v140, v167
v_mov_b32 v141, 0
v_mov_b32 v136, 0
v_mov_b32 v137, 0
v_mov_b32 v138, 0
v_mov_b32 v139, 0
s_branch L_A_swdc2
L_A_sigc:
s_mov_b32 s65, 1
s_atomic_add s65, s[52:53], 0x400 glc
s_branch L_A_sigdc
L_A_maxb:
v_max_f32_dpp v145, v145, v145 row_bcast:15 row_mask:0xa bank_mask:0xf
s_nop 1
v_max_f32_dpp v145, v145, v145 row_bcast:31 row_mask:0xc bank_mask:0xf
s_nop 0
v_readlane_b32 s62, v145, 63
s_nop 1
v_max_f32 v143, s62, v140
v_sub_f32 v142, v140, v143
v_exp_f32 v142, v142
v_mov_b32 v140, v143
v_mul_f32 v136, v136, v142
v_mul_f32 v137, v137, v142
v_mul_f32 v138, v138, v142
v_mul_f32 v139, v139, v142
v_mul_f32 v141, v141, v142
s_branch L_A_maxdb
L_A_sigb:
s_mov_b32 s65, 1
s_atomic_add s65, s[52:53], 0x400 glc
s_branch L_A_sigdb
L_roleW:
s_lshl_b32 s60, s32, 8
s_sub_u32 s61, 0x400000, s60
s_add_u32 s40, s18, s60
s_addc_u32 s41, s19, 0
s_and_b32 s41, s41, 0xffff
s_mov_b32 s42, s61
s_mov_b32 s43, 0x20000
s_add_u32 s44, s20, s60
s_addc_u32 s45, s21, 0
s_and_b32 s45, s45, 0xffff
s_mov_b32 s46, s61
s_mov_b32 s47, 0x20000
s_mov_b32 s48, s14
s_and_b32 s49, s15, 0xffff
s_mov_b32 s50, 0x800
s_mov_b32 s51, 0x20000
v_lshrrev_b32 v192, 3, v2
v_lshlrev_b32 v192, 10, v192
v_lshl_add_u32 v192, v3, 5, v192
s_lshl_b32 s62, s34, 7
v_add_u32 v192, s62, v192
s_mov_b32 s80, 0
buffer_load_dwordx4 v[12:15], v192, s[48:51], 0 offen
buffer_load_dwordx4 v[16:19], v192, s[48:51], 0 offen offset:16
v_lshlrev_b32 v9, 17, v3
v_lshl_add_u32 v9, v2, 4, v9
s_lshl_b32 s62, s34, 19
v_add_u32 v9, s62, v9
s_xor_b32 s62, s80, 0
buffer_load_dwordx4 v[64:67], v9, s[40:43], s62 offen nt
s_xor_b32 s62, s80, 8192
buffer_load_dwordx4 v[68:71], v9, s[40:43], s62 offen nt
s_xor_b32 s62, s80, 16384
buffer_load_dwordx4 v[72:75], v9, s[40:43], s62 offen nt
s_xor_b32 s62, s80, 24576
buffer_load_dwordx4 v[76:79], v9, s[40:43], s62 offen nt
s_xor_b32 s62, s80, 32768
buffer_load_dwordx4 v[80:83], v9, s[40:43], s62 offen nt
s_xor_b32 s62, s80, 40960
buffer_load_dwordx4 v[84:87], v9, s[40:43], s62 offen nt
s_xor_b32 s62, s80, 49152
buffer_load_dwordx4 v[88:91], v9, s[40:43], s62 offen nt
s_xor_b32 s62, s80, 57344
buffer_load_dwordx4 v[92:95], v9, s[40:43], s62 offen nt
s_xor_b32 s62, s80, 65536
buffer_load_dwordx4 v[96:99], v9, s[40:43], s62 offen nt
s_xor_b32 s62, s80, 73728
buffer_load_dwordx4 v[100:103], v9, s[40:43], s62 offen nt
s_xor_b32 s62, s80, 81920
buffer_load_dwordx4 v[104:107], v9, s[40:43], s62 offen nt
s_xor_b32 s62, s80, 90112
buffer_load_dwordx4 v[108:111], v9, s[40:43], s62 offen nt
s_xor_b32 s62, s80, 98304
buffer_load_dwordx4 v[112:115], v9, s[40:43], s62 offen nt
s_xor_b32 s62, s80, 106496
buffer_load_dwordx4 v[116:119], v9, s[40:43], s62 offen nt
s_xor_b32 s62, s80, 114688
buffer_load_dwordx4 v[120:123], v9, s[40:43], s62 offen nt
s_xor_b32 s62, s80, 122880
buffer_load_dwordx4 v[124:127], v9, s[40:43], s62 offen nt
v_mov_b32 v8, 0
s_mov_b32 s52, s30
s_and_b32 s53, s31, 0xffff
s_mov_b32 s54, 0x1000000
s_mov_b32 s55, 0x20000
s_load_dword s58, s[30:31], 0x14000
v_and_b32 v192, 1, v0
v_lshlrev_b32 v192, 4, v192
v_mov_b32 v193, 0xffff
v_lshlrev_b32 v192, v192, v193
v_bfe_u32 v193, v0, 1, 2
v_cmp_eq_u32 vcc, 0, v193
s_nop 1
v_cndmask_b32 v4, 0, v192, vcc
v_cmp_eq_u32 vcc, 1, v193
s_nop 1
v_cndmask_b32 v5, 0, v192, vcc
v_cmp_eq_u32 vcc, 2, v193
s_nop 1
v_cndmask_b32 v6, 0, v192, vcc
v_cmp_eq_u32 vcc, 3, v193
s_nop 1
v_cndmask_b32 v7, 0, v192, vcc
s_barrier
s_waitcnt vmcnt(16)
s_mov_b32 s60, 0x01000100
v_perm_b32 v192, v12, v12, s60
v_and_b32 v28, v192, v4
v_and_b32 v29, v192, v5
v_and_b32 v30, v192, v6
v_and_b32 v31, v192, v7
s_waitcnt vmcnt(15)
s_nop 0
v_mfma_f32_16x16x32_bf16 v[44:47], v[28:31], v[64:67], 0
s_xor_b32 s62, s80, 0
buffer_load_dwordx4 v[128:131], v9, s[44:47], s62 offen nt
s_mov_b32 s60, 0x03020302
v_perm_b32 v193, v12, v12, s60
v_and_b32 v32, v193, v4
v_and_b32 v33, v193, v5
v_and_b32 v34, v193, v6
v_and_b32 v35, v193, v7
s_waitcnt vmcnt(15)
s_nop 0
v_mfma_f32_16x16x32_bf16 v[44:47], v[32:35], v[68:71], v[44:47]
s_xor_b32 s62, s80, 8192
buffer_load_dwordx4 v[132:135], v9, s[44:47], s62 offen nt
s_mov_b32 s60, 0x01000100
v_perm_b32 v192, v13, v13, s60
v_and_b32 v28, v192, v4
v_and_b32 v29, v192, v5
v_and_b32 v30, v192, v6
v_and_b32 v31, v192, v7
s_waitcnt vmcnt(15)
s_nop 0
v_mfma_f32_16x16x32_bf16 v[44:47], v[28:31], v[72:75], v[44:47]
s_xor_b32 s62, s80, 16384
buffer_load_dwordx4 v[136:139], v9, s[44:47], s62 offen nt
s_mov_b32 s60, 0x03020302
v_perm_b32 v193, v13, v13, s60
v_and_b32 v32, v193, v4
v_and_b32 v33, v193, v5
v_and_b32 v34, v193, v6
v_and_b32 v35, v193, v7
s_waitcnt vmcnt(15)
s_nop 0
v_mfma_f32_16x16x32_bf16 v[44:47], v[32:35], v[76:79], v[44:47]
s_xor_b32 s62, s80, 24576
buffer_load_dwordx4 v[140:143], v9, s[44:47], s62 offen nt
s_mov_b32 s60, 0x01000100
v_perm_b32 v192, v14, v14, s60
v_and_b32 v28, v192, v4
v_and_b32 v29, v192, v5
v_and_b32 v30, v192, v6
v_and_b32 v31, v192, v7
s_waitcnt vmcnt(15)
s_nop 0
v_mfma_f32_16x16x32_bf16 v[44:47], v[28:31], v[80:83], v[44:47]
s_xor_b32 s62, s80, 32768
buffer_load_dwordx4 v[144:147], v9, s[44:47], s62 offen nt
s_mov_b32 s60, 0x03020302
v_perm_b32 v193, v14, v14, s60
v_and_b32 v32, v193, v4
v_and_b32 v33, v193, v5
v_and_b32 v34, v193, v6
v_and_b32 v35, v193, v7
s_waitcnt vmcnt(15)
s_nop 0
v_mfma_f32_16x16x32_bf16 v[44:47], v[32:35], v[84:87], v[44:47]
s_xor_b32 s62, s80, 40960
buffer_load_dwordx4 v[148:151], v9, s[44:47], s62 offen nt
s_mov_b32 s60, 0x01000100
v_perm_b32 v192, v15, v15, s60
v_and_b32 v28, v192, v4
v_and_b32 v29, v192, v5
v_and_b32 v30, v192, v6
v_and_b32 v31, v192, v7
s_waitcnt vmcnt(15)
s_nop 0
v_mfma_f32_16x16x32_bf16 v[44:47], v[28:31], v[88:91], v[44:47]
s_xor_b32 s62, s80, 49152
buffer_load_dwordx4 v[152:155], v9, s[44:47], s62 offen nt
s_mov_b32 s60, 0x03020302
v_perm_b32 v193, v15, v15, s60
v_and_b32 v32, v193, v4
v_and_b32 v33, v193, v5
v_and_b32 v34, v193, v6
v_and_b32 v35, v193, v7
s_waitcnt vmcnt(15)
s_nop 0
v_mfma_f32_16x16x32_bf16 v[44:47], v[32:35], v[92:95], v[44:47]
s_xor_b32 s62, s80, 57344
buffer_load_dwordx4 v[156:159], v9, s[44:47], s62 offen nt
s_mov_b32 s60, 0x01000100
v_perm_b32 v192, v16, v16, s60
v_and_b32 v28, v192, v4
v_and_b32 v29, v192, v5
v_and_b32 v30, v192, v6
v_and_b32 v31, v192, v7
s_waitcnt vmcnt(15)
s_nop 0
v_mfma_f32_16x16x32_bf16 v[44:47], v[28:31], v[96:99], v[44:47]
s_xor_b32 s62, s80, 65536
buffer_load_dwordx4 v[160:163], v9, s[44:47], s62 offen nt
s_mov_b32 s60, 0x03020302
v_perm_b32 v193, v16, v16, s60
v_and_b32 v32, v193, v4
v_and_b32 v33, v193, v5
v_and_b32 v34, v193, v6
v_and_b32 v35, v193, v7
s_waitcnt vmcnt(15)
s_nop 0
v_mfma_f32_16x16x32_bf16 v[44:47], v[32:35], v[100:103], v[44:47]
s_xor_b32 s62, s80, 73728
buffer_load_dwordx4 v[164:167], v9, s[44:47], s62 offen nt
s_mov_b32 s60, 0x01000100
v_perm_b32 v192, v17, v17, s60
v_and_b32 v28, v192, v4
v_and_b32 v29, v192, v5
v_and_b32 v30, v192, v6
v_and_b32 v31, v192, v7
s_waitcnt vmcnt(15)
s_nop 0
v_mfma_f32_16x16x32_bf16 v[44:47], v[28:31], v[104:107], v[44:47]
s_xor_b32 s62, s80, 81920
buffer_load_dwordx4 v[168:171], v9, s[44:47], s62 offen nt
s_mov_b32 s60, 0x03020302
v_perm_b32 v193, v17, v17, s60
v_and_b32 v32, v193, v4
v_and_b32 v33, v193, v5
v_and_b32 v34, v193, v6
v_and_b32 v35, v193, v7
s_waitcnt vmcnt(15)
s_nop 0
v_mfma_f32_16x16x32_bf16 v[44:47], v[32:35], v[108:111], v[44:47]
s_xor_b32 s62, s80, 90112
buffer_load_dwordx4 v[172:175], v9, s[44:47], s62 offen nt
s_mov_b32 s60, 0x01000100
v_perm_b32 v192, v18, v18, s60
v_and_b32 v28, v192, v4
v_and_b32 v29, v192, v5
v_and_b32 v30, v192, v6
v_and_b32 v31, v192, v7
s_waitcnt vmcnt(15)
s_nop 0
v_mfma_f32_16x16x32_bf16 v[44:47], v[28:31], v[112:115], v[44:47]
s_xor_b32 s62, s80, 98304
buffer_load_dwordx4 v[176:179], v9, s[44:47], s62 offen nt
s_mov_b32 s60, 0x03020302
v_perm_b32 v193, v18, v18, s60
v_and_b32 v32, v193, v4
v_and_b32 v33, v193, v5
v_and_b32 v34, v193, v6
v_and_b32 v35, v193, v7
s_waitcnt vmcnt(15)
s_nop 0
v_mfma_f32_16x16x32_bf16 v[44:47], v[32:35], v[116:119], v[44:47]
s_xor_b32 s62, s80, 106496
buffer_load_dwordx4 v[180:183], v9, s[44:47], s62 offen nt
s_mov_b32 s60, 0x01000100
v_perm_b32 v192, v19, v19, s60
v_and_b32 v28, v192, v4
v_and_b32 v29, v192, v5
v_and_b32 v30, v192, v6
v_and_b32 v31, v192, v7
s_waitcnt vmcnt(15)
s_nop 0
v_mfma_f32_16x16x32_bf16 v[44:47], v[28:31], v[120:123], v[44:47]
s_xor_b32 s62, s80, 114688
buffer_load_dwordx4 v[184:187], v9, s[44:47], s62 offen nt
s_mov_b32 s60, 0x03020302
v_perm_b32 v193, v19, v19, s60
v_and_b32 v32, v193, v4
v_and_b32 v33, v193, v5
v_and_b32 v34, v193, v6
v_and_b32 v35, v193, v7
s_waitcnt vmcnt(15)
s_nop 0
v_mfma_f32_16x16x32_bf16 v[44:47], v[32:35], v[124:127], v[44:47]
s_xor_b32 s62, s80, 122880
buffer_load_dwordx4 v[188:191], v9, s[44:47], s62 offen nt
v_lshrrev_b32 v192, 1, v3
v_lshlrev_b32 v192, 9, v192
v_lshl_add_u32 v192, v2, 5, v192
v_and_b32 v193, 1, v3
v_lshl_add_u32 v192, v193, 4, v192
s_lshl_b32 s63, s34, 10
v_add_u32 v192, s63, v192
s_nop 1
s_nop 5
ds_write_b128 v192, v[44:47] offset:0
s_waitcnt lgkmcnt(0)
s_barrier
s_cmp_ge_u32 s34, 4
s_cbranch_scc1 L_W_qskip
v_lshlrev_b32 v194, 2, v0
ds_read_b32 v196, v194 offset:0
ds_read_b32 v197, v194 offset:1024
ds_read_b32 v198, v194 offset:2048
ds_read_b32 v199, v194 offset:3072
ds_read_b32 v200, v194 offset:4096
ds_read_b32 v201, v194 offset:5120
ds_read_b32 v202, v194 offset:6144
ds_read_b32 v203, v194 offset:7168
s_waitcnt lgkmcnt(0)
v_add_f32 v196, v196, v197
v_add_f32 v196, v196, v198
v_add_f32 v196, v196, v199
v_add_f32 v196, v196, v200
v_add_f32 v196, v196, v201
v_add_f32 v196, v196, v202
v_add_f32 v196, v196, v203
v_cvt_pk_bf16_f32 v196, v196, v196
v_lshlrev_b32 v194, 1, v0
ds_write_b16 v194, v196 offset:8192
s_waitcnt lgkmcnt(0)
L_W_qskip:
s_barrier
v_lshlrev_b32 v194, 4, v2
ds_read_b128 v[20:23], v194 offset:8192
ds_read_b128 v[24:27], v194 offset:8448
s_lshl_b32 s60, s32, 8
s_sub_u32 s61, 0x400000, s60
s_add_u32 s40, s22, s60
s_addc_u32 s41, s23, 0
s_and_b32 s41, s41, 0xffff
s_mov_b32 s42, s61
s_mov_b32 s43, 0x20000
s_xor_b32 s62, s80, 0
buffer_load_dwordx4 v[64:67], v9, s[40:43], s62 offen nt
s_xor_b32 s62, s80, 8192
buffer_load_dwordx4 v[68:71], v9, s[40:43], s62 offen nt
s_xor_b32 s62, s80, 16384
buffer_load_dwordx4 v[72:75], v9, s[40:43], s62 offen nt
s_xor_b32 s62, s80, 24576
buffer_load_dwordx4 v[76:79], v9, s[40:43], s62 offen nt
s_xor_b32 s62, s80, 32768
buffer_load_dwordx4 v[80:83], v9, s[40:43], s62 offen nt
s_xor_b32 s62, s80, 40960
buffer_load_dwordx4 v[84:87], v9, s[40:43], s62 offen nt
s_xor_b32 s62, s80, 49152
buffer_load_dwordx4 v[88:91], v9, s[40:43], s62 offen nt
s_xor_b32 s62, s80, 57344
buffer_load_dwordx4 v[92:95], v9, s[40:43], s62 offen nt
s_xor_b32 s62, s80, 65536
buffer_load_dwordx4 v[96:99], v9, s[40:43], s62 offen nt
s_xor_b32 s62, s80, 73728
buffer_load_dwordx4 v[100:103], v9, s[40:43], s62 offen nt
s_xor_b32 s62, s80, 81920
buffer_load_dwordx4 v[104:107], v9, s[40:43], s62 offen nt
s_xor_b32 s62, s80, 90112
buffer_load_dwordx4 v[108:111], v9, s[40:43], s62 offen nt
s_xor_b32 s62, s80, 98304
buffer_load_dwordx4 v[112:115], v9, s[40:43], s62 offen nt
s_xor_b32 s62, s80, 106496
buffer_load_dwordx4 v[116:119], v9, s[40:43], s62 offen nt
s_xor_b32 s62, s80, 114688
buffer_load_dwordx4 v[120:123], v9, s[40:43], s62 offen nt
s_xor_b32 s62, s80, 122880
buffer_load_dwordx4 v[124:127], v9, s[40:43], s62 offen nt
s_lshl_b32 s60, s32, 17
s_mov_b32 s61, 0x20000
s_add_u32 s44, s24, s60
s_addc_u32 s45, s25, 0
s_and_b32 s45, s45, 0xffff
s_mov_b32 s46, s61
s_mov_b32 s47, 0x20000
v_lshlrev_b32 v10, 12, v3
v_lshl_add_u32 v10, v2, 4, v10
s_lshl_b32 s62, s34, 14
v_add_u32 v10, s62, v10
v_mov_b32 v200, 0
v_mov_b32 v201, 0
s_lshr_b32 s62, s80, 13
v_xor_b32 v202, s62, v2
s_waitcnt lgkmcnt(0)
s_add_u32 s58, s58, 0x9e3779b9
s_bfe_u32 s76, s58, 0x80000
s_bfe_u32 s77, s58, 0x80008
s_bfe_u32 s78, s58, 0x80010
s_bfe_u32 s79, s58, 0x80018
s_waitcnt vmcnt(30)
v_dot2_f32_bf16 v60, v128, v20, 0
v_dot2_f32_bf16 v61, v128, v24, 0
v_dot2_f32_bf16 v62, v132, v20, 0
v_dot2_f32_bf16 v63, v132, v24, 0
v_dot2_f32_bf16 v60, v129, v21, v60
v_dot2_f32_bf16 v61, v129, v25, v61
v_dot2_f32_bf16 v62, v133, v21, v62
v_dot2_f32_bf16 v63, v133, v25, v63
v_dot2_f32_bf16 v60, v130, v22, v60
v_dot2_f32_bf16 v61, v130, v26, v61
v_dot2_f32_bf16 v62, v134, v22, v62
v_dot2_f32_bf16 v63, v134, v26, v63
v_dot2_f32_bf16 v60, v131, v23, v60
v_dot2_f32_bf16 v61, v131, v27, v61
v_dot2_f32_bf16 v62, v135, v23, v62
v_dot2_f32_bf16 v63, v135, v27, v63
buffer_load_dwordx4 v[128:131], v10, s[44:47], 0 offen offset:0 nt
buffer_load_dwordx4 v[132:135], v10, s[44:47], 0 offen offset:256 nt
v_add_f32_dpp v60, v60, v60 row_ror:8 row_mask:0xf bank_mask:0xf
v_add_f32_dpp v61, v61, v61 row_ror:8 row_mask:0xf bank_mask:0xf
v_add_f32_dpp v62, v62, v62 row_ror:8 row_mask:0xf bank_mask:0xf
v_add_f32_dpp v63, v63, v63 row_ror:8 row_mask:0xf bank_mask:0xf
v_add_f32_dpp v60, v60, v60 row_ror:4 row_mask:0xf bank_mask:0xf
v_add_f32_dpp v61, v61, v61 row_ror:4 row_mask:0xf bank_mask:0xf
v_add_f32_dpp v62, v62, v62 row_ror:4 row_mask:0xf bank_mask:0xf
v_add_f32_dpp v63, v63, v63 row_ror:4 row_mask:0xf bank_mask:0xf
v_add_f32_dpp v60, v60, v60 row_ror:2 row_mask:0xf bank_mask:0xf
v_add_f32_dpp v61, v61, v61 row_ror:2 row_mask:0xf bank_mask:0xf
v_add_f32_dpp v62, v62, v62 row_ror:2 row_mask:0xf bank_mask:0xf
v_add_f32_dpp v63, v63, v63 row_ror:2 row_mask:0xf bank_mask:0xf
v_add_f32_dpp v60, v60, v60 row_ror:1 row_mask:0xf bank_mask:0xf
v_add_f32_dpp v61, v61, v61 row_ror:1 row_mask:0xf bank_mask:0xf
v_add_f32_dpp v62, v62, v62 row_ror:1 row_mask:0xf bank_mask:0xf
v_add_f32_dpp v63, v63, v63 row_ror:1 row_mask:0xf bank_mask:0xf
v_cmp_eq_u32 vcc, 0, v202
s_nop 1
v_cndmask_b32 v200, v200, v60, vcc
v_cndmask_b32 v201, v201, v61, vcc
v_cmp_eq_u32 vcc, 1, v202
s_nop 1
v_cndmask_b32 v200, v200, v62, vcc
v_cndmask_b32 v201, v201, v63, vcc
s_waitcnt vmcnt(30)
v_dot2_f32_bf16 v60, v136, v20, 0
v_dot2_f32_bf16 v61, v136, v24, 0
v_dot2_f32_bf16 v62, v140, v20, 0
v_dot2_f32_bf16 v63, v140, v24, 0
v_dot2_f32_bf16 v60, v137, v21, v60
v_dot2_f32_bf16 v61, v137, v25, v61
v_dot2_f32_bf16 v62, v141, v21, v62
v_dot2_f32_bf16 v63, v141, v25, v63
v_dot2_f32_bf16 v60, v138, v22, v60
v_dot2_f32_bf16 v61, v138, v26, v61
v_dot2_f32_bf16 v62, v142, v22, v62
v_dot2_f32_bf16 v63, v142, v26, v63
v_dot2_f32_bf16 v60, v139, v23, v60
v_dot2_f32_bf16 v61, v139, v27, v61
v_dot2_f32_bf16 v62, v143, v23, v62
v_dot2_f32_bf16 v63, v143, v27, v63
buffer_load_dwordx4 v[136:139], v10, s[44:47], 0 offen offset:512 nt
buffer_load_dwordx4 v[140:143], v10, s[44:47], 0 offen offset:768 nt
v_add_f32_dpp v60, v60, v60 row_ror:8 row_mask:0xf bank_mask:0xf
v_add_f32_dpp v61, v61, v61 row_ror:8 row_mask:0xf bank_mask:0xf
v_add_f32_dpp v62, v62, v62 row_ror:8 row_mask:0xf bank_mask:0xf
v_add_f32_dpp v63, v63, v63 row_ror:8 row_mask:0xf bank_mask:0xf
v_add_f32_dpp v60, v60, v60 row_ror:4 row_mask:0xf bank_mask:0xf
v_add_f32_dpp v61, v61, v61 row_ror:4 row_mask:0xf bank_mask:0xf
v_add_f32_dpp v62, v62, v62 row_ror:4 row_mask:0xf bank_mask:0xf
v_add_f32_dpp v63, v63, v63 row_ror:4 row_mask:0xf bank_mask:0xf
v_add_f32_dpp v60, v60, v60 row_ror:2 row_mask:0xf bank_mask:0xf
v_add_f32_dpp v61, v61, v61 row_ror:2 row_mask:0xf bank_mask:0xf
v_add_f32_dpp v62, v62, v62 row_ror:2 row_mask:0xf bank_mask:0xf
v_add_f32_dpp v63, v63, v63 row_ror:2 row_mask:0xf bank_mask:0xf
v_add_f32_dpp v60, v60, v60 row_ror:1 row_mask:0xf bank_mask:0xf
v_add_f32_dpp v61, v61, v61 row_ror:1 row_mask:0xf bank_mask:0xf
v_add_f32_dpp v62, v62, v62 row_ror:1 row_mask:0xf bank_mask:0xf
v_add_f32_dpp v63, v63, v63 row_ror:1 row_mask:0xf bank_mask:0xf
v_cmp_eq_u32 vcc, 2, v202
s_nop 1
v_cndmask_b32 v200, v200, v60, vcc
v_cndmask_b32 v201, v201, v61, vcc
v_cmp_eq_u32 vcc, 3, v202
s_nop 1
v_cndmask_b32 v200, v200, v62, vcc
v_cndmask_b32 v201, v201, v63, vcc
s_waitcnt vmcnt(30)
v_dot2_f32_bf16 v60, v144, v20, 0
v_dot2_f32_bf16 v61, v144, v24, 0
v_dot2_f32_bf16 v62, v148, v20, 0
v_dot2_f32_bf16 v63, v148, v24, 0
v_dot2_f32_bf16 v60, v145, v21, v60
v_dot2_f32_bf16 v61, v145, v25, v61
v_dot2_f32_bf16 v62, v149, v21, v62
v_dot2_f32_bf16 v63, v149, v25, v63
v_dot2_f32_bf16 v60, v146, v22, v60
v_dot2_f32_bf16 v61, v146, v26, v61
v_dot2_f32_bf16 v62, v150, v22, v62
v_dot2_f32_bf16 v63, v150, v26, v63
v_dot2_f32_bf16 v60, v147, v23, v60
v_dot2_f32_bf16 v61, v147, v27, v61
v_dot2_f32_bf16 v62, v151, v23, v62
v_dot2_f32_bf16 v63, v151, v27, v63
buffer_load_dwordx4 v[144:147], v10, s[44:47], 0 offen offset:1024 nt
buffer_load_dwordx4 v[148:151], v10, s[44:47], 0 offen offset:1280 nt
v_add_f32_dpp v60, v60, v60 row_ror:8 row_mask:0xf bank_mask:0xf
v_add_f32_dpp v61, v61, v61 row_ror:8 row_mask:0xf bank_mask:0xf
v_add_f32_dpp v62, v62, v62 row_ror:8 row_mask:0xf bank_mask:0xf
v_add_f32_dpp v63, v63, v63 row_ror:8 row_mask:0xf bank_mask:0xf
v_add_f32_dpp v60, v60, v60 row_ror:4 row_mask:0xf bank_mask:0xf
v_add_f32_dpp v61, v61, v61 row_ror:4 row_mask:0xf bank_mask:0xf
v_add_f32_dpp v62, v62, v62 row_ror:4 row_mask:0xf bank_mask:0xf
v_add_f32_dpp v63, v63, v63 row_ror:4 row_mask:0xf bank_mask:0xf
v_add_f32_dpp v60, v60, v60 row_ror:2 row_mask:0xf bank_mask:0xf
v_add_f32_dpp v61, v61, v61 row_ror:2 row_mask:0xf bank_mask:0xf
v_add_f32_dpp v62, v62, v62 row_ror:2 row_mask:0xf bank_mask:0xf
v_add_f32_dpp v63, v63, v63 row_ror:2 row_mask:0xf bank_mask:0xf
v_add_f32_dpp v60, v60, v60 row_ror:1 row_mask:0xf bank_mask:0xf
v_add_f32_dpp v61, v61, v61 row_ror:1 row_mask:0xf bank_mask:0xf
v_add_f32_dpp v62, v62, v62 row_ror:1 row_mask:0xf bank_mask:0xf
v_add_f32_dpp v63, v63, v63 row_ror:1 row_mask:0xf bank_mask:0xf
v_cmp_eq_u32 vcc, 4, v202
s_nop 1
v_cndmask_b32 v200, v200, v60, vcc
v_cndmask_b32 v201, v201, v61, vcc
v_cmp_eq_u32 vcc, 5, v202
s_nop 1
v_cndmask_b32 v200, v200, v62, vcc
v_cndmask_b32 v201, v201, v63, vcc
s_waitcnt vmcnt(30)
v_dot2_f32_bf16 v60, v152, v20, 0
v_dot2_f32_bf16 v61, v152, v24, 0
v_dot2_f32_bf16 v62, v156, v20, 0
v_dot2_f32_bf16 v63, v156, v24, 0
v_dot2_f32_bf16 v60, v153, v21, v60
v_dot2_f32_bf16 v61, v153, v25, v61
v_dot2_f32_bf16 v62, v157, v21, v62
v_dot2_f32_bf16 v63, v157, v25, v63
v_dot2_f32_bf16 v60, v154, v22, v60
v_dot2_f32_bf16 v61, v154, v26, v61
v_dot2_f32_bf16 v62, v158, v22, v62
v_dot2_f32_bf16 v63, v158, v26, v63
v_dot2_f32_bf16 v60, v155, v23, v60
v_dot2_f32_bf16 v61, v155, v27, v61
v_dot2_f32_bf16 v62, v159, v23, v62
v_dot2_f32_bf16 v63, v159, v27, v63
buffer_load_dwordx4 v[152:155], v10, s[44:47], 0 offen offset:1536 nt
buffer_load_dwordx4 v[156:159], v10, s[44:47], 0 offen offset:1792 nt
v_add_f32_dpp v60, v60, v60 row_ror:8 row_mask:0xf bank_mask:0xf
v_add_f32_dpp v61, v61, v61 row_ror:8 row_mask:0xf bank_mask:0xf
v_add_f32_dpp v62, v62, v62 row_ror:8 row_mask:0xf bank_mask:0xf
v_add_f32_dpp v63, v63, v63 row_ror:8 row_mask:0xf bank_mask:0xf
v_add_f32_dpp v60, v60, v60 row_ror:4 row_mask:0xf bank_mask:0xf
v_add_f32_dpp v61, v61, v61 row_ror:4 row_mask:0xf bank_mask:0xf
v_add_f32_dpp v62, v62, v62 row_ror:4 row_mask:0xf bank_mask:0xf
v_add_f32_dpp v63, v63, v63 row_ror:4 row_mask:0xf bank_mask:0xf
v_add_f32_dpp v60, v60, v60 row_ror:2 row_mask:0xf bank_mask:0xf
v_add_f32_dpp v61, v61, v61 row_ror:2 row_mask:0xf bank_mask:0xf
v_add_f32_dpp v62, v62, v62 row_ror:2 row_mask:0xf bank_mask:0xf
v_add_f32_dpp v63, v63, v63 row_ror:2 row_mask:0xf bank_mask:0xf
v_add_f32_dpp v60, v60, v60 row_ror:1 row_mask:0xf bank_mask:0xf
v_add_f32_dpp v61, v61, v61 row_ror:1 row_mask:0xf bank_mask:0xf
v_add_f32_dpp v62, v62, v62 row_ror:1 row_mask:0xf bank_mask:0xf
v_add_f32_dpp v63, v63, v63 row_ror:1 row_mask:0xf bank_mask:0xf
v_cmp_eq_u32 vcc, 6, v202
s_nop 1
v_cndmask_b32 v200, v200, v60, vcc
v_cndmask_b32 v201, v201, v61, vcc
v_cmp_eq_u32 vcc, 7, v202
s_nop 1
v_cndmask_b32 v200, v200, v62, vcc
v_cndmask_b32 v201, v201, v63, vcc
s_waitcnt vmcnt(30)
v_dot2_f32_bf16 v60, v160, v20, 0
v_dot2_f32_bf16 v61, v160, v24, 0
v_dot2_f32_bf16 v62, v164, v20, 0
v_dot2_f32_bf16 v63, v164, v24, 0
v_dot2_f32_bf16 v60, v161, v21, v60
v_dot2_f32_bf16 v61, v161, v25, v61
v_dot2_f32_bf16 v62, v165, v21, v62
v_dot2_f32_bf16 v63, v165, v25, v63
v_dot2_f32_bf16 v60, v162, v22, v60
v_dot2_f32_bf16 v61, v162, v26, v61
v_dot2_f32_bf16 v62, v166, v22, v62
v_dot2_f32_bf16 v63, v166, v26, v63
v_dot2_f32_bf16 v60, v163, v23, v60
v_dot2_f32_bf16 v61, v163, v27, v61
v_dot2_f32_bf16 v62, v167, v23, v62
v_dot2_f32_bf16 v63, v167, v27, v63
buffer_load_dwordx4 v[160:163], v10, s[44:47], 0 offen offset:2048 nt
buffer_load_dwordx4 v[164:167], v10, s[44:47], 0 offen offset:2304 nt
v_add_f32_dpp v60, v60, v60 row_ror:8 row_mask:0xf bank_mask:0xf
v_add_f32_dpp v61, v61, v61 row_ror:8 row_mask:0xf bank_mask:0xf
v_add_f32_dpp v62, v62, v62 row_ror:8 row_mask:0xf bank_mask:0xf
v_add_f32_dpp v63, v63, v63 row_ror:8 row_mask:0xf bank_mask:0xf
v_add_f32_dpp v60, v60, v60 row_ror:4 row_mask:0xf bank_mask:0xf
v_add_f32_dpp v61, v61, v61 row_ror:4 row_mask:0xf bank_mask:0xf
v_add_f32_dpp v62, v62, v62 row_ror:4 row_mask:0xf bank_mask:0xf
v_add_f32_dpp v63, v63, v63 row_ror:4 row_mask:0xf bank_mask:0xf
v_add_f32_dpp v60, v60, v60 row_ror:2 row_mask:0xf bank_mask:0xf
v_add_f32_dpp v61, v61, v61 row_ror:2 row_mask:0xf bank_mask:0xf
v_add_f32_dpp v62, v62, v62 row_ror:2 row_mask:0xf bank_mask:0xf
v_add_f32_dpp v63, v63, v63 row_ror:2 row_mask:0xf bank_mask:0xf
v_add_f32_dpp v60, v60, v60 row_ror:1 row_mask:0xf bank_mask:0xf
v_add_f32_dpp v61, v61, v61 row_ror:1 row_mask:0xf bank_mask:0xf
v_add_f32_dpp v62, v62, v62 row_ror:1 row_mask:0xf bank_mask:0xf
v_add_f32_dpp v63, v63, v63 row_ror:1 row_mask:0xf bank_mask:0xf
v_cmp_eq_u32 vcc, 8, v202
s_nop 1
v_cndmask_b32 v200, v200, v60, vcc
v_cndmask_b32 v201, v201, v61, vcc
v_cmp_eq_u32 vcc, 9, v202
s_nop 1
v_cndmask_b32 v200, v200, v62, vcc
v_cndmask_b32 v201, v201, v63, vcc
s_waitcnt vmcnt(30)
v_dot2_f32_bf16 v60, v168, v20, 0
v_dot2_f32_bf16 v61, v168, v24, 0
v_dot2_f32_bf16 v62, v172, v20, 0
v_dot2_f32_bf16 v63, v172, v24, 0
v_dot2_f32_bf16 v60, v169, v21, v60
v_dot2_f32_bf16 v61, v169, v25, v61
v_dot2_f32_bf16 v62, v173, v21, v62
v_dot2_f32_bf16 v63, v173, v25, v63
v_dot2_f32_bf16 v60, v170, v22, v60
v_dot2_f32_bf16 v61, v170, v26, v61
v_dot2_f32_bf16 v62, v174, v22, v62
v_dot2_f32_bf16 v63, v174, v26, v63
v_dot2_f32_bf16 v60, v171, v23, v60
v_dot2_f32_bf16 v61, v171, v27, v61
v_dot2_f32_bf16 v62, v175, v23, v62
v_dot2_f32_bf16 v63, v175, v27, v63
buffer_load_dwordx4 v[168:171], v10, s[44:47], 0 offen offset:2560 nt
buffer_load_dwordx4 v[172:175], v10, s[44:47], 0 offen offset:2816 nt
v_add_f32_dpp v60, v60, v60 row_ror:8 row_mask:0xf bank_mask:0xf
v_add_f32_dpp v61, v61, v61 row_ror:8 row_mask:0xf bank_mask:0xf
v_add_f32_dpp v62, v62, v62 row_ror:8 row_mask:0xf bank_mask:0xf
v_add_f32_dpp v63, v63, v63 row_ror:8 row_mask:0xf bank_mask:0xf
v_add_f32_dpp v60, v60, v60 row_ror:4 row_mask:0xf bank_mask:0xf
v_add_f32_dpp v61, v61, v61 row_ror:4 row_mask:0xf bank_mask:0xf
v_add_f32_dpp v62, v62, v62 row_ror:4 row_mask:0xf bank_mask:0xf
v_add_f32_dpp v63, v63, v63 row_ror:4 row_mask:0xf bank_mask:0xf
v_add_f32_dpp v60, v60, v60 row_ror:2 row_mask:0xf bank_mask:0xf
v_add_f32_dpp v61, v61, v61 row_ror:2 row_mask:0xf bank_mask:0xf
v_add_f32_dpp v62, v62, v62 row_ror:2 row_mask:0xf bank_mask:0xf
v_add_f32_dpp v63, v63, v63 row_ror:2 row_mask:0xf bank_mask:0xf
v_add_f32_dpp v60, v60, v60 row_ror:1 row_mask:0xf bank_mask:0xf
v_add_f32_dpp v61, v61, v61 row_ror:1 row_mask:0xf bank_mask:0xf
v_add_f32_dpp v62, v62, v62 row_ror:1 row_mask:0xf bank_mask:0xf
v_add_f32_dpp v63, v63, v63 row_ror:1 row_mask:0xf bank_mask:0xf
v_cmp_eq_u32 vcc, 10, v202
s_nop 1
v_cndmask_b32 v200, v200, v60, vcc
v_cndmask_b32 v201, v201, v61, vcc
v_cmp_eq_u32 vcc, 11, v202
s_nop 1
v_cndmask_b32 v200, v200, v62, vcc
v_cndmask_b32 v201, v201, v63, vcc
s_waitcnt vmcnt(30)
v_dot2_f32_bf16 v60, v176, v20, 0
v_dot2_f32_bf16 v61, v176, v24, 0
v_dot2_f32_bf16 v62, v180, v20, 0
v_dot2_f32_bf16 v63, v180, v24, 0
v_dot2_f32_bf16 v60, v177, v21, v60
v_dot2_f32_bf16 v61, v177, v25, v61
v_dot2_f32_bf16 v62, v181, v21, v62
v_dot2_f32_bf16 v63, v181, v25, v63
v_dot2_f32_bf16 v60, v178, v22, v60
v_dot2_f32_bf16 v61, v178, v26, v61
v_dot2_f32_bf16 v62, v182, v22, v62
v_dot2_f32_bf16 v63, v182, v26, v63
v_dot2_f32_bf16 v60, v179, v23, v60
v_dot2_f32_bf16 v61, v179, v27, v61
v_dot2_f32_bf16 v62, v183, v23, v62
v_dot2_f32_bf16 v63, v183, v27, v63
buffer_load_dwordx4 v[176:179], v10, s[44:47], 0 offen offset:3072 nt
buffer_load_dwordx4 v[180:183], v10, s[44:47], 0 offen offset:3328 nt
v_add_f32_dpp v60, v60, v60 row_ror:8 row_mask:0xf bank_mask:0xf
v_add_f32_dpp v61, v61, v61 row_ror:8 row_mask:0xf bank_mask:0xf
v_add_f32_dpp v62, v62, v62 row_ror:8 row_mask:0xf bank_mask:0xf
v_add_f32_dpp v63, v63, v63 row_ror:8 row_mask:0xf bank_mask:0xf
v_add_f32_dpp v60, v60, v60 row_ror:4 row_mask:0xf bank_mask:0xf
v_add_f32_dpp v61, v61, v61 row_ror:4 row_mask:0xf bank_mask:0xf
v_add_f32_dpp v62, v62, v62 row_ror:4 row_mask:0xf bank_mask:0xf
v_add_f32_dpp v63, v63, v63 row_ror:4 row_mask:0xf bank_mask:0xf
v_add_f32_dpp v60, v60, v60 row_ror:2 row_mask:0xf bank_mask:0xf
v_add_f32_dpp v61, v61, v61 row_ror:2 row_mask:0xf bank_mask:0xf
v_add_f32_dpp v62, v62, v62 row_ror:2 row_mask:0xf bank_mask:0xf
v_add_f32_dpp v63, v63, v63 row_ror:2 row_mask:0xf bank_mask:0xf
v_add_f32_dpp v60, v60, v60 row_ror:1 row_mask:0xf bank_mask:0xf
v_add_f32_dpp v61, v61, v61 row_ror:1 row_mask:0xf bank_mask:0xf
v_add_f32_dpp v62, v62, v62 row_ror:1 row_mask:0xf bank_mask:0xf
v_add_f32_dpp v63, v63, v63 row_ror:1 row_mask:0xf bank_mask:0xf
v_cmp_eq_u32 vcc, 12, v202
s_nop 1
v_cndmask_b32 v200, v200, v60, vcc
v_cndmask_b32 v201, v201, v61, vcc
v_cmp_eq_u32 vcc, 13, v202
s_nop 1
v_cndmask_b32 v200, v200, v62, vcc
v_cndmask_b32 v201, v201, v63, vcc
s_waitcnt vmcnt(30)
v_dot2_f32_bf16 v60, v184, v20, 0
v_dot2_f32_bf16 v61, v184, v24, 0
v_dot2_f32_bf16 v62, v188, v20, 0
v_dot2_f32_bf16 v63, v188, v24, 0
v_dot2_f32_bf16 v60, v185, v21, v60
v_dot2_f32_bf16 v61, v185, v25, v61
v_dot2_f32_bf16 v62, v189, v21, v62
v_dot2_f32_bf16 v63, v189, v25, v63
v_dot2_f32_bf16 v60, v186, v22, v60
v_dot2_f32_bf16 v61, v186, v26, v61
v_dot2_f32_bf16 v62, v190, v22, v62
v_dot2_f32_bf16 v63, v190, v26, v63
v_dot2_f32_bf16 v60, v187, v23, v60
v_dot2_f32_bf16 v61, v187, v27, v61
v_dot2_f32_bf16 v62, v191, v23, v62
v_dot2_f32_bf16 v63, v191, v27, v63
buffer_load_dwordx4 v[184:187], v10, s[44:47], 0 offen offset:3584 nt
buffer_load_dwordx4 v[188:191], v10, s[44:47], 0 offen offset:3840 nt
v_add_f32_dpp v60, v60, v60 row_ror:8 row_mask:0xf bank_mask:0xf
v_add_f32_dpp v61, v61, v61 row_ror:8 row_mask:0xf bank_mask:0xf
v_add_f32_dpp v62, v62, v62 row_ror:8 row_mask:0xf bank_mask:0xf
v_add_f32_dpp v63, v63, v63 row_ror:8 row_mask:0xf bank_mask:0xf
v_add_f32_dpp v60, v60, v60 row_ror:4 row_mask:0xf bank_mask:0xf
v_add_f32_dpp v61, v61, v61 row_ror:4 row_mask:0xf bank_mask:0xf
v_add_f32_dpp v62, v62, v62 row_ror:4 row_mask:0xf bank_mask:0xf
v_add_f32_dpp v63, v63, v63 row_ror:4 row_mask:0xf bank_mask:0xf
v_add_f32_dpp v60, v60, v60 row_ror:2 row_mask:0xf bank_mask:0xf
v_add_f32_dpp v61, v61, v61 row_ror:2 row_mask:0xf bank_mask:0xf
v_add_f32_dpp v62, v62, v62 row_ror:2 row_mask:0xf bank_mask:0xf
v_add_f32_dpp v63, v63, v63 row_ror:2 row_mask:0xf bank_mask:0xf
v_add_f32_dpp v60, v60, v60 row_ror:1 row_mask:0xf bank_mask:0xf
v_add_f32_dpp v61, v61, v61 row_ror:1 row_mask:0xf bank_mask:0xf
v_add_f32_dpp v62, v62, v62 row_ror:1 row_mask:0xf bank_mask:0xf
v_add_f32_dpp v63, v63, v63 row_ror:1 row_mask:0xf bank_mask:0xf
v_cmp_eq_u32 vcc, 14, v202
s_nop 1
v_cndmask_b32 v200, v200, v60, vcc
v_cndmask_b32 v201, v201, v61, vcc
v_cmp_eq_u32 vcc, 15, v202
s_nop 1
v_cndmask_b32 v200, v200, v62, vcc
v_cndmask_b32 v201, v201, v63, vcc
v_cvt_pk_bf16_f32 v200, v200, v200
v_cvt_pk_bf16_f32 v201, v201, v201
v_lshlrev_b32 v192, 1, v0
ds_write_b16 v192, v200 offset:0
ds_write_b16 v192, v201 offset:1024
s_waitcnt lgkmcnt(0)
s_barrier
s_cmp_lg_u32 s34, 0
s_cbranch_scc1 L_W_q
v_lshlrev_b32 v192, 4, v1
ds_read_b128 v[20:23], v192 offset:0
ds_read_b128 v[24:27], v192 offset:1024
s_lshl_b32 s62, s32, 10
s_add_u32 s62, s62, 0x0
s_add_u32 s63, s62, 32768
s_waitcnt lgkmcnt(0)
buffer_store_dwordx4 v[20:23], v192, s[52:55], s62 offen sc1
buffer_store_dwordx4 v[24:27], v192, s[52:55], s63 offen sc1
s_lshl_b32 s62, s32, 7
s_add_u32 s62, s62, 0x15000
v_mov_b32 v192, s62
v_mov_b32 v193, s58
s_mov_b64 exec, 1
s_waitcnt vmcnt(0)
buffer_store_dword v193, v192, s[52:55], 0 offen sc1
s_mov_b64 exec, -1
L_W_q:
s_waitcnt vmcnt(0)
v_bfe_u32 v9, v1, 2, 3
v_lshlrev_b32 v9, 11, v9
v_and_b32 v192, 3, v1
v_lshrrev_b32 v10, 5, v1
v_lshl_add_u32 v192, v10, 2, v192
v_lshl_add_u32 v9, v192, 4, v9
s_lshr_b32 s62, s32, 4
s_and_b32 s63, s32, 15
s_lshl_b32 s60, s62, 16
s_lshl_b32 s61, s63, 7
s_add_u32 s60, s60, s61
s_add_u32 s60, s60, 0x20000
v_add_u32 v9, s60, v9
s_lshl_b32 s60, s62, 11
s_lshl_b32 s61, s63, 6
s_add_u32 s60, s60, s61
s_add_u32 s60, s60, 1024
v_lshl_add_u32 v10, v192, 3, s60
s_mov_b32 s37, 65536
s_lshr_b32 s35, s34, 2
s_and_b32 s36, s34, 3
s_branch L_W_merge
L_W_poll:
s_lshl_b32 s63, s32, 4
s_add_u32 s63, s63, 0x10000
v_lshl_add_u32 v192, v1, 9, s63
s_cmp_lg_u32 s34, 0
s_cbranch_scc1 L_wf_Wc
s_lshl_b64 exec, 1, s32
s_mov_b32 s64, 0
L_pl_Wc1:
buffer_load_dwordx4 v[196:199], v192, s[52:55], 0 offen sc1
s_add_u32 s64, s64, 1
s_waitcnt vmcnt(0)
v_xor_b32 v196, s76, v196
v_xor_b32 v197, s77, v197
v_xor_b32 v198, s78, v198
v_xor_b32 v199, s79, v199
v_or_b32 v193, v196, v197
v_or3_b32 v193, v193, v198, v199
v_and_b32 v193, 0xff, v193
v_cmp_ne_u32 vcc, 0, v193
s_nop 0
s_cmp_eq_u64 vcc, 0
s_cbranch_scc1 L_pd_Wc1
s_mov_b64 exec, vcc
s_sleep 2
s_cmp_lt_u32 s64, 65536
s_cbranch_scc1 L_pl_Wc1
L_pd_Wc1:
s_mov_b32 exec_lo, -1
s_mov_b32 exec_hi, 0
s_mov_b32 s64, 0
L_pl_Wc2:
buffer_load_dwordx4 v[196:199], v192, s[52:55], 0 offen sc1
s_add_u32 s64, s64, 1
s_waitcnt vmcnt(0)
v_xor_b32 v196, s76, v196
v_xor_b32 v197, s77, v197
v_xor_b32 v198, s78, v198
v_xor_b32 v199, s79, v199
v_or_b32 v193, v196, v197
v_or3_b32 v193, v193, v198, v199
v_and_b32 v193, 0xff, v193
v_cmp_ne_u32 vcc, 0, v193
s_nop 0
s_cmp_eq_u64 vcc, 0
s_cbranch_scc1 L_pd_Wc2
s_mov_b64 exec, vcc
s_cmp_lt_u32 s64, 65536
s_cbranch_scc1 L_pl_Wc2
L_pd_Wc2:
s_mov_b64 exec, -1
L_wf_Wc:
s_barrier
s_lshl_b32 s62, s35, 13
s_add_u32 s63, s63, s62
v_lshl_add_u32 v192, v2, 9, s63
buffer_load_dwordx4 v[196:199], v192, s[52:55], 0 offen sc1
s_lshl_b32 s62, s35, 5
s_add_u32 s62, s62, s32
s_lshl_b32 s63, s62, 14
s_add_u32 s63, s63, 0x200000
s_lshl_b32 s64, s36, 12
s_add_u32 s63, s63, s64
v_lshl_add_u32 v193, v1, 4, s63
buffer_load_dwordx4 v[200:203], v193, s[52:55], 0 offen offset:0 sc1
buffer_load_dwordx4 v[204:207], v193, s[52:55], 0 offen offset:1024 sc1
buffer_load_dwordx4 v[208:211], v193, s[52:55], 0 offen offset:2048 sc1
buffer_load_dwordx4 v[212:215], v193, s[52:55], 0 offen offset:3072 sc1
L_W_merge:
s_mov_b32 s60, 0x07060302
s_waitcnt vmcnt(4)
v_perm_b32 v194, v196, v197, s60
v_perm_b32 v195, v198, v199, s60
v_mov_b32 v196, v194
s_nop 1
v_max_f32_dpp v196, v196, v196 row_ror:8 row_mask:0xf bank_mask:0xf
s_nop 1
v_max_f32_dpp v196, v196, v196 row_ror:4 row_mask:0xf bank_mask:0xf
s_nop 1
v_max_f32_dpp v196, v196, v196 row_ror:2 row_mask:0xf bank_mask:0xf
s_nop 1
v_max_f32_dpp v196, v196, v196 row_ror:1 row_mask:0xf bank_mask:0xf
v_sub_f32 v197, v194, v196
v_exp_f32 v197, v197
s_nop 0
v_mul_f32 v195, v195, v197
s_nop 1
v_add_f32_dpp v195, v195, v195 row_ror:8 row_mask:0xf bank_mask:0xf
s_nop 1
v_add_f32_dpp v195, v195, v195 row_ror:4 row_mask:0xf bank_mask:0xf
s_nop 1
v_add_f32_dpp v195, v195, v195 row_ror:2 row_mask:0xf bank_mask:0xf
s_nop 1
v_add_f32_dpp v195, v195, v195 row_ror:1 row_mask:0xf bank_mask:0xf
v_rcp_f32 v195, v195
s_nop 0
v_mul_f32 v197, v197, v195
s_lshl_b32 s64, s36, 2
s_add_u32 s65, s64, 0
v_readlane_b32 s66, v197, s65
s_add_u32 s65, s64, 1
v_readlane_b32 s67, v197, s65
s_add_u32 s65, s64, 2
v_readlane_b32 s68, v197, s65
s_add_u32 s65, s64, 3
v_readlane_b32 s69, v197, s65
s_waitcnt vmcnt(3)
v_lshlrev_b32 v216, 16, v200
v_and_b32 v217, 0xffff0000, v200
v_lshlrev_b32 v218, 16, v201
v_and_b32 v219, 0xffff0000, v201
v_lshlrev_b32 v220, 16, v202
v_and_b32 v221, 0xffff0000, v202
v_lshlrev_b32 v222, 16, v203
v_and_b32 v223, 0xffff0000, v203
v_mul_f32 v232, s66, v216
v_mul_f32 v233, s66, v217
v_mul_f32 v234, s66, v218
v_mul_f32 v235, s66, v219
v_mul_f32 v236, s66, v220
v_mul_f32 v237, s66, v221
v_mul_f32 v238, s66, v222
v_mul_f32 v239, s66, v223
s_waitcnt vmcnt(2)
v_lshlrev_b32 v216, 16, v204
v_and_b32 v217, 0xffff0000, v204
v_lshlrev_b32 v218, 16, v205
v_and_b32 v219, 0xffff0000, v205
v_lshlrev_b32 v220, 16, v206
v_and_b32 v221, 0xffff0000, v206
v_lshlrev_b32 v222, 16, v207
v_and_b32 v223, 0xffff0000, v207
v_fma_f32 v232, v216, s67, v232
v_fma_f32 v233, v217, s67, v233
v_fma_f32 v234, v218, s67, v234
v_fma_f32 v235, v219, s67, v235
v_fma_f32 v236, v220, s67, v236
v_fma_f32 v237, v221, s67, v237
v_fma_f32 v238, v222, s67, v238
v_fma_f32 v239, v223, s67, v239
s_waitcnt vmcnt(1)
v_lshlrev_b32 v216, 16, v208
v_and_b32 v217, 0xffff0000, v208
v_lshlrev_b32 v218, 16, v209
v_and_b32 v219, 0xffff0000, v209
v_lshlrev_b32 v220, 16, v210
v_and_b32 v221, 0xffff0000, v210
v_lshlrev_b32 v222, 16, v211
v_and_b32 v223, 0xffff0000, v211
v_fma_f32 v232, v216, s68, v232
v_fma_f32 v233, v217, s68, v233
v_fma_f32 v234, v218, s68, v234
v_fma_f32 v235, v219, s68, v235
v_fma_f32 v236, v220, s68, v236
v_fma_f32 v237, v221, s68, v237
v_fma_f32 v238, v222, s68, v238
v_fma_f32 v239, v223, s68, v239
s_waitcnt vmcnt(0)
v_lshlrev_b32 v216, 16, v212
v_and_b32 v217, 0xffff0000, v212
v_lshlrev_b32 v218, 16, v213
v_and_b32 v219, 0xffff0000, v213
v_lshlrev_b32 v220, 16, v214
v_and_b32 v221, 0xffff0000, v214
v_lshlrev_b32 v222, 16, v215
v_and_b32 v223, 0xffff0000, v215
v_fma_f32 v232, v216, s69, v232
v_fma_f32 v233, v217, s69, v233
v_fma_f32 v234, v218, s69, v234
v_fma_f32 v235, v219, s69, v235
v_fma_f32 v236, v220, s69, v236
v_fma_f32 v237, v221, s69, v237
v_fma_f32 v238, v222, s69, v238
v_fma_f32 v239, v223, s69, v239
s_lshl_b32 s62, s34, 11
v_lshl_add_u32 v192, v1, 5, s62
ds_write_b128 v192, v[232:235] offset:18432
ds_write_b128 v192, v[236:239] offset:18448
s_waitcnt lgkmcnt(0)
s_barrier
v_lshrrev_b32 v192, 3, v2
v_lshlrev_b32 v192, 13, v192
v_lshl_add_u32 v192, v3, 6, v192
s_lshl_b32 s62, s34, 8
s_lshr_b32 s63, s80, 11
s_add_u32 s62, s62, s63
v_add_u32 v192, s62, v192
v_xor_b32 v193, 16, v192
v_xor_b32 v194, 32, v192
v_xor_b32 v195, 48, v192
ds_read_b128 v[200:203], v192 offset:18432
ds_read_b128 v[204:207], v193 offset:18432
ds_read_b128 v[208:211], v194 offset:18432
ds_read_b128 v[212:215], v195 offset:18432
ds_read_b128 v[216:219], v192 offset:20480
ds_read_b128 v[220:223], v193 offset:20480
ds_read_b128 v[224:227], v194 offset:20480
ds_read_b128 v[228:231], v195 offset:20480
s_waitcnt lgkmcnt(0)
v_add_f32 v200, v200, v216
v_add_f32 v201, v201, v217
v_add_f32 v202, v202, v218
v_add_f32 v203, v203, v219
v_add_f32 v204, v204, v220
v_add_f32 v205, v205, v221
v_add_f32 v206, v206, v222
v_add_f32 v207, v207, v223
v_add_f32 v208, v208, v224
v_add_f32 v209, v209, v225
v_add_f32 v210, v210, v226
v_add_f32 v211, v211, v227
v_add_f32 v212, v212, v228
v_add_f32 v213, v213, v229
v_add_f32 v214, v214, v230
v_add_f32 v215, v215, v231
ds_read_b128 v[216:219], v192 offset:22528
ds_read_b128 v[220:223], v193 offset:22528
ds_read_b128 v[224:227], v194 offset:22528
ds_read_b128 v[228:231], v195 offset:22528
s_waitcnt lgkmcnt(0)
v_add_f32 v200, v200, v216
v_add_f32 v201, v201, v217
v_add_f32 v202, v202, v218
v_add_f32 v203, v203, v219
v_add_f32 v204, v204, v220
v_add_f32 v205, v205, v221
v_add_f32 v206, v206, v222
v_add_f32 v207, v207, v223
v_add_f32 v208, v208, v224
v_add_f32 v209, v209, v225
v_add_f32 v210, v210, v226
v_add_f32 v211, v211, v227
v_add_f32 v212, v212, v228
v_add_f32 v213, v213, v229
v_add_f32 v214, v214, v230
v_add_f32 v215, v215, v231
ds_read_b128 v[216:219], v192 offset:24576
ds_read_b128 v[220:223], v193 offset:24576
ds_read_b128 v[224:227], v194 offset:24576
ds_read_b128 v[228:231], v195 offset:24576
s_waitcnt lgkmcnt(0)
v_add_f32 v200, v200, v216
v_add_f32 v201, v201, v217
v_add_f32 v202, v202, v218
v_add_f32 v203, v203, v219
v_add_f32 v204, v204, v220
v_add_f32 v205, v205, v221
v_add_f32 v206, v206, v222
v_add_f32 v207, v207, v223
v_add_f32 v208, v208, v224
v_add_f32 v209, v209, v225
v_add_f32 v210, v210, v226
v_add_f32 v211, v211, v227
v_add_f32 v212, v212, v228
v_add_f32 v213, v213, v229
v_add_f32 v214, v214, v230
v_add_f32 v215, v215, v231
v_cvt_pk_bf16_f32 v12, v200, v201
v_cvt_pk_bf16_f32 v13, v202, v203
v_cvt_pk_bf16_f32 v14, v204, v205
v_cvt_pk_bf16_f32 v15, v206, v207
v_cvt_pk_bf16_f32 v16, v208, v209
v_cvt_pk_bf16_f32 v17, v210, v211
v_cvt_pk_bf16_f32 v18, v212, v213
v_cvt_pk_bf16_f32 v19, v214, v215
s_mov_b32 s60, 0x01000100
v_perm_b32 v192, v12, v12, s60
v_and_b32 v28, v192, v4
v_and_b32 v29, v192, v5
v_and_b32 v30, v192, v6
v_and_b32 v31, v192, v7
s_waitcnt vmcnt(63)
s_nop 0
v_mfma_f32_16x16x32_bf16 v[44:47], v[28:31], v[64:67], 0
s_mov_b32 s60, 0x03020302
v_perm_b32 v193, v12, v12, s60
v_and_b32 v32, v193, v4
v_and_b32 v33, v193, v5
v_and_b32 v34, v193, v6
v_and_b32 v35, v193, v7
s_waitcnt vmcnt(63)
s_nop 0
v_mfma_f32_16x16x32_bf16 v[44:47], v[32:35], v[68:71], v[44:47]
s_mov_b32 s60, 0x01000100
v_perm_b32 v192, v13, v13, s60
v_and_b32 v28, v192, v4
v_and_b32 v29, v192, v5
v_and_b32 v30, v192, v6
v_and_b32 v31, v192, v7
s_waitcnt vmcnt(63)
s_nop 0
v_mfma_f32_16x16x32_bf16 v[44:47], v[28:31], v[72:75], v[44:47]
s_mov_b32 s60, 0x03020302
v_perm_b32 v193, v13, v13, s60
v_and_b32 v32, v193, v4
v_and_b32 v33, v193, v5
v_and_b32 v34, v193, v6
v_and_b32 v35, v193, v7
s_waitcnt vmcnt(63)
s_nop 0
v_mfma_f32_16x16x32_bf16 v[44:47], v[32:35], v[76:79], v[44:47]
s_mov_b32 s60, 0x01000100
v_perm_b32 v192, v14, v14, s60
v_and_b32 v28, v192, v4
v_and_b32 v29, v192, v5
v_and_b32 v30, v192, v6
v_and_b32 v31, v192, v7
s_waitcnt vmcnt(63)
s_nop 0
v_mfma_f32_16x16x32_bf16 v[44:47], v[28:31], v[80:83], v[44:47]
s_mov_b32 s60, 0x03020302
v_perm_b32 v193, v14, v14, s60
v_and_b32 v32, v193, v4
v_and_b32 v33, v193, v5
v_and_b32 v34, v193, v6
v_and_b32 v35, v193, v7
s_waitcnt vmcnt(63)
s_nop 0
v_mfma_f32_16x16x32_bf16 v[44:47], v[32:35], v[84:87], v[44:47]
s_mov_b32 s60, 0x01000100
v_perm_b32 v192, v15, v15, s60
v_and_b32 v28, v192, v4
v_and_b32 v29, v192, v5
v_and_b32 v30, v192, v6
v_and_b32 v31, v192, v7
s_waitcnt vmcnt(63)
s_nop 0
v_mfma_f32_16x16x32_bf16 v[44:47], v[28:31], v[88:91], v[44:47]
s_mov_b32 s60, 0x03020302
v_perm_b32 v193, v15, v15, s60
v_and_b32 v32, v193, v4
v_and_b32 v33, v193, v5
v_and_b32 v34, v193, v6
v_and_b32 v35, v193, v7
s_waitcnt vmcnt(63)
s_nop 0
v_mfma_f32_16x16x32_bf16 v[44:47], v[32:35], v[92:95], v[44:47]
s_mov_b32 s60, 0x01000100
v_perm_b32 v192, v16, v16, s60
v_and_b32 v28, v192, v4
v_and_b32 v29, v192, v5
v_and_b32 v30, v192, v6
v_and_b32 v31, v192, v7
s_waitcnt vmcnt(63)
s_nop 0
v_mfma_f32_16x16x32_bf16 v[44:47], v[28:31], v[96:99], v[44:47]
s_mov_b32 s60, 0x03020302
v_perm_b32 v193, v16, v16, s60
v_and_b32 v32, v193, v4
v_and_b32 v33, v193, v5
v_and_b32 v34, v193, v6
v_and_b32 v35, v193, v7
s_waitcnt vmcnt(63)
s_nop 0
v_mfma_f32_16x16x32_bf16 v[44:47], v[32:35], v[100:103], v[44:47]
s_mov_b32 s60, 0x01000100
v_perm_b32 v192, v17, v17, s60
v_and_b32 v28, v192, v4
v_and_b32 v29, v192, v5
v_and_b32 v30, v192, v6
v_and_b32 v31, v192, v7
s_waitcnt vmcnt(63)
s_nop 0
v_mfma_f32_16x16x32_bf16 v[44:47], v[28:31], v[104:107], v[44:47]
s_mov_b32 s60, 0x03020302
v_perm_b32 v193, v17, v17, s60
v_and_b32 v32, v193, v4
v_and_b32 v33, v193, v5
v_and_b32 v34, v193, v6
v_and_b32 v35, v193, v7
s_waitcnt vmcnt(63)
s_nop 0
v_mfma_f32_16x16x32_bf16 v[44:47], v[32:35], v[108:111], v[44:47]
s_mov_b32 s60, 0x01000100
v_perm_b32 v192, v18, v18, s60
v_and_b32 v28, v192, v4
v_and_b32 v29, v192, v5
v_and_b32 v30, v192, v6
v_and_b32 v31, v192, v7
s_waitcnt vmcnt(63)
s_nop 0
v_mfma_f32_16x16x32_bf16 v[44:47], v[28:31], v[112:115], v[44:47]
s_mov_b32 s60, 0x03020302
v_perm_b32 v193, v18, v18, s60
v_and_b32 v32, v193, v4
v_and_b32 v33, v193, v5
v_and_b32 v34, v193, v6
v_and_b32 v35, v193, v7
s_waitcnt vmcnt(63)
s_nop 0
v_mfma_f32_16x16x32_bf16 v[44:47], v[32:35], v[116:119], v[44:47]
s_mov_b32 s60, 0x01000100
v_perm_b32 v192, v19, v19, s60
v_and_b32 v28, v192, v4
v_and_b32 v29, v192, v5
v_and_b32 v30, v192, v6
v_and_b32 v31, v192, v7
s_waitcnt vmcnt(63)
s_nop 0
v_mfma_f32_16x16x32_bf16 v[44:47], v[28:31], v[120:123], v[44:47]
s_mov_b32 s60, 0x03020302
v_perm_b32 v193, v19, v19, s60
v_and_b32 v32, v193, v4
v_and_b32 v33, v193, v5
v_and_b32 v34, v193, v6
v_and_b32 v35, v193, v7
s_waitcnt vmcnt(63)
s_nop 0
v_mfma_f32_16x16x32_bf16 v[44:47], v[32:35], v[124:127], v[44:47]
v_lshrrev_b32 v192, 1, v3
v_lshlrev_b32 v192, 9, v192
v_lshl_add_u32 v192, v2, 5, v192
v_and_b32 v193, 1, v3
v_lshl_add_u32 v192, v193, 4, v192
s_lshl_b32 s63, s34, 10
v_add_u32 v192, s63, v192
s_nop 1
s_nop 5
ds_write_b128 v192, v[44:47] offset:9216
s_waitcnt lgkmcnt(0)
s_barrier
v_lshrrev_b32 v192, 3, v2
v_lshlrev_b32 v192, 9, v192
v_lshl_add_u32 v192, v3, 4, v192
s_lshl_b32 s62, s34, 6
v_add_u32 v192, s62, v192
ds_read_b128 v[200:203], v192 offset:9216
ds_read_b128 v[204:207], v192 offset:10240
ds_read_b128 v[208:211], v192 offset:11264
ds_read_b128 v[212:215], v192 offset:12288
ds_read_b128 v[216:219], v192 offset:13312
ds_read_b128 v[220:223], v192 offset:14336
ds_read_b128 v[224:227], v192 offset:15360
ds_read_b128 v[228:231], v192 offset:16384
s_waitcnt lgkmcnt(6)
v_add_f32 v200, v200, v204
v_add_f32 v201, v201, v205
v_add_f32 v202, v202, v206
v_add_f32 v203, v203, v207
s_waitcnt lgkmcnt(5)
v_add_f32 v200, v200, v208
v_add_f32 v201, v201, v209
v_add_f32 v202, v202, v210
v_add_f32 v203, v203, v211
s_waitcnt lgkmcnt(4)
v_add_f32 v200, v200, v212
v_add_f32 v201, v201, v213
v_add_f32 v202, v202, v214
v_add_f32 v203, v203, v215
s_waitcnt lgkmcnt(3)
v_add_f32 v200, v200, v216
v_add_f32 v201, v201, v217
v_add_f32 v202, v202, v218
v_add_f32 v203, v203, v219
s_waitcnt lgkmcnt(2)
v_add_f32 v200, v200, v220
v_add_f32 v201, v201, v221
v_add_f32 v202, v202, v222
v_add_f32 v203, v203, v223
s_waitcnt lgkmcnt(1)
v_add_f32 v200, v200, v224
v_add_f32 v201, v201, v225
v_add_f32 v202, v202, v226
v_add_f32 v203, v203, v227
s_waitcnt lgkmcnt(0)
v_add_f32 v200, v200, v228
v_add_f32 v201, v201, v229
v_add_f32 v202, v202, v230
v_add_f32 v203, v203, v231
v_cvt_pk_bf16_f32 v60, v200, v200
v_cvt_pk_bf16_f32 v61, v201, v201
v_cvt_pk_bf16_f32 v62, v202, v202
v_cvt_pk_bf16_f32 v63, v203, v203
v_and_b32 v28, v60, v4
v_and_b32 v29, v60, v5
v_and_b32 v30, v60, v6
v_and_b32 v31, v60, v7
v_and_b32 v32, v61, v4
v_and_b32 v33, v61, v5
v_and_b32 v34, v61, v6
v_and_b32 v35, v61, v7
v_and_b32 v36, v62, v4
v_and_b32 v37, v62, v5
v_and_b32 v38, v62, v6
v_and_b32 v39, v62, v7
v_and_b32 v40, v63, v4
v_and_b32 v41, v63, v5
v_and_b32 v42, v63, v6
v_and_b32 v43, v63, v7
v_mfma_f32_16x16x32_bf16 v[44:47], v[28:31], v[128:131], 0
v_mfma_f32_16x16x32_bf16 v[48:51], v[28:31], v[132:135], 0
v_mfma_f32_16x16x32_bf16 v[52:55], v[28:31], v[136:139], 0
v_mfma_f32_16x16x32_bf16 v[56:59], v[28:31], v[140:143], 0
v_mfma_f32_16x16x32_bf16 v[44:47], v[32:35], v[144:147], v[44:47]
v_mfma_f32_16x16x32_bf16 v[48:51], v[32:35], v[148:151], v[48:51]
v_mfma_f32_16x16x32_bf16 v[52:55], v[32:35], v[152:155], v[52:55]
v_mfma_f32_16x16x32_bf16 v[56:59], v[32:35], v[156:159], v[56:59]
v_mfma_f32_16x16x32_bf16 v[44:47], v[36:39], v[160:163], v[44:47]
v_mfma_f32_16x16x32_bf16 v[48:51], v[36:39], v[164:167], v[48:51]
v_mfma_f32_16x16x32_bf16 v[52:55], v[36:39], v[168:171], v[52:55]
v_mfma_f32_16x16x32_bf16 v[56:59], v[36:39], v[172:175], v[56:59]
v_mfma_f32_16x16x32_bf16 v[44:47], v[40:43], v[176:179], v[44:47]
v_mfma_f32_16x16x32_bf16 v[48:51], v[40:43], v[180:183], v[48:51]
v_mfma_f32_16x16x32_bf16 v[52:55], v[40:43], v[184:187], v[52:55]
v_mfma_f32_16x16x32_bf16 v[56:59], v[40:43], v[188:191], v[56:59]
v_lshrrev_b32 v192, 1, v3
v_lshlrev_b32 v192, 11, v192
v_lshl_add_u32 v192, v2, 5, v192
v_and_b32 v193, 1, v3
v_lshl_add_u32 v192, v193, 4, v192
s_lshl_b32 s63, s34, 12
v_add_u32 v192, s63, v192
s_nop 1
ds_write_b128 v192, v[44:47] offset:18432
ds_write_b128 v192, v[48:51] offset:18944
ds_write_b128 v192, v[52:55] offset:19456
s_nop 5
ds_write_b128 v192, v[56:59] offset:19968
s_waitcnt lgkmcnt(0)
s_barrier
s_cmp_ge_u32 s34, 4
s_cbranch_scc1 L_W_yskip
v_lshlrev_b32 v192, 4, v0
ds_read_b128 v[200:203], v192 offset:18432
ds_read_b128 v[204:207], v192 offset:22528
ds_read_b128 v[208:211], v192 offset:26624
ds_read_b128 v[212:215], v192 offset:30720
ds_read_b128 v[216:219], v192 offset:34816
ds_read_b128 v[220:223], v192 offset:38912
ds_read_b128 v[224:227], v192 offset:43008
ds_read_b128 v[228:231], v192 offset:47104
v_bfe_u32 v193, v0, 7, 1
v_lshlrev_b32 v193, 16, v193
v_and_b32 v194, 127, v0
v_lshl_add_u32 v193, v194, 4, v193
s_lshl_b32 s63, s32, 11
s_add_u32 s63, s63, 0x20000
v_add_u32 v193, s63, v193
v_mov_b32 v194, 0xffffff00
s_waitcnt lgkmcnt(6)
v_add_f32 v200, v200, v204
v_add_f32 v201, v201, v205
v_add_f32 v202, v202, v206
v_add_f32 v203, v203, v207
s_waitcnt lgkmcnt(5)
v_add_f32 v200, v200, v208
v_add_f32 v201, v201, v209
v_add_f32 v202, v202, v210
v_add_f32 v203, v203, v211
s_waitcnt lgkmcnt(4)
v_add_f32 v200, v200, v212
v_add_f32 v201, v201, v213
v_add_f32 v202, v202, v214
v_add_f32 v203, v203, v215
s_waitcnt lgkmcnt(3)
v_add_f32 v200, v200, v216
v_add_f32 v201, v201, v217
v_add_f32 v202, v202, v218
v_add_f32 v203, v203, v219
s_waitcnt lgkmcnt(2)
v_add_f32 v200, v200, v220
v_add_f32 v201, v201, v221
v_add_f32 v202, v202, v222
v_add_f32 v203, v203, v223
s_waitcnt lgkmcnt(1)
v_add_f32 v200, v200, v224
v_add_f32 v201, v201, v225
v_add_f32 v202, v202, v226
v_add_f32 v203, v203, v227
s_waitcnt lgkmcnt(0)
v_add_f32 v200, v200, v228
v_add_f32 v201, v201, v229
v_add_f32 v202, v202, v230
v_add_f32 v203, v203, v231
v_add_u32 v200, 0x80, v200
v_add_u32 v201, 0x80, v201
v_add_u32 v202, 0x80, v202
v_add_u32 v203, 0x80, v203
v_and_or_b32 v200, v200, v194, s76
v_and_or_b32 v201, v201, v194, s77
v_and_or_b32 v202, v202, v194, s78
v_and_or_b32 v203, v203, v194, s79
s_cmp_lg_u32 s37, 0
s_cbranch_scc1 L_W_yskip
buffer_store_dwordx4 v[200:203], v193, s[52:55], 0 offen sc1
L_W_yskip:
s_cmp_lg_u32 s34, 4
s_cbranch_scc1 L_W_fin
s_mov_b32 s64, s37
s_mov_b32 s66, 0x4000
s_mov_b32 s67, 0x8000
s_mov_b32 s65, 0xc000
buffer_load_dwordx4 v[12:15], v9, s[52:55], 0 offen sc1
buffer_load_dwordx4 v[16:19], v9, s[52:55], s66 offen sc1
buffer_load_dwordx4 v[20:23], v9, s[52:55], s67 offen sc1
buffer_load_dwordx4 v[24:27], v9, s[52:55], s65 offen sc1
L_ps_Wf:
s_waitcnt vmcnt(3)
v_xor_b32 v200, s76, v12
v_xor_b32 v201, s77, v13
v_xor_b32 v202, s78, v14
v_xor_b32 v203, s79, v15
v_or_b32 v192, v200, v201
v_or3_b32 v192, v192, v202, v203
s_waitcnt vmcnt(2)
v_xor_b32 v204, s76, v16
v_xor_b32 v205, s77, v17
v_xor_b32 v206, s78, v18
v_xor_b32 v207, s79, v19
v_or3_b32 v192, v192, v204, v205
v_or3_b32 v192, v192, v206, v207
v_add_f32 v200, v200, v204
v_add_f32 v201, v201, v205
v_add_f32 v202, v202, v206
v_add_f32 v203, v203, v207
s_waitcnt vmcnt(1)
v_xor_b32 v204, s76, v20
v_xor_b32 v205, s77, v21
v_xor_b32 v206, s78, v22
v_xor_b32 v207, s79, v23
v_or3_b32 v192, v192, v204, v205
v_or3_b32 v192, v192, v206, v207
v_add_f32 v200, v200, v204
v_add_f32 v201, v201, v205
v_add_f32 v202, v202, v206
v_add_f32 v203, v203, v207
s_waitcnt vmcnt(0)
v_xor_b32 v204, s76, v24
v_xor_b32 v205, s77, v25
v_xor_b32 v206, s78, v26
v_xor_b32 v207, s79, v27
v_or3_b32 v192, v192, v204, v205
v_or3_b32 v192, v192, v206, v207
v_add_f32 v200, v200, v204
v_add_f32 v201, v201, v205
v_add_f32 v202, v202, v206
v_add_f32 v203, v203, v207
v_and_b32 v192, 0xff, v192
v_cmp_ne_u32 vcc, 0, v192
v_add_f32_dpp v200, v200, v200 row_ror:8 row_mask:0xf bank_mask:0xf
v_add_f32_dpp v201, v201, v201 row_ror:8 row_mask:0xf bank_mask:0xf
v_add_f32_dpp v202, v202, v202 row_ror:8 row_mask:0xf bank_mask:0xf
v_add_f32_dpp v203, v203, v203 row_ror:8 row_mask:0xf bank_mask:0xf
s_cmp_eq_u64 vcc, 0
s_cbranch_scc1 L_pe_Wf
s_sleep 2
buffer_load_dwordx4 v[12:15], v9, s[52:55], 0 offen sc1
buffer_load_dwordx4 v[16:19], v9, s[52:55], s66 offen sc1
buffer_load_dwordx4 v[20:23], v9, s[52:55], s67 offen sc1
buffer_load_dwordx4 v[24:27], v9, s[52:55], s65 offen sc1
s_add_u32 s64, s64, 1
s_cmp_lt_u32 s64, 65536
s_cbranch_scc1 L_ps_Wf
L_pe_Wf:
v_add_f32_dpp v200, v200, v200 row_ror:4 row_mask:0xf bank_mask:0xf
v_add_f32_dpp v201, v201, v201 row_ror:4 row_mask:0xf bank_mask:0xf
v_add_f32_dpp v202, v202, v202 row_ror:4 row_mask:0xf bank_mask:0xf
v_add_f32_dpp v203, v203, v203 row_ror:4 row_mask:0xf bank_mask:0xf
v_mov_b32 v192, v200
v_mov_b32 v193, v201
v_mov_b32 v194, v202
v_mov_b32 v195, v203
v_permlane16_swap_b32 v200, v192
v_permlane16_swap_b32 v201, v193
v_permlane16_swap_b32 v202, v194
v_permlane16_swap_b32 v203, v195
v_add_f32 v200, v200, v192
v_add_f32 v201, v201, v193
v_add_f32 v202, v202, v194
v_add_f32 v203, v203, v195
v_cvt_pk_bf16_f32 v200, v200, v201
v_cvt_pk_bf16_f32 v201, v202, v203
s_cmp_lg_u32 s37, 0
s_cbranch_scc1 L_W_fin
s_mov_b32 exec_lo, 15
s_mov_b32 exec_hi, 15
global_store_dwordx2 v10, v[200:201], s[26:27]
s_mov_b64 exec, -1
L_W_fin:
s_cmp_eq_u32 s37, 0
s_cbranch_scc1 L_W_end
s_mov_b32 s37, 0
s_waitcnt vmcnt(0)
s_branch L_W_poll
L_W_end:
s_endpgm
L_roleC:
s_lshl_b32 s60, s32, 8
s_sub_u32 s61, 0x400000, s60
s_add_u32 s68, s10, s60
s_addc_u32 s69, s11, 0
s_and_b32 s69, s69, 0xffff
s_mov_b32 s70, s61
s_mov_b32 s71, 0x20000
s_mov_b32 s72, s4
s_and_b32 s73, s5, 0xffff
s_mov_b32 s74, 0x800
s_mov_b32 s75, 0x20000
v_lshrrev_b32 v240, 3, v2
v_lshlrev_b32 v240, 10, v240
v_lshl_add_u32 v240, v3, 5, v240
s_lshl_b32 s62, s34, 7
v_add_u32 v240, s62, v240
s_mov_b32 s80, 0
buffer_load_dwordx4 v[32:35], v240, s[72:75], 0 offen
buffer_load_dwordx4 v[36:39], v240, s[72:75], 0 offen offset:16
v_lshlrev_b32 v9, 17, v3
v_lshl_add_u32 v9, v2, 4, v9
s_lshl_b32 s62, s34, 19
v_add_u32 v9, s62, v9
s_xor_b32 s62, s80, 0
buffer_load_dwordx4 v[128:131], v9, s[68:71], s62 offen nt
s_xor_b32 s62, s80, 8192
buffer_load_dwordx4 v[132:135], v9, s[68:71], s62 offen nt
s_xor_b32 s62, s80, 16384
buffer_load_dwordx4 v[136:139], v9, s[68:71], s62 offen nt
s_xor_b32 s62, s80, 24576
buffer_load_dwordx4 v[140:143], v9, s[68:71], s62 offen nt
s_xor_b32 s62, s80, 32768
buffer_load_dwordx4 v[144:147], v9, s[68:71], s62 offen nt
s_xor_b32 s62, s80, 40960
buffer_load_dwordx4 v[148:151], v9, s[68:71], s62 offen nt
s_xor_b32 s62, s80, 49152
buffer_load_dwordx4 v[152:155], v9, s[68:71], s62 offen nt
s_xor_b32 s62, s80, 57344
buffer_load_dwordx4 v[156:159], v9, s[68:71], s62 offen nt
s_xor_b32 s62, s80, 65536
buffer_load_dwordx4 v[160:163], v9, s[68:71], s62 offen nt
s_xor_b32 s62, s80, 73728
buffer_load_dwordx4 v[164:167], v9, s[68:71], s62 offen nt
s_xor_b32 s62, s80, 81920
buffer_load_dwordx4 v[168:171], v9, s[68:71], s62 offen nt
s_xor_b32 s62, s80, 90112
buffer_load_dwordx4 v[172:175], v9, s[68:71], s62 offen nt
s_xor_b32 s62, s80, 98304
buffer_load_dwordx4 v[176:179], v9, s[68:71], s62 offen nt
s_xor_b32 s62, s80, 106496
buffer_load_dwordx4 v[180:183], v9, s[68:71], s62 offen nt
s_xor_b32 s62, s80, 114688
buffer_load_dwordx4 v[184:187], v9, s[68:71], s62 offen nt
s_xor_b32 s62, s80, 122880
buffer_load_dwordx4 v[188:191], v9, s[68:71], s62 offen nt
s_load_dword s58, s[30:31], 0x14000
s_mov_b32 s44, s30
s_and_b32 s45, s31, 0xffff
s_mov_b32 s46, 0x1000000
s_mov_b32 s47, 0x20000
s_cmp_lg_u32 s34, 6
s_cbranch_scc1 L_C_ctr
v_mov_b32 v192, -1
s_lshl_b32 s62, s32, 13
s_add_u32 s62, s62, 0x61800
v_lshl_add_u32 v240, v1, 7, s62
s_mov_b64 exec, 1
buffer_store_dword v192, v240, s[44:47], 0 offen sc1
buffer_store_dword v192, v240, s[44:47], 0 offen offset:1024 sc1
s_mov_b64 exec, -1
L_C_ctr:
v_and_b32 v242, 1, v0
v_lshlrev_b32 v242, 4, v242
v_mov_b32 v243, 0xffff
v_lshlrev_b32 v242, v242, v243
v_bfe_u32 v243, v0, 1, 2
v_cmp_eq_u32 vcc, 0, v243
s_nop 1
v_cndmask_b32 v4, 0, v242, vcc
v_cmp_eq_u32 vcc, 1, v243
s_nop 1
v_cndmask_b32 v5, 0, v242, vcc
v_cmp_eq_u32 vcc, 2, v243
s_nop 1
v_cndmask_b32 v6, 0, v242, vcc
v_cmp_eq_u32 vcc, 3, v243
s_nop 1
v_cndmask_b32 v7, 0, v242, vcc
v_mov_b32 v8, 0
s_lshr_b32 s35, s32, 4
s_lshr_b32 s36, s34, 1
s_and_b32 s37, s34, 1
s_lshr_b32 s60, s32, 0
s_lshl_b32 s60, s60, 19
s_mov_b32 s61, 0x80000
s_add_u32 s40, s16, s60
s_addc_u32 s41, s17, 0
s_and_b32 s41, s41, 0xffff
s_mov_b32 s42, s61
s_mov_b32 s43, 0x20000
v_lshrrev_b32 v242, 1, v3
v_lshlrev_b32 v242, 9, v242
v_lshl_add_u32 v242, v2, 5, v242
v_and_b32 v243, 1, v3
v_lshl_add_u32 v242, v243, 4, v242
s_lshl_b32 s63, s34, 10
v_add_u32 v242, s63, v242
v_add_u32 v242, 140288, v242
v_lshlrev_b32 v243, 4, v1
s_lshl_b32 s62, s32, 10
s_add_u32 s62, s62, 0x18000
v_add_u32 v244, s62, v243
v_add_u32 v243, 140288, v243
s_waitcnt vmcnt(16) lgkmcnt(0)
s_add_u32 s58, s58, 0x9e3779b9
s_bfe_u32 s76, s58, 0x80000
s_bfe_u32 s77, s58, 0x80008
s_bfe_u32 s78, s58, 0x80010
s_bfe_u32 s79, s58, 0x80018
v_mov_b32 v245, s58
s_mov_b32 s60, 0x01000100
v_perm_b32 v240, v32, v32, s60
v_and_b32 v40, v240, v4
v_and_b32 v41, v240, v5
v_and_b32 v42, v240, v6
v_and_b32 v43, v240, v7
s_waitcnt vmcnt(15)
s_nop 0
v_mfma_f32_16x16x32_bf16 v[48:51], v[40:43], v[128:131], 0
s_mov_b32 s60, 0x03020302
v_perm_b32 v241, v32, v32, s60
v_and_b32 v44, v241, v4
v_and_b32 v45, v241, v5
v_and_b32 v46, v241, v6
v_and_b32 v47, v241, v7
s_waitcnt vmcnt(14)
s_nop 0
v_mfma_f32_16x16x32_bf16 v[48:51], v[44:47], v[132:135], v[48:51]
s_mov_b32 s60, 0x01000100
v_perm_b32 v240, v33, v33, s60
v_and_b32 v40, v240, v4
v_and_b32 v41, v240, v5
v_and_b32 v42, v240, v6
v_and_b32 v43, v240, v7
s_waitcnt vmcnt(13)
s_nop 0
v_mfma_f32_16x16x32_bf16 v[48:51], v[40:43], v[136:139], v[48:51]
s_mov_b32 s60, 0x03020302
v_perm_b32 v241, v33, v33, s60
v_and_b32 v44, v241, v4
v_and_b32 v45, v241, v5
v_and_b32 v46, v241, v6
v_and_b32 v47, v241, v7
s_waitcnt vmcnt(12)
s_nop 0
v_mfma_f32_16x16x32_bf16 v[48:51], v[44:47], v[140:143], v[48:51]
s_mov_b32 s60, 0x01000100
v_perm_b32 v240, v34, v34, s60
v_and_b32 v40, v240, v4
v_and_b32 v41, v240, v5
v_and_b32 v42, v240, v6
v_and_b32 v43, v240, v7
s_waitcnt vmcnt(11)
s_nop 0
v_mfma_f32_16x16x32_bf16 v[48:51], v[40:43], v[144:147], v[48:51]
s_mov_b32 s60, 0x03020302
v_perm_b32 v241, v34, v34, s60
v_and_b32 v44, v241, v4
v_and_b32 v45, v241, v5
v_and_b32 v46, v241, v6
v_and_b32 v47, v241, v7
s_waitcnt vmcnt(10)
s_nop 0
v_mfma_f32_16x16x32_bf16 v[48:51], v[44:47], v[148:151], v[48:51]
s_mov_b32 s60, 0x01000100
v_perm_b32 v240, v35, v35, s60
v_and_b32 v40, v240, v4
v_and_b32 v41, v240, v5
v_and_b32 v42, v240, v6
v_and_b32 v43, v240, v7
s_waitcnt vmcnt(9)
s_nop 0
v_mfma_f32_16x16x32_bf16 v[48:51], v[40:43], v[152:155], v[48:51]
s_mov_b32 s60, 0x03020302
v_perm_b32 v241, v35, v35, s60
v_and_b32 v44, v241, v4
v_and_b32 v45, v241, v5
v_and_b32 v46, v241, v6
v_and_b32 v47, v241, v7
s_waitcnt vmcnt(8)
s_nop 0
v_mfma_f32_16x16x32_bf16 v[48:51], v[44:47], v[156:159], v[48:51]
s_mov_b32 s60, 0x01000100
v_perm_b32 v240, v36, v36, s60
v_and_b32 v40, v240, v4
v_and_b32 v41, v240, v5
v_and_b32 v42, v240, v6
v_and_b32 v43, v240, v7
s_waitcnt vmcnt(7)
s_nop 0
v_mfma_f32_16x16x32_bf16 v[48:51], v[40:43], v[160:163], v[48:51]
s_mov_b32 s60, 0x03020302
v_perm_b32 v241, v36, v36, s60
v_and_b32 v44, v241, v4
v_and_b32 v45, v241, v5
v_and_b32 v46, v241, v6
v_and_b32 v47, v241, v7
s_waitcnt vmcnt(6)
s_nop 0
v_mfma_f32_16x16x32_bf16 v[48:51], v[44:47], v[164:167], v[48:51]
s_mov_b32 s60, 0x01000100
v_perm_b32 v240, v37, v37, s60
v_and_b32 v40, v240, v4
v_and_b32 v41, v240, v5
v_and_b32 v42, v240, v6
v_and_b32 v43, v240, v7
s_waitcnt vmcnt(5)
s_nop 0
v_mfma_f32_16x16x32_bf16 v[48:51], v[40:43], v[168:171], v[48:51]
s_mov_b32 s60, 0x03020302
v_perm_b32 v241, v37, v37, s60
v_and_b32 v44, v241, v4
v_and_b32 v45, v241, v5
v_and_b32 v46, v241, v6
v_and_b32 v47, v241, v7
s_waitcnt vmcnt(4)
s_nop 0
v_mfma_f32_16x16x32_bf16 v[48:51], v[44:47], v[172:175], v[48:51]
s_mov_b32 s60, 0x01000100
v_perm_b32 v240, v38, v38, s60
v_and_b32 v40, v240, v4
v_and_b32 v41, v240, v5
v_and_b32 v42, v240, v6
v_and_b32 v43, v240, v7
s_waitcnt vmcnt(3)
s_nop 0
v_mfma_f32_16x16x32_bf16 v[48:51], v[40:43], v[176:179], v[48:51]
s_mov_b32 s60, 0x03020302
v_perm_b32 v241, v38, v38, s60
v_and_b32 v44, v241, v4
v_and_b32 v45, v241, v5
v_and_b32 v46, v241, v6
v_and_b32 v47, v241, v7
s_waitcnt vmcnt(2)
s_nop 0
v_mfma_f32_16x16x32_bf16 v[48:51], v[44:47], v[180:183], v[48:51]
s_mov_b32 s60, 0x01000100
v_perm_b32 v240, v39, v39, s60
v_and_b32 v40, v240, v4
v_and_b32 v41, v240, v5
v_and_b32 v42, v240, v6
v_and_b32 v43, v240, v7
s_waitcnt vmcnt(1)
s_nop 0
v_mfma_f32_16x16x32_bf16 v[48:51], v[40:43], v[184:187], v[48:51]
s_mov_b32 s60, 0x03020302
v_perm_b32 v241, v39, v39, s60
v_and_b32 v44, v241, v4
v_and_b32 v45, v241, v5
v_and_b32 v46, v241, v6
v_and_b32 v47, v241, v7
s_waitcnt vmcnt(0)
s_nop 0
v_mfma_f32_16x16x32_bf16 v[48:51], v[44:47], v[188:191], v[48:51]
s_nop 7
ds_write_b128 v242, v[48:51]
s_waitcnt lgkmcnt(0)
s_barrier
s_cmp_lg_u32 s34, 0
s_cbranch_scc1 L_C_qs
ds_read_b128 v[128:131], v243 offset:0
ds_read_b128 v[132:135], v243 offset:1024
ds_read_b128 v[136:139], v243 offset:2048
ds_read_b128 v[140:143], v243 offset:3072
ds_read_b128 v[144:147], v243 offset:4096
ds_read_b128 v[148:151], v243 offset:5120
ds_read_b128 v[152:155], v243 offset:6144
ds_read_b128 v[156:159], v243 offset:7168
s_mov_b32 s60, 0x05040100
s_mov_b32 s61, 0x07060302
s_waitcnt lgkmcnt(6)
v_add_f32 v128, v128, v132
v_add_f32 v129, v129, v133
v_add_f32 v130, v130, v134
v_add_f32 v131, v131, v135
s_waitcnt lgkmcnt(5)
v_add_f32 v128, v128, v136
v_add_f32 v129, v129, v137
v_add_f32 v130, v130, v138
v_add_f32 v131, v131, v139
s_waitcnt lgkmcnt(4)
v_add_f32 v128, v128, v140
v_add_f32 v129, v129, v141
v_add_f32 v130, v130, v142
v_add_f32 v131, v131, v143
s_waitcnt lgkmcnt(3)
v_add_f32 v128, v128, v144
v_add_f32 v129, v129, v145
v_add_f32 v130, v130, v146
v_add_f32 v131, v131, v147
s_waitcnt lgkmcnt(2)
v_add_f32 v128, v128, v148
v_add_f32 v129, v129, v149
v_add_f32 v130, v130, v150
v_add_f32 v131, v131, v151
s_waitcnt lgkmcnt(1)
v_add_f32 v128, v128, v152
v_add_f32 v129, v129, v153
v_add_f32 v130, v130, v154
v_add_f32 v131, v131, v155
s_waitcnt lgkmcnt(0)
v_add_f32 v128, v128, v156
v_add_f32 v129, v129, v157
v_add_f32 v130, v130, v158
v_add_f32 v131, v131, v159
v_cvt_pk_bf16_f32 v128, v128, v129
v_cvt_pk_bf16_f32 v129, v130, v131
v_perm_b32 v132, v128, v245, s60
v_perm_b32 v133, v128, v245, s61
v_perm_b32 v134, v129, v245, s60
v_perm_b32 v135, v129, v245, s61
buffer_store_dwordx4 v[132:135], v244, s[44:47], 0 offen sc1
L_C_qs:
v_lshlrev_b32 v9, 4, v1
s_mul_i32 s62, s34, 4096
v_add_u32 v9, s62, v9
s_mul_i32 s38, s34, 4224
s_and_b32 s54, s32, 3
s_lshl_b32 s54, s54, 17
s_mov_b32 s53, 0
s_lshl_b32 s60, s32, 17
s_mov_b32 s61, 0x20000
s_add_u32 s68, s12, s60
s_addc_u32 s69, s13, 0
s_and_b32 s69, s69, 0xffff
s_mov_b32 s70, s61
s_mov_b32 s71, 0x20000
s_add_u32 s50, s38, 5120
s_cmp_lt_u32 s53, 0x80000
s_cselect_b32 s40, s40, s68
s_cselect_b32 s41, s41, s69
s_cselect_b32 s42, s42, s70
s_cselect_b32 s54, s54, 0
s_and_b32 s49, s53, 0x70000
s_xor_b32 s49, s49, s54
s_add_u32 s51, s49, 32768
s_add_u32 s53, s53, 0x10000
s_add_u32 m0, s50, 0
s_nop 0
buffer_load_dwordx4 v9, s[40:43], s49 offen offset:0 nt lds
s_add_u32 m0, s50, 32
s_nop 0
buffer_load_dwordx4 v9, s[40:43], s49 offen offset:1024 nt lds
s_add_u32 m0, s50, 64
s_nop 0
buffer_load_dwordx4 v9, s[40:43], s49 offen offset:2048 nt lds
s_add_u32 m0, s50, 96
s_nop 0
buffer_load_dwordx4 v9, s[40:43], s49 offen offset:3072 nt lds
s_add_u32 m0, s50, 33792
s_nop 0
buffer_load_dwordx4 v9, s[40:43], s51 offen offset:0 nt lds
s_add_u32 m0, s50, 33824
s_nop 0
buffer_load_dwordx4 v9, s[40:43], s51 offen offset:1024 nt lds
s_add_u32 m0, s50, 33856
s_nop 0
buffer_load_dwordx4 v9, s[40:43], s51 offen offset:2048 nt lds
s_add_u32 m0, s50, 33888
s_nop 0
buffer_load_dwordx4 v9, s[40:43], s51 offen offset:3072 nt lds
s_add_u32 s50, s38, 72704
s_cmp_lt_u32 s53, 0x80000
s_cselect_b32 s40, s40, s68
s_cselect_b32 s41, s41, s69
s_cselect_b32 s42, s42, s70
s_cselect_b32 s54, s54, 0
s_and_b32 s49, s53, 0x70000
s_xor_b32 s49, s49, s54
s_add_u32 s51, s49, 32768
s_add_u32 s53, s53, 0x10000
s_add_u32 m0, s50, 0
s_nop 0
buffer_load_dwordx4 v9, s[40:43], s49 offen offset:0 nt lds
s_add_u32 m0, s50, 32
s_nop 0
buffer_load_dwordx4 v9, s[40:43], s49 offen offset:1024 nt lds
s_add_u32 m0, s50, 64
s_nop 0
buffer_load_dwordx4 v9, s[40:43], s49 offen offset:2048 nt lds
s_add_u32 m0, s50, 96
s_nop 0
buffer_load_dwordx4 v9, s[40:43], s49 offen offset:3072 nt lds
s_add_u32 m0, s50, 33792
s_nop 0
buffer_load_dwordx4 v9, s[40:43], s51 offen offset:0 nt lds
s_add_u32 m0, s50, 33824
s_nop 0
buffer_load_dwordx4 v9, s[40:43], s51 offen offset:1024 nt lds
s_add_u32 m0, s50, 33856
s_nop 0
buffer_load_dwordx4 v9, s[40:43], s51 offen offset:2048 nt lds
s_add_u32 m0, s50, 33888
s_nop 0
buffer_load_dwordx4 v9, s[40:43], s51 offen offset:3072 nt lds
s_cmp_lt_u32 s53, 0x80000
s_cselect_b32 s40, s40, s68
s_cselect_b32 s41, s41, s69
s_cselect_b32 s42, s42, s70
s_cselect_b32 s54, s54, 0
s_and_b32 s49, s53, 0x70000
s_xor_b32 s49, s49, s54
s_add_u32 s51, s49, 32768
s_add_u32 s53, s53, 0x10000
buffer_load_dwordx4 v[208:211], v9, s[40:43], s49 offen offset:0 nt
buffer_load_dwordx4 v[212:215], v9, s[40:43], s49 offen offset:1024 nt
buffer_load_dwordx4 v[216:219], v9, s[40:43], s49 offen offset:2048 nt
buffer_load_dwordx4 v[220:223], v9, s[40:43], s49 offen offset:3072 nt
buffer_load_dwordx4 v[224:227], v9, s[40:43], s51 offen offset:0 nt
buffer_load_dwordx4 v[228:231], v9, s[40:43], s51 offen offset:1024 nt
buffer_load_dwordx4 v[232:235], v9, s[40:43], s51 offen offset:2048 nt
buffer_load_dwordx4 v[236:239], v9, s[40:43], s51 offen offset:3072 nt
s_add_u32 s62, s38, 5120
v_lshl_add_u32 v22, v1, 4, s62
s_lshl_b32 s62, s36, 4
v_add_u32 v240, s62, v2
v_mul_u32_u24 v10, 1056, v240
v_lshl_add_u32 v10, v3, 4, v10
v_add_u32 v10, 5120, v10
v_lshrrev_b32 v240, 1, v3
v_lshlrev_b32 v240, 3, v240
v_lshrrev_b32 v241, 2, v2
v_add_u32 v240, v240, v241
v_mul_u32_u24 v11, 1056, v240
v_and_b32 v240, 1, v3
v_lshl_add_u32 v11, v240, 5, v11
v_and_b32 v240, 3, v2
v_lshl_add_u32 v11, v240, 3, v11
s_lshl_b32 s62, s34, 7
s_add_u32 s62, s62, 5120
v_add_u32 v11, s62, v11
s_lshl_b32 s62, s37, 4
v_add_u32 v240, s62, v2
v_mul_u32_u24 v12, 144, v240
v_lshl_add_u32 v12, v3, 3, v12
s_lshl_b32 s62, s36, 5
v_add_u32 v12, s62, v12
v_lshlrev_b32 v15, 4, v240
s_lshl_b32 s62, s36, 2
v_add_u32 v14, s62, v15
v_and_b32 v240, 31, v1
v_mul_u32_u24 v13, 144, v240
v_lshrrev_b32 v241, 5, v1
v_lshl_add_u32 v13, v241, 4, v13
v_lshlrev_b32 v16, 4, v240
v_mov_b32 v17, 0x3e0293ee
v_mov_b32 v18, 0xff800000
v_mov_b32 v19, 0xff800000
v_mov_b32 v20, 0
v_mov_b32 v96, 0
v_mov_b32 v97, 0
v_mov_b32 v98, 0
v_mov_b32 v99, 0
v_mov_b32 v100, 0
v_mov_b32 v101, 0
v_mov_b32 v102, 0
v_mov_b32 v103, 0
v_mov_b32 v104, 0
v_mov_b32 v105, 0
v_mov_b32 v106, 0
v_mov_b32 v107, 0
v_mov_b32 v108, 0
v_mov_b32 v109, 0
v_mov_b32 v110, 0
v_mov_b32 v111, 0
v_mov_b32 v112, 0
v_mov_b32 v113, 0
v_mov_b32 v114, 0
v_mov_b32 v115, 0
v_mov_b32 v116, 0
v_mov_b32 v117, 0
v_mov_b32 v118, 0
v_mov_b32 v119, 0
v_mov_b32 v120, 0
v_mov_b32 v121, 0
v_mov_b32 v122, 0
v_mov_b32 v123, 0
v_mov_b32 v124, 0
v_mov_b32 v125, 0
v_mov_b32 v126, 0
v_mov_b32 v127, 0
v_lshrrev_b32 v240, 5, v1
s_lshl_b32 s62, s34, 2
v_add_u32 v240, s62, v240
v_and_b32 v241, 31, v1
v_lshlrev_b32 v241, 4, v241
v_lshl_add_u32 v242, v240, 10, v241
s_lshl_b32 s62, s35, 15
s_add_u32 s62, s62, 0x0
v_add_u32 v242, s62, v242
v_mul_u32_u24 v243, 528, v240
v_add_u32 v243, v243, v241
v_add_u32 v243, 140288, v243
s_lshl_b32 s62, s37, 4
v_add_u32 v240, s62, v2
v_mul_u32_u24 v244, 528, v240
v_lshl_add_u32 v244, v3, 4, v244
v_add_u32 v244, 140288, v244
v_lshlrev_b32 v240, 7, v1
v_add_u32 v240, 0x15000, v240
s_cmp_lg_u32 s34, 0
s_cbranch_scc1 L_wf_Cq
s_lshl_b64 exec, 1, s32
s_mov_b32 s64, 0
L_pl_Cq1:
buffer_load_dword v241, v240, s[44:47], 0 offen sc1
s_add_u32 s64, s64, 1
s_waitcnt vmcnt(0)
v_cmp_ne_u32 vcc, s58, v241
s_nop 0
s_cmp_eq_u64 vcc, 0
s_cbranch_scc1 L_pd_Cq1
s_mov_b64 exec, vcc
s_sleep 2
s_cmp_lt_u32 s64, 65536
s_cbranch_scc1 L_pl_Cq1
L_pd_Cq1:
s_mov_b32 exec_lo, -1
s_mov_b32 exec_hi, 0
s_mov_b32 s64, 0
L_pl_Cq2:
buffer_load_dword v241, v240, s[44:47], 0 offen sc1
s_add_u32 s64, s64, 1
s_waitcnt vmcnt(0)
v_cmp_ne_u32 vcc, s58, v241
s_nop 0
s_cmp_eq_u64 vcc, 0
s_cbranch_scc1 L_pd_Cq2
s_mov_b64 exec, vcc
s_cmp_lt_u32 s64, 65536
s_cbranch_scc1 L_pl_Cq2
L_pd_Cq2:
s_mov_b64 exec, -1
L_wf_Cq:
s_barrier
buffer_load_dwordx4 v[128:131], v242, s[44:47], 0 offen offset:0 sc1
buffer_load_dwordx4 v[132:135], v242, s[44:47], 0 offen offset:2048 sc1
buffer_load_dwordx4 v[136:139], v242, s[44:47], 0 offen offset:512 sc1
buffer_load_dwordx4 v[140:143], v242, s[44:47], 0 offen offset:2560 sc1
s_waitcnt vmcnt(2)
ds_write_b128 v243, v[128:131] offset:0
ds_write_b128 v243, v[132:135] offset:1056
s_waitcnt lgkmcnt(0)
s_barrier
ds_read_b128 v[32:35], v244 offset:0
ds_read_b128 v[36:39], v244 offset:64
ds_read_b128 v[40:43], v244 offset:128
ds_read_b128 v[44:47], v244 offset:192
ds_read_b128 v[48:51], v244 offset:256
ds_read_b128 v[52:55], v244 offset:320
ds_read_b128 v[56:59], v244 offset:384
ds_read_b128 v[60:63], v244 offset:448
s_waitcnt vmcnt(0)
s_waitcnt lgkmcnt(0)
s_barrier
ds_write_b128 v243, v[136:139] offset:0
ds_write_b128 v243, v[140:143] offset:1056
s_waitcnt lgkmcnt(0)
s_barrier
ds_read_b128 v[64:67], v244 offset:0
ds_read_b128 v[68:71], v244 offset:64
ds_read_b128 v[72:75], v244 offset:128
ds_read_b128 v[76:79], v244 offset:192
ds_read_b128 v[80:83], v244 offset:256
ds_read_b128 v[84:87], v244 offset:320
ds_read_b128 v[88:91], v244 offset:384
ds_read_b128 v[92:95], v244 offset:448
s_mov_b32 s39, 0
s_mov_b32 s48, 0
s_waitcnt vmcnt(0)
.p2align 6
L_C_loop:
s_waitcnt lgkmcnt(0)
s_barrier
s_mov_b32 s52, 1
s_cmp_eq_u32 s39, 0
s_cselect_b32 s52, 0, s52
s_sub_u32 s50, 67584, s48
v_add_u32 v23, s50, v22
s_cmp_eq_u32 s52, 0
s_cbranch_scc1 L_C_st0
s_cmp_lt_u32 s53, 0x80000
s_cselect_b32 s40, s40, s68
s_cselect_b32 s41, s41, s69
s_cselect_b32 s42, s42, s70
s_cselect_b32 s54, s54, 0
s_and_b32 s49, s53, 0x70000
s_xor_b32 s49, s49, s54
s_add_u32 s51, s49, 32768
s_add_u32 s53, s53, 0x10000
s_waitcnt vmcnt(7)
ds_write_b128 v23, v[208:211] offset:0
buffer_load_dwordx4 v[208:211], v9, s[40:43], s49 offen offset:0 nt
s_waitcnt vmcnt(7)
ds_write_b128 v23, v[212:215] offset:1056
buffer_load_dwordx4 v[212:215], v9, s[40:43], s49 offen offset:1024 nt
s_waitcnt vmcnt(7)
ds_write_b128 v23, v[216:219] offset:2112
buffer_load_dwordx4 v[216:219], v9, s[40:43], s49 offen offset:2048 nt
s_waitcnt vmcnt(7)
ds_write_b128 v23, v[220:223] offset:3168
buffer_load_dwordx4 v[220:223], v9, s[40:43], s49 offen offset:3072 nt
s_waitcnt vmcnt(7)
ds_write_b128 v23, v[224:227] offset:33792
buffer_load_dwordx4 v[224:227], v9, s[40:43], s51 offen offset:0 nt
s_waitcnt vmcnt(7)
ds_write_b128 v23, v[228:231] offset:34848
buffer_load_dwordx4 v[228:231], v9, s[40:43], s51 offen offset:1024 nt
s_waitcnt vmcnt(7)
ds_write_b128 v23, v[232:235] offset:35904
buffer_load_dwordx4 v[232:235], v9, s[40:43], s51 offen offset:2048 nt
s_waitcnt vmcnt(7)
ds_write_b128 v23, v[236:239] offset:36960
buffer_load_dwordx4 v[236:239], v9, s[40:43], s51 offen offset:3072 nt
L_C_st0:
v_add_u32 v240, s48, v10
v_add_u32 v241, s48, v11
ds_read_b128 v[128:131], v240 offset:0
ds_read_b128 v[132:135], v240 offset:64
ds_read_b128 v[136:139], v240 offset:128
ds_read_b128 v[140:143], v240 offset:192
ds_read_b128 v[144:147], v240 offset:256
ds_read_b128 v[148:151], v240 offset:320
ds_read_b128 v[152:155], v240 offset:384
ds_read_b128 v[156:159], v240 offset:448
ds_read_b128 v[160:163], v240 offset:512
ds_read_b128 v[164:167], v240 offset:576
ds_read_b128 v[168:171], v240 offset:640
ds_read_b128 v[172:175], v240 offset:704
ds_read_b128 v[176:179], v240 offset:768
ds_read_b128 v[180:183], v240 offset:832
ds_read_b128 v[184:187], v240 offset:896
ds_read_b128 v[188:191], v240 offset:960
s_waitcnt lgkmcnt(15)
v_mfma_f32_16x16x32_bf16 v[28:31], v[128:131], v[32:35], 0
s_waitcnt lgkmcnt(14)
v_mfma_f32_16x16x32_bf16 v[28:31], v[132:135], v[36:39], v[28:31]
s_waitcnt lgkmcnt(13)
v_mfma_f32_16x16x32_bf16 v[28:31], v[136:139], v[40:43], v[28:31]
s_waitcnt lgkmcnt(12)
v_mfma_f32_16x16x32_bf16 v[28:31], v[140:143], v[44:47], v[28:31]
s_waitcnt lgkmcnt(11)
v_mfma_f32_16x16x32_bf16 v[28:31], v[144:147], v[48:51], v[28:31]
s_waitcnt lgkmcnt(10)
v_mfma_f32_16x16x32_bf16 v[28:31], v[148:151], v[52:55], v[28:31]
s_waitcnt lgkmcnt(9)
v_mfma_f32_16x16x32_bf16 v[28:31], v[152:155], v[56:59], v[28:31]
s_waitcnt lgkmcnt(8)
v_mfma_f32_16x16x32_bf16 v[28:31], v[156:159], v[60:63], v[28:31]
s_waitcnt lgkmcnt(7)
v_mfma_f32_16x16x32_bf16 v[28:31], v[160:163], v[64:67], v[28:31]
s_waitcnt lgkmcnt(6)
v_mfma_f32_16x16x32_bf16 v[28:31], v[164:167], v[68:71], v[28:31]
s_waitcnt lgkmcnt(5)
v_mfma_f32_16x16x32_bf16 v[28:31], v[168:171], v[72:75], v[28:31]
s_waitcnt lgkmcnt(4)
v_mfma_f32_16x16x32_bf16 v[28:31], v[172:175], v[76:79], v[28:31]
s_waitcnt lgkmcnt(3)
v_mfma_f32_16x16x32_bf16 v[28:31], v[176:179], v[80:83], v[28:31]
s_waitcnt lgkmcnt(2)
v_mfma_f32_16x16x32_bf16 v[28:31], v[180:183], v[84:87], v[28:31]
s_waitcnt lgkmcnt(1)
v_mfma_f32_16x16x32_bf16 v[28:31], v[184:187], v[88:91], v[28:31]
s_waitcnt lgkmcnt(0)
v_mfma_f32_16x16x32_bf16 v[28:31], v[188:191], v[92:95], v[28:31]
s_nop 7
v_mul_f32 v24, v28, v17
v_mul_f32 v25, v29, v17
v_mul_f32 v26, v30, v17
v_mul_f32 v27, v31, v17
v_max3_f32 v242, v24, v25, v26
v_max_f32 v242, v242, v27
v_mov_b32 v243, v242
s_nop 1
v_permlane16_swap_b32 v242, v243
s_nop 0
v_max_f32 v242, v242, v243
v_mov_b32 v243, v242
s_nop 1
v_permlane32_swap_b32 v242, v243
s_nop 0
v_max_f32 v242, v242, v243
s_mov_b64 exec, 0xffff
ds_write_b32 v14, v242 offset:0
s_mov_b64 exec, -1
s_waitcnt lgkmcnt(0)
s_barrier
ds_read_b128 v[192:195], v15 offset:0
ds_read_b128 v[196:199], v16 offset:0
s_waitcnt lgkmcnt(1)
v_max3_f32 v242, v192, v193, v194
v_max3_f32 v242, v242, v195, v18
v_sub_f32 v21, v18, v242
v_sub_f32 v24, v24, v242
v_sub_f32 v25, v25, v242
v_sub_f32 v26, v26, v242
v_sub_f32 v27, v27, v242
v_exp_f32 v21, v21
v_exp_f32 v24, v24
v_exp_f32 v25, v25
v_exp_f32 v26, v26
v_exp_f32 v27, v27
v_mov_b32 v18, v242
v_cvt_pk_bf16_f32 v244, v24, v25
v_cvt_pk_bf16_f32 v245, v26, v27
ds_write_b64 v12, v[244:245] offset:512
v_add_f32 v24, v24, v25
v_add_f32 v26, v26, v27
v_fma_f32 v20, v20, v21, v24
v_add_f32 v20, v20, v26
s_waitcnt lgkmcnt(1)
v_max3_f32 v242, v196, v197, v198
v_max3_f32 v242, v242, v199, v19
v_sub_f32 v21, v19, v242
v_exp_f32 v21, v21
v_mov_b32 v19, v242
v_mul_f32 v96, v96, v21
v_mul_f32 v97, v97, v21
v_mul_f32 v98, v98, v21
v_mul_f32 v99, v99, v21
v_mul_f32 v100, v100, v21
v_mul_f32 v101, v101, v21
v_mul_f32 v102, v102, v21
v_mul_f32 v103, v103, v21
v_mul_f32 v104, v104, v21
v_mul_f32 v105, v105, v21
v_mul_f32 v106, v106, v21
v_mul_f32 v107, v107, v21
v_mul_f32 v108, v108, v21
v_mul_f32 v109, v109, v21
v_mul_f32 v110, v110, v21
v_mul_f32 v111, v111, v21
v_mul_f32 v112, v112, v21
v_mul_f32 v113, v113, v21
v_mul_f32 v114, v114, v21
v_mul_f32 v115, v115, v21
v_mul_f32 v116, v116, v21
v_mul_f32 v117, v117, v21
v_mul_f32 v118, v118, v21
v_mul_f32 v119, v119, v21
v_mul_f32 v120, v120, v21
v_mul_f32 v121, v121, v21
v_mul_f32 v122, v122, v21
v_mul_f32 v123, v123, v21
v_mul_f32 v124, v124, v21
v_mul_f32 v125, v125, v21
v_mul_f32 v126, v126, v21
v_mul_f32 v127, v127, v21
s_waitcnt lgkmcnt(0)
s_barrier
ds_read_b128 v[192:195], v13 offset:512
ds_read_b128 v[196:199], v13 offset:544
ds_read_b128 v[200:203], v13 offset:576
ds_read_b128 v[204:207], v13 offset:608
ds_read_b64_tr_b16 v[128:129], v241 offset:0
ds_read_b64_tr_b16 v[130:131], v241 offset:4224
ds_read_b64_tr_b16 v[132:133], v241 offset:64
ds_read_b64_tr_b16 v[134:135], v241 offset:4288
ds_read_b64_tr_b16 v[136:137], v241 offset:16896
ds_read_b64_tr_b16 v[138:139], v241 offset:21120
ds_read_b64_tr_b16 v[140:141], v241 offset:16960
ds_read_b64_tr_b16 v[142:143], v241 offset:21184
ds_read_b64_tr_b16 v[144:145], v241 offset:33792
ds_read_b64_tr_b16 v[146:147], v241 offset:38016
ds_read_b64_tr_b16 v[148:149], v241 offset:33856
ds_read_b64_tr_b16 v[150:151], v241 offset:38080
ds_read_b64_tr_b16 v[152:153], v241 offset:50688
ds_read_b64_tr_b16 v[154:155], v241 offset:54912
ds_read_b64_tr_b16 v[156:157], v241 offset:50752
ds_read_b64_tr_b16 v[158:159], v241 offset:54976
s_waitcnt lgkmcnt(12)
v_mfma_f32_32x32x16_bf16 v[96:111], v[128:131], v[192:195], v[96:111]
v_mfma_f32_32x32x16_bf16 v[112:127], v[132:135], v[192:195], v[112:127]
s_waitcnt lgkmcnt(8)
v_mfma_f32_32x32x16_bf16 v[96:111], v[136:139], v[196:199], v[96:111]
v_mfma_f32_32x32x16_bf16 v[112:127], v[140:143], v[196:199], v[112:127]
s_waitcnt lgkmcnt(4)
v_mfma_f32_32x32x16_bf16 v[96:111], v[144:147], v[200:203], v[96:111]
v_mfma_f32_32x32x16_bf16 v[112:127], v[148:151], v[200:203], v[112:127]
s_waitcnt lgkmcnt(0)
v_mfma_f32_32x32x16_bf16 v[96:111], v[152:155], v[204:207], v[96:111]
v_mfma_f32_32x32x16_bf16 v[112:127], v[156:159], v[204:207], v[112:127]
s_sub_u32 s48, 67584, s48
s_add_u32 s39, s39, 1
s_cmp_lt_u32 s39, 8
s_cbranch_scc1 L_C_loop
v_mov_b32 v243, v20
s_nop 1
v_permlane16_swap_b32 v20, v243
s_nop 0
v_add_f32 v20, v20, v243
v_mov_b32 v243, v20
s_nop 1
v_permlane32_swap_b32 v20, v243
s_nop 0
v_add_f32 v20, v20, v243
s_barrier
s_mov_b64 exec, 0xffff
ds_write_b32 v14, v20 offset:0
s_mov_b64 exec, -1
v_and_b32 v240, 31, v1
v_mul_u32_u24 v240, 2064, v240
v_lshrrev_b32 v241, 5, v1
v_lshl_add_u32 v240, v241, 4, v240
s_lshl_b32 s62, s34, 8
s_add_u32 s62, s62, 72704
v_add_u32 v240, s62, v240
s_nop 5
ds_write_b128 v240, v[96:99] offset:0
ds_write_b128 v240, v[100:103] offset:32
ds_write_b128 v240, v[104:107] offset:64
ds_write_b128 v240, v[108:111] offset:96
ds_write_b128 v240, v[112:115] offset:128
ds_write_b128 v240, v[116:119] offset:160
ds_write_b128 v240, v[120:123] offset:192
ds_write_b128 v240, v[124:127] offset:224
s_waitcnt lgkmcnt(0)
s_barrier
s_mul_i32 s62, s34, 8256
s_add_u32 s62, s62, 72704
v_lshl_add_u32 v240, v1, 5, s62
ds_read_b128 v[128:131], v240 offset:0
ds_read_b128 v[132:135], v240 offset:16
ds_read_b128 v[136:139], v240 offset:2064
ds_read_b128 v[140:143], v240 offset:2080
ds_read_b128 v[144:147], v240 offset:4128
ds_read_b128 v[148:151], v240 offset:4144
ds_read_b128 v[152:155], v240 offset:6192
ds_read_b128 v[156:159], v240 offset:6208
ds_read_b128 v[192:195], v16 offset:0
s_lshl_b32 s62, s35, 5
s_lshl_b32 s63, s34, 2
s_add_u32 s62, s62, s63
s_lshl_b32 s62, s62, 4
s_and_b32 s63, s32, 15
s_add_u32 s62, s62, s63
s_lshl_b32 s62, s62, 10
s_add_u32 s62, s62, 0x200000
v_lshl_add_u32 v17, v1, 4, s62
s_lshl_b32 s63, s32, 9
s_add_u32 s63, s63, 0x10000
v_lshl_add_u32 v18, v1, 4, s63
v_mov_b32 v241, 0xffff0000
s_waitcnt lgkmcnt(0)
v_add_f32 v192, v192, v193
v_add_f32 v194, v194, v195
v_add_f32 v196, v192, v194
v_and_or_b32 v200, v19, v241, s76
v_lshl_or_b32 v201, v19, 16, s77
v_and_or_b32 v202, v196, v241, s78
v_lshl_or_b32 v203, v196, 16, s79
s_waitcnt vmcnt(0)
s_barrier
L_C_tail:
v_add_u32 v23, 67584, v22
ds_write_b128 v23, v[208:211] offset:0
ds_write_b128 v23, v[212:215] offset:1056
ds_write_b128 v23, v[216:219] offset:2112
ds_write_b128 v23, v[220:223] offset:3168
ds_write_b128 v23, v[224:227] offset:33792
ds_write_b128 v23, v[228:231] offset:34848
ds_write_b128 v23, v[232:235] offset:35904
ds_write_b128 v23, v[236:239] offset:36960
v_lshrrev_b32 v240, 2, v2
v_lshl_add_u32 v240, v3, 3, v240
v_mul_u32_u24 v240, 1056, v240
v_and_b32 v241, 3, v2
v_lshl_add_u32 v240, v241, 3, v240
s_lshl_b32 s62, s34, 7
s_add_u32 s62, s62, 5120
v_add_u32 v240, s62, v240
s_waitcnt lgkmcnt(0)
v_cvt_pk_bf16_f32 v224, v128, v129
v_cvt_pk_bf16_f32 v225, v130, v131
v_cvt_pk_bf16_f32 v226, v132, v133
v_cvt_pk_bf16_f32 v227, v134, v135
v_cvt_pk_bf16_f32 v228, v136, v137
v_cvt_pk_bf16_f32 v229, v138, v139
v_cvt_pk_bf16_f32 v230, v140, v141
v_cvt_pk_bf16_f32 v231, v142, v143
v_cvt_pk_bf16_f32 v232, v144, v145
v_cvt_pk_bf16_f32 v233, v146, v147
v_cvt_pk_bf16_f32 v234, v148, v149
v_cvt_pk_bf16_f32 v235, v150, v151
v_cvt_pk_bf16_f32 v236, v152, v153
v_cvt_pk_bf16_f32 v237, v154, v155
v_cvt_pk_bf16_f32 v238, v156, v157
v_cvt_pk_bf16_f32 v239, v158, v159
s_barrier
ds_read_b64_tr_b16 v[32:33], v240 offset:0
ds_read_b64_tr_b16 v[34:35], v240 offset:4224
ds_read_b64_tr_b16 v[36:37], v240 offset:32
ds_read_b64_tr_b16 v[38:39], v240 offset:4256
ds_read_b64_tr_b16 v[40:41], v240 offset:64
ds_read_b64_tr_b16 v[42:43], v240 offset:4288
ds_read_b64_tr_b16 v[44:45], v240 offset:96
ds_read_b64_tr_b16 v[46:47], v240 offset:4320
s_waitcnt lgkmcnt(0)
v_add_u32 v240, 33792, v240
ds_read_b64_tr_b16 v[48:49], v240 offset:0
ds_read_b64_tr_b16 v[50:51], v240 offset:4224
ds_read_b64_tr_b16 v[52:53], v240 offset:32
ds_read_b64_tr_b16 v[54:55], v240 offset:4256
ds_read_b64_tr_b16 v[56:57], v240 offset:64
ds_read_b64_tr_b16 v[58:59], v240 offset:4288
ds_read_b64_tr_b16 v[60:61], v240 offset:96
ds_read_b64_tr_b16 v[62:63], v240 offset:4320
s_waitcnt lgkmcnt(0)
v_add_u32 v240, 33792, v240
ds_read_b64_tr_b16 v[64:65], v240 offset:0
ds_read_b64_tr_b16 v[66:67], v240 offset:4224
ds_read_b64_tr_b16 v[68:69], v240 offset:32
ds_read_b64_tr_b16 v[70:71], v240 offset:4256
ds_read_b64_tr_b16 v[72:73], v240 offset:64
ds_read_b64_tr_b16 v[74:75], v240 offset:4288
ds_read_b64_tr_b16 v[76:77], v240 offset:96
ds_read_b64_tr_b16 v[78:79], v240 offset:4320
s_waitcnt lgkmcnt(0)
v_add_u32 v240, 33792, v240
ds_read_b64_tr_b16 v[80:81], v240 offset:0
ds_read_b64_tr_b16 v[82:83], v240 offset:4224
ds_read_b64_tr_b16 v[84:85], v240 offset:32
ds_read_b64_tr_b16 v[86:87], v240 offset:4256
ds_read_b64_tr_b16 v[88:89], v240 offset:64
ds_read_b64_tr_b16 v[90:91], v240 offset:4288
ds_read_b64_tr_b16 v[92:93], v240 offset:96
ds_read_b64_tr_b16 v[94:95], v240 offset:4320
s_waitcnt lgkmcnt(0)
v_bfe_u32 v10, v1, 2, 3
v_lshlrev_b32 v10, 11, v10
v_and_b32 v241, 3, v1
v_lshrrev_b32 v11, 5, v1
v_lshl_add_u32 v241, v11, 2, v241
v_lshl_add_u32 v10, v241, 4, v10
s_lshr_b32 s62, s32, 4
s_and_b32 s63, s32, 15
s_lshl_b32 s60, s62, 16
s_lshl_b32 s61, s63, 7
s_add_u32 s60, s60, s61
s_add_u32 s60, s60, 0x40000
v_add_u32 v10, s60, v10
s_lshl_b32 s60, s62, 11
s_lshl_b32 s61, s63, 6
s_add_u32 s60, s60, s61
s_add_u32 s60, s60, 0
v_lshl_add_u32 v11, v241, 3, s60
v_and_b32 v9, 7, v2
v_lshlrev_b32 v9, 10, v9
v_lshrrev_b32 v241, 3, v2
v_mul_u32_u24 v242, 512, v241
v_add_u32 v9, v9, v242
v_lshl_add_u32 v9, v3, 4, v9
s_lshl_b32 s62, s32, 13
s_add_u32 s62, s62, 0x60000
s_lshl_b32 s63, s34, 6
s_add_u32 s63, s63, s62
v_add_u32 v9, s63, v9
v_mul_u32_u24 v12, 272, v241
v_lshl_add_u32 v12, v3, 3, v12
s_lshl_b32 s62, s34, 5
v_add_u32 v12, s62, v12
v_and_b32 v241, 1, v2
v_mul_u32_u24 v13, 272, v241
v_lshl_add_u32 v13, v3, 4, v13
v_lshlrev_b32 v14, 16, v241
v_bfe_u32 v241, v2, 1, 2
v_lshl_add_u32 v14, v241, 6, v14
v_lshl_add_u32 v14, v3, 4, v14
s_lshl_b32 s62, s32, 11
s_lshl_b32 s63, s34, 8
s_add_u32 s62, s62, s63
s_add_u32 s62, s62, 0x40000
v_add_u32 v14, s62, v14
s_mov_b32 s82, 0xc0c0c0c
s_mov_b32 s83, 0xc0c0c0c
s_mov_b32 s84, 0x30303030
s_mov_b32 s85, 0x30303030
s_mov_b32 s86, 0xc0c0c0c0
s_mov_b32 s87, 0xc0c0c0c0
v_mov_b32 v15, 0xffffff00
s_mov_b32 s60, 0x0c0c0501
s_mov_b32 s61, 0x05010c0c
s_mov_b32 s53, 65536
s_branch L_C_merge
L_C_poll:
v_mov_b32 v96, 0
v_mov_b32 v97, 0
v_mov_b32 v98, 0x8000
v_mov_b32 v99, 0xff00
s_cmp_lg_u32 s34, 0
s_cbranch_scc1 L_Ch_d
s_lshl_b32 s62, s32, 13
s_add_u32 s62, s62, 0x61800
v_lshl_add_u32 v241, v1, 7, s62
s_mov_b64 exec, 1
s_mov_b32 s64, 0
L_pl_Ch:
buffer_load_dword v240, v241, s[44:47], 0 offen offset:1024 sc1
s_add_u32 s64, s64, 1
s_waitcnt vmcnt(0)
v_cmp_gt_i32 vcc, 0, v240
s_nop 0
s_cmp_eq_u64 vcc, 0
s_cbranch_scc1 L_pd_Ch
s_mov_b64 exec, vcc
s_sleep 2
s_cmp_lt_u32 s64, 65536
s_cbranch_scc1 L_pl_Ch
L_pd_Ch:
s_mov_b64 exec, -1
L_Ch_d:
s_barrier
s_mov_b32 s63, 0
buffer_store_dwordx4 v[224:227], v17, s[44:47], s63 offen sc1
s_mov_b32 s63, 16384
buffer_store_dwordx4 v[228:231], v17, s[44:47], s63 offen sc1
s_mov_b32 s63, 32768
buffer_store_dwordx4 v[232:235], v17, s[44:47], s63 offen sc1
s_mov_b32 s63, 49152
buffer_store_dwordx4 v[236:239], v17, s[44:47], s63 offen sc1
s_waitcnt vmcnt(0)
s_barrier
s_cmp_lg_u32 s34, 0
s_cbranch_scc1 L_C_nostat
s_mov_b32 exec_hi, 0
buffer_store_dwordx4 v[200:203], v18, s[44:47], 0 offen sc1
s_mov_b64 exec, -1
L_C_nostat:
s_cmp_lg_u32 s34, 0
s_cbranch_scc1 L_Cg_d
s_lshl_b32 s62, s32, 13
s_add_u32 s62, s62, 0x61800
v_lshl_add_u32 v241, v1, 7, s62
s_mov_b64 exec, 1
s_mov_b32 s64, 0
L_pl_Cg:
buffer_load_dword v240, v241, s[44:47], 0 offen offset:1024 sc1
s_add_u32 s64, s64, 1
s_waitcnt vmcnt(0)
v_cmp_gt_i32 vcc, 1, v240
s_nop 0
s_cmp_eq_u64 vcc, 0
s_cbranch_scc1 L_pd_Cg
s_mov_b64 exec, vcc
s_sleep 2
s_cmp_lt_u32 s64, 65536
s_cbranch_scc1 L_pl_Cg
L_pd_Cg:
s_mov_b64 exec, -1
L_Cg_d:
s_barrier
s_mov_b32 exec_lo, 0x3f3f3f3f
s_mov_b32 exec_hi, 0x3f3f3f3f
s_mov_b32 s64, 0
s_mov_b32 s66, 0x1000
s_mov_b32 s67, 0x2000
buffer_load_dwordx4 v[208:211], v9, s[44:47], 0 offen sc1
L_ps_Co:
s_waitcnt vmcnt(0)
v_xor_b32 v96, s76, v208
v_xor_b32 v97, s77, v209
v_xor_b32 v98, s78, v210
v_xor_b32 v99, s79, v211
v_or_b32 v240, v96, v97
v_or3_b32 v240, v240, v98, v99
v_and_b32 v240, 0xff, v240
v_cmp_ne_u32 vcc, 0, v240
s_cmp_eq_u64 vcc, 0
s_cbranch_scc1 L_pe_Co
buffer_load_dwordx4 v[208:211], v9, s[44:47], 0 offen sc1
s_add_u32 s64, s64, 1
s_cmp_lt_u32 s64, 65536
s_cbranch_scc1 L_ps_Co
L_pe_Co:
s_mov_b64 exec, -1
L_C_merge:
v_perm_b32 v100, v97, v96, s60
v_perm_b32 v101, v99, v98, s61
v_or_b32 v100, v100, v101
v_and_b32 v96, 0xffff0000, v96
v_and_b32 v97, 0xffff0000, v97
v_max_f32_dpp v101, v100, v100 quad_perm:[1,0,3,2] row_mask:0xf bank_mask:0xf
v_and_b32 v98, 0xffff0000, v98
v_and_b32 v99, 0xffff0000, v99
v_max_f32_dpp v101, v101, v101 quad_perm:[2,3,0,1] row_mask:0xf bank_mask:0xf
s_nop 1
v_max_f32_dpp v101, v101, v101 row_half_mirror row_mask:0xf bank_mask:0xf
v_sub_f32 v100, v100, v101
v_exp_f32 v100, v100
s_nop 0
v_mul_f32 v96, v96, v100
v_mul_f32 v97, v97, v100
v_mul_f32 v98, v98, v100
v_mul_f32 v99, v99, v100
v_add_f32_dpp v100, v100, v100 quad_perm:[1,0,3,2] row_mask:0xf bank_mask:0xf
v_add_f32_dpp v96, v96, v96 quad_perm:[1,0,3,2] row_mask:0xf bank_mask:0xf
v_add_f32_dpp v97, v97, v97 quad_perm:[1,0,3,2] row_mask:0xf bank_mask:0xf
v_add_f32_dpp v98, v98, v98 quad_perm:[1,0,3,2] row_mask:0xf bank_mask:0xf
v_add_f32_dpp v99, v99, v99 quad_perm:[1,0,3,2] row_mask:0xf bank_mask:0xf
v_add_f32_dpp v100, v100, v100 quad_perm:[2,3,0,1] row_mask:0xf bank_mask:0xf
v_add_f32_dpp v96, v96, v96 quad_perm:[2,3,0,1] row_mask:0xf bank_mask:0xf
v_add_f32_dpp v97, v97, v97 quad_perm:[2,3,0,1] row_mask:0xf bank_mask:0xf
v_add_f32_dpp v98, v98, v98 quad_perm:[2,3,0,1] row_mask:0xf bank_mask:0xf
v_add_f32_dpp v99, v99, v99 quad_perm:[2,3,0,1] row_mask:0xf bank_mask:0xf
v_add_f32_dpp v100, v100, v100 row_half_mirror row_mask:0xf bank_mask:0xf
v_add_f32_dpp v96, v96, v96 row_half_mirror row_mask:0xf bank_mask:0xf
v_add_f32_dpp v97, v97, v97 row_half_mirror row_mask:0xf bank_mask:0xf
v_add_f32_dpp v98, v98, v98 row_half_mirror row_mask:0xf bank_mask:0xf
v_add_f32_dpp v99, v99, v99 row_half_mirror row_mask:0xf bank_mask:0xf
v_rcp_f32 v100, v100
s_mov_b32 exec_lo, 0x01010101
s_mov_b32 exec_hi, 0x01010101
v_mul_f32 v96, v96, v100
v_mul_f32 v97, v97, v100
v_mul_f32 v98, v98, v100
v_mul_f32 v99, v99, v100
v_cvt_pk_bf16_f32 v96, v96, v97
v_cvt_pk_bf16_f32 v97, v98, v99
ds_write_b64 v12, v[96:97] offset:0
s_mov_b64 exec, -1
s_waitcnt lgkmcnt(0)
s_barrier
ds_read_b128 v[104:107], v13 offset:0
ds_read_b128 v[108:111], v13 offset:64
ds_read_b128 v[112:115], v13 offset:128
ds_read_b128 v[116:119], v13 offset:192
s_waitcnt lgkmcnt(3)
v_mfma_f32_16x16x32_bf16 v[128:131], v[32:35], v[104:107], 0
v_mfma_f32_16x16x32_bf16 v[132:135], v[36:39], v[104:107], 0
v_mfma_f32_16x16x32_bf16 v[136:139], v[40:43], v[104:107], 0
v_mfma_f32_16x16x32_bf16 v[140:143], v[44:47], v[104:107], 0
s_waitcnt lgkmcnt(2)
v_mfma_f32_16x16x32_bf16 v[128:131], v[48:51], v[108:111], v[128:131]
v_mfma_f32_16x16x32_bf16 v[132:135], v[52:55], v[108:111], v[132:135]
v_mfma_f32_16x16x32_bf16 v[136:139], v[56:59], v[108:111], v[136:139]
v_mfma_f32_16x16x32_bf16 v[140:143], v[60:63], v[108:111], v[140:143]
s_waitcnt lgkmcnt(1)
v_mfma_f32_16x16x32_bf16 v[128:131], v[64:67], v[112:115], v[128:131]
v_mfma_f32_16x16x32_bf16 v[132:135], v[68:71], v[112:115], v[132:135]
v_mfma_f32_16x16x32_bf16 v[136:139], v[72:75], v[112:115], v[136:139]
v_mfma_f32_16x16x32_bf16 v[140:143], v[76:79], v[112:115], v[140:143]
s_waitcnt lgkmcnt(0)
v_mfma_f32_16x16x32_bf16 v[128:131], v[80:83], v[116:119], v[128:131]
v_mfma_f32_16x16x32_bf16 v[132:135], v[84:87], v[116:119], v[132:135]
v_mfma_f32_16x16x32_bf16 v[136:139], v[88:91], v[116:119], v[136:139]
v_mfma_f32_16x16x32_bf16 v[140:143], v[92:95], v[116:119], v[140:143]
s_mov_b32 s64, s53
s_nop 4
v_cndmask_b32 v128, v128, v132, s[82:83]
v_cndmask_b32 v129, v129, v133, s[82:83]
v_cndmask_b32 v130, v130, v134, s[82:83]
v_cndmask_b32 v131, v131, v135, s[82:83]
v_cndmask_b32 v128, v128, v136, s[84:85]
v_cndmask_b32 v129, v129, v137, s[84:85]
v_cndmask_b32 v130, v130, v138, s[84:85]
v_cndmask_b32 v131, v131, v139, s[84:85]
v_cndmask_b32 v128, v128, v140, s[86:87]
v_cndmask_b32 v129, v129, v141, s[86:87]
v_cndmask_b32 v130, v130, v142, s[86:87]
v_cndmask_b32 v131, v131, v143, s[86:87]
v_add_u32 v128, 0x80, v128
v_add_u32 v129, 0x80, v129
v_add_u32 v130, 0x80, v130
v_add_u32 v131, 0x80, v131
v_and_or_b32 v128, v128, v15, s76
v_and_or_b32 v129, v129, v15, s77
v_and_or_b32 v130, v130, v15, s78
v_and_or_b32 v131, v131, v15, s79
s_cmp_lg_u32 s53, 0
s_cbranch_scc1 L_C_nost
s_mov_b32 exec_lo, 0x00ff00ff
s_mov_b32 exec_hi, 0x00ff00ff
buffer_store_dwordx4 v[128:131], v14, s[44:47], 0 offen sc1
s_mov_b64 exec, -1
L_C_nost:
s_cmp_lg_u32 s34, 4
s_cbranch_scc1 L_C_end
s_mov_b32 s66, 0x4000
s_mov_b32 s67, 0x8000
s_mov_b32 s65, 0xc000
buffer_load_dwordx4 v[144:147], v10, s[44:47], 0 offen sc1
buffer_load_dwordx4 v[148:151], v10, s[44:47], s66 offen sc1
buffer_load_dwordx4 v[152:155], v10, s[44:47], s67 offen sc1
buffer_load_dwordx4 v[156:159], v10, s[44:47], s65 offen sc1
s_sleep 6
buffer_load_dwordx4 v[160:163], v10, s[44:47], 0 offen sc1
buffer_load_dwordx4 v[164:167], v10, s[44:47], s66 offen sc1
buffer_load_dwordx4 v[168:171], v10, s[44:47], s67 offen sc1
buffer_load_dwordx4 v[172:175], v10, s[44:47], s65 offen sc1
s_sleep 6
buffer_load_dwordx4 v[176:179], v10, s[44:47], 0 offen sc1
buffer_load_dwordx4 v[180:183], v10, s[44:47], s66 offen sc1
buffer_load_dwordx4 v[184:187], v10, s[44:47], s67 offen sc1
buffer_load_dwordx4 v[188:191], v10, s[44:47], s65 offen sc1
L_ps_Cf:
s_waitcnt vmcnt(11)
v_xor_b32 v192, s76, v144
v_xor_b32 v193, s77, v145
v_xor_b32 v194, s78, v146
v_xor_b32 v195, s79, v147
v_or_b32 v240, v192, v193
v_or3_b32 v240, v240, v194, v195
s_waitcnt vmcnt(10)
v_xor_b32 v196, s76, v148
v_xor_b32 v197, s77, v149
v_xor_b32 v198, s78, v150
v_xor_b32 v199, s79, v151
v_or3_b32 v240, v240, v196, v197
v_or3_b32 v240, v240, v198, v199
v_add_f32 v192, v192, v196
v_add_f32 v193, v193, v197
v_add_f32 v194, v194, v198
v_add_f32 v195, v195, v199
s_waitcnt vmcnt(9)
v_xor_b32 v196, s76, v152
v_xor_b32 v197, s77, v153
v_xor_b32 v198, s78, v154
v_xor_b32 v199, s79, v155
v_or3_b32 v240, v240, v196, v197
v_or3_b32 v240, v240, v198, v199
v_add_f32 v192, v192, v196
v_add_f32 v193, v193, v197
v_add_f32 v194, v194, v198
v_add_f32 v195, v195, v199
s_waitcnt vmcnt(8)
v_xor_b32 v196, s76, v156
v_xor_b32 v197, s77, v157
v_xor_b32 v198, s78, v158
v_xor_b32 v199, s79, v159
v_or3_b32 v240, v240, v196, v197
v_or3_b32 v240, v240, v198, v199
v_add_f32 v192, v192, v196
v_add_f32 v193, v193, v197
v_add_f32 v194, v194, v198
v_add_f32 v195, v195, v199
v_and_b32 v240, 0xff, v240
v_cmp_ne_u32 vcc, 0, v240
v_add_f32_dpp v192, v192, v192 row_ror:8 row_mask:0xf bank_mask:0xf
v_add_f32_dpp v193, v193, v193 row_ror:8 row_mask:0xf bank_mask:0xf
v_add_f32_dpp v194, v194, v194 row_ror:8 row_mask:0xf bank_mask:0xf
v_add_f32_dpp v195, v195, v195 row_ror:8 row_mask:0xf bank_mask:0xf
s_cmp_eq_u64 vcc, 0
s_cbranch_scc1 L_pe_Cf
buffer_load_dwordx4 v[144:147], v10, s[44:47], 0 offen sc1
buffer_load_dwordx4 v[148:151], v10, s[44:47], s66 offen sc1
buffer_load_dwordx4 v[152:155], v10, s[44:47], s67 offen sc1
buffer_load_dwordx4 v[156:159], v10, s[44:47], s65 offen sc1
s_waitcnt vmcnt(11)
v_xor_b32 v192, s76, v160
v_xor_b32 v193, s77, v161
v_xor_b32 v194, s78, v162
v_xor_b32 v195, s79, v163
v_or_b32 v240, v192, v193
v_or3_b32 v240, v240, v194, v195
s_waitcnt vmcnt(10)
v_xor_b32 v196, s76, v164
v_xor_b32 v197, s77, v165
v_xor_b32 v198, s78, v166
v_xor_b32 v199, s79, v167
v_or3_b32 v240, v240, v196, v197
v_or3_b32 v240, v240, v198, v199
v_add_f32 v192, v192, v196
v_add_f32 v193, v193, v197
v_add_f32 v194, v194, v198
v_add_f32 v195, v195, v199
s_waitcnt vmcnt(9)
v_xor_b32 v196, s76, v168
v_xor_b32 v197, s77, v169
v_xor_b32 v198, s78, v170
v_xor_b32 v199, s79, v171
v_or3_b32 v240, v240, v196, v197
v_or3_b32 v240, v240, v198, v199
v_add_f32 v192, v192, v196
v_add_f32 v193, v193, v197
v_add_f32 v194, v194, v198
v_add_f32 v195, v195, v199
s_waitcnt vmcnt(8)
v_xor_b32 v196, s76, v172
v_xor_b32 v197, s77, v173
v_xor_b32 v198, s78, v174
v_xor_b32 v199, s79, v175
v_or3_b32 v240, v240, v196, v197
v_or3_b32 v240, v240, v198, v199
v_add_f32 v192, v192, v196
v_add_f32 v193, v193, v197
v_add_f32 v194, v194, v198
v_add_f32 v195, v195, v199
v_and_b32 v240, 0xff, v240
v_cmp_ne_u32 vcc, 0, v240
v_add_f32_dpp v192, v192, v192 row_ror:8 row_mask:0xf bank_mask:0xf
v_add_f32_dpp v193, v193, v193 row_ror:8 row_mask:0xf bank_mask:0xf
v_add_f32_dpp v194, v194, v194 row_ror:8 row_mask:0xf bank_mask:0xf
v_add_f32_dpp v195, v195, v195 row_ror:8 row_mask:0xf bank_mask:0xf
s_cmp_eq_u64 vcc, 0
s_cbranch_scc1 L_pe_Cf
buffer_load_dwordx4 v[160:163], v10, s[44:47], 0 offen sc1
buffer_load_dwordx4 v[164:167], v10, s[44:47], s66 offen sc1
buffer_load_dwordx4 v[168:171], v10, s[44:47], s67 offen sc1
buffer_load_dwordx4 v[172:175], v10, s[44:47], s65 offen sc1
s_waitcnt vmcnt(11)
v_xor_b32 v192, s76, v176
v_xor_b32 v193, s77, v177
v_xor_b32 v194, s78, v178
v_xor_b32 v195, s79, v179
v_or_b32 v240, v192, v193
v_or3_b32 v240, v240, v194, v195
s_waitcnt vmcnt(10)
v_xor_b32 v196, s76, v180
v_xor_b32 v197, s77, v181
v_xor_b32 v198, s78, v182
v_xor_b32 v199, s79, v183
v_or3_b32 v240, v240, v196, v197
v_or3_b32 v240, v240, v198, v199
v_add_f32 v192, v192, v196
v_add_f32 v193, v193, v197
v_add_f32 v194, v194, v198
v_add_f32 v195, v195, v199
s_waitcnt vmcnt(9)
v_xor_b32 v196, s76, v184
v_xor_b32 v197, s77, v185
v_xor_b32 v198, s78, v186
v_xor_b32 v199, s79, v187
v_or3_b32 v240, v240, v196, v197
v_or3_b32 v240, v240, v198, v199
v_add_f32 v192, v192, v196
v_add_f32 v193, v193, v197
v_add_f32 v194, v194, v198
v_add_f32 v195, v195, v199
s_waitcnt vmcnt(8)
v_xor_b32 v196, s76, v188
v_xor_b32 v197, s77, v189
v_xor_b32 v198, s78, v190
v_xor_b32 v199, s79, v191
v_or3_b32 v240, v240, v196, v197
v_or3_b32 v240, v240, v198, v199
v_add_f32 v192, v192, v196
v_add_f32 v193, v193, v197
v_add_f32 v194, v194, v198
v_add_f32 v195, v195, v199
v_and_b32 v240, 0xff, v240
v_cmp_ne_u32 vcc, 0, v240
v_add_f32_dpp v192, v192, v192 row_ror:8 row_mask:0xf bank_mask:0xf
v_add_f32_dpp v193, v193, v193 row_ror:8 row_mask:0xf bank_mask:0xf
v_add_f32_dpp v194, v194, v194 row_ror:8 row_mask:0xf bank_mask:0xf
v_add_f32_dpp v195, v195, v195 row_ror:8 row_mask:0xf bank_mask:0xf
s_cmp_eq_u64 vcc, 0
s_cbranch_scc1 L_pe_Cf
buffer_load_dwordx4 v[176:179], v10, s[44:47], 0 offen sc1
buffer_load_dwordx4 v[180:183], v10, s[44:47], s66 offen sc1
buffer_load_dwordx4 v[184:187], v10, s[44:47], s67 offen sc1
buffer_load_dwordx4 v[188:191], v10, s[44:47], s65 offen sc1
s_add_u32 s64, s64, 1
s_cmp_lt_u32 s64, 65536
s_cbranch_scc1 L_ps_Cf
L_pe_Cf:
v_add_f32_dpp v192, v192, v192 row_ror:4 row_mask:0xf bank_mask:0xf
v_add_f32_dpp v193, v193, v193 row_ror:4 row_mask:0xf bank_mask:0xf
v_add_f32_dpp v194, v194, v194 row_ror:4 row_mask:0xf bank_mask:0xf
v_add_f32_dpp v195, v195, v195 row_ror:4 row_mask:0xf bank_mask:0xf
v_mov_b32 v240, v192
v_mov_b32 v241, v193
v_mov_b32 v242, v194
v_mov_b32 v243, v195
v_permlane16_swap_b32 v192, v240
v_permlane16_swap_b32 v193, v241
v_permlane16_swap_b32 v194, v242
v_permlane16_swap_b32 v195, v243
v_add_f32 v192, v192, v240
v_add_f32 v193, v193, v241
v_add_f32 v194, v194, v242
v_add_f32 v195, v195, v243
v_cvt_pk_bf16_f32 v192, v192, v193
v_cvt_pk_bf16_f32 v193, v194, v195
s_cmp_lg_u32 s53, 0
s_cbranch_scc1 L_C_end
s_mov_b32 exec_lo, 15
s_mov_b32 exec_hi, 15
global_store_dwordx2 v11, v[192:193], s[26:27]
s_mov_b64 exec, -1
s_cmp_lg_u32 s32, 0
s_cbranch_scc1 L_C_end
v_mov_b32 v240, 0x14000
v_mov_b32 v241, s58
s_mov_b64 exec, 1
buffer_store_dword v241, v240, s[44:47], 0 offen sc1
L_C_end:
s_cmp_lg_u32 s53, 0
s_mov_b32 s53, 0
s_cbranch_scc1 L_C_poll
s_endpgm
L_exit:
s_endpgm
.section .rodata,"a"
.p2align 6
.amdhsa_kernel concat_heads__gqa_block_cached__compressed_kv_cla__decode_kernel
  .amdhsa_next_free_vgpr 256
  .amdhsa_next_free_sgpr 102
  .amdhsa_accum_offset 256
  .amdhsa_group_segment_fixed_size 0
  .amdhsa_kernarg_size 112
  .amdhsa_user_sgpr_count 2
  .amdhsa_user_sgpr_kernarg_segment_ptr 1
  .amdhsa_system_sgpr_workgroup_id_x 1
.end_amdhsa_kernel
```

```asm
; @launch grid=(256,1,1) block=(512,1,1) lds=157696
.amdgcn_target "amdgcn-amd-amdhsa--gfx950"
.text
.globl concat_heads__gqa_block_cached__compressed_kv_cla__decode_kernel
.p2align 12
.type concat_heads__gqa_block_cached__compressed_kv_cla__decode_kernel,@function
concat_heads__gqa_block_cached__compressed_kv_cla__decode_kernel:
s_cmpk_ge_u32 s2, 256
s_cbranch_scc1 L_exit
s_load_dwordx16 s[4:19], s[0:1], 0
s_load_dwordx8 s[20:27], s[0:1], 64
s_load_dwordx4 s[28:31], s[0:1], 96
v_readfirstlane_b32 s34, v0
s_lshr_b32 s32, s2, 3
s_lshr_b32 s60, s2, 6
s_lshl1_add_u32 s61, s60, 2
s_sub_u32 s33, s32, s61
s_and_b32 s33, s33, 7
s_xor_b32 s61, s2, s60
s_and_b32 s61, s61, 7
s_lshl3_add_u32 s82, s60, s61
s_lshr_b32 s34, s34, 6
v_and_b32 v2, 15, v0
v_bfe_u32 v3, v0, 4, 2
v_lshlrev_b32 v11, 4, v2
s_mov_b32 s87, 0x20000
v_lshl_add_u32 v9, v3, 13, v11
s_add_u32 s63, s33, 1
s_and_b32 s60, s63, 3
s_bitcmp1_b32 s63, 2
s_cselect_b32 s61, 0, 5
s_lshl3_add_u32 s60, s60, s34
s_lshl_b32 s60, s60, 9
s_xor_b32 s61, s61, s82
s_add_u32 s60, s60, s61
s_lshl_b32 s88, s60, 8
s_lshl_b32 s89, 1, 15
s_add_u32 s60, s88, s89
s_add_u32 s61, s60, s89
s_add_u32 s62, s61, s89
s_mov_b32 s86, 0x400000
s_bitcmp1_b32 s63, 2
s_waitcnt lgkmcnt(0)
s_cselect_b64 s[84:85], s[18:19], s[10:11]
s_and_b32 s85, s85, 0xffff
buffer_load_dwordx4 v[128:131], v9, s[84:87], s88 offen
buffer_load_dwordx4 v[132:135], v9, s[84:87], s60 offen
buffer_load_dwordx4 v[136:139], v9, s[84:87], s61 offen
buffer_load_dwordx4 v[140:143], v9, s[84:87], s62 offen
s_cmp_eq_u32 s33, 6
s_cbranch_scc1 L_roleW
s_cmp_eq_u32 s33, 7
s_cbranch_scc1 L_roleC
L_ids:
v_and_b32 v1, 63, v0
s_lshl_b32 s61, s33, 2
s_lshr_b32 s61, 0x50764321, s61
s_and_b32 s61, s61, 7
s_xor_b32 s32, s82, s61
L_roleA:
s_xor_b32 s83, s82, 5
s_add_u32 s60, s33, 0x0
s_lshl3_add_u32 s60, s60, s34
s_lshl_b32 s60, s60, 17
s_lshl_b32 s61, s82, 8
s_add_u32 s60, s60, s61
s_mov_b64 s[84:85], s[20:21]
s_mov_b32 s86, 0x400000
s_mov_b32 s88, s60
s_mov_b32 s81, 13
s_add_u32 s60, s33, 0xfffffffc
s_lshl3_add_u32 s60, s60, s34
s_lshl_b32 s60, s60, 17
s_lshl_b32 s61, s82, 8
s_add_u32 s60, s60, s61
s_cmp_ge_u32 s33, 4
s_cselect_b64 s[84:85], s[22:23], s[84:85]
s_cselect_b32 s86, 0x400000, s86
s_cselect_b32 s88, s60, s88
s_cselect_b32 s81, 13, s81
s_and_b32 s85, s85, 0xffff
s_lshl_b32 s89, 4, s81
v_lshl_add_u32 v10, v3, s81, v11
s_waitcnt vmcnt(3)
buffer_load_dwordx4 v[20:23], v10, s[84:87], s88 offen
s_add_u32 s88, s88, s89
s_waitcnt vmcnt(3)
buffer_load_dwordx4 v[24:27], v10, s[84:87], s88 offen
s_add_u32 s88, s88, s89
s_waitcnt vmcnt(3)
buffer_load_dwordx4 v[28:31], v10, s[84:87], s88 offen
s_add_u32 s88, s88, s89
s_waitcnt vmcnt(3)
buffer_load_dwordx4 v[32:35], v10, s[84:87], s88 offen
v_lshlrev_b32 v8, 4, v1
s_bfe_u32 s55, s32, 0x10004
s_lshl_b32 s55, s55, 26
s_lshl_b32 s35, s33, 3
s_add_u32 s35, s35, s34
s_bfe_u32 s63, s35, 0x10009
s_lshl_b32 s63, s63, 26
s_xor_b32 s37, s63, s55
s_bfe_u32 s63, s35, 0x90000
s_lshl_b32 s63, s63, 12
s_or_b32 s37, s37, s63
s_lshl_b32 s62, s32, 21
s_add_u32 s40, s6, s62
s_addc_u32 s41, s7, 0
s_and_b32 s41, s41, 0xffff
s_mov_b32 s42, 0x4200000
s_mov_b32 s43, 0x20000
s_add_u32 s60, s33, 0x2
s_lshl3_add_u32 s60, s60, s34
s_lshl_b32 s60, s60, 17
s_lshl_b32 s61, s82, 8
s_add_u32 s60, s60, s61
s_mov_b64 s[84:85], s[22:23]
s_mov_b32 s86, 0x400000
s_mov_b32 s88, s60
s_mov_b32 s81, 13
s_add_u32 s60, s33, 0xfffffffe
s_lshl3_add_u32 s60, s60, s34
s_lshl_b32 s60, s60, 12
s_lshl_b32 s61, s82, 17
s_add_u32 s60, s60, s61
s_cmp_ge_u32 s33, 2
s_cselect_b64 s[84:85], s[24:25], s[84:85]
s_cselect_b32 s86, 0x400000, s86
s_cselect_b32 s88, s60, s88
s_cselect_b32 s81, 8, s81
s_and_b32 s85, s85, 0xffff
s_lshl_b32 s89, 4, s81
v_lshl_add_u32 v9, v3, s81, v11
s_waitcnt vmcnt(3)
buffer_load_dwordx4 v[20:23], v9, s[84:87], s88 offen
s_add_u32 s88, s88, s89
s_waitcnt vmcnt(3)
buffer_load_dwordx4 v[24:27], v9, s[84:87], s88 offen
s_add_u32 s88, s88, s89
s_waitcnt vmcnt(3)
buffer_load_dwordx4 v[28:31], v9, s[84:87], s88 offen
s_add_u32 s88, s88, s89
s_waitcnt vmcnt(3)
buffer_load_dwordx4 v[32:35], v9, s[84:87], s88 offen
s_add_u32 s60, s33, 0x2
s_lshl3_add_u32 s60, s60, s34
s_lshl_b32 s60, s60, 12
s_and_b32 s61, s83, 3
s_lshl_b32 s61, s61, 17
s_xor_b32 s60, s60, s61
s_lshl_b32 s61, s83, 19
s_add_u32 s60, s60, s61
s_mov_b64 s[84:85], s[16:17]
s_mov_b32 s86, 0x1000000
s_mov_b32 s88, s60
s_mov_b32 s81, 8
s_and_b32 s85, s85, 0xffff
s_lshl_b32 s89, 4, s81
v_lshl_add_u32 v10, v3, s81, v11
s_waitcnt vmcnt(3)
buffer_load_dwordx4 v[20:23], v10, s[84:87], s88 offen
s_add_u32 s88, s88, s89
s_waitcnt vmcnt(3)
buffer_load_dwordx4 v[24:27], v10, s[84:87], s88 offen
s_add_u32 s88, s88, s89
s_waitcnt vmcnt(3)
buffer_load_dwordx4 v[28:31], v10, s[84:87], s88 offen
s_add_u32 s88, s88, s89
s_waitcnt vmcnt(3)
buffer_load_dwordx4 v[32:35], v10, s[84:87], s88 offen
s_add_u32 s60, s33, 0x8
s_lshl3_add_u32 s60, s60, s34
s_lshl_b32 s60, s60, 12
s_and_b32 s61, s83, 3
s_lshl_b32 s61, s61, 17
s_xor_b32 s60, s60, s61
s_lshl_b32 s61, s83, 19
s_add_u32 s60, s60, s61
s_mov_b64 s[84:85], s[16:17]
s_mov_b32 s86, 0x1000000
s_mov_b32 s88, s60
s_mov_b32 s81, 8
s_and_b32 s85, s85, 0xffff
s_lshl_b32 s89, 4, s81
v_lshl_add_u32 v9, v3, s81, v11
s_waitcnt vmcnt(3)
buffer_load_dwordx4 v[20:23], v9, s[84:87], s88 offen
s_add_u32 s88, s88, s89
s_waitcnt vmcnt(3)
buffer_load_dwordx4 v[24:27], v9, s[84:87], s88 offen
s_add_u32 s88, s88, s89
s_waitcnt vmcnt(3)
buffer_load_dwordx4 v[28:31], v9, s[84:87], s88 offen
s_add_u32 s88, s88, s89
s_waitcnt vmcnt(3)
buffer_load_dwordx4 v[32:35], v9, s[84:87], s88 offen
s_add_u32 s60, s33, 0xe
s_lshl3_add_u32 s60, s60, s34
s_lshl_b32 s60, s60, 12
s_and_b32 s61, s83, 3
s_lshl_b32 s61, s61, 17
s_xor_b32 s60, s60, s61
s_lshl_b32 s61, s83, 19
s_add_u32 s60, s60, s61
s_mov_b64 s[84:85], s[16:17]
s_mov_b32 s86, 0x1000000
s_mov_b32 s88, s60
s_mov_b32 s81, 8
s_add_u32 s60, s33, 0xfffffffe
s_lshl3_add_u32 s60, s60, s34
s_lshl_b32 s60, s60, 12
s_lshl_b32 s61, s83, 17
s_add_u32 s60, s60, s61
s_cmp_ge_u32 s33, 2
s_cselect_b64 s[84:85], s[12:13], s[84:85]
s_cselect_b32 s86, 0x400000, s86
s_cselect_b32 s88, s60, s88
s_cselect_b32 s81, 8, s81
s_and_b32 s85, s85, 0xffff
s_lshl_b32 s89, 4, s81
v_lshl_add_u32 v10, v3, s81, v11
s_waitcnt vmcnt(3)
buffer_load_dwordx4 v[20:23], v10, s[84:87], s88 offen
s_add_u32 s88, s88, s89
s_waitcnt vmcnt(3)
buffer_load_dwordx4 v[24:27], v10, s[84:87], s88 offen
s_add_u32 s88, s88, s89
s_waitcnt vmcnt(3)
buffer_load_dwordx4 v[28:31], v10, s[84:87], s88 offen
s_add_u32 s88, s88, s89
s_waitcnt vmcnt(3)
buffer_load_dwordx4 v[32:35], v10, s[84:87], s88 offen
s_waitcnt vmcnt(3)
buffer_load_dwordx4 v[52:55], v8, s[40:43], s37 offen offset:0 nt
s_waitcnt vmcnt(3)
buffer_load_dwordx4 v[56:59], v8, s[40:43], s37 offen offset:1024 nt
s_waitcnt vmcnt(3)
buffer_load_dwordx4 v[60:63], v8, s[40:43], s37 offen offset:2048 nt
s_waitcnt vmcnt(3)
buffer_load_dwordx4 v[64:67], v8, s[40:43], s37 offen offset:3072 nt
s_add_u32 s44, s8, s62
s_addc_u32 s45, s9, 0
s_and_b32 s45, s45, 0xffff
s_mov_b32 s46, 0x4200000
s_mov_b32 s47, 0x20000
s_mov_b64 s[70:71], s[40:41]
s_mov_b64 s[72:73], s[44:45]
s_mov_b64 s[44:45], s[40:41]
s_mov_b32 s50, s35
s_mov_b32 s74, 0x00010001
s_mov_b32 s75, 0x00010001
s_mul_i32 s63, s34, 1216
s_add_u32 s63, s63, 8832
v_lshl_add_u32 v165, v3, 4, s63
v_add_u32 v164, 256, v165
v_mov_b32 v166, 0xff7fffff
v_mov_b32 v167, 0xff7fffff
v_and_b32 v132, 1, v0
v_lshlrev_b32 v132, 4, v132
v_mov_b32 v133, 0xffff
v_lshlrev_b32 v132, v132, v133
v_bfe_u32 v133, v0, 1, 2
v_cmp_eq_u32 vcc, 0, v133
s_nop 1
v_cndmask_b32 v4, 0, v132, vcc
v_cmp_eq_u32 vcc, 1, v133
s_nop 1
v_cndmask_b32 v5, 0, v132, vcc
v_cmp_eq_u32 vcc, 2, v133
s_nop 1
v_cndmask_b32 v6, 0, v132, vcc
v_cmp_eq_u32 vcc, 3, v133
s_nop 1
v_cndmask_b32 v7, 0, v132, vcc
s_load_dword s58, s[30:31], 0x14000
s_lshl_b32 s62, s32, 13
s_add_u32 s62, s62, 0x61800
s_mov_b32 s66, 16
s_add_u32 s52, s30, s62
s_addc_u32 s53, s31, 0
v_mov_b32 v140, 0xff7fffff
v_mov_b32 v141, 0
v_mov_b32 v136, 0
v_mov_b32 v137, 0
v_mov_b32 v138, 0
v_mov_b32 v139, 0
v_mov_b32 v144, 0x3e0293ee
s_mov_b32 s56, 0
s_mov_b32 s54, 0
s_lshr_b32 s61, s55, 17
v_lshrrev_b32 v151, 1, v3
v_lshlrev_b32 v151, 9, v151
v_xor_b32 v151, s61, v151
v_lshl_add_u32 v151, v2, 5, v151
v_and_b32 v132, 1, v3
v_lshl_add_u32 v151, v132, 4, v151
s_lshl_b32 s62, s32, 10
s_add_u32 s62, s62, 0x18000
v_add_u32 v151, s62, v151
v_lshlrev_b32 v148, 5, v2
v_lshl_add_u32 v148, v3, 4, v148
s_mul_i32 s62, s34, 1056
v_add_u32 v148, s62, v148
s_lshl_b32 s62, s34, 3
v_mov_b32 v149, s62
v_and_b32 v132, 7, v1
v_lshrrev_b32 v133, 3, v1
v_add_u32 v133, s62, v133
v_lshlrev_b32 v133, 4, v133
v_mul_u32_u24 v150, 1056, v132
v_add_u32 v150, v150, v133
v_xor_b32 v154, s61, v133
s_lshl_b32 s62, s32, 3
s_add_u32 s62, s62, s33
s_lshl_b32 s62, s62, 10
s_add_u32 s62, s62, 0x60000
v_add_u32 v154, s62, v154
s_waitcnt vmcnt(3)
s_add_u32 s35, s35, 48
s_bfe_u32 s63, s35, 0x10009
s_lshl_b32 s63, s63, 26
s_xor_b32 s37, s63, s55
s_bfe_u32 s63, s35, 0x90000
s_lshl_b32 s63, s63, 12
s_or_b32 s37, s37, s63
buffer_load_dwordx4 v[68:71], v8, s[44:47], s37 offen offset:0 nt
s_waitcnt vmcnt(3)
buffer_load_dwordx4 v[72:75], v8, s[44:47], s37 offen offset:1024 nt
s_waitcnt vmcnt(3)
buffer_load_dwordx4 v[76:79], v8, s[44:47], s37 offen offset:2048 nt
s_waitcnt vmcnt(3)
buffer_load_dwordx4 v[80:83], v8, s[44:47], s37 offen offset:3072 nt
s_waitcnt vmcnt(3)
s_add_u32 s35, s35, 48
s_bfe_u32 s63, s35, 0x10009
s_lshl_b32 s63, s63, 26
s_xor_b32 s37, s63, s55
s_bfe_u32 s63, s35, 0x90000
s_lshl_b32 s63, s63, 12
s_or_b32 s37, s37, s63
buffer_load_dwordx4 v[84:87], v8, s[40:43], s37 offen offset:0 nt
s_waitcnt vmcnt(3)
buffer_load_dwordx4 v[88:91], v8, s[40:43], s37 offen offset:1024 nt
s_waitcnt vmcnt(3)
buffer_load_dwordx4 v[92:95], v8, s[40:43], s37 offen offset:2048 nt
s_waitcnt vmcnt(3)
buffer_load_dwordx4 v[96:99], v8, s[40:43], s37 offen offset:3072 nt
s_waitcnt vmcnt(3)
s_add_u32 s35, s35, 48
s_bfe_u32 s63, s35, 0x10009
s_lshl_b32 s63, s63, 26
s_xor_b32 s37, s63, s55
s_bfe_u32 s63, s35, 0x90000
s_lshl_b32 s63, s63, 12
s_or_b32 s37, s37, s63
buffer_load_dwordx4 v[100:103], v8, s[44:47], s37 offen offset:0 nt
s_waitcnt vmcnt(3)
buffer_load_dwordx4 v[104:107], v8, s[44:47], s37 offen offset:1024 nt
s_waitcnt vmcnt(3)
buffer_load_dwordx4 v[108:111], v8, s[44:47], s37 offen offset:2048 nt
s_waitcnt vmcnt(3)
buffer_load_dwordx4 v[112:115], v8, s[44:47], s37 offen offset:3072 nt
global_load_dwordx4 v[120:123], v151, s[30:31] sc1
s_waitcnt vmcnt(4)
s_add_u32 s35, s35, 48
s_bfe_u32 s63, s35, 0x10009
s_lshl_b32 s63, s63, 26
s_xor_b32 s37, s63, s55
s_bfe_u32 s63, s35, 0x90000
s_lshl_b32 s63, s63, 12
s_or_b32 s37, s37, s63
buffer_load_dwordx4 v[20:23], v8, s[40:43], s37 offen offset:0 nt
s_waitcnt vmcnt(4)
buffer_load_dwordx4 v[24:27], v8, s[40:43], s37 offen offset:1024 nt
s_waitcnt vmcnt(4)
buffer_load_dwordx4 v[28:31], v8, s[40:43], s37 offen offset:2048 nt
s_waitcnt vmcnt(4)
buffer_load_dwordx4 v[32:35], v8, s[40:43], s37 offen offset:3072 nt
s_waitcnt lgkmcnt(0)
s_add_u32 s58, s58, 0x9e3779b9
s_bfe_u32 s76, s58, 0x80000
s_bfe_u32 s77, s58, 0x80008
s_bfe_u32 s78, s58, 0x80010
s_bfe_u32 s79, s58, 0x80018
s_mov_b32 s64, 0
s_mov_b32 s60, 0x05040100
s_mov_b32 s61, 0x07060302
s_waitcnt vmcnt(4)
L_A_qchk:
v_perm_b32 v132, v121, v120, s60
v_perm_b32 v133, v123, v122, s60
v_xor_b32 v132, s58, v132
v_xor_b32 v133, s58, v133
v_or_b32 v132, v132, v133
v_cmp_ne_u32 vcc, 0, v132
s_add_u32 s64, s64, 1
s_cmp_eq_u64 vcc, 0
s_cbranch_scc1 L_A_qok
s_cmp_ge_u32 s64, 65536
s_cbranch_scc1 L_A_qok
global_load_dwordx4 v[120:123], v151, s[30:31] sc1
s_waitcnt vmcnt(0)
s_branch L_A_qchk
L_A_qok:
v_perm_b32 v132, v121, v120, s61
v_perm_b32 v133, v123, v122, s61
v_lshlrev_b32 v134, 2, v2
ds_bpermute_b32 v12, v134, v132 offset:0
ds_bpermute_b32 v13, v134, v133 offset:0
ds_bpermute_b32 v14, v134, v132 offset:64
ds_bpermute_b32 v15, v134, v133 offset:64
ds_bpermute_b32 v16, v134, v132 offset:128
ds_bpermute_b32 v17, v134, v133 offset:128
ds_bpermute_b32 v18, v134, v132 offset:192
ds_bpermute_b32 v19, v134, v133 offset:192
s_waitcnt lgkmcnt(0)
v_mov_b32 v160, v12
v_mov_b32 v161, v13
v_mov_b32 v162, v14
v_mov_b32 v163, v15
.p2align 6
L_A_loopa:
s_cmp_lt_u32 s54, 2
s_cbranch_scc1 L_A_back
L_A_backd:
s_add_u32 s49, s35, 48
s_bfe_u32 s63, s49, 0x10009
s_lshl_b32 s63, s63, 26
s_xor_b32 s48, s63, s55
s_bfe_u32 s63, s49, 0x90000
s_lshl_b32 s63, s63, 12
s_or_b32 s48, s48, s63
s_lshr_b32 s62, s35, 9
s_cmp_lg_u32 s62, s56
s_cbranch_scc1 L_A_swa
L_A_swda:
s_waitcnt vmcnt(3)
buffer_load_dwordx4 v[36:39], v8, s[44:47], s48 offen offset:0 nt
v_dot2_f32_bf16 v116, v20, v160, 0
v_dot2_f32_bf16 v116, v21, v161, v116
v_dot2_f32_bf16 v116, v22, v162, v116
v_dot2_f32_bf16 v116, v23, v163, v116
s_nop 2
v_add_f32_dpp v116, v116, v116 row_ror:8 row_mask:0xf bank_mask:0xf
s_nop 1
v_add_f32_dpp v116, v116, v116 row_ror:4 row_mask:0xf bank_mask:0xf
s_nop 1
v_add_f32_dpp v116, v116, v116 row_ror:2 row_mask:0xf bank_mask:0xf
s_nop 1
v_add_f32_dpp v116, v116, v116 row_ror:1 row_mask:0xf bank_mask:0xf
v_mul_f32 v116, v116, v144
s_waitcnt vmcnt(3)
buffer_load_dwordx4 v[40:43], v8, s[44:47], s48 offen offset:1024 nt
v_dot2_f32_bf16 v117, v24, v160, 0
v_dot2_f32_bf16 v117, v25, v161, v117
v_dot2_f32_bf16 v117, v26, v162, v117
v_dot2_f32_bf16 v117, v27, v163, v117
s_nop 2
v_add_f32_dpp v117, v117, v117 row_ror:8 row_mask:0xf bank_mask:0xf
s_nop 1
v_add_f32_dpp v117, v117, v117 row_ror:4 row_mask:0xf bank_mask:0xf
s_nop 1
v_add_f32_dpp v117, v117, v117 row_ror:2 row_mask:0xf bank_mask:0xf
s_nop 1
v_add_f32_dpp v117, v117, v117 row_ror:1 row_mask:0xf bank_mask:0xf
v_mul_f32 v117, v117, v144
s_waitcnt vmcnt(3)
buffer_load_dwordx4 v[44:47], v8, s[44:47], s48 offen offset:2048 nt
v_dot2_f32_bf16 v118, v28, v160, 0
v_dot2_f32_bf16 v118, v29, v161, v118
v_dot2_f32_bf16 v118, v30, v162, v118
v_dot2_f32_bf16 v118, v31, v163, v118
s_nop 2
v_add_f32_dpp v118, v118, v118 row_ror:8 row_mask:0xf bank_mask:0xf
s_nop 1
v_add_f32_dpp v118, v118, v118 row_ror:4 row_mask:0xf bank_mask:0xf
s_nop 1
v_add_f32_dpp v118, v118, v118 row_ror:2 row_mask:0xf bank_mask:0xf
s_nop 1
v_add_f32_dpp v118, v118, v118 row_ror:1 row_mask:0xf bank_mask:0xf
v_mul_f32 v118, v118, v144
s_waitcnt vmcnt(3)
buffer_load_dwordx4 v[48:51], v8, s[44:47], s48 offen offset:3072 nt
v_dot2_f32_bf16 v119, v32, v160, 0
v_dot2_f32_bf16 v119, v33, v161, v119
v_dot2_f32_bf16 v119, v34, v162, v119
v_dot2_f32_bf16 v119, v35, v163, v119
s_nop 2
v_add_f32_dpp v119, v119, v119 row_ror:8 row_mask:0xf bank_mask:0xf
s_nop 1
v_add_f32_dpp v119, v119, v119 row_ror:4 row_mask:0xf bank_mask:0xf
s_nop 1
v_add_f32_dpp v119, v119, v119 row_ror:2 row_mask:0xf bank_mask:0xf
s_nop 1
v_add_f32_dpp v119, v119, v119 row_ror:1 row_mask:0xf bank_mask:0xf
v_mul_f32 v119, v119, v144
s_mov_b64 exec, s[74:75]
ds_write_b128 v164, v[116:119] offset:0
s_mov_b64 exec, -1
v_max3_f32 v167, v167, v116, v117
v_max3_f32 v167, v167, v118, v119
s_lshr_b32 s62, s49, 9
s_cmp_lg_u32 s62, s56
s_cbranch_scc1 L_A_swa2
L_A_swda2:
s_add_u32 s36, s35, 96
s_cmp_eq_u32 s54, 6
s_cselect_b32 s36, s50, s36
s_cselect_b64 s[40:41], s[72:73], s[40:41]
s_bfe_u32 s63, s36, 0x10009
s_lshl_b32 s63, s63, 26
s_xor_b32 s38, s63, s55
s_bfe_u32 s63, s36, 0x90000
s_lshl_b32 s63, s63, 12
s_or_b32 s38, s38, s63
s_waitcnt vmcnt(3)
buffer_load_dwordx4 v[20:23], v8, s[40:43], s38 offen offset:0 nt
v_dot2_f32_bf16 v156, v36, v160, 0
v_dot2_f32_bf16 v156, v37, v161, v156
v_dot2_f32_bf16 v156, v38, v162, v156
v_dot2_f32_bf16 v156, v39, v163, v156
s_nop 2
v_add_f32_dpp v156, v156, v156 row_ror:8 row_mask:0xf bank_mask:0xf
s_nop 1
v_add_f32_dpp v156, v156, v156 row_ror:4 row_mask:0xf bank_mask:0xf
s_nop 1
v_add_f32_dpp v156, v156, v156 row_ror:2 row_mask:0xf bank_mask:0xf
s_nop 1
v_add_f32_dpp v156, v156, v156 row_ror:1 row_mask:0xf bank_mask:0xf
v_mul_f32 v156, v156, v144
s_waitcnt vmcnt(3)
buffer_load_dwordx4 v[24:27], v8, s[40:43], s38 offen offset:1024 nt
v_dot2_f32_bf16 v157, v40, v160, 0
v_dot2_f32_bf16 v157, v41, v161, v157
v_dot2_f32_bf16 v157, v42, v162, v157
v_dot2_f32_bf16 v157, v43, v163, v157
s_nop 2
v_add_f32_dpp v157, v157, v157 row_ror:8 row_mask:0xf bank_mask:0xf
s_nop 1
v_add_f32_dpp v157, v157, v157 row_ror:4 row_mask:0xf bank_mask:0xf
s_nop 1
v_add_f32_dpp v157, v157, v157 row_ror:2 row_mask:0xf bank_mask:0xf
s_nop 1
v_add_f32_dpp v157, v157, v157 row_ror:1 row_mask:0xf bank_mask:0xf
v_mul_f32 v157, v157, v144
s_waitcnt vmcnt(3)
buffer_load_dwordx4 v[28:31], v8, s[40:43], s38 offen offset:2048 nt
v_dot2_f32_bf16 v158, v44, v160, 0
v_dot2_f32_bf16 v158, v45, v161, v158
v_dot2_f32_bf16 v158, v46, v162, v158
v_dot2_f32_bf16 v158, v47, v163, v158
s_nop 2
v_add_f32_dpp v158, v158, v158 row_ror:8 row_mask:0xf bank_mask:0xf
s_nop 1
v_add_f32_dpp v158, v158, v158 row_ror:4 row_mask:0xf bank_mask:0xf
s_nop 1
v_add_f32_dpp v158, v158, v158 row_ror:2 row_mask:0xf bank_mask:0xf
s_nop 1
v_add_f32_dpp v158, v158, v158 row_ror:1 row_mask:0xf bank_mask:0xf
v_mul_f32 v158, v158, v144
s_waitcnt vmcnt(3)
buffer_load_dwordx4 v[32:35], v8, s[40:43], s38 offen offset:3072 nt
v_dot2_f32_bf16 v159, v48, v160, 0
v_dot2_f32_bf16 v159, v49, v161, v159
v_dot2_f32_bf16 v159, v50, v162, v159
v_dot2_f32_bf16 v159, v51, v163, v159
s_nop 2
v_add_f32_dpp v159, v159, v159 row_ror:8 row_mask:0xf bank_mask:0xf
s_nop 1
v_add_f32_dpp v159, v159, v159 row_ror:4 row_mask:0xf bank_mask:0xf
s_nop 1
v_add_f32_dpp v159, v159, v159 row_ror:2 row_mask:0xf bank_mask:0xf
s_nop 1
v_add_f32_dpp v159, v159, v159 row_ror:1 row_mask:0xf bank_mask:0xf
v_mul_f32 v159, v159, v144
s_mov_b64 exec, s[74:75]
ds_write_b128 v164, v[156:159] offset:64
s_mov_b64 exec, -1
v_max3_f32 v167, v167, v156, v157
v_max3_f32 v167, v167, v158, v159
v_add_u32 v164, 128, v164
s_mov_b32 s35, s36
s_mov_b32 s37, s38
s_add_u32 s54, s54, 1
s_cmp_lt_u32 s54, 7
s_cbranch_scc1 L_A_loopa
s_mov_b64 s[44:45], s[72:73]
s_mov_b32 s56, 0
v_mov_b32 v164, v165
ds_read_b128 v[116:119], v165
v_mov_b32 v145, v166
s_nop 1
v_permlane16_swap_b32 v166, v145
s_nop 0
v_max_f32 v166, v166, v145
v_mov_b32 v145, v166
s_nop 1
v_permlane32_swap_b32 v166, v145
s_nop 0
v_max_f32 v166, v166, v145
v_mov_b32 v145, v167
s_nop 1
v_permlane16_swap_b32 v167, v145
s_nop 0
v_max_f32 v167, v167, v145
v_mov_b32 v145, v167
s_nop 1
v_permlane32_swap_b32 v167, v145
s_nop 0
v_max_f32 v167, v167, v145
v_mov_b32 v140, v166
.p2align 6
L_A_loopc:
s_add_u32 s49, s35, 48
s_bfe_u32 s63, s49, 0x10009
s_lshl_b32 s63, s63, 26
s_xor_b32 s48, s63, s55
s_bfe_u32 s63, s49, 0x90000
s_lshl_b32 s63, s63, 12
s_or_b32 s48, s48, s63
s_lshr_b32 s62, s35, 9
s_cmp_lg_u32 s62, s56
s_cbranch_scc1 L_A_swc
L_A_swdc:
s_waitcnt lgkmcnt(0)
s_cmp_lt_u32 s54, s66
s_cbranch_scc1 L_A_nogc
s_mov_b32 s39, 1
s_atomic_add s39, s[52:53], 0 glc
L_A_nogc:
ds_read_b128 v[156:159], v164 offset:64
v_sub_f32 v116, v116, v140
v_sub_f32 v117, v117, v140
v_sub_f32 v118, v118, v140
v_sub_f32 v119, v119, v140
v_exp_f32 v116, v116
v_exp_f32 v117, v117
v_exp_f32 v118, v118
v_exp_f32 v119, v119
v_cvt_pk_bf16_f32 v146, v116, v116
v_add_f32 v141, v141, v116
v_and_b32 v120, v146, v4
v_and_b32 v121, v146, v5
v_and_b32 v122, v146, v6
v_and_b32 v123, v146, v7
s_waitcnt vmcnt(3)
buffer_load_dwordx4 v[36:39], v8, s[44:47], s48 offen offset:0 nt
v_mfma_f32_16x16x32_bf16 v[136:139], v[120:123], v[20:23], v[136:139]
v_cvt_pk_bf16_f32 v147, v117, v117
v_add_f32 v141, v141, v117
v_and_b32 v124, v147, v4
v_and_b32 v125, v147, v5
v_and_b32 v126, v147, v6
v_and_b32 v127, v147, v7
s_waitcnt vmcnt(3)
buffer_load_dwordx4 v[40:43], v8, s[44:47], s48 offen offset:1024 nt
v_mfma_f32_16x16x32_bf16 v[136:139], v[124:127], v[24:27], v[136:139]
v_cvt_pk_bf16_f32 v146, v118, v118
v_add_f32 v141, v141, v118
v_and_b32 v128, v146, v4
v_and_b32 v129, v146, v5
v_and_b32 v130, v146, v6
v_and_b32 v131, v146, v7
s_waitcnt vmcnt(3)
buffer_load_dwordx4 v[44:47], v8, s[44:47], s48 offen offset:2048 nt
v_mfma_f32_16x16x32_bf16 v[136:139], v[128:131], v[28:31], v[136:139]
v_cvt_pk_bf16_f32 v147, v119, v119
v_add_f32 v141, v141, v119
v_and_b32 v132, v147, v4
v_and_b32 v133, v147, v5
v_and_b32 v134, v147, v6
v_and_b32 v135, v147, v7
s_waitcnt vmcnt(3)
buffer_load_dwordx4 v[48:51], v8, s[44:47], s48 offen offset:3072 nt
v_mfma_f32_16x16x32_bf16 v[136:139], v[132:135], v[32:35], v[136:139]
s_lshr_b32 s62, s49, 9
s_cmp_lg_u32 s62, s56
s_cbranch_scc1 L_A_swc2
L_A_swdc2:
s_waitcnt lgkmcnt(0)
ds_read_b128 v[116:119], v164 offset:128
v_sub_f32 v156, v156, v140
v_sub_f32 v157, v157, v140
v_sub_f32 v158, v158, v140
v_sub_f32 v159, v159, v140
v_exp_f32 v156, v156
v_exp_f32 v157, v157
v_exp_f32 v158, v158
v_exp_f32 v159, v159
v_cvt_pk_bf16_f32 v146, v156, v156
v_add_f32 v141, v141, v156
v_and_b32 v120, v146, v4
v_and_b32 v121, v146, v5
v_and_b32 v122, v146, v6
v_and_b32 v123, v146, v7
s_add_u32 s36, s35, 96
s_cmp_eq_u32 s54, 15
s_cselect_b64 s[40:41], s[70:71], s[40:41]
s_cmp_lt_u32 s54, 16
s_cbranch_scc1 L_A_notc
s_waitcnt lgkmcnt(0)
s_add_u32 s39, s39, 1
s_cmp_eq_u32 s39, 39
s_cbranch_scc1 L_A_sigc
s_cmp_eq_u32 s39, 95
s_cbranch_scc1 L_A_sigc
L_A_sigdc:
s_min_u32 s39, s39, 1024
s_add_u32 s36, s39, 912
L_A_notc:
s_bfe_u32 s63, s36, 0x10009
s_lshl_b32 s63, s63, 26
s_xor_b32 s38, s63, s55
s_bfe_u32 s63, s36, 0x90000
s_lshl_b32 s63, s63, 12
s_or_b32 s38, s38, s63
s_cmp_lt_u32 s36, 1024
s_cselect_b32 s42, s42, 0
s_waitcnt vmcnt(3)
buffer_load_dwordx4 v[20:23], v8, s[40:43], s38 offen offset:0 nt
v_mfma_f32_16x16x32_bf16 v[136:139], v[120:123], v[36:39], v[136:139]
v_cvt_pk_bf16_f32 v147, v157, v157
v_add_f32 v141, v141, v157
v_and_b32 v124, v147, v4
v_and_b32 v125, v147, v5
v_and_b32 v126, v147, v6
v_and_b32 v127, v147, v7
s_waitcnt vmcnt(3)
buffer_load_dwordx4 v[24:27], v8, s[40:43], s38 offen offset:1024 nt
v_mfma_f32_16x16x32_bf16 v[136:139], v[124:127], v[40:43], v[136:139]
v_cvt_pk_bf16_f32 v146, v158, v158
v_add_f32 v141, v141, v158
v_and_b32 v128, v146, v4
v_and_b32 v129, v146, v5
v_and_b32 v130, v146, v6
v_and_b32 v131, v146, v7
s_waitcnt vmcnt(3)
buffer_load_dwordx4 v[28:31], v8, s[40:43], s38 offen offset:2048 nt
v_mfma_f32_16x16x32_bf16 v[136:139], v[128:131], v[44:47], v[136:139]
v_cvt_pk_bf16_f32 v147, v159, v159
v_add_f32 v141, v141, v159
v_and_b32 v132, v147, v4
v_and_b32 v133, v147, v5
v_and_b32 v134, v147, v6
v_and_b32 v135, v147, v7
s_waitcnt vmcnt(3)
buffer_load_dwordx4 v[32:35], v8, s[40:43], s38 offen offset:3072 nt
v_mfma_f32_16x16x32_bf16 v[136:139], v[132:135], v[48:51], v[136:139]
v_add_u32 v164, 128, v164
s_mov_b32 s35, s36
s_mov_b32 s37, s38
s_add_u32 s54, s54, 1
s_cmp_ge_u32 s35, 1024
s_cbranch_scc1 L_A_out
s_cmp_lt_u32 s54, 16
s_cbranch_scc1 L_A_loopc
s_waitcnt lgkmcnt(0)
.p2align 6
L_A_loopb:
s_cmp_lt_u32 s54, s66
s_cbranch_scc1 L_A_nogb
s_mov_b32 s39, 1
s_atomic_add s39, s[52:53], 0 glc
L_A_nogb:
s_waitcnt vmcnt(3)
buffer_load_dwordx4 v[36:39], v8, s[44:47], s37 offen offset:0 nt
v_dot2_f32_bf16 v116, v20, v160, 0
v_dot2_f32_bf16 v116, v21, v161, v116
v_dot2_f32_bf16 v116, v22, v162, v116
v_dot2_f32_bf16 v116, v23, v163, v116
s_nop 2
v_add_f32_dpp v116, v116, v116 row_ror:8 row_mask:0xf bank_mask:0xf
s_nop 1
v_add_f32_dpp v116, v116, v116 row_ror:4 row_mask:0xf bank_mask:0xf
s_nop 1
v_add_f32_dpp v116, v116, v116 row_ror:2 row_mask:0xf bank_mask:0xf
s_nop 1
v_add_f32_dpp v116, v116, v116 row_ror:1 row_mask:0xf bank_mask:0xf
v_mul_f32 v116, v116, v144
s_waitcnt vmcnt(3)
buffer_load_dwordx4 v[40:43], v8, s[44:47], s37 offen offset:1024 nt
v_dot2_f32_bf16 v117, v24, v160, 0
v_dot2_f32_bf16 v117, v25, v161, v117
v_dot2_f32_bf16 v117, v26, v162, v117
v_dot2_f32_bf16 v117, v27, v163, v117
s_nop 2
v_add_f32_dpp v117, v117, v117 row_ror:8 row_mask:0xf bank_mask:0xf
s_nop 1
v_add_f32_dpp v117, v117, v117 row_ror:4 row_mask:0xf bank_mask:0xf
s_nop 1
v_add_f32_dpp v117, v117, v117 row_ror:2 row_mask:0xf bank_mask:0xf
s_nop 1
v_add_f32_dpp v117, v117, v117 row_ror:1 row_mask:0xf bank_mask:0xf
v_mul_f32 v117, v117, v144
s_waitcnt vmcnt(3)
buffer_load_dwordx4 v[44:47], v8, s[44:47], s37 offen offset:2048 nt
v_dot2_f32_bf16 v118, v28, v160, 0
v_dot2_f32_bf16 v118, v29, v161, v118
v_dot2_f32_bf16 v118, v30, v162, v118
v_dot2_f32_bf16 v118, v31, v163, v118
s_nop 2
v_add_f32_dpp v118, v118, v118 row_ror:8 row_mask:0xf bank_mask:0xf
s_nop 1
v_add_f32_dpp v118, v118, v118 row_ror:4 row_mask:0xf bank_mask:0xf
s_nop 1
v_add_f32_dpp v118, v118, v118 row_ror:2 row_mask:0xf bank_mask:0xf
s_nop 1
v_add_f32_dpp v118, v118, v118 row_ror:1 row_mask:0xf bank_mask:0xf
v_mul_f32 v118, v118, v144
s_waitcnt vmcnt(3)
buffer_load_dwordx4 v[48:51], v8, s[44:47], s37 offen offset:3072 nt
v_dot2_f32_bf16 v119, v32, v160, 0
v_dot2_f32_bf16 v119, v33, v161, v119
v_dot2_f32_bf16 v119, v34, v162, v119
v_dot2_f32_bf16 v119, v35, v163, v119
s_nop 2
v_add_f32_dpp v119, v119, v119 row_ror:8 row_mask:0xf bank_mask:0xf
s_nop 1
v_add_f32_dpp v119, v119, v119 row_ror:4 row_mask:0xf bank_mask:0xf
s_nop 1
v_add_f32_dpp v119, v119, v119 row_ror:2 row_mask:0xf bank_mask:0xf
s_nop 1
v_add_f32_dpp v119, v119, v119 row_ror:1 row_mask:0xf bank_mask:0xf
v_mul_f32 v119, v119, v144
v_max3_f32 v145, v116, v117, v118
v_max_f32 v145, v145, v119
v_cmp_gt_f32 vcc, v145, v140
s_nop 0
s_cmp_lg_u64 vcc, 0
s_cbranch_scc1 L_A_maxb
L_A_maxdb:
v_sub_f32 v116, v116, v140
v_sub_f32 v117, v117, v140
v_sub_f32 v118, v118, v140
v_sub_f32 v119, v119, v140
v_exp_f32 v116, v116
v_exp_f32 v117, v117
v_exp_f32 v118, v118
v_exp_f32 v119, v119
v_cvt_pk_bf16_f32 v146, v116, v116
v_add_f32 v141, v141, v116
v_and_b32 v120, v146, v4
v_and_b32 v121, v146, v5
v_and_b32 v122, v146, v6
v_and_b32 v123, v146, v7
s_add_u32 s36, s35, 48
s_cmp_lt_u32 s54, 16
s_cbranch_scc1 L_A_notb
s_waitcnt lgkmcnt(0)
s_add_u32 s39, s39, 1
s_cmp_eq_u32 s39, 39
s_cbranch_scc1 L_A_sigb
s_cmp_eq_u32 s39, 95
s_cbranch_scc1 L_A_sigb
L_A_sigdb:
s_min_u32 s39, s39, 1024
s_add_u32 s36, s39, 912
L_A_notb:
s_bfe_u32 s63, s36, 0x10009
s_lshl_b32 s63, s63, 26
s_xor_b32 s38, s63, s55
s_bfe_u32 s63, s36, 0x90000
s_lshl_b32 s63, s63, 12
s_or_b32 s38, s38, s63
s_cmp_lt_u32 s36, 1024
s_cselect_b32 s42, s42, 0
s_waitcnt vmcnt(3)
buffer_load_dwordx4 v[20:23], v8, s[40:43], s38 offen offset:0 nt
v_mfma_f32_16x16x32_bf16 v[136:139], v[120:123], v[36:39], v[136:139]
v_cvt_pk_bf16_f32 v147, v117, v117
v_add_f32 v141, v141, v117
v_and_b32 v124, v147, v4
v_and_b32 v125, v147, v5
v_and_b32 v126, v147, v6
v_and_b32 v127, v147, v7
s_waitcnt vmcnt(3)
buffer_load_dwordx4 v[24:27], v8, s[40:43], s38 offen offset:1024 nt
v_mfma_f32_16x16x32_bf16 v[136:139], v[124:127], v[40:43], v[136:139]
v_cvt_pk_bf16_f32 v146, v118, v118
v_add_f32 v141, v141, v118
v_and_b32 v128, v146, v4
v_and_b32 v129, v146, v5
v_and_b32 v130, v146, v6
v_and_b32 v131, v146, v7
s_waitcnt vmcnt(3)
buffer_load_dwordx4 v[28:31], v8, s[40:43], s38 offen offset:2048 nt
v_mfma_f32_16x16x32_bf16 v[136:139], v[128:131], v[44:47], v[136:139]
v_cvt_pk_bf16_f32 v147, v119, v119
v_add_f32 v141, v141, v119
v_and_b32 v132, v147, v4
v_and_b32 v133, v147, v5
v_and_b32 v134, v147, v6
v_and_b32 v135, v147, v7
s_waitcnt vmcnt(3)
buffer_load_dwordx4 v[32:35], v8, s[40:43], s38 offen offset:3072 nt
v_mfma_f32_16x16x32_bf16 v[136:139], v[132:135], v[48:51], v[136:139]
s_mov_b32 s35, s36
s_mov_b32 s37, s38
s_add_u32 s54, s54, 1
s_cmp_lt_u32 s35, 1024
s_cbranch_scc1 L_A_loopb
L_A_out:
v_add_f32_dpp v141, v141, v141 row_bcast:15 row_mask:0xa bank_mask:0xf
s_nop 1
v_add_f32_dpp v141, v141, v141 row_bcast:31 row_mask:0xc bank_mask:0xf
s_mov_b32 exec_lo, 0
s_brev_b32 exec_hi, 1
ds_write_b64 v149, v[140:141] offset:8512
s_mov_b32 exec_lo, -1
s_mov_b32 exec_hi, 0
ds_write_b128 v148, v[136:139] offset:512
s_mov_b64 exec, -1
s_waitcnt lgkmcnt(0)
s_barrier
L_A_nobar:
ds_read_b128 v[120:123], v150 offset:0
v_and_b32 v132, 7, v1
s_lshr_b32 s62, s34, 2
s_lshl_b32 s62, s62, 6
v_lshl_add_u32 v132, v132, 3, s62
ds_read_b64 v[124:125], v132 offset:8448
s_waitcnt lgkmcnt(0)
v_mov_b32 v126, v124
s_nop 1
v_max_f32_dpp v126, v126, v126 quad_perm:[1,0,3,2] row_mask:0xf bank_mask:0xf
s_nop 1
v_max_f32_dpp v126, v126, v126 quad_perm:[2,3,0,1] row_mask:0xf bank_mask:0xf
s_nop 1
v_max_f32_dpp v126, v126, v126 row_half_mirror row_mask:0xf bank_mask:0xf
v_sub_f32 v124, v124, v126
v_exp_f32 v124, v124
v_mov_b32 v132, s58
v_mul_f32 v127, v125, v124
v_mul_f32 v120, v120, v124
v_mul_f32 v121, v121, v124
v_mul_f32 v122, v122, v124
v_mul_f32 v123, v123, v124
v_add_f32_dpp v127, v127, v127 quad_perm:[1,0,3,2] row_mask:0xf bank_mask:0xf
v_add_f32_dpp v120, v120, v120 quad_perm:[1,0,3,2] row_mask:0xf bank_mask:0xf
v_add_f32_dpp v121, v121, v121 quad_perm:[1,0,3,2] row_mask:0xf bank_mask:0xf
v_add_f32_dpp v122, v122, v122 quad_perm:[1,0,3,2] row_mask:0xf bank_mask:0xf
v_add_f32_dpp v123, v123, v123 quad_perm:[1,0,3,2] row_mask:0xf bank_mask:0xf
v_add_f32_dpp v127, v127, v127 quad_perm:[2,3,0,1] row_mask:0xf bank_mask:0xf
v_add_f32_dpp v120, v120, v120 quad_perm:[2,3,0,1] row_mask:0xf bank_mask:0xf
v_add_f32_dpp v121, v121, v121 quad_perm:[2,3,0,1] row_mask:0xf bank_mask:0xf
v_add_f32_dpp v122, v122, v122 quad_perm:[2,3,0,1] row_mask:0xf bank_mask:0xf
v_add_f32_dpp v123, v123, v123 quad_perm:[2,3,0,1] row_mask:0xf bank_mask:0xf
v_add_f32_dpp v127, v127, v127 row_half_mirror row_mask:0xf bank_mask:0xf
v_add_f32_dpp v120, v120, v120 row_half_mirror row_mask:0xf bank_mask:0xf
v_add_f32_dpp v121, v121, v121 row_half_mirror row_mask:0xf bank_mask:0xf
v_add_f32_dpp v122, v122, v122 row_half_mirror row_mask:0xf bank_mask:0xf
v_add_f32_dpp v123, v123, v123 row_half_mirror row_mask:0xf bank_mask:0xf
v_max_f32 v127, 0x00800000, v127
v_log_f32 v124, v127
v_rcp_f32 v127, v127
s_mov_b32 s62, 0x05010400
s_mov_b32 s63, 0x07030602
v_add_f32 v126, v126, v124
v_mul_f32 v120, v120, v127
v_mul_f32 v121, v121, v127
v_mul_f32 v122, v122, v127
v_mul_f32 v123, v123, v127
v_perm_b32 v124, v126, v132, s62
v_perm_b32 v125, v126, v132, s63
v_cvt_pk_bf16_f32 v120, v120, v121
v_cvt_pk_bf16_f32 v121, v122, v123
s_mov_b32 exec_lo, 0x01010101
s_mov_b32 exec_hi, 0x01010101
v_perm_b32 v128, v120, v124, s60
v_perm_b32 v129, v120, v124, s61
v_perm_b32 v130, v121, v125, s60
v_perm_b32 v131, v121, v125, s61
global_store_dwordx4 v154, v[128:131], s[30:31] sc1
s_endpgm
L_A_back:
s_cmp_lg_u32 s54, 0
s_cbranch_scc1 L_A_bk1
v_dot2_f32_bf16 v116, v52, v12, 0
v_dot2_f32_bf16 v116, v53, v13, v116
v_dot2_f32_bf16 v116, v54, v14, v116
v_dot2_f32_bf16 v116, v55, v15, v116
v_dot2_f32_bf16 v117, v56, v12, 0
v_dot2_f32_bf16 v117, v57, v13, v117
v_dot2_f32_bf16 v117, v58, v14, v117
v_dot2_f32_bf16 v117, v59, v15, v117
v_dot2_f32_bf16 v118, v60, v12, 0
v_dot2_f32_bf16 v118, v61, v13, v118
v_dot2_f32_bf16 v118, v62, v14, v118
v_dot2_f32_bf16 v118, v63, v15, v118
v_dot2_f32_bf16 v119, v64, v12, 0
v_dot2_f32_bf16 v119, v65, v13, v119
v_dot2_f32_bf16 v119, v66, v14, v119
v_dot2_f32_bf16 v119, v67, v15, v119
s_nop 1
v_add_f32_dpp v116, v116, v116 row_ror:8 row_mask:0xf bank_mask:0xf
v_add_f32_dpp v117, v117, v117 row_ror:8 row_mask:0xf bank_mask:0xf
v_add_f32_dpp v118, v118, v118 row_ror:8 row_mask:0xf bank_mask:0xf
v_add_f32_dpp v119, v119, v119 row_ror:8 row_mask:0xf bank_mask:0xf
v_add_f32_dpp v116, v116, v116 row_ror:4 row_mask:0xf bank_mask:0xf
v_add_f32_dpp v117, v117, v117 row_ror:4 row_mask:0xf bank_mask:0xf
v_add_f32_dpp v118, v118, v118 row_ror:4 row_mask:0xf bank_mask:0xf
v_add_f32_dpp v119, v119, v119 row_ror:4 row_mask:0xf bank_mask:0xf
v_add_f32_dpp v116, v116, v116 row_ror:2 row_mask:0xf bank_mask:0xf
v_add_f32_dpp v117, v117, v117 row_ror:2 row_mask:0xf bank_mask:0xf
v_add_f32_dpp v118, v118, v118 row_ror:2 row_mask:0xf bank_mask:0xf
v_add_f32_dpp v119, v119, v119 row_ror:2 row_mask:0xf bank_mask:0xf
v_add_f32_dpp v116, v116, v116 row_ror:1 row_mask:0xf bank_mask:0xf
v_add_f32_dpp v117, v117, v117 row_ror:1 row_mask:0xf bank_mask:0xf
v_add_f32_dpp v118, v118, v118 row_ror:1 row_mask:0xf bank_mask:0xf
v_add_f32_dpp v119, v119, v119 row_ror:1 row_mask:0xf bank_mask:0xf
v_mul_f32 v116, v116, v144
v_mul_f32 v117, v117, v144
v_mul_f32 v118, v118, v144
v_mul_f32 v119, v119, v144
s_mov_b64 exec, s[74:75]
ds_write_b128 v165, v[116:119] offset:0
s_mov_b64 exec, -1
v_max3_f32 v166, v166, v116, v117
v_max3_f32 v166, v166, v118, v119
v_dot2_f32_bf16 v156, v68, v12, 0
v_dot2_f32_bf16 v156, v69, v13, v156
v_dot2_f32_bf16 v156, v70, v14, v156
v_dot2_f32_bf16 v156, v71, v15, v156
v_dot2_f32_bf16 v157, v72, v12, 0
v_dot2_f32_bf16 v157, v73, v13, v157
v_dot2_f32_bf16 v157, v74, v14, v157
v_dot2_f32_bf16 v157, v75, v15, v157
v_dot2_f32_bf16 v158, v76, v12, 0
v_dot2_f32_bf16 v158, v77, v13, v158
v_dot2_f32_bf16 v158, v78, v14, v158
v_dot2_f32_bf16 v158, v79, v15, v158
v_dot2_f32_bf16 v159, v80, v12, 0
v_dot2_f32_bf16 v159, v81, v13, v159
v_dot2_f32_bf16 v159, v82, v14, v159
v_dot2_f32_bf16 v159, v83, v15, v159
s_nop 1
v_add_f32_dpp v156, v156, v156 row_ror:8 row_mask:0xf bank_mask:0xf
v_add_f32_dpp v157, v157, v157 row_ror:8 row_mask:0xf bank_mask:0xf
v_add_f32_dpp v158, v158, v158 row_ror:8 row_mask:0xf bank_mask:0xf
v_add_f32_dpp v159, v159, v159 row_ror:8 row_mask:0xf bank_mask:0xf
v_add_f32_dpp v156, v156, v156 row_ror:4 row_mask:0xf bank_mask:0xf
v_add_f32_dpp v157, v157, v157 row_ror:4 row_mask:0xf bank_mask:0xf
v_add_f32_dpp v158, v158, v158 row_ror:4 row_mask:0xf bank_mask:0xf
v_add_f32_dpp v159, v159, v159 row_ror:4 row_mask:0xf bank_mask:0xf
v_add_f32_dpp v156, v156, v156 row_ror:2 row_mask:0xf bank_mask:0xf
v_add_f32_dpp v157, v157, v157 row_ror:2 row_mask:0xf bank_mask:0xf
v_add_f32_dpp v158, v158, v158 row_ror:2 row_mask:0xf bank_mask:0xf
v_add_f32_dpp v159, v159, v159 row_ror:2 row_mask:0xf bank_mask:0xf
v_add_f32_dpp v156, v156, v156 row_ror:1 row_mask:0xf bank_mask:0xf
v_add_f32_dpp v157, v157, v157 row_ror:1 row_mask:0xf bank_mask:0xf
v_add_f32_dpp v158, v158, v158 row_ror:1 row_mask:0xf bank_mask:0xf
v_add_f32_dpp v159, v159, v159 row_ror:1 row_mask:0xf bank_mask:0xf
v_mul_f32 v156, v156, v144
v_mul_f32 v157, v157, v144
v_mul_f32 v158, v158, v144
v_mul_f32 v159, v159, v144
s_mov_b64 exec, s[74:75]
ds_write_b128 v165, v[156:159] offset:64
s_mov_b64 exec, -1
v_max3_f32 v166, v166, v156, v157
v_max3_f32 v166, v166, v158, v159
s_branch L_A_backd
L_A_bk1:
v_dot2_f32_bf16 v116, v84, v12, 0
v_dot2_f32_bf16 v116, v85, v13, v116
v_dot2_f32_bf16 v116, v86, v14, v116
v_dot2_f32_bf16 v116, v87, v15, v116
v_dot2_f32_bf16 v117, v88, v12, 0
v_dot2_f32_bf16 v117, v89, v13, v117
v_dot2_f32_bf16 v117, v90, v14, v117
v_dot2_f32_bf16 v117, v91, v15, v117
v_dot2_f32_bf16 v118, v92, v12, 0
v_dot2_f32_bf16 v118, v93, v13, v118
v_dot2_f32_bf16 v118, v94, v14, v118
v_dot2_f32_bf16 v118, v95, v15, v118
v_dot2_f32_bf16 v119, v96, v12, 0
v_dot2_f32_bf16 v119, v97, v13, v119
v_dot2_f32_bf16 v119, v98, v14, v119
v_dot2_f32_bf16 v119, v99, v15, v119
s_nop 1
v_add_f32_dpp v116, v116, v116 row_ror:8 row_mask:0xf bank_mask:0xf
v_add_f32_dpp v117, v117, v117 row_ror:8 row_mask:0xf bank_mask:0xf
v_add_f32_dpp v118, v118, v118 row_ror:8 row_mask:0xf bank_mask:0xf
v_add_f32_dpp v119, v119, v119 row_ror:8 row_mask:0xf bank_mask:0xf
v_add_f32_dpp v116, v116, v116 row_ror:4 row_mask:0xf bank_mask:0xf
v_add_f32_dpp v117, v117, v117 row_ror:4 row_mask:0xf bank_mask:0xf
v_add_f32_dpp v118, v118, v118 row_ror:4 row_mask:0xf bank_mask:0xf
v_add_f32_dpp v119, v119, v119 row_ror:4 row_mask:0xf bank_mask:0xf
v_add_f32_dpp v116, v116, v116 row_ror:2 row_mask:0xf bank_mask:0xf
v_add_f32_dpp v117, v117, v117 row_ror:2 row_mask:0xf bank_mask:0xf
v_add_f32_dpp v118, v118, v118 row_ror:2 row_mask:0xf bank_mask:0xf
v_add_f32_dpp v119, v119, v119 row_ror:2 row_mask:0xf bank_mask:0xf
v_add_f32_dpp v116, v116, v116 row_ror:1 row_mask:0xf bank_mask:0xf
v_add_f32_dpp v117, v117, v117 row_ror:1 row_mask:0xf bank_mask:0xf
v_add_f32_dpp v118, v118, v118 row_ror:1 row_mask:0xf bank_mask:0xf
v_add_f32_dpp v119, v119, v119 row_ror:1 row_mask:0xf bank_mask:0xf
v_mul_f32 v116, v116, v144
v_mul_f32 v117, v117, v144
v_mul_f32 v118, v118, v144
v_mul_f32 v119, v119, v144
s_mov_b64 exec, s[74:75]
ds_write_b128 v165, v[116:119] offset:128
s_mov_b64 exec, -1
v_max3_f32 v166, v166, v116, v117
v_max3_f32 v166, v166, v118, v119
v_dot2_f32_bf16 v156, v100, v12, 0
v_dot2_f32_bf16 v156, v101, v13, v156
v_dot2_f32_bf16 v156, v102, v14, v156
v_dot2_f32_bf16 v156, v103, v15, v156
v_dot2_f32_bf16 v157, v104, v12, 0
v_dot2_f32_bf16 v157, v105, v13, v157
v_dot2_f32_bf16 v157, v106, v14, v157
v_dot2_f32_bf16 v157, v107, v15, v157
v_dot2_f32_bf16 v158, v108, v12, 0
v_dot2_f32_bf16 v158, v109, v13, v158
v_dot2_f32_bf16 v158, v110, v14, v158
v_dot2_f32_bf16 v158, v111, v15, v158
v_dot2_f32_bf16 v159, v112, v12, 0
v_dot2_f32_bf16 v159, v113, v13, v159
v_dot2_f32_bf16 v159, v114, v14, v159
v_dot2_f32_bf16 v159, v115, v15, v159
s_nop 1
v_add_f32_dpp v156, v156, v156 row_ror:8 row_mask:0xf bank_mask:0xf
v_add_f32_dpp v157, v157, v157 row_ror:8 row_mask:0xf bank_mask:0xf
v_add_f32_dpp v158, v158, v158 row_ror:8 row_mask:0xf bank_mask:0xf
v_add_f32_dpp v159, v159, v159 row_ror:8 row_mask:0xf bank_mask:0xf
v_add_f32_dpp v156, v156, v156 row_ror:4 row_mask:0xf bank_mask:0xf
v_add_f32_dpp v157, v157, v157 row_ror:4 row_mask:0xf bank_mask:0xf
v_add_f32_dpp v158, v158, v158 row_ror:4 row_mask:0xf bank_mask:0xf
v_add_f32_dpp v159, v159, v159 row_ror:4 row_mask:0xf bank_mask:0xf
v_add_f32_dpp v156, v156, v156 row_ror:2 row_mask:0xf bank_mask:0xf
v_add_f32_dpp v157, v157, v157 row_ror:2 row_mask:0xf bank_mask:0xf
v_add_f32_dpp v158, v158, v158 row_ror:2 row_mask:0xf bank_mask:0xf
v_add_f32_dpp v159, v159, v159 row_ror:2 row_mask:0xf bank_mask:0xf
v_add_f32_dpp v156, v156, v156 row_ror:1 row_mask:0xf bank_mask:0xf
v_add_f32_dpp v157, v157, v157 row_ror:1 row_mask:0xf bank_mask:0xf
v_add_f32_dpp v158, v158, v158 row_ror:1 row_mask:0xf bank_mask:0xf
v_add_f32_dpp v159, v159, v159 row_ror:1 row_mask:0xf bank_mask:0xf
v_mul_f32 v156, v156, v144
v_mul_f32 v157, v157, v144
v_mul_f32 v158, v158, v144
v_mul_f32 v159, v159, v144
s_mov_b64 exec, s[74:75]
ds_write_b128 v165, v[156:159] offset:192
s_mov_b64 exec, -1
v_max3_f32 v166, v166, v156, v157
v_max3_f32 v166, v166, v158, v159
s_branch L_A_backd
L_A_swa:
s_mov_b32 s56, 1
v_max_f32 v166, v166, v167
v_mov_b32 v167, 0xff7fffff
v_mov_b32 v160, v16
v_mov_b32 v161, v17
v_mov_b32 v162, v18
v_mov_b32 v163, v19
s_branch L_A_swda
L_A_swa2:
s_mov_b32 s56, 1
v_max_f32 v166, v166, v167
v_mov_b32 v167, 0xff7fffff
v_mov_b32 v160, v16
v_mov_b32 v161, v17
v_mov_b32 v162, v18
v_mov_b32 v163, v19
s_branch L_A_swda2
L_A_swc:
s_mov_b32 s56, 1
s_nop 3
v_add_f32_dpp v141, v141, v141 row_bcast:15 row_mask:0xa bank_mask:0xf
s_nop 1
v_add_f32_dpp v141, v141, v141 row_bcast:31 row_mask:0xc bank_mask:0xf
s_mov_b32 exec_lo, 0
s_brev_b32 exec_hi, 1
ds_write_b64 v149, v[140:141] offset:8448
s_mov_b32 exec_lo, -1
s_mov_b32 exec_hi, 0
ds_write_b128 v148, v[136:139] offset:0
s_mov_b64 exec, -1
s_waitcnt lgkmcnt(0)
v_mov_b32 v140, v167
v_mov_b32 v141, 0
v_mov_b32 v136, 0
v_mov_b32 v137, 0
v_mov_b32 v138, 0
v_mov_b32 v139, 0
s_branch L_A_swdc
L_A_swc2:
s_mov_b32 s56, 1
s_nop 3
v_add_f32_dpp v141, v141, v141 row_bcast:15 row_mask:0xa bank_mask:0xf
s_nop 1
v_add_f32_dpp v141, v141, v141 row_bcast:31 row_mask:0xc bank_mask:0xf
s_mov_b32 exec_lo, 0
s_brev_b32 exec_hi, 1
ds_write_b64 v149, v[140:141] offset:8448
s_mov_b32 exec_lo, -1
s_mov_b32 exec_hi, 0
ds_write_b128 v148, v[136:139] offset:0
s_mov_b64 exec, -1
s_waitcnt lgkmcnt(0)
v_mov_b32 v140, v167
v_mov_b32 v141, 0
v_mov_b32 v136, 0
v_mov_b32 v137, 0
v_mov_b32 v138, 0
v_mov_b32 v139, 0
s_branch L_A_swdc2
L_A_sigc:
s_mov_b32 s65, 1
s_atomic_add s65, s[52:53], 0x400 glc
s_branch L_A_sigdc
L_A_maxb:
v_max_f32_dpp v145, v145, v145 row_bcast:15 row_mask:0xa bank_mask:0xf
s_nop 1
v_max_f32_dpp v145, v145, v145 row_bcast:31 row_mask:0xc bank_mask:0xf
s_nop 0
v_readlane_b32 s62, v145, 63
s_nop 1
v_max_f32 v143, s62, v140
v_sub_f32 v142, v140, v143
v_exp_f32 v142, v142
v_mov_b32 v140, v143
v_mul_f32 v136, v136, v142
v_mul_f32 v137, v137, v142
v_mul_f32 v138, v138, v142
v_mul_f32 v139, v139, v142
v_mul_f32 v141, v141, v142
s_branch L_A_maxdb
L_A_sigb:
s_mov_b32 s65, 1
s_atomic_add s65, s[52:53], 0x400 glc
s_branch L_A_sigdb
L_roleW:
v_and_b32 v1, 63, v0
s_mov_b32 s32, s82
s_waitcnt lgkmcnt(0)
s_lshl_b32 s60, s32, 8
s_sub_u32 s61, 0x400000, s60
s_add_u32 s40, s18, s60
s_addc_u32 s41, s19, 0
s_and_b32 s41, s41, 0xffff
s_mov_b32 s42, s61
s_mov_b32 s43, 0x20000
s_add_u32 s44, s20, s60
s_addc_u32 s45, s21, 0
s_and_b32 s45, s45, 0xffff
s_mov_b32 s46, s61
s_mov_b32 s47, 0x20000
s_mov_b32 s48, s14
s_and_b32 s49, s15, 0xffff
s_mov_b32 s50, 0x800
s_mov_b32 s51, 0x20000
v_lshrrev_b32 v192, 3, v2
v_lshlrev_b32 v192, 10, v192
v_lshl_add_u32 v192, v3, 5, v192
s_lshl_b32 s62, s34, 7
v_add_u32 v192, s62, v192
s_mov_b32 s80, 0
buffer_load_dwordx4 v[12:15], v192, s[48:51], 0 offen
buffer_load_dwordx4 v[16:19], v192, s[48:51], 0 offen offset:16
v_lshlrev_b32 v9, 17, v3
v_lshl_add_u32 v9, v2, 4, v9
s_lshl_b32 s62, s34, 19
v_add_u32 v9, s62, v9
s_xor_b32 s62, s80, 0
buffer_load_dwordx4 v[64:67], v9, s[40:43], s62 offen nt
s_xor_b32 s62, s80, 8192
buffer_load_dwordx4 v[68:71], v9, s[40:43], s62 offen nt
s_xor_b32 s62, s80, 16384
buffer_load_dwordx4 v[72:75], v9, s[40:43], s62 offen nt
s_xor_b32 s62, s80, 24576
buffer_load_dwordx4 v[76:79], v9, s[40:43], s62 offen nt
s_xor_b32 s62, s80, 32768
buffer_load_dwordx4 v[80:83], v9, s[40:43], s62 offen nt
s_xor_b32 s62, s80, 40960
buffer_load_dwordx4 v[84:87], v9, s[40:43], s62 offen nt
s_xor_b32 s62, s80, 49152
buffer_load_dwordx4 v[88:91], v9, s[40:43], s62 offen nt
s_xor_b32 s62, s80, 57344
buffer_load_dwordx4 v[92:95], v9, s[40:43], s62 offen nt
s_xor_b32 s62, s80, 65536
buffer_load_dwordx4 v[96:99], v9, s[40:43], s62 offen nt
s_xor_b32 s62, s80, 73728
buffer_load_dwordx4 v[100:103], v9, s[40:43], s62 offen nt
s_xor_b32 s62, s80, 81920
buffer_load_dwordx4 v[104:107], v9, s[40:43], s62 offen nt
s_xor_b32 s62, s80, 90112
buffer_load_dwordx4 v[108:111], v9, s[40:43], s62 offen nt
s_xor_b32 s62, s80, 98304
buffer_load_dwordx4 v[112:115], v9, s[40:43], s62 offen nt
s_xor_b32 s62, s80, 106496
buffer_load_dwordx4 v[116:119], v9, s[40:43], s62 offen nt
s_xor_b32 s62, s80, 114688
buffer_load_dwordx4 v[120:123], v9, s[40:43], s62 offen nt
s_xor_b32 s62, s80, 122880
buffer_load_dwordx4 v[124:127], v9, s[40:43], s62 offen nt
v_mov_b32 v8, 0
s_mov_b32 s52, s30
s_and_b32 s53, s31, 0xffff
s_mov_b32 s54, 0x1000000
s_mov_b32 s55, 0x20000
s_load_dword s58, s[30:31], 0x14000
v_and_b32 v192, 1, v0
v_lshlrev_b32 v192, 4, v192
v_mov_b32 v193, 0xffff
v_lshlrev_b32 v192, v192, v193
v_bfe_u32 v193, v0, 1, 2
v_cmp_eq_u32 vcc, 0, v193
s_nop 1
v_cndmask_b32 v4, 0, v192, vcc
v_cmp_eq_u32 vcc, 1, v193
s_nop 1
v_cndmask_b32 v5, 0, v192, vcc
v_cmp_eq_u32 vcc, 2, v193
s_nop 1
v_cndmask_b32 v6, 0, v192, vcc
v_cmp_eq_u32 vcc, 3, v193
s_nop 1
v_cndmask_b32 v7, 0, v192, vcc
s_barrier
s_waitcnt vmcnt(16)
s_mov_b32 s60, 0x01000100
v_perm_b32 v192, v12, v12, s60
v_and_b32 v28, v192, v4
v_and_b32 v29, v192, v5
v_and_b32 v30, v192, v6
v_and_b32 v31, v192, v7
s_waitcnt vmcnt(15)
s_nop 0
v_mfma_f32_16x16x32_bf16 v[44:47], v[28:31], v[64:67], 0
s_xor_b32 s62, s80, 0
buffer_load_dwordx4 v[128:131], v9, s[44:47], s62 offen nt
s_mov_b32 s60, 0x03020302
v_perm_b32 v193, v12, v12, s60
v_and_b32 v32, v193, v4
v_and_b32 v33, v193, v5
v_and_b32 v34, v193, v6
v_and_b32 v35, v193, v7
s_waitcnt vmcnt(15)
s_nop 0
v_mfma_f32_16x16x32_bf16 v[44:47], v[32:35], v[68:71], v[44:47]
s_xor_b32 s62, s80, 8192
buffer_load_dwordx4 v[132:135], v9, s[44:47], s62 offen nt
s_mov_b32 s60, 0x01000100
v_perm_b32 v192, v13, v13, s60
v_and_b32 v28, v192, v4
v_and_b32 v29, v192, v5
v_and_b32 v30, v192, v6
v_and_b32 v31, v192, v7
s_waitcnt vmcnt(15)
s_nop 0
v_mfma_f32_16x16x32_bf16 v[44:47], v[28:31], v[72:75], v[44:47]
s_xor_b32 s62, s80, 16384
buffer_load_dwordx4 v[136:139], v9, s[44:47], s62 offen nt
s_mov_b32 s60, 0x03020302
v_perm_b32 v193, v13, v13, s60
v_and_b32 v32, v193, v4
v_and_b32 v33, v193, v5
v_and_b32 v34, v193, v6
v_and_b32 v35, v193, v7
s_waitcnt vmcnt(15)
s_nop 0
v_mfma_f32_16x16x32_bf16 v[44:47], v[32:35], v[76:79], v[44:47]
s_xor_b32 s62, s80, 24576
buffer_load_dwordx4 v[140:143], v9, s[44:47], s62 offen nt
s_mov_b32 s60, 0x01000100
v_perm_b32 v192, v14, v14, s60
v_and_b32 v28, v192, v4
v_and_b32 v29, v192, v5
v_and_b32 v30, v192, v6
v_and_b32 v31, v192, v7
s_waitcnt vmcnt(15)
s_nop 0
v_mfma_f32_16x16x32_bf16 v[44:47], v[28:31], v[80:83], v[44:47]
s_xor_b32 s62, s80, 32768
buffer_load_dwordx4 v[144:147], v9, s[44:47], s62 offen nt
s_mov_b32 s60, 0x03020302
v_perm_b32 v193, v14, v14, s60
v_and_b32 v32, v193, v4
v_and_b32 v33, v193, v5
v_and_b32 v34, v193, v6
v_and_b32 v35, v193, v7
s_waitcnt vmcnt(15)
s_nop 0
v_mfma_f32_16x16x32_bf16 v[44:47], v[32:35], v[84:87], v[44:47]
s_xor_b32 s62, s80, 40960
buffer_load_dwordx4 v[148:151], v9, s[44:47], s62 offen nt
s_mov_b32 s60, 0x01000100
v_perm_b32 v192, v15, v15, s60
v_and_b32 v28, v192, v4
v_and_b32 v29, v192, v5
v_and_b32 v30, v192, v6
v_and_b32 v31, v192, v7
s_waitcnt vmcnt(15)
s_nop 0
v_mfma_f32_16x16x32_bf16 v[44:47], v[28:31], v[88:91], v[44:47]
s_xor_b32 s62, s80, 49152
buffer_load_dwordx4 v[152:155], v9, s[44:47], s62 offen nt
s_mov_b32 s60, 0x03020302
v_perm_b32 v193, v15, v15, s60
v_and_b32 v32, v193, v4
v_and_b32 v33, v193, v5
v_and_b32 v34, v193, v6
v_and_b32 v35, v193, v7
s_waitcnt vmcnt(15)
s_nop 0
v_mfma_f32_16x16x32_bf16 v[44:47], v[32:35], v[92:95], v[44:47]
s_xor_b32 s62, s80, 57344
buffer_load_dwordx4 v[156:159], v9, s[44:47], s62 offen nt
s_mov_b32 s60, 0x01000100
v_perm_b32 v192, v16, v16, s60
v_and_b32 v28, v192, v4
v_and_b32 v29, v192, v5
v_and_b32 v30, v192, v6
v_and_b32 v31, v192, v7
s_waitcnt vmcnt(15)
s_nop 0
v_mfma_f32_16x16x32_bf16 v[44:47], v[28:31], v[96:99], v[44:47]
s_xor_b32 s62, s80, 65536
buffer_load_dwordx4 v[160:163], v9, s[44:47], s62 offen nt
s_mov_b32 s60, 0x03020302
v_perm_b32 v193, v16, v16, s60
v_and_b32 v32, v193, v4
v_and_b32 v33, v193, v5
v_and_b32 v34, v193, v6
v_and_b32 v35, v193, v7
s_waitcnt vmcnt(15)
s_nop 0
v_mfma_f32_16x16x32_bf16 v[44:47], v[32:35], v[100:103], v[44:47]
s_xor_b32 s62, s80, 73728
buffer_load_dwordx4 v[164:167], v9, s[44:47], s62 offen nt
s_mov_b32 s60, 0x01000100
v_perm_b32 v192, v17, v17, s60
v_and_b32 v28, v192, v4
v_and_b32 v29, v192, v5
v_and_b32 v30, v192, v6
v_and_b32 v31, v192, v7
s_waitcnt vmcnt(15)
s_nop 0
v_mfma_f32_16x16x32_bf16 v[44:47], v[28:31], v[104:107], v[44:47]
s_xor_b32 s62, s80, 81920
buffer_load_dwordx4 v[168:171], v9, s[44:47], s62 offen nt
s_mov_b32 s60, 0x03020302
v_perm_b32 v193, v17, v17, s60
v_and_b32 v32, v193, v4
v_and_b32 v33, v193, v5
v_and_b32 v34, v193, v6
v_and_b32 v35, v193, v7
s_waitcnt vmcnt(15)
s_nop 0
v_mfma_f32_16x16x32_bf16 v[44:47], v[32:35], v[108:111], v[44:47]
s_xor_b32 s62, s80, 90112
buffer_load_dwordx4 v[172:175], v9, s[44:47], s62 offen nt
s_mov_b32 s60, 0x01000100
v_perm_b32 v192, v18, v18, s60
v_and_b32 v28, v192, v4
v_and_b32 v29, v192, v5
v_and_b32 v30, v192, v6
v_and_b32 v31, v192, v7
s_waitcnt vmcnt(15)
s_nop 0
v_mfma_f32_16x16x32_bf16 v[44:47], v[28:31], v[112:115], v[44:47]
s_xor_b32 s62, s80, 98304
buffer_load_dwordx4 v[176:179], v9, s[44:47], s62 offen nt
s_mov_b32 s60, 0x03020302
v_perm_b32 v193, v18, v18, s60
v_and_b32 v32, v193, v4
v_and_b32 v33, v193, v5
v_and_b32 v34, v193, v6
v_and_b32 v35, v193, v7
s_waitcnt vmcnt(15)
s_nop 0
v_mfma_f32_16x16x32_bf16 v[44:47], v[32:35], v[116:119], v[44:47]
s_xor_b32 s62, s80, 106496
buffer_load_dwordx4 v[180:183], v9, s[44:47], s62 offen nt
s_mov_b32 s60, 0x01000100
v_perm_b32 v192, v19, v19, s60
v_and_b32 v28, v192, v4
v_and_b32 v29, v192, v5
v_and_b32 v30, v192, v6
v_and_b32 v31, v192, v7
s_waitcnt vmcnt(15)
s_nop 0
v_mfma_f32_16x16x32_bf16 v[44:47], v[28:31], v[120:123], v[44:47]
s_xor_b32 s62, s80, 114688
buffer_load_dwordx4 v[184:187], v9, s[44:47], s62 offen nt
s_mov_b32 s60, 0x03020302
v_perm_b32 v193, v19, v19, s60
v_and_b32 v32, v193, v4
v_and_b32 v33, v193, v5
v_and_b32 v34, v193, v6
v_and_b32 v35, v193, v7
s_waitcnt vmcnt(15)
s_nop 0
v_mfma_f32_16x16x32_bf16 v[44:47], v[32:35], v[124:127], v[44:47]
s_xor_b32 s62, s80, 122880
buffer_load_dwordx4 v[188:191], v9, s[44:47], s62 offen nt
v_lshrrev_b32 v192, 1, v3
v_lshlrev_b32 v192, 9, v192
v_lshl_add_u32 v192, v2, 5, v192
v_and_b32 v193, 1, v3
v_lshl_add_u32 v192, v193, 4, v192
s_lshl_b32 s63, s34, 10
v_add_u32 v192, s63, v192
s_nop 1
s_nop 5
ds_write_b128 v192, v[44:47] offset:0
s_waitcnt lgkmcnt(0)
s_barrier
s_cmp_ge_u32 s34, 4
s_cbranch_scc1 L_W_qskip
v_lshlrev_b32 v194, 2, v0
ds_read_b32 v196, v194 offset:0
ds_read_b32 v197, v194 offset:1024
ds_read_b32 v198, v194 offset:2048
ds_read_b32 v199, v194 offset:3072
ds_read_b32 v200, v194 offset:4096
ds_read_b32 v201, v194 offset:5120
ds_read_b32 v202, v194 offset:6144
ds_read_b32 v203, v194 offset:7168
s_waitcnt lgkmcnt(0)
v_add_f32 v196, v196, v197
v_add_f32 v196, v196, v198
v_add_f32 v196, v196, v199
v_add_f32 v196, v196, v200
v_add_f32 v196, v196, v201
v_add_f32 v196, v196, v202
v_add_f32 v196, v196, v203
v_cvt_pk_bf16_f32 v196, v196, v196
v_lshlrev_b32 v194, 1, v0
ds_write_b16 v194, v196 offset:8192
s_waitcnt lgkmcnt(0)
L_W_qskip:
s_barrier
v_lshlrev_b32 v194, 4, v2
ds_read_b128 v[20:23], v194 offset:8192
ds_read_b128 v[24:27], v194 offset:8448
s_lshl_b32 s60, s32, 8
s_sub_u32 s61, 0x400000, s60
s_add_u32 s40, s22, s60
s_addc_u32 s41, s23, 0
s_and_b32 s41, s41, 0xffff
s_mov_b32 s42, s61
s_mov_b32 s43, 0x20000
s_xor_b32 s62, s80, 0
buffer_load_dwordx4 v[64:67], v9, s[40:43], s62 offen nt
s_xor_b32 s62, s80, 8192
buffer_load_dwordx4 v[68:71], v9, s[40:43], s62 offen nt
s_xor_b32 s62, s80, 16384
buffer_load_dwordx4 v[72:75], v9, s[40:43], s62 offen nt
s_xor_b32 s62, s80, 24576
buffer_load_dwordx4 v[76:79], v9, s[40:43], s62 offen nt
s_xor_b32 s62, s80, 32768
buffer_load_dwordx4 v[80:83], v9, s[40:43], s62 offen nt
s_xor_b32 s62, s80, 40960
buffer_load_dwordx4 v[84:87], v9, s[40:43], s62 offen nt
s_xor_b32 s62, s80, 49152
buffer_load_dwordx4 v[88:91], v9, s[40:43], s62 offen nt
s_xor_b32 s62, s80, 57344
buffer_load_dwordx4 v[92:95], v9, s[40:43], s62 offen nt
s_xor_b32 s62, s80, 65536
buffer_load_dwordx4 v[96:99], v9, s[40:43], s62 offen nt
s_xor_b32 s62, s80, 73728
buffer_load_dwordx4 v[100:103], v9, s[40:43], s62 offen nt
s_xor_b32 s62, s80, 81920
buffer_load_dwordx4 v[104:107], v9, s[40:43], s62 offen nt
s_xor_b32 s62, s80, 90112
buffer_load_dwordx4 v[108:111], v9, s[40:43], s62 offen nt
s_xor_b32 s62, s80, 98304
buffer_load_dwordx4 v[112:115], v9, s[40:43], s62 offen nt
s_xor_b32 s62, s80, 106496
buffer_load_dwordx4 v[116:119], v9, s[40:43], s62 offen nt
s_xor_b32 s62, s80, 114688
buffer_load_dwordx4 v[120:123], v9, s[40:43], s62 offen nt
s_xor_b32 s62, s80, 122880
buffer_load_dwordx4 v[124:127], v9, s[40:43], s62 offen nt
s_lshl_b32 s60, s32, 17
s_mov_b32 s61, 0x20000
s_add_u32 s44, s24, s60
s_addc_u32 s45, s25, 0
s_and_b32 s45, s45, 0xffff
s_mov_b32 s46, s61
s_mov_b32 s47, 0x20000
v_lshlrev_b32 v10, 12, v3
v_lshl_add_u32 v10, v2, 4, v10
s_lshl_b32 s62, s34, 14
v_add_u32 v10, s62, v10
v_mov_b32 v200, 0
v_mov_b32 v201, 0
s_lshr_b32 s62, s80, 13
v_xor_b32 v202, s62, v2
s_waitcnt lgkmcnt(0)
s_add_u32 s58, s58, 0x9e3779b9
s_bfe_u32 s76, s58, 0x80000
s_bfe_u32 s77, s58, 0x80008
s_bfe_u32 s78, s58, 0x80010
s_bfe_u32 s79, s58, 0x80018
s_waitcnt vmcnt(30)
v_dot2_f32_bf16 v60, v128, v20, 0
v_dot2_f32_bf16 v61, v128, v24, 0
v_dot2_f32_bf16 v62, v132, v20, 0
v_dot2_f32_bf16 v63, v132, v24, 0
v_dot2_f32_bf16 v60, v129, v21, v60
v_dot2_f32_bf16 v61, v129, v25, v61
v_dot2_f32_bf16 v62, v133, v21, v62
v_dot2_f32_bf16 v63, v133, v25, v63
v_dot2_f32_bf16 v60, v130, v22, v60
v_dot2_f32_bf16 v61, v130, v26, v61
v_dot2_f32_bf16 v62, v134, v22, v62
v_dot2_f32_bf16 v63, v134, v26, v63
v_dot2_f32_bf16 v60, v131, v23, v60
v_dot2_f32_bf16 v61, v131, v27, v61
v_dot2_f32_bf16 v62, v135, v23, v62
v_dot2_f32_bf16 v63, v135, v27, v63
buffer_load_dwordx4 v[128:131], v10, s[44:47], 0 offen offset:0 nt
buffer_load_dwordx4 v[132:135], v10, s[44:47], 0 offen offset:256 nt
v_add_f32_dpp v60, v60, v60 row_ror:8 row_mask:0xf bank_mask:0xf
v_add_f32_dpp v61, v61, v61 row_ror:8 row_mask:0xf bank_mask:0xf
v_add_f32_dpp v62, v62, v62 row_ror:8 row_mask:0xf bank_mask:0xf
v_add_f32_dpp v63, v63, v63 row_ror:8 row_mask:0xf bank_mask:0xf
v_add_f32_dpp v60, v60, v60 row_ror:4 row_mask:0xf bank_mask:0xf
v_add_f32_dpp v61, v61, v61 row_ror:4 row_mask:0xf bank_mask:0xf
v_add_f32_dpp v62, v62, v62 row_ror:4 row_mask:0xf bank_mask:0xf
v_add_f32_dpp v63, v63, v63 row_ror:4 row_mask:0xf bank_mask:0xf
v_add_f32_dpp v60, v60, v60 row_ror:2 row_mask:0xf bank_mask:0xf
v_add_f32_dpp v61, v61, v61 row_ror:2 row_mask:0xf bank_mask:0xf
v_add_f32_dpp v62, v62, v62 row_ror:2 row_mask:0xf bank_mask:0xf
v_add_f32_dpp v63, v63, v63 row_ror:2 row_mask:0xf bank_mask:0xf
v_add_f32_dpp v60, v60, v60 row_ror:1 row_mask:0xf bank_mask:0xf
v_add_f32_dpp v61, v61, v61 row_ror:1 row_mask:0xf bank_mask:0xf
v_add_f32_dpp v62, v62, v62 row_ror:1 row_mask:0xf bank_mask:0xf
v_add_f32_dpp v63, v63, v63 row_ror:1 row_mask:0xf bank_mask:0xf
v_cmp_eq_u32 vcc, 0, v202
s_nop 1
v_cndmask_b32 v200, v200, v60, vcc
v_cndmask_b32 v201, v201, v61, vcc
v_cmp_eq_u32 vcc, 1, v202
s_nop 1
v_cndmask_b32 v200, v200, v62, vcc
v_cndmask_b32 v201, v201, v63, vcc
s_waitcnt vmcnt(30)
v_dot2_f32_bf16 v60, v136, v20, 0
v_dot2_f32_bf16 v61, v136, v24, 0
v_dot2_f32_bf16 v62, v140, v20, 0
v_dot2_f32_bf16 v63, v140, v24, 0
v_dot2_f32_bf16 v60, v137, v21, v60
v_dot2_f32_bf16 v61, v137, v25, v61
v_dot2_f32_bf16 v62, v141, v21, v62
v_dot2_f32_bf16 v63, v141, v25, v63
v_dot2_f32_bf16 v60, v138, v22, v60
v_dot2_f32_bf16 v61, v138, v26, v61
v_dot2_f32_bf16 v62, v142, v22, v62
v_dot2_f32_bf16 v63, v142, v26, v63
v_dot2_f32_bf16 v60, v139, v23, v60
v_dot2_f32_bf16 v61, v139, v27, v61
v_dot2_f32_bf16 v62, v143, v23, v62
v_dot2_f32_bf16 v63, v143, v27, v63
buffer_load_dwordx4 v[136:139], v10, s[44:47], 0 offen offset:512 nt
buffer_load_dwordx4 v[140:143], v10, s[44:47], 0 offen offset:768 nt
v_add_f32_dpp v60, v60, v60 row_ror:8 row_mask:0xf bank_mask:0xf
v_add_f32_dpp v61, v61, v61 row_ror:8 row_mask:0xf bank_mask:0xf
v_add_f32_dpp v62, v62, v62 row_ror:8 row_mask:0xf bank_mask:0xf
v_add_f32_dpp v63, v63, v63 row_ror:8 row_mask:0xf bank_mask:0xf
v_add_f32_dpp v60, v60, v60 row_ror:4 row_mask:0xf bank_mask:0xf
v_add_f32_dpp v61, v61, v61 row_ror:4 row_mask:0xf bank_mask:0xf
v_add_f32_dpp v62, v62, v62 row_ror:4 row_mask:0xf bank_mask:0xf
v_add_f32_dpp v63, v63, v63 row_ror:4 row_mask:0xf bank_mask:0xf
v_add_f32_dpp v60, v60, v60 row_ror:2 row_mask:0xf bank_mask:0xf
v_add_f32_dpp v61, v61, v61 row_ror:2 row_mask:0xf bank_mask:0xf
v_add_f32_dpp v62, v62, v62 row_ror:2 row_mask:0xf bank_mask:0xf
v_add_f32_dpp v63, v63, v63 row_ror:2 row_mask:0xf bank_mask:0xf
v_add_f32_dpp v60, v60, v60 row_ror:1 row_mask:0xf bank_mask:0xf
v_add_f32_dpp v61, v61, v61 row_ror:1 row_mask:0xf bank_mask:0xf
v_add_f32_dpp v62, v62, v62 row_ror:1 row_mask:0xf bank_mask:0xf
v_add_f32_dpp v63, v63, v63 row_ror:1 row_mask:0xf bank_mask:0xf
v_cmp_eq_u32 vcc, 2, v202
s_nop 1
v_cndmask_b32 v200, v200, v60, vcc
v_cndmask_b32 v201, v201, v61, vcc
v_cmp_eq_u32 vcc, 3, v202
s_nop 1
v_cndmask_b32 v200, v200, v62, vcc
v_cndmask_b32 v201, v201, v63, vcc
s_waitcnt vmcnt(30)
v_dot2_f32_bf16 v60, v144, v20, 0
v_dot2_f32_bf16 v61, v144, v24, 0
v_dot2_f32_bf16 v62, v148, v20, 0
v_dot2_f32_bf16 v63, v148, v24, 0
v_dot2_f32_bf16 v60, v145, v21, v60
v_dot2_f32_bf16 v61, v145, v25, v61
v_dot2_f32_bf16 v62, v149, v21, v62
v_dot2_f32_bf16 v63, v149, v25, v63
v_dot2_f32_bf16 v60, v146, v22, v60
v_dot2_f32_bf16 v61, v146, v26, v61
v_dot2_f32_bf16 v62, v150, v22, v62
v_dot2_f32_bf16 v63, v150, v26, v63
v_dot2_f32_bf16 v60, v147, v23, v60
v_dot2_f32_bf16 v61, v147, v27, v61
v_dot2_f32_bf16 v62, v151, v23, v62
v_dot2_f32_bf16 v63, v151, v27, v63
buffer_load_dwordx4 v[144:147], v10, s[44:47], 0 offen offset:1024 nt
buffer_load_dwordx4 v[148:151], v10, s[44:47], 0 offen offset:1280 nt
v_add_f32_dpp v60, v60, v60 row_ror:8 row_mask:0xf bank_mask:0xf
v_add_f32_dpp v61, v61, v61 row_ror:8 row_mask:0xf bank_mask:0xf
v_add_f32_dpp v62, v62, v62 row_ror:8 row_mask:0xf bank_mask:0xf
v_add_f32_dpp v63, v63, v63 row_ror:8 row_mask:0xf bank_mask:0xf
v_add_f32_dpp v60, v60, v60 row_ror:4 row_mask:0xf bank_mask:0xf
v_add_f32_dpp v61, v61, v61 row_ror:4 row_mask:0xf bank_mask:0xf
v_add_f32_dpp v62, v62, v62 row_ror:4 row_mask:0xf bank_mask:0xf
v_add_f32_dpp v63, v63, v63 row_ror:4 row_mask:0xf bank_mask:0xf
v_add_f32_dpp v60, v60, v60 row_ror:2 row_mask:0xf bank_mask:0xf
v_add_f32_dpp v61, v61, v61 row_ror:2 row_mask:0xf bank_mask:0xf
v_add_f32_dpp v62, v62, v62 row_ror:2 row_mask:0xf bank_mask:0xf
v_add_f32_dpp v63, v63, v63 row_ror:2 row_mask:0xf bank_mask:0xf
v_add_f32_dpp v60, v60, v60 row_ror:1 row_mask:0xf bank_mask:0xf
v_add_f32_dpp v61, v61, v61 row_ror:1 row_mask:0xf bank_mask:0xf
v_add_f32_dpp v62, v62, v62 row_ror:1 row_mask:0xf bank_mask:0xf
v_add_f32_dpp v63, v63, v63 row_ror:1 row_mask:0xf bank_mask:0xf
v_cmp_eq_u32 vcc, 4, v202
s_nop 1
v_cndmask_b32 v200, v200, v60, vcc
v_cndmask_b32 v201, v201, v61, vcc
v_cmp_eq_u32 vcc, 5, v202
s_nop 1
v_cndmask_b32 v200, v200, v62, vcc
v_cndmask_b32 v201, v201, v63, vcc
s_waitcnt vmcnt(30)
v_dot2_f32_bf16 v60, v152, v20, 0
v_dot2_f32_bf16 v61, v152, v24, 0
v_dot2_f32_bf16 v62, v156, v20, 0
v_dot2_f32_bf16 v63, v156, v24, 0
v_dot2_f32_bf16 v60, v153, v21, v60
v_dot2_f32_bf16 v61, v153, v25, v61
v_dot2_f32_bf16 v62, v157, v21, v62
v_dot2_f32_bf16 v63, v157, v25, v63
v_dot2_f32_bf16 v60, v154, v22, v60
v_dot2_f32_bf16 v61, v154, v26, v61
v_dot2_f32_bf16 v62, v158, v22, v62
v_dot2_f32_bf16 v63, v158, v26, v63
v_dot2_f32_bf16 v60, v155, v23, v60
v_dot2_f32_bf16 v61, v155, v27, v61
v_dot2_f32_bf16 v62, v159, v23, v62
v_dot2_f32_bf16 v63, v159, v27, v63
buffer_load_dwordx4 v[152:155], v10, s[44:47], 0 offen offset:1536 nt
buffer_load_dwordx4 v[156:159], v10, s[44:47], 0 offen offset:1792 nt
v_add_f32_dpp v60, v60, v60 row_ror:8 row_mask:0xf bank_mask:0xf
v_add_f32_dpp v61, v61, v61 row_ror:8 row_mask:0xf bank_mask:0xf
v_add_f32_dpp v62, v62, v62 row_ror:8 row_mask:0xf bank_mask:0xf
v_add_f32_dpp v63, v63, v63 row_ror:8 row_mask:0xf bank_mask:0xf
v_add_f32_dpp v60, v60, v60 row_ror:4 row_mask:0xf bank_mask:0xf
v_add_f32_dpp v61, v61, v61 row_ror:4 row_mask:0xf bank_mask:0xf
v_add_f32_dpp v62, v62, v62 row_ror:4 row_mask:0xf bank_mask:0xf
v_add_f32_dpp v63, v63, v63 row_ror:4 row_mask:0xf bank_mask:0xf
v_add_f32_dpp v60, v60, v60 row_ror:2 row_mask:0xf bank_mask:0xf
v_add_f32_dpp v61, v61, v61 row_ror:2 row_mask:0xf bank_mask:0xf
v_add_f32_dpp v62, v62, v62 row_ror:2 row_mask:0xf bank_mask:0xf
v_add_f32_dpp v63, v63, v63 row_ror:2 row_mask:0xf bank_mask:0xf
v_add_f32_dpp v60, v60, v60 row_ror:1 row_mask:0xf bank_mask:0xf
v_add_f32_dpp v61, v61, v61 row_ror:1 row_mask:0xf bank_mask:0xf
v_add_f32_dpp v62, v62, v62 row_ror:1 row_mask:0xf bank_mask:0xf
v_add_f32_dpp v63, v63, v63 row_ror:1 row_mask:0xf bank_mask:0xf
v_cmp_eq_u32 vcc, 6, v202
s_nop 1
v_cndmask_b32 v200, v200, v60, vcc
v_cndmask_b32 v201, v201, v61, vcc
v_cmp_eq_u32 vcc, 7, v202
s_nop 1
v_cndmask_b32 v200, v200, v62, vcc
v_cndmask_b32 v201, v201, v63, vcc
s_waitcnt vmcnt(30)
v_dot2_f32_bf16 v60, v160, v20, 0
v_dot2_f32_bf16 v61, v160, v24, 0
v_dot2_f32_bf16 v62, v164, v20, 0
v_dot2_f32_bf16 v63, v164, v24, 0
v_dot2_f32_bf16 v60, v161, v21, v60
v_dot2_f32_bf16 v61, v161, v25, v61
v_dot2_f32_bf16 v62, v165, v21, v62
v_dot2_f32_bf16 v63, v165, v25, v63
v_dot2_f32_bf16 v60, v162, v22, v60
v_dot2_f32_bf16 v61, v162, v26, v61
v_dot2_f32_bf16 v62, v166, v22, v62
v_dot2_f32_bf16 v63, v166, v26, v63
v_dot2_f32_bf16 v60, v163, v23, v60
v_dot2_f32_bf16 v61, v163, v27, v61
v_dot2_f32_bf16 v62, v167, v23, v62
v_dot2_f32_bf16 v63, v167, v27, v63
buffer_load_dwordx4 v[160:163], v10, s[44:47], 0 offen offset:2048 nt
buffer_load_dwordx4 v[164:167], v10, s[44:47], 0 offen offset:2304 nt
v_add_f32_dpp v60, v60, v60 row_ror:8 row_mask:0xf bank_mask:0xf
v_add_f32_dpp v61, v61, v61 row_ror:8 row_mask:0xf bank_mask:0xf
v_add_f32_dpp v62, v62, v62 row_ror:8 row_mask:0xf bank_mask:0xf
v_add_f32_dpp v63, v63, v63 row_ror:8 row_mask:0xf bank_mask:0xf
v_add_f32_dpp v60, v60, v60 row_ror:4 row_mask:0xf bank_mask:0xf
v_add_f32_dpp v61, v61, v61 row_ror:4 row_mask:0xf bank_mask:0xf
v_add_f32_dpp v62, v62, v62 row_ror:4 row_mask:0xf bank_mask:0xf
v_add_f32_dpp v63, v63, v63 row_ror:4 row_mask:0xf bank_mask:0xf
v_add_f32_dpp v60, v60, v60 row_ror:2 row_mask:0xf bank_mask:0xf
v_add_f32_dpp v61, v61, v61 row_ror:2 row_mask:0xf bank_mask:0xf
v_add_f32_dpp v62, v62, v62 row_ror:2 row_mask:0xf bank_mask:0xf
v_add_f32_dpp v63, v63, v63 row_ror:2 row_mask:0xf bank_mask:0xf
v_add_f32_dpp v60, v60, v60 row_ror:1 row_mask:0xf bank_mask:0xf
v_add_f32_dpp v61, v61, v61 row_ror:1 row_mask:0xf bank_mask:0xf
v_add_f32_dpp v62, v62, v62 row_ror:1 row_mask:0xf bank_mask:0xf
v_add_f32_dpp v63, v63, v63 row_ror:1 row_mask:0xf bank_mask:0xf
v_cmp_eq_u32 vcc, 8, v202
s_nop 1
v_cndmask_b32 v200, v200, v60, vcc
v_cndmask_b32 v201, v201, v61, vcc
v_cmp_eq_u32 vcc, 9, v202
s_nop 1
v_cndmask_b32 v200, v200, v62, vcc
v_cndmask_b32 v201, v201, v63, vcc
s_waitcnt vmcnt(30)
v_dot2_f32_bf16 v60, v168, v20, 0
v_dot2_f32_bf16 v61, v168, v24, 0
v_dot2_f32_bf16 v62, v172, v20, 0
v_dot2_f32_bf16 v63, v172, v24, 0
v_dot2_f32_bf16 v60, v169, v21, v60
v_dot2_f32_bf16 v61, v169, v25, v61
v_dot2_f32_bf16 v62, v173, v21, v62
v_dot2_f32_bf16 v63, v173, v25, v63
v_dot2_f32_bf16 v60, v170, v22, v60
v_dot2_f32_bf16 v61, v170, v26, v61
v_dot2_f32_bf16 v62, v174, v22, v62
v_dot2_f32_bf16 v63, v174, v26, v63
v_dot2_f32_bf16 v60, v171, v23, v60
v_dot2_f32_bf16 v61, v171, v27, v61
v_dot2_f32_bf16 v62, v175, v23, v62
v_dot2_f32_bf16 v63, v175, v27, v63
buffer_load_dwordx4 v[168:171], v10, s[44:47], 0 offen offset:2560 nt
buffer_load_dwordx4 v[172:175], v10, s[44:47], 0 offen offset:2816 nt
v_add_f32_dpp v60, v60, v60 row_ror:8 row_mask:0xf bank_mask:0xf
v_add_f32_dpp v61, v61, v61 row_ror:8 row_mask:0xf bank_mask:0xf
v_add_f32_dpp v62, v62, v62 row_ror:8 row_mask:0xf bank_mask:0xf
v_add_f32_dpp v63, v63, v63 row_ror:8 row_mask:0xf bank_mask:0xf
v_add_f32_dpp v60, v60, v60 row_ror:4 row_mask:0xf bank_mask:0xf
v_add_f32_dpp v61, v61, v61 row_ror:4 row_mask:0xf bank_mask:0xf
v_add_f32_dpp v62, v62, v62 row_ror:4 row_mask:0xf bank_mask:0xf
v_add_f32_dpp v63, v63, v63 row_ror:4 row_mask:0xf bank_mask:0xf
v_add_f32_dpp v60, v60, v60 row_ror:2 row_mask:0xf bank_mask:0xf
v_add_f32_dpp v61, v61, v61 row_ror:2 row_mask:0xf bank_mask:0xf
v_add_f32_dpp v62, v62, v62 row_ror:2 row_mask:0xf bank_mask:0xf
v_add_f32_dpp v63, v63, v63 row_ror:2 row_mask:0xf bank_mask:0xf
v_add_f32_dpp v60, v60, v60 row_ror:1 row_mask:0xf bank_mask:0xf
v_add_f32_dpp v61, v61, v61 row_ror:1 row_mask:0xf bank_mask:0xf
v_add_f32_dpp v62, v62, v62 row_ror:1 row_mask:0xf bank_mask:0xf
v_add_f32_dpp v63, v63, v63 row_ror:1 row_mask:0xf bank_mask:0xf
v_cmp_eq_u32 vcc, 10, v202
s_nop 1
v_cndmask_b32 v200, v200, v60, vcc
v_cndmask_b32 v201, v201, v61, vcc
v_cmp_eq_u32 vcc, 11, v202
s_nop 1
v_cndmask_b32 v200, v200, v62, vcc
v_cndmask_b32 v201, v201, v63, vcc
s_waitcnt vmcnt(30)
v_dot2_f32_bf16 v60, v176, v20, 0
v_dot2_f32_bf16 v61, v176, v24, 0
v_dot2_f32_bf16 v62, v180, v20, 0
v_dot2_f32_bf16 v63, v180, v24, 0
v_dot2_f32_bf16 v60, v177, v21, v60
v_dot2_f32_bf16 v61, v177, v25, v61
v_dot2_f32_bf16 v62, v181, v21, v62
v_dot2_f32_bf16 v63, v181, v25, v63
v_dot2_f32_bf16 v60, v178, v22, v60
v_dot2_f32_bf16 v61, v178, v26, v61
v_dot2_f32_bf16 v62, v182, v22, v62
v_dot2_f32_bf16 v63, v182, v26, v63
v_dot2_f32_bf16 v60, v179, v23, v60
v_dot2_f32_bf16 v61, v179, v27, v61
v_dot2_f32_bf16 v62, v183, v23, v62
v_dot2_f32_bf16 v63, v183, v27, v63
buffer_load_dwordx4 v[176:179], v10, s[44:47], 0 offen offset:3072 nt
buffer_load_dwordx4 v[180:183], v10, s[44:47], 0 offen offset:3328 nt
v_add_f32_dpp v60, v60, v60 row_ror:8 row_mask:0xf bank_mask:0xf
v_add_f32_dpp v61, v61, v61 row_ror:8 row_mask:0xf bank_mask:0xf
v_add_f32_dpp v62, v62, v62 row_ror:8 row_mask:0xf bank_mask:0xf
v_add_f32_dpp v63, v63, v63 row_ror:8 row_mask:0xf bank_mask:0xf
v_add_f32_dpp v60, v60, v60 row_ror:4 row_mask:0xf bank_mask:0xf
v_add_f32_dpp v61, v61, v61 row_ror:4 row_mask:0xf bank_mask:0xf
v_add_f32_dpp v62, v62, v62 row_ror:4 row_mask:0xf bank_mask:0xf
v_add_f32_dpp v63, v63, v63 row_ror:4 row_mask:0xf bank_mask:0xf
v_add_f32_dpp v60, v60, v60 row_ror:2 row_mask:0xf bank_mask:0xf
v_add_f32_dpp v61, v61, v61 row_ror:2 row_mask:0xf bank_mask:0xf
v_add_f32_dpp v62, v62, v62 row_ror:2 row_mask:0xf bank_mask:0xf
v_add_f32_dpp v63, v63, v63 row_ror:2 row_mask:0xf bank_mask:0xf
v_add_f32_dpp v60, v60, v60 row_ror:1 row_mask:0xf bank_mask:0xf
v_add_f32_dpp v61, v61, v61 row_ror:1 row_mask:0xf bank_mask:0xf
v_add_f32_dpp v62, v62, v62 row_ror:1 row_mask:0xf bank_mask:0xf
v_add_f32_dpp v63, v63, v63 row_ror:1 row_mask:0xf bank_mask:0xf
v_cmp_eq_u32 vcc, 12, v202
s_nop 1
v_cndmask_b32 v200, v200, v60, vcc
v_cndmask_b32 v201, v201, v61, vcc
v_cmp_eq_u32 vcc, 13, v202
s_nop 1
v_cndmask_b32 v200, v200, v62, vcc
v_cndmask_b32 v201, v201, v63, vcc
s_waitcnt vmcnt(30)
v_dot2_f32_bf16 v60, v184, v20, 0
v_dot2_f32_bf16 v61, v184, v24, 0
v_dot2_f32_bf16 v62, v188, v20, 0
v_dot2_f32_bf16 v63, v188, v24, 0
v_dot2_f32_bf16 v60, v185, v21, v60
v_dot2_f32_bf16 v61, v185, v25, v61
v_dot2_f32_bf16 v62, v189, v21, v62
v_dot2_f32_bf16 v63, v189, v25, v63
v_dot2_f32_bf16 v60, v186, v22, v60
v_dot2_f32_bf16 v61, v186, v26, v61
v_dot2_f32_bf16 v62, v190, v22, v62
v_dot2_f32_bf16 v63, v190, v26, v63
v_dot2_f32_bf16 v60, v187, v23, v60
v_dot2_f32_bf16 v61, v187, v27, v61
v_dot2_f32_bf16 v62, v191, v23, v62
v_dot2_f32_bf16 v63, v191, v27, v63
buffer_load_dwordx4 v[184:187], v10, s[44:47], 0 offen offset:3584 nt
buffer_load_dwordx4 v[188:191], v10, s[44:47], 0 offen offset:3840 nt
v_add_f32_dpp v60, v60, v60 row_ror:8 row_mask:0xf bank_mask:0xf
v_add_f32_dpp v61, v61, v61 row_ror:8 row_mask:0xf bank_mask:0xf
v_add_f32_dpp v62, v62, v62 row_ror:8 row_mask:0xf bank_mask:0xf
v_add_f32_dpp v63, v63, v63 row_ror:8 row_mask:0xf bank_mask:0xf
v_add_f32_dpp v60, v60, v60 row_ror:4 row_mask:0xf bank_mask:0xf
v_add_f32_dpp v61, v61, v61 row_ror:4 row_mask:0xf bank_mask:0xf
v_add_f32_dpp v62, v62, v62 row_ror:4 row_mask:0xf bank_mask:0xf
v_add_f32_dpp v63, v63, v63 row_ror:4 row_mask:0xf bank_mask:0xf
v_add_f32_dpp v60, v60, v60 row_ror:2 row_mask:0xf bank_mask:0xf
v_add_f32_dpp v61, v61, v61 row_ror:2 row_mask:0xf bank_mask:0xf
v_add_f32_dpp v62, v62, v62 row_ror:2 row_mask:0xf bank_mask:0xf
v_add_f32_dpp v63, v63, v63 row_ror:2 row_mask:0xf bank_mask:0xf
v_add_f32_dpp v60, v60, v60 row_ror:1 row_mask:0xf bank_mask:0xf
v_add_f32_dpp v61, v61, v61 row_ror:1 row_mask:0xf bank_mask:0xf
v_add_f32_dpp v62, v62, v62 row_ror:1 row_mask:0xf bank_mask:0xf
v_add_f32_dpp v63, v63, v63 row_ror:1 row_mask:0xf bank_mask:0xf
v_cmp_eq_u32 vcc, 14, v202
s_nop 1
v_cndmask_b32 v200, v200, v60, vcc
v_cndmask_b32 v201, v201, v61, vcc
v_cmp_eq_u32 vcc, 15, v202
s_nop 1
v_cndmask_b32 v200, v200, v62, vcc
v_cndmask_b32 v201, v201, v63, vcc
v_cvt_pk_bf16_f32 v200, v200, v200
v_cvt_pk_bf16_f32 v201, v201, v201
v_lshlrev_b32 v192, 1, v0
ds_write_b16 v192, v200 offset:0
ds_write_b16 v192, v201 offset:1024
s_waitcnt lgkmcnt(0)
s_barrier
s_cmp_lg_u32 s34, 0
s_cbranch_scc1 L_W_q
v_lshlrev_b32 v192, 4, v1
ds_read_b128 v[20:23], v192 offset:0
ds_read_b128 v[24:27], v192 offset:1024
s_lshl_b32 s62, s32, 10
s_add_u32 s62, s62, 0x0
s_add_u32 s63, s62, 32768
s_waitcnt lgkmcnt(0)
buffer_store_dwordx4 v[20:23], v192, s[52:55], s62 offen sc1
buffer_store_dwordx4 v[24:27], v192, s[52:55], s63 offen sc1
s_lshl_b32 s62, s32, 7
s_add_u32 s62, s62, 0x15000
v_mov_b32 v192, s62
v_mov_b32 v193, s58
s_mov_b64 exec, 1
s_waitcnt vmcnt(0)
buffer_store_dword v193, v192, s[52:55], 0 offen sc1
s_mov_b64 exec, -1
L_W_q:
s_waitcnt vmcnt(0)
v_bfe_u32 v9, v1, 2, 3
v_lshlrev_b32 v9, 11, v9
v_and_b32 v192, 3, v1
v_lshrrev_b32 v10, 5, v1
v_lshl_add_u32 v192, v10, 2, v192
v_lshl_add_u32 v9, v192, 4, v9
s_lshr_b32 s62, s32, 4
s_and_b32 s63, s32, 15
s_lshl_b32 s60, s62, 16
s_lshl_b32 s61, s63, 7
s_add_u32 s60, s60, s61
s_add_u32 s60, s60, 0x20000
v_add_u32 v9, s60, v9
s_lshl_b32 s60, s62, 11
s_lshl_b32 s61, s63, 6
s_add_u32 s60, s60, s61
s_add_u32 s60, s60, 1024
v_lshl_add_u32 v10, v192, 3, s60
s_mov_b32 s37, 65536
s_lshr_b32 s35, s34, 2
s_and_b32 s36, s34, 3
s_branch L_W_merge
L_W_poll:
s_lshl_b32 s63, s32, 4
s_add_u32 s63, s63, 0x10000
v_lshl_add_u32 v192, v1, 9, s63
s_cmp_lg_u32 s34, 0
s_cbranch_scc1 L_wf_Wc
s_lshl_b64 exec, 1, s32
s_mov_b32 s64, 0
L_pl_Wc1:
buffer_load_dwordx4 v[196:199], v192, s[52:55], 0 offen sc1
s_add_u32 s64, s64, 1
s_waitcnt vmcnt(0)
v_xor_b32 v196, s76, v196
v_xor_b32 v197, s77, v197
v_xor_b32 v198, s78, v198
v_xor_b32 v199, s79, v199
v_or_b32 v193, v196, v197
v_or3_b32 v193, v193, v198, v199
v_and_b32 v193, 0xff, v193
v_cmp_ne_u32 vcc, 0, v193
s_nop 0
s_cmp_eq_u64 vcc, 0
s_cbranch_scc1 L_pd_Wc1
s_mov_b64 exec, vcc
s_sleep 2
s_cmp_lt_u32 s64, 65536
s_cbranch_scc1 L_pl_Wc1
L_pd_Wc1:
s_mov_b32 exec_lo, -1
s_mov_b32 exec_hi, 0
s_mov_b32 s64, 0
L_pl_Wc2:
buffer_load_dwordx4 v[196:199], v192, s[52:55], 0 offen sc1
s_add_u32 s64, s64, 1
s_waitcnt vmcnt(0)
v_xor_b32 v196, s76, v196
v_xor_b32 v197, s77, v197
v_xor_b32 v198, s78, v198
v_xor_b32 v199, s79, v199
v_or_b32 v193, v196, v197
v_or3_b32 v193, v193, v198, v199
v_and_b32 v193, 0xff, v193
v_cmp_ne_u32 vcc, 0, v193
s_nop 0
s_cmp_eq_u64 vcc, 0
s_cbranch_scc1 L_pd_Wc2
s_mov_b64 exec, vcc
s_cmp_lt_u32 s64, 65536
s_cbranch_scc1 L_pl_Wc2
L_pd_Wc2:
s_mov_b64 exec, -1
L_wf_Wc:
s_barrier
s_lshl_b32 s62, s35, 13
s_add_u32 s63, s63, s62
v_lshl_add_u32 v192, v2, 9, s63
buffer_load_dwordx4 v[196:199], v192, s[52:55], 0 offen sc1
s_lshl_b32 s62, s35, 5
s_add_u32 s62, s62, s32
s_lshl_b32 s63, s62, 14
s_add_u32 s63, s63, 0x200000
s_lshl_b32 s64, s36, 12
s_add_u32 s63, s63, s64
v_lshl_add_u32 v193, v1, 4, s63
buffer_load_dwordx4 v[200:203], v193, s[52:55], 0 offen offset:0 sc1
buffer_load_dwordx4 v[204:207], v193, s[52:55], 0 offen offset:1024 sc1
buffer_load_dwordx4 v[208:211], v193, s[52:55], 0 offen offset:2048 sc1
buffer_load_dwordx4 v[212:215], v193, s[52:55], 0 offen offset:3072 sc1
L_W_merge:
s_mov_b32 s60, 0x07060302
s_waitcnt vmcnt(4)
v_perm_b32 v194, v196, v197, s60
v_perm_b32 v195, v198, v199, s60
v_mov_b32 v196, v194
s_nop 1
v_max_f32_dpp v196, v196, v196 row_ror:8 row_mask:0xf bank_mask:0xf
s_nop 1
v_max_f32_dpp v196, v196, v196 row_ror:4 row_mask:0xf bank_mask:0xf
s_nop 1
v_max_f32_dpp v196, v196, v196 row_ror:2 row_mask:0xf bank_mask:0xf
s_nop 1
v_max_f32_dpp v196, v196, v196 row_ror:1 row_mask:0xf bank_mask:0xf
v_sub_f32 v197, v194, v196
v_exp_f32 v197, v197
s_nop 0
v_mul_f32 v195, v195, v197
s_nop 1
v_add_f32_dpp v195, v195, v195 row_ror:8 row_mask:0xf bank_mask:0xf
s_nop 1
v_add_f32_dpp v195, v195, v195 row_ror:4 row_mask:0xf bank_mask:0xf
s_nop 1
v_add_f32_dpp v195, v195, v195 row_ror:2 row_mask:0xf bank_mask:0xf
s_nop 1
v_add_f32_dpp v195, v195, v195 row_ror:1 row_mask:0xf bank_mask:0xf
v_rcp_f32 v195, v195
s_nop 0
v_mul_f32 v197, v197, v195
s_lshl_b32 s64, s36, 2
s_add_u32 s65, s64, 0
v_readlane_b32 s66, v197, s65
s_add_u32 s65, s64, 1
v_readlane_b32 s67, v197, s65
s_add_u32 s65, s64, 2
v_readlane_b32 s68, v197, s65
s_add_u32 s65, s64, 3
v_readlane_b32 s69, v197, s65
s_waitcnt vmcnt(3)
v_lshlrev_b32 v216, 16, v200
v_and_b32 v217, 0xffff0000, v200
v_lshlrev_b32 v218, 16, v201
v_and_b32 v219, 0xffff0000, v201
v_lshlrev_b32 v220, 16, v202
v_and_b32 v221, 0xffff0000, v202
v_lshlrev_b32 v222, 16, v203
v_and_b32 v223, 0xffff0000, v203
v_mul_f32 v232, s66, v216
v_mul_f32 v233, s66, v217
v_mul_f32 v234, s66, v218
v_mul_f32 v235, s66, v219
v_mul_f32 v236, s66, v220
v_mul_f32 v237, s66, v221
v_mul_f32 v238, s66, v222
v_mul_f32 v239, s66, v223
s_waitcnt vmcnt(2)
v_lshlrev_b32 v216, 16, v204
v_and_b32 v217, 0xffff0000, v204
v_lshlrev_b32 v218, 16, v205
v_and_b32 v219, 0xffff0000, v205
v_lshlrev_b32 v220, 16, v206
v_and_b32 v221, 0xffff0000, v206
v_lshlrev_b32 v222, 16, v207
v_and_b32 v223, 0xffff0000, v207
v_fma_f32 v232, v216, s67, v232
v_fma_f32 v233, v217, s67, v233
v_fma_f32 v234, v218, s67, v234
v_fma_f32 v235, v219, s67, v235
v_fma_f32 v236, v220, s67, v236
v_fma_f32 v237, v221, s67, v237
v_fma_f32 v238, v222, s67, v238
v_fma_f32 v239, v223, s67, v239
s_waitcnt vmcnt(1)
v_lshlrev_b32 v216, 16, v208
v_and_b32 v217, 0xffff0000, v208
v_lshlrev_b32 v218, 16, v209
v_and_b32 v219, 0xffff0000, v209
v_lshlrev_b32 v220, 16, v210
v_and_b32 v221, 0xffff0000, v210
v_lshlrev_b32 v222, 16, v211
v_and_b32 v223, 0xffff0000, v211
v_fma_f32 v232, v216, s68, v232
v_fma_f32 v233, v217, s68, v233
v_fma_f32 v234, v218, s68, v234
v_fma_f32 v235, v219, s68, v235
v_fma_f32 v236, v220, s68, v236
v_fma_f32 v237, v221, s68, v237
v_fma_f32 v238, v222, s68, v238
v_fma_f32 v239, v223, s68, v239
s_waitcnt vmcnt(0)
v_lshlrev_b32 v216, 16, v212
v_and_b32 v217, 0xffff0000, v212
v_lshlrev_b32 v218, 16, v213
v_and_b32 v219, 0xffff0000, v213
v_lshlrev_b32 v220, 16, v214
v_and_b32 v221, 0xffff0000, v214
v_lshlrev_b32 v222, 16, v215
v_and_b32 v223, 0xffff0000, v215
v_fma_f32 v232, v216, s69, v232
v_fma_f32 v233, v217, s69, v233
v_fma_f32 v234, v218, s69, v234
v_fma_f32 v235, v219, s69, v235
v_fma_f32 v236, v220, s69, v236
v_fma_f32 v237, v221, s69, v237
v_fma_f32 v238, v222, s69, v238
v_fma_f32 v239, v223, s69, v239
s_lshl_b32 s62, s34, 11
v_lshl_add_u32 v192, v1, 5, s62
ds_write_b128 v192, v[232:235] offset:18432
ds_write_b128 v192, v[236:239] offset:18448
s_waitcnt lgkmcnt(0)
s_barrier
v_lshrrev_b32 v192, 3, v2
v_lshlrev_b32 v192, 13, v192
v_lshl_add_u32 v192, v3, 6, v192
s_lshl_b32 s62, s34, 8
s_lshr_b32 s63, s80, 11
s_add_u32 s62, s62, s63
v_add_u32 v192, s62, v192
v_xor_b32 v193, 16, v192
v_xor_b32 v194, 32, v192
v_xor_b32 v195, 48, v192
ds_read_b128 v[200:203], v192 offset:18432
ds_read_b128 v[204:207], v193 offset:18432
ds_read_b128 v[208:211], v194 offset:18432
ds_read_b128 v[212:215], v195 offset:18432
ds_read_b128 v[216:219], v192 offset:20480
ds_read_b128 v[220:223], v193 offset:20480
ds_read_b128 v[224:227], v194 offset:20480
ds_read_b128 v[228:231], v195 offset:20480
s_waitcnt lgkmcnt(0)
v_add_f32 v200, v200, v216
v_add_f32 v201, v201, v217
v_add_f32 v202, v202, v218
v_add_f32 v203, v203, v219
v_add_f32 v204, v204, v220
v_add_f32 v205, v205, v221
v_add_f32 v206, v206, v222
v_add_f32 v207, v207, v223
v_add_f32 v208, v208, v224
v_add_f32 v209, v209, v225
v_add_f32 v210, v210, v226
v_add_f32 v211, v211, v227
v_add_f32 v212, v212, v228
v_add_f32 v213, v213, v229
v_add_f32 v214, v214, v230
v_add_f32 v215, v215, v231
ds_read_b128 v[216:219], v192 offset:22528
ds_read_b128 v[220:223], v193 offset:22528
ds_read_b128 v[224:227], v194 offset:22528
ds_read_b128 v[228:231], v195 offset:22528
s_waitcnt lgkmcnt(0)
v_add_f32 v200, v200, v216
v_add_f32 v201, v201, v217
v_add_f32 v202, v202, v218
v_add_f32 v203, v203, v219
v_add_f32 v204, v204, v220
v_add_f32 v205, v205, v221
v_add_f32 v206, v206, v222
v_add_f32 v207, v207, v223
v_add_f32 v208, v208, v224
v_add_f32 v209, v209, v225
v_add_f32 v210, v210, v226
v_add_f32 v211, v211, v227
v_add_f32 v212, v212, v228
v_add_f32 v213, v213, v229
v_add_f32 v214, v214, v230
v_add_f32 v215, v215, v231
ds_read_b128 v[216:219], v192 offset:24576
ds_read_b128 v[220:223], v193 offset:24576
ds_read_b128 v[224:227], v194 offset:24576
ds_read_b128 v[228:231], v195 offset:24576
s_waitcnt lgkmcnt(0)
v_add_f32 v200, v200, v216
v_add_f32 v201, v201, v217
v_add_f32 v202, v202, v218
v_add_f32 v203, v203, v219
v_add_f32 v204, v204, v220
v_add_f32 v205, v205, v221
v_add_f32 v206, v206, v222
v_add_f32 v207, v207, v223
v_add_f32 v208, v208, v224
v_add_f32 v209, v209, v225
v_add_f32 v210, v210, v226
v_add_f32 v211, v211, v227
v_add_f32 v212, v212, v228
v_add_f32 v213, v213, v229
v_add_f32 v214, v214, v230
v_add_f32 v215, v215, v231
v_cvt_pk_bf16_f32 v12, v200, v201
v_cvt_pk_bf16_f32 v13, v202, v203
v_cvt_pk_bf16_f32 v14, v204, v205
v_cvt_pk_bf16_f32 v15, v206, v207
v_cvt_pk_bf16_f32 v16, v208, v209
v_cvt_pk_bf16_f32 v17, v210, v211
v_cvt_pk_bf16_f32 v18, v212, v213
v_cvt_pk_bf16_f32 v19, v214, v215
s_mov_b32 s60, 0x01000100
v_perm_b32 v192, v12, v12, s60
v_and_b32 v28, v192, v4
v_and_b32 v29, v192, v5
v_and_b32 v30, v192, v6
v_and_b32 v31, v192, v7
s_waitcnt vmcnt(63)
s_nop 0
v_mfma_f32_16x16x32_bf16 v[44:47], v[28:31], v[64:67], 0
s_mov_b32 s60, 0x03020302
v_perm_b32 v193, v12, v12, s60
v_and_b32 v32, v193, v4
v_and_b32 v33, v193, v5
v_and_b32 v34, v193, v6
v_and_b32 v35, v193, v7
s_waitcnt vmcnt(63)
s_nop 0
v_mfma_f32_16x16x32_bf16 v[44:47], v[32:35], v[68:71], v[44:47]
s_mov_b32 s60, 0x01000100
v_perm_b32 v192, v13, v13, s60
v_and_b32 v28, v192, v4
v_and_b32 v29, v192, v5
v_and_b32 v30, v192, v6
v_and_b32 v31, v192, v7
s_waitcnt vmcnt(63)
s_nop 0
v_mfma_f32_16x16x32_bf16 v[44:47], v[28:31], v[72:75], v[44:47]
s_mov_b32 s60, 0x03020302
v_perm_b32 v193, v13, v13, s60
v_and_b32 v32, v193, v4
v_and_b32 v33, v193, v5
v_and_b32 v34, v193, v6
v_and_b32 v35, v193, v7
s_waitcnt vmcnt(63)
s_nop 0
v_mfma_f32_16x16x32_bf16 v[44:47], v[32:35], v[76:79], v[44:47]
s_mov_b32 s60, 0x01000100
v_perm_b32 v192, v14, v14, s60
v_and_b32 v28, v192, v4
v_and_b32 v29, v192, v5
v_and_b32 v30, v192, v6
v_and_b32 v31, v192, v7
s_waitcnt vmcnt(63)
s_nop 0
v_mfma_f32_16x16x32_bf16 v[44:47], v[28:31], v[80:83], v[44:47]
s_mov_b32 s60, 0x03020302
v_perm_b32 v193, v14, v14, s60
v_and_b32 v32, v193, v4
v_and_b32 v33, v193, v5
v_and_b32 v34, v193, v6
v_and_b32 v35, v193, v7
s_waitcnt vmcnt(63)
s_nop 0
v_mfma_f32_16x16x32_bf16 v[44:47], v[32:35], v[84:87], v[44:47]
s_mov_b32 s60, 0x01000100
v_perm_b32 v192, v15, v15, s60
v_and_b32 v28, v192, v4
v_and_b32 v29, v192, v5
v_and_b32 v30, v192, v6
v_and_b32 v31, v192, v7
s_waitcnt vmcnt(63)
s_nop 0
v_mfma_f32_16x16x32_bf16 v[44:47], v[28:31], v[88:91], v[44:47]
s_mov_b32 s60, 0x03020302
v_perm_b32 v193, v15, v15, s60
v_and_b32 v32, v193, v4
v_and_b32 v33, v193, v5
v_and_b32 v34, v193, v6
v_and_b32 v35, v193, v7
s_waitcnt vmcnt(63)
s_nop 0
v_mfma_f32_16x16x32_bf16 v[44:47], v[32:35], v[92:95], v[44:47]
s_mov_b32 s60, 0x01000100
v_perm_b32 v192, v16, v16, s60
v_and_b32 v28, v192, v4
v_and_b32 v29, v192, v5
v_and_b32 v30, v192, v6
v_and_b32 v31, v192, v7
s_waitcnt vmcnt(63)
s_nop 0
v_mfma_f32_16x16x32_bf16 v[44:47], v[28:31], v[96:99], v[44:47]
s_mov_b32 s60, 0x03020302
v_perm_b32 v193, v16, v16, s60
v_and_b32 v32, v193, v4
v_and_b32 v33, v193, v5
v_and_b32 v34, v193, v6
v_and_b32 v35, v193, v7
s_waitcnt vmcnt(63)
s_nop 0
v_mfma_f32_16x16x32_bf16 v[44:47], v[32:35], v[100:103], v[44:47]
s_mov_b32 s60, 0x01000100
v_perm_b32 v192, v17, v17, s60
v_and_b32 v28, v192, v4
v_and_b32 v29, v192, v5
v_and_b32 v30, v192, v6
v_and_b32 v31, v192, v7
s_waitcnt vmcnt(63)
s_nop 0
v_mfma_f32_16x16x32_bf16 v[44:47], v[28:31], v[104:107], v[44:47]
s_mov_b32 s60, 0x03020302
v_perm_b32 v193, v17, v17, s60
v_and_b32 v32, v193, v4
v_and_b32 v33, v193, v5
v_and_b32 v34, v193, v6
v_and_b32 v35, v193, v7
s_waitcnt vmcnt(63)
s_nop 0
v_mfma_f32_16x16x32_bf16 v[44:47], v[32:35], v[108:111], v[44:47]
s_mov_b32 s60, 0x01000100
v_perm_b32 v192, v18, v18, s60
v_and_b32 v28, v192, v4
v_and_b32 v29, v192, v5
v_and_b32 v30, v192, v6
v_and_b32 v31, v192, v7
s_waitcnt vmcnt(63)
s_nop 0
v_mfma_f32_16x16x32_bf16 v[44:47], v[28:31], v[112:115], v[44:47]
s_mov_b32 s60, 0x03020302
v_perm_b32 v193, v18, v18, s60
v_and_b32 v32, v193, v4
v_and_b32 v33, v193, v5
v_and_b32 v34, v193, v6
v_and_b32 v35, v193, v7
s_waitcnt vmcnt(63)
s_nop 0
v_mfma_f32_16x16x32_bf16 v[44:47], v[32:35], v[116:119], v[44:47]
s_mov_b32 s60, 0x01000100
v_perm_b32 v192, v19, v19, s60
v_and_b32 v28, v192, v4
v_and_b32 v29, v192, v5
v_and_b32 v30, v192, v6
v_and_b32 v31, v192, v7
s_waitcnt vmcnt(63)
s_nop 0
v_mfma_f32_16x16x32_bf16 v[44:47], v[28:31], v[120:123], v[44:47]
s_mov_b32 s60, 0x03020302
v_perm_b32 v193, v19, v19, s60
v_and_b32 v32, v193, v4
v_and_b32 v33, v193, v5
v_and_b32 v34, v193, v6
v_and_b32 v35, v193, v7
s_waitcnt vmcnt(63)
s_nop 0
v_mfma_f32_16x16x32_bf16 v[44:47], v[32:35], v[124:127], v[44:47]
v_lshrrev_b32 v192, 1, v3
v_lshlrev_b32 v192, 9, v192
v_lshl_add_u32 v192, v2, 5, v192
v_and_b32 v193, 1, v3
v_lshl_add_u32 v192, v193, 4, v192
s_lshl_b32 s63, s34, 10
v_add_u32 v192, s63, v192
s_nop 1
s_nop 5
ds_write_b128 v192, v[44:47] offset:9216
s_waitcnt lgkmcnt(0)
s_barrier
v_lshrrev_b32 v192, 3, v2
v_lshlrev_b32 v192, 9, v192
v_lshl_add_u32 v192, v3, 4, v192
s_lshl_b32 s62, s34, 6
v_add_u32 v192, s62, v192
ds_read_b128 v[200:203], v192 offset:9216
ds_read_b128 v[204:207], v192 offset:10240
ds_read_b128 v[208:211], v192 offset:11264
ds_read_b128 v[212:215], v192 offset:12288
ds_read_b128 v[216:219], v192 offset:13312
ds_read_b128 v[220:223], v192 offset:14336
ds_read_b128 v[224:227], v192 offset:15360
ds_read_b128 v[228:231], v192 offset:16384
s_waitcnt lgkmcnt(6)
v_add_f32 v200, v200, v204
v_add_f32 v201, v201, v205
v_add_f32 v202, v202, v206
v_add_f32 v203, v203, v207
s_waitcnt lgkmcnt(5)
v_add_f32 v200, v200, v208
v_add_f32 v201, v201, v209
v_add_f32 v202, v202, v210
v_add_f32 v203, v203, v211
s_waitcnt lgkmcnt(4)
v_add_f32 v200, v200, v212
v_add_f32 v201, v201, v213
v_add_f32 v202, v202, v214
v_add_f32 v203, v203, v215
s_waitcnt lgkmcnt(3)
v_add_f32 v200, v200, v216
v_add_f32 v201, v201, v217
v_add_f32 v202, v202, v218
v_add_f32 v203, v203, v219
s_waitcnt lgkmcnt(2)
v_add_f32 v200, v200, v220
v_add_f32 v201, v201, v221
v_add_f32 v202, v202, v222
v_add_f32 v203, v203, v223
s_waitcnt lgkmcnt(1)
v_add_f32 v200, v200, v224
v_add_f32 v201, v201, v225
v_add_f32 v202, v202, v226
v_add_f32 v203, v203, v227
s_waitcnt lgkmcnt(0)
v_add_f32 v200, v200, v228
v_add_f32 v201, v201, v229
v_add_f32 v202, v202, v230
v_add_f32 v203, v203, v231
v_cvt_pk_bf16_f32 v60, v200, v200
v_cvt_pk_bf16_f32 v61, v201, v201
v_cvt_pk_bf16_f32 v62, v202, v202
v_cvt_pk_bf16_f32 v63, v203, v203
v_and_b32 v28, v60, v4
v_and_b32 v29, v60, v5
v_and_b32 v30, v60, v6
v_and_b32 v31, v60, v7
v_and_b32 v32, v61, v4
v_and_b32 v33, v61, v5
v_and_b32 v34, v61, v6
v_and_b32 v35, v61, v7
v_and_b32 v36, v62, v4
v_and_b32 v37, v62, v5
v_and_b32 v38, v62, v6
v_and_b32 v39, v62, v7
v_and_b32 v40, v63, v4
v_and_b32 v41, v63, v5
v_and_b32 v42, v63, v6
v_and_b32 v43, v63, v7
v_mfma_f32_16x16x32_bf16 v[44:47], v[28:31], v[128:131], 0
v_mfma_f32_16x16x32_bf16 v[48:51], v[28:31], v[132:135], 0
v_mfma_f32_16x16x32_bf16 v[52:55], v[28:31], v[136:139], 0
v_mfma_f32_16x16x32_bf16 v[56:59], v[28:31], v[140:143], 0
v_mfma_f32_16x16x32_bf16 v[44:47], v[32:35], v[144:147], v[44:47]
v_mfma_f32_16x16x32_bf16 v[48:51], v[32:35], v[148:151], v[48:51]
v_mfma_f32_16x16x32_bf16 v[52:55], v[32:35], v[152:155], v[52:55]
v_mfma_f32_16x16x32_bf16 v[56:59], v[32:35], v[156:159], v[56:59]
v_mfma_f32_16x16x32_bf16 v[44:47], v[36:39], v[160:163], v[44:47]
v_mfma_f32_16x16x32_bf16 v[48:51], v[36:39], v[164:167], v[48:51]
v_mfma_f32_16x16x32_bf16 v[52:55], v[36:39], v[168:171], v[52:55]
v_mfma_f32_16x16x32_bf16 v[56:59], v[36:39], v[172:175], v[56:59]
v_mfma_f32_16x16x32_bf16 v[44:47], v[40:43], v[176:179], v[44:47]
v_mfma_f32_16x16x32_bf16 v[48:51], v[40:43], v[180:183], v[48:51]
v_mfma_f32_16x16x32_bf16 v[52:55], v[40:43], v[184:187], v[52:55]
v_mfma_f32_16x16x32_bf16 v[56:59], v[40:43], v[188:191], v[56:59]
v_lshrrev_b32 v192, 1, v3
v_lshlrev_b32 v192, 11, v192
v_lshl_add_u32 v192, v2, 5, v192
v_and_b32 v193, 1, v3
v_lshl_add_u32 v192, v193, 4, v192
s_lshl_b32 s63, s34, 12
v_add_u32 v192, s63, v192
s_nop 1
ds_write_b128 v192, v[44:47] offset:18432
ds_write_b128 v192, v[48:51] offset:18944
ds_write_b128 v192, v[52:55] offset:19456
s_nop 5
ds_write_b128 v192, v[56:59] offset:19968
s_waitcnt lgkmcnt(0)
s_barrier
s_cmp_ge_u32 s34, 4
s_cbranch_scc1 L_W_yskip
v_lshlrev_b32 v192, 4, v0
ds_read_b128 v[200:203], v192 offset:18432
ds_read_b128 v[204:207], v192 offset:22528
ds_read_b128 v[208:211], v192 offset:26624
ds_read_b128 v[212:215], v192 offset:30720
ds_read_b128 v[216:219], v192 offset:34816
ds_read_b128 v[220:223], v192 offset:38912
ds_read_b128 v[224:227], v192 offset:43008
ds_read_b128 v[228:231], v192 offset:47104
v_bfe_u32 v193, v0, 7, 1
v_lshlrev_b32 v193, 16, v193
v_and_b32 v194, 127, v0
v_lshl_add_u32 v193, v194, 4, v193
s_lshl_b32 s63, s32, 11
s_add_u32 s63, s63, 0x20000
v_add_u32 v193, s63, v193
v_mov_b32 v194, 0xffffff00
s_waitcnt lgkmcnt(6)
v_add_f32 v200, v200, v204
v_add_f32 v201, v201, v205
v_add_f32 v202, v202, v206
v_add_f32 v203, v203, v207
s_waitcnt lgkmcnt(5)
v_add_f32 v200, v200, v208
v_add_f32 v201, v201, v209
v_add_f32 v202, v202, v210
v_add_f32 v203, v203, v211
s_waitcnt lgkmcnt(4)
v_add_f32 v200, v200, v212
v_add_f32 v201, v201, v213
v_add_f32 v202, v202, v214
v_add_f32 v203, v203, v215
s_waitcnt lgkmcnt(3)
v_add_f32 v200, v200, v216
v_add_f32 v201, v201, v217
v_add_f32 v202, v202, v218
v_add_f32 v203, v203, v219
s_waitcnt lgkmcnt(2)
v_add_f32 v200, v200, v220
v_add_f32 v201, v201, v221
v_add_f32 v202, v202, v222
v_add_f32 v203, v203, v223
s_waitcnt lgkmcnt(1)
v_add_f32 v200, v200, v224
v_add_f32 v201, v201, v225
v_add_f32 v202, v202, v226
v_add_f32 v203, v203, v227
s_waitcnt lgkmcnt(0)
v_add_f32 v200, v200, v228
v_add_f32 v201, v201, v229
v_add_f32 v202, v202, v230
v_add_f32 v203, v203, v231
v_add_u32 v200, 0x80, v200
v_add_u32 v201, 0x80, v201
v_add_u32 v202, 0x80, v202
v_add_u32 v203, 0x80, v203
v_and_or_b32 v200, v200, v194, s76
v_and_or_b32 v201, v201, v194, s77
v_and_or_b32 v202, v202, v194, s78
v_and_or_b32 v203, v203, v194, s79
s_cmp_lg_u32 s37, 0
s_cbranch_scc1 L_W_yskip
buffer_store_dwordx4 v[200:203], v193, s[52:55], 0 offen sc1
L_W_yskip:
s_cmp_lg_u32 s34, 4
s_cbranch_scc1 L_W_fin
s_mov_b32 s64, s37
s_mov_b32 s66, 0x4000
s_mov_b32 s67, 0x8000
s_mov_b32 s65, 0xc000
buffer_load_dwordx4 v[12:15], v9, s[52:55], 0 offen sc1
buffer_load_dwordx4 v[16:19], v9, s[52:55], s66 offen sc1
buffer_load_dwordx4 v[20:23], v9, s[52:55], s67 offen sc1
buffer_load_dwordx4 v[24:27], v9, s[52:55], s65 offen sc1
L_ps_Wf:
s_waitcnt vmcnt(3)
v_xor_b32 v200, s76, v12
v_xor_b32 v201, s77, v13
v_xor_b32 v202, s78, v14
v_xor_b32 v203, s79, v15
v_or_b32 v192, v200, v201
v_or3_b32 v192, v192, v202, v203
s_waitcnt vmcnt(2)
v_xor_b32 v204, s76, v16
v_xor_b32 v205, s77, v17
v_xor_b32 v206, s78, v18
v_xor_b32 v207, s79, v19
v_or3_b32 v192, v192, v204, v205
v_or3_b32 v192, v192, v206, v207
v_add_f32 v200, v200, v204
v_add_f32 v201, v201, v205
v_add_f32 v202, v202, v206
v_add_f32 v203, v203, v207
s_waitcnt vmcnt(1)
v_xor_b32 v204, s76, v20
v_xor_b32 v205, s77, v21
v_xor_b32 v206, s78, v22
v_xor_b32 v207, s79, v23
v_or3_b32 v192, v192, v204, v205
v_or3_b32 v192, v192, v206, v207
v_add_f32 v200, v200, v204
v_add_f32 v201, v201, v205
v_add_f32 v202, v202, v206
v_add_f32 v203, v203, v207
s_waitcnt vmcnt(0)
v_xor_b32 v204, s76, v24
v_xor_b32 v205, s77, v25
v_xor_b32 v206, s78, v26
v_xor_b32 v207, s79, v27
v_or3_b32 v192, v192, v204, v205
v_or3_b32 v192, v192, v206, v207
v_add_f32 v200, v200, v204
v_add_f32 v201, v201, v205
v_add_f32 v202, v202, v206
v_add_f32 v203, v203, v207
v_and_b32 v192, 0xff, v192
v_cmp_ne_u32 vcc, 0, v192
v_add_f32_dpp v200, v200, v200 row_ror:8 row_mask:0xf bank_mask:0xf
v_add_f32_dpp v201, v201, v201 row_ror:8 row_mask:0xf bank_mask:0xf
v_add_f32_dpp v202, v202, v202 row_ror:8 row_mask:0xf bank_mask:0xf
v_add_f32_dpp v203, v203, v203 row_ror:8 row_mask:0xf bank_mask:0xf
s_cmp_eq_u64 vcc, 0
s_cbranch_scc1 L_pe_Wf
s_sleep 2
buffer_load_dwordx4 v[12:15], v9, s[52:55], 0 offen sc1
buffer_load_dwordx4 v[16:19], v9, s[52:55], s66 offen sc1
buffer_load_dwordx4 v[20:23], v9, s[52:55], s67 offen sc1
buffer_load_dwordx4 v[24:27], v9, s[52:55], s65 offen sc1
s_add_u32 s64, s64, 1
s_cmp_lt_u32 s64, 65536
s_cbranch_scc1 L_ps_Wf
L_pe_Wf:
v_add_f32_dpp v200, v200, v200 row_ror:4 row_mask:0xf bank_mask:0xf
v_add_f32_dpp v201, v201, v201 row_ror:4 row_mask:0xf bank_mask:0xf
v_add_f32_dpp v202, v202, v202 row_ror:4 row_mask:0xf bank_mask:0xf
v_add_f32_dpp v203, v203, v203 row_ror:4 row_mask:0xf bank_mask:0xf
v_mov_b32 v192, v200
v_mov_b32 v193, v201
v_mov_b32 v194, v202
v_mov_b32 v195, v203
v_permlane16_swap_b32 v200, v192
v_permlane16_swap_b32 v201, v193
v_permlane16_swap_b32 v202, v194
v_permlane16_swap_b32 v203, v195
v_add_f32 v200, v200, v192
v_add_f32 v201, v201, v193
v_add_f32 v202, v202, v194
v_add_f32 v203, v203, v195
v_cvt_pk_bf16_f32 v200, v200, v201
v_cvt_pk_bf16_f32 v201, v202, v203
s_cmp_lg_u32 s37, 0
s_cbranch_scc1 L_W_fin
s_mov_b32 exec_lo, 15
s_mov_b32 exec_hi, 15
global_store_dwordx2 v10, v[200:201], s[26:27]
s_mov_b64 exec, -1
L_W_fin:
s_cmp_eq_u32 s37, 0
s_cbranch_scc1 L_W_end
s_mov_b32 s37, 0
s_waitcnt vmcnt(0)
s_branch L_W_poll
L_W_end:
s_endpgm
L_roleC:
v_and_b32 v1, 63, v0
s_xor_b32 s32, s82, 5
s_waitcnt lgkmcnt(0)
s_lshl_b32 s60, s32, 8
s_sub_u32 s61, 0x400000, s60
s_add_u32 s68, s10, s60
s_addc_u32 s69, s11, 0
s_and_b32 s69, s69, 0xffff
s_mov_b32 s70, s61
s_mov_b32 s71, 0x20000
s_mov_b32 s72, s4
s_and_b32 s73, s5, 0xffff
s_mov_b32 s74, 0x800
s_mov_b32 s75, 0x20000
v_lshrrev_b32 v240, 3, v2
v_lshlrev_b32 v240, 10, v240
v_lshl_add_u32 v240, v3, 5, v240
s_lshl_b32 s62, s34, 7
v_add_u32 v240, s62, v240
s_mov_b32 s80, 0
buffer_load_dwordx4 v[32:35], v240, s[72:75], 0 offen
buffer_load_dwordx4 v[36:39], v240, s[72:75], 0 offen offset:16
v_lshlrev_b32 v9, 17, v3
v_lshl_add_u32 v9, v2, 4, v9
s_lshl_b32 s62, s34, 19
v_add_u32 v9, s62, v9
s_xor_b32 s62, s80, 0
buffer_load_dwordx4 v[128:131], v9, s[68:71], s62 offen nt
s_xor_b32 s62, s80, 8192
buffer_load_dwordx4 v[132:135], v9, s[68:71], s62 offen nt
s_xor_b32 s62, s80, 16384
buffer_load_dwordx4 v[136:139], v9, s[68:71], s62 offen nt
s_xor_b32 s62, s80, 24576
buffer_load_dwordx4 v[140:143], v9, s[68:71], s62 offen nt
s_xor_b32 s62, s80, 32768
buffer_load_dwordx4 v[144:147], v9, s[68:71], s62 offen nt
s_xor_b32 s62, s80, 40960
buffer_load_dwordx4 v[148:151], v9, s[68:71], s62 offen nt
s_xor_b32 s62, s80, 49152
buffer_load_dwordx4 v[152:155], v9, s[68:71], s62 offen nt
s_xor_b32 s62, s80, 57344
buffer_load_dwordx4 v[156:159], v9, s[68:71], s62 offen nt
s_xor_b32 s62, s80, 65536
buffer_load_dwordx4 v[160:163], v9, s[68:71], s62 offen nt
s_xor_b32 s62, s80, 73728
buffer_load_dwordx4 v[164:167], v9, s[68:71], s62 offen nt
s_xor_b32 s62, s80, 81920
buffer_load_dwordx4 v[168:171], v9, s[68:71], s62 offen nt
s_xor_b32 s62, s80, 90112
buffer_load_dwordx4 v[172:175], v9, s[68:71], s62 offen nt
s_xor_b32 s62, s80, 98304
buffer_load_dwordx4 v[176:179], v9, s[68:71], s62 offen nt
s_xor_b32 s62, s80, 106496
buffer_load_dwordx4 v[180:183], v9, s[68:71], s62 offen nt
s_xor_b32 s62, s80, 114688
buffer_load_dwordx4 v[184:187], v9, s[68:71], s62 offen nt
s_xor_b32 s62, s80, 122880
buffer_load_dwordx4 v[188:191], v9, s[68:71], s62 offen nt
s_load_dword s58, s[30:31], 0x14000
s_mov_b32 s44, s30
s_and_b32 s45, s31, 0xffff
s_mov_b32 s46, 0x1000000
s_mov_b32 s47, 0x20000
s_cmp_lg_u32 s34, 6
s_cbranch_scc1 L_C_ctr
v_mov_b32 v192, -1
s_lshl_b32 s62, s32, 13
s_add_u32 s62, s62, 0x61800
v_lshl_add_u32 v240, v1, 7, s62
s_mov_b64 exec, 1
buffer_store_dword v192, v240, s[44:47], 0 offen sc1
buffer_store_dword v192, v240, s[44:47], 0 offen offset:1024 sc1
s_mov_b64 exec, -1
L_C_ctr:
v_and_b32 v242, 1, v0
v_lshlrev_b32 v242, 4, v242
v_mov_b32 v243, 0xffff
v_lshlrev_b32 v242, v242, v243
v_bfe_u32 v243, v0, 1, 2
v_cmp_eq_u32 vcc, 0, v243
s_nop 1
v_cndmask_b32 v4, 0, v242, vcc
v_cmp_eq_u32 vcc, 1, v243
s_nop 1
v_cndmask_b32 v5, 0, v242, vcc
v_cmp_eq_u32 vcc, 2, v243
s_nop 1
v_cndmask_b32 v6, 0, v242, vcc
v_cmp_eq_u32 vcc, 3, v243
s_nop 1
v_cndmask_b32 v7, 0, v242, vcc
v_mov_b32 v8, 0
s_lshr_b32 s35, s32, 4
s_lshr_b32 s36, s34, 1
s_and_b32 s37, s34, 1
s_lshr_b32 s60, s32, 0
s_lshl_b32 s60, s60, 19
s_mov_b32 s61, 0x80000
s_add_u32 s40, s16, s60
s_addc_u32 s41, s17, 0
s_and_b32 s41, s41, 0xffff
s_mov_b32 s42, s61
s_mov_b32 s43, 0x20000
v_lshrrev_b32 v242, 1, v3
v_lshlrev_b32 v242, 9, v242
v_lshl_add_u32 v242, v2, 5, v242
v_and_b32 v243, 1, v3
v_lshl_add_u32 v242, v243, 4, v242
s_lshl_b32 s63, s34, 10
v_add_u32 v242, s63, v242
v_add_u32 v242, 140288, v242
v_lshlrev_b32 v243, 4, v1
s_lshl_b32 s62, s32, 10
s_add_u32 s62, s62, 0x18000
v_add_u32 v244, s62, v243
v_add_u32 v243, 140288, v243
s_waitcnt vmcnt(16) lgkmcnt(0)
s_add_u32 s58, s58, 0x9e3779b9
s_bfe_u32 s76, s58, 0x80000
s_bfe_u32 s77, s58, 0x80008
s_bfe_u32 s78, s58, 0x80010
s_bfe_u32 s79, s58, 0x80018
v_mov_b32 v245, s58
s_mov_b32 s60, 0x01000100
v_perm_b32 v240, v32, v32, s60
v_and_b32 v40, v240, v4
v_and_b32 v41, v240, v5
v_and_b32 v42, v240, v6
v_and_b32 v43, v240, v7
s_waitcnt vmcnt(15)
s_nop 0
v_mfma_f32_16x16x32_bf16 v[48:51], v[40:43], v[128:131], 0
s_mov_b32 s60, 0x03020302
v_perm_b32 v241, v32, v32, s60
v_and_b32 v44, v241, v4
v_and_b32 v45, v241, v5
v_and_b32 v46, v241, v6
v_and_b32 v47, v241, v7
s_waitcnt vmcnt(14)
s_nop 0
v_mfma_f32_16x16x32_bf16 v[48:51], v[44:47], v[132:135], v[48:51]
s_mov_b32 s60, 0x01000100
v_perm_b32 v240, v33, v33, s60
v_and_b32 v40, v240, v4
v_and_b32 v41, v240, v5
v_and_b32 v42, v240, v6
v_and_b32 v43, v240, v7
s_waitcnt vmcnt(13)
s_nop 0
v_mfma_f32_16x16x32_bf16 v[48:51], v[40:43], v[136:139], v[48:51]
s_mov_b32 s60, 0x03020302
v_perm_b32 v241, v33, v33, s60
v_and_b32 v44, v241, v4
v_and_b32 v45, v241, v5
v_and_b32 v46, v241, v6
v_and_b32 v47, v241, v7
s_waitcnt vmcnt(12)
s_nop 0
v_mfma_f32_16x16x32_bf16 v[48:51], v[44:47], v[140:143], v[48:51]
s_mov_b32 s60, 0x01000100
v_perm_b32 v240, v34, v34, s60
v_and_b32 v40, v240, v4
v_and_b32 v41, v240, v5
v_and_b32 v42, v240, v6
v_and_b32 v43, v240, v7
s_waitcnt vmcnt(11)
s_nop 0
v_mfma_f32_16x16x32_bf16 v[48:51], v[40:43], v[144:147], v[48:51]
s_mov_b32 s60, 0x03020302
v_perm_b32 v241, v34, v34, s60
v_and_b32 v44, v241, v4
v_and_b32 v45, v241, v5
v_and_b32 v46, v241, v6
v_and_b32 v47, v241, v7
s_waitcnt vmcnt(10)
s_nop 0
v_mfma_f32_16x16x32_bf16 v[48:51], v[44:47], v[148:151], v[48:51]
s_mov_b32 s60, 0x01000100
v_perm_b32 v240, v35, v35, s60
v_and_b32 v40, v240, v4
v_and_b32 v41, v240, v5
v_and_b32 v42, v240, v6
v_and_b32 v43, v240, v7
s_waitcnt vmcnt(9)
s_nop 0
v_mfma_f32_16x16x32_bf16 v[48:51], v[40:43], v[152:155], v[48:51]
s_mov_b32 s60, 0x03020302
v_perm_b32 v241, v35, v35, s60
v_and_b32 v44, v241, v4
v_and_b32 v45, v241, v5
v_and_b32 v46, v241, v6
v_and_b32 v47, v241, v7
s_waitcnt vmcnt(8)
s_nop 0
v_mfma_f32_16x16x32_bf16 v[48:51], v[44:47], v[156:159], v[48:51]
s_mov_b32 s60, 0x01000100
v_perm_b32 v240, v36, v36, s60
v_and_b32 v40, v240, v4
v_and_b32 v41, v240, v5
v_and_b32 v42, v240, v6
v_and_b32 v43, v240, v7
s_waitcnt vmcnt(7)
s_nop 0
v_mfma_f32_16x16x32_bf16 v[48:51], v[40:43], v[160:163], v[48:51]
s_mov_b32 s60, 0x03020302
v_perm_b32 v241, v36, v36, s60
v_and_b32 v44, v241, v4
v_and_b32 v45, v241, v5
v_and_b32 v46, v241, v6
v_and_b32 v47, v241, v7
s_waitcnt vmcnt(6)
s_nop 0
v_mfma_f32_16x16x32_bf16 v[48:51], v[44:47], v[164:167], v[48:51]
s_mov_b32 s60, 0x01000100
v_perm_b32 v240, v37, v37, s60
v_and_b32 v40, v240, v4
v_and_b32 v41, v240, v5
v_and_b32 v42, v240, v6
v_and_b32 v43, v240, v7
s_waitcnt vmcnt(5)
s_nop 0
v_mfma_f32_16x16x32_bf16 v[48:51], v[40:43], v[168:171], v[48:51]
s_mov_b32 s60, 0x03020302
v_perm_b32 v241, v37, v37, s60
v_and_b32 v44, v241, v4
v_and_b32 v45, v241, v5
v_and_b32 v46, v241, v6
v_and_b32 v47, v241, v7
s_waitcnt vmcnt(4)
s_nop 0
v_mfma_f32_16x16x32_bf16 v[48:51], v[44:47], v[172:175], v[48:51]
s_mov_b32 s60, 0x01000100
v_perm_b32 v240, v38, v38, s60
v_and_b32 v40, v240, v4
v_and_b32 v41, v240, v5
v_and_b32 v42, v240, v6
v_and_b32 v43, v240, v7
s_waitcnt vmcnt(3)
s_nop 0
v_mfma_f32_16x16x32_bf16 v[48:51], v[40:43], v[176:179], v[48:51]
s_mov_b32 s60, 0x03020302
v_perm_b32 v241, v38, v38, s60
v_and_b32 v44, v241, v4
v_and_b32 v45, v241, v5
v_and_b32 v46, v241, v6
v_and_b32 v47, v241, v7
s_waitcnt vmcnt(2)
s_nop 0
v_mfma_f32_16x16x32_bf16 v[48:51], v[44:47], v[180:183], v[48:51]
s_mov_b32 s60, 0x01000100
v_perm_b32 v240, v39, v39, s60
v_and_b32 v40, v240, v4
v_and_b32 v41, v240, v5
v_and_b32 v42, v240, v6
v_and_b32 v43, v240, v7
s_waitcnt vmcnt(1)
s_nop 0
v_mfma_f32_16x16x32_bf16 v[48:51], v[40:43], v[184:187], v[48:51]
s_mov_b32 s60, 0x03020302
v_perm_b32 v241, v39, v39, s60
v_and_b32 v44, v241, v4
v_and_b32 v45, v241, v5
v_and_b32 v46, v241, v6
v_and_b32 v47, v241, v7
s_waitcnt vmcnt(0)
s_nop 0
v_mfma_f32_16x16x32_bf16 v[48:51], v[44:47], v[188:191], v[48:51]
s_nop 7
ds_write_b128 v242, v[48:51]
s_waitcnt lgkmcnt(0)
s_barrier
s_cmp_lg_u32 s34, 0
s_cbranch_scc1 L_C_qs
ds_read_b128 v[128:131], v243 offset:0
ds_read_b128 v[132:135], v243 offset:1024
ds_read_b128 v[136:139], v243 offset:2048
ds_read_b128 v[140:143], v243 offset:3072
ds_read_b128 v[144:147], v243 offset:4096
ds_read_b128 v[148:151], v243 offset:5120
ds_read_b128 v[152:155], v243 offset:6144
ds_read_b128 v[156:159], v243 offset:7168
s_mov_b32 s60, 0x05040100
s_mov_b32 s61, 0x07060302
s_waitcnt lgkmcnt(6)
v_add_f32 v128, v128, v132
v_add_f32 v129, v129, v133
v_add_f32 v130, v130, v134
v_add_f32 v131, v131, v135
s_waitcnt lgkmcnt(5)
v_add_f32 v128, v128, v136
v_add_f32 v129, v129, v137
v_add_f32 v130, v130, v138
v_add_f32 v131, v131, v139
s_waitcnt lgkmcnt(4)
v_add_f32 v128, v128, v140
v_add_f32 v129, v129, v141
v_add_f32 v130, v130, v142
v_add_f32 v131, v131, v143
s_waitcnt lgkmcnt(3)
v_add_f32 v128, v128, v144
v_add_f32 v129, v129, v145
v_add_f32 v130, v130, v146
v_add_f32 v131, v131, v147
s_waitcnt lgkmcnt(2)
v_add_f32 v128, v128, v148
v_add_f32 v129, v129, v149
v_add_f32 v130, v130, v150
v_add_f32 v131, v131, v151
s_waitcnt lgkmcnt(1)
v_add_f32 v128, v128, v152
v_add_f32 v129, v129, v153
v_add_f32 v130, v130, v154
v_add_f32 v131, v131, v155
s_waitcnt lgkmcnt(0)
v_add_f32 v128, v128, v156
v_add_f32 v129, v129, v157
v_add_f32 v130, v130, v158
v_add_f32 v131, v131, v159
v_cvt_pk_bf16_f32 v128, v128, v129
v_cvt_pk_bf16_f32 v129, v130, v131
v_perm_b32 v132, v128, v245, s60
v_perm_b32 v133, v128, v245, s61
v_perm_b32 v134, v129, v245, s60
v_perm_b32 v135, v129, v245, s61
buffer_store_dwordx4 v[132:135], v244, s[44:47], 0 offen sc1
L_C_qs:
v_lshlrev_b32 v9, 4, v1
s_mul_i32 s62, s34, 4096
v_add_u32 v9, s62, v9
s_mul_i32 s38, s34, 4224
s_and_b32 s54, s32, 3
s_lshl_b32 s54, s54, 17
s_mov_b32 s53, 0
s_lshl_b32 s60, s32, 17
s_mov_b32 s61, 0x20000
s_add_u32 s68, s12, s60
s_addc_u32 s69, s13, 0
s_and_b32 s69, s69, 0xffff
s_mov_b32 s70, s61
s_mov_b32 s71, 0x20000
s_add_u32 s50, s38, 5120
s_cmp_lt_u32 s53, 0x80000
s_cselect_b32 s40, s40, s68
s_cselect_b32 s41, s41, s69
s_cselect_b32 s42, s42, s70
s_cselect_b32 s54, s54, 0
s_and_b32 s49, s53, 0x70000
s_xor_b32 s49, s49, s54
s_add_u32 s51, s49, 32768
s_add_u32 s53, s53, 0x10000
s_add_u32 m0, s50, 0
s_nop 0
buffer_load_dwordx4 v9, s[40:43], s49 offen offset:0 nt lds
s_add_u32 m0, s50, 32
s_nop 0
buffer_load_dwordx4 v9, s[40:43], s49 offen offset:1024 nt lds
s_add_u32 m0, s50, 64
s_nop 0
buffer_load_dwordx4 v9, s[40:43], s49 offen offset:2048 nt lds
s_add_u32 m0, s50, 96
s_nop 0
buffer_load_dwordx4 v9, s[40:43], s49 offen offset:3072 nt lds
s_add_u32 m0, s50, 33792
s_nop 0
buffer_load_dwordx4 v9, s[40:43], s51 offen offset:0 nt lds
s_add_u32 m0, s50, 33824
s_nop 0
buffer_load_dwordx4 v9, s[40:43], s51 offen offset:1024 nt lds
s_add_u32 m0, s50, 33856
s_nop 0
buffer_load_dwordx4 v9, s[40:43], s51 offen offset:2048 nt lds
s_add_u32 m0, s50, 33888
s_nop 0
buffer_load_dwordx4 v9, s[40:43], s51 offen offset:3072 nt lds
s_add_u32 s50, s38, 72704
s_cmp_lt_u32 s53, 0x80000
s_cselect_b32 s40, s40, s68
s_cselect_b32 s41, s41, s69
s_cselect_b32 s42, s42, s70
s_cselect_b32 s54, s54, 0
s_and_b32 s49, s53, 0x70000
s_xor_b32 s49, s49, s54
s_add_u32 s51, s49, 32768
s_add_u32 s53, s53, 0x10000
s_add_u32 m0, s50, 0
s_nop 0
buffer_load_dwordx4 v9, s[40:43], s49 offen offset:0 nt lds
s_add_u32 m0, s50, 32
s_nop 0
buffer_load_dwordx4 v9, s[40:43], s49 offen offset:1024 nt lds
s_add_u32 m0, s50, 64
s_nop 0
buffer_load_dwordx4 v9, s[40:43], s49 offen offset:2048 nt lds
s_add_u32 m0, s50, 96
s_nop 0
buffer_load_dwordx4 v9, s[40:43], s49 offen offset:3072 nt lds
s_add_u32 m0, s50, 33792
s_nop 0
buffer_load_dwordx4 v9, s[40:43], s51 offen offset:0 nt lds
s_add_u32 m0, s50, 33824
s_nop 0
buffer_load_dwordx4 v9, s[40:43], s51 offen offset:1024 nt lds
s_add_u32 m0, s50, 33856
s_nop 0
buffer_load_dwordx4 v9, s[40:43], s51 offen offset:2048 nt lds
s_add_u32 m0, s50, 33888
s_nop 0
buffer_load_dwordx4 v9, s[40:43], s51 offen offset:3072 nt lds
s_cmp_lt_u32 s53, 0x80000
s_cselect_b32 s40, s40, s68
s_cselect_b32 s41, s41, s69
s_cselect_b32 s42, s42, s70
s_cselect_b32 s54, s54, 0
s_and_b32 s49, s53, 0x70000
s_xor_b32 s49, s49, s54
s_add_u32 s51, s49, 32768
s_add_u32 s53, s53, 0x10000
buffer_load_dwordx4 v[208:211], v9, s[40:43], s49 offen offset:0 nt
buffer_load_dwordx4 v[212:215], v9, s[40:43], s49 offen offset:1024 nt
buffer_load_dwordx4 v[216:219], v9, s[40:43], s49 offen offset:2048 nt
buffer_load_dwordx4 v[220:223], v9, s[40:43], s49 offen offset:3072 nt
buffer_load_dwordx4 v[224:227], v9, s[40:43], s51 offen offset:0 nt
buffer_load_dwordx4 v[228:231], v9, s[40:43], s51 offen offset:1024 nt
buffer_load_dwordx4 v[232:235], v9, s[40:43], s51 offen offset:2048 nt
buffer_load_dwordx4 v[236:239], v9, s[40:43], s51 offen offset:3072 nt
s_add_u32 s62, s38, 5120
v_lshl_add_u32 v22, v1, 4, s62
s_lshl_b32 s62, s36, 4
v_add_u32 v240, s62, v2
v_mul_u32_u24 v10, 1056, v240
v_lshl_add_u32 v10, v3, 4, v10
v_add_u32 v10, 5120, v10
v_lshrrev_b32 v240, 1, v3
v_lshlrev_b32 v240, 3, v240
v_lshrrev_b32 v241, 2, v2
v_add_u32 v240, v240, v241
v_mul_u32_u24 v11, 1056, v240
v_and_b32 v240, 1, v3
v_lshl_add_u32 v11, v240, 5, v11
v_and_b32 v240, 3, v2
v_lshl_add_u32 v11, v240, 3, v11
s_lshl_b32 s62, s34, 7
s_add_u32 s62, s62, 5120
v_add_u32 v11, s62, v11
s_lshl_b32 s62, s37, 4
v_add_u32 v240, s62, v2
v_mul_u32_u24 v12, 144, v240
v_lshl_add_u32 v12, v3, 3, v12
s_lshl_b32 s62, s36, 5
v_add_u32 v12, s62, v12
v_lshlrev_b32 v15, 4, v240
s_lshl_b32 s62, s36, 2
v_add_u32 v14, s62, v15
v_and_b32 v240, 31, v1
v_mul_u32_u24 v13, 144, v240
v_lshrrev_b32 v241, 5, v1
v_lshl_add_u32 v13, v241, 4, v13
v_lshlrev_b32 v16, 4, v240
v_mov_b32 v17, 0x3e0293ee
v_mov_b32 v18, 0xff800000
v_mov_b32 v19, 0xff800000
v_mov_b32 v20, 0
v_mov_b32 v96, 0
v_mov_b32 v97, 0
v_mov_b32 v98, 0
v_mov_b32 v99, 0
v_mov_b32 v100, 0
v_mov_b32 v101, 0
v_mov_b32 v102, 0
v_mov_b32 v103, 0
v_mov_b32 v104, 0
v_mov_b32 v105, 0
v_mov_b32 v106, 0
v_mov_b32 v107, 0
v_mov_b32 v108, 0
v_mov_b32 v109, 0
v_mov_b32 v110, 0
v_mov_b32 v111, 0
v_mov_b32 v112, 0
v_mov_b32 v113, 0
v_mov_b32 v114, 0
v_mov_b32 v115, 0
v_mov_b32 v116, 0
v_mov_b32 v117, 0
v_mov_b32 v118, 0
v_mov_b32 v119, 0
v_mov_b32 v120, 0
v_mov_b32 v121, 0
v_mov_b32 v122, 0
v_mov_b32 v123, 0
v_mov_b32 v124, 0
v_mov_b32 v125, 0
v_mov_b32 v126, 0
v_mov_b32 v127, 0
v_lshrrev_b32 v240, 5, v1
s_lshl_b32 s62, s34, 2
v_add_u32 v240, s62, v240
v_and_b32 v241, 31, v1
v_lshlrev_b32 v241, 4, v241
v_lshl_add_u32 v242, v240, 10, v241
s_lshl_b32 s62, s35, 15
s_add_u32 s62, s62, 0x0
v_add_u32 v242, s62, v242
v_mul_u32_u24 v243, 528, v240
v_add_u32 v243, v243, v241
v_add_u32 v243, 140288, v243
s_lshl_b32 s62, s37, 4
v_add_u32 v240, s62, v2
v_mul_u32_u24 v244, 528, v240
v_lshl_add_u32 v244, v3, 4, v244
v_add_u32 v244, 140288, v244
v_lshlrev_b32 v240, 7, v1
v_add_u32 v240, 0x15000, v240
s_cmp_lg_u32 s34, 0
s_cbranch_scc1 L_wf_Cq
s_lshl_b64 exec, 1, s32
s_mov_b32 s64, 0
L_pl_Cq1:
buffer_load_dword v241, v240, s[44:47], 0 offen sc1
s_add_u32 s64, s64, 1
s_waitcnt vmcnt(0)
v_cmp_ne_u32 vcc, s58, v241
s_nop 0
s_cmp_eq_u64 vcc, 0
s_cbranch_scc1 L_pd_Cq1
s_mov_b64 exec, vcc
s_sleep 2
s_cmp_lt_u32 s64, 65536
s_cbranch_scc1 L_pl_Cq1
L_pd_Cq1:
s_mov_b32 exec_lo, -1
s_mov_b32 exec_hi, 0
s_mov_b32 s64, 0
L_pl_Cq2:
buffer_load_dword v241, v240, s[44:47], 0 offen sc1
s_add_u32 s64, s64, 1
s_waitcnt vmcnt(0)
v_cmp_ne_u32 vcc, s58, v241
s_nop 0
s_cmp_eq_u64 vcc, 0
s_cbranch_scc1 L_pd_Cq2
s_mov_b64 exec, vcc
s_cmp_lt_u32 s64, 65536
s_cbranch_scc1 L_pl_Cq2
L_pd_Cq2:
s_mov_b64 exec, -1
L_wf_Cq:
s_barrier
buffer_load_dwordx4 v[128:131], v242, s[44:47], 0 offen offset:0 sc1
buffer_load_dwordx4 v[132:135], v242, s[44:47], 0 offen offset:2048 sc1
buffer_load_dwordx4 v[136:139], v242, s[44:47], 0 offen offset:512 sc1
buffer_load_dwordx4 v[140:143], v242, s[44:47], 0 offen offset:2560 sc1
s_waitcnt vmcnt(2)
ds_write_b128 v243, v[128:131] offset:0
ds_write_b128 v243, v[132:135] offset:1056
s_waitcnt lgkmcnt(0)
s_barrier
ds_read_b128 v[32:35], v244 offset:0
ds_read_b128 v[36:39], v244 offset:64
ds_read_b128 v[40:43], v244 offset:128
ds_read_b128 v[44:47], v244 offset:192
ds_read_b128 v[48:51], v244 offset:256
ds_read_b128 v[52:55], v244 offset:320
ds_read_b128 v[56:59], v244 offset:384
ds_read_b128 v[60:63], v244 offset:448
s_waitcnt vmcnt(0)
s_waitcnt lgkmcnt(0)
s_barrier
ds_write_b128 v243, v[136:139] offset:0
ds_write_b128 v243, v[140:143] offset:1056
s_waitcnt lgkmcnt(0)
s_barrier
ds_read_b128 v[64:67], v244 offset:0
ds_read_b128 v[68:71], v244 offset:64
ds_read_b128 v[72:75], v244 offset:128
ds_read_b128 v[76:79], v244 offset:192
ds_read_b128 v[80:83], v244 offset:256
ds_read_b128 v[84:87], v244 offset:320
ds_read_b128 v[88:91], v244 offset:384
ds_read_b128 v[92:95], v244 offset:448
s_mov_b32 s39, 0
s_mov_b32 s48, 0
s_waitcnt vmcnt(0)
.p2align 6
L_C_loop:
s_waitcnt lgkmcnt(0)
s_barrier
s_mov_b32 s52, 1
s_cmp_eq_u32 s39, 0
s_cselect_b32 s52, 0, s52
s_sub_u32 s50, 67584, s48
v_add_u32 v23, s50, v22
s_cmp_eq_u32 s52, 0
s_cbranch_scc1 L_C_st0
s_cmp_lt_u32 s53, 0x80000
s_cselect_b32 s40, s40, s68
s_cselect_b32 s41, s41, s69
s_cselect_b32 s42, s42, s70
s_cselect_b32 s54, s54, 0
s_and_b32 s49, s53, 0x70000
s_xor_b32 s49, s49, s54
s_add_u32 s51, s49, 32768
s_add_u32 s53, s53, 0x10000
s_waitcnt vmcnt(7)
ds_write_b128 v23, v[208:211] offset:0
buffer_load_dwordx4 v[208:211], v9, s[40:43], s49 offen offset:0 nt
s_waitcnt vmcnt(7)
ds_write_b128 v23, v[212:215] offset:1056
buffer_load_dwordx4 v[212:215], v9, s[40:43], s49 offen offset:1024 nt
s_waitcnt vmcnt(7)
ds_write_b128 v23, v[216:219] offset:2112
buffer_load_dwordx4 v[216:219], v9, s[40:43], s49 offen offset:2048 nt
s_waitcnt vmcnt(7)
ds_write_b128 v23, v[220:223] offset:3168
buffer_load_dwordx4 v[220:223], v9, s[40:43], s49 offen offset:3072 nt
s_waitcnt vmcnt(7)
ds_write_b128 v23, v[224:227] offset:33792
buffer_load_dwordx4 v[224:227], v9, s[40:43], s51 offen offset:0 nt
s_waitcnt vmcnt(7)
ds_write_b128 v23, v[228:231] offset:34848
buffer_load_dwordx4 v[228:231], v9, s[40:43], s51 offen offset:1024 nt
s_waitcnt vmcnt(7)
ds_write_b128 v23, v[232:235] offset:35904
buffer_load_dwordx4 v[232:235], v9, s[40:43], s51 offen offset:2048 nt
s_waitcnt vmcnt(7)
ds_write_b128 v23, v[236:239] offset:36960
buffer_load_dwordx4 v[236:239], v9, s[40:43], s51 offen offset:3072 nt
L_C_st0:
v_add_u32 v240, s48, v10
v_add_u32 v241, s48, v11
ds_read_b128 v[128:131], v240 offset:0
ds_read_b128 v[132:135], v240 offset:64
ds_read_b128 v[136:139], v240 offset:128
ds_read_b128 v[140:143], v240 offset:192
ds_read_b128 v[144:147], v240 offset:256
ds_read_b128 v[148:151], v240 offset:320
ds_read_b128 v[152:155], v240 offset:384
ds_read_b128 v[156:159], v240 offset:448
ds_read_b128 v[160:163], v240 offset:512
ds_read_b128 v[164:167], v240 offset:576
ds_read_b128 v[168:171], v240 offset:640
ds_read_b128 v[172:175], v240 offset:704
ds_read_b128 v[176:179], v240 offset:768
ds_read_b128 v[180:183], v240 offset:832
ds_read_b128 v[184:187], v240 offset:896
ds_read_b128 v[188:191], v240 offset:960
s_waitcnt lgkmcnt(15)
v_mfma_f32_16x16x32_bf16 v[28:31], v[128:131], v[32:35], 0
s_waitcnt lgkmcnt(14)
v_mfma_f32_16x16x32_bf16 v[28:31], v[132:135], v[36:39], v[28:31]
s_waitcnt lgkmcnt(13)
v_mfma_f32_16x16x32_bf16 v[28:31], v[136:139], v[40:43], v[28:31]
s_waitcnt lgkmcnt(12)
v_mfma_f32_16x16x32_bf16 v[28:31], v[140:143], v[44:47], v[28:31]
s_waitcnt lgkmcnt(11)
v_mfma_f32_16x16x32_bf16 v[28:31], v[144:147], v[48:51], v[28:31]
s_waitcnt lgkmcnt(10)
v_mfma_f32_16x16x32_bf16 v[28:31], v[148:151], v[52:55], v[28:31]
s_waitcnt lgkmcnt(9)
v_mfma_f32_16x16x32_bf16 v[28:31], v[152:155], v[56:59], v[28:31]
s_waitcnt lgkmcnt(8)
v_mfma_f32_16x16x32_bf16 v[28:31], v[156:159], v[60:63], v[28:31]
s_waitcnt lgkmcnt(7)
v_mfma_f32_16x16x32_bf16 v[28:31], v[160:163], v[64:67], v[28:31]
s_waitcnt lgkmcnt(6)
v_mfma_f32_16x16x32_bf16 v[28:31], v[164:167], v[68:71], v[28:31]
s_waitcnt lgkmcnt(5)
v_mfma_f32_16x16x32_bf16 v[28:31], v[168:171], v[72:75], v[28:31]
s_waitcnt lgkmcnt(4)
v_mfma_f32_16x16x32_bf16 v[28:31], v[172:175], v[76:79], v[28:31]
s_waitcnt lgkmcnt(3)
v_mfma_f32_16x16x32_bf16 v[28:31], v[176:179], v[80:83], v[28:31]
s_waitcnt lgkmcnt(2)
v_mfma_f32_16x16x32_bf16 v[28:31], v[180:183], v[84:87], v[28:31]
s_waitcnt lgkmcnt(1)
v_mfma_f32_16x16x32_bf16 v[28:31], v[184:187], v[88:91], v[28:31]
s_waitcnt lgkmcnt(0)
v_mfma_f32_16x16x32_bf16 v[28:31], v[188:191], v[92:95], v[28:31]
s_nop 7
v_mul_f32 v24, v28, v17
v_mul_f32 v25, v29, v17
v_mul_f32 v26, v30, v17
v_mul_f32 v27, v31, v17
v_max3_f32 v242, v24, v25, v26
v_max_f32 v242, v242, v27
v_mov_b32 v243, v242
s_nop 1
v_permlane16_swap_b32 v242, v243
s_nop 0
v_max_f32 v242, v242, v243
v_mov_b32 v243, v242
s_nop 1
v_permlane32_swap_b32 v242, v243
s_nop 0
v_max_f32 v242, v242, v243
s_mov_b64 exec, 0xffff
ds_write_b32 v14, v242 offset:0
s_mov_b64 exec, -1
s_waitcnt lgkmcnt(0)
s_barrier
ds_read_b128 v[192:195], v15 offset:0
ds_read_b128 v[196:199], v16 offset:0
s_waitcnt lgkmcnt(1)
v_max3_f32 v242, v192, v193, v194
v_max3_f32 v242, v242, v195, v18
v_sub_f32 v21, v18, v242
v_sub_f32 v24, v24, v242
v_sub_f32 v25, v25, v242
v_sub_f32 v26, v26, v242
v_sub_f32 v27, v27, v242
v_exp_f32 v21, v21
v_exp_f32 v24, v24
v_exp_f32 v25, v25
v_exp_f32 v26, v26
v_exp_f32 v27, v27
v_mov_b32 v18, v242
v_cvt_pk_bf16_f32 v244, v24, v25
v_cvt_pk_bf16_f32 v245, v26, v27
ds_write_b64 v12, v[244:245] offset:512
v_add_f32 v24, v24, v25
v_add_f32 v26, v26, v27
v_fma_f32 v20, v20, v21, v24
v_add_f32 v20, v20, v26
s_waitcnt lgkmcnt(1)
v_max3_f32 v242, v196, v197, v198
v_max3_f32 v242, v242, v199, v19
v_sub_f32 v21, v19, v242
v_exp_f32 v21, v21
v_mov_b32 v19, v242
v_mul_f32 v96, v96, v21
v_mul_f32 v97, v97, v21
v_mul_f32 v98, v98, v21
v_mul_f32 v99, v99, v21
v_mul_f32 v100, v100, v21
v_mul_f32 v101, v101, v21
v_mul_f32 v102, v102, v21
v_mul_f32 v103, v103, v21
v_mul_f32 v104, v104, v21
v_mul_f32 v105, v105, v21
v_mul_f32 v106, v106, v21
v_mul_f32 v107, v107, v21
v_mul_f32 v108, v108, v21
v_mul_f32 v109, v109, v21
v_mul_f32 v110, v110, v21
v_mul_f32 v111, v111, v21
v_mul_f32 v112, v112, v21
v_mul_f32 v113, v113, v21
v_mul_f32 v114, v114, v21
v_mul_f32 v115, v115, v21
v_mul_f32 v116, v116, v21
v_mul_f32 v117, v117, v21
v_mul_f32 v118, v118, v21
v_mul_f32 v119, v119, v21
v_mul_f32 v120, v120, v21
v_mul_f32 v121, v121, v21
v_mul_f32 v122, v122, v21
v_mul_f32 v123, v123, v21
v_mul_f32 v124, v124, v21
v_mul_f32 v125, v125, v21
v_mul_f32 v126, v126, v21
v_mul_f32 v127, v127, v21
s_waitcnt lgkmcnt(0)
s_barrier
ds_read_b128 v[192:195], v13 offset:512
ds_read_b128 v[196:199], v13 offset:544
ds_read_b128 v[200:203], v13 offset:576
ds_read_b128 v[204:207], v13 offset:608
ds_read_b64_tr_b16 v[128:129], v241 offset:0
ds_read_b64_tr_b16 v[130:131], v241 offset:4224
ds_read_b64_tr_b16 v[132:133], v241 offset:64
ds_read_b64_tr_b16 v[134:135], v241 offset:4288
ds_read_b64_tr_b16 v[136:137], v241 offset:16896
ds_read_b64_tr_b16 v[138:139], v241 offset:21120
ds_read_b64_tr_b16 v[140:141], v241 offset:16960
ds_read_b64_tr_b16 v[142:143], v241 offset:21184
ds_read_b64_tr_b16 v[144:145], v241 offset:33792
ds_read_b64_tr_b16 v[146:147], v241 offset:38016
ds_read_b64_tr_b16 v[148:149], v241 offset:33856
ds_read_b64_tr_b16 v[150:151], v241 offset:38080
ds_read_b64_tr_b16 v[152:153], v241 offset:50688
ds_read_b64_tr_b16 v[154:155], v241 offset:54912
ds_read_b64_tr_b16 v[156:157], v241 offset:50752
ds_read_b64_tr_b16 v[158:159], v241 offset:54976
s_waitcnt lgkmcnt(12)
v_mfma_f32_32x32x16_bf16 v[96:111], v[128:131], v[192:195], v[96:111]
v_mfma_f32_32x32x16_bf16 v[112:127], v[132:135], v[192:195], v[112:127]
s_waitcnt lgkmcnt(8)
v_mfma_f32_32x32x16_bf16 v[96:111], v[136:139], v[196:199], v[96:111]
v_mfma_f32_32x32x16_bf16 v[112:127], v[140:143], v[196:199], v[112:127]
s_waitcnt lgkmcnt(4)
v_mfma_f32_32x32x16_bf16 v[96:111], v[144:147], v[200:203], v[96:111]
v_mfma_f32_32x32x16_bf16 v[112:127], v[148:151], v[200:203], v[112:127]
s_waitcnt lgkmcnt(0)
v_mfma_f32_32x32x16_bf16 v[96:111], v[152:155], v[204:207], v[96:111]
v_mfma_f32_32x32x16_bf16 v[112:127], v[156:159], v[204:207], v[112:127]
s_sub_u32 s48, 67584, s48
s_add_u32 s39, s39, 1
s_cmp_lt_u32 s39, 8
s_cbranch_scc1 L_C_loop
v_mov_b32 v243, v20
s_nop 1
v_permlane16_swap_b32 v20, v243
s_nop 0
v_add_f32 v20, v20, v243
v_mov_b32 v243, v20
s_nop 1
v_permlane32_swap_b32 v20, v243
s_nop 0
v_add_f32 v20, v20, v243
s_barrier
s_mov_b64 exec, 0xffff
ds_write_b32 v14, v20 offset:0
s_mov_b64 exec, -1
v_and_b32 v240, 31, v1
v_mul_u32_u24 v240, 2064, v240
v_lshrrev_b32 v241, 5, v1
v_lshl_add_u32 v240, v241, 4, v240
s_lshl_b32 s62, s34, 8
s_add_u32 s62, s62, 72704
v_add_u32 v240, s62, v240
s_nop 5
ds_write_b128 v240, v[96:99] offset:0
ds_write_b128 v240, v[100:103] offset:32
ds_write_b128 v240, v[104:107] offset:64
ds_write_b128 v240, v[108:111] offset:96
ds_write_b128 v240, v[112:115] offset:128
ds_write_b128 v240, v[116:119] offset:160
ds_write_b128 v240, v[120:123] offset:192
ds_write_b128 v240, v[124:127] offset:224
s_waitcnt lgkmcnt(0)
s_barrier
s_mul_i32 s62, s34, 8256
s_add_u32 s62, s62, 72704
v_lshl_add_u32 v240, v1, 5, s62
ds_read_b128 v[128:131], v240 offset:0
ds_read_b128 v[132:135], v240 offset:16
ds_read_b128 v[136:139], v240 offset:2064
ds_read_b128 v[140:143], v240 offset:2080
ds_read_b128 v[144:147], v240 offset:4128
ds_read_b128 v[148:151], v240 offset:4144
ds_read_b128 v[152:155], v240 offset:6192
ds_read_b128 v[156:159], v240 offset:6208
ds_read_b128 v[192:195], v16 offset:0
s_lshl_b32 s62, s35, 5
s_lshl_b32 s63, s34, 2
s_add_u32 s62, s62, s63
s_lshl_b32 s62, s62, 4
s_and_b32 s63, s32, 15
s_add_u32 s62, s62, s63
s_lshl_b32 s62, s62, 10
s_add_u32 s62, s62, 0x200000
v_lshl_add_u32 v17, v1, 4, s62
s_lshl_b32 s63, s32, 9
s_add_u32 s63, s63, 0x10000
v_lshl_add_u32 v18, v1, 4, s63
v_mov_b32 v241, 0xffff0000
s_waitcnt lgkmcnt(0)
v_add_f32 v192, v192, v193
v_add_f32 v194, v194, v195
v_add_f32 v196, v192, v194
v_and_or_b32 v200, v19, v241, s76
v_lshl_or_b32 v201, v19, 16, s77
v_and_or_b32 v202, v196, v241, s78
v_lshl_or_b32 v203, v196, 16, s79
s_waitcnt vmcnt(0)
s_barrier
L_C_tail:
v_add_u32 v23, 67584, v22
ds_write_b128 v23, v[208:211] offset:0
ds_write_b128 v23, v[212:215] offset:1056
ds_write_b128 v23, v[216:219] offset:2112
ds_write_b128 v23, v[220:223] offset:3168
ds_write_b128 v23, v[224:227] offset:33792
ds_write_b128 v23, v[228:231] offset:34848
ds_write_b128 v23, v[232:235] offset:35904
ds_write_b128 v23, v[236:239] offset:36960
v_lshrrev_b32 v240, 2, v2
v_lshl_add_u32 v240, v3, 3, v240
v_mul_u32_u24 v240, 1056, v240
v_and_b32 v241, 3, v2
v_lshl_add_u32 v240, v241, 3, v240
s_lshl_b32 s62, s34, 7
s_add_u32 s62, s62, 5120
v_add_u32 v240, s62, v240
s_waitcnt lgkmcnt(0)
v_cvt_pk_bf16_f32 v224, v128, v129
v_cvt_pk_bf16_f32 v225, v130, v131
v_cvt_pk_bf16_f32 v226, v132, v133
v_cvt_pk_bf16_f32 v227, v134, v135
v_cvt_pk_bf16_f32 v228, v136, v137
v_cvt_pk_bf16_f32 v229, v138, v139
v_cvt_pk_bf16_f32 v230, v140, v141
v_cvt_pk_bf16_f32 v231, v142, v143
v_cvt_pk_bf16_f32 v232, v144, v145
v_cvt_pk_bf16_f32 v233, v146, v147
v_cvt_pk_bf16_f32 v234, v148, v149
v_cvt_pk_bf16_f32 v235, v150, v151
v_cvt_pk_bf16_f32 v236, v152, v153
v_cvt_pk_bf16_f32 v237, v154, v155
v_cvt_pk_bf16_f32 v238, v156, v157
v_cvt_pk_bf16_f32 v239, v158, v159
s_barrier
ds_read_b64_tr_b16 v[32:33], v240 offset:0
ds_read_b64_tr_b16 v[34:35], v240 offset:4224
ds_read_b64_tr_b16 v[36:37], v240 offset:32
ds_read_b64_tr_b16 v[38:39], v240 offset:4256
ds_read_b64_tr_b16 v[40:41], v240 offset:64
ds_read_b64_tr_b16 v[42:43], v240 offset:4288
ds_read_b64_tr_b16 v[44:45], v240 offset:96
ds_read_b64_tr_b16 v[46:47], v240 offset:4320
s_waitcnt lgkmcnt(0)
v_add_u32 v240, 33792, v240
ds_read_b64_tr_b16 v[48:49], v240 offset:0
ds_read_b64_tr_b16 v[50:51], v240 offset:4224
ds_read_b64_tr_b16 v[52:53], v240 offset:32
ds_read_b64_tr_b16 v[54:55], v240 offset:4256
ds_read_b64_tr_b16 v[56:57], v240 offset:64
ds_read_b64_tr_b16 v[58:59], v240 offset:4288
ds_read_b64_tr_b16 v[60:61], v240 offset:96
ds_read_b64_tr_b16 v[62:63], v240 offset:4320
s_waitcnt lgkmcnt(0)
v_add_u32 v240, 33792, v240
ds_read_b64_tr_b16 v[64:65], v240 offset:0
ds_read_b64_tr_b16 v[66:67], v240 offset:4224
ds_read_b64_tr_b16 v[68:69], v240 offset:32
ds_read_b64_tr_b16 v[70:71], v240 offset:4256
ds_read_b64_tr_b16 v[72:73], v240 offset:64
ds_read_b64_tr_b16 v[74:75], v240 offset:4288
ds_read_b64_tr_b16 v[76:77], v240 offset:96
ds_read_b64_tr_b16 v[78:79], v240 offset:4320
s_waitcnt lgkmcnt(0)
v_add_u32 v240, 33792, v240
ds_read_b64_tr_b16 v[80:81], v240 offset:0
ds_read_b64_tr_b16 v[82:83], v240 offset:4224
ds_read_b64_tr_b16 v[84:85], v240 offset:32
ds_read_b64_tr_b16 v[86:87], v240 offset:4256
ds_read_b64_tr_b16 v[88:89], v240 offset:64
ds_read_b64_tr_b16 v[90:91], v240 offset:4288
ds_read_b64_tr_b16 v[92:93], v240 offset:96
ds_read_b64_tr_b16 v[94:95], v240 offset:4320
s_waitcnt lgkmcnt(0)
v_bfe_u32 v10, v1, 2, 3
v_lshlrev_b32 v10, 11, v10
v_and_b32 v241, 3, v1
v_lshrrev_b32 v11, 5, v1
v_lshl_add_u32 v241, v11, 2, v241
v_lshl_add_u32 v10, v241, 4, v10
s_lshr_b32 s62, s32, 4
s_and_b32 s63, s32, 15
s_lshl_b32 s60, s62, 16
s_lshl_b32 s61, s63, 7
s_add_u32 s60, s60, s61
s_add_u32 s60, s60, 0x40000
v_add_u32 v10, s60, v10
s_lshl_b32 s60, s62, 11
s_lshl_b32 s61, s63, 6
s_add_u32 s60, s60, s61
s_add_u32 s60, s60, 0
v_lshl_add_u32 v11, v241, 3, s60
v_and_b32 v9, 7, v2
v_lshlrev_b32 v9, 10, v9
v_lshrrev_b32 v241, 3, v2
v_mul_u32_u24 v242, 512, v241
v_add_u32 v9, v9, v242
v_lshl_add_u32 v9, v3, 4, v9
s_lshl_b32 s62, s32, 13
s_add_u32 s62, s62, 0x60000
s_lshl_b32 s63, s34, 6
s_add_u32 s63, s63, s62
v_add_u32 v9, s63, v9
v_mul_u32_u24 v12, 272, v241
v_lshl_add_u32 v12, v3, 3, v12
s_lshl_b32 s62, s34, 5
v_add_u32 v12, s62, v12
v_and_b32 v241, 1, v2
v_mul_u32_u24 v13, 272, v241
v_lshl_add_u32 v13, v3, 4, v13
v_lshlrev_b32 v14, 16, v241
v_bfe_u32 v241, v2, 1, 2
v_lshl_add_u32 v14, v241, 6, v14
v_lshl_add_u32 v14, v3, 4, v14
s_lshl_b32 s62, s32, 11
s_lshl_b32 s63, s34, 8
s_add_u32 s62, s62, s63
s_add_u32 s62, s62, 0x40000
v_add_u32 v14, s62, v14
s_mov_b32 s82, 0xc0c0c0c
s_mov_b32 s83, 0xc0c0c0c
s_mov_b32 s84, 0x30303030
s_mov_b32 s85, 0x30303030
s_mov_b32 s86, 0xc0c0c0c0
s_mov_b32 s87, 0xc0c0c0c0
v_mov_b32 v15, 0xffffff00
s_mov_b32 s60, 0x0c0c0501
s_mov_b32 s61, 0x05010c0c
s_mov_b32 s53, 65536
s_branch L_C_merge
L_C_poll:
v_mov_b32 v96, 0
v_mov_b32 v97, 0
v_mov_b32 v98, 0x8000
v_mov_b32 v99, 0xff00
s_cmp_lg_u32 s34, 0
s_cbranch_scc1 L_Ch_d
s_lshl_b32 s62, s32, 13
s_add_u32 s62, s62, 0x61800
v_lshl_add_u32 v241, v1, 7, s62
s_mov_b64 exec, 1
s_mov_b32 s64, 0
L_pl_Ch:
buffer_load_dword v240, v241, s[44:47], 0 offen offset:1024 sc1
s_add_u32 s64, s64, 1
s_waitcnt vmcnt(0)
v_cmp_gt_i32 vcc, 0, v240
s_nop 0
s_cmp_eq_u64 vcc, 0
s_cbranch_scc1 L_pd_Ch
s_mov_b64 exec, vcc
s_sleep 2
s_cmp_lt_u32 s64, 65536
s_cbranch_scc1 L_pl_Ch
L_pd_Ch:
s_mov_b64 exec, -1
L_Ch_d:
s_barrier
s_mov_b32 s63, 0
buffer_store_dwordx4 v[224:227], v17, s[44:47], s63 offen sc1
s_mov_b32 s63, 16384
buffer_store_dwordx4 v[228:231], v17, s[44:47], s63 offen sc1
s_mov_b32 s63, 32768
buffer_store_dwordx4 v[232:235], v17, s[44:47], s63 offen sc1
s_mov_b32 s63, 49152
buffer_store_dwordx4 v[236:239], v17, s[44:47], s63 offen sc1
s_waitcnt vmcnt(0)
s_barrier
s_cmp_lg_u32 s34, 0
s_cbranch_scc1 L_C_nostat
s_mov_b32 exec_hi, 0
buffer_store_dwordx4 v[200:203], v18, s[44:47], 0 offen sc1
s_mov_b64 exec, -1
L_C_nostat:
s_cmp_lg_u32 s34, 0
s_cbranch_scc1 L_Cg_d
s_lshl_b32 s62, s32, 13
s_add_u32 s62, s62, 0x61800
v_lshl_add_u32 v241, v1, 7, s62
s_mov_b64 exec, 1
s_mov_b32 s64, 0
L_pl_Cg:
buffer_load_dword v240, v241, s[44:47], 0 offen offset:1024 sc1
s_add_u32 s64, s64, 1
s_waitcnt vmcnt(0)
v_cmp_gt_i32 vcc, 1, v240
s_nop 0
s_cmp_eq_u64 vcc, 0
s_cbranch_scc1 L_pd_Cg
s_mov_b64 exec, vcc
s_sleep 2
s_cmp_lt_u32 s64, 65536
s_cbranch_scc1 L_pl_Cg
L_pd_Cg:
s_mov_b64 exec, -1
L_Cg_d:
s_barrier
s_mov_b32 exec_lo, 0x3f3f3f3f
s_mov_b32 exec_hi, 0x3f3f3f3f
s_mov_b32 s64, 0
s_mov_b32 s66, 0x1000
s_mov_b32 s67, 0x2000
buffer_load_dwordx4 v[208:211], v9, s[44:47], 0 offen sc1
L_ps_Co:
s_waitcnt vmcnt(0)
v_xor_b32 v96, s76, v208
v_xor_b32 v97, s77, v209
v_xor_b32 v98, s78, v210
v_xor_b32 v99, s79, v211
v_or_b32 v240, v96, v97
v_or3_b32 v240, v240, v98, v99
v_and_b32 v240, 0xff, v240
v_cmp_ne_u32 vcc, 0, v240
s_cmp_eq_u64 vcc, 0
s_cbranch_scc1 L_pe_Co
buffer_load_dwordx4 v[208:211], v9, s[44:47], 0 offen sc1
s_add_u32 s64, s64, 1
s_cmp_lt_u32 s64, 65536
s_cbranch_scc1 L_ps_Co
L_pe_Co:
s_mov_b64 exec, -1
L_C_merge:
v_perm_b32 v100, v97, v96, s60
v_perm_b32 v101, v99, v98, s61
v_or_b32 v100, v100, v101
v_and_b32 v96, 0xffff0000, v96
v_and_b32 v97, 0xffff0000, v97
v_max_f32_dpp v101, v100, v100 quad_perm:[1,0,3,2] row_mask:0xf bank_mask:0xf
v_and_b32 v98, 0xffff0000, v98
v_and_b32 v99, 0xffff0000, v99
v_max_f32_dpp v101, v101, v101 quad_perm:[2,3,0,1] row_mask:0xf bank_mask:0xf
s_nop 1
v_max_f32_dpp v101, v101, v101 row_half_mirror row_mask:0xf bank_mask:0xf
v_sub_f32 v100, v100, v101
v_exp_f32 v100, v100
s_nop 0
v_mul_f32 v96, v96, v100
v_mul_f32 v97, v97, v100
v_mul_f32 v98, v98, v100
v_mul_f32 v99, v99, v100
v_add_f32_dpp v100, v100, v100 quad_perm:[1,0,3,2] row_mask:0xf bank_mask:0xf
v_add_f32_dpp v96, v96, v96 quad_perm:[1,0,3,2] row_mask:0xf bank_mask:0xf
v_add_f32_dpp v97, v97, v97 quad_perm:[1,0,3,2] row_mask:0xf bank_mask:0xf
v_add_f32_dpp v98, v98, v98 quad_perm:[1,0,3,2] row_mask:0xf bank_mask:0xf
v_add_f32_dpp v99, v99, v99 quad_perm:[1,0,3,2] row_mask:0xf bank_mask:0xf
v_add_f32_dpp v100, v100, v100 quad_perm:[2,3,0,1] row_mask:0xf bank_mask:0xf
v_add_f32_dpp v96, v96, v96 quad_perm:[2,3,0,1] row_mask:0xf bank_mask:0xf
v_add_f32_dpp v97, v97, v97 quad_perm:[2,3,0,1] row_mask:0xf bank_mask:0xf
v_add_f32_dpp v98, v98, v98 quad_perm:[2,3,0,1] row_mask:0xf bank_mask:0xf
v_add_f32_dpp v99, v99, v99 quad_perm:[2,3,0,1] row_mask:0xf bank_mask:0xf
v_add_f32_dpp v100, v100, v100 row_half_mirror row_mask:0xf bank_mask:0xf
v_add_f32_dpp v96, v96, v96 row_half_mirror row_mask:0xf bank_mask:0xf
v_add_f32_dpp v97, v97, v97 row_half_mirror row_mask:0xf bank_mask:0xf
v_add_f32_dpp v98, v98, v98 row_half_mirror row_mask:0xf bank_mask:0xf
v_add_f32_dpp v99, v99, v99 row_half_mirror row_mask:0xf bank_mask:0xf
v_rcp_f32 v100, v100
s_mov_b32 exec_lo, 0x01010101
s_mov_b32 exec_hi, 0x01010101
v_mul_f32 v96, v96, v100
v_mul_f32 v97, v97, v100
v_mul_f32 v98, v98, v100
v_mul_f32 v99, v99, v100
v_cvt_pk_bf16_f32 v96, v96, v97
v_cvt_pk_bf16_f32 v97, v98, v99
ds_write_b64 v12, v[96:97] offset:0
s_mov_b64 exec, -1
s_waitcnt lgkmcnt(0)
s_barrier
ds_read_b128 v[104:107], v13 offset:0
ds_read_b128 v[108:111], v13 offset:64
ds_read_b128 v[112:115], v13 offset:128
ds_read_b128 v[116:119], v13 offset:192
s_waitcnt lgkmcnt(3)
v_mfma_f32_16x16x32_bf16 v[128:131], v[32:35], v[104:107], 0
v_mfma_f32_16x16x32_bf16 v[132:135], v[36:39], v[104:107], 0
v_mfma_f32_16x16x32_bf16 v[136:139], v[40:43], v[104:107], 0
v_mfma_f32_16x16x32_bf16 v[140:143], v[44:47], v[104:107], 0
s_waitcnt lgkmcnt(2)
v_mfma_f32_16x16x32_bf16 v[128:131], v[48:51], v[108:111], v[128:131]
v_mfma_f32_16x16x32_bf16 v[132:135], v[52:55], v[108:111], v[132:135]
v_mfma_f32_16x16x32_bf16 v[136:139], v[56:59], v[108:111], v[136:139]
v_mfma_f32_16x16x32_bf16 v[140:143], v[60:63], v[108:111], v[140:143]
s_waitcnt lgkmcnt(1)
v_mfma_f32_16x16x32_bf16 v[128:131], v[64:67], v[112:115], v[128:131]
v_mfma_f32_16x16x32_bf16 v[132:135], v[68:71], v[112:115], v[132:135]
v_mfma_f32_16x16x32_bf16 v[136:139], v[72:75], v[112:115], v[136:139]
v_mfma_f32_16x16x32_bf16 v[140:143], v[76:79], v[112:115], v[140:143]
s_waitcnt lgkmcnt(0)
v_mfma_f32_16x16x32_bf16 v[128:131], v[80:83], v[116:119], v[128:131]
v_mfma_f32_16x16x32_bf16 v[132:135], v[84:87], v[116:119], v[132:135]
v_mfma_f32_16x16x32_bf16 v[136:139], v[88:91], v[116:119], v[136:139]
v_mfma_f32_16x16x32_bf16 v[140:143], v[92:95], v[116:119], v[140:143]
s_mov_b32 s64, s53
s_nop 4
v_cndmask_b32 v128, v128, v132, s[82:83]
v_cndmask_b32 v129, v129, v133, s[82:83]
v_cndmask_b32 v130, v130, v134, s[82:83]
v_cndmask_b32 v131, v131, v135, s[82:83]
v_cndmask_b32 v128, v128, v136, s[84:85]
v_cndmask_b32 v129, v129, v137, s[84:85]
v_cndmask_b32 v130, v130, v138, s[84:85]
v_cndmask_b32 v131, v131, v139, s[84:85]
v_cndmask_b32 v128, v128, v140, s[86:87]
v_cndmask_b32 v129, v129, v141, s[86:87]
v_cndmask_b32 v130, v130, v142, s[86:87]
v_cndmask_b32 v131, v131, v143, s[86:87]
v_add_u32 v128, 0x80, v128
v_add_u32 v129, 0x80, v129
v_add_u32 v130, 0x80, v130
v_add_u32 v131, 0x80, v131
v_and_or_b32 v128, v128, v15, s76
v_and_or_b32 v129, v129, v15, s77
v_and_or_b32 v130, v130, v15, s78
v_and_or_b32 v131, v131, v15, s79
s_cmp_lg_u32 s53, 0
s_cbranch_scc1 L_C_nost
s_mov_b32 exec_lo, 0x00ff00ff
s_mov_b32 exec_hi, 0x00ff00ff
buffer_store_dwordx4 v[128:131], v14, s[44:47], 0 offen sc1
s_mov_b64 exec, -1
L_C_nost:
s_cmp_lg_u32 s34, 4
s_cbranch_scc1 L_C_end
s_mov_b32 s66, 0x4000
s_mov_b32 s67, 0x8000
s_mov_b32 s65, 0xc000
buffer_load_dwordx4 v[144:147], v10, s[44:47], 0 offen sc1
buffer_load_dwordx4 v[148:151], v10, s[44:47], s66 offen sc1
buffer_load_dwordx4 v[152:155], v10, s[44:47], s67 offen sc1
buffer_load_dwordx4 v[156:159], v10, s[44:47], s65 offen sc1
s_sleep 6
buffer_load_dwordx4 v[160:163], v10, s[44:47], 0 offen sc1
buffer_load_dwordx4 v[164:167], v10, s[44:47], s66 offen sc1
buffer_load_dwordx4 v[168:171], v10, s[44:47], s67 offen sc1
buffer_load_dwordx4 v[172:175], v10, s[44:47], s65 offen sc1
s_sleep 6
buffer_load_dwordx4 v[176:179], v10, s[44:47], 0 offen sc1
buffer_load_dwordx4 v[180:183], v10, s[44:47], s66 offen sc1
buffer_load_dwordx4 v[184:187], v10, s[44:47], s67 offen sc1
buffer_load_dwordx4 v[188:191], v10, s[44:47], s65 offen sc1
L_ps_Cf:
s_waitcnt vmcnt(11)
v_xor_b32 v192, s76, v144
v_xor_b32 v193, s77, v145
v_xor_b32 v194, s78, v146
v_xor_b32 v195, s79, v147
v_or_b32 v240, v192, v193
v_or3_b32 v240, v240, v194, v195
s_waitcnt vmcnt(10)
v_xor_b32 v196, s76, v148
v_xor_b32 v197, s77, v149
v_xor_b32 v198, s78, v150
v_xor_b32 v199, s79, v151
v_or3_b32 v240, v240, v196, v197
v_or3_b32 v240, v240, v198, v199
v_add_f32 v192, v192, v196
v_add_f32 v193, v193, v197
v_add_f32 v194, v194, v198
v_add_f32 v195, v195, v199
s_waitcnt vmcnt(9)
v_xor_b32 v196, s76, v152
v_xor_b32 v197, s77, v153
v_xor_b32 v198, s78, v154
v_xor_b32 v199, s79, v155
v_or3_b32 v240, v240, v196, v197
v_or3_b32 v240, v240, v198, v199
v_add_f32 v192, v192, v196
v_add_f32 v193, v193, v197
v_add_f32 v194, v194, v198
v_add_f32 v195, v195, v199
s_waitcnt vmcnt(8)
v_xor_b32 v196, s76, v156
v_xor_b32 v197, s77, v157
v_xor_b32 v198, s78, v158
v_xor_b32 v199, s79, v159
v_or3_b32 v240, v240, v196, v197
v_or3_b32 v240, v240, v198, v199
v_add_f32 v192, v192, v196
v_add_f32 v193, v193, v197
v_add_f32 v194, v194, v198
v_add_f32 v195, v195, v199
v_and_b32 v240, 0xff, v240
v_cmp_ne_u32 vcc, 0, v240
v_add_f32_dpp v192, v192, v192 row_ror:8 row_mask:0xf bank_mask:0xf
v_add_f32_dpp v193, v193, v193 row_ror:8 row_mask:0xf bank_mask:0xf
v_add_f32_dpp v194, v194, v194 row_ror:8 row_mask:0xf bank_mask:0xf
v_add_f32_dpp v195, v195, v195 row_ror:8 row_mask:0xf bank_mask:0xf
s_cmp_eq_u64 vcc, 0
s_cbranch_scc1 L_pe_Cf
buffer_load_dwordx4 v[144:147], v10, s[44:47], 0 offen sc1
buffer_load_dwordx4 v[148:151], v10, s[44:47], s66 offen sc1
buffer_load_dwordx4 v[152:155], v10, s[44:47], s67 offen sc1
buffer_load_dwordx4 v[156:159], v10, s[44:47], s65 offen sc1
s_waitcnt vmcnt(11)
v_xor_b32 v192, s76, v160
v_xor_b32 v193, s77, v161
v_xor_b32 v194, s78, v162
v_xor_b32 v195, s79, v163
v_or_b32 v240, v192, v193
v_or3_b32 v240, v240, v194, v195
s_waitcnt vmcnt(10)
v_xor_b32 v196, s76, v164
v_xor_b32 v197, s77, v165
v_xor_b32 v198, s78, v166
v_xor_b32 v199, s79, v167
v_or3_b32 v240, v240, v196, v197
v_or3_b32 v240, v240, v198, v199
v_add_f32 v192, v192, v196
v_add_f32 v193, v193, v197
v_add_f32 v194, v194, v198
v_add_f32 v195, v195, v199
s_waitcnt vmcnt(9)
v_xor_b32 v196, s76, v168
v_xor_b32 v197, s77, v169
v_xor_b32 v198, s78, v170
v_xor_b32 v199, s79, v171
v_or3_b32 v240, v240, v196, v197
v_or3_b32 v240, v240, v198, v199
v_add_f32 v192, v192, v196
v_add_f32 v193, v193, v197
v_add_f32 v194, v194, v198
v_add_f32 v195, v195, v199
s_waitcnt vmcnt(8)
v_xor_b32 v196, s76, v172
v_xor_b32 v197, s77, v173
v_xor_b32 v198, s78, v174
v_xor_b32 v199, s79, v175
v_or3_b32 v240, v240, v196, v197
v_or3_b32 v240, v240, v198, v199
v_add_f32 v192, v192, v196
v_add_f32 v193, v193, v197
v_add_f32 v194, v194, v198
v_add_f32 v195, v195, v199
v_and_b32 v240, 0xff, v240
v_cmp_ne_u32 vcc, 0, v240
v_add_f32_dpp v192, v192, v192 row_ror:8 row_mask:0xf bank_mask:0xf
v_add_f32_dpp v193, v193, v193 row_ror:8 row_mask:0xf bank_mask:0xf
v_add_f32_dpp v194, v194, v194 row_ror:8 row_mask:0xf bank_mask:0xf
v_add_f32_dpp v195, v195, v195 row_ror:8 row_mask:0xf bank_mask:0xf
s_cmp_eq_u64 vcc, 0
s_cbranch_scc1 L_pe_Cf
buffer_load_dwordx4 v[160:163], v10, s[44:47], 0 offen sc1
buffer_load_dwordx4 v[164:167], v10, s[44:47], s66 offen sc1
buffer_load_dwordx4 v[168:171], v10, s[44:47], s67 offen sc1
buffer_load_dwordx4 v[172:175], v10, s[44:47], s65 offen sc1
s_waitcnt vmcnt(11)
v_xor_b32 v192, s76, v176
v_xor_b32 v193, s77, v177
v_xor_b32 v194, s78, v178
v_xor_b32 v195, s79, v179
v_or_b32 v240, v192, v193
v_or3_b32 v240, v240, v194, v195
s_waitcnt vmcnt(10)
v_xor_b32 v196, s76, v180
v_xor_b32 v197, s77, v181
v_xor_b32 v198, s78, v182
v_xor_b32 v199, s79, v183
v_or3_b32 v240, v240, v196, v197
v_or3_b32 v240, v240, v198, v199
v_add_f32 v192, v192, v196
v_add_f32 v193, v193, v197
v_add_f32 v194, v194, v198
v_add_f32 v195, v195, v199
s_waitcnt vmcnt(9)
v_xor_b32 v196, s76, v184
v_xor_b32 v197, s77, v185
v_xor_b32 v198, s78, v186
v_xor_b32 v199, s79, v187
v_or3_b32 v240, v240, v196, v197
v_or3_b32 v240, v240, v198, v199
v_add_f32 v192, v192, v196
v_add_f32 v193, v193, v197
v_add_f32 v194, v194, v198
v_add_f32 v195, v195, v199
s_waitcnt vmcnt(8)
v_xor_b32 v196, s76, v188
v_xor_b32 v197, s77, v189
v_xor_b32 v198, s78, v190
v_xor_b32 v199, s79, v191
v_or3_b32 v240, v240, v196, v197
v_or3_b32 v240, v240, v198, v199
v_add_f32 v192, v192, v196
v_add_f32 v193, v193, v197
v_add_f32 v194, v194, v198
v_add_f32 v195, v195, v199
v_and_b32 v240, 0xff, v240
v_cmp_ne_u32 vcc, 0, v240
v_add_f32_dpp v192, v192, v192 row_ror:8 row_mask:0xf bank_mask:0xf
v_add_f32_dpp v193, v193, v193 row_ror:8 row_mask:0xf bank_mask:0xf
v_add_f32_dpp v194, v194, v194 row_ror:8 row_mask:0xf bank_mask:0xf
v_add_f32_dpp v195, v195, v195 row_ror:8 row_mask:0xf bank_mask:0xf
s_cmp_eq_u64 vcc, 0
s_cbranch_scc1 L_pe_Cf
buffer_load_dwordx4 v[176:179], v10, s[44:47], 0 offen sc1
buffer_load_dwordx4 v[180:183], v10, s[44:47], s66 offen sc1
buffer_load_dwordx4 v[184:187], v10, s[44:47], s67 offen sc1
buffer_load_dwordx4 v[188:191], v10, s[44:47], s65 offen sc1
s_add_u32 s64, s64, 1
s_cmp_lt_u32 s64, 65536
s_cbranch_scc1 L_ps_Cf
L_pe_Cf:
v_add_f32_dpp v192, v192, v192 row_ror:4 row_mask:0xf bank_mask:0xf
v_add_f32_dpp v193, v193, v193 row_ror:4 row_mask:0xf bank_mask:0xf
v_add_f32_dpp v194, v194, v194 row_ror:4 row_mask:0xf bank_mask:0xf
v_add_f32_dpp v195, v195, v195 row_ror:4 row_mask:0xf bank_mask:0xf
v_mov_b32 v240, v192
v_mov_b32 v241, v193
v_mov_b32 v242, v194
v_mov_b32 v243, v195
v_permlane16_swap_b32 v192, v240
v_permlane16_swap_b32 v193, v241
v_permlane16_swap_b32 v194, v242
v_permlane16_swap_b32 v195, v243
v_add_f32 v192, v192, v240
v_add_f32 v193, v193, v241
v_add_f32 v194, v194, v242
v_add_f32 v195, v195, v243
v_cvt_pk_bf16_f32 v192, v192, v193
v_cvt_pk_bf16_f32 v193, v194, v195
s_cmp_lg_u32 s53, 0
s_cbranch_scc1 L_C_end
s_mov_b32 exec_lo, 15
s_mov_b32 exec_hi, 15
global_store_dwordx2 v11, v[192:193], s[26:27]
s_mov_b64 exec, -1
s_cmp_lg_u32 s32, 0
s_cbranch_scc1 L_C_end
v_mov_b32 v240, 0x14000
v_mov_b32 v241, s58
s_mov_b64 exec, 1
buffer_store_dword v241, v240, s[44:47], 0 offen sc1
L_C_end:
s_cmp_lg_u32 s53, 0
s_mov_b32 s53, 0
s_cbranch_scc1 L_C_poll
s_endpgm
L_exit:
s_endpgm
.section .rodata,"a"
.p2align 6
.amdhsa_kernel concat_heads__gqa_block_cached__compressed_kv_cla__decode_kernel
  .amdhsa_next_free_vgpr 256
  .amdhsa_next_free_sgpr 102
  .amdhsa_accum_offset 256
  .amdhsa_group_segment_fixed_size 0
  .amdhsa_kernarg_size 112
  .amdhsa_user_sgpr_count 2
  .amdhsa_user_sgpr_kernarg_segment_ptr 1
  .amdhsa_system_sgpr_workgroup_id_x 1
.end_amdhsa_kernel
```

```asm
; @launch grid=(256,1,1) block=(512,1,1) lds=157696
.amdgcn_target "amdgcn-amd-amdhsa--gfx950"
.text
.globl concat_heads__gqa_block_cached__compressed_kv_cla__decode_kernel
.p2align 12
.type concat_heads__gqa_block_cached__compressed_kv_cla__decode_kernel,@function
concat_heads__gqa_block_cached__compressed_kv_cla__decode_kernel:
s_cmpk_ge_u32 s2, 256
s_cbranch_scc1 L_exit
s_load_dwordx16 s[4:19], s[0:1], 0
s_load_dwordx8 s[20:27], s[0:1], 64
s_load_dwordx4 s[28:31], s[0:1], 96
v_readfirstlane_b32 s34, v0
s_lshr_b32 s32, s2, 3
s_lshr_b32 s60, s2, 6
s_lshl1_add_u32 s61, s60, 2
s_sub_u32 s33, s32, s61
s_and_b32 s33, s33, 7
s_xor_b32 s61, s2, s60
s_and_b32 s61, s61, 7
s_lshl3_add_u32 s82, s60, s61
s_lshr_b32 s34, s34, 6
v_and_b32 v2, 15, v0
v_bfe_u32 v3, v0, 4, 2
v_lshlrev_b32 v11, 4, v2
s_mov_b32 s87, 0x20000
v_lshl_add_u32 v9, v3, 13, v11
s_add_u32 s63, s33, 1
s_and_b32 s60, s63, 3
s_bitcmp1_b32 s63, 2
s_cselect_b32 s61, 0, 5
s_lshl3_add_u32 s60, s60, s34
s_lshl_b32 s60, s60, 9
s_xor_b32 s61, s61, s82
s_add_u32 s60, s60, s61
s_lshl_b32 s88, s60, 8
s_lshl_b32 s89, 1, 15
s_add_u32 s60, s88, s89
s_add_u32 s61, s60, s89
s_add_u32 s62, s61, s89
s_mov_b32 s86, 0x400000
s_bitcmp1_b32 s63, 2
s_waitcnt lgkmcnt(0)
s_cselect_b64 s[84:85], s[18:19], s[10:11]
s_and_b32 s85, s85, 0xffff
buffer_load_dwordx4 v[128:131], v9, s[84:87], s88 offen
buffer_load_dwordx4 v[132:135], v9, s[84:87], s60 offen
buffer_load_dwordx4 v[136:139], v9, s[84:87], s61 offen
buffer_load_dwordx4 v[140:143], v9, s[84:87], s62 offen
s_cmp_eq_u32 s33, 6
s_cbranch_scc1 L_roleW
s_cmp_eq_u32 s33, 7
s_cbranch_scc1 L_roleC
L_ids:
v_and_b32 v1, 63, v0
s_lshl_b32 s61, s33, 2
s_lshr_b32 s61, 0x50764321, s61
s_and_b32 s61, s61, 7
s_xor_b32 s32, s82, s61
L_roleA:
s_xor_b32 s83, s82, 5
s_add_u32 s60, s33, 0x0
s_lshl3_add_u32 s60, s60, s34
s_lshl_b32 s60, s60, 17
s_lshl_b32 s61, s82, 8
s_add_u32 s60, s60, s61
s_mov_b64 s[84:85], s[20:21]
s_mov_b32 s86, 0x400000
s_mov_b32 s88, s60
s_mov_b32 s81, 13
s_add_u32 s60, s33, 0xfffffffc
s_lshl3_add_u32 s60, s60, s34
s_lshl_b32 s60, s60, 17
s_xor_b32 s61, s82, 7
s_lshl_b32 s61, s61, 8
s_add_u32 s60, s60, s61
s_cmp_ge_u32 s33, 4
s_cselect_b64 s[84:85], s[22:23], s[84:85]
s_cselect_b32 s86, 0x400000, s86
s_cselect_b32 s88, s60, s88
s_cselect_b32 s81, 13, s81
s_and_b32 s85, s85, 0xffff
s_lshl_b32 s89, 4, s81
v_lshl_add_u32 v10, v3, s81, v11
s_and_b32 s63, s2, 7
s_bitcmp1_b32 7, s63
s_cselect_b64 vcc, -1, 0
s_waitcnt vmcnt(3)
s_cbranch_vccz L_A_pf4
s_waitcnt vmcnt(2)
L_A_pf4:
buffer_load_dwordx4 v[20:23], v10, s[84:87], s88 offen
s_add_u32 s88, s88, s89
s_waitcnt vmcnt(3)
s_cbranch_vccz L_A_pf5
s_waitcnt vmcnt(2)
L_A_pf5:
buffer_load_dwordx4 v[24:27], v10, s[84:87], s88 offen
s_add_u32 s88, s88, s89
s_waitcnt vmcnt(3)
s_cbranch_vccz L_A_pf6
s_waitcnt vmcnt(2)
L_A_pf6:
buffer_load_dwordx4 v[28:31], v10, s[84:87], s88 offen
s_add_u32 s88, s88, s89
s_waitcnt vmcnt(3)
s_cbranch_vccz L_A_pf7
s_waitcnt vmcnt(2)
L_A_pf7:
buffer_load_dwordx4 v[32:35], v10, s[84:87], s88 offen
v_lshlrev_b32 v8, 4, v1
s_bfe_u32 s55, s32, 0x10004
s_lshl_b32 s55, s55, 26
s_lshl_b32 s35, s33, 3
s_add_u32 s35, s35, s34
s_bfe_u32 s63, s35, 0x10009
s_lshl_b32 s63, s63, 26
s_xor_b32 s37, s63, s55
s_bfe_u32 s63, s35, 0x90000
s_lshl_b32 s63, s63, 12
s_or_b32 s37, s37, s63
s_lshl_b32 s62, s32, 21
s_add_u32 s40, s6, s62
s_addc_u32 s41, s7, 0
s_and_b32 s41, s41, 0xffff
s_mov_b32 s42, 0x4200000
s_mov_b32 s43, 0x20000
s_add_u32 s60, s33, 0x2
s_lshl3_add_u32 s60, s60, s34
s_lshl_b32 s60, s60, 17
s_xor_b32 s61, s82, 7
s_lshl_b32 s61, s61, 8
s_add_u32 s60, s60, s61
s_mov_b64 s[84:85], s[22:23]
s_mov_b32 s86, 0x400000
s_mov_b32 s88, s60
s_mov_b32 s81, 13
s_add_u32 s60, s33, 0xfffffffe
s_lshl3_add_u32 s60, s60, s34
s_lshl_b32 s60, s60, 12
s_xor_b32 s61, s82, 7
s_lshl_b32 s61, s61, 17
s_add_u32 s60, s60, s61
s_cmp_ge_u32 s33, 2
s_cselect_b64 s[84:85], s[24:25], s[84:85]
s_cselect_b32 s86, 0x400000, s86
s_cselect_b32 s88, s60, s88
s_cselect_b32 s81, 8, s81
s_and_b32 s85, s85, 0xffff
s_lshl_b32 s89, 4, s81
v_lshl_add_u32 v9, v3, s81, v11
s_and_b32 s63, s2, 7
s_bitcmp1_b32 15, s63
s_cselect_b64 vcc, -1, 0
s_waitcnt vmcnt(3)
s_cbranch_vccz L_A_pf8
s_waitcnt vmcnt(2)
L_A_pf8:
buffer_load_dwordx4 v[20:23], v9, s[84:87], s88 offen
s_add_u32 s88, s88, s89
s_waitcnt vmcnt(3)
s_cbranch_vccz L_A_pf9
s_waitcnt vmcnt(2)
L_A_pf9:
buffer_load_dwordx4 v[24:27], v9, s[84:87], s88 offen
s_add_u32 s88, s88, s89
s_waitcnt vmcnt(3)
s_cbranch_vccz L_A_pf10
s_waitcnt vmcnt(2)
L_A_pf10:
buffer_load_dwordx4 v[28:31], v9, s[84:87], s88 offen
s_add_u32 s88, s88, s89
s_waitcnt vmcnt(3)
s_cbranch_vccz L_A_pf11
s_waitcnt vmcnt(2)
L_A_pf11:
buffer_load_dwordx4 v[32:35], v9, s[84:87], s88 offen
s_add_u32 s60, s33, 0x2
s_lshl3_add_u32 s60, s60, s34
s_lshl_b32 s60, s60, 12
s_and_b32 s61, s83, 3
s_lshl_b32 s61, s61, 17
s_xor_b32 s60, s60, s61
s_lshl_b32 s61, s83, 19
s_add_u32 s60, s60, s61
s_mov_b64 s[84:85], s[16:17]
s_mov_b32 s86, 0x1000000
s_mov_b32 s88, s60
s_mov_b32 s81, 8
s_and_b32 s85, s85, 0xffff
s_lshl_b32 s89, 4, s81
v_lshl_add_u32 v10, v3, s81, v11
s_and_b32 s63, s2, 7
s_bitcmp1_b32 79, s63
s_cselect_b64 vcc, -1, 0
s_waitcnt vmcnt(3)
s_cbranch_vccz L_A_pf12
s_waitcnt vmcnt(2)
L_A_pf12:
buffer_load_dwordx4 v[20:23], v10, s[84:87], s88 offen
s_add_u32 s88, s88, s89
s_waitcnt vmcnt(3)
s_cbranch_vccz L_A_pf13
s_waitcnt vmcnt(2)
L_A_pf13:
buffer_load_dwordx4 v[24:27], v10, s[84:87], s88 offen
s_add_u32 s88, s88, s89
s_waitcnt vmcnt(3)
s_cbranch_vccz L_A_pf14
s_waitcnt vmcnt(2)
L_A_pf14:
buffer_load_dwordx4 v[28:31], v10, s[84:87], s88 offen
s_add_u32 s88, s88, s89
s_waitcnt vmcnt(3)
s_cbranch_vccz L_A_pf15
s_waitcnt vmcnt(2)
L_A_pf15:
buffer_load_dwordx4 v[32:35], v10, s[84:87], s88 offen
s_add_u32 s60, s33, 0x8
s_lshl3_add_u32 s60, s60, s34
s_lshl_b32 s60, s60, 12
s_and_b32 s61, s83, 3
s_lshl_b32 s61, s61, 17
s_xor_b32 s60, s60, s61
s_lshl_b32 s61, s83, 19
s_add_u32 s60, s60, s61
s_mov_b64 s[84:85], s[16:17]
s_mov_b32 s86, 0x1000000
s_mov_b32 s88, s60
s_mov_b32 s81, 8
s_and_b32 s85, s85, 0xffff
s_lshl_b32 s89, 4, s81
v_lshl_add_u32 v9, v3, s81, v11
s_and_b32 s63, s2, 7
s_bitcmp1_b32 79, s63
s_cselect_b64 vcc, -1, 0
s_waitcnt vmcnt(3)
s_cbranch_vccz L_A_pf16
s_waitcnt vmcnt(2)
L_A_pf16:
buffer_load_dwordx4 v[20:23], v9, s[84:87], s88 offen
s_add_u32 s88, s88, s89
s_waitcnt vmcnt(3)
s_cbranch_vccz L_A_pf17
s_waitcnt vmcnt(2)
L_A_pf17:
buffer_load_dwordx4 v[24:27], v9, s[84:87], s88 offen
s_add_u32 s88, s88, s89
s_waitcnt vmcnt(3)
s_cbranch_vccz L_A_pf18
s_waitcnt vmcnt(2)
L_A_pf18:
buffer_load_dwordx4 v[28:31], v9, s[84:87], s88 offen
s_add_u32 s88, s88, s89
s_waitcnt vmcnt(3)
s_cbranch_vccz L_A_pf19
s_waitcnt vmcnt(2)
L_A_pf19:
buffer_load_dwordx4 v[32:35], v9, s[84:87], s88 offen
s_add_u32 s60, s33, 0xe
s_lshl3_add_u32 s60, s60, s34
s_lshl_b32 s60, s60, 12
s_and_b32 s61, s83, 3
s_lshl_b32 s61, s61, 17
s_xor_b32 s60, s60, s61
s_lshl_b32 s61, s83, 19
s_add_u32 s60, s60, s61
s_mov_b64 s[84:85], s[16:17]
s_mov_b32 s86, 0x1000000
s_mov_b32 s88, s60
s_mov_b32 s81, 8
s_add_u32 s60, s33, 0xfffffffe
s_lshl3_add_u32 s60, s60, s34
s_lshl_b32 s60, s60, 12
s_lshl_b32 s61, s83, 17
s_add_u32 s60, s60, s61
s_cmp_ge_u32 s33, 2
s_cselect_b64 s[84:85], s[12:13], s[84:85]
s_cselect_b32 s86, 0x400000, s86
s_cselect_b32 s88, s60, s88
s_cselect_b32 s81, 8, s81
s_and_b32 s85, s85, 0xffff
s_lshl_b32 s89, 4, s81
v_lshl_add_u32 v10, v3, s81, v11
s_and_b32 s63, s2, 7
s_bitcmp1_b32 79, s63
s_cselect_b64 vcc, -1, 0
s_waitcnt vmcnt(3)
s_cbranch_vccz L_A_pf20
s_waitcnt vmcnt(2)
L_A_pf20:
buffer_load_dwordx4 v[20:23], v10, s[84:87], s88 offen
s_add_u32 s88, s88, s89
s_waitcnt vmcnt(3)
s_cbranch_vccz L_A_pf21
s_waitcnt vmcnt(2)
L_A_pf21:
buffer_load_dwordx4 v[24:27], v10, s[84:87], s88 offen
s_add_u32 s88, s88, s89
s_waitcnt vmcnt(3)
s_cbranch_vccz L_A_pf22
s_waitcnt vmcnt(2)
L_A_pf22:
buffer_load_dwordx4 v[28:31], v10, s[84:87], s88 offen
s_add_u32 s88, s88, s89
s_waitcnt vmcnt(3)
s_cbranch_vccz L_A_pf23
s_waitcnt vmcnt(2)
L_A_pf23:
buffer_load_dwordx4 v[32:35], v10, s[84:87], s88 offen
s_waitcnt vmcnt(3)
s_and_b32 s63, s2, 7
s_bitcmp1_b32 7, s63
s_cselect_b64 vcc, -1, 0
s_cbranch_vccz L_A_pre0
s_waitcnt vmcnt(2)
L_A_pre0:
buffer_load_dwordx4 v[52:55], v8, s[40:43], s37 offen offset:0 nt
s_waitcnt vmcnt(3)
s_cbranch_vccz L_A_pre1
s_waitcnt vmcnt(2)
L_A_pre1:
buffer_load_dwordx4 v[56:59], v8, s[40:43], s37 offen offset:1024 nt
s_waitcnt vmcnt(3)
s_cbranch_vccz L_A_pre2
s_waitcnt vmcnt(2)
L_A_pre2:
buffer_load_dwordx4 v[60:63], v8, s[40:43], s37 offen offset:2048 nt
s_waitcnt vmcnt(3)
s_cbranch_vccz L_A_pre3
s_waitcnt vmcnt(2)
L_A_pre3:
buffer_load_dwordx4 v[64:67], v8, s[40:43], s37 offen offset:3072 nt
s_add_u32 s44, s8, s62
s_addc_u32 s45, s9, 0
s_and_b32 s45, s45, 0xffff
s_mov_b32 s46, 0x4200000
s_mov_b32 s47, 0x20000
s_mov_b64 s[70:71], s[40:41]
s_mov_b64 s[72:73], s[44:45]
s_mov_b64 s[44:45], s[40:41]
s_mov_b32 s50, s35
s_mov_b32 s74, 0x00010001
s_mov_b32 s75, 0x00010001
s_mul_i32 s63, s34, 1280
s_add_u32 s63, s63, 8832
v_lshl_add_u32 v165, v3, 4, s63
v_add_u32 v164, 256, v165
v_mov_b32 v166, 0xff7fffff
v_mov_b32 v167, 0xff7fffff
v_and_b32 v132, 1, v0
v_lshlrev_b32 v132, 4, v132
v_mov_b32 v133, 0xffff
v_lshlrev_b32 v132, v132, v133
v_bfe_u32 v133, v0, 1, 2
v_cmp_eq_u32 vcc, 0, v133
s_nop 1
v_cndmask_b32 v4, 0, v132, vcc
v_cmp_eq_u32 vcc, 1, v133
s_nop 1
v_cndmask_b32 v5, 0, v132, vcc
v_cmp_eq_u32 vcc, 2, v133
s_nop 1
v_cndmask_b32 v6, 0, v132, vcc
v_cmp_eq_u32 vcc, 3, v133
s_nop 1
v_cndmask_b32 v7, 0, v132, vcc
s_load_dword s58, s[30:31], 0x14000
s_lshl_b32 s62, s32, 13
s_add_u32 s62, s62, 0x61800
s_mov_b32 s66, 17
s_add_u32 s52, s30, s62
s_addc_u32 s53, s31, 0
v_mov_b32 v140, 0xff7fffff
v_mov_b32 v141, 0
v_mov_b32 v136, 0
v_mov_b32 v137, 0
v_mov_b32 v138, 0
v_mov_b32 v139, 0
v_mov_b32 v144, 0x3e0293ee
s_mov_b32 s56, 0
s_mov_b32 s54, 0
s_lshr_b32 s61, s55, 17
v_lshrrev_b32 v151, 1, v3
v_lshlrev_b32 v151, 9, v151
v_xor_b32 v151, s61, v151
v_lshl_add_u32 v151, v2, 5, v151
v_and_b32 v132, 1, v3
v_lshl_add_u32 v151, v132, 4, v151
s_lshl_b32 s62, s32, 10
s_add_u32 s62, s62, 0x18000
v_add_u32 v151, s62, v151
v_lshlrev_b32 v148, 5, v2
v_lshl_add_u32 v148, v3, 4, v148
s_mul_i32 s62, s34, 1056
v_add_u32 v148, s62, v148
s_lshl_b32 s62, s34, 3
v_mov_b32 v149, s62
v_and_b32 v132, 7, v1
v_lshrrev_b32 v133, 3, v1
v_add_u32 v133, s62, v133
v_lshlrev_b32 v133, 4, v133
v_mul_u32_u24 v150, 1056, v132
v_add_u32 v150, v150, v133
v_xor_b32 v154, s61, v133
s_lshl_b32 s62, s32, 3
s_add_u32 s62, s62, s33
s_lshl_b32 s62, s62, 10
s_add_u32 s62, s62, 0x60000
v_add_u32 v154, s62, v154
s_waitcnt vmcnt(3)
s_add_u32 s35, s35, 48
s_bfe_u32 s63, s35, 0x10009
s_lshl_b32 s63, s63, 26
s_xor_b32 s37, s63, s55
s_bfe_u32 s63, s35, 0x90000
s_lshl_b32 s63, s63, 12
s_or_b32 s37, s37, s63
buffer_load_dwordx4 v[68:71], v8, s[44:47], s37 offen offset:0 nt
s_waitcnt vmcnt(3)
buffer_load_dwordx4 v[72:75], v8, s[44:47], s37 offen offset:1024 nt
s_waitcnt vmcnt(3)
buffer_load_dwordx4 v[76:79], v8, s[44:47], s37 offen offset:2048 nt
s_waitcnt vmcnt(3)
buffer_load_dwordx4 v[80:83], v8, s[44:47], s37 offen offset:3072 nt
s_waitcnt vmcnt(3)
s_add_u32 s35, s35, 48
s_bfe_u32 s63, s35, 0x10009
s_lshl_b32 s63, s63, 26
s_xor_b32 s37, s63, s55
s_bfe_u32 s63, s35, 0x90000
s_lshl_b32 s63, s63, 12
s_or_b32 s37, s37, s63
buffer_load_dwordx4 v[84:87], v8, s[40:43], s37 offen offset:0 nt
s_waitcnt vmcnt(3)
buffer_load_dwordx4 v[88:91], v8, s[40:43], s37 offen offset:1024 nt
s_waitcnt vmcnt(3)
buffer_load_dwordx4 v[92:95], v8, s[40:43], s37 offen offset:2048 nt
s_waitcnt vmcnt(3)
buffer_load_dwordx4 v[96:99], v8, s[40:43], s37 offen offset:3072 nt
s_waitcnt vmcnt(3)
s_add_u32 s35, s35, 48
s_bfe_u32 s63, s35, 0x10009
s_lshl_b32 s63, s63, 26
s_xor_b32 s37, s63, s55
s_bfe_u32 s63, s35, 0x90000
s_lshl_b32 s63, s63, 12
s_or_b32 s37, s37, s63
buffer_load_dwordx4 v[100:103], v8, s[44:47], s37 offen offset:0 nt
s_waitcnt vmcnt(3)
buffer_load_dwordx4 v[104:107], v8, s[44:47], s37 offen offset:1024 nt
s_waitcnt vmcnt(3)
buffer_load_dwordx4 v[108:111], v8, s[44:47], s37 offen offset:2048 nt
s_waitcnt vmcnt(3)
buffer_load_dwordx4 v[112:115], v8, s[44:47], s37 offen offset:3072 nt
global_load_dwordx4 v[120:123], v151, s[30:31] sc1
s_waitcnt vmcnt(4)
s_add_u32 s35, s35, 48
s_bfe_u32 s63, s35, 0x10009
s_lshl_b32 s63, s63, 26
s_xor_b32 s37, s63, s55
s_bfe_u32 s63, s35, 0x90000
s_lshl_b32 s63, s63, 12
s_or_b32 s37, s37, s63
buffer_load_dwordx4 v[20:23], v8, s[40:43], s37 offen offset:0 nt
s_waitcnt vmcnt(4)
buffer_load_dwordx4 v[24:27], v8, s[40:43], s37 offen offset:1024 nt
s_waitcnt vmcnt(4)
buffer_load_dwordx4 v[28:31], v8, s[40:43], s37 offen offset:2048 nt
s_waitcnt vmcnt(4)
buffer_load_dwordx4 v[32:35], v8, s[40:43], s37 offen offset:3072 nt
s_waitcnt lgkmcnt(0)
s_add_u32 s58, s58, 0x9e3779b9
s_bfe_u32 s76, s58, 0x80000
s_bfe_u32 s77, s58, 0x80008
s_bfe_u32 s78, s58, 0x80010
s_bfe_u32 s79, s58, 0x80018
s_mov_b32 s64, 0
s_mov_b32 s60, 0x05040100
s_mov_b32 s61, 0x07060302
s_waitcnt vmcnt(4)
L_A_qchk:
v_perm_b32 v132, v121, v120, s60
v_perm_b32 v133, v123, v122, s60
v_xor_b32 v132, s58, v132
v_xor_b32 v133, s58, v133
v_or_b32 v132, v132, v133
v_cmp_ne_u32 vcc, 0, v132
s_add_u32 s64, s64, 1
s_cmp_eq_u64 vcc, 0
s_cbranch_scc1 L_A_qok
s_cmp_ge_u32 s64, 65536
s_cbranch_scc1 L_A_qok
global_load_dwordx4 v[120:123], v151, s[30:31] sc1
s_waitcnt vmcnt(0)
s_branch L_A_qchk
L_A_qok:
v_perm_b32 v132, v121, v120, s61
v_perm_b32 v133, v123, v122, s61
v_lshlrev_b32 v134, 2, v2
ds_bpermute_b32 v12, v134, v132 offset:0
ds_bpermute_b32 v13, v134, v133 offset:0
ds_bpermute_b32 v14, v134, v132 offset:64
ds_bpermute_b32 v15, v134, v133 offset:64
ds_bpermute_b32 v16, v134, v132 offset:128
ds_bpermute_b32 v17, v134, v133 offset:128
ds_bpermute_b32 v18, v134, v132 offset:192
ds_bpermute_b32 v19, v134, v133 offset:192
s_waitcnt lgkmcnt(0)
v_mov_b32 v160, v12
v_mov_b32 v161, v13
v_mov_b32 v162, v14
v_mov_b32 v163, v15
.p2align 6
L_A_loopa:
s_cmp_lt_u32 s54, 2
s_cbranch_scc1 L_A_back
L_A_backd:
s_add_u32 s49, s35, 48
s_bfe_u32 s63, s49, 0x10009
s_lshl_b32 s63, s63, 26
s_xor_b32 s48, s63, s55
s_bfe_u32 s63, s49, 0x90000
s_lshl_b32 s63, s63, 12
s_or_b32 s48, s48, s63
s_lshr_b32 s62, s35, 9
s_cmp_lg_u32 s62, s56
s_cbranch_scc1 L_A_swa
L_A_swda:
s_waitcnt vmcnt(3)
buffer_load_dwordx4 v[36:39], v8, s[44:47], s48 offen offset:0 nt
v_dot2_f32_bf16 v116, v20, v160, 0
v_dot2_f32_bf16 v116, v21, v161, v116
v_dot2_f32_bf16 v116, v22, v162, v116
v_dot2_f32_bf16 v116, v23, v163, v116
s_nop 2
v_add_f32_dpp v116, v116, v116 row_ror:8 row_mask:0xf bank_mask:0xf
s_nop 1
v_add_f32_dpp v116, v116, v116 row_ror:4 row_mask:0xf bank_mask:0xf
s_nop 1
v_add_f32_dpp v116, v116, v116 row_ror:2 row_mask:0xf bank_mask:0xf
s_nop 1
v_add_f32_dpp v116, v116, v116 row_ror:1 row_mask:0xf bank_mask:0xf
v_mul_f32 v116, v116, v144
s_waitcnt vmcnt(3)
buffer_load_dwordx4 v[40:43], v8, s[44:47], s48 offen offset:1024 nt
v_dot2_f32_bf16 v117, v24, v160, 0
v_dot2_f32_bf16 v117, v25, v161, v117
v_dot2_f32_bf16 v117, v26, v162, v117
v_dot2_f32_bf16 v117, v27, v163, v117
s_nop 2
v_add_f32_dpp v117, v117, v117 row_ror:8 row_mask:0xf bank_mask:0xf
s_nop 1
v_add_f32_dpp v117, v117, v117 row_ror:4 row_mask:0xf bank_mask:0xf
s_nop 1
v_add_f32_dpp v117, v117, v117 row_ror:2 row_mask:0xf bank_mask:0xf
s_nop 1
v_add_f32_dpp v117, v117, v117 row_ror:1 row_mask:0xf bank_mask:0xf
v_mul_f32 v117, v117, v144
s_waitcnt vmcnt(3)
buffer_load_dwordx4 v[44:47], v8, s[44:47], s48 offen offset:2048 nt
v_dot2_f32_bf16 v118, v28, v160, 0
v_dot2_f32_bf16 v118, v29, v161, v118
v_dot2_f32_bf16 v118, v30, v162, v118
v_dot2_f32_bf16 v118, v31, v163, v118
s_nop 2
v_add_f32_dpp v118, v118, v118 row_ror:8 row_mask:0xf bank_mask:0xf
s_nop 1
v_add_f32_dpp v118, v118, v118 row_ror:4 row_mask:0xf bank_mask:0xf
s_nop 1
v_add_f32_dpp v118, v118, v118 row_ror:2 row_mask:0xf bank_mask:0xf
s_nop 1
v_add_f32_dpp v118, v118, v118 row_ror:1 row_mask:0xf bank_mask:0xf
v_mul_f32 v118, v118, v144
s_waitcnt vmcnt(3)
buffer_load_dwordx4 v[48:51], v8, s[44:47], s48 offen offset:3072 nt
v_dot2_f32_bf16 v119, v32, v160, 0
v_dot2_f32_bf16 v119, v33, v161, v119
v_dot2_f32_bf16 v119, v34, v162, v119
v_dot2_f32_bf16 v119, v35, v163, v119
s_nop 2
v_add_f32_dpp v119, v119, v119 row_ror:8 row_mask:0xf bank_mask:0xf
s_nop 1
v_add_f32_dpp v119, v119, v119 row_ror:4 row_mask:0xf bank_mask:0xf
s_nop 1
v_add_f32_dpp v119, v119, v119 row_ror:2 row_mask:0xf bank_mask:0xf
s_nop 1
v_add_f32_dpp v119, v119, v119 row_ror:1 row_mask:0xf bank_mask:0xf
v_mul_f32 v119, v119, v144
s_mov_b64 exec, s[74:75]
ds_write_b128 v164, v[116:119] offset:0
s_mov_b64 exec, -1
v_max3_f32 v167, v167, v116, v117
v_max3_f32 v167, v167, v118, v119
s_lshr_b32 s62, s49, 9
s_cmp_lg_u32 s62, s56
s_cbranch_scc1 L_A_swa2
L_A_swda2:
s_add_u32 s36, s35, 96
s_cmp_eq_u32 s54, 7
s_cselect_b32 s36, s50, s36
s_cselect_b64 s[40:41], s[72:73], s[40:41]
s_bfe_u32 s63, s36, 0x10009
s_lshl_b32 s63, s63, 26
s_xor_b32 s38, s63, s55
s_bfe_u32 s63, s36, 0x90000
s_lshl_b32 s63, s63, 12
s_or_b32 s38, s38, s63
s_waitcnt vmcnt(3)
buffer_load_dwordx4 v[20:23], v8, s[40:43], s38 offen offset:0 nt
v_dot2_f32_bf16 v156, v36, v160, 0
v_dot2_f32_bf16 v156, v37, v161, v156
v_dot2_f32_bf16 v156, v38, v162, v156
v_dot2_f32_bf16 v156, v39, v163, v156
s_nop 2
v_add_f32_dpp v156, v156, v156 row_ror:8 row_mask:0xf bank_mask:0xf
s_nop 1
v_add_f32_dpp v156, v156, v156 row_ror:4 row_mask:0xf bank_mask:0xf
s_nop 1
v_add_f32_dpp v156, v156, v156 row_ror:2 row_mask:0xf bank_mask:0xf
s_nop 1
v_add_f32_dpp v156, v156, v156 row_ror:1 row_mask:0xf bank_mask:0xf
v_mul_f32 v156, v156, v144
s_waitcnt vmcnt(3)
buffer_load_dwordx4 v[24:27], v8, s[40:43], s38 offen offset:1024 nt
v_dot2_f32_bf16 v157, v40, v160, 0
v_dot2_f32_bf16 v157, v41, v161, v157
v_dot2_f32_bf16 v157, v42, v162, v157
v_dot2_f32_bf16 v157, v43, v163, v157
s_nop 2
v_add_f32_dpp v157, v157, v157 row_ror:8 row_mask:0xf bank_mask:0xf
s_nop 1
v_add_f32_dpp v157, v157, v157 row_ror:4 row_mask:0xf bank_mask:0xf
s_nop 1
v_add_f32_dpp v157, v157, v157 row_ror:2 row_mask:0xf bank_mask:0xf
s_nop 1
v_add_f32_dpp v157, v157, v157 row_ror:1 row_mask:0xf bank_mask:0xf
v_mul_f32 v157, v157, v144
s_waitcnt vmcnt(3)
buffer_load_dwordx4 v[28:31], v8, s[40:43], s38 offen offset:2048 nt
v_dot2_f32_bf16 v158, v44, v160, 0
v_dot2_f32_bf16 v158, v45, v161, v158
v_dot2_f32_bf16 v158, v46, v162, v158
v_dot2_f32_bf16 v158, v47, v163, v158
s_nop 2
v_add_f32_dpp v158, v158, v158 row_ror:8 row_mask:0xf bank_mask:0xf
s_nop 1
v_add_f32_dpp v158, v158, v158 row_ror:4 row_mask:0xf bank_mask:0xf
s_nop 1
v_add_f32_dpp v158, v158, v158 row_ror:2 row_mask:0xf bank_mask:0xf
s_nop 1
v_add_f32_dpp v158, v158, v158 row_ror:1 row_mask:0xf bank_mask:0xf
v_mul_f32 v158, v158, v144
s_waitcnt vmcnt(3)
buffer_load_dwordx4 v[32:35], v8, s[40:43], s38 offen offset:3072 nt
v_dot2_f32_bf16 v159, v48, v160, 0
v_dot2_f32_bf16 v159, v49, v161, v159
v_dot2_f32_bf16 v159, v50, v162, v159
v_dot2_f32_bf16 v159, v51, v163, v159
s_nop 2
v_add_f32_dpp v159, v159, v159 row_ror:8 row_mask:0xf bank_mask:0xf
s_nop 1
v_add_f32_dpp v159, v159, v159 row_ror:4 row_mask:0xf bank_mask:0xf
s_nop 1
v_add_f32_dpp v159, v159, v159 row_ror:2 row_mask:0xf bank_mask:0xf
s_nop 1
v_add_f32_dpp v159, v159, v159 row_ror:1 row_mask:0xf bank_mask:0xf
v_mul_f32 v159, v159, v144
s_mov_b64 exec, s[74:75]
ds_write_b128 v164, v[156:159] offset:64
s_mov_b64 exec, -1
v_max3_f32 v167, v167, v156, v157
v_max3_f32 v167, v167, v158, v159
v_add_u32 v164, 128, v164
s_mov_b32 s35, s36
s_mov_b32 s37, s38
s_add_u32 s54, s54, 1
s_cmp_lt_u32 s54, 8
s_cbranch_scc1 L_A_loopa
s_mov_b64 s[44:45], s[72:73]
s_mov_b32 s56, 0
v_mov_b32 v164, v165
ds_read_b128 v[116:119], v165
v_mov_b32 v145, v166
s_nop 1
v_permlane16_swap_b32 v166, v145
s_nop 0
v_max_f32 v166, v166, v145
v_mov_b32 v145, v166
s_nop 1
v_permlane32_swap_b32 v166, v145
s_nop 0
v_max_f32 v166, v166, v145
v_mov_b32 v145, v167
s_nop 1
v_permlane16_swap_b32 v167, v145
s_nop 0
v_max_f32 v167, v167, v145
v_mov_b32 v145, v167
s_nop 1
v_permlane32_swap_b32 v167, v145
s_nop 0
v_max_f32 v167, v167, v145
v_mov_b32 v140, v166
.p2align 6
L_A_loopc:
s_add_u32 s49, s35, 48
s_bfe_u32 s63, s49, 0x10009
s_lshl_b32 s63, s63, 26
s_xor_b32 s48, s63, s55
s_bfe_u32 s63, s49, 0x90000
s_lshl_b32 s63, s63, 12
s_or_b32 s48, s48, s63
s_lshr_b32 s62, s35, 9
s_cmp_lg_u32 s62, s56
s_cbranch_scc1 L_A_swc
L_A_swdc:
s_waitcnt lgkmcnt(0)
s_cmp_lt_u32 s54, s66
s_cbranch_scc1 L_A_nogc
s_mov_b32 s39, 1
s_atomic_add s39, s[52:53], 0 glc
L_A_nogc:
ds_read_b128 v[156:159], v164 offset:64
v_sub_f32 v116, v116, v140
v_sub_f32 v117, v117, v140
v_sub_f32 v118, v118, v140
v_sub_f32 v119, v119, v140
v_exp_f32 v116, v116
v_exp_f32 v117, v117
v_exp_f32 v118, v118
v_exp_f32 v119, v119
v_cvt_pk_bf16_f32 v146, v116, v116
v_add_f32 v141, v141, v116
v_and_b32 v120, v146, v4
v_and_b32 v121, v146, v5
v_and_b32 v122, v146, v6
v_and_b32 v123, v146, v7
s_waitcnt vmcnt(3)
buffer_load_dwordx4 v[36:39], v8, s[44:47], s48 offen offset:0 nt
v_mfma_f32_16x16x32_bf16 v[136:139], v[120:123], v[20:23], v[136:139]
v_cvt_pk_bf16_f32 v147, v117, v117
v_add_f32 v141, v141, v117
v_and_b32 v124, v147, v4
v_and_b32 v125, v147, v5
v_and_b32 v126, v147, v6
v_and_b32 v127, v147, v7
s_waitcnt vmcnt(3)
buffer_load_dwordx4 v[40:43], v8, s[44:47], s48 offen offset:1024 nt
v_mfma_f32_16x16x32_bf16 v[136:139], v[124:127], v[24:27], v[136:139]
v_cvt_pk_bf16_f32 v146, v118, v118
v_add_f32 v141, v141, v118
v_and_b32 v128, v146, v4
v_and_b32 v129, v146, v5
v_and_b32 v130, v146, v6
v_and_b32 v131, v146, v7
s_waitcnt vmcnt(3)
buffer_load_dwordx4 v[44:47], v8, s[44:47], s48 offen offset:2048 nt
v_mfma_f32_16x16x32_bf16 v[136:139], v[128:131], v[28:31], v[136:139]
v_cvt_pk_bf16_f32 v147, v119, v119
v_add_f32 v141, v141, v119
v_and_b32 v132, v147, v4
v_and_b32 v133, v147, v5
v_and_b32 v134, v147, v6
v_and_b32 v135, v147, v7
s_waitcnt vmcnt(3)
buffer_load_dwordx4 v[48:51], v8, s[44:47], s48 offen offset:3072 nt
v_mfma_f32_16x16x32_bf16 v[136:139], v[132:135], v[32:35], v[136:139]
s_lshr_b32 s62, s49, 9
s_cmp_lg_u32 s62, s56
s_cbranch_scc1 L_A_swc2
L_A_swdc2:
s_waitcnt lgkmcnt(0)
ds_read_b128 v[116:119], v164 offset:128
v_sub_f32 v156, v156, v140
v_sub_f32 v157, v157, v140
v_sub_f32 v158, v158, v140
v_sub_f32 v159, v159, v140
v_exp_f32 v156, v156
v_exp_f32 v157, v157
v_exp_f32 v158, v158
v_exp_f32 v159, v159
v_cvt_pk_bf16_f32 v146, v156, v156
v_add_f32 v141, v141, v156
v_and_b32 v120, v146, v4
v_and_b32 v121, v146, v5
v_and_b32 v122, v146, v6
v_and_b32 v123, v146, v7
s_add_u32 s36, s35, 96
s_cmp_eq_u32 s54, 17
s_cselect_b64 s[40:41], s[70:71], s[40:41]
s_cmp_lt_u32 s54, 17
s_cbranch_scc1 L_A_notc
s_waitcnt lgkmcnt(0)
s_add_u32 s39, s39, 1
s_cmp_eq_u32 s39, 0
s_cbranch_scc1 L_A_sigc
s_cmp_eq_u32 s39, 67
s_cbranch_scc1 L_A_sigc
L_A_sigdc:
s_min_u32 s39, s39, 1024
s_add_u32 s36, s39, 960
L_A_notc:
s_bfe_u32 s63, s36, 0x10009
s_lshl_b32 s63, s63, 26
s_xor_b32 s38, s63, s55
s_bfe_u32 s63, s36, 0x90000
s_lshl_b32 s63, s63, 12
s_or_b32 s38, s38, s63
s_cmp_lt_u32 s36, 1024
s_cselect_b32 s42, s42, 0
s_waitcnt vmcnt(3)
buffer_load_dwordx4 v[20:23], v8, s[40:43], s38 offen offset:0 nt
v_mfma_f32_16x16x32_bf16 v[136:139], v[120:123], v[36:39], v[136:139]
v_cvt_pk_bf16_f32 v147, v157, v157
v_add_f32 v141, v141, v157
v_and_b32 v124, v147, v4
v_and_b32 v125, v147, v5
v_and_b32 v126, v147, v6
v_and_b32 v127, v147, v7
s_waitcnt vmcnt(3)
buffer_load_dwordx4 v[24:27], v8, s[40:43], s38 offen offset:1024 nt
v_mfma_f32_16x16x32_bf16 v[136:139], v[124:127], v[40:43], v[136:139]
v_cvt_pk_bf16_f32 v146, v158, v158
v_add_f32 v141, v141, v158
v_and_b32 v128, v146, v4
v_and_b32 v129, v146, v5
v_and_b32 v130, v146, v6
v_and_b32 v131, v146, v7
s_waitcnt vmcnt(3)
buffer_load_dwordx4 v[28:31], v8, s[40:43], s38 offen offset:2048 nt
v_mfma_f32_16x16x32_bf16 v[136:139], v[128:131], v[44:47], v[136:139]
v_cvt_pk_bf16_f32 v147, v159, v159
v_add_f32 v141, v141, v159
v_and_b32 v132, v147, v4
v_and_b32 v133, v147, v5
v_and_b32 v134, v147, v6
v_and_b32 v135, v147, v7
s_waitcnt vmcnt(3)
buffer_load_dwordx4 v[32:35], v8, s[40:43], s38 offen offset:3072 nt
v_mfma_f32_16x16x32_bf16 v[136:139], v[132:135], v[48:51], v[136:139]
v_add_u32 v164, 128, v164
s_mov_b32 s35, s36
s_mov_b32 s37, s38
s_add_u32 s54, s54, 1
s_cmp_ge_u32 s35, 1024
s_cbranch_scc1 L_A_out
s_cmp_lt_u32 s54, 18
s_cbranch_scc1 L_A_loopc
s_waitcnt lgkmcnt(0)
.p2align 6
L_A_loopb:
s_cmp_lt_u32 s54, s66
s_cbranch_scc1 L_A_nogb
s_mov_b32 s39, 1
s_atomic_add s39, s[52:53], 0 glc
L_A_nogb:
s_waitcnt vmcnt(3)
buffer_load_dwordx4 v[36:39], v8, s[44:47], s37 offen offset:0 nt
v_dot2_f32_bf16 v116, v20, v160, 0
v_dot2_f32_bf16 v116, v21, v161, v116
v_dot2_f32_bf16 v116, v22, v162, v116
v_dot2_f32_bf16 v116, v23, v163, v116
s_nop 2
v_add_f32_dpp v116, v116, v116 row_ror:8 row_mask:0xf bank_mask:0xf
s_nop 1
v_add_f32_dpp v116, v116, v116 row_ror:4 row_mask:0xf bank_mask:0xf
s_nop 1
v_add_f32_dpp v116, v116, v116 row_ror:2 row_mask:0xf bank_mask:0xf
s_nop 1
v_add_f32_dpp v116, v116, v116 row_ror:1 row_mask:0xf bank_mask:0xf
v_mul_f32 v116, v116, v144
s_waitcnt vmcnt(3)
buffer_load_dwordx4 v[40:43], v8, s[44:47], s37 offen offset:1024 nt
v_dot2_f32_bf16 v117, v24, v160, 0
v_dot2_f32_bf16 v117, v25, v161, v117
v_dot2_f32_bf16 v117, v26, v162, v117
v_dot2_f32_bf16 v117, v27, v163, v117
s_nop 2
v_add_f32_dpp v117, v117, v117 row_ror:8 row_mask:0xf bank_mask:0xf
s_nop 1
v_add_f32_dpp v117, v117, v117 row_ror:4 row_mask:0xf bank_mask:0xf
s_nop 1
v_add_f32_dpp v117, v117, v117 row_ror:2 row_mask:0xf bank_mask:0xf
s_nop 1
v_add_f32_dpp v117, v117, v117 row_ror:1 row_mask:0xf bank_mask:0xf
v_mul_f32 v117, v117, v144
s_waitcnt vmcnt(3)
buffer_load_dwordx4 v[44:47], v8, s[44:47], s37 offen offset:2048 nt
v_dot2_f32_bf16 v118, v28, v160, 0
v_dot2_f32_bf16 v118, v29, v161, v118
v_dot2_f32_bf16 v118, v30, v162, v118
v_dot2_f32_bf16 v118, v31, v163, v118
s_nop 2
v_add_f32_dpp v118, v118, v118 row_ror:8 row_mask:0xf bank_mask:0xf
s_nop 1
v_add_f32_dpp v118, v118, v118 row_ror:4 row_mask:0xf bank_mask:0xf
s_nop 1
v_add_f32_dpp v118, v118, v118 row_ror:2 row_mask:0xf bank_mask:0xf
s_nop 1
v_add_f32_dpp v118, v118, v118 row_ror:1 row_mask:0xf bank_mask:0xf
v_mul_f32 v118, v118, v144
s_waitcnt vmcnt(3)
buffer_load_dwordx4 v[48:51], v8, s[44:47], s37 offen offset:3072 nt
v_dot2_f32_bf16 v119, v32, v160, 0
v_dot2_f32_bf16 v119, v33, v161, v119
v_dot2_f32_bf16 v119, v34, v162, v119
v_dot2_f32_bf16 v119, v35, v163, v119
s_nop 2
v_add_f32_dpp v119, v119, v119 row_ror:8 row_mask:0xf bank_mask:0xf
s_nop 1
v_add_f32_dpp v119, v119, v119 row_ror:4 row_mask:0xf bank_mask:0xf
s_nop 1
v_add_f32_dpp v119, v119, v119 row_ror:2 row_mask:0xf bank_mask:0xf
s_nop 1
v_add_f32_dpp v119, v119, v119 row_ror:1 row_mask:0xf bank_mask:0xf
v_mul_f32 v119, v119, v144
v_max3_f32 v145, v116, v117, v118
v_max_f32 v145, v145, v119
v_cmp_gt_f32 vcc, v145, v140
s_nop 0
s_cmp_lg_u64 vcc, 0
s_cbranch_scc1 L_A_maxb
L_A_maxdb:
v_sub_f32 v116, v116, v140
v_sub_f32 v117, v117, v140
v_sub_f32 v118, v118, v140
v_sub_f32 v119, v119, v140
v_exp_f32 v116, v116
v_exp_f32 v117, v117
v_exp_f32 v118, v118
v_exp_f32 v119, v119
v_cvt_pk_bf16_f32 v146, v116, v116
v_add_f32 v141, v141, v116
v_and_b32 v120, v146, v4
v_and_b32 v121, v146, v5
v_and_b32 v122, v146, v6
v_and_b32 v123, v146, v7
s_add_u32 s36, s35, 48
s_cmp_lt_u32 s54, 17
s_cbranch_scc1 L_A_notb
s_waitcnt lgkmcnt(0)
s_add_u32 s39, s39, 1
s_cmp_eq_u32 s39, 0
s_cbranch_scc1 L_A_sigb
s_cmp_eq_u32 s39, 67
s_cbranch_scc1 L_A_sigb
L_A_sigdb:
s_min_u32 s39, s39, 1024
s_add_u32 s36, s39, 960
L_A_notb:
s_bfe_u32 s63, s36, 0x10009
s_lshl_b32 s63, s63, 26
s_xor_b32 s38, s63, s55
s_bfe_u32 s63, s36, 0x90000
s_lshl_b32 s63, s63, 12
s_or_b32 s38, s38, s63
s_cmp_lt_u32 s36, 1024
s_cselect_b32 s42, s42, 0
s_waitcnt vmcnt(3)
buffer_load_dwordx4 v[20:23], v8, s[40:43], s38 offen offset:0 nt
v_mfma_f32_16x16x32_bf16 v[136:139], v[120:123], v[36:39], v[136:139]
v_cvt_pk_bf16_f32 v147, v117, v117
v_add_f32 v141, v141, v117
v_and_b32 v124, v147, v4
v_and_b32 v125, v147, v5
v_and_b32 v126, v147, v6
v_and_b32 v127, v147, v7
s_waitcnt vmcnt(3)
buffer_load_dwordx4 v[24:27], v8, s[40:43], s38 offen offset:1024 nt
v_mfma_f32_16x16x32_bf16 v[136:139], v[124:127], v[40:43], v[136:139]
v_cvt_pk_bf16_f32 v146, v118, v118
v_add_f32 v141, v141, v118
v_and_b32 v128, v146, v4
v_and_b32 v129, v146, v5
v_and_b32 v130, v146, v6
v_and_b32 v131, v146, v7
s_waitcnt vmcnt(3)
buffer_load_dwordx4 v[28:31], v8, s[40:43], s38 offen offset:2048 nt
v_mfma_f32_16x16x32_bf16 v[136:139], v[128:131], v[44:47], v[136:139]
v_cvt_pk_bf16_f32 v147, v119, v119
v_add_f32 v141, v141, v119
v_and_b32 v132, v147, v4
v_and_b32 v133, v147, v5
v_and_b32 v134, v147, v6
v_and_b32 v135, v147, v7
s_waitcnt vmcnt(3)
buffer_load_dwordx4 v[32:35], v8, s[40:43], s38 offen offset:3072 nt
v_mfma_f32_16x16x32_bf16 v[136:139], v[132:135], v[48:51], v[136:139]
s_mov_b32 s35, s36
s_mov_b32 s37, s38
s_add_u32 s54, s54, 1
s_cmp_lt_u32 s35, 1024
s_cbranch_scc1 L_A_loopb
L_A_out:
v_add_f32_dpp v141, v141, v141 row_bcast:15 row_mask:0xa bank_mask:0xf
s_nop 1
v_add_f32_dpp v141, v141, v141 row_bcast:31 row_mask:0xc bank_mask:0xf
s_mov_b32 exec_lo, 0
s_brev_b32 exec_hi, 1
ds_write_b64 v149, v[140:141] offset:8512
s_mov_b32 exec_lo, -1
s_mov_b32 exec_hi, 0
ds_write_b128 v148, v[136:139] offset:512
s_mov_b64 exec, -1
s_waitcnt lgkmcnt(0)
s_barrier
L_A_nobar:
ds_read_b128 v[120:123], v150 offset:0
v_and_b32 v132, 7, v1
s_lshr_b32 s62, s34, 2
s_lshl_b32 s62, s62, 6
v_lshl_add_u32 v132, v132, 3, s62
ds_read_b64 v[124:125], v132 offset:8448
s_waitcnt lgkmcnt(0)
v_mov_b32 v126, v124
s_nop 1
v_max_f32_dpp v126, v126, v126 quad_perm:[1,0,3,2] row_mask:0xf bank_mask:0xf
s_nop 1
v_max_f32_dpp v126, v126, v126 quad_perm:[2,3,0,1] row_mask:0xf bank_mask:0xf
s_nop 1
v_max_f32_dpp v126, v126, v126 row_half_mirror row_mask:0xf bank_mask:0xf
v_sub_f32 v124, v124, v126
v_exp_f32 v124, v124
v_mov_b32 v132, s58
v_mul_f32 v127, v125, v124
v_mul_f32 v120, v120, v124
v_mul_f32 v121, v121, v124
v_mul_f32 v122, v122, v124
v_mul_f32 v123, v123, v124
v_add_f32_dpp v127, v127, v127 quad_perm:[1,0,3,2] row_mask:0xf bank_mask:0xf
v_add_f32_dpp v120, v120, v120 quad_perm:[1,0,3,2] row_mask:0xf bank_mask:0xf
v_add_f32_dpp v121, v121, v121 quad_perm:[1,0,3,2] row_mask:0xf bank_mask:0xf
v_add_f32_dpp v122, v122, v122 quad_perm:[1,0,3,2] row_mask:0xf bank_mask:0xf
v_add_f32_dpp v123, v123, v123 quad_perm:[1,0,3,2] row_mask:0xf bank_mask:0xf
v_add_f32_dpp v127, v127, v127 quad_perm:[2,3,0,1] row_mask:0xf bank_mask:0xf
v_add_f32_dpp v120, v120, v120 quad_perm:[2,3,0,1] row_mask:0xf bank_mask:0xf
v_add_f32_dpp v121, v121, v121 quad_perm:[2,3,0,1] row_mask:0xf bank_mask:0xf
v_add_f32_dpp v122, v122, v122 quad_perm:[2,3,0,1] row_mask:0xf bank_mask:0xf
v_add_f32_dpp v123, v123, v123 quad_perm:[2,3,0,1] row_mask:0xf bank_mask:0xf
v_add_f32_dpp v127, v127, v127 row_half_mirror row_mask:0xf bank_mask:0xf
v_add_f32_dpp v120, v120, v120 row_half_mirror row_mask:0xf bank_mask:0xf
v_add_f32_dpp v121, v121, v121 row_half_mirror row_mask:0xf bank_mask:0xf
v_add_f32_dpp v122, v122, v122 row_half_mirror row_mask:0xf bank_mask:0xf
v_add_f32_dpp v123, v123, v123 row_half_mirror row_mask:0xf bank_mask:0xf
v_max_f32 v127, 0x00800000, v127
v_log_f32 v124, v127
v_rcp_f32 v127, v127
s_mov_b32 s62, 0x05010400
s_mov_b32 s63, 0x07030602
v_add_f32 v126, v126, v124
v_mul_f32 v120, v120, v127
v_mul_f32 v121, v121, v127
v_mul_f32 v122, v122, v127
v_mul_f32 v123, v123, v127
v_perm_b32 v124, v126, v132, s62
v_perm_b32 v125, v126, v132, s63
v_cvt_pk_bf16_f32 v120, v120, v121
v_cvt_pk_bf16_f32 v121, v122, v123
s_mov_b32 exec_lo, 0x01010101
s_mov_b32 exec_hi, 0x01010101
v_perm_b32 v128, v120, v124, s60
v_perm_b32 v129, v120, v124, s61
v_perm_b32 v130, v121, v125, s60
v_perm_b32 v131, v121, v125, s61
global_store_dwordx4 v154, v[128:131], s[30:31] sc1
s_endpgm
L_A_back:
s_cmp_lg_u32 s54, 0
s_cbranch_scc1 L_A_bk1
v_dot2_f32_bf16 v116, v52, v12, 0
v_dot2_f32_bf16 v116, v53, v13, v116
v_dot2_f32_bf16 v116, v54, v14, v116
v_dot2_f32_bf16 v116, v55, v15, v116
v_dot2_f32_bf16 v117, v56, v12, 0
v_dot2_f32_bf16 v117, v57, v13, v117
v_dot2_f32_bf16 v117, v58, v14, v117
v_dot2_f32_bf16 v117, v59, v15, v117
v_dot2_f32_bf16 v118, v60, v12, 0
v_dot2_f32_bf16 v118, v61, v13, v118
v_dot2_f32_bf16 v118, v62, v14, v118
v_dot2_f32_bf16 v118, v63, v15, v118
v_dot2_f32_bf16 v119, v64, v12, 0
v_dot2_f32_bf16 v119, v65, v13, v119
v_dot2_f32_bf16 v119, v66, v14, v119
v_dot2_f32_bf16 v119, v67, v15, v119
s_nop 1
v_add_f32_dpp v116, v116, v116 row_ror:8 row_mask:0xf bank_mask:0xf
v_add_f32_dpp v117, v117, v117 row_ror:8 row_mask:0xf bank_mask:0xf
v_add_f32_dpp v118, v118, v118 row_ror:8 row_mask:0xf bank_mask:0xf
v_add_f32_dpp v119, v119, v119 row_ror:8 row_mask:0xf bank_mask:0xf
v_add_f32_dpp v116, v116, v116 row_ror:4 row_mask:0xf bank_mask:0xf
v_add_f32_dpp v117, v117, v117 row_ror:4 row_mask:0xf bank_mask:0xf
v_add_f32_dpp v118, v118, v118 row_ror:4 row_mask:0xf bank_mask:0xf
v_add_f32_dpp v119, v119, v119 row_ror:4 row_mask:0xf bank_mask:0xf
v_add_f32_dpp v116, v116, v116 row_ror:2 row_mask:0xf bank_mask:0xf
v_add_f32_dpp v117, v117, v117 row_ror:2 row_mask:0xf bank_mask:0xf
v_add_f32_dpp v118, v118, v118 row_ror:2 row_mask:0xf bank_mask:0xf
v_add_f32_dpp v119, v119, v119 row_ror:2 row_mask:0xf bank_mask:0xf
v_add_f32_dpp v116, v116, v116 row_ror:1 row_mask:0xf bank_mask:0xf
v_add_f32_dpp v117, v117, v117 row_ror:1 row_mask:0xf bank_mask:0xf
v_add_f32_dpp v118, v118, v118 row_ror:1 row_mask:0xf bank_mask:0xf
v_add_f32_dpp v119, v119, v119 row_ror:1 row_mask:0xf bank_mask:0xf
v_mul_f32 v116, v116, v144
v_mul_f32 v117, v117, v144
v_mul_f32 v118, v118, v144
v_mul_f32 v119, v119, v144
s_mov_b64 exec, s[74:75]
ds_write_b128 v165, v[116:119] offset:0
s_mov_b64 exec, -1
v_max3_f32 v166, v166, v116, v117
v_max3_f32 v166, v166, v118, v119
v_dot2_f32_bf16 v156, v68, v12, 0
v_dot2_f32_bf16 v156, v69, v13, v156
v_dot2_f32_bf16 v156, v70, v14, v156
v_dot2_f32_bf16 v156, v71, v15, v156
v_dot2_f32_bf16 v157, v72, v12, 0
v_dot2_f32_bf16 v157, v73, v13, v157
v_dot2_f32_bf16 v157, v74, v14, v157
v_dot2_f32_bf16 v157, v75, v15, v157
v_dot2_f32_bf16 v158, v76, v12, 0
v_dot2_f32_bf16 v158, v77, v13, v158
v_dot2_f32_bf16 v158, v78, v14, v158
v_dot2_f32_bf16 v158, v79, v15, v158
v_dot2_f32_bf16 v159, v80, v12, 0
v_dot2_f32_bf16 v159, v81, v13, v159
v_dot2_f32_bf16 v159, v82, v14, v159
v_dot2_f32_bf16 v159, v83, v15, v159
s_nop 1
v_add_f32_dpp v156, v156, v156 row_ror:8 row_mask:0xf bank_mask:0xf
v_add_f32_dpp v157, v157, v157 row_ror:8 row_mask:0xf bank_mask:0xf
v_add_f32_dpp v158, v158, v158 row_ror:8 row_mask:0xf bank_mask:0xf
v_add_f32_dpp v159, v159, v159 row_ror:8 row_mask:0xf bank_mask:0xf
v_add_f32_dpp v156, v156, v156 row_ror:4 row_mask:0xf bank_mask:0xf
v_add_f32_dpp v157, v157, v157 row_ror:4 row_mask:0xf bank_mask:0xf
v_add_f32_dpp v158, v158, v158 row_ror:4 row_mask:0xf bank_mask:0xf
v_add_f32_dpp v159, v159, v159 row_ror:4 row_mask:0xf bank_mask:0xf
v_add_f32_dpp v156, v156, v156 row_ror:2 row_mask:0xf bank_mask:0xf
v_add_f32_dpp v157, v157, v157 row_ror:2 row_mask:0xf bank_mask:0xf
v_add_f32_dpp v158, v158, v158 row_ror:2 row_mask:0xf bank_mask:0xf
v_add_f32_dpp v159, v159, v159 row_ror:2 row_mask:0xf bank_mask:0xf
v_add_f32_dpp v156, v156, v156 row_ror:1 row_mask:0xf bank_mask:0xf
v_add_f32_dpp v157, v157, v157 row_ror:1 row_mask:0xf bank_mask:0xf
v_add_f32_dpp v158, v158, v158 row_ror:1 row_mask:0xf bank_mask:0xf
v_add_f32_dpp v159, v159, v159 row_ror:1 row_mask:0xf bank_mask:0xf
v_mul_f32 v156, v156, v144
v_mul_f32 v157, v157, v144
v_mul_f32 v158, v158, v144
v_mul_f32 v159, v159, v144
s_mov_b64 exec, s[74:75]
ds_write_b128 v165, v[156:159] offset:64
s_mov_b64 exec, -1
v_max3_f32 v166, v166, v156, v157
v_max3_f32 v166, v166, v158, v159
s_branch L_A_backd
L_A_bk1:
v_dot2_f32_bf16 v116, v84, v12, 0
v_dot2_f32_bf16 v116, v85, v13, v116
v_dot2_f32_bf16 v116, v86, v14, v116
v_dot2_f32_bf16 v116, v87, v15, v116
v_dot2_f32_bf16 v117, v88, v12, 0
v_dot2_f32_bf16 v117, v89, v13, v117
v_dot2_f32_bf16 v117, v90, v14, v117
v_dot2_f32_bf16 v117, v91, v15, v117
v_dot2_f32_bf16 v118, v92, v12, 0
v_dot2_f32_bf16 v118, v93, v13, v118
v_dot2_f32_bf16 v118, v94, v14, v118
v_dot2_f32_bf16 v118, v95, v15, v118
v_dot2_f32_bf16 v119, v96, v12, 0
v_dot2_f32_bf16 v119, v97, v13, v119
v_dot2_f32_bf16 v119, v98, v14, v119
v_dot2_f32_bf16 v119, v99, v15, v119
s_nop 1
v_add_f32_dpp v116, v116, v116 row_ror:8 row_mask:0xf bank_mask:0xf
v_add_f32_dpp v117, v117, v117 row_ror:8 row_mask:0xf bank_mask:0xf
v_add_f32_dpp v118, v118, v118 row_ror:8 row_mask:0xf bank_mask:0xf
v_add_f32_dpp v119, v119, v119 row_ror:8 row_mask:0xf bank_mask:0xf
v_add_f32_dpp v116, v116, v116 row_ror:4 row_mask:0xf bank_mask:0xf
v_add_f32_dpp v117, v117, v117 row_ror:4 row_mask:0xf bank_mask:0xf
v_add_f32_dpp v118, v118, v118 row_ror:4 row_mask:0xf bank_mask:0xf
v_add_f32_dpp v119, v119, v119 row_ror:4 row_mask:0xf bank_mask:0xf
v_add_f32_dpp v116, v116, v116 row_ror:2 row_mask:0xf bank_mask:0xf
v_add_f32_dpp v117, v117, v117 row_ror:2 row_mask:0xf bank_mask:0xf
v_add_f32_dpp v118, v118, v118 row_ror:2 row_mask:0xf bank_mask:0xf
v_add_f32_dpp v119, v119, v119 row_ror:2 row_mask:0xf bank_mask:0xf
v_add_f32_dpp v116, v116, v116 row_ror:1 row_mask:0xf bank_mask:0xf
v_add_f32_dpp v117, v117, v117 row_ror:1 row_mask:0xf bank_mask:0xf
v_add_f32_dpp v118, v118, v118 row_ror:1 row_mask:0xf bank_mask:0xf
v_add_f32_dpp v119, v119, v119 row_ror:1 row_mask:0xf bank_mask:0xf
v_mul_f32 v116, v116, v144
v_mul_f32 v117, v117, v144
v_mul_f32 v118, v118, v144
v_mul_f32 v119, v119, v144
s_mov_b64 exec, s[74:75]
ds_write_b128 v165, v[116:119] offset:128
s_mov_b64 exec, -1
v_max3_f32 v166, v166, v116, v117
v_max3_f32 v166, v166, v118, v119
v_dot2_f32_bf16 v156, v100, v12, 0
v_dot2_f32_bf16 v156, v101, v13, v156
v_dot2_f32_bf16 v156, v102, v14, v156
v_dot2_f32_bf16 v156, v103, v15, v156
v_dot2_f32_bf16 v157, v104, v12, 0
v_dot2_f32_bf16 v157, v105, v13, v157
v_dot2_f32_bf16 v157, v106, v14, v157
v_dot2_f32_bf16 v157, v107, v15, v157
v_dot2_f32_bf16 v158, v108, v12, 0
v_dot2_f32_bf16 v158, v109, v13, v158
v_dot2_f32_bf16 v158, v110, v14, v158
v_dot2_f32_bf16 v158, v111, v15, v158
v_dot2_f32_bf16 v159, v112, v12, 0
v_dot2_f32_bf16 v159, v113, v13, v159
v_dot2_f32_bf16 v159, v114, v14, v159
v_dot2_f32_bf16 v159, v115, v15, v159
s_nop 1
v_add_f32_dpp v156, v156, v156 row_ror:8 row_mask:0xf bank_mask:0xf
v_add_f32_dpp v157, v157, v157 row_ror:8 row_mask:0xf bank_mask:0xf
v_add_f32_dpp v158, v158, v158 row_ror:8 row_mask:0xf bank_mask:0xf
v_add_f32_dpp v159, v159, v159 row_ror:8 row_mask:0xf bank_mask:0xf
v_add_f32_dpp v156, v156, v156 row_ror:4 row_mask:0xf bank_mask:0xf
v_add_f32_dpp v157, v157, v157 row_ror:4 row_mask:0xf bank_mask:0xf
v_add_f32_dpp v158, v158, v158 row_ror:4 row_mask:0xf bank_mask:0xf
v_add_f32_dpp v159, v159, v159 row_ror:4 row_mask:0xf bank_mask:0xf
v_add_f32_dpp v156, v156, v156 row_ror:2 row_mask:0xf bank_mask:0xf
v_add_f32_dpp v157, v157, v157 row_ror:2 row_mask:0xf bank_mask:0xf
v_add_f32_dpp v158, v158, v158 row_ror:2 row_mask:0xf bank_mask:0xf
v_add_f32_dpp v159, v159, v159 row_ror:2 row_mask:0xf bank_mask:0xf
v_add_f32_dpp v156, v156, v156 row_ror:1 row_mask:0xf bank_mask:0xf
v_add_f32_dpp v157, v157, v157 row_ror:1 row_mask:0xf bank_mask:0xf
v_add_f32_dpp v158, v158, v158 row_ror:1 row_mask:0xf bank_mask:0xf
v_add_f32_dpp v159, v159, v159 row_ror:1 row_mask:0xf bank_mask:0xf
v_mul_f32 v156, v156, v144
v_mul_f32 v157, v157, v144
v_mul_f32 v158, v158, v144
v_mul_f32 v159, v159, v144
s_mov_b64 exec, s[74:75]
ds_write_b128 v165, v[156:159] offset:192
s_mov_b64 exec, -1
v_max3_f32 v166, v166, v156, v157
v_max3_f32 v166, v166, v158, v159
s_branch L_A_backd
L_A_swa:
s_mov_b32 s56, 1
v_max_f32 v166, v166, v167
v_mov_b32 v167, 0xff7fffff
v_mov_b32 v160, v16
v_mov_b32 v161, v17
v_mov_b32 v162, v18
v_mov_b32 v163, v19
s_branch L_A_swda
L_A_swa2:
s_mov_b32 s56, 1
v_max_f32 v166, v166, v167
v_mov_b32 v167, 0xff7fffff
v_mov_b32 v160, v16
v_mov_b32 v161, v17
v_mov_b32 v162, v18
v_mov_b32 v163, v19
s_branch L_A_swda2
L_A_swc:
s_mov_b32 s56, 1
s_nop 3
v_add_f32_dpp v141, v141, v141 row_bcast:15 row_mask:0xa bank_mask:0xf
s_nop 1
v_add_f32_dpp v141, v141, v141 row_bcast:31 row_mask:0xc bank_mask:0xf
s_mov_b32 exec_lo, 0
s_brev_b32 exec_hi, 1
ds_write_b64 v149, v[140:141] offset:8448
s_mov_b32 exec_lo, -1
s_mov_b32 exec_hi, 0
ds_write_b128 v148, v[136:139] offset:0
s_mov_b64 exec, -1
s_waitcnt lgkmcnt(0)
v_mov_b32 v140, v167
v_mov_b32 v141, 0
v_mov_b32 v136, 0
v_mov_b32 v137, 0
v_mov_b32 v138, 0
v_mov_b32 v139, 0
s_branch L_A_swdc
L_A_swc2:
s_mov_b32 s56, 1
s_nop 3
v_add_f32_dpp v141, v141, v141 row_bcast:15 row_mask:0xa bank_mask:0xf
s_nop 1
v_add_f32_dpp v141, v141, v141 row_bcast:31 row_mask:0xc bank_mask:0xf
s_mov_b32 exec_lo, 0
s_brev_b32 exec_hi, 1
ds_write_b64 v149, v[140:141] offset:8448
s_mov_b32 exec_lo, -1
s_mov_b32 exec_hi, 0
ds_write_b128 v148, v[136:139] offset:0
s_mov_b64 exec, -1
s_waitcnt lgkmcnt(0)
v_mov_b32 v140, v167
v_mov_b32 v141, 0
v_mov_b32 v136, 0
v_mov_b32 v137, 0
v_mov_b32 v138, 0
v_mov_b32 v139, 0
s_branch L_A_swdc2
L_A_sigc:
s_mov_b32 s65, 1
s_atomic_add s65, s[52:53], 0x400 glc
s_branch L_A_sigdc
L_A_maxb:
v_max_f32_dpp v145, v145, v145 row_bcast:15 row_mask:0xa bank_mask:0xf
s_nop 1
v_max_f32_dpp v145, v145, v145 row_bcast:31 row_mask:0xc bank_mask:0xf
s_nop 0
v_readlane_b32 s62, v145, 63
s_nop 1
v_max_f32 v143, s62, v140
v_sub_f32 v142, v140, v143
v_exp_f32 v142, v142
v_mov_b32 v140, v143
v_mul_f32 v136, v136, v142
v_mul_f32 v137, v137, v142
v_mul_f32 v138, v138, v142
v_mul_f32 v139, v139, v142
v_mul_f32 v141, v141, v142
s_branch L_A_maxdb
L_A_sigb:
s_mov_b32 s65, 1
s_atomic_add s65, s[52:53], 0x400 glc
s_branch L_A_sigdb
L_roleW:
v_and_b32 v1, 63, v0
s_mov_b32 s32, s82
s_waitcnt lgkmcnt(0)
s_lshl_b32 s60, s32, 8
s_sub_u32 s61, 0x400000, s60
s_add_u32 s40, s18, s60
s_addc_u32 s41, s19, 0
s_and_b32 s41, s41, 0xffff
s_mov_b32 s42, s61
s_mov_b32 s43, 0x20000
s_add_u32 s44, s20, s60
s_addc_u32 s45, s21, 0
s_and_b32 s45, s45, 0xffff
s_mov_b32 s46, s61
s_mov_b32 s47, 0x20000
s_mov_b32 s48, s14
s_and_b32 s49, s15, 0xffff
s_mov_b32 s50, 0x800
s_mov_b32 s51, 0x20000
v_lshrrev_b32 v192, 3, v2
v_lshlrev_b32 v192, 10, v192
v_lshl_add_u32 v192, v3, 5, v192
s_lshl_b32 s62, s34, 7
v_add_u32 v192, s62, v192
s_mov_b32 s80, 0
buffer_load_dwordx4 v[12:15], v192, s[48:51], 0 offen
buffer_load_dwordx4 v[16:19], v192, s[48:51], 0 offen offset:16
v_lshlrev_b32 v9, 17, v3
v_lshl_add_u32 v9, v2, 4, v9
s_lshl_b32 s62, s34, 19
v_add_u32 v9, s62, v9
s_xor_b32 s62, s80, 0
buffer_load_dwordx4 v[64:67], v9, s[40:43], s62 offen nt
s_xor_b32 s62, s80, 8192
buffer_load_dwordx4 v[68:71], v9, s[40:43], s62 offen nt
s_xor_b32 s62, s80, 16384
buffer_load_dwordx4 v[72:75], v9, s[40:43], s62 offen nt
s_xor_b32 s62, s80, 24576
buffer_load_dwordx4 v[76:79], v9, s[40:43], s62 offen nt
s_xor_b32 s62, s80, 32768
buffer_load_dwordx4 v[80:83], v9, s[40:43], s62 offen nt
s_xor_b32 s62, s80, 40960
buffer_load_dwordx4 v[84:87], v9, s[40:43], s62 offen nt
s_xor_b32 s62, s80, 49152
buffer_load_dwordx4 v[88:91], v9, s[40:43], s62 offen nt
s_xor_b32 s62, s80, 57344
buffer_load_dwordx4 v[92:95], v9, s[40:43], s62 offen nt
s_xor_b32 s62, s80, 65536
buffer_load_dwordx4 v[96:99], v9, s[40:43], s62 offen nt
s_xor_b32 s62, s80, 73728
buffer_load_dwordx4 v[100:103], v9, s[40:43], s62 offen nt
s_xor_b32 s62, s80, 81920
buffer_load_dwordx4 v[104:107], v9, s[40:43], s62 offen nt
s_xor_b32 s62, s80, 90112
buffer_load_dwordx4 v[108:111], v9, s[40:43], s62 offen nt
s_xor_b32 s62, s80, 98304
buffer_load_dwordx4 v[112:115], v9, s[40:43], s62 offen nt
s_xor_b32 s62, s80, 106496
buffer_load_dwordx4 v[116:119], v9, s[40:43], s62 offen nt
s_xor_b32 s62, s80, 114688
buffer_load_dwordx4 v[120:123], v9, s[40:43], s62 offen nt
s_xor_b32 s62, s80, 122880
buffer_load_dwordx4 v[124:127], v9, s[40:43], s62 offen nt
v_mov_b32 v8, 0
s_mov_b32 s52, s30
s_and_b32 s53, s31, 0xffff
s_mov_b32 s54, 0x1000000
s_mov_b32 s55, 0x20000
s_load_dword s58, s[30:31], 0x14000
v_and_b32 v192, 1, v0
v_lshlrev_b32 v192, 4, v192
v_mov_b32 v193, 0xffff
v_lshlrev_b32 v192, v192, v193
v_bfe_u32 v193, v0, 1, 2
v_cmp_eq_u32 vcc, 0, v193
s_nop 1
v_cndmask_b32 v4, 0, v192, vcc
v_cmp_eq_u32 vcc, 1, v193
s_nop 1
v_cndmask_b32 v5, 0, v192, vcc
v_cmp_eq_u32 vcc, 2, v193
s_nop 1
v_cndmask_b32 v6, 0, v192, vcc
v_cmp_eq_u32 vcc, 3, v193
s_nop 1
v_cndmask_b32 v7, 0, v192, vcc
s_barrier
s_waitcnt vmcnt(16)
s_mov_b32 s60, 0x01000100
v_perm_b32 v192, v12, v12, s60
v_and_b32 v28, v192, v4
v_and_b32 v29, v192, v5
v_and_b32 v30, v192, v6
v_and_b32 v31, v192, v7
s_waitcnt vmcnt(15)
s_nop 0
v_mfma_f32_16x16x32_bf16 v[44:47], v[28:31], v[64:67], 0
s_xor_b32 s62, s80, 0
buffer_load_dwordx4 v[128:131], v9, s[44:47], s62 offen nt
s_mov_b32 s60, 0x03020302
v_perm_b32 v193, v12, v12, s60
v_and_b32 v32, v193, v4
v_and_b32 v33, v193, v5
v_and_b32 v34, v193, v6
v_and_b32 v35, v193, v7
s_waitcnt vmcnt(15)
s_nop 0
v_mfma_f32_16x16x32_bf16 v[44:47], v[32:35], v[68:71], v[44:47]
s_xor_b32 s62, s80, 8192
buffer_load_dwordx4 v[132:135], v9, s[44:47], s62 offen nt
s_mov_b32 s60, 0x01000100
v_perm_b32 v192, v13, v13, s60
v_and_b32 v28, v192, v4
v_and_b32 v29, v192, v5
v_and_b32 v30, v192, v6
v_and_b32 v31, v192, v7
s_waitcnt vmcnt(15)
s_nop 0
v_mfma_f32_16x16x32_bf16 v[44:47], v[28:31], v[72:75], v[44:47]
s_xor_b32 s62, s80, 16384
buffer_load_dwordx4 v[136:139], v9, s[44:47], s62 offen nt
s_mov_b32 s60, 0x03020302
v_perm_b32 v193, v13, v13, s60
v_and_b32 v32, v193, v4
v_and_b32 v33, v193, v5
v_and_b32 v34, v193, v6
v_and_b32 v35, v193, v7
s_waitcnt vmcnt(15)
s_nop 0
v_mfma_f32_16x16x32_bf16 v[44:47], v[32:35], v[76:79], v[44:47]
s_xor_b32 s62, s80, 24576
buffer_load_dwordx4 v[140:143], v9, s[44:47], s62 offen nt
s_mov_b32 s60, 0x01000100
v_perm_b32 v192, v14, v14, s60
v_and_b32 v28, v192, v4
v_and_b32 v29, v192, v5
v_and_b32 v30, v192, v6
v_and_b32 v31, v192, v7
s_waitcnt vmcnt(15)
s_nop 0
v_mfma_f32_16x16x32_bf16 v[44:47], v[28:31], v[80:83], v[44:47]
s_xor_b32 s62, s80, 32768
buffer_load_dwordx4 v[144:147], v9, s[44:47], s62 offen nt
s_mov_b32 s60, 0x03020302
v_perm_b32 v193, v14, v14, s60
v_and_b32 v32, v193, v4
v_and_b32 v33, v193, v5
v_and_b32 v34, v193, v6
v_and_b32 v35, v193, v7
s_waitcnt vmcnt(15)
s_nop 0
v_mfma_f32_16x16x32_bf16 v[44:47], v[32:35], v[84:87], v[44:47]
s_xor_b32 s62, s80, 40960
buffer_load_dwordx4 v[148:151], v9, s[44:47], s62 offen nt
s_mov_b32 s60, 0x01000100
v_perm_b32 v192, v15, v15, s60
v_and_b32 v28, v192, v4
v_and_b32 v29, v192, v5
v_and_b32 v30, v192, v6
v_and_b32 v31, v192, v7
s_waitcnt vmcnt(15)
s_nop 0
v_mfma_f32_16x16x32_bf16 v[44:47], v[28:31], v[88:91], v[44:47]
s_xor_b32 s62, s80, 49152
buffer_load_dwordx4 v[152:155], v9, s[44:47], s62 offen nt
s_mov_b32 s60, 0x03020302
v_perm_b32 v193, v15, v15, s60
v_and_b32 v32, v193, v4
v_and_b32 v33, v193, v5
v_and_b32 v34, v193, v6
v_and_b32 v35, v193, v7
s_waitcnt vmcnt(15)
s_nop 0
v_mfma_f32_16x16x32_bf16 v[44:47], v[32:35], v[92:95], v[44:47]
s_xor_b32 s62, s80, 57344
buffer_load_dwordx4 v[156:159], v9, s[44:47], s62 offen nt
s_mov_b32 s60, 0x01000100
v_perm_b32 v192, v16, v16, s60
v_and_b32 v28, v192, v4
v_and_b32 v29, v192, v5
v_and_b32 v30, v192, v6
v_and_b32 v31, v192, v7
s_waitcnt vmcnt(15)
s_nop 0
v_mfma_f32_16x16x32_bf16 v[44:47], v[28:31], v[96:99], v[44:47]
s_xor_b32 s62, s80, 65536
buffer_load_dwordx4 v[160:163], v9, s[44:47], s62 offen nt
s_mov_b32 s60, 0x03020302
v_perm_b32 v193, v16, v16, s60
v_and_b32 v32, v193, v4
v_and_b32 v33, v193, v5
v_and_b32 v34, v193, v6
v_and_b32 v35, v193, v7
s_waitcnt vmcnt(15)
s_nop 0
v_mfma_f32_16x16x32_bf16 v[44:47], v[32:35], v[100:103], v[44:47]
s_xor_b32 s62, s80, 73728
buffer_load_dwordx4 v[164:167], v9, s[44:47], s62 offen nt
s_mov_b32 s60, 0x01000100
v_perm_b32 v192, v17, v17, s60
v_and_b32 v28, v192, v4
v_and_b32 v29, v192, v5
v_and_b32 v30, v192, v6
v_and_b32 v31, v192, v7
s_waitcnt vmcnt(15)
s_nop 0
v_mfma_f32_16x16x32_bf16 v[44:47], v[28:31], v[104:107], v[44:47]
s_xor_b32 s62, s80, 81920
buffer_load_dwordx4 v[168:171], v9, s[44:47], s62 offen nt
s_mov_b32 s60, 0x03020302
v_perm_b32 v193, v17, v17, s60
v_and_b32 v32, v193, v4
v_and_b32 v33, v193, v5
v_and_b32 v34, v193, v6
v_and_b32 v35, v193, v7
s_waitcnt vmcnt(15)
s_nop 0
v_mfma_f32_16x16x32_bf16 v[44:47], v[32:35], v[108:111], v[44:47]
s_xor_b32 s62, s80, 90112
buffer_load_dwordx4 v[172:175], v9, s[44:47], s62 offen nt
s_mov_b32 s60, 0x01000100
v_perm_b32 v192, v18, v18, s60
v_and_b32 v28, v192, v4
v_and_b32 v29, v192, v5
v_and_b32 v30, v192, v6
v_and_b32 v31, v192, v7
s_waitcnt vmcnt(15)
s_nop 0
v_mfma_f32_16x16x32_bf16 v[44:47], v[28:31], v[112:115], v[44:47]
s_xor_b32 s62, s80, 98304
buffer_load_dwordx4 v[176:179], v9, s[44:47], s62 offen nt
s_mov_b32 s60, 0x03020302
v_perm_b32 v193, v18, v18, s60
v_and_b32 v32, v193, v4
v_and_b32 v33, v193, v5
v_and_b32 v34, v193, v6
v_and_b32 v35, v193, v7
s_waitcnt vmcnt(15)
s_nop 0
v_mfma_f32_16x16x32_bf16 v[44:47], v[32:35], v[116:119], v[44:47]
s_xor_b32 s62, s80, 106496
buffer_load_dwordx4 v[180:183], v9, s[44:47], s62 offen nt
s_mov_b32 s60, 0x01000100
v_perm_b32 v192, v19, v19, s60
v_and_b32 v28, v192, v4
v_and_b32 v29, v192, v5
v_and_b32 v30, v192, v6
v_and_b32 v31, v192, v7
s_waitcnt vmcnt(15)
s_nop 0
v_mfma_f32_16x16x32_bf16 v[44:47], v[28:31], v[120:123], v[44:47]
s_xor_b32 s62, s80, 114688
buffer_load_dwordx4 v[184:187], v9, s[44:47], s62 offen nt
s_mov_b32 s60, 0x03020302
v_perm_b32 v193, v19, v19, s60
v_and_b32 v32, v193, v4
v_and_b32 v33, v193, v5
v_and_b32 v34, v193, v6
v_and_b32 v35, v193, v7
s_waitcnt vmcnt(15)
s_nop 0
v_mfma_f32_16x16x32_bf16 v[44:47], v[32:35], v[124:127], v[44:47]
s_xor_b32 s62, s80, 122880
buffer_load_dwordx4 v[188:191], v9, s[44:47], s62 offen nt
v_lshrrev_b32 v192, 1, v3
v_lshlrev_b32 v192, 9, v192
v_lshl_add_u32 v192, v2, 5, v192
v_and_b32 v193, 1, v3
v_lshl_add_u32 v192, v193, 4, v192
s_lshl_b32 s63, s34, 10
v_add_u32 v192, s63, v192
s_nop 1
s_nop 5
ds_write_b128 v192, v[44:47] offset:0
s_waitcnt lgkmcnt(0)
s_barrier
s_cmp_ge_u32 s34, 4
s_cbranch_scc1 L_W_qskip
v_lshlrev_b32 v194, 2, v0
ds_read_b32 v196, v194 offset:0
ds_read_b32 v197, v194 offset:1024
ds_read_b32 v198, v194 offset:2048
ds_read_b32 v199, v194 offset:3072
ds_read_b32 v200, v194 offset:4096
ds_read_b32 v201, v194 offset:5120
ds_read_b32 v202, v194 offset:6144
ds_read_b32 v203, v194 offset:7168
s_waitcnt lgkmcnt(0)
v_add_f32 v196, v196, v197
v_add_f32 v196, v196, v198
v_add_f32 v196, v196, v199
v_add_f32 v196, v196, v200
v_add_f32 v196, v196, v201
v_add_f32 v196, v196, v202
v_add_f32 v196, v196, v203
v_cvt_pk_bf16_f32 v196, v196, v196
v_lshlrev_b32 v194, 1, v0
ds_write_b16 v194, v196 offset:8192
s_waitcnt lgkmcnt(0)
L_W_qskip:
s_barrier
v_lshlrev_b32 v194, 4, v2
ds_read_b128 v[20:23], v194 offset:8192
ds_read_b128 v[24:27], v194 offset:8448
s_xor_b32 s60, s32, 7
s_lshl_b32 s60, s60, 8
s_sub_u32 s61, 0x400000, s60
s_add_u32 s40, s22, s60
s_addc_u32 s41, s23, 0
s_and_b32 s41, s41, 0xffff
s_mov_b32 s42, s61
s_mov_b32 s43, 0x20000
s_xor_b32 s62, s80, 0
buffer_load_dwordx4 v[64:67], v9, s[40:43], s62 offen nt
s_xor_b32 s62, s80, 8192
buffer_load_dwordx4 v[68:71], v9, s[40:43], s62 offen nt
s_xor_b32 s62, s80, 16384
buffer_load_dwordx4 v[72:75], v9, s[40:43], s62 offen nt
s_xor_b32 s62, s80, 24576
buffer_load_dwordx4 v[76:79], v9, s[40:43], s62 offen nt
s_xor_b32 s62, s80, 32768
buffer_load_dwordx4 v[80:83], v9, s[40:43], s62 offen nt
s_xor_b32 s62, s80, 40960
buffer_load_dwordx4 v[84:87], v9, s[40:43], s62 offen nt
s_xor_b32 s62, s80, 49152
buffer_load_dwordx4 v[88:91], v9, s[40:43], s62 offen nt
s_xor_b32 s62, s80, 57344
buffer_load_dwordx4 v[92:95], v9, s[40:43], s62 offen nt
s_xor_b32 s62, s80, 65536
buffer_load_dwordx4 v[96:99], v9, s[40:43], s62 offen nt
s_xor_b32 s62, s80, 73728
buffer_load_dwordx4 v[100:103], v9, s[40:43], s62 offen nt
s_xor_b32 s62, s80, 81920
buffer_load_dwordx4 v[104:107], v9, s[40:43], s62 offen nt
s_xor_b32 s62, s80, 90112
buffer_load_dwordx4 v[108:111], v9, s[40:43], s62 offen nt
s_xor_b32 s62, s80, 98304
buffer_load_dwordx4 v[112:115], v9, s[40:43], s62 offen nt
s_xor_b32 s62, s80, 106496
buffer_load_dwordx4 v[116:119], v9, s[40:43], s62 offen nt
s_xor_b32 s62, s80, 114688
buffer_load_dwordx4 v[120:123], v9, s[40:43], s62 offen nt
s_xor_b32 s62, s80, 122880
buffer_load_dwordx4 v[124:127], v9, s[40:43], s62 offen nt
s_xor_b32 s60, s32, 7
s_lshl_b32 s60, s60, 17
s_mov_b32 s61, 0x20000
s_add_u32 s44, s24, s60
s_addc_u32 s45, s25, 0
s_and_b32 s45, s45, 0xffff
s_mov_b32 s46, s61
s_mov_b32 s47, 0x20000
v_lshlrev_b32 v10, 12, v3
v_lshl_add_u32 v10, v2, 4, v10
s_lshl_b32 s62, s34, 14
v_add_u32 v10, s62, v10
v_mov_b32 v200, 0
v_mov_b32 v201, 0
s_lshr_b32 s62, s80, 13
v_xor_b32 v202, s62, v2
s_waitcnt lgkmcnt(0)
s_add_u32 s58, s58, 0x9e3779b9
s_bfe_u32 s76, s58, 0x80000
s_bfe_u32 s77, s58, 0x80008
s_bfe_u32 s78, s58, 0x80010
s_bfe_u32 s79, s58, 0x80018
s_waitcnt vmcnt(30)
v_dot2_f32_bf16 v60, v128, v20, 0
v_dot2_f32_bf16 v61, v128, v24, 0
v_dot2_f32_bf16 v62, v132, v20, 0
v_dot2_f32_bf16 v63, v132, v24, 0
v_dot2_f32_bf16 v60, v129, v21, v60
v_dot2_f32_bf16 v61, v129, v25, v61
v_dot2_f32_bf16 v62, v133, v21, v62
v_dot2_f32_bf16 v63, v133, v25, v63
v_dot2_f32_bf16 v60, v130, v22, v60
v_dot2_f32_bf16 v61, v130, v26, v61
v_dot2_f32_bf16 v62, v134, v22, v62
v_dot2_f32_bf16 v63, v134, v26, v63
v_dot2_f32_bf16 v60, v131, v23, v60
v_dot2_f32_bf16 v61, v131, v27, v61
v_dot2_f32_bf16 v62, v135, v23, v62
v_dot2_f32_bf16 v63, v135, v27, v63
buffer_load_dwordx4 v[128:131], v10, s[44:47], 0 offen offset:0 nt
buffer_load_dwordx4 v[132:135], v10, s[44:47], 0 offen offset:256 nt
v_add_f32_dpp v60, v60, v60 row_ror:8 row_mask:0xf bank_mask:0xf
v_add_f32_dpp v61, v61, v61 row_ror:8 row_mask:0xf bank_mask:0xf
v_add_f32_dpp v62, v62, v62 row_ror:8 row_mask:0xf bank_mask:0xf
v_add_f32_dpp v63, v63, v63 row_ror:8 row_mask:0xf bank_mask:0xf
v_add_f32_dpp v60, v60, v60 row_ror:4 row_mask:0xf bank_mask:0xf
v_add_f32_dpp v61, v61, v61 row_ror:4 row_mask:0xf bank_mask:0xf
v_add_f32_dpp v62, v62, v62 row_ror:4 row_mask:0xf bank_mask:0xf
v_add_f32_dpp v63, v63, v63 row_ror:4 row_mask:0xf bank_mask:0xf
v_add_f32_dpp v60, v60, v60 row_ror:2 row_mask:0xf bank_mask:0xf
v_add_f32_dpp v61, v61, v61 row_ror:2 row_mask:0xf bank_mask:0xf
v_add_f32_dpp v62, v62, v62 row_ror:2 row_mask:0xf bank_mask:0xf
v_add_f32_dpp v63, v63, v63 row_ror:2 row_mask:0xf bank_mask:0xf
v_add_f32_dpp v60, v60, v60 row_ror:1 row_mask:0xf bank_mask:0xf
v_add_f32_dpp v61, v61, v61 row_ror:1 row_mask:0xf bank_mask:0xf
v_add_f32_dpp v62, v62, v62 row_ror:1 row_mask:0xf bank_mask:0xf
v_add_f32_dpp v63, v63, v63 row_ror:1 row_mask:0xf bank_mask:0xf
v_cmp_eq_u32 vcc, 0, v202
s_nop 1
v_cndmask_b32 v200, v200, v60, vcc
v_cndmask_b32 v201, v201, v61, vcc
v_cmp_eq_u32 vcc, 1, v202
s_nop 1
v_cndmask_b32 v200, v200, v62, vcc
v_cndmask_b32 v201, v201, v63, vcc
s_waitcnt vmcnt(30)
v_dot2_f32_bf16 v60, v136, v20, 0
v_dot2_f32_bf16 v61, v136, v24, 0
v_dot2_f32_bf16 v62, v140, v20, 0
v_dot2_f32_bf16 v63, v140, v24, 0
v_dot2_f32_bf16 v60, v137, v21, v60
v_dot2_f32_bf16 v61, v137, v25, v61
v_dot2_f32_bf16 v62, v141, v21, v62
v_dot2_f32_bf16 v63, v141, v25, v63
v_dot2_f32_bf16 v60, v138, v22, v60
v_dot2_f32_bf16 v61, v138, v26, v61
v_dot2_f32_bf16 v62, v142, v22, v62
v_dot2_f32_bf16 v63, v142, v26, v63
v_dot2_f32_bf16 v60, v139, v23, v60
v_dot2_f32_bf16 v61, v139, v27, v61
v_dot2_f32_bf16 v62, v143, v23, v62
v_dot2_f32_bf16 v63, v143, v27, v63
buffer_load_dwordx4 v[136:139], v10, s[44:47], 0 offen offset:512 nt
buffer_load_dwordx4 v[140:143], v10, s[44:47], 0 offen offset:768 nt
v_add_f32_dpp v60, v60, v60 row_ror:8 row_mask:0xf bank_mask:0xf
v_add_f32_dpp v61, v61, v61 row_ror:8 row_mask:0xf bank_mask:0xf
v_add_f32_dpp v62, v62, v62 row_ror:8 row_mask:0xf bank_mask:0xf
v_add_f32_dpp v63, v63, v63 row_ror:8 row_mask:0xf bank_mask:0xf
v_add_f32_dpp v60, v60, v60 row_ror:4 row_mask:0xf bank_mask:0xf
v_add_f32_dpp v61, v61, v61 row_ror:4 row_mask:0xf bank_mask:0xf
v_add_f32_dpp v62, v62, v62 row_ror:4 row_mask:0xf bank_mask:0xf
v_add_f32_dpp v63, v63, v63 row_ror:4 row_mask:0xf bank_mask:0xf
v_add_f32_dpp v60, v60, v60 row_ror:2 row_mask:0xf bank_mask:0xf
v_add_f32_dpp v61, v61, v61 row_ror:2 row_mask:0xf bank_mask:0xf
v_add_f32_dpp v62, v62, v62 row_ror:2 row_mask:0xf bank_mask:0xf
v_add_f32_dpp v63, v63, v63 row_ror:2 row_mask:0xf bank_mask:0xf
v_add_f32_dpp v60, v60, v60 row_ror:1 row_mask:0xf bank_mask:0xf
v_add_f32_dpp v61, v61, v61 row_ror:1 row_mask:0xf bank_mask:0xf
v_add_f32_dpp v62, v62, v62 row_ror:1 row_mask:0xf bank_mask:0xf
v_add_f32_dpp v63, v63, v63 row_ror:1 row_mask:0xf bank_mask:0xf
v_cmp_eq_u32 vcc, 2, v202
s_nop 1
v_cndmask_b32 v200, v200, v60, vcc
v_cndmask_b32 v201, v201, v61, vcc
v_cmp_eq_u32 vcc, 3, v202
s_nop 1
v_cndmask_b32 v200, v200, v62, vcc
v_cndmask_b32 v201, v201, v63, vcc
s_waitcnt vmcnt(30)
v_dot2_f32_bf16 v60, v144, v20, 0
v_dot2_f32_bf16 v61, v144, v24, 0
v_dot2_f32_bf16 v62, v148, v20, 0
v_dot2_f32_bf16 v63, v148, v24, 0
v_dot2_f32_bf16 v60, v145, v21, v60
v_dot2_f32_bf16 v61, v145, v25, v61
v_dot2_f32_bf16 v62, v149, v21, v62
v_dot2_f32_bf16 v63, v149, v25, v63
v_dot2_f32_bf16 v60, v146, v22, v60
v_dot2_f32_bf16 v61, v146, v26, v61
v_dot2_f32_bf16 v62, v150, v22, v62
v_dot2_f32_bf16 v63, v150, v26, v63
v_dot2_f32_bf16 v60, v147, v23, v60
v_dot2_f32_bf16 v61, v147, v27, v61
v_dot2_f32_bf16 v62, v151, v23, v62
v_dot2_f32_bf16 v63, v151, v27, v63
buffer_load_dwordx4 v[144:147], v10, s[44:47], 0 offen offset:1024 nt
buffer_load_dwordx4 v[148:151], v10, s[44:47], 0 offen offset:1280 nt
v_add_f32_dpp v60, v60, v60 row_ror:8 row_mask:0xf bank_mask:0xf
v_add_f32_dpp v61, v61, v61 row_ror:8 row_mask:0xf bank_mask:0xf
v_add_f32_dpp v62, v62, v62 row_ror:8 row_mask:0xf bank_mask:0xf
v_add_f32_dpp v63, v63, v63 row_ror:8 row_mask:0xf bank_mask:0xf
v_add_f32_dpp v60, v60, v60 row_ror:4 row_mask:0xf bank_mask:0xf
v_add_f32_dpp v61, v61, v61 row_ror:4 row_mask:0xf bank_mask:0xf
v_add_f32_dpp v62, v62, v62 row_ror:4 row_mask:0xf bank_mask:0xf
v_add_f32_dpp v63, v63, v63 row_ror:4 row_mask:0xf bank_mask:0xf
v_add_f32_dpp v60, v60, v60 row_ror:2 row_mask:0xf bank_mask:0xf
v_add_f32_dpp v61, v61, v61 row_ror:2 row_mask:0xf bank_mask:0xf
v_add_f32_dpp v62, v62, v62 row_ror:2 row_mask:0xf bank_mask:0xf
v_add_f32_dpp v63, v63, v63 row_ror:2 row_mask:0xf bank_mask:0xf
v_add_f32_dpp v60, v60, v60 row_ror:1 row_mask:0xf bank_mask:0xf
v_add_f32_dpp v61, v61, v61 row_ror:1 row_mask:0xf bank_mask:0xf
v_add_f32_dpp v62, v62, v62 row_ror:1 row_mask:0xf bank_mask:0xf
v_add_f32_dpp v63, v63, v63 row_ror:1 row_mask:0xf bank_mask:0xf
v_cmp_eq_u32 vcc, 4, v202
s_nop 1
v_cndmask_b32 v200, v200, v60, vcc
v_cndmask_b32 v201, v201, v61, vcc
v_cmp_eq_u32 vcc, 5, v202
s_nop 1
v_cndmask_b32 v200, v200, v62, vcc
v_cndmask_b32 v201, v201, v63, vcc
s_waitcnt vmcnt(30)
v_dot2_f32_bf16 v60, v152, v20, 0
v_dot2_f32_bf16 v61, v152, v24, 0
v_dot2_f32_bf16 v62, v156, v20, 0
v_dot2_f32_bf16 v63, v156, v24, 0
v_dot2_f32_bf16 v60, v153, v21, v60
v_dot2_f32_bf16 v61, v153, v25, v61
v_dot2_f32_bf16 v62, v157, v21, v62
v_dot2_f32_bf16 v63, v157, v25, v63
v_dot2_f32_bf16 v60, v154, v22, v60
v_dot2_f32_bf16 v61, v154, v26, v61
v_dot2_f32_bf16 v62, v158, v22, v62
v_dot2_f32_bf16 v63, v158, v26, v63
v_dot2_f32_bf16 v60, v155, v23, v60
v_dot2_f32_bf16 v61, v155, v27, v61
v_dot2_f32_bf16 v62, v159, v23, v62
v_dot2_f32_bf16 v63, v159, v27, v63
buffer_load_dwordx4 v[152:155], v10, s[44:47], 0 offen offset:1536 nt
buffer_load_dwordx4 v[156:159], v10, s[44:47], 0 offen offset:1792 nt
v_add_f32_dpp v60, v60, v60 row_ror:8 row_mask:0xf bank_mask:0xf
v_add_f32_dpp v61, v61, v61 row_ror:8 row_mask:0xf bank_mask:0xf
v_add_f32_dpp v62, v62, v62 row_ror:8 row_mask:0xf bank_mask:0xf
v_add_f32_dpp v63, v63, v63 row_ror:8 row_mask:0xf bank_mask:0xf
v_add_f32_dpp v60, v60, v60 row_ror:4 row_mask:0xf bank_mask:0xf
v_add_f32_dpp v61, v61, v61 row_ror:4 row_mask:0xf bank_mask:0xf
v_add_f32_dpp v62, v62, v62 row_ror:4 row_mask:0xf bank_mask:0xf
v_add_f32_dpp v63, v63, v63 row_ror:4 row_mask:0xf bank_mask:0xf
v_add_f32_dpp v60, v60, v60 row_ror:2 row_mask:0xf bank_mask:0xf
v_add_f32_dpp v61, v61, v61 row_ror:2 row_mask:0xf bank_mask:0xf
v_add_f32_dpp v62, v62, v62 row_ror:2 row_mask:0xf bank_mask:0xf
v_add_f32_dpp v63, v63, v63 row_ror:2 row_mask:0xf bank_mask:0xf
v_add_f32_dpp v60, v60, v60 row_ror:1 row_mask:0xf bank_mask:0xf
v_add_f32_dpp v61, v61, v61 row_ror:1 row_mask:0xf bank_mask:0xf
v_add_f32_dpp v62, v62, v62 row_ror:1 row_mask:0xf bank_mask:0xf
v_add_f32_dpp v63, v63, v63 row_ror:1 row_mask:0xf bank_mask:0xf
v_cmp_eq_u32 vcc, 6, v202
s_nop 1
v_cndmask_b32 v200, v200, v60, vcc
v_cndmask_b32 v201, v201, v61, vcc
v_cmp_eq_u32 vcc, 7, v202
s_nop 1
v_cndmask_b32 v200, v200, v62, vcc
v_cndmask_b32 v201, v201, v63, vcc
s_waitcnt vmcnt(30)
v_dot2_f32_bf16 v60, v160, v20, 0
v_dot2_f32_bf16 v61, v160, v24, 0
v_dot2_f32_bf16 v62, v164, v20, 0
v_dot2_f32_bf16 v63, v164, v24, 0
v_dot2_f32_bf16 v60, v161, v21, v60
v_dot2_f32_bf16 v61, v161, v25, v61
v_dot2_f32_bf16 v62, v165, v21, v62
v_dot2_f32_bf16 v63, v165, v25, v63
v_dot2_f32_bf16 v60, v162, v22, v60
v_dot2_f32_bf16 v61, v162, v26, v61
v_dot2_f32_bf16 v62, v166, v22, v62
v_dot2_f32_bf16 v63, v166, v26, v63
v_dot2_f32_bf16 v60, v163, v23, v60
v_dot2_f32_bf16 v61, v163, v27, v61
v_dot2_f32_bf16 v62, v167, v23, v62
v_dot2_f32_bf16 v63, v167, v27, v63
buffer_load_dwordx4 v[160:163], v10, s[44:47], 0 offen offset:2048 nt
buffer_load_dwordx4 v[164:167], v10, s[44:47], 0 offen offset:2304 nt
v_add_f32_dpp v60, v60, v60 row_ror:8 row_mask:0xf bank_mask:0xf
v_add_f32_dpp v61, v61, v61 row_ror:8 row_mask:0xf bank_mask:0xf
v_add_f32_dpp v62, v62, v62 row_ror:8 row_mask:0xf bank_mask:0xf
v_add_f32_dpp v63, v63, v63 row_ror:8 row_mask:0xf bank_mask:0xf
v_add_f32_dpp v60, v60, v60 row_ror:4 row_mask:0xf bank_mask:0xf
v_add_f32_dpp v61, v61, v61 row_ror:4 row_mask:0xf bank_mask:0xf
v_add_f32_dpp v62, v62, v62 row_ror:4 row_mask:0xf bank_mask:0xf
v_add_f32_dpp v63, v63, v63 row_ror:4 row_mask:0xf bank_mask:0xf
v_add_f32_dpp v60, v60, v60 row_ror:2 row_mask:0xf bank_mask:0xf
v_add_f32_dpp v61, v61, v61 row_ror:2 row_mask:0xf bank_mask:0xf
v_add_f32_dpp v62, v62, v62 row_ror:2 row_mask:0xf bank_mask:0xf
v_add_f32_dpp v63, v63, v63 row_ror:2 row_mask:0xf bank_mask:0xf
v_add_f32_dpp v60, v60, v60 row_ror:1 row_mask:0xf bank_mask:0xf
v_add_f32_dpp v61, v61, v61 row_ror:1 row_mask:0xf bank_mask:0xf
v_add_f32_dpp v62, v62, v62 row_ror:1 row_mask:0xf bank_mask:0xf
v_add_f32_dpp v63, v63, v63 row_ror:1 row_mask:0xf bank_mask:0xf
v_cmp_eq_u32 vcc, 8, v202
s_nop 1
v_cndmask_b32 v200, v200, v60, vcc
v_cndmask_b32 v201, v201, v61, vcc
v_cmp_eq_u32 vcc, 9, v202
s_nop 1
v_cndmask_b32 v200, v200, v62, vcc
v_cndmask_b32 v201, v201, v63, vcc
s_waitcnt vmcnt(30)
v_dot2_f32_bf16 v60, v168, v20, 0
v_dot2_f32_bf16 v61, v168, v24, 0
v_dot2_f32_bf16 v62, v172, v20, 0
v_dot2_f32_bf16 v63, v172, v24, 0
v_dot2_f32_bf16 v60, v169, v21, v60
v_dot2_f32_bf16 v61, v169, v25, v61
v_dot2_f32_bf16 v62, v173, v21, v62
v_dot2_f32_bf16 v63, v173, v25, v63
v_dot2_f32_bf16 v60, v170, v22, v60
v_dot2_f32_bf16 v61, v170, v26, v61
v_dot2_f32_bf16 v62, v174, v22, v62
v_dot2_f32_bf16 v63, v174, v26, v63
v_dot2_f32_bf16 v60, v171, v23, v60
v_dot2_f32_bf16 v61, v171, v27, v61
v_dot2_f32_bf16 v62, v175, v23, v62
v_dot2_f32_bf16 v63, v175, v27, v63
buffer_load_dwordx4 v[168:171], v10, s[44:47], 0 offen offset:2560 nt
buffer_load_dwordx4 v[172:175], v10, s[44:47], 0 offen offset:2816 nt
v_add_f32_dpp v60, v60, v60 row_ror:8 row_mask:0xf bank_mask:0xf
v_add_f32_dpp v61, v61, v61 row_ror:8 row_mask:0xf bank_mask:0xf
v_add_f32_dpp v62, v62, v62 row_ror:8 row_mask:0xf bank_mask:0xf
v_add_f32_dpp v63, v63, v63 row_ror:8 row_mask:0xf bank_mask:0xf
v_add_f32_dpp v60, v60, v60 row_ror:4 row_mask:0xf bank_mask:0xf
v_add_f32_dpp v61, v61, v61 row_ror:4 row_mask:0xf bank_mask:0xf
v_add_f32_dpp v62, v62, v62 row_ror:4 row_mask:0xf bank_mask:0xf
v_add_f32_dpp v63, v63, v63 row_ror:4 row_mask:0xf bank_mask:0xf
v_add_f32_dpp v60, v60, v60 row_ror:2 row_mask:0xf bank_mask:0xf
v_add_f32_dpp v61, v61, v61 row_ror:2 row_mask:0xf bank_mask:0xf
v_add_f32_dpp v62, v62, v62 row_ror:2 row_mask:0xf bank_mask:0xf
v_add_f32_dpp v63, v63, v63 row_ror:2 row_mask:0xf bank_mask:0xf
v_add_f32_dpp v60, v60, v60 row_ror:1 row_mask:0xf bank_mask:0xf
v_add_f32_dpp v61, v61, v61 row_ror:1 row_mask:0xf bank_mask:0xf
v_add_f32_dpp v62, v62, v62 row_ror:1 row_mask:0xf bank_mask:0xf
v_add_f32_dpp v63, v63, v63 row_ror:1 row_mask:0xf bank_mask:0xf
v_cmp_eq_u32 vcc, 10, v202
s_nop 1
v_cndmask_b32 v200, v200, v60, vcc
v_cndmask_b32 v201, v201, v61, vcc
v_cmp_eq_u32 vcc, 11, v202
s_nop 1
v_cndmask_b32 v200, v200, v62, vcc
v_cndmask_b32 v201, v201, v63, vcc
s_waitcnt vmcnt(30)
v_dot2_f32_bf16 v60, v176, v20, 0
v_dot2_f32_bf16 v61, v176, v24, 0
v_dot2_f32_bf16 v62, v180, v20, 0
v_dot2_f32_bf16 v63, v180, v24, 0
v_dot2_f32_bf16 v60, v177, v21, v60
v_dot2_f32_bf16 v61, v177, v25, v61
v_dot2_f32_bf16 v62, v181, v21, v62
v_dot2_f32_bf16 v63, v181, v25, v63
v_dot2_f32_bf16 v60, v178, v22, v60
v_dot2_f32_bf16 v61, v178, v26, v61
v_dot2_f32_bf16 v62, v182, v22, v62
v_dot2_f32_bf16 v63, v182, v26, v63
v_dot2_f32_bf16 v60, v179, v23, v60
v_dot2_f32_bf16 v61, v179, v27, v61
v_dot2_f32_bf16 v62, v183, v23, v62
v_dot2_f32_bf16 v63, v183, v27, v63
buffer_load_dwordx4 v[176:179], v10, s[44:47], 0 offen offset:3072 nt
buffer_load_dwordx4 v[180:183], v10, s[44:47], 0 offen offset:3328 nt
v_add_f32_dpp v60, v60, v60 row_ror:8 row_mask:0xf bank_mask:0xf
v_add_f32_dpp v61, v61, v61 row_ror:8 row_mask:0xf bank_mask:0xf
v_add_f32_dpp v62, v62, v62 row_ror:8 row_mask:0xf bank_mask:0xf
v_add_f32_dpp v63, v63, v63 row_ror:8 row_mask:0xf bank_mask:0xf
v_add_f32_dpp v60, v60, v60 row_ror:4 row_mask:0xf bank_mask:0xf
v_add_f32_dpp v61, v61, v61 row_ror:4 row_mask:0xf bank_mask:0xf
v_add_f32_dpp v62, v62, v62 row_ror:4 row_mask:0xf bank_mask:0xf
v_add_f32_dpp v63, v63, v63 row_ror:4 row_mask:0xf bank_mask:0xf
v_add_f32_dpp v60, v60, v60 row_ror:2 row_mask:0xf bank_mask:0xf
v_add_f32_dpp v61, v61, v61 row_ror:2 row_mask:0xf bank_mask:0xf
v_add_f32_dpp v62, v62, v62 row_ror:2 row_mask:0xf bank_mask:0xf
v_add_f32_dpp v63, v63, v63 row_ror:2 row_mask:0xf bank_mask:0xf
v_add_f32_dpp v60, v60, v60 row_ror:1 row_mask:0xf bank_mask:0xf
v_add_f32_dpp v61, v61, v61 row_ror:1 row_mask:0xf bank_mask:0xf
v_add_f32_dpp v62, v62, v62 row_ror:1 row_mask:0xf bank_mask:0xf
v_add_f32_dpp v63, v63, v63 row_ror:1 row_mask:0xf bank_mask:0xf
v_cmp_eq_u32 vcc, 12, v202
s_nop 1
v_cndmask_b32 v200, v200, v60, vcc
v_cndmask_b32 v201, v201, v61, vcc
v_cmp_eq_u32 vcc, 13, v202
s_nop 1
v_cndmask_b32 v200, v200, v62, vcc
v_cndmask_b32 v201, v201, v63, vcc
s_waitcnt vmcnt(30)
v_dot2_f32_bf16 v60, v184, v20, 0
v_dot2_f32_bf16 v61, v184, v24, 0
v_dot2_f32_bf16 v62, v188, v20, 0
v_dot2_f32_bf16 v63, v188, v24, 0
v_dot2_f32_bf16 v60, v185, v21, v60
v_dot2_f32_bf16 v61, v185, v25, v61
v_dot2_f32_bf16 v62, v189, v21, v62
v_dot2_f32_bf16 v63, v189, v25, v63
v_dot2_f32_bf16 v60, v186, v22, v60
v_dot2_f32_bf16 v61, v186, v26, v61
v_dot2_f32_bf16 v62, v190, v22, v62
v_dot2_f32_bf16 v63, v190, v26, v63
v_dot2_f32_bf16 v60, v187, v23, v60
v_dot2_f32_bf16 v61, v187, v27, v61
v_dot2_f32_bf16 v62, v191, v23, v62
v_dot2_f32_bf16 v63, v191, v27, v63
buffer_load_dwordx4 v[184:187], v10, s[44:47], 0 offen offset:3584 nt
buffer_load_dwordx4 v[188:191], v10, s[44:47], 0 offen offset:3840 nt
v_add_f32_dpp v60, v60, v60 row_ror:8 row_mask:0xf bank_mask:0xf
v_add_f32_dpp v61, v61, v61 row_ror:8 row_mask:0xf bank_mask:0xf
v_add_f32_dpp v62, v62, v62 row_ror:8 row_mask:0xf bank_mask:0xf
v_add_f32_dpp v63, v63, v63 row_ror:8 row_mask:0xf bank_mask:0xf
v_add_f32_dpp v60, v60, v60 row_ror:4 row_mask:0xf bank_mask:0xf
v_add_f32_dpp v61, v61, v61 row_ror:4 row_mask:0xf bank_mask:0xf
v_add_f32_dpp v62, v62, v62 row_ror:4 row_mask:0xf bank_mask:0xf
v_add_f32_dpp v63, v63, v63 row_ror:4 row_mask:0xf bank_mask:0xf
v_add_f32_dpp v60, v60, v60 row_ror:2 row_mask:0xf bank_mask:0xf
v_add_f32_dpp v61, v61, v61 row_ror:2 row_mask:0xf bank_mask:0xf
v_add_f32_dpp v62, v62, v62 row_ror:2 row_mask:0xf bank_mask:0xf
v_add_f32_dpp v63, v63, v63 row_ror:2 row_mask:0xf bank_mask:0xf
v_add_f32_dpp v60, v60, v60 row_ror:1 row_mask:0xf bank_mask:0xf
v_add_f32_dpp v61, v61, v61 row_ror:1 row_mask:0xf bank_mask:0xf
v_add_f32_dpp v62, v62, v62 row_ror:1 row_mask:0xf bank_mask:0xf
v_add_f32_dpp v63, v63, v63 row_ror:1 row_mask:0xf bank_mask:0xf
v_cmp_eq_u32 vcc, 14, v202
s_nop 1
v_cndmask_b32 v200, v200, v60, vcc
v_cndmask_b32 v201, v201, v61, vcc
v_cmp_eq_u32 vcc, 15, v202
s_nop 1
v_cndmask_b32 v200, v200, v62, vcc
v_cndmask_b32 v201, v201, v63, vcc
v_cvt_pk_bf16_f32 v200, v200, v200
v_cvt_pk_bf16_f32 v201, v201, v201
v_lshlrev_b32 v192, 1, v0
ds_write_b16 v192, v200 offset:0
ds_write_b16 v192, v201 offset:1024
s_waitcnt lgkmcnt(0)
s_barrier
s_cmp_lg_u32 s34, 0
s_cbranch_scc1 L_W_q
v_lshlrev_b32 v192, 4, v1
ds_read_b128 v[20:23], v192 offset:0
ds_read_b128 v[24:27], v192 offset:1024
s_lshl_b32 s62, s32, 10
s_add_u32 s62, s62, 0x0
s_add_u32 s63, s62, 32768
s_waitcnt lgkmcnt(0)
buffer_store_dwordx4 v[20:23], v192, s[52:55], s62 offen sc1
buffer_store_dwordx4 v[24:27], v192, s[52:55], s63 offen sc1
s_lshl_b32 s62, s32, 7
s_add_u32 s62, s62, 0x15000
v_mov_b32 v192, s62
v_mov_b32 v193, s58
s_mov_b64 exec, 1
s_waitcnt vmcnt(0)
buffer_store_dword v193, v192, s[52:55], 0 offen sc1
s_mov_b64 exec, -1
L_W_q:
s_waitcnt vmcnt(0)
s_xor_b32 s32, s32, 7
v_bfe_u32 v9, v1, 2, 3
v_lshlrev_b32 v9, 11, v9
v_and_b32 v192, 3, v1
v_lshrrev_b32 v10, 5, v1
v_lshl_add_u32 v192, v10, 2, v192
v_lshl_add_u32 v9, v192, 4, v9
s_lshr_b32 s62, s32, 4
s_and_b32 s63, s32, 15
s_lshl_b32 s60, s62, 16
s_lshl_b32 s61, s63, 7
s_add_u32 s60, s60, s61
s_add_u32 s60, s60, 0x20000
v_add_u32 v9, s60, v9
s_lshl_b32 s60, s62, 11
s_lshl_b32 s61, s63, 6
s_add_u32 s60, s60, s61
s_add_u32 s60, s60, 1024
v_lshl_add_u32 v10, v192, 3, s60
s_mov_b32 s37, 65536
s_lshr_b32 s35, s34, 2
s_and_b32 s36, s34, 3
s_branch L_W_merge
L_W_poll:
s_lshl_b32 s63, s32, 4
s_add_u32 s63, s63, 0x10000
v_lshl_add_u32 v192, v1, 9, s63
s_cmp_lg_u32 s34, 0
s_cbranch_scc1 L_wf_Wc
s_lshl_b64 exec, 1, s32
s_mov_b32 s64, 0
L_pl_Wc1:
buffer_load_dwordx4 v[196:199], v192, s[52:55], 0 offen sc1
s_add_u32 s64, s64, 1
s_waitcnt vmcnt(0)
v_xor_b32 v196, s76, v196
v_xor_b32 v197, s77, v197
v_xor_b32 v198, s78, v198
v_xor_b32 v199, s79, v199
v_or_b32 v193, v196, v197
v_or3_b32 v193, v193, v198, v199
v_and_b32 v193, 0xff, v193
v_cmp_ne_u32 vcc, 0, v193
s_nop 0
s_cmp_eq_u64 vcc, 0
s_cbranch_scc1 L_pd_Wc1
s_mov_b64 exec, vcc
s_sleep 2
s_cmp_lt_u32 s64, 65536
s_cbranch_scc1 L_pl_Wc1
L_pd_Wc1:
s_mov_b32 exec_lo, -1
s_mov_b32 exec_hi, 0
s_mov_b32 s64, 0
L_pl_Wc2:
buffer_load_dwordx4 v[196:199], v192, s[52:55], 0 offen sc1
s_add_u32 s64, s64, 1
s_waitcnt vmcnt(0)
v_xor_b32 v196, s76, v196
v_xor_b32 v197, s77, v197
v_xor_b32 v198, s78, v198
v_xor_b32 v199, s79, v199
v_or_b32 v193, v196, v197
v_or3_b32 v193, v193, v198, v199
v_and_b32 v193, 0xff, v193
v_cmp_ne_u32 vcc, 0, v193
s_nop 0
s_cmp_eq_u64 vcc, 0
s_cbranch_scc1 L_pd_Wc2
s_mov_b64 exec, vcc
s_cmp_lt_u32 s64, 65536
s_cbranch_scc1 L_pl_Wc2
L_pd_Wc2:
s_mov_b64 exec, -1
L_wf_Wc:
s_barrier
s_lshl_b32 s62, s35, 13
s_add_u32 s63, s63, s62
v_lshl_add_u32 v192, v2, 9, s63
buffer_load_dwordx4 v[196:199], v192, s[52:55], 0 offen sc1
s_lshl_b32 s62, s35, 5
s_add_u32 s62, s62, s32
s_lshl_b32 s63, s62, 14
s_add_u32 s63, s63, 0x200000
s_lshl_b32 s64, s36, 12
s_add_u32 s63, s63, s64
v_lshl_add_u32 v193, v1, 4, s63
buffer_load_dwordx4 v[200:203], v193, s[52:55], 0 offen offset:0 sc1
buffer_load_dwordx4 v[204:207], v193, s[52:55], 0 offen offset:1024 sc1
buffer_load_dwordx4 v[208:211], v193, s[52:55], 0 offen offset:2048 sc1
buffer_load_dwordx4 v[212:215], v193, s[52:55], 0 offen offset:3072 sc1
L_W_merge:
s_mov_b32 s60, 0x07060302
s_waitcnt vmcnt(4)
v_perm_b32 v194, v196, v197, s60
v_perm_b32 v195, v198, v199, s60
v_mov_b32 v196, v194
s_nop 1
v_max_f32_dpp v196, v196, v196 row_ror:8 row_mask:0xf bank_mask:0xf
s_nop 1
v_max_f32_dpp v196, v196, v196 row_ror:4 row_mask:0xf bank_mask:0xf
s_nop 1
v_max_f32_dpp v196, v196, v196 row_ror:2 row_mask:0xf bank_mask:0xf
s_nop 1
v_max_f32_dpp v196, v196, v196 row_ror:1 row_mask:0xf bank_mask:0xf
v_sub_f32 v197, v194, v196
v_exp_f32 v197, v197
s_nop 0
v_mul_f32 v195, v195, v197
s_nop 1
v_add_f32_dpp v195, v195, v195 row_ror:8 row_mask:0xf bank_mask:0xf
s_nop 1
v_add_f32_dpp v195, v195, v195 row_ror:4 row_mask:0xf bank_mask:0xf
s_nop 1
v_add_f32_dpp v195, v195, v195 row_ror:2 row_mask:0xf bank_mask:0xf
s_nop 1
v_add_f32_dpp v195, v195, v195 row_ror:1 row_mask:0xf bank_mask:0xf
v_rcp_f32 v195, v195
s_nop 0
v_mul_f32 v197, v197, v195
s_lshl_b32 s64, s36, 2
s_add_u32 s65, s64, 0
v_readlane_b32 s66, v197, s65
s_add_u32 s65, s64, 1
v_readlane_b32 s67, v197, s65
s_add_u32 s65, s64, 2
v_readlane_b32 s68, v197, s65
s_add_u32 s65, s64, 3
v_readlane_b32 s69, v197, s65
s_waitcnt vmcnt(3)
v_lshlrev_b32 v216, 16, v200
v_and_b32 v217, 0xffff0000, v200
v_lshlrev_b32 v218, 16, v201
v_and_b32 v219, 0xffff0000, v201
v_lshlrev_b32 v220, 16, v202
v_and_b32 v221, 0xffff0000, v202
v_lshlrev_b32 v222, 16, v203
v_and_b32 v223, 0xffff0000, v203
v_mul_f32 v232, s66, v216
v_mul_f32 v233, s66, v217
v_mul_f32 v234, s66, v218
v_mul_f32 v235, s66, v219
v_mul_f32 v236, s66, v220
v_mul_f32 v237, s66, v221
v_mul_f32 v238, s66, v222
v_mul_f32 v239, s66, v223
s_waitcnt vmcnt(2)
v_lshlrev_b32 v216, 16, v204
v_and_b32 v217, 0xffff0000, v204
v_lshlrev_b32 v218, 16, v205
v_and_b32 v219, 0xffff0000, v205
v_lshlrev_b32 v220, 16, v206
v_and_b32 v221, 0xffff0000, v206
v_lshlrev_b32 v222, 16, v207
v_and_b32 v223, 0xffff0000, v207
v_fma_f32 v232, v216, s67, v232
v_fma_f32 v233, v217, s67, v233
v_fma_f32 v234, v218, s67, v234
v_fma_f32 v235, v219, s67, v235
v_fma_f32 v236, v220, s67, v236
v_fma_f32 v237, v221, s67, v237
v_fma_f32 v238, v222, s67, v238
v_fma_f32 v239, v223, s67, v239
s_waitcnt vmcnt(1)
v_lshlrev_b32 v216, 16, v208
v_and_b32 v217, 0xffff0000, v208
v_lshlrev_b32 v218, 16, v209
v_and_b32 v219, 0xffff0000, v209
v_lshlrev_b32 v220, 16, v210
v_and_b32 v221, 0xffff0000, v210
v_lshlrev_b32 v222, 16, v211
v_and_b32 v223, 0xffff0000, v211
v_fma_f32 v232, v216, s68, v232
v_fma_f32 v233, v217, s68, v233
v_fma_f32 v234, v218, s68, v234
v_fma_f32 v235, v219, s68, v235
v_fma_f32 v236, v220, s68, v236
v_fma_f32 v237, v221, s68, v237
v_fma_f32 v238, v222, s68, v238
v_fma_f32 v239, v223, s68, v239
s_waitcnt vmcnt(0)
v_lshlrev_b32 v216, 16, v212
v_and_b32 v217, 0xffff0000, v212
v_lshlrev_b32 v218, 16, v213
v_and_b32 v219, 0xffff0000, v213
v_lshlrev_b32 v220, 16, v214
v_and_b32 v221, 0xffff0000, v214
v_lshlrev_b32 v222, 16, v215
v_and_b32 v223, 0xffff0000, v215
v_fma_f32 v232, v216, s69, v232
v_fma_f32 v233, v217, s69, v233
v_fma_f32 v234, v218, s69, v234
v_fma_f32 v235, v219, s69, v235
v_fma_f32 v236, v220, s69, v236
v_fma_f32 v237, v221, s69, v237
v_fma_f32 v238, v222, s69, v238
v_fma_f32 v239, v223, s69, v239
s_lshl_b32 s62, s34, 11
v_lshl_add_u32 v192, v1, 5, s62
ds_write_b128 v192, v[232:235] offset:18432
ds_write_b128 v192, v[236:239] offset:18448
s_waitcnt lgkmcnt(0)
s_barrier
v_lshrrev_b32 v192, 3, v2
v_lshlrev_b32 v192, 13, v192
v_lshl_add_u32 v192, v3, 6, v192
s_lshl_b32 s62, s34, 8
s_lshr_b32 s63, s80, 11
s_add_u32 s62, s62, s63
v_add_u32 v192, s62, v192
v_xor_b32 v193, 16, v192
v_xor_b32 v194, 32, v192
v_xor_b32 v195, 48, v192
ds_read_b128 v[200:203], v192 offset:18432
ds_read_b128 v[204:207], v193 offset:18432
ds_read_b128 v[208:211], v194 offset:18432
ds_read_b128 v[212:215], v195 offset:18432
ds_read_b128 v[216:219], v192 offset:20480
ds_read_b128 v[220:223], v193 offset:20480
ds_read_b128 v[224:227], v194 offset:20480
ds_read_b128 v[228:231], v195 offset:20480
s_waitcnt lgkmcnt(0)
v_add_f32 v200, v200, v216
v_add_f32 v201, v201, v217
v_add_f32 v202, v202, v218
v_add_f32 v203, v203, v219
v_add_f32 v204, v204, v220
v_add_f32 v205, v205, v221
v_add_f32 v206, v206, v222
v_add_f32 v207, v207, v223
v_add_f32 v208, v208, v224
v_add_f32 v209, v209, v225
v_add_f32 v210, v210, v226
v_add_f32 v211, v211, v227
v_add_f32 v212, v212, v228
v_add_f32 v213, v213, v229
v_add_f32 v214, v214, v230
v_add_f32 v215, v215, v231
ds_read_b128 v[216:219], v192 offset:22528
ds_read_b128 v[220:223], v193 offset:22528
ds_read_b128 v[224:227], v194 offset:22528
ds_read_b128 v[228:231], v195 offset:22528
s_waitcnt lgkmcnt(0)
v_add_f32 v200, v200, v216
v_add_f32 v201, v201, v217
v_add_f32 v202, v202, v218
v_add_f32 v203, v203, v219
v_add_f32 v204, v204, v220
v_add_f32 v205, v205, v221
v_add_f32 v206, v206, v222
v_add_f32 v207, v207, v223
v_add_f32 v208, v208, v224
v_add_f32 v209, v209, v225
v_add_f32 v210, v210, v226
v_add_f32 v211, v211, v227
v_add_f32 v212, v212, v228
v_add_f32 v213, v213, v229
v_add_f32 v214, v214, v230
v_add_f32 v215, v215, v231
ds_read_b128 v[216:219], v192 offset:24576
ds_read_b128 v[220:223], v193 offset:24576
ds_read_b128 v[224:227], v194 offset:24576
ds_read_b128 v[228:231], v195 offset:24576
s_waitcnt lgkmcnt(0)
v_add_f32 v200, v200, v216
v_add_f32 v201, v201, v217
v_add_f32 v202, v202, v218
v_add_f32 v203, v203, v219
v_add_f32 v204, v204, v220
v_add_f32 v205, v205, v221
v_add_f32 v206, v206, v222
v_add_f32 v207, v207, v223
v_add_f32 v208, v208, v224
v_add_f32 v209, v209, v225
v_add_f32 v210, v210, v226
v_add_f32 v211, v211, v227
v_add_f32 v212, v212, v228
v_add_f32 v213, v213, v229
v_add_f32 v214, v214, v230
v_add_f32 v215, v215, v231
v_cvt_pk_bf16_f32 v12, v200, v201
v_cvt_pk_bf16_f32 v13, v202, v203
v_cvt_pk_bf16_f32 v14, v204, v205
v_cvt_pk_bf16_f32 v15, v206, v207
v_cvt_pk_bf16_f32 v16, v208, v209
v_cvt_pk_bf16_f32 v17, v210, v211
v_cvt_pk_bf16_f32 v18, v212, v213
v_cvt_pk_bf16_f32 v19, v214, v215
s_mov_b32 s60, 0x01000100
v_perm_b32 v192, v12, v12, s60
v_and_b32 v28, v192, v4
v_and_b32 v29, v192, v5
v_and_b32 v30, v192, v6
v_and_b32 v31, v192, v7
s_waitcnt vmcnt(63)
s_nop 0
v_mfma_f32_16x16x32_bf16 v[44:47], v[28:31], v[64:67], 0
s_mov_b32 s60, 0x03020302
v_perm_b32 v193, v12, v12, s60
v_and_b32 v32, v193, v4
v_and_b32 v33, v193, v5
v_and_b32 v34, v193, v6
v_and_b32 v35, v193, v7
s_waitcnt vmcnt(63)
s_nop 0
v_mfma_f32_16x16x32_bf16 v[44:47], v[32:35], v[68:71], v[44:47]
s_mov_b32 s60, 0x01000100
v_perm_b32 v192, v13, v13, s60
v_and_b32 v28, v192, v4
v_and_b32 v29, v192, v5
v_and_b32 v30, v192, v6
v_and_b32 v31, v192, v7
s_waitcnt vmcnt(63)
s_nop 0
v_mfma_f32_16x16x32_bf16 v[44:47], v[28:31], v[72:75], v[44:47]
s_mov_b32 s60, 0x03020302
v_perm_b32 v193, v13, v13, s60
v_and_b32 v32, v193, v4
v_and_b32 v33, v193, v5
v_and_b32 v34, v193, v6
v_and_b32 v35, v193, v7
s_waitcnt vmcnt(63)
s_nop 0
v_mfma_f32_16x16x32_bf16 v[44:47], v[32:35], v[76:79], v[44:47]
s_mov_b32 s60, 0x01000100
v_perm_b32 v192, v14, v14, s60
v_and_b32 v28, v192, v4
v_and_b32 v29, v192, v5
v_and_b32 v30, v192, v6
v_and_b32 v31, v192, v7
s_waitcnt vmcnt(63)
s_nop 0
v_mfma_f32_16x16x32_bf16 v[44:47], v[28:31], v[80:83], v[44:47]
s_mov_b32 s60, 0x03020302
v_perm_b32 v193, v14, v14, s60
v_and_b32 v32, v193, v4
v_and_b32 v33, v193, v5
v_and_b32 v34, v193, v6
v_and_b32 v35, v193, v7
s_waitcnt vmcnt(63)
s_nop 0
v_mfma_f32_16x16x32_bf16 v[44:47], v[32:35], v[84:87], v[44:47]
s_mov_b32 s60, 0x01000100
v_perm_b32 v192, v15, v15, s60
v_and_b32 v28, v192, v4
v_and_b32 v29, v192, v5
v_and_b32 v30, v192, v6
v_and_b32 v31, v192, v7
s_waitcnt vmcnt(63)
s_nop 0
v_mfma_f32_16x16x32_bf16 v[44:47], v[28:31], v[88:91], v[44:47]
s_mov_b32 s60, 0x03020302
v_perm_b32 v193, v15, v15, s60
v_and_b32 v32, v193, v4
v_and_b32 v33, v193, v5
v_and_b32 v34, v193, v6
v_and_b32 v35, v193, v7
s_waitcnt vmcnt(63)
s_nop 0
v_mfma_f32_16x16x32_bf16 v[44:47], v[32:35], v[92:95], v[44:47]
s_mov_b32 s60, 0x01000100
v_perm_b32 v192, v16, v16, s60
v_and_b32 v28, v192, v4
v_and_b32 v29, v192, v5
v_and_b32 v30, v192, v6
v_and_b32 v31, v192, v7
s_waitcnt vmcnt(63)
s_nop 0
v_mfma_f32_16x16x32_bf16 v[44:47], v[28:31], v[96:99], v[44:47]
s_mov_b32 s60, 0x03020302
v_perm_b32 v193, v16, v16, s60
v_and_b32 v32, v193, v4
v_and_b32 v33, v193, v5
v_and_b32 v34, v193, v6
v_and_b32 v35, v193, v7
s_waitcnt vmcnt(63)
s_nop 0
v_mfma_f32_16x16x32_bf16 v[44:47], v[32:35], v[100:103], v[44:47]
s_mov_b32 s60, 0x01000100
v_perm_b32 v192, v17, v17, s60
v_and_b32 v28, v192, v4
v_and_b32 v29, v192, v5
v_and_b32 v30, v192, v6
v_and_b32 v31, v192, v7
s_waitcnt vmcnt(63)
s_nop 0
v_mfma_f32_16x16x32_bf16 v[44:47], v[28:31], v[104:107], v[44:47]
s_mov_b32 s60, 0x03020302
v_perm_b32 v193, v17, v17, s60
v_and_b32 v32, v193, v4
v_and_b32 v33, v193, v5
v_and_b32 v34, v193, v6
v_and_b32 v35, v193, v7
s_waitcnt vmcnt(63)
s_nop 0
v_mfma_f32_16x16x32_bf16 v[44:47], v[32:35], v[108:111], v[44:47]
s_mov_b32 s60, 0x01000100
v_perm_b32 v192, v18, v18, s60
v_and_b32 v28, v192, v4
v_and_b32 v29, v192, v5
v_and_b32 v30, v192, v6
v_and_b32 v31, v192, v7
s_waitcnt vmcnt(63)
s_nop 0
v_mfma_f32_16x16x32_bf16 v[44:47], v[28:31], v[112:115], v[44:47]
s_mov_b32 s60, 0x03020302
v_perm_b32 v193, v18, v18, s60
v_and_b32 v32, v193, v4
v_and_b32 v33, v193, v5
v_and_b32 v34, v193, v6
v_and_b32 v35, v193, v7
s_waitcnt vmcnt(63)
s_nop 0
v_mfma_f32_16x16x32_bf16 v[44:47], v[32:35], v[116:119], v[44:47]
s_mov_b32 s60, 0x01000100
v_perm_b32 v192, v19, v19, s60
v_and_b32 v28, v192, v4
v_and_b32 v29, v192, v5
v_and_b32 v30, v192, v6
v_and_b32 v31, v192, v7
s_waitcnt vmcnt(63)
s_nop 0
v_mfma_f32_16x16x32_bf16 v[44:47], v[28:31], v[120:123], v[44:47]
s_mov_b32 s60, 0x03020302
v_perm_b32 v193, v19, v19, s60
v_and_b32 v32, v193, v4
v_and_b32 v33, v193, v5
v_and_b32 v34, v193, v6
v_and_b32 v35, v193, v7
s_waitcnt vmcnt(63)
s_nop 0
v_mfma_f32_16x16x32_bf16 v[44:47], v[32:35], v[124:127], v[44:47]
v_lshrrev_b32 v192, 1, v3
v_lshlrev_b32 v192, 9, v192
v_lshl_add_u32 v192, v2, 5, v192
v_and_b32 v193, 1, v3
v_lshl_add_u32 v192, v193, 4, v192
s_lshl_b32 s63, s34, 10
v_add_u32 v192, s63, v192
s_nop 1
s_nop 5
ds_write_b128 v192, v[44:47] offset:9216
s_waitcnt lgkmcnt(0)
s_barrier
v_lshrrev_b32 v192, 3, v2
v_lshlrev_b32 v192, 9, v192
v_lshl_add_u32 v192, v3, 4, v192
s_lshl_b32 s62, s34, 6
v_add_u32 v192, s62, v192
ds_read_b128 v[200:203], v192 offset:9216
ds_read_b128 v[204:207], v192 offset:10240
ds_read_b128 v[208:211], v192 offset:11264
ds_read_b128 v[212:215], v192 offset:12288
ds_read_b128 v[216:219], v192 offset:13312
ds_read_b128 v[220:223], v192 offset:14336
ds_read_b128 v[224:227], v192 offset:15360
ds_read_b128 v[228:231], v192 offset:16384
s_waitcnt lgkmcnt(6)
v_add_f32 v200, v200, v204
v_add_f32 v201, v201, v205
v_add_f32 v202, v202, v206
v_add_f32 v203, v203, v207
s_waitcnt lgkmcnt(5)
v_add_f32 v200, v200, v208
v_add_f32 v201, v201, v209
v_add_f32 v202, v202, v210
v_add_f32 v203, v203, v211
s_waitcnt lgkmcnt(4)
v_add_f32 v200, v200, v212
v_add_f32 v201, v201, v213
v_add_f32 v202, v202, v214
v_add_f32 v203, v203, v215
s_waitcnt lgkmcnt(3)
v_add_f32 v200, v200, v216
v_add_f32 v201, v201, v217
v_add_f32 v202, v202, v218
v_add_f32 v203, v203, v219
s_waitcnt lgkmcnt(2)
v_add_f32 v200, v200, v220
v_add_f32 v201, v201, v221
v_add_f32 v202, v202, v222
v_add_f32 v203, v203, v223
s_waitcnt lgkmcnt(1)
v_add_f32 v200, v200, v224
v_add_f32 v201, v201, v225
v_add_f32 v202, v202, v226
v_add_f32 v203, v203, v227
s_waitcnt lgkmcnt(0)
v_add_f32 v200, v200, v228
v_add_f32 v201, v201, v229
v_add_f32 v202, v202, v230
v_add_f32 v203, v203, v231
v_cvt_pk_bf16_f32 v60, v200, v200
v_cvt_pk_bf16_f32 v61, v201, v201
v_cvt_pk_bf16_f32 v62, v202, v202
v_cvt_pk_bf16_f32 v63, v203, v203
v_and_b32 v28, v60, v4
v_and_b32 v29, v60, v5
v_and_b32 v30, v60, v6
v_and_b32 v31, v60, v7
v_and_b32 v32, v61, v4
v_and_b32 v33, v61, v5
v_and_b32 v34, v61, v6
v_and_b32 v35, v61, v7
v_and_b32 v36, v62, v4
v_and_b32 v37, v62, v5
v_and_b32 v38, v62, v6
v_and_b32 v39, v62, v7
v_and_b32 v40, v63, v4
v_and_b32 v41, v63, v5
v_and_b32 v42, v63, v6
v_and_b32 v43, v63, v7
v_mfma_f32_16x16x32_bf16 v[44:47], v[28:31], v[128:131], 0
v_mfma_f32_16x16x32_bf16 v[48:51], v[28:31], v[132:135], 0
v_mfma_f32_16x16x32_bf16 v[52:55], v[28:31], v[136:139], 0
v_mfma_f32_16x16x32_bf16 v[56:59], v[28:31], v[140:143], 0
v_mfma_f32_16x16x32_bf16 v[44:47], v[32:35], v[144:147], v[44:47]
v_mfma_f32_16x16x32_bf16 v[48:51], v[32:35], v[148:151], v[48:51]
v_mfma_f32_16x16x32_bf16 v[52:55], v[32:35], v[152:155], v[52:55]
v_mfma_f32_16x16x32_bf16 v[56:59], v[32:35], v[156:159], v[56:59]
v_mfma_f32_16x16x32_bf16 v[44:47], v[36:39], v[160:163], v[44:47]
v_mfma_f32_16x16x32_bf16 v[48:51], v[36:39], v[164:167], v[48:51]
v_mfma_f32_16x16x32_bf16 v[52:55], v[36:39], v[168:171], v[52:55]
v_mfma_f32_16x16x32_bf16 v[56:59], v[36:39], v[172:175], v[56:59]
v_mfma_f32_16x16x32_bf16 v[44:47], v[40:43], v[176:179], v[44:47]
v_mfma_f32_16x16x32_bf16 v[48:51], v[40:43], v[180:183], v[48:51]
v_mfma_f32_16x16x32_bf16 v[52:55], v[40:43], v[184:187], v[52:55]
v_mfma_f32_16x16x32_bf16 v[56:59], v[40:43], v[188:191], v[56:59]
v_lshrrev_b32 v192, 1, v3
v_lshlrev_b32 v192, 11, v192
v_lshl_add_u32 v192, v2, 5, v192
v_and_b32 v193, 1, v3
v_lshl_add_u32 v192, v193, 4, v192
s_lshl_b32 s63, s34, 12
v_add_u32 v192, s63, v192
s_nop 1
ds_write_b128 v192, v[44:47] offset:18432
ds_write_b128 v192, v[48:51] offset:18944
ds_write_b128 v192, v[52:55] offset:19456
s_nop 5
ds_write_b128 v192, v[56:59] offset:19968
s_waitcnt lgkmcnt(0)
s_barrier
s_cmp_ge_u32 s34, 4
s_cbranch_scc1 L_W_yskip
v_lshlrev_b32 v192, 4, v0
ds_read_b128 v[200:203], v192 offset:18432
ds_read_b128 v[204:207], v192 offset:22528
ds_read_b128 v[208:211], v192 offset:26624
ds_read_b128 v[212:215], v192 offset:30720
ds_read_b128 v[216:219], v192 offset:34816
ds_read_b128 v[220:223], v192 offset:38912
ds_read_b128 v[224:227], v192 offset:43008
ds_read_b128 v[228:231], v192 offset:47104
v_bfe_u32 v193, v0, 7, 1
v_lshlrev_b32 v193, 16, v193
v_and_b32 v194, 127, v0
v_lshl_add_u32 v193, v194, 4, v193
s_lshl_b32 s63, s32, 11
s_add_u32 s63, s63, 0x20000
v_add_u32 v193, s63, v193
v_mov_b32 v194, 0xffffff00
s_waitcnt lgkmcnt(6)
v_add_f32 v200, v200, v204
v_add_f32 v201, v201, v205
v_add_f32 v202, v202, v206
v_add_f32 v203, v203, v207
s_waitcnt lgkmcnt(5)
v_add_f32 v200, v200, v208
v_add_f32 v201, v201, v209
v_add_f32 v202, v202, v210
v_add_f32 v203, v203, v211
s_waitcnt lgkmcnt(4)
v_add_f32 v200, v200, v212
v_add_f32 v201, v201, v213
v_add_f32 v202, v202, v214
v_add_f32 v203, v203, v215
s_waitcnt lgkmcnt(3)
v_add_f32 v200, v200, v216
v_add_f32 v201, v201, v217
v_add_f32 v202, v202, v218
v_add_f32 v203, v203, v219
s_waitcnt lgkmcnt(2)
v_add_f32 v200, v200, v220
v_add_f32 v201, v201, v221
v_add_f32 v202, v202, v222
v_add_f32 v203, v203, v223
s_waitcnt lgkmcnt(1)
v_add_f32 v200, v200, v224
v_add_f32 v201, v201, v225
v_add_f32 v202, v202, v226
v_add_f32 v203, v203, v227
s_waitcnt lgkmcnt(0)
v_add_f32 v200, v200, v228
v_add_f32 v201, v201, v229
v_add_f32 v202, v202, v230
v_add_f32 v203, v203, v231
v_add_u32 v200, 0x80, v200
v_add_u32 v201, 0x80, v201
v_add_u32 v202, 0x80, v202
v_add_u32 v203, 0x80, v203
v_and_or_b32 v200, v200, v194, s76
v_and_or_b32 v201, v201, v194, s77
v_and_or_b32 v202, v202, v194, s78
v_and_or_b32 v203, v203, v194, s79
s_cmp_lg_u32 s37, 0
s_cbranch_scc1 L_W_yskip
buffer_store_dwordx4 v[200:203], v193, s[52:55], 0 offen sc1
L_W_yskip:
s_cmp_lg_u32 s34, 4
s_cbranch_scc1 L_W_fin
s_mov_b32 s64, s37
s_mov_b32 s66, 0x4000
s_mov_b32 s67, 0x8000
s_mov_b32 s65, 0xc000
buffer_load_dwordx4 v[12:15], v9, s[52:55], 0 offen sc1
buffer_load_dwordx4 v[16:19], v9, s[52:55], s66 offen sc1
buffer_load_dwordx4 v[20:23], v9, s[52:55], s67 offen sc1
buffer_load_dwordx4 v[24:27], v9, s[52:55], s65 offen sc1
L_ps_Wf:
s_waitcnt vmcnt(3)
v_xor_b32 v200, s76, v12
v_xor_b32 v201, s77, v13
v_xor_b32 v202, s78, v14
v_xor_b32 v203, s79, v15
v_or_b32 v192, v200, v201
v_or3_b32 v192, v192, v202, v203
s_waitcnt vmcnt(2)
v_xor_b32 v204, s76, v16
v_xor_b32 v205, s77, v17
v_xor_b32 v206, s78, v18
v_xor_b32 v207, s79, v19
v_or3_b32 v192, v192, v204, v205
v_or3_b32 v192, v192, v206, v207
v_add_f32 v200, v200, v204
v_add_f32 v201, v201, v205
v_add_f32 v202, v202, v206
v_add_f32 v203, v203, v207
s_waitcnt vmcnt(1)
v_xor_b32 v204, s76, v20
v_xor_b32 v205, s77, v21
v_xor_b32 v206, s78, v22
v_xor_b32 v207, s79, v23
v_or3_b32 v192, v192, v204, v205
v_or3_b32 v192, v192, v206, v207
v_add_f32 v200, v200, v204
v_add_f32 v201, v201, v205
v_add_f32 v202, v202, v206
v_add_f32 v203, v203, v207
s_waitcnt vmcnt(0)
v_xor_b32 v204, s76, v24
v_xor_b32 v205, s77, v25
v_xor_b32 v206, s78, v26
v_xor_b32 v207, s79, v27
v_or3_b32 v192, v192, v204, v205
v_or3_b32 v192, v192, v206, v207
v_add_f32 v200, v200, v204
v_add_f32 v201, v201, v205
v_add_f32 v202, v202, v206
v_add_f32 v203, v203, v207
v_and_b32 v192, 0xff, v192
v_cmp_ne_u32 vcc, 0, v192
v_add_f32_dpp v200, v200, v200 row_ror:8 row_mask:0xf bank_mask:0xf
v_add_f32_dpp v201, v201, v201 row_ror:8 row_mask:0xf bank_mask:0xf
v_add_f32_dpp v202, v202, v202 row_ror:8 row_mask:0xf bank_mask:0xf
v_add_f32_dpp v203, v203, v203 row_ror:8 row_mask:0xf bank_mask:0xf
s_cmp_eq_u64 vcc, 0
s_cbranch_scc1 L_pe_Wf
s_sleep 2
buffer_load_dwordx4 v[12:15], v9, s[52:55], 0 offen sc1
buffer_load_dwordx4 v[16:19], v9, s[52:55], s66 offen sc1
buffer_load_dwordx4 v[20:23], v9, s[52:55], s67 offen sc1
buffer_load_dwordx4 v[24:27], v9, s[52:55], s65 offen sc1
s_add_u32 s64, s64, 1
s_cmp_lt_u32 s64, 65536
s_cbranch_scc1 L_ps_Wf
L_pe_Wf:
v_add_f32_dpp v200, v200, v200 row_ror:4 row_mask:0xf bank_mask:0xf
v_add_f32_dpp v201, v201, v201 row_ror:4 row_mask:0xf bank_mask:0xf
v_add_f32_dpp v202, v202, v202 row_ror:4 row_mask:0xf bank_mask:0xf
v_add_f32_dpp v203, v203, v203 row_ror:4 row_mask:0xf bank_mask:0xf
v_mov_b32 v192, v200
v_mov_b32 v193, v201
v_mov_b32 v194, v202
v_mov_b32 v195, v203
v_permlane16_swap_b32 v200, v192
v_permlane16_swap_b32 v201, v193
v_permlane16_swap_b32 v202, v194
v_permlane16_swap_b32 v203, v195
v_add_f32 v200, v200, v192
v_add_f32 v201, v201, v193
v_add_f32 v202, v202, v194
v_add_f32 v203, v203, v195
v_cvt_pk_bf16_f32 v200, v200, v201
v_cvt_pk_bf16_f32 v201, v202, v203
s_cmp_lg_u32 s37, 0
s_cbranch_scc1 L_W_fin
s_mov_b32 exec_lo, 15
s_mov_b32 exec_hi, 15
global_store_dwordx2 v10, v[200:201], s[26:27]
s_mov_b64 exec, -1
L_W_fin:
s_cmp_eq_u32 s37, 0
s_cbranch_scc1 L_W_end
s_mov_b32 s37, 0
s_waitcnt vmcnt(0)
s_branch L_W_poll
L_W_end:
s_endpgm
L_roleC:
v_and_b32 v1, 63, v0
s_xor_b32 s32, s82, 5
s_waitcnt lgkmcnt(0)
s_lshl_b32 s60, s32, 8
s_sub_u32 s61, 0x400000, s60
s_add_u32 s68, s10, s60
s_addc_u32 s69, s11, 0
s_and_b32 s69, s69, 0xffff
s_mov_b32 s70, s61
s_mov_b32 s71, 0x20000
s_mov_b32 s72, s4
s_and_b32 s73, s5, 0xffff
s_mov_b32 s74, 0x800
s_mov_b32 s75, 0x20000
v_lshrrev_b32 v240, 3, v2
v_lshlrev_b32 v240, 10, v240
v_lshl_add_u32 v240, v3, 5, v240
s_lshl_b32 s62, s34, 7
v_add_u32 v240, s62, v240
s_mov_b32 s80, 0
buffer_load_dwordx4 v[32:35], v240, s[72:75], 0 offen
buffer_load_dwordx4 v[36:39], v240, s[72:75], 0 offen offset:16
v_lshlrev_b32 v9, 17, v3
v_lshl_add_u32 v9, v2, 4, v9
s_lshl_b32 s62, s34, 19
v_add_u32 v9, s62, v9
s_xor_b32 s62, s80, 0
buffer_load_dwordx4 v[128:131], v9, s[68:71], s62 offen nt
s_xor_b32 s62, s80, 8192
buffer_load_dwordx4 v[132:135], v9, s[68:71], s62 offen nt
s_xor_b32 s62, s80, 16384
buffer_load_dwordx4 v[136:139], v9, s[68:71], s62 offen nt
s_xor_b32 s62, s80, 24576
buffer_load_dwordx4 v[140:143], v9, s[68:71], s62 offen nt
s_xor_b32 s62, s80, 32768
buffer_load_dwordx4 v[144:147], v9, s[68:71], s62 offen nt
s_xor_b32 s62, s80, 40960
buffer_load_dwordx4 v[148:151], v9, s[68:71], s62 offen nt
s_xor_b32 s62, s80, 49152
buffer_load_dwordx4 v[152:155], v9, s[68:71], s62 offen nt
s_xor_b32 s62, s80, 57344
buffer_load_dwordx4 v[156:159], v9, s[68:71], s62 offen nt
s_xor_b32 s62, s80, 65536
buffer_load_dwordx4 v[160:163], v9, s[68:71], s62 offen nt
s_xor_b32 s62, s80, 73728
buffer_load_dwordx4 v[164:167], v9, s[68:71], s62 offen nt
s_xor_b32 s62, s80, 81920
buffer_load_dwordx4 v[168:171], v9, s[68:71], s62 offen nt
s_xor_b32 s62, s80, 90112
buffer_load_dwordx4 v[172:175], v9, s[68:71], s62 offen nt
s_xor_b32 s62, s80, 98304
buffer_load_dwordx4 v[176:179], v9, s[68:71], s62 offen nt
s_xor_b32 s62, s80, 106496
buffer_load_dwordx4 v[180:183], v9, s[68:71], s62 offen nt
s_xor_b32 s62, s80, 114688
buffer_load_dwordx4 v[184:187], v9, s[68:71], s62 offen nt
s_xor_b32 s62, s80, 122880
buffer_load_dwordx4 v[188:191], v9, s[68:71], s62 offen nt
s_load_dword s58, s[30:31], 0x14000
s_mov_b32 s44, s30
s_and_b32 s45, s31, 0xffff
s_mov_b32 s46, 0x1000000
s_mov_b32 s47, 0x20000
s_cmp_lg_u32 s34, 6
s_cbranch_scc1 L_C_ctr
v_mov_b32 v192, -1
s_lshl_b32 s62, s32, 13
s_add_u32 s62, s62, 0x61800
v_lshl_add_u32 v240, v1, 7, s62
s_mov_b64 exec, 1
buffer_store_dword v192, v240, s[44:47], 0 offen sc1
buffer_store_dword v192, v240, s[44:47], 0 offen offset:1024 sc1
s_mov_b64 exec, -1
L_C_ctr:
v_and_b32 v242, 1, v0
v_lshlrev_b32 v242, 4, v242
v_mov_b32 v243, 0xffff
v_lshlrev_b32 v242, v242, v243
v_bfe_u32 v243, v0, 1, 2
v_cmp_eq_u32 vcc, 0, v243
s_nop 1
v_cndmask_b32 v4, 0, v242, vcc
v_cmp_eq_u32 vcc, 1, v243
s_nop 1
v_cndmask_b32 v5, 0, v242, vcc
v_cmp_eq_u32 vcc, 2, v243
s_nop 1
v_cndmask_b32 v6, 0, v242, vcc
v_cmp_eq_u32 vcc, 3, v243
s_nop 1
v_cndmask_b32 v7, 0, v242, vcc
v_mov_b32 v8, 0
s_lshr_b32 s35, s32, 4
s_lshr_b32 s36, s34, 1
s_and_b32 s37, s34, 1
s_lshr_b32 s60, s32, 0
s_lshl_b32 s60, s60, 19
s_mov_b32 s61, 0x80000
s_add_u32 s40, s16, s60
s_addc_u32 s41, s17, 0
s_and_b32 s41, s41, 0xffff
s_mov_b32 s42, s61
s_mov_b32 s43, 0x20000
v_lshrrev_b32 v242, 1, v3
v_lshlrev_b32 v242, 9, v242
v_lshl_add_u32 v242, v2, 5, v242
v_and_b32 v243, 1, v3
v_lshl_add_u32 v242, v243, 4, v242
s_lshl_b32 s63, s34, 10
v_add_u32 v242, s63, v242
v_add_u32 v242, 140288, v242
v_lshlrev_b32 v243, 4, v1
s_lshl_b32 s62, s32, 10
s_add_u32 s62, s62, 0x18000
v_add_u32 v244, s62, v243
v_add_u32 v243, 140288, v243
s_waitcnt vmcnt(16) lgkmcnt(0)
s_add_u32 s58, s58, 0x9e3779b9
s_bfe_u32 s76, s58, 0x80000
s_bfe_u32 s77, s58, 0x80008
s_bfe_u32 s78, s58, 0x80010
s_bfe_u32 s79, s58, 0x80018
v_mov_b32 v245, s58
s_mov_b32 s60, 0x01000100
v_perm_b32 v240, v32, v32, s60
v_and_b32 v40, v240, v4
v_and_b32 v41, v240, v5
v_and_b32 v42, v240, v6
v_and_b32 v43, v240, v7
s_waitcnt vmcnt(15)
s_nop 0
v_mfma_f32_16x16x32_bf16 v[48:51], v[40:43], v[128:131], 0
s_mov_b32 s60, 0x03020302
v_perm_b32 v241, v32, v32, s60
v_and_b32 v44, v241, v4
v_and_b32 v45, v241, v5
v_and_b32 v46, v241, v6
v_and_b32 v47, v241, v7
s_waitcnt vmcnt(14)
s_nop 0
v_mfma_f32_16x16x32_bf16 v[48:51], v[44:47], v[132:135], v[48:51]
s_mov_b32 s60, 0x01000100
v_perm_b32 v240, v33, v33, s60
v_and_b32 v40, v240, v4
v_and_b32 v41, v240, v5
v_and_b32 v42, v240, v6
v_and_b32 v43, v240, v7
s_waitcnt vmcnt(13)
s_nop 0
v_mfma_f32_16x16x32_bf16 v[48:51], v[40:43], v[136:139], v[48:51]
s_mov_b32 s60, 0x03020302
v_perm_b32 v241, v33, v33, s60
v_and_b32 v44, v241, v4
v_and_b32 v45, v241, v5
v_and_b32 v46, v241, v6
v_and_b32 v47, v241, v7
s_waitcnt vmcnt(12)
s_nop 0
v_mfma_f32_16x16x32_bf16 v[48:51], v[44:47], v[140:143], v[48:51]
s_mov_b32 s60, 0x01000100
v_perm_b32 v240, v34, v34, s60
v_and_b32 v40, v240, v4
v_and_b32 v41, v240, v5
v_and_b32 v42, v240, v6
v_and_b32 v43, v240, v7
s_waitcnt vmcnt(11)
s_nop 0
v_mfma_f32_16x16x32_bf16 v[48:51], v[40:43], v[144:147], v[48:51]
s_mov_b32 s60, 0x03020302
v_perm_b32 v241, v34, v34, s60
v_and_b32 v44, v241, v4
v_and_b32 v45, v241, v5
v_and_b32 v46, v241, v6
v_and_b32 v47, v241, v7
s_waitcnt vmcnt(10)
s_nop 0
v_mfma_f32_16x16x32_bf16 v[48:51], v[44:47], v[148:151], v[48:51]
s_mov_b32 s60, 0x01000100
v_perm_b32 v240, v35, v35, s60
v_and_b32 v40, v240, v4
v_and_b32 v41, v240, v5
v_and_b32 v42, v240, v6
v_and_b32 v43, v240, v7
s_waitcnt vmcnt(9)
s_nop 0
v_mfma_f32_16x16x32_bf16 v[48:51], v[40:43], v[152:155], v[48:51]
s_mov_b32 s60, 0x03020302
v_perm_b32 v241, v35, v35, s60
v_and_b32 v44, v241, v4
v_and_b32 v45, v241, v5
v_and_b32 v46, v241, v6
v_and_b32 v47, v241, v7
s_waitcnt vmcnt(8)
s_nop 0
v_mfma_f32_16x16x32_bf16 v[48:51], v[44:47], v[156:159], v[48:51]
s_mov_b32 s60, 0x01000100
v_perm_b32 v240, v36, v36, s60
v_and_b32 v40, v240, v4
v_and_b32 v41, v240, v5
v_and_b32 v42, v240, v6
v_and_b32 v43, v240, v7
s_waitcnt vmcnt(7)
s_nop 0
v_mfma_f32_16x16x32_bf16 v[48:51], v[40:43], v[160:163], v[48:51]
s_mov_b32 s60, 0x03020302
v_perm_b32 v241, v36, v36, s60
v_and_b32 v44, v241, v4
v_and_b32 v45, v241, v5
v_and_b32 v46, v241, v6
v_and_b32 v47, v241, v7
s_waitcnt vmcnt(6)
s_nop 0
v_mfma_f32_16x16x32_bf16 v[48:51], v[44:47], v[164:167], v[48:51]
s_mov_b32 s60, 0x01000100
v_perm_b32 v240, v37, v37, s60
v_and_b32 v40, v240, v4
v_and_b32 v41, v240, v5
v_and_b32 v42, v240, v6
v_and_b32 v43, v240, v7
s_waitcnt vmcnt(5)
s_nop 0
v_mfma_f32_16x16x32_bf16 v[48:51], v[40:43], v[168:171], v[48:51]
s_mov_b32 s60, 0x03020302
v_perm_b32 v241, v37, v37, s60
v_and_b32 v44, v241, v4
v_and_b32 v45, v241, v5
v_and_b32 v46, v241, v6
v_and_b32 v47, v241, v7
s_waitcnt vmcnt(4)
s_nop 0
v_mfma_f32_16x16x32_bf16 v[48:51], v[44:47], v[172:175], v[48:51]
s_mov_b32 s60, 0x01000100
v_perm_b32 v240, v38, v38, s60
v_and_b32 v40, v240, v4
v_and_b32 v41, v240, v5
v_and_b32 v42, v240, v6
v_and_b32 v43, v240, v7
s_waitcnt vmcnt(3)
s_nop 0
v_mfma_f32_16x16x32_bf16 v[48:51], v[40:43], v[176:179], v[48:51]
s_mov_b32 s60, 0x03020302
v_perm_b32 v241, v38, v38, s60
v_and_b32 v44, v241, v4
v_and_b32 v45, v241, v5
v_and_b32 v46, v241, v6
v_and_b32 v47, v241, v7
s_waitcnt vmcnt(2)
s_nop 0
v_mfma_f32_16x16x32_bf16 v[48:51], v[44:47], v[180:183], v[48:51]
s_mov_b32 s60, 0x01000100
v_perm_b32 v240, v39, v39, s60
v_and_b32 v40, v240, v4
v_and_b32 v41, v240, v5
v_and_b32 v42, v240, v6
v_and_b32 v43, v240, v7
s_waitcnt vmcnt(1)
s_nop 0
v_mfma_f32_16x16x32_bf16 v[48:51], v[40:43], v[184:187], v[48:51]
s_mov_b32 s60, 0x03020302
v_perm_b32 v241, v39, v39, s60
v_and_b32 v44, v241, v4
v_and_b32 v45, v241, v5
v_and_b32 v46, v241, v6
v_and_b32 v47, v241, v7
s_waitcnt vmcnt(0)
s_nop 0
v_mfma_f32_16x16x32_bf16 v[48:51], v[44:47], v[188:191], v[48:51]
s_nop 7
ds_write_b128 v242, v[48:51]
s_waitcnt lgkmcnt(0)
s_barrier
s_cmp_lg_u32 s34, 0
s_cbranch_scc1 L_C_qs
ds_read_b128 v[128:131], v243 offset:0
ds_read_b128 v[132:135], v243 offset:1024
ds_read_b128 v[136:139], v243 offset:2048
ds_read_b128 v[140:143], v243 offset:3072
ds_read_b128 v[144:147], v243 offset:4096
ds_read_b128 v[148:151], v243 offset:5120
ds_read_b128 v[152:155], v243 offset:6144
ds_read_b128 v[156:159], v243 offset:7168
s_mov_b32 s60, 0x05040100
s_mov_b32 s61, 0x07060302
s_waitcnt lgkmcnt(6)
v_add_f32 v128, v128, v132
v_add_f32 v129, v129, v133
v_add_f32 v130, v130, v134
v_add_f32 v131, v131, v135
s_waitcnt lgkmcnt(5)
v_add_f32 v128, v128, v136
v_add_f32 v129, v129, v137
v_add_f32 v130, v130, v138
v_add_f32 v131, v131, v139
s_waitcnt lgkmcnt(4)
v_add_f32 v128, v128, v140
v_add_f32 v129, v129, v141
v_add_f32 v130, v130, v142
v_add_f32 v131, v131, v143
s_waitcnt lgkmcnt(3)
v_add_f32 v128, v128, v144
v_add_f32 v129, v129, v145
v_add_f32 v130, v130, v146
v_add_f32 v131, v131, v147
s_waitcnt lgkmcnt(2)
v_add_f32 v128, v128, v148
v_add_f32 v129, v129, v149
v_add_f32 v130, v130, v150
v_add_f32 v131, v131, v151
s_waitcnt lgkmcnt(1)
v_add_f32 v128, v128, v152
v_add_f32 v129, v129, v153
v_add_f32 v130, v130, v154
v_add_f32 v131, v131, v155
s_waitcnt lgkmcnt(0)
v_add_f32 v128, v128, v156
v_add_f32 v129, v129, v157
v_add_f32 v130, v130, v158
v_add_f32 v131, v131, v159
v_cvt_pk_bf16_f32 v128, v128, v129
v_cvt_pk_bf16_f32 v129, v130, v131
v_perm_b32 v132, v128, v245, s60
v_perm_b32 v133, v128, v245, s61
v_perm_b32 v134, v129, v245, s60
v_perm_b32 v135, v129, v245, s61
buffer_store_dwordx4 v[132:135], v244, s[44:47], 0 offen sc1
L_C_qs:
v_lshlrev_b32 v9, 4, v1
s_mul_i32 s62, s34, 4096
v_add_u32 v9, s62, v9
s_mul_i32 s38, s34, 4224
s_and_b32 s54, s32, 3
s_lshl_b32 s54, s54, 17
s_mov_b32 s53, 0
s_lshl_b32 s60, s32, 17
s_mov_b32 s61, 0x20000
s_add_u32 s68, s12, s60
s_addc_u32 s69, s13, 0
s_and_b32 s69, s69, 0xffff
s_mov_b32 s70, s61
s_mov_b32 s71, 0x20000
s_add_u32 s50, s38, 5120
s_cmp_lt_u32 s53, 0x80000
s_cselect_b32 s40, s40, s68
s_cselect_b32 s41, s41, s69
s_cselect_b32 s42, s42, s70
s_cselect_b32 s54, s54, 0
s_and_b32 s49, s53, 0x70000
s_xor_b32 s49, s49, s54
s_add_u32 s51, s49, 32768
s_add_u32 s53, s53, 0x10000
s_add_u32 m0, s50, 0
s_nop 0
buffer_load_dwordx4 v9, s[40:43], s49 offen offset:0 nt lds
s_add_u32 m0, s50, 32
s_nop 0
buffer_load_dwordx4 v9, s[40:43], s49 offen offset:1024 nt lds
s_add_u32 m0, s50, 64
s_nop 0
buffer_load_dwordx4 v9, s[40:43], s49 offen offset:2048 nt lds
s_add_u32 m0, s50, 96
s_nop 0
buffer_load_dwordx4 v9, s[40:43], s49 offen offset:3072 nt lds
s_add_u32 m0, s50, 33792
s_nop 0
buffer_load_dwordx4 v9, s[40:43], s51 offen offset:0 nt lds
s_add_u32 m0, s50, 33824
s_nop 0
buffer_load_dwordx4 v9, s[40:43], s51 offen offset:1024 nt lds
s_add_u32 m0, s50, 33856
s_nop 0
buffer_load_dwordx4 v9, s[40:43], s51 offen offset:2048 nt lds
s_add_u32 m0, s50, 33888
s_nop 0
buffer_load_dwordx4 v9, s[40:43], s51 offen offset:3072 nt lds
s_add_u32 s50, s38, 72704
s_cmp_lt_u32 s53, 0x80000
s_cselect_b32 s40, s40, s68
s_cselect_b32 s41, s41, s69
s_cselect_b32 s42, s42, s70
s_cselect_b32 s54, s54, 0
s_and_b32 s49, s53, 0x70000
s_xor_b32 s49, s49, s54
s_add_u32 s51, s49, 32768
s_add_u32 s53, s53, 0x10000
s_add_u32 m0, s50, 0
s_nop 0
buffer_load_dwordx4 v9, s[40:43], s49 offen offset:0 nt lds
s_add_u32 m0, s50, 32
s_nop 0
buffer_load_dwordx4 v9, s[40:43], s49 offen offset:1024 nt lds
s_add_u32 m0, s50, 64
s_nop 0
buffer_load_dwordx4 v9, s[40:43], s49 offen offset:2048 nt lds
s_add_u32 m0, s50, 96
s_nop 0
buffer_load_dwordx4 v9, s[40:43], s49 offen offset:3072 nt lds
s_add_u32 m0, s50, 33792
s_nop 0
buffer_load_dwordx4 v9, s[40:43], s51 offen offset:0 nt lds
s_add_u32 m0, s50, 33824
s_nop 0
buffer_load_dwordx4 v9, s[40:43], s51 offen offset:1024 nt lds
s_add_u32 m0, s50, 33856
s_nop 0
buffer_load_dwordx4 v9, s[40:43], s51 offen offset:2048 nt lds
s_add_u32 m0, s50, 33888
s_nop 0
buffer_load_dwordx4 v9, s[40:43], s51 offen offset:3072 nt lds
s_cmp_lt_u32 s53, 0x80000
s_cselect_b32 s40, s40, s68
s_cselect_b32 s41, s41, s69
s_cselect_b32 s42, s42, s70
s_cselect_b32 s54, s54, 0
s_and_b32 s49, s53, 0x70000
s_xor_b32 s49, s49, s54
s_add_u32 s51, s49, 32768
s_add_u32 s53, s53, 0x10000
buffer_load_dwordx4 v[208:211], v9, s[40:43], s49 offen offset:0 nt
buffer_load_dwordx4 v[212:215], v9, s[40:43], s49 offen offset:1024 nt
buffer_load_dwordx4 v[216:219], v9, s[40:43], s49 offen offset:2048 nt
buffer_load_dwordx4 v[220:223], v9, s[40:43], s49 offen offset:3072 nt
buffer_load_dwordx4 v[224:227], v9, s[40:43], s51 offen offset:0 nt
buffer_load_dwordx4 v[228:231], v9, s[40:43], s51 offen offset:1024 nt
buffer_load_dwordx4 v[232:235], v9, s[40:43], s51 offen offset:2048 nt
buffer_load_dwordx4 v[236:239], v9, s[40:43], s51 offen offset:3072 nt
s_add_u32 s62, s38, 5120
v_lshl_add_u32 v22, v1, 4, s62
s_lshl_b32 s62, s36, 4
v_add_u32 v240, s62, v2
v_mul_u32_u24 v10, 1056, v240
v_lshl_add_u32 v10, v3, 4, v10
v_add_u32 v10, 5120, v10
v_lshrrev_b32 v240, 1, v3
v_lshlrev_b32 v240, 3, v240
v_lshrrev_b32 v241, 2, v2
v_add_u32 v240, v240, v241
v_mul_u32_u24 v11, 1056, v240
v_and_b32 v240, 1, v3
v_lshl_add_u32 v11, v240, 5, v11
v_and_b32 v240, 3, v2
v_lshl_add_u32 v11, v240, 3, v11
s_lshl_b32 s62, s34, 7
s_add_u32 s62, s62, 5120
v_add_u32 v11, s62, v11
s_lshl_b32 s62, s37, 4
v_add_u32 v240, s62, v2
v_mul_u32_u24 v12, 144, v240
v_lshl_add_u32 v12, v3, 3, v12
s_lshl_b32 s62, s36, 5
v_add_u32 v12, s62, v12
v_lshlrev_b32 v15, 4, v240
s_lshl_b32 s62, s36, 2
v_add_u32 v14, s62, v15
v_and_b32 v240, 31, v1
v_mul_u32_u24 v13, 144, v240
v_lshrrev_b32 v241, 5, v1
v_lshl_add_u32 v13, v241, 4, v13
v_lshlrev_b32 v16, 4, v240
v_mov_b32 v17, 0x3e0293ee
v_mov_b32 v18, 0xff800000
v_mov_b32 v19, 0xff800000
v_mov_b32 v20, 0
v_mov_b32 v96, 0
v_mov_b32 v97, 0
v_mov_b32 v98, 0
v_mov_b32 v99, 0
v_mov_b32 v100, 0
v_mov_b32 v101, 0
v_mov_b32 v102, 0
v_mov_b32 v103, 0
v_mov_b32 v104, 0
v_mov_b32 v105, 0
v_mov_b32 v106, 0
v_mov_b32 v107, 0
v_mov_b32 v108, 0
v_mov_b32 v109, 0
v_mov_b32 v110, 0
v_mov_b32 v111, 0
v_mov_b32 v112, 0
v_mov_b32 v113, 0
v_mov_b32 v114, 0
v_mov_b32 v115, 0
v_mov_b32 v116, 0
v_mov_b32 v117, 0
v_mov_b32 v118, 0
v_mov_b32 v119, 0
v_mov_b32 v120, 0
v_mov_b32 v121, 0
v_mov_b32 v122, 0
v_mov_b32 v123, 0
v_mov_b32 v124, 0
v_mov_b32 v125, 0
v_mov_b32 v126, 0
v_mov_b32 v127, 0
v_lshrrev_b32 v240, 5, v1
s_lshl_b32 s62, s34, 2
v_add_u32 v240, s62, v240
v_and_b32 v241, 31, v1
v_lshlrev_b32 v241, 4, v241
v_lshl_add_u32 v242, v240, 10, v241
s_lshl_b32 s62, s35, 15
s_add_u32 s62, s62, 0x0
v_add_u32 v242, s62, v242
v_mul_u32_u24 v243, 528, v240
v_add_u32 v243, v243, v241
v_add_u32 v243, 140288, v243
s_lshl_b32 s62, s37, 4
v_add_u32 v240, s62, v2
v_mul_u32_u24 v244, 528, v240
v_lshl_add_u32 v244, v3, 4, v244
v_add_u32 v244, 140288, v244
v_lshlrev_b32 v240, 7, v1
v_add_u32 v240, 0x15000, v240
s_cmp_lg_u32 s34, 0
s_cbranch_scc1 L_wf_Cq
s_lshl_b64 exec, 1, s32
s_mov_b32 s64, 0
L_pl_Cq1:
buffer_load_dword v241, v240, s[44:47], 0 offen sc1
s_add_u32 s64, s64, 1
s_waitcnt vmcnt(0)
v_cmp_ne_u32 vcc, s58, v241
s_nop 0
s_cmp_eq_u64 vcc, 0
s_cbranch_scc1 L_pd_Cq1
s_mov_b64 exec, vcc
s_sleep 2
s_cmp_lt_u32 s64, 65536
s_cbranch_scc1 L_pl_Cq1
L_pd_Cq1:
s_mov_b32 exec_lo, -1
s_mov_b32 exec_hi, 0
s_mov_b32 s64, 0
L_pl_Cq2:
buffer_load_dword v241, v240, s[44:47], 0 offen sc1
s_add_u32 s64, s64, 1
s_waitcnt vmcnt(0)
v_cmp_ne_u32 vcc, s58, v241
s_nop 0
s_cmp_eq_u64 vcc, 0
s_cbranch_scc1 L_pd_Cq2
s_mov_b64 exec, vcc
s_cmp_lt_u32 s64, 65536
s_cbranch_scc1 L_pl_Cq2
L_pd_Cq2:
s_mov_b64 exec, -1
L_wf_Cq:
s_barrier
buffer_load_dwordx4 v[128:131], v242, s[44:47], 0 offen offset:0 sc1
buffer_load_dwordx4 v[132:135], v242, s[44:47], 0 offen offset:2048 sc1
buffer_load_dwordx4 v[136:139], v242, s[44:47], 0 offen offset:512 sc1
buffer_load_dwordx4 v[140:143], v242, s[44:47], 0 offen offset:2560 sc1
s_waitcnt vmcnt(2)
ds_write_b128 v243, v[128:131] offset:0
ds_write_b128 v243, v[132:135] offset:1056
s_waitcnt lgkmcnt(0)
s_barrier
ds_read_b128 v[32:35], v244 offset:0
ds_read_b128 v[36:39], v244 offset:64
ds_read_b128 v[40:43], v244 offset:128
ds_read_b128 v[44:47], v244 offset:192
ds_read_b128 v[48:51], v244 offset:256
ds_read_b128 v[52:55], v244 offset:320
ds_read_b128 v[56:59], v244 offset:384
ds_read_b128 v[60:63], v244 offset:448
s_waitcnt vmcnt(0)
s_waitcnt lgkmcnt(0)
s_barrier
ds_write_b128 v243, v[136:139] offset:0
ds_write_b128 v243, v[140:143] offset:1056
s_waitcnt lgkmcnt(0)
s_barrier
ds_read_b128 v[64:67], v244 offset:0
ds_read_b128 v[68:71], v244 offset:64
ds_read_b128 v[72:75], v244 offset:128
ds_read_b128 v[76:79], v244 offset:192
ds_read_b128 v[80:83], v244 offset:256
ds_read_b128 v[84:87], v244 offset:320
ds_read_b128 v[88:91], v244 offset:384
ds_read_b128 v[92:95], v244 offset:448
s_mov_b32 s39, 0
s_mov_b32 s48, 0
s_waitcnt vmcnt(0)
.p2align 6
L_C_loop:
s_waitcnt lgkmcnt(0)
s_barrier
s_mov_b32 s52, 1
s_cmp_eq_u32 s39, 0
s_cselect_b32 s52, 0, s52
s_sub_u32 s50, 67584, s48
v_add_u32 v23, s50, v22
s_cmp_eq_u32 s52, 0
s_cbranch_scc1 L_C_st0
s_cmp_lt_u32 s53, 0x80000
s_cselect_b32 s40, s40, s68
s_cselect_b32 s41, s41, s69
s_cselect_b32 s42, s42, s70
s_cselect_b32 s54, s54, 0
s_and_b32 s49, s53, 0x70000
s_xor_b32 s49, s49, s54
s_add_u32 s51, s49, 32768
s_add_u32 s53, s53, 0x10000
s_waitcnt vmcnt(7)
ds_write_b128 v23, v[208:211] offset:0
buffer_load_dwordx4 v[208:211], v9, s[40:43], s49 offen offset:0 nt
s_waitcnt vmcnt(7)
ds_write_b128 v23, v[212:215] offset:1056
buffer_load_dwordx4 v[212:215], v9, s[40:43], s49 offen offset:1024 nt
s_waitcnt vmcnt(7)
ds_write_b128 v23, v[216:219] offset:2112
buffer_load_dwordx4 v[216:219], v9, s[40:43], s49 offen offset:2048 nt
s_waitcnt vmcnt(7)
ds_write_b128 v23, v[220:223] offset:3168
buffer_load_dwordx4 v[220:223], v9, s[40:43], s49 offen offset:3072 nt
s_waitcnt vmcnt(7)
ds_write_b128 v23, v[224:227] offset:33792
buffer_load_dwordx4 v[224:227], v9, s[40:43], s51 offen offset:0 nt
s_waitcnt vmcnt(7)
ds_write_b128 v23, v[228:231] offset:34848
buffer_load_dwordx4 v[228:231], v9, s[40:43], s51 offen offset:1024 nt
s_waitcnt vmcnt(7)
ds_write_b128 v23, v[232:235] offset:35904
buffer_load_dwordx4 v[232:235], v9, s[40:43], s51 offen offset:2048 nt
s_waitcnt vmcnt(7)
ds_write_b128 v23, v[236:239] offset:36960
buffer_load_dwordx4 v[236:239], v9, s[40:43], s51 offen offset:3072 nt
L_C_st0:
v_add_u32 v240, s48, v10
v_add_u32 v241, s48, v11
ds_read_b128 v[128:131], v240 offset:0
ds_read_b128 v[132:135], v240 offset:64
ds_read_b128 v[136:139], v240 offset:128
ds_read_b128 v[140:143], v240 offset:192
ds_read_b128 v[144:147], v240 offset:256
ds_read_b128 v[148:151], v240 offset:320
ds_read_b128 v[152:155], v240 offset:384
ds_read_b128 v[156:159], v240 offset:448
ds_read_b128 v[160:163], v240 offset:512
ds_read_b128 v[164:167], v240 offset:576
ds_read_b128 v[168:171], v240 offset:640
ds_read_b128 v[172:175], v240 offset:704
ds_read_b128 v[176:179], v240 offset:768
ds_read_b128 v[180:183], v240 offset:832
ds_read_b128 v[184:187], v240 offset:896
ds_read_b128 v[188:191], v240 offset:960
s_waitcnt lgkmcnt(15)
v_mfma_f32_16x16x32_bf16 v[28:31], v[128:131], v[32:35], 0
s_waitcnt lgkmcnt(14)
v_mfma_f32_16x16x32_bf16 v[28:31], v[132:135], v[36:39], v[28:31]
s_waitcnt lgkmcnt(13)
v_mfma_f32_16x16x32_bf16 v[28:31], v[136:139], v[40:43], v[28:31]
s_waitcnt lgkmcnt(12)
v_mfma_f32_16x16x32_bf16 v[28:31], v[140:143], v[44:47], v[28:31]
s_waitcnt lgkmcnt(11)
v_mfma_f32_16x16x32_bf16 v[28:31], v[144:147], v[48:51], v[28:31]
s_waitcnt lgkmcnt(10)
v_mfma_f32_16x16x32_bf16 v[28:31], v[148:151], v[52:55], v[28:31]
s_waitcnt lgkmcnt(9)
v_mfma_f32_16x16x32_bf16 v[28:31], v[152:155], v[56:59], v[28:31]
s_waitcnt lgkmcnt(8)
v_mfma_f32_16x16x32_bf16 v[28:31], v[156:159], v[60:63], v[28:31]
s_waitcnt lgkmcnt(7)
v_mfma_f32_16x16x32_bf16 v[28:31], v[160:163], v[64:67], v[28:31]
s_waitcnt lgkmcnt(6)
v_mfma_f32_16x16x32_bf16 v[28:31], v[164:167], v[68:71], v[28:31]
s_waitcnt lgkmcnt(5)
v_mfma_f32_16x16x32_bf16 v[28:31], v[168:171], v[72:75], v[28:31]
s_waitcnt lgkmcnt(4)
v_mfma_f32_16x16x32_bf16 v[28:31], v[172:175], v[76:79], v[28:31]
s_waitcnt lgkmcnt(3)
v_mfma_f32_16x16x32_bf16 v[28:31], v[176:179], v[80:83], v[28:31]
s_waitcnt lgkmcnt(2)
v_mfma_f32_16x16x32_bf16 v[28:31], v[180:183], v[84:87], v[28:31]
s_waitcnt lgkmcnt(1)
v_mfma_f32_16x16x32_bf16 v[28:31], v[184:187], v[88:91], v[28:31]
s_waitcnt lgkmcnt(0)
v_mfma_f32_16x16x32_bf16 v[28:31], v[188:191], v[92:95], v[28:31]
s_nop 7
v_mul_f32 v24, v28, v17
v_mul_f32 v25, v29, v17
v_mul_f32 v26, v30, v17
v_mul_f32 v27, v31, v17
v_max3_f32 v242, v24, v25, v26
v_max_f32 v242, v242, v27
v_mov_b32 v243, v242
s_nop 1
v_permlane16_swap_b32 v242, v243
s_nop 0
v_max_f32 v242, v242, v243
v_mov_b32 v243, v242
s_nop 1
v_permlane32_swap_b32 v242, v243
s_nop 0
v_max_f32 v242, v242, v243
s_mov_b64 exec, 0xffff
ds_write_b32 v14, v242 offset:0
s_mov_b64 exec, -1
s_waitcnt lgkmcnt(0)
s_barrier
ds_read_b128 v[192:195], v15 offset:0
ds_read_b128 v[196:199], v16 offset:0
s_waitcnt lgkmcnt(1)
v_max3_f32 v242, v192, v193, v194
v_max3_f32 v242, v242, v195, v18
v_sub_f32 v21, v18, v242
v_sub_f32 v24, v24, v242
v_sub_f32 v25, v25, v242
v_sub_f32 v26, v26, v242
v_sub_f32 v27, v27, v242
v_exp_f32 v21, v21
v_exp_f32 v24, v24
v_exp_f32 v25, v25
v_exp_f32 v26, v26
v_exp_f32 v27, v27
v_mov_b32 v18, v242
v_cvt_pk_bf16_f32 v244, v24, v25
v_cvt_pk_bf16_f32 v245, v26, v27
ds_write_b64 v12, v[244:245] offset:512
v_add_f32 v24, v24, v25
v_add_f32 v26, v26, v27
v_fma_f32 v20, v20, v21, v24
v_add_f32 v20, v20, v26
s_waitcnt lgkmcnt(1)
v_max3_f32 v242, v196, v197, v198
v_max3_f32 v242, v242, v199, v19
v_sub_f32 v21, v19, v242
v_exp_f32 v21, v21
v_mov_b32 v19, v242
v_mul_f32 v96, v96, v21
v_mul_f32 v97, v97, v21
v_mul_f32 v98, v98, v21
v_mul_f32 v99, v99, v21
v_mul_f32 v100, v100, v21
v_mul_f32 v101, v101, v21
v_mul_f32 v102, v102, v21
v_mul_f32 v103, v103, v21
v_mul_f32 v104, v104, v21
v_mul_f32 v105, v105, v21
v_mul_f32 v106, v106, v21
v_mul_f32 v107, v107, v21
v_mul_f32 v108, v108, v21
v_mul_f32 v109, v109, v21
v_mul_f32 v110, v110, v21
v_mul_f32 v111, v111, v21
v_mul_f32 v112, v112, v21
v_mul_f32 v113, v113, v21
v_mul_f32 v114, v114, v21
v_mul_f32 v115, v115, v21
v_mul_f32 v116, v116, v21
v_mul_f32 v117, v117, v21
v_mul_f32 v118, v118, v21
v_mul_f32 v119, v119, v21
v_mul_f32 v120, v120, v21
v_mul_f32 v121, v121, v21
v_mul_f32 v122, v122, v21
v_mul_f32 v123, v123, v21
v_mul_f32 v124, v124, v21
v_mul_f32 v125, v125, v21
v_mul_f32 v126, v126, v21
v_mul_f32 v127, v127, v21
s_waitcnt lgkmcnt(0)
s_barrier
ds_read_b128 v[192:195], v13 offset:512
ds_read_b128 v[196:199], v13 offset:544
ds_read_b128 v[200:203], v13 offset:576
ds_read_b128 v[204:207], v13 offset:608
ds_read_b64_tr_b16 v[128:129], v241 offset:0
ds_read_b64_tr_b16 v[130:131], v241 offset:4224
ds_read_b64_tr_b16 v[132:133], v241 offset:64
ds_read_b64_tr_b16 v[134:135], v241 offset:4288
ds_read_b64_tr_b16 v[136:137], v241 offset:16896
ds_read_b64_tr_b16 v[138:139], v241 offset:21120
ds_read_b64_tr_b16 v[140:141], v241 offset:16960
ds_read_b64_tr_b16 v[142:143], v241 offset:21184
ds_read_b64_tr_b16 v[144:145], v241 offset:33792
ds_read_b64_tr_b16 v[146:147], v241 offset:38016
ds_read_b64_tr_b16 v[148:149], v241 offset:33856
ds_read_b64_tr_b16 v[150:151], v241 offset:38080
ds_read_b64_tr_b16 v[152:153], v241 offset:50688
ds_read_b64_tr_b16 v[154:155], v241 offset:54912
ds_read_b64_tr_b16 v[156:157], v241 offset:50752
ds_read_b64_tr_b16 v[158:159], v241 offset:54976
s_waitcnt lgkmcnt(12)
v_mfma_f32_32x32x16_bf16 v[96:111], v[128:131], v[192:195], v[96:111]
v_mfma_f32_32x32x16_bf16 v[112:127], v[132:135], v[192:195], v[112:127]
s_waitcnt lgkmcnt(8)
v_mfma_f32_32x32x16_bf16 v[96:111], v[136:139], v[196:199], v[96:111]
v_mfma_f32_32x32x16_bf16 v[112:127], v[140:143], v[196:199], v[112:127]
s_waitcnt lgkmcnt(4)
v_mfma_f32_32x32x16_bf16 v[96:111], v[144:147], v[200:203], v[96:111]
v_mfma_f32_32x32x16_bf16 v[112:127], v[148:151], v[200:203], v[112:127]
s_waitcnt lgkmcnt(0)
v_mfma_f32_32x32x16_bf16 v[96:111], v[152:155], v[204:207], v[96:111]
v_mfma_f32_32x32x16_bf16 v[112:127], v[156:159], v[204:207], v[112:127]
s_sub_u32 s48, 67584, s48
s_add_u32 s39, s39, 1
s_cmp_lt_u32 s39, 8
s_cbranch_scc1 L_C_loop
v_mov_b32 v243, v20
s_nop 1
v_permlane16_swap_b32 v20, v243
s_nop 0
v_add_f32 v20, v20, v243
v_mov_b32 v243, v20
s_nop 1
v_permlane32_swap_b32 v20, v243
s_nop 0
v_add_f32 v20, v20, v243
s_barrier
s_mov_b64 exec, 0xffff
ds_write_b32 v14, v20 offset:0
s_mov_b64 exec, -1
v_and_b32 v240, 31, v1
v_mul_u32_u24 v240, 2064, v240
v_lshrrev_b32 v241, 5, v1
v_lshl_add_u32 v240, v241, 4, v240
s_lshl_b32 s62, s34, 8
s_add_u32 s62, s62, 72704
v_add_u32 v240, s62, v240
s_nop 5
ds_write_b128 v240, v[96:99] offset:0
ds_write_b128 v240, v[100:103] offset:32
ds_write_b128 v240, v[104:107] offset:64
ds_write_b128 v240, v[108:111] offset:96
ds_write_b128 v240, v[112:115] offset:128
ds_write_b128 v240, v[116:119] offset:160
ds_write_b128 v240, v[120:123] offset:192
ds_write_b128 v240, v[124:127] offset:224
s_waitcnt lgkmcnt(0)
s_barrier
s_mul_i32 s62, s34, 8256
s_add_u32 s62, s62, 72704
v_lshl_add_u32 v240, v1, 5, s62
ds_read_b128 v[128:131], v240 offset:0
ds_read_b128 v[132:135], v240 offset:16
ds_read_b128 v[136:139], v240 offset:2064
ds_read_b128 v[140:143], v240 offset:2080
ds_read_b128 v[144:147], v240 offset:4128
ds_read_b128 v[148:151], v240 offset:4144
ds_read_b128 v[152:155], v240 offset:6192
ds_read_b128 v[156:159], v240 offset:6208
ds_read_b128 v[192:195], v16 offset:0
s_lshl_b32 s62, s35, 5
s_lshl_b32 s63, s34, 2
s_add_u32 s62, s62, s63
s_lshl_b32 s62, s62, 4
s_and_b32 s63, s32, 15
s_add_u32 s62, s62, s63
s_lshl_b32 s62, s62, 10
s_add_u32 s62, s62, 0x200000
v_lshl_add_u32 v17, v1, 4, s62
s_lshl_b32 s63, s32, 9
s_add_u32 s63, s63, 0x10000
v_lshl_add_u32 v18, v1, 4, s63
v_mov_b32 v241, 0xffff0000
s_waitcnt lgkmcnt(0)
v_add_f32 v192, v192, v193
v_add_f32 v194, v194, v195
v_add_f32 v196, v192, v194
v_and_or_b32 v200, v19, v241, s76
v_lshl_or_b32 v201, v19, 16, s77
v_and_or_b32 v202, v196, v241, s78
v_lshl_or_b32 v203, v196, 16, s79
s_waitcnt vmcnt(0)
s_barrier
L_C_tail:
v_add_u32 v23, 67584, v22
ds_write_b128 v23, v[208:211] offset:0
ds_write_b128 v23, v[212:215] offset:1056
ds_write_b128 v23, v[216:219] offset:2112
ds_write_b128 v23, v[220:223] offset:3168
ds_write_b128 v23, v[224:227] offset:33792
ds_write_b128 v23, v[228:231] offset:34848
ds_write_b128 v23, v[232:235] offset:35904
ds_write_b128 v23, v[236:239] offset:36960
v_lshrrev_b32 v240, 2, v2
v_lshl_add_u32 v240, v3, 3, v240
v_mul_u32_u24 v240, 1056, v240
v_and_b32 v241, 3, v2
v_lshl_add_u32 v240, v241, 3, v240
s_lshl_b32 s62, s34, 7
s_add_u32 s62, s62, 5120
v_add_u32 v240, s62, v240
s_waitcnt lgkmcnt(0)
v_cvt_pk_bf16_f32 v224, v128, v129
v_cvt_pk_bf16_f32 v225, v130, v131
v_cvt_pk_bf16_f32 v226, v132, v133
v_cvt_pk_bf16_f32 v227, v134, v135
v_cvt_pk_bf16_f32 v228, v136, v137
v_cvt_pk_bf16_f32 v229, v138, v139
v_cvt_pk_bf16_f32 v230, v140, v141
v_cvt_pk_bf16_f32 v231, v142, v143
v_cvt_pk_bf16_f32 v232, v144, v145
v_cvt_pk_bf16_f32 v233, v146, v147
v_cvt_pk_bf16_f32 v234, v148, v149
v_cvt_pk_bf16_f32 v235, v150, v151
v_cvt_pk_bf16_f32 v236, v152, v153
v_cvt_pk_bf16_f32 v237, v154, v155
v_cvt_pk_bf16_f32 v238, v156, v157
v_cvt_pk_bf16_f32 v239, v158, v159
s_barrier
ds_read_b64_tr_b16 v[32:33], v240 offset:0
ds_read_b64_tr_b16 v[34:35], v240 offset:4224
ds_read_b64_tr_b16 v[36:37], v240 offset:32
ds_read_b64_tr_b16 v[38:39], v240 offset:4256
ds_read_b64_tr_b16 v[40:41], v240 offset:64
ds_read_b64_tr_b16 v[42:43], v240 offset:4288
ds_read_b64_tr_b16 v[44:45], v240 offset:96
ds_read_b64_tr_b16 v[46:47], v240 offset:4320
s_waitcnt lgkmcnt(0)
v_add_u32 v240, 33792, v240
ds_read_b64_tr_b16 v[48:49], v240 offset:0
ds_read_b64_tr_b16 v[50:51], v240 offset:4224
ds_read_b64_tr_b16 v[52:53], v240 offset:32
ds_read_b64_tr_b16 v[54:55], v240 offset:4256
ds_read_b64_tr_b16 v[56:57], v240 offset:64
ds_read_b64_tr_b16 v[58:59], v240 offset:4288
ds_read_b64_tr_b16 v[60:61], v240 offset:96
ds_read_b64_tr_b16 v[62:63], v240 offset:4320
s_waitcnt lgkmcnt(0)
v_add_u32 v240, 33792, v240
ds_read_b64_tr_b16 v[64:65], v240 offset:0
ds_read_b64_tr_b16 v[66:67], v240 offset:4224
ds_read_b64_tr_b16 v[68:69], v240 offset:32
ds_read_b64_tr_b16 v[70:71], v240 offset:4256
ds_read_b64_tr_b16 v[72:73], v240 offset:64
ds_read_b64_tr_b16 v[74:75], v240 offset:4288
ds_read_b64_tr_b16 v[76:77], v240 offset:96
ds_read_b64_tr_b16 v[78:79], v240 offset:4320
s_waitcnt lgkmcnt(0)
v_add_u32 v240, 33792, v240
ds_read_b64_tr_b16 v[80:81], v240 offset:0
ds_read_b64_tr_b16 v[82:83], v240 offset:4224
ds_read_b64_tr_b16 v[84:85], v240 offset:32
ds_read_b64_tr_b16 v[86:87], v240 offset:4256
ds_read_b64_tr_b16 v[88:89], v240 offset:64
ds_read_b64_tr_b16 v[90:91], v240 offset:4288
ds_read_b64_tr_b16 v[92:93], v240 offset:96
ds_read_b64_tr_b16 v[94:95], v240 offset:4320
s_waitcnt lgkmcnt(0)
v_bfe_u32 v10, v1, 2, 3
v_lshlrev_b32 v10, 11, v10
v_and_b32 v241, 3, v1
v_lshrrev_b32 v11, 5, v1
v_lshl_add_u32 v241, v11, 2, v241
v_lshl_add_u32 v10, v241, 4, v10
s_lshr_b32 s62, s32, 4
s_and_b32 s63, s32, 15
s_lshl_b32 s60, s62, 16
s_lshl_b32 s61, s63, 7
s_add_u32 s60, s60, s61
s_add_u32 s60, s60, 0x40000
v_add_u32 v10, s60, v10
s_lshl_b32 s60, s62, 11
s_lshl_b32 s61, s63, 6
s_add_u32 s60, s60, s61
s_add_u32 s60, s60, 0
v_lshl_add_u32 v11, v241, 3, s60
v_and_b32 v9, 7, v2
v_lshlrev_b32 v9, 10, v9
v_lshrrev_b32 v241, 3, v2
v_mul_u32_u24 v242, 512, v241
v_add_u32 v9, v9, v242
v_lshl_add_u32 v9, v3, 4, v9
s_lshl_b32 s62, s32, 13
s_add_u32 s62, s62, 0x60000
s_lshl_b32 s63, s34, 6
s_add_u32 s63, s63, s62
v_add_u32 v9, s63, v9
v_mul_u32_u24 v12, 272, v241
v_lshl_add_u32 v12, v3, 3, v12
s_lshl_b32 s62, s34, 5
v_add_u32 v12, s62, v12
v_and_b32 v241, 1, v2
v_mul_u32_u24 v13, 272, v241
v_lshl_add_u32 v13, v3, 4, v13
v_lshlrev_b32 v14, 16, v241
v_bfe_u32 v241, v2, 1, 2
v_lshl_add_u32 v14, v241, 6, v14
v_lshl_add_u32 v14, v3, 4, v14
s_lshl_b32 s62, s32, 11
s_lshl_b32 s63, s34, 8
s_add_u32 s62, s62, s63
s_add_u32 s62, s62, 0x40000
v_add_u32 v14, s62, v14
s_mov_b32 s82, 0xc0c0c0c
s_mov_b32 s83, 0xc0c0c0c
s_mov_b32 s84, 0x30303030
s_mov_b32 s85, 0x30303030
s_mov_b32 s86, 0xc0c0c0c0
s_mov_b32 s87, 0xc0c0c0c0
v_mov_b32 v15, 0xffffff00
s_mov_b32 s60, 0x0c0c0501
s_mov_b32 s61, 0x05010c0c
s_mov_b32 s53, 65536
s_branch L_C_merge
L_C_poll:
v_mov_b32 v96, 0
v_mov_b32 v97, 0
v_mov_b32 v98, 0x8000
v_mov_b32 v99, 0xff00
s_cmp_lg_u32 s34, 0
s_cbranch_scc1 L_Ch_d
s_lshl_b32 s62, s32, 13
s_add_u32 s62, s62, 0x61800
v_lshl_add_u32 v241, v1, 7, s62
s_mov_b64 exec, 1
s_mov_b32 s64, 0
L_pl_Ch:
buffer_load_dword v240, v241, s[44:47], 0 offen offset:1024 sc1
s_add_u32 s64, s64, 1
s_waitcnt vmcnt(0)
v_cmp_gt_i32 vcc, 0, v240
s_nop 0
s_cmp_eq_u64 vcc, 0
s_cbranch_scc1 L_pd_Ch
s_mov_b64 exec, vcc
s_sleep 2
s_cmp_lt_u32 s64, 65536
s_cbranch_scc1 L_pl_Ch
L_pd_Ch:
s_mov_b64 exec, -1
L_Ch_d:
s_barrier
s_mov_b32 s63, 0
buffer_store_dwordx4 v[224:227], v17, s[44:47], s63 offen sc1
s_mov_b32 s63, 16384
buffer_store_dwordx4 v[228:231], v17, s[44:47], s63 offen sc1
s_mov_b32 s63, 32768
buffer_store_dwordx4 v[232:235], v17, s[44:47], s63 offen sc1
s_mov_b32 s63, 49152
buffer_store_dwordx4 v[236:239], v17, s[44:47], s63 offen sc1
s_waitcnt vmcnt(0)
s_barrier
s_cmp_lg_u32 s34, 0
s_cbranch_scc1 L_C_nostat
s_mov_b32 exec_hi, 0
buffer_store_dwordx4 v[200:203], v18, s[44:47], 0 offen sc1
s_mov_b64 exec, -1
L_C_nostat:
s_cmp_lg_u32 s34, 0
s_cbranch_scc1 L_Cg_d
s_lshl_b32 s62, s32, 13
s_add_u32 s62, s62, 0x61800
v_lshl_add_u32 v241, v1, 7, s62
s_mov_b64 exec, 1
s_mov_b32 s64, 0
L_pl_Cg:
buffer_load_dword v240, v241, s[44:47], 0 offen offset:1024 sc1
s_add_u32 s64, s64, 1
s_waitcnt vmcnt(0)
v_cmp_gt_i32 vcc, 1, v240
s_nop 0
s_cmp_eq_u64 vcc, 0
s_cbranch_scc1 L_pd_Cg
s_mov_b64 exec, vcc
s_sleep 2
s_cmp_lt_u32 s64, 65536
s_cbranch_scc1 L_pl_Cg
L_pd_Cg:
s_mov_b64 exec, -1
L_Cg_d:
s_barrier
s_mov_b32 exec_lo, 0x3f3f3f3f
s_mov_b32 exec_hi, 0x3f3f3f3f
s_mov_b32 s64, 0
s_mov_b32 s66, 0x1000
s_mov_b32 s67, 0x2000
buffer_load_dwordx4 v[208:211], v9, s[44:47], 0 offen sc1
L_ps_Co:
s_waitcnt vmcnt(0)
v_xor_b32 v96, s76, v208
v_xor_b32 v97, s77, v209
v_xor_b32 v98, s78, v210
v_xor_b32 v99, s79, v211
v_or_b32 v240, v96, v97
v_or3_b32 v240, v240, v98, v99
v_and_b32 v240, 0xff, v240
v_cmp_ne_u32 vcc, 0, v240
s_cmp_eq_u64 vcc, 0
s_cbranch_scc1 L_pe_Co
buffer_load_dwordx4 v[208:211], v9, s[44:47], 0 offen sc1
s_add_u32 s64, s64, 1
s_cmp_lt_u32 s64, 65536
s_cbranch_scc1 L_ps_Co
L_pe_Co:
s_mov_b64 exec, -1
L_C_merge:
v_perm_b32 v100, v97, v96, s60
v_perm_b32 v101, v99, v98, s61
v_or_b32 v100, v100, v101
v_and_b32 v96, 0xffff0000, v96
v_and_b32 v97, 0xffff0000, v97
v_max_f32_dpp v101, v100, v100 quad_perm:[1,0,3,2] row_mask:0xf bank_mask:0xf
v_and_b32 v98, 0xffff0000, v98
v_and_b32 v99, 0xffff0000, v99
v_max_f32_dpp v101, v101, v101 quad_perm:[2,3,0,1] row_mask:0xf bank_mask:0xf
s_nop 1
v_max_f32_dpp v101, v101, v101 row_half_mirror row_mask:0xf bank_mask:0xf
v_sub_f32 v100, v100, v101
v_exp_f32 v100, v100
s_nop 0
v_mul_f32 v96, v96, v100
v_mul_f32 v97, v97, v100
v_mul_f32 v98, v98, v100
v_mul_f32 v99, v99, v100
v_add_f32_dpp v100, v100, v100 quad_perm:[1,0,3,2] row_mask:0xf bank_mask:0xf
v_add_f32_dpp v96, v96, v96 quad_perm:[1,0,3,2] row_mask:0xf bank_mask:0xf
v_add_f32_dpp v97, v97, v97 quad_perm:[1,0,3,2] row_mask:0xf bank_mask:0xf
v_add_f32_dpp v98, v98, v98 quad_perm:[1,0,3,2] row_mask:0xf bank_mask:0xf
v_add_f32_dpp v99, v99, v99 quad_perm:[1,0,3,2] row_mask:0xf bank_mask:0xf
v_add_f32_dpp v100, v100, v100 quad_perm:[2,3,0,1] row_mask:0xf bank_mask:0xf
v_add_f32_dpp v96, v96, v96 quad_perm:[2,3,0,1] row_mask:0xf bank_mask:0xf
v_add_f32_dpp v97, v97, v97 quad_perm:[2,3,0,1] row_mask:0xf bank_mask:0xf
v_add_f32_dpp v98, v98, v98 quad_perm:[2,3,0,1] row_mask:0xf bank_mask:0xf
v_add_f32_dpp v99, v99, v99 quad_perm:[2,3,0,1] row_mask:0xf bank_mask:0xf
v_add_f32_dpp v100, v100, v100 row_half_mirror row_mask:0xf bank_mask:0xf
v_add_f32_dpp v96, v96, v96 row_half_mirror row_mask:0xf bank_mask:0xf
v_add_f32_dpp v97, v97, v97 row_half_mirror row_mask:0xf bank_mask:0xf
v_add_f32_dpp v98, v98, v98 row_half_mirror row_mask:0xf bank_mask:0xf
v_add_f32_dpp v99, v99, v99 row_half_mirror row_mask:0xf bank_mask:0xf
v_rcp_f32 v100, v100
s_mov_b32 exec_lo, 0x01010101
s_mov_b32 exec_hi, 0x01010101
v_mul_f32 v96, v96, v100
v_mul_f32 v97, v97, v100
v_mul_f32 v98, v98, v100
v_mul_f32 v99, v99, v100
v_cvt_pk_bf16_f32 v96, v96, v97
v_cvt_pk_bf16_f32 v97, v98, v99
ds_write_b64 v12, v[96:97] offset:0
s_mov_b64 exec, -1
s_waitcnt lgkmcnt(0)
s_barrier
ds_read_b128 v[104:107], v13 offset:0
ds_read_b128 v[108:111], v13 offset:64
ds_read_b128 v[112:115], v13 offset:128
ds_read_b128 v[116:119], v13 offset:192
s_waitcnt lgkmcnt(3)
v_mfma_f32_16x16x32_bf16 v[128:131], v[32:35], v[104:107], 0
v_mfma_f32_16x16x32_bf16 v[132:135], v[36:39], v[104:107], 0
v_mfma_f32_16x16x32_bf16 v[136:139], v[40:43], v[104:107], 0
v_mfma_f32_16x16x32_bf16 v[140:143], v[44:47], v[104:107], 0
s_waitcnt lgkmcnt(2)
v_mfma_f32_16x16x32_bf16 v[128:131], v[48:51], v[108:111], v[128:131]
v_mfma_f32_16x16x32_bf16 v[132:135], v[52:55], v[108:111], v[132:135]
v_mfma_f32_16x16x32_bf16 v[136:139], v[56:59], v[108:111], v[136:139]
v_mfma_f32_16x16x32_bf16 v[140:143], v[60:63], v[108:111], v[140:143]
s_waitcnt lgkmcnt(1)
v_mfma_f32_16x16x32_bf16 v[128:131], v[64:67], v[112:115], v[128:131]
v_mfma_f32_16x16x32_bf16 v[132:135], v[68:71], v[112:115], v[132:135]
v_mfma_f32_16x16x32_bf16 v[136:139], v[72:75], v[112:115], v[136:139]
v_mfma_f32_16x16x32_bf16 v[140:143], v[76:79], v[112:115], v[140:143]
s_waitcnt lgkmcnt(0)
v_mfma_f32_16x16x32_bf16 v[128:131], v[80:83], v[116:119], v[128:131]
v_mfma_f32_16x16x32_bf16 v[132:135], v[84:87], v[116:119], v[132:135]
v_mfma_f32_16x16x32_bf16 v[136:139], v[88:91], v[116:119], v[136:139]
v_mfma_f32_16x16x32_bf16 v[140:143], v[92:95], v[116:119], v[140:143]
s_mov_b32 s64, s53
s_nop 4
v_cndmask_b32 v128, v128, v132, s[82:83]
v_cndmask_b32 v129, v129, v133, s[82:83]
v_cndmask_b32 v130, v130, v134, s[82:83]
v_cndmask_b32 v131, v131, v135, s[82:83]
v_cndmask_b32 v128, v128, v136, s[84:85]
v_cndmask_b32 v129, v129, v137, s[84:85]
v_cndmask_b32 v130, v130, v138, s[84:85]
v_cndmask_b32 v131, v131, v139, s[84:85]
v_cndmask_b32 v128, v128, v140, s[86:87]
v_cndmask_b32 v129, v129, v141, s[86:87]
v_cndmask_b32 v130, v130, v142, s[86:87]
v_cndmask_b32 v131, v131, v143, s[86:87]
v_add_u32 v128, 0x80, v128
v_add_u32 v129, 0x80, v129
v_add_u32 v130, 0x80, v130
v_add_u32 v131, 0x80, v131
v_and_or_b32 v128, v128, v15, s76
v_and_or_b32 v129, v129, v15, s77
v_and_or_b32 v130, v130, v15, s78
v_and_or_b32 v131, v131, v15, s79
s_cmp_lg_u32 s53, 0
s_cbranch_scc1 L_C_nost
s_mov_b32 exec_lo, 0x00ff00ff
s_mov_b32 exec_hi, 0x00ff00ff
buffer_store_dwordx4 v[128:131], v14, s[44:47], 0 offen sc1
s_mov_b64 exec, -1
L_C_nost:
s_cmp_lg_u32 s34, 4
s_cbranch_scc1 L_C_end
s_mov_b32 s66, 0x4000
s_mov_b32 s67, 0x8000
s_mov_b32 s65, 0xc000
buffer_load_dwordx4 v[144:147], v10, s[44:47], 0 offen sc1
buffer_load_dwordx4 v[148:151], v10, s[44:47], s66 offen sc1
buffer_load_dwordx4 v[152:155], v10, s[44:47], s67 offen sc1
buffer_load_dwordx4 v[156:159], v10, s[44:47], s65 offen sc1
s_sleep 6
buffer_load_dwordx4 v[160:163], v10, s[44:47], 0 offen sc1
buffer_load_dwordx4 v[164:167], v10, s[44:47], s66 offen sc1
buffer_load_dwordx4 v[168:171], v10, s[44:47], s67 offen sc1
buffer_load_dwordx4 v[172:175], v10, s[44:47], s65 offen sc1
s_sleep 6
buffer_load_dwordx4 v[176:179], v10, s[44:47], 0 offen sc1
buffer_load_dwordx4 v[180:183], v10, s[44:47], s66 offen sc1
buffer_load_dwordx4 v[184:187], v10, s[44:47], s67 offen sc1
buffer_load_dwordx4 v[188:191], v10, s[44:47], s65 offen sc1
L_ps_Cf:
s_waitcnt vmcnt(11)
v_xor_b32 v192, s76, v144
v_xor_b32 v193, s77, v145
v_xor_b32 v194, s78, v146
v_xor_b32 v195, s79, v147
v_or_b32 v240, v192, v193
v_or3_b32 v240, v240, v194, v195
s_waitcnt vmcnt(10)
v_xor_b32 v196, s76, v148
v_xor_b32 v197, s77, v149
v_xor_b32 v198, s78, v150
v_xor_b32 v199, s79, v151
v_or3_b32 v240, v240, v196, v197
v_or3_b32 v240, v240, v198, v199
v_add_f32 v192, v192, v196
v_add_f32 v193, v193, v197
v_add_f32 v194, v194, v198
v_add_f32 v195, v195, v199
s_waitcnt vmcnt(9)
v_xor_b32 v196, s76, v152
v_xor_b32 v197, s77, v153
v_xor_b32 v198, s78, v154
v_xor_b32 v199, s79, v155
v_or3_b32 v240, v240, v196, v197
v_or3_b32 v240, v240, v198, v199
v_add_f32 v192, v192, v196
v_add_f32 v193, v193, v197
v_add_f32 v194, v194, v198
v_add_f32 v195, v195, v199
s_waitcnt vmcnt(8)
v_xor_b32 v196, s76, v156
v_xor_b32 v197, s77, v157
v_xor_b32 v198, s78, v158
v_xor_b32 v199, s79, v159
v_or3_b32 v240, v240, v196, v197
v_or3_b32 v240, v240, v198, v199
v_add_f32 v192, v192, v196
v_add_f32 v193, v193, v197
v_add_f32 v194, v194, v198
v_add_f32 v195, v195, v199
v_and_b32 v240, 0xff, v240
v_cmp_ne_u32 vcc, 0, v240
v_add_f32_dpp v192, v192, v192 row_ror:8 row_mask:0xf bank_mask:0xf
v_add_f32_dpp v193, v193, v193 row_ror:8 row_mask:0xf bank_mask:0xf
v_add_f32_dpp v194, v194, v194 row_ror:8 row_mask:0xf bank_mask:0xf
v_add_f32_dpp v195, v195, v195 row_ror:8 row_mask:0xf bank_mask:0xf
s_cmp_eq_u64 vcc, 0
s_cbranch_scc1 L_pe_Cf
buffer_load_dwordx4 v[144:147], v10, s[44:47], 0 offen sc1
buffer_load_dwordx4 v[148:151], v10, s[44:47], s66 offen sc1
buffer_load_dwordx4 v[152:155], v10, s[44:47], s67 offen sc1
buffer_load_dwordx4 v[156:159], v10, s[44:47], s65 offen sc1
s_waitcnt vmcnt(11)
v_xor_b32 v192, s76, v160
v_xor_b32 v193, s77, v161
v_xor_b32 v194, s78, v162
v_xor_b32 v195, s79, v163
v_or_b32 v240, v192, v193
v_or3_b32 v240, v240, v194, v195
s_waitcnt vmcnt(10)
v_xor_b32 v196, s76, v164
v_xor_b32 v197, s77, v165
v_xor_b32 v198, s78, v166
v_xor_b32 v199, s79, v167
v_or3_b32 v240, v240, v196, v197
v_or3_b32 v240, v240, v198, v199
v_add_f32 v192, v192, v196
v_add_f32 v193, v193, v197
v_add_f32 v194, v194, v198
v_add_f32 v195, v195, v199
s_waitcnt vmcnt(9)
v_xor_b32 v196, s76, v168
v_xor_b32 v197, s77, v169
v_xor_b32 v198, s78, v170
v_xor_b32 v199, s79, v171
v_or3_b32 v240, v240, v196, v197
v_or3_b32 v240, v240, v198, v199
v_add_f32 v192, v192, v196
v_add_f32 v193, v193, v197
v_add_f32 v194, v194, v198
v_add_f32 v195, v195, v199
s_waitcnt vmcnt(8)
v_xor_b32 v196, s76, v172
v_xor_b32 v197, s77, v173
v_xor_b32 v198, s78, v174
v_xor_b32 v199, s79, v175
v_or3_b32 v240, v240, v196, v197
v_or3_b32 v240, v240, v198, v199
v_add_f32 v192, v192, v196
v_add_f32 v193, v193, v197
v_add_f32 v194, v194, v198
v_add_f32 v195, v195, v199
v_and_b32 v240, 0xff, v240
v_cmp_ne_u32 vcc, 0, v240
v_add_f32_dpp v192, v192, v192 row_ror:8 row_mask:0xf bank_mask:0xf
v_add_f32_dpp v193, v193, v193 row_ror:8 row_mask:0xf bank_mask:0xf
v_add_f32_dpp v194, v194, v194 row_ror:8 row_mask:0xf bank_mask:0xf
v_add_f32_dpp v195, v195, v195 row_ror:8 row_mask:0xf bank_mask:0xf
s_cmp_eq_u64 vcc, 0
s_cbranch_scc1 L_pe_Cf
buffer_load_dwordx4 v[160:163], v10, s[44:47], 0 offen sc1
buffer_load_dwordx4 v[164:167], v10, s[44:47], s66 offen sc1
buffer_load_dwordx4 v[168:171], v10, s[44:47], s67 offen sc1
buffer_load_dwordx4 v[172:175], v10, s[44:47], s65 offen sc1
s_waitcnt vmcnt(11)
v_xor_b32 v192, s76, v176
v_xor_b32 v193, s77, v177
v_xor_b32 v194, s78, v178
v_xor_b32 v195, s79, v179
v_or_b32 v240, v192, v193
v_or3_b32 v240, v240, v194, v195
s_waitcnt vmcnt(10)
v_xor_b32 v196, s76, v180
v_xor_b32 v197, s77, v181
v_xor_b32 v198, s78, v182
v_xor_b32 v199, s79, v183
v_or3_b32 v240, v240, v196, v197
v_or3_b32 v240, v240, v198, v199
v_add_f32 v192, v192, v196
v_add_f32 v193, v193, v197
v_add_f32 v194, v194, v198
v_add_f32 v195, v195, v199
s_waitcnt vmcnt(9)
v_xor_b32 v196, s76, v184
v_xor_b32 v197, s77, v185
v_xor_b32 v198, s78, v186
v_xor_b32 v199, s79, v187
v_or3_b32 v240, v240, v196, v197
v_or3_b32 v240, v240, v198, v199
v_add_f32 v192, v192, v196
v_add_f32 v193, v193, v197
v_add_f32 v194, v194, v198
v_add_f32 v195, v195, v199
s_waitcnt vmcnt(8)
v_xor_b32 v196, s76, v188
v_xor_b32 v197, s77, v189
v_xor_b32 v198, s78, v190
v_xor_b32 v199, s79, v191
v_or3_b32 v240, v240, v196, v197
v_or3_b32 v240, v240, v198, v199
v_add_f32 v192, v192, v196
v_add_f32 v193, v193, v197
v_add_f32 v194, v194, v198
v_add_f32 v195, v195, v199
v_and_b32 v240, 0xff, v240
v_cmp_ne_u32 vcc, 0, v240
v_add_f32_dpp v192, v192, v192 row_ror:8 row_mask:0xf bank_mask:0xf
v_add_f32_dpp v193, v193, v193 row_ror:8 row_mask:0xf bank_mask:0xf
v_add_f32_dpp v194, v194, v194 row_ror:8 row_mask:0xf bank_mask:0xf
v_add_f32_dpp v195, v195, v195 row_ror:8 row_mask:0xf bank_mask:0xf
s_cmp_eq_u64 vcc, 0
s_cbranch_scc1 L_pe_Cf
buffer_load_dwordx4 v[176:179], v10, s[44:47], 0 offen sc1
buffer_load_dwordx4 v[180:183], v10, s[44:47], s66 offen sc1
buffer_load_dwordx4 v[184:187], v10, s[44:47], s67 offen sc1
buffer_load_dwordx4 v[188:191], v10, s[44:47], s65 offen sc1
s_add_u32 s64, s64, 1
s_cmp_lt_u32 s64, 65536
s_cbranch_scc1 L_ps_Cf
L_pe_Cf:
v_add_f32_dpp v192, v192, v192 row_ror:4 row_mask:0xf bank_mask:0xf
v_add_f32_dpp v193, v193, v193 row_ror:4 row_mask:0xf bank_mask:0xf
v_add_f32_dpp v194, v194, v194 row_ror:4 row_mask:0xf bank_mask:0xf
v_add_f32_dpp v195, v195, v195 row_ror:4 row_mask:0xf bank_mask:0xf
v_mov_b32 v240, v192
v_mov_b32 v241, v193
v_mov_b32 v242, v194
v_mov_b32 v243, v195
v_permlane16_swap_b32 v192, v240
v_permlane16_swap_b32 v193, v241
v_permlane16_swap_b32 v194, v242
v_permlane16_swap_b32 v195, v243
v_add_f32 v192, v192, v240
v_add_f32 v193, v193, v241
v_add_f32 v194, v194, v242
v_add_f32 v195, v195, v243
v_cvt_pk_bf16_f32 v192, v192, v193
v_cvt_pk_bf16_f32 v193, v194, v195
s_cmp_lg_u32 s53, 0
s_cbranch_scc1 L_C_end
s_mov_b32 exec_lo, 15
s_mov_b32 exec_hi, 15
global_store_dwordx2 v11, v[192:193], s[26:27]
s_mov_b64 exec, -1
s_cmp_lg_u32 s32, 0
s_cbranch_scc1 L_C_end
v_mov_b32 v240, 0x14000
v_mov_b32 v241, s58
s_mov_b64 exec, 1
buffer_store_dword v241, v240, s[44:47], 0 offen sc1
L_C_end:
s_cmp_lg_u32 s53, 0
s_mov_b32 s53, 0
s_cbranch_scc1 L_C_poll
s_endpgm
L_exit:
s_endpgm
.section .rodata,"a"
.p2align 6
.amdhsa_kernel concat_heads__gqa_block_cached__compressed_kv_cla__decode_kernel
  .amdhsa_next_free_vgpr 256
  .amdhsa_next_free_sgpr 102
  .amdhsa_accum_offset 256
  .amdhsa_group_segment_fixed_size 0
  .amdhsa_kernarg_size 112
  .amdhsa_user_sgpr_count 2
  .amdhsa_user_sgpr_kernarg_segment_ptr 1
  .amdhsa_system_sgpr_workgroup_id_x 1
.end_amdhsa_kernel
```

```asm
; @launch grid=(256,1,1) block=(512,1,1) lds=157696
.amdgcn_target "amdgcn-amd-amdhsa--gfx950"
.text
.globl concat_heads__gqa_block_cached__compressed_kv_cla__decode_kernel
.p2align 12
.type concat_heads__gqa_block_cached__compressed_kv_cla__decode_kernel,@function
concat_heads__gqa_block_cached__compressed_kv_cla__decode_kernel:
s_cmp_ge_u32 s2, 256
s_cbranch_scc1 L_exit
s_load_dwordx16 s[4:19], s[0:1], 0
s_load_dwordx8 s[20:27], s[0:1], 64
s_load_dwordx4 s[28:31], s[0:1], 96
v_lshrrev_b32 v8, 6, v0
s_lshr_b32 s32, s2, 3
s_mov_b32 s60, 0x54321076
s_cmp_ge_u32 s2, 64
s_cselect_b32 s60, 0x54327610, s60
s_cmp_ge_u32 s2, 128
s_cselect_b32 s60, 0x54763210, s60
s_cmp_ge_u32 s2, 192
s_cselect_b32 s60, 0x76543210, s60
s_and_b32 s61, s32, 7
s_lshl_b32 s61, s61, 2
s_lshr_b32 s33, s60, s61
s_and_b32 s33, s33, 7
s_lshl_b32 s61, s33, 2
s_lshr_b32 s61, 0x50764321, s61
s_xor_b32 s61, s61, s2
s_lshr_b32 s60, s2, 6
s_xor_b32 s61, s61, s60
s_and_b32 s61, s61, 7
s_andn2_b32 s32, s32, 7
s_or_b32 s32, s32, s61
s_and_b32 s33, s33, 7
v_readfirstlane_b32 s34, v8
v_and_b32 v1, 63, v0
v_and_b32 v2, 15, v0
v_bfe_u32 v3, v0, 4, 2
s_cmp_eq_u32 s33, 6
s_cbranch_scc1 L_roleW
s_cmp_eq_u32 s33, 7
s_cbranch_scc1 L_roleC
L_roleA:
s_mov_b32 s87, 0x20000
s_andn2_b32 s60, s32, 7
s_and_b32 s61, s2, 7
s_or_b32 s82, s60, s61
s_lshr_b32 s60, s2, 6
s_xor_b32 s82, s82, s60
s_xor_b32 s83, s82, 5
v_lshlrev_b32 v11, 4, v2
s_add_u32 s60, s33, 0x1
s_lshl3_add_u32 s60, s60, s34
s_lshl_b32 s60, s60, 17
s_lshl_b32 s61, s83, 8
s_add_u32 s60, s60, s61
s_mov_b32 s86, 0x400000
s_mov_b32 s88, s60
s_mov_b32 s81, 13
s_add_u32 s60, s33, 0xfffffffe
s_lshl3_add_u32 s60, s60, s34
s_lshl_b32 s60, s60, 17
s_lshl_b32 s61, s82, 8
s_add_u32 s60, s60, s61
s_cmp_ge_u32 s33, 3
s_cselect_b32 s86, 0x400000, s86
s_cselect_b32 s88, s60, s88
s_cselect_b32 s81, 13, s81
s_lshl_b32 s89, 4, s81
v_lshl_add_u32 v9, v3, s81, v11
s_add_u32 s60, s88, s89
s_add_u32 s61, s60, s89
s_add_u32 s62, s61, s89
s_cmp_ge_u32 s33, 3
s_waitcnt lgkmcnt(0)
s_cselect_b64 s[84:85], s[18:19], s[10:11]
s_and_b32 s85, s85, 0xffff
buffer_load_dwordx4 v[20:23], v9, s[84:87], s88 offen
buffer_load_dwordx4 v[24:27], v9, s[84:87], s60 offen
buffer_load_dwordx4 v[28:31], v9, s[84:87], s61 offen
buffer_load_dwordx4 v[32:35], v9, s[84:87], s62 offen
v_lshlrev_b32 v8, 4, v1
s_bfe_u32 s55, s32, 0x10004
s_lshl_b32 s55, s55, 26
s_lshl_b32 s35, s33, 3
s_add_u32 s35, s35, s34
s_bfe_u32 s63, s35, 0x10009
s_lshl_b32 s63, s63, 26
s_xor_b32 s37, s63, s55
s_bfe_u32 s63, s35, 0x90000
s_lshl_b32 s63, s63, 12
s_or_b32 s37, s37, s63
s_lshl_b32 s62, s32, 21
s_add_u32 s40, s6, s62
s_addc_u32 s41, s7, 0
s_and_b32 s41, s41, 0xffff
s_mov_b32 s42, 0x4200000
s_mov_b32 s43, 0x20000
s_add_u32 s60, s33, 0x0
s_lshl3_add_u32 s60, s60, s34
s_lshl_b32 s60, s60, 17
s_lshl_b32 s61, s82, 8
s_add_u32 s60, s60, s61
s_mov_b64 s[84:85], s[20:21]
s_mov_b32 s86, 0x400000
s_mov_b32 s88, s60
s_mov_b32 s81, 13
s_add_u32 s60, s33, 0xfffffffc
s_lshl3_add_u32 s60, s60, s34
s_lshl_b32 s60, s60, 17
s_xor_b32 s61, s82, 7
s_lshl_b32 s61, s61, 8
s_add_u32 s60, s60, s61
s_cmp_ge_u32 s33, 4
s_cselect_b64 s[84:85], s[22:23], s[84:85]
s_cselect_b32 s86, 0x400000, s86
s_cselect_b32 s88, s60, s88
s_cselect_b32 s81, 13, s81
s_and_b32 s85, s85, 0xffff
s_lshl_b32 s89, 4, s81
v_lshl_add_u32 v10, v3, s81, v11
s_waitcnt vmcnt(3)
buffer_load_dwordx4 v[20:23], v10, s[84:87], s88 offen
s_add_u32 s88, s88, s89
s_waitcnt vmcnt(3)
buffer_load_dwordx4 v[24:27], v10, s[84:87], s88 offen
s_add_u32 s88, s88, s89
s_waitcnt vmcnt(3)
buffer_load_dwordx4 v[28:31], v10, s[84:87], s88 offen
s_add_u32 s88, s88, s89
s_waitcnt vmcnt(3)
buffer_load_dwordx4 v[32:35], v10, s[84:87], s88 offen
s_add_u32 s60, s33, 0x2
s_lshl3_add_u32 s60, s60, s34
s_lshl_b32 s60, s60, 17
s_xor_b32 s61, s82, 7
s_lshl_b32 s61, s61, 8
s_add_u32 s60, s60, s61
s_mov_b64 s[84:85], s[22:23]
s_mov_b32 s86, 0x400000
s_mov_b32 s88, s60
s_mov_b32 s81, 13
s_add_u32 s60, s33, 0xfffffffe
s_lshl3_add_u32 s60, s60, s34
s_lshl_b32 s60, s60, 12
s_xor_b32 s61, s82, 7
s_lshl_b32 s61, s61, 17
s_add_u32 s60, s60, s61
s_cmp_ge_u32 s33, 2
s_cselect_b64 s[84:85], s[24:25], s[84:85]
s_cselect_b32 s86, 0x400000, s86
s_cselect_b32 s88, s60, s88
s_cselect_b32 s81, 8, s81
s_and_b32 s85, s85, 0xffff
s_lshl_b32 s89, 4, s81
v_lshl_add_u32 v9, v3, s81, v11
s_waitcnt vmcnt(3)
buffer_load_dwordx4 v[20:23], v9, s[84:87], s88 offen
s_add_u32 s88, s88, s89
s_waitcnt vmcnt(3)
buffer_load_dwordx4 v[24:27], v9, s[84:87], s88 offen
s_add_u32 s88, s88, s89
s_waitcnt vmcnt(3)
buffer_load_dwordx4 v[28:31], v9, s[84:87], s88 offen
s_add_u32 s88, s88, s89
s_waitcnt vmcnt(3)
buffer_load_dwordx4 v[32:35], v9, s[84:87], s88 offen
s_add_u32 s60, s33, 0x2
s_lshl3_add_u32 s60, s60, s34
s_lshl_b32 s60, s60, 12
s_and_b32 s61, s83, 3
s_lshl_b32 s61, s61, 17
s_xor_b32 s60, s60, s61
s_lshl_b32 s61, s83, 19
s_add_u32 s60, s60, s61
s_mov_b64 s[84:85], s[16:17]
s_mov_b32 s86, 0x1000000
s_mov_b32 s88, s60
s_mov_b32 s81, 8
s_and_b32 s85, s85, 0xffff
s_lshl_b32 s89, 4, s81
v_lshl_add_u32 v10, v3, s81, v11
s_waitcnt vmcnt(3)
buffer_load_dwordx4 v[20:23], v10, s[84:87], s88 offen
s_add_u32 s88, s88, s89
s_waitcnt vmcnt(3)
buffer_load_dwordx4 v[24:27], v10, s[84:87], s88 offen
s_add_u32 s88, s88, s89
s_waitcnt vmcnt(3)
buffer_load_dwordx4 v[28:31], v10, s[84:87], s88 offen
s_add_u32 s88, s88, s89
s_waitcnt vmcnt(3)
buffer_load_dwordx4 v[32:35], v10, s[84:87], s88 offen
s_add_u32 s60, s33, 0x8
s_lshl3_add_u32 s60, s60, s34
s_lshl_b32 s60, s60, 12
s_and_b32 s61, s83, 3
s_lshl_b32 s61, s61, 17
s_xor_b32 s60, s60, s61
s_lshl_b32 s61, s83, 19
s_add_u32 s60, s60, s61
s_mov_b64 s[84:85], s[16:17]
s_mov_b32 s86, 0x1000000
s_mov_b32 s88, s60
s_mov_b32 s81, 8
s_and_b32 s85, s85, 0xffff
s_lshl_b32 s89, 4, s81
v_lshl_add_u32 v9, v3, s81, v11
s_waitcnt vmcnt(3)
buffer_load_dwordx4 v[20:23], v9, s[84:87], s88 offen
s_add_u32 s88, s88, s89
s_waitcnt vmcnt(3)
buffer_load_dwordx4 v[24:27], v9, s[84:87], s88 offen
s_add_u32 s88, s88, s89
s_waitcnt vmcnt(3)
buffer_load_dwordx4 v[28:31], v9, s[84:87], s88 offen
s_add_u32 s88, s88, s89
s_waitcnt vmcnt(3)
buffer_load_dwordx4 v[32:35], v9, s[84:87], s88 offen
s_add_u32 s60, s33, 0xe
s_lshl3_add_u32 s60, s60, s34
s_lshl_b32 s60, s60, 12
s_and_b32 s61, s83, 3
s_lshl_b32 s61, s61, 17
s_xor_b32 s60, s60, s61
s_lshl_b32 s61, s83, 19
s_add_u32 s60, s60, s61
s_mov_b64 s[84:85], s[16:17]
s_mov_b32 s86, 0x1000000
s_mov_b32 s88, s60
s_mov_b32 s81, 8
s_add_u32 s60, s33, 0xfffffffe
s_lshl3_add_u32 s60, s60, s34
s_lshl_b32 s60, s60, 12
s_lshl_b32 s61, s83, 17
s_add_u32 s60, s60, s61
s_cmp_ge_u32 s33, 2
s_cselect_b64 s[84:85], s[12:13], s[84:85]
s_cselect_b32 s86, 0x400000, s86
s_cselect_b32 s88, s60, s88
s_cselect_b32 s81, 8, s81
s_and_b32 s85, s85, 0xffff
s_lshl_b32 s89, 4, s81
v_lshl_add_u32 v10, v3, s81, v11
s_waitcnt vmcnt(3)
buffer_load_dwordx4 v[20:23], v10, s[84:87], s88 offen
s_add_u32 s88, s88, s89
s_waitcnt vmcnt(3)
buffer_load_dwordx4 v[24:27], v10, s[84:87], s88 offen
s_add_u32 s88, s88, s89
s_waitcnt vmcnt(3)
buffer_load_dwordx4 v[28:31], v10, s[84:87], s88 offen
s_add_u32 s88, s88, s89
s_waitcnt vmcnt(3)
buffer_load_dwordx4 v[32:35], v10, s[84:87], s88 offen
s_waitcnt vmcnt(3)
buffer_load_dwordx4 v[52:55], v8, s[40:43], s37 offen offset:0 nt
s_waitcnt vmcnt(3)
buffer_load_dwordx4 v[56:59], v8, s[40:43], s37 offen offset:1024 nt
s_waitcnt vmcnt(3)
buffer_load_dwordx4 v[60:63], v8, s[40:43], s37 offen offset:2048 nt
s_waitcnt vmcnt(3)
buffer_load_dwordx4 v[64:67], v8, s[40:43], s37 offen offset:3072 nt
s_add_u32 s44, s8, s62
s_addc_u32 s45, s9, 0
s_and_b32 s45, s45, 0xffff
s_mov_b32 s46, 0x4200000
s_mov_b32 s47, 0x20000
s_mov_b64 s[70:71], s[40:41]
s_mov_b64 s[72:73], s[44:45]
s_mov_b64 s[44:45], s[40:41]
s_mov_b32 s50, s35
s_mov_b32 s74, 0x00010001
s_mov_b32 s75, 0x00010001
s_mul_i32 s63, s34, 1216
s_add_u32 s63, s63, 8832
v_lshl_add_u32 v165, v3, 4, s63
v_add_u32 v164, 256, v165
v_mov_b32 v166, 0xff7fffff
v_mov_b32 v167, 0xff7fffff
v_and_b32 v132, 1, v0
v_lshlrev_b32 v132, 4, v132
v_mov_b32 v133, 0xffff
v_lshlrev_b32 v132, v132, v133
v_bfe_u32 v133, v0, 1, 2
v_cmp_eq_u32 vcc, 0, v133
s_nop 1
v_cndmask_b32 v4, 0, v132, vcc
v_cmp_eq_u32 vcc, 1, v133
s_nop 1
v_cndmask_b32 v5, 0, v132, vcc
v_cmp_eq_u32 vcc, 2, v133
s_nop 1
v_cndmask_b32 v6, 0, v132, vcc
v_cmp_eq_u32 vcc, 3, v133
s_nop 1
v_cndmask_b32 v7, 0, v132, vcc
s_load_dword s58, s[30:31], 0x14000
s_lshl_b32 s62, s32, 13
s_add_u32 s62, s62, 0x61800
s_mov_b32 s66, 16
s_add_u32 s52, s30, s62
s_addc_u32 s53, s31, 0
v_mov_b32 v140, 0xff7fffff
v_mov_b32 v141, 0
v_mov_b32 v136, 0
v_mov_b32 v137, 0
v_mov_b32 v138, 0
v_mov_b32 v139, 0
v_mov_b32 v144, 0x3e0293ee
s_mov_b32 s56, 0
s_mov_b32 s54, 0
s_lshr_b32 s61, s55, 17
v_lshrrev_b32 v151, 1, v3
v_lshlrev_b32 v151, 9, v151
v_xor_b32 v151, s61, v151
v_lshl_add_u32 v151, v2, 5, v151
v_and_b32 v132, 1, v3
v_lshl_add_u32 v151, v132, 4, v151
s_lshl_b32 s62, s32, 10
s_add_u32 s62, s62, 0x18000
v_add_u32 v151, s62, v151
v_lshlrev_b32 v148, 5, v2
v_lshl_add_u32 v148, v3, 4, v148
s_mul_i32 s62, s34, 1056
v_add_u32 v148, s62, v148
s_lshl_b32 s62, s34, 3
v_mov_b32 v149, s62
v_and_b32 v132, 7, v1
v_lshrrev_b32 v133, 3, v1
v_add_u32 v133, s62, v133
v_lshlrev_b32 v133, 4, v133
v_mul_u32_u24 v150, 1056, v132
v_add_u32 v150, v150, v133
v_xor_b32 v154, s61, v133
s_lshl_b32 s62, s32, 3
s_add_u32 s62, s62, s33
s_lshl_b32 s62, s62, 10
s_add_u32 s62, s62, 0x60000
v_add_u32 v154, s62, v154
s_waitcnt vmcnt(3)
s_add_u32 s35, s35, 48
s_bfe_u32 s63, s35, 0x10009
s_lshl_b32 s63, s63, 26
s_xor_b32 s37, s63, s55
s_bfe_u32 s63, s35, 0x90000
s_lshl_b32 s63, s63, 12
s_or_b32 s37, s37, s63
buffer_load_dwordx4 v[68:71], v8, s[44:47], s37 offen offset:0 nt
s_waitcnt vmcnt(3)
buffer_load_dwordx4 v[72:75], v8, s[44:47], s37 offen offset:1024 nt
s_waitcnt vmcnt(3)
buffer_load_dwordx4 v[76:79], v8, s[44:47], s37 offen offset:2048 nt
s_waitcnt vmcnt(3)
buffer_load_dwordx4 v[80:83], v8, s[44:47], s37 offen offset:3072 nt
s_waitcnt vmcnt(3)
s_add_u32 s35, s35, 48
s_bfe_u32 s63, s35, 0x10009
s_lshl_b32 s63, s63, 26
s_xor_b32 s37, s63, s55
s_bfe_u32 s63, s35, 0x90000
s_lshl_b32 s63, s63, 12
s_or_b32 s37, s37, s63
buffer_load_dwordx4 v[84:87], v8, s[40:43], s37 offen offset:0 nt
s_waitcnt vmcnt(3)
buffer_load_dwordx4 v[88:91], v8, s[40:43], s37 offen offset:1024 nt
s_waitcnt vmcnt(3)
buffer_load_dwordx4 v[92:95], v8, s[40:43], s37 offen offset:2048 nt
s_waitcnt vmcnt(3)
buffer_load_dwordx4 v[96:99], v8, s[40:43], s37 offen offset:3072 nt
s_waitcnt vmcnt(3)
s_add_u32 s35, s35, 48
s_bfe_u32 s63, s35, 0x10009
s_lshl_b32 s63, s63, 26
s_xor_b32 s37, s63, s55
s_bfe_u32 s63, s35, 0x90000
s_lshl_b32 s63, s63, 12
s_or_b32 s37, s37, s63
buffer_load_dwordx4 v[100:103], v8, s[44:47], s37 offen offset:0 nt
s_waitcnt vmcnt(3)
buffer_load_dwordx4 v[104:107], v8, s[44:47], s37 offen offset:1024 nt
s_waitcnt vmcnt(3)
buffer_load_dwordx4 v[108:111], v8, s[44:47], s37 offen offset:2048 nt
s_waitcnt vmcnt(3)
buffer_load_dwordx4 v[112:115], v8, s[44:47], s37 offen offset:3072 nt
global_load_dwordx4 v[120:123], v151, s[30:31] sc1
s_waitcnt vmcnt(4)
s_add_u32 s35, s35, 48
s_bfe_u32 s63, s35, 0x10009
s_lshl_b32 s63, s63, 26
s_xor_b32 s37, s63, s55
s_bfe_u32 s63, s35, 0x90000
s_lshl_b32 s63, s63, 12
s_or_b32 s37, s37, s63
buffer_load_dwordx4 v[20:23], v8, s[40:43], s37 offen offset:0 nt
s_waitcnt vmcnt(4)
buffer_load_dwordx4 v[24:27], v8, s[40:43], s37 offen offset:1024 nt
s_waitcnt vmcnt(4)
buffer_load_dwordx4 v[28:31], v8, s[40:43], s37 offen offset:2048 nt
s_waitcnt vmcnt(4)
buffer_load_dwordx4 v[32:35], v8, s[40:43], s37 offen offset:3072 nt
s_waitcnt lgkmcnt(0)
s_add_u32 s58, s58, 0x9e3779b9
s_bfe_u32 s76, s58, 0x80000
s_bfe_u32 s77, s58, 0x80008
s_bfe_u32 s78, s58, 0x80010
s_bfe_u32 s79, s58, 0x80018
s_mov_b32 s64, 0
s_mov_b32 s60, 0x05040100
s_mov_b32 s61, 0x07060302
s_waitcnt vmcnt(4)
L_A_qchk:
v_perm_b32 v132, v121, v120, s60
v_perm_b32 v133, v123, v122, s60
v_xor_b32 v132, s58, v132
v_xor_b32 v133, s58, v133
v_or_b32 v132, v132, v133
v_cmp_ne_u32 vcc, 0, v132
s_add_u32 s64, s64, 1
s_cmp_eq_u64 vcc, 0
s_cbranch_scc1 L_A_qok
s_cmp_ge_u32 s64, 65536
s_cbranch_scc1 L_A_qok
global_load_dwordx4 v[120:123], v151, s[30:31] sc1
s_waitcnt vmcnt(0)
s_branch L_A_qchk
L_A_qok:
v_perm_b32 v132, v121, v120, s61
v_perm_b32 v133, v123, v122, s61
v_lshlrev_b32 v134, 2, v2
ds_bpermute_b32 v12, v134, v132 offset:0
ds_bpermute_b32 v13, v134, v133 offset:0
ds_bpermute_b32 v14, v134, v132 offset:64
ds_bpermute_b32 v15, v134, v133 offset:64
ds_bpermute_b32 v16, v134, v132 offset:128
ds_bpermute_b32 v17, v134, v133 offset:128
ds_bpermute_b32 v18, v134, v132 offset:192
ds_bpermute_b32 v19, v134, v133 offset:192
s_waitcnt lgkmcnt(0)
v_mov_b32 v160, v12
v_mov_b32 v161, v13
v_mov_b32 v162, v14
v_mov_b32 v163, v15
.p2align 6
L_A_loopa:
s_cmp_lt_u32 s54, 2
s_cbranch_scc1 L_A_back
L_A_backd:
s_add_u32 s49, s35, 48
s_bfe_u32 s63, s49, 0x10009
s_lshl_b32 s63, s63, 26
s_xor_b32 s48, s63, s55
s_bfe_u32 s63, s49, 0x90000
s_lshl_b32 s63, s63, 12
s_or_b32 s48, s48, s63
s_lshr_b32 s62, s35, 9
s_cmp_lg_u32 s62, s56
s_cbranch_scc1 L_A_swa
L_A_swda:
s_waitcnt vmcnt(3)
buffer_load_dwordx4 v[36:39], v8, s[44:47], s48 offen offset:0 nt
v_dot2_f32_bf16 v116, v20, v160, 0
v_dot2_f32_bf16 v116, v21, v161, v116
v_dot2_f32_bf16 v116, v22, v162, v116
v_dot2_f32_bf16 v116, v23, v163, v116
s_nop 2
v_add_f32_dpp v116, v116, v116 row_ror:8 row_mask:0xf bank_mask:0xf
s_nop 1
v_add_f32_dpp v116, v116, v116 row_ror:4 row_mask:0xf bank_mask:0xf
s_nop 1
v_add_f32_dpp v116, v116, v116 row_ror:2 row_mask:0xf bank_mask:0xf
s_nop 1
v_add_f32_dpp v116, v116, v116 row_ror:1 row_mask:0xf bank_mask:0xf
v_mul_f32 v116, v116, v144
s_waitcnt vmcnt(3)
buffer_load_dwordx4 v[40:43], v8, s[44:47], s48 offen offset:1024 nt
v_dot2_f32_bf16 v117, v24, v160, 0
v_dot2_f32_bf16 v117, v25, v161, v117
v_dot2_f32_bf16 v117, v26, v162, v117
v_dot2_f32_bf16 v117, v27, v163, v117
s_nop 2
v_add_f32_dpp v117, v117, v117 row_ror:8 row_mask:0xf bank_mask:0xf
s_nop 1
v_add_f32_dpp v117, v117, v117 row_ror:4 row_mask:0xf bank_mask:0xf
s_nop 1
v_add_f32_dpp v117, v117, v117 row_ror:2 row_mask:0xf bank_mask:0xf
s_nop 1
v_add_f32_dpp v117, v117, v117 row_ror:1 row_mask:0xf bank_mask:0xf
v_mul_f32 v117, v117, v144
s_waitcnt vmcnt(3)
buffer_load_dwordx4 v[44:47], v8, s[44:47], s48 offen offset:2048 nt
v_dot2_f32_bf16 v118, v28, v160, 0
v_dot2_f32_bf16 v118, v29, v161, v118
v_dot2_f32_bf16 v118, v30, v162, v118
v_dot2_f32_bf16 v118, v31, v163, v118
s_nop 2
v_add_f32_dpp v118, v118, v118 row_ror:8 row_mask:0xf bank_mask:0xf
s_nop 1
v_add_f32_dpp v118, v118, v118 row_ror:4 row_mask:0xf bank_mask:0xf
s_nop 1
v_add_f32_dpp v118, v118, v118 row_ror:2 row_mask:0xf bank_mask:0xf
s_nop 1
v_add_f32_dpp v118, v118, v118 row_ror:1 row_mask:0xf bank_mask:0xf
v_mul_f32 v118, v118, v144
s_waitcnt vmcnt(3)
buffer_load_dwordx4 v[48:51], v8, s[44:47], s48 offen offset:3072 nt
v_dot2_f32_bf16 v119, v32, v160, 0
v_dot2_f32_bf16 v119, v33, v161, v119
v_dot2_f32_bf16 v119, v34, v162, v119
v_dot2_f32_bf16 v119, v35, v163, v119
s_nop 2
v_add_f32_dpp v119, v119, v119 row_ror:8 row_mask:0xf bank_mask:0xf
s_nop 1
v_add_f32_dpp v119, v119, v119 row_ror:4 row_mask:0xf bank_mask:0xf
s_nop 1
v_add_f32_dpp v119, v119, v119 row_ror:2 row_mask:0xf bank_mask:0xf
s_nop 1
v_add_f32_dpp v119, v119, v119 row_ror:1 row_mask:0xf bank_mask:0xf
v_mul_f32 v119, v119, v144
s_mov_b64 exec, s[74:75]
ds_write_b128 v164, v[116:119] offset:0
s_mov_b64 exec, -1
v_max3_f32 v167, v167, v116, v117
v_max3_f32 v167, v167, v118, v119
s_lshr_b32 s62, s49, 9
s_cmp_lg_u32 s62, s56
s_cbranch_scc1 L_A_swa2
L_A_swda2:
s_add_u32 s36, s35, 96
s_cmp_eq_u32 s54, 6
s_cselect_b32 s36, s50, s36
s_cselect_b64 s[40:41], s[72:73], s[40:41]
s_bfe_u32 s63, s36, 0x10009
s_lshl_b32 s63, s63, 26
s_xor_b32 s38, s63, s55
s_bfe_u32 s63, s36, 0x90000
s_lshl_b32 s63, s63, 12
s_or_b32 s38, s38, s63
s_waitcnt vmcnt(3)
buffer_load_dwordx4 v[20:23], v8, s[40:43], s38 offen offset:0 nt
v_dot2_f32_bf16 v156, v36, v160, 0
v_dot2_f32_bf16 v156, v37, v161, v156
v_dot2_f32_bf16 v156, v38, v162, v156
v_dot2_f32_bf16 v156, v39, v163, v156
s_nop 2
v_add_f32_dpp v156, v156, v156 row_ror:8 row_mask:0xf bank_mask:0xf
s_nop 1
v_add_f32_dpp v156, v156, v156 row_ror:4 row_mask:0xf bank_mask:0xf
s_nop 1
v_add_f32_dpp v156, v156, v156 row_ror:2 row_mask:0xf bank_mask:0xf
s_nop 1
v_add_f32_dpp v156, v156, v156 row_ror:1 row_mask:0xf bank_mask:0xf
v_mul_f32 v156, v156, v144
s_waitcnt vmcnt(3)
buffer_load_dwordx4 v[24:27], v8, s[40:43], s38 offen offset:1024 nt
v_dot2_f32_bf16 v157, v40, v160, 0
v_dot2_f32_bf16 v157, v41, v161, v157
v_dot2_f32_bf16 v157, v42, v162, v157
v_dot2_f32_bf16 v157, v43, v163, v157
s_nop 2
v_add_f32_dpp v157, v157, v157 row_ror:8 row_mask:0xf bank_mask:0xf
s_nop 1
v_add_f32_dpp v157, v157, v157 row_ror:4 row_mask:0xf bank_mask:0xf
s_nop 1
v_add_f32_dpp v157, v157, v157 row_ror:2 row_mask:0xf bank_mask:0xf
s_nop 1
v_add_f32_dpp v157, v157, v157 row_ror:1 row_mask:0xf bank_mask:0xf
v_mul_f32 v157, v157, v144
s_waitcnt vmcnt(3)
buffer_load_dwordx4 v[28:31], v8, s[40:43], s38 offen offset:2048 nt
v_dot2_f32_bf16 v158, v44, v160, 0
v_dot2_f32_bf16 v158, v45, v161, v158
v_dot2_f32_bf16 v158, v46, v162, v158
v_dot2_f32_bf16 v158, v47, v163, v158
s_nop 2
v_add_f32_dpp v158, v158, v158 row_ror:8 row_mask:0xf bank_mask:0xf
s_nop 1
v_add_f32_dpp v158, v158, v158 row_ror:4 row_mask:0xf bank_mask:0xf
s_nop 1
v_add_f32_dpp v158, v158, v158 row_ror:2 row_mask:0xf bank_mask:0xf
s_nop 1
v_add_f32_dpp v158, v158, v158 row_ror:1 row_mask:0xf bank_mask:0xf
v_mul_f32 v158, v158, v144
s_waitcnt vmcnt(3)
buffer_load_dwordx4 v[32:35], v8, s[40:43], s38 offen offset:3072 nt
v_dot2_f32_bf16 v159, v48, v160, 0
v_dot2_f32_bf16 v159, v49, v161, v159
v_dot2_f32_bf16 v159, v50, v162, v159
v_dot2_f32_bf16 v159, v51, v163, v159
s_nop 2
v_add_f32_dpp v159, v159, v159 row_ror:8 row_mask:0xf bank_mask:0xf
s_nop 1
v_add_f32_dpp v159, v159, v159 row_ror:4 row_mask:0xf bank_mask:0xf
s_nop 1
v_add_f32_dpp v159, v159, v159 row_ror:2 row_mask:0xf bank_mask:0xf
s_nop 1
v_add_f32_dpp v159, v159, v159 row_ror:1 row_mask:0xf bank_mask:0xf
v_mul_f32 v159, v159, v144
s_mov_b64 exec, s[74:75]
ds_write_b128 v164, v[156:159] offset:64
s_mov_b64 exec, -1
v_max3_f32 v167, v167, v156, v157
v_max3_f32 v167, v167, v158, v159
v_add_u32 v164, 128, v164
s_mov_b32 s35, s36
s_mov_b32 s37, s38
s_add_u32 s54, s54, 1
s_cmp_lt_u32 s54, 7
s_cbranch_scc1 L_A_loopa
s_mov_b64 s[44:45], s[72:73]
s_mov_b32 s56, 0
v_mov_b32 v164, v165
ds_read_b128 v[116:119], v165
v_mov_b32 v145, v166
s_nop 1
v_permlane16_swap_b32 v166, v145
s_nop 0
v_max_f32 v166, v166, v145
v_mov_b32 v145, v166
s_nop 1
v_permlane32_swap_b32 v166, v145
s_nop 0
v_max_f32 v166, v166, v145
v_mov_b32 v145, v167
s_nop 1
v_permlane16_swap_b32 v167, v145
s_nop 0
v_max_f32 v167, v167, v145
v_mov_b32 v145, v167
s_nop 1
v_permlane32_swap_b32 v167, v145
s_nop 0
v_max_f32 v167, v167, v145
v_mov_b32 v140, v166
.p2align 6
L_A_loopc:
s_add_u32 s49, s35, 48
s_bfe_u32 s63, s49, 0x10009
s_lshl_b32 s63, s63, 26
s_xor_b32 s48, s63, s55
s_bfe_u32 s63, s49, 0x90000
s_lshl_b32 s63, s63, 12
s_or_b32 s48, s48, s63
s_lshr_b32 s62, s35, 9
s_cmp_lg_u32 s62, s56
s_cbranch_scc1 L_A_swc
L_A_swdc:
s_waitcnt lgkmcnt(0)
s_cmp_lt_u32 s54, s66
s_cbranch_scc1 L_A_nogc
s_mov_b32 s39, 1
s_atomic_add s39, s[52:53], 0 glc
L_A_nogc:
ds_read_b128 v[156:159], v164 offset:64
v_sub_f32 v116, v116, v140
v_sub_f32 v117, v117, v140
v_sub_f32 v118, v118, v140
v_sub_f32 v119, v119, v140
v_exp_f32 v116, v116
v_exp_f32 v117, v117
v_exp_f32 v118, v118
v_exp_f32 v119, v119
v_cvt_pk_bf16_f32 v146, v116, v116
v_add_f32 v141, v141, v116
v_and_b32 v120, v146, v4
v_and_b32 v121, v146, v5
v_and_b32 v122, v146, v6
v_and_b32 v123, v146, v7
s_waitcnt vmcnt(3)
buffer_load_dwordx4 v[36:39], v8, s[44:47], s48 offen offset:0 nt
v_mfma_f32_16x16x32_bf16 v[136:139], v[120:123], v[20:23], v[136:139]
v_cvt_pk_bf16_f32 v147, v117, v117
v_add_f32 v141, v141, v117
v_and_b32 v124, v147, v4
v_and_b32 v125, v147, v5
v_and_b32 v126, v147, v6
v_and_b32 v127, v147, v7
s_waitcnt vmcnt(3)
buffer_load_dwordx4 v[40:43], v8, s[44:47], s48 offen offset:1024 nt
v_mfma_f32_16x16x32_bf16 v[136:139], v[124:127], v[24:27], v[136:139]
v_cvt_pk_bf16_f32 v146, v118, v118
v_add_f32 v141, v141, v118
v_and_b32 v128, v146, v4
v_and_b32 v129, v146, v5
v_and_b32 v130, v146, v6
v_and_b32 v131, v146, v7
s_waitcnt vmcnt(3)
buffer_load_dwordx4 v[44:47], v8, s[44:47], s48 offen offset:2048 nt
v_mfma_f32_16x16x32_bf16 v[136:139], v[128:131], v[28:31], v[136:139]
v_cvt_pk_bf16_f32 v147, v119, v119
v_add_f32 v141, v141, v119
v_and_b32 v132, v147, v4
v_and_b32 v133, v147, v5
v_and_b32 v134, v147, v6
v_and_b32 v135, v147, v7
s_waitcnt vmcnt(3)
buffer_load_dwordx4 v[48:51], v8, s[44:47], s48 offen offset:3072 nt
v_mfma_f32_16x16x32_bf16 v[136:139], v[132:135], v[32:35], v[136:139]
s_lshr_b32 s62, s49, 9
s_cmp_lg_u32 s62, s56
s_cbranch_scc1 L_A_swc2
L_A_swdc2:
s_waitcnt lgkmcnt(0)
ds_read_b128 v[116:119], v164 offset:128
v_sub_f32 v156, v156, v140
v_sub_f32 v157, v157, v140
v_sub_f32 v158, v158, v140
v_sub_f32 v159, v159, v140
v_exp_f32 v156, v156
v_exp_f32 v157, v157
v_exp_f32 v158, v158
v_exp_f32 v159, v159
v_cvt_pk_bf16_f32 v146, v156, v156
v_add_f32 v141, v141, v156
v_and_b32 v120, v146, v4
v_and_b32 v121, v146, v5
v_and_b32 v122, v146, v6
v_and_b32 v123, v146, v7
s_add_u32 s36, s35, 96
s_cmp_eq_u32 s54, 15
s_cselect_b64 s[40:41], s[70:71], s[40:41]
s_cmp_lt_u32 s54, 16
s_cbranch_scc1 L_A_notc
s_waitcnt lgkmcnt(0)
s_add_u32 s39, s39, 1
s_cmp_eq_u32 s39, 39
s_cbranch_scc1 L_A_sigc
s_cmp_eq_u32 s39, 95
s_cbranch_scc1 L_A_sigc
L_A_sigdc:
s_min_u32 s39, s39, 1024
s_add_u32 s36, s39, 912
L_A_notc:
s_bfe_u32 s63, s36, 0x10009
s_lshl_b32 s63, s63, 26
s_xor_b32 s38, s63, s55
s_bfe_u32 s63, s36, 0x90000
s_lshl_b32 s63, s63, 12
s_or_b32 s38, s38, s63
s_cmp_lt_u32 s36, 1024
s_cselect_b32 s42, s42, 0
s_waitcnt vmcnt(3)
buffer_load_dwordx4 v[20:23], v8, s[40:43], s38 offen offset:0 nt
v_mfma_f32_16x16x32_bf16 v[136:139], v[120:123], v[36:39], v[136:139]
v_cvt_pk_bf16_f32 v147, v157, v157
v_add_f32 v141, v141, v157
v_and_b32 v124, v147, v4
v_and_b32 v125, v147, v5
v_and_b32 v126, v147, v6
v_and_b32 v127, v147, v7
s_waitcnt vmcnt(3)
buffer_load_dwordx4 v[24:27], v8, s[40:43], s38 offen offset:1024 nt
v_mfma_f32_16x16x32_bf16 v[136:139], v[124:127], v[40:43], v[136:139]
v_cvt_pk_bf16_f32 v146, v158, v158
v_add_f32 v141, v141, v158
v_and_b32 v128, v146, v4
v_and_b32 v129, v146, v5
v_and_b32 v130, v146, v6
v_and_b32 v131, v146, v7
s_waitcnt vmcnt(3)
buffer_load_dwordx4 v[28:31], v8, s[40:43], s38 offen offset:2048 nt
v_mfma_f32_16x16x32_bf16 v[136:139], v[128:131], v[44:47], v[136:139]
v_cvt_pk_bf16_f32 v147, v159, v159
v_add_f32 v141, v141, v159
v_and_b32 v132, v147, v4
v_and_b32 v133, v147, v5
v_and_b32 v134, v147, v6
v_and_b32 v135, v147, v7
s_waitcnt vmcnt(3)
buffer_load_dwordx4 v[32:35], v8, s[40:43], s38 offen offset:3072 nt
v_mfma_f32_16x16x32_bf16 v[136:139], v[132:135], v[48:51], v[136:139]
v_add_u32 v164, 128, v164
s_mov_b32 s35, s36
s_mov_b32 s37, s38
s_add_u32 s54, s54, 1
s_cmp_ge_u32 s35, 1024
s_cbranch_scc1 L_A_out
s_cmp_lt_u32 s54, 16
s_cbranch_scc1 L_A_loopc
s_waitcnt lgkmcnt(0)
.p2align 6
L_A_loopb:
s_cmp_lt_u32 s54, s66
s_cbranch_scc1 L_A_nogb
s_mov_b32 s39, 1
s_atomic_add s39, s[52:53], 0 glc
L_A_nogb:
s_waitcnt vmcnt(3)
buffer_load_dwordx4 v[36:39], v8, s[44:47], s37 offen offset:0 nt
v_dot2_f32_bf16 v116, v20, v160, 0
v_dot2_f32_bf16 v116, v21, v161, v116
v_dot2_f32_bf16 v116, v22, v162, v116
v_dot2_f32_bf16 v116, v23, v163, v116
s_nop 2
v_add_f32_dpp v116, v116, v116 row_ror:8 row_mask:0xf bank_mask:0xf
s_nop 1
v_add_f32_dpp v116, v116, v116 row_ror:4 row_mask:0xf bank_mask:0xf
s_nop 1
v_add_f32_dpp v116, v116, v116 row_ror:2 row_mask:0xf bank_mask:0xf
s_nop 1
v_add_f32_dpp v116, v116, v116 row_ror:1 row_mask:0xf bank_mask:0xf
v_mul_f32 v116, v116, v144
s_waitcnt vmcnt(3)
buffer_load_dwordx4 v[40:43], v8, s[44:47], s37 offen offset:1024 nt
v_dot2_f32_bf16 v117, v24, v160, 0
v_dot2_f32_bf16 v117, v25, v161, v117
v_dot2_f32_bf16 v117, v26, v162, v117
v_dot2_f32_bf16 v117, v27, v163, v117
s_nop 2
v_add_f32_dpp v117, v117, v117 row_ror:8 row_mask:0xf bank_mask:0xf
s_nop 1
v_add_f32_dpp v117, v117, v117 row_ror:4 row_mask:0xf bank_mask:0xf
s_nop 1
v_add_f32_dpp v117, v117, v117 row_ror:2 row_mask:0xf bank_mask:0xf
s_nop 1
v_add_f32_dpp v117, v117, v117 row_ror:1 row_mask:0xf bank_mask:0xf
v_mul_f32 v117, v117, v144
s_waitcnt vmcnt(3)
buffer_load_dwordx4 v[44:47], v8, s[44:47], s37 offen offset:2048 nt
v_dot2_f32_bf16 v118, v28, v160, 0
v_dot2_f32_bf16 v118, v29, v161, v118
v_dot2_f32_bf16 v118, v30, v162, v118
v_dot2_f32_bf16 v118, v31, v163, v118
s_nop 2
v_add_f32_dpp v118, v118, v118 row_ror:8 row_mask:0xf bank_mask:0xf
s_nop 1
v_add_f32_dpp v118, v118, v118 row_ror:4 row_mask:0xf bank_mask:0xf
s_nop 1
v_add_f32_dpp v118, v118, v118 row_ror:2 row_mask:0xf bank_mask:0xf
s_nop 1
v_add_f32_dpp v118, v118, v118 row_ror:1 row_mask:0xf bank_mask:0xf
v_mul_f32 v118, v118, v144
s_waitcnt vmcnt(3)
buffer_load_dwordx4 v[48:51], v8, s[44:47], s37 offen offset:3072 nt
v_dot2_f32_bf16 v119, v32, v160, 0
v_dot2_f32_bf16 v119, v33, v161, v119
v_dot2_f32_bf16 v119, v34, v162, v119
v_dot2_f32_bf16 v119, v35, v163, v119
s_nop 2
v_add_f32_dpp v119, v119, v119 row_ror:8 row_mask:0xf bank_mask:0xf
s_nop 1
v_add_f32_dpp v119, v119, v119 row_ror:4 row_mask:0xf bank_mask:0xf
s_nop 1
v_add_f32_dpp v119, v119, v119 row_ror:2 row_mask:0xf bank_mask:0xf
s_nop 1
v_add_f32_dpp v119, v119, v119 row_ror:1 row_mask:0xf bank_mask:0xf
v_mul_f32 v119, v119, v144
v_max3_f32 v145, v116, v117, v118
v_max_f32 v145, v145, v119
v_cmp_gt_f32 vcc, v145, v140
s_nop 0
s_cmp_lg_u64 vcc, 0
s_cbranch_scc1 L_A_maxb
L_A_maxdb:
v_sub_f32 v116, v116, v140
v_sub_f32 v117, v117, v140
v_sub_f32 v118, v118, v140
v_sub_f32 v119, v119, v140
v_exp_f32 v116, v116
v_exp_f32 v117, v117
v_exp_f32 v118, v118
v_exp_f32 v119, v119
v_cvt_pk_bf16_f32 v146, v116, v116
v_add_f32 v141, v141, v116
v_and_b32 v120, v146, v4
v_and_b32 v121, v146, v5
v_and_b32 v122, v146, v6
v_and_b32 v123, v146, v7
s_add_u32 s36, s35, 48
s_cmp_lt_u32 s54, 16
s_cbranch_scc1 L_A_notb
s_waitcnt lgkmcnt(0)
s_add_u32 s39, s39, 1
s_cmp_eq_u32 s39, 39
s_cbranch_scc1 L_A_sigb
s_cmp_eq_u32 s39, 95
s_cbranch_scc1 L_A_sigb
L_A_sigdb:
s_min_u32 s39, s39, 1024
s_add_u32 s36, s39, 912
L_A_notb:
s_bfe_u32 s63, s36, 0x10009
s_lshl_b32 s63, s63, 26
s_xor_b32 s38, s63, s55
s_bfe_u32 s63, s36, 0x90000
s_lshl_b32 s63, s63, 12
s_or_b32 s38, s38, s63
s_cmp_lt_u32 s36, 1024
s_cselect_b32 s42, s42, 0
s_waitcnt vmcnt(3)
buffer_load_dwordx4 v[20:23], v8, s[40:43], s38 offen offset:0 nt
v_mfma_f32_16x16x32_bf16 v[136:139], v[120:123], v[36:39], v[136:139]
v_cvt_pk_bf16_f32 v147, v117, v117
v_add_f32 v141, v141, v117
v_and_b32 v124, v147, v4
v_and_b32 v125, v147, v5
v_and_b32 v126, v147, v6
v_and_b32 v127, v147, v7
s_waitcnt vmcnt(3)
buffer_load_dwordx4 v[24:27], v8, s[40:43], s38 offen offset:1024 nt
v_mfma_f32_16x16x32_bf16 v[136:139], v[124:127], v[40:43], v[136:139]
v_cvt_pk_bf16_f32 v146, v118, v118
v_add_f32 v141, v141, v118
v_and_b32 v128, v146, v4
v_and_b32 v129, v146, v5
v_and_b32 v130, v146, v6
v_and_b32 v131, v146, v7
s_waitcnt vmcnt(3)
buffer_load_dwordx4 v[28:31], v8, s[40:43], s38 offen offset:2048 nt
v_mfma_f32_16x16x32_bf16 v[136:139], v[128:131], v[44:47], v[136:139]
v_cvt_pk_bf16_f32 v147, v119, v119
v_add_f32 v141, v141, v119
v_and_b32 v132, v147, v4
v_and_b32 v133, v147, v5
v_and_b32 v134, v147, v6
v_and_b32 v135, v147, v7
s_waitcnt vmcnt(3)
buffer_load_dwordx4 v[32:35], v8, s[40:43], s38 offen offset:3072 nt
v_mfma_f32_16x16x32_bf16 v[136:139], v[132:135], v[48:51], v[136:139]
s_mov_b32 s35, s36
s_mov_b32 s37, s38
s_add_u32 s54, s54, 1
s_cmp_lt_u32 s35, 1024
s_cbranch_scc1 L_A_loopb
L_A_out:
v_add_f32_dpp v141, v141, v141 row_bcast:15 row_mask:0xa bank_mask:0xf
s_nop 1
v_add_f32_dpp v141, v141, v141 row_bcast:31 row_mask:0xc bank_mask:0xf
s_mov_b32 exec_lo, 0
s_brev_b32 exec_hi, 1
ds_write_b64 v149, v[140:141] offset:8512
s_mov_b32 exec_lo, -1
s_mov_b32 exec_hi, 0
ds_write_b128 v148, v[136:139] offset:512
s_mov_b64 exec, -1
v_and_b32 v133, 7, v1
s_lshr_b32 s62, s34, 2
s_lshl_b32 s62, s62, 6
v_lshl_add_u32 v133, v133, 3, s62
v_mov_b32 v132, s58
s_mov_b32 s62, 0x05010400
s_mov_b32 s63, 0x07030602
s_mov_b32 s68, 0x01010101
s_mov_b32 s69, 0x01010101
s_waitcnt lgkmcnt(0)
s_barrier
L_A_nobar:
ds_read_b64 v[124:125], v133 offset:8448
ds_read_b128 v[120:123], v150 offset:0
s_waitcnt lgkmcnt(1)
v_max_f32_dpp v126, v124, v124 quad_perm:[1,0,3,2] row_mask:0xf bank_mask:0xf
s_nop 1
v_max_f32_dpp v126, v126, v126 quad_perm:[2,3,0,1] row_mask:0xf bank_mask:0xf
s_nop 1
v_max_f32_dpp v126, v126, v126 row_half_mirror row_mask:0xf bank_mask:0xf
v_sub_f32 v124, v124, v126
v_exp_f32 v124, v124
s_waitcnt lgkmcnt(0)
v_mul_f32 v127, v125, v124
v_mul_f32 v120, v120, v124
v_mul_f32 v121, v121, v124
v_mul_f32 v122, v122, v124
v_mul_f32 v123, v123, v124
v_add_f32_dpp v127, v127, v127 quad_perm:[1,0,3,2] row_mask:0xf bank_mask:0xf
v_add_f32_dpp v120, v120, v120 quad_perm:[1,0,3,2] row_mask:0xf bank_mask:0xf
v_add_f32_dpp v121, v121, v121 quad_perm:[1,0,3,2] row_mask:0xf bank_mask:0xf
v_add_f32_dpp v122, v122, v122 quad_perm:[1,0,3,2] row_mask:0xf bank_mask:0xf
v_add_f32_dpp v123, v123, v123 quad_perm:[1,0,3,2] row_mask:0xf bank_mask:0xf
v_add_f32_dpp v127, v127, v127 quad_perm:[2,3,0,1] row_mask:0xf bank_mask:0xf
v_add_f32_dpp v120, v120, v120 quad_perm:[2,3,0,1] row_mask:0xf bank_mask:0xf
v_add_f32_dpp v121, v121, v121 quad_perm:[2,3,0,1] row_mask:0xf bank_mask:0xf
v_add_f32_dpp v122, v122, v122 quad_perm:[2,3,0,1] row_mask:0xf bank_mask:0xf
v_add_f32_dpp v123, v123, v123 quad_perm:[2,3,0,1] row_mask:0xf bank_mask:0xf
v_add_f32_dpp v127, v127, v127 row_half_mirror row_mask:0xf bank_mask:0xf
v_add_f32_dpp v120, v120, v120 row_half_mirror row_mask:0xf bank_mask:0xf
v_add_f32_dpp v121, v121, v121 row_half_mirror row_mask:0xf bank_mask:0xf
v_add_f32_dpp v122, v122, v122 row_half_mirror row_mask:0xf bank_mask:0xf
v_add_f32_dpp v123, v123, v123 row_half_mirror row_mask:0xf bank_mask:0xf
v_max_f32 v127, 0x00800000, v127
v_log_f32 v124, v127
v_rcp_f32 v127, v127
s_mov_b64 exec, s[68:69]
v_add_f32 v126, v126, v124
v_mul_f32 v120, v120, v127
v_mul_f32 v121, v121, v127
v_mul_f32 v122, v122, v127
v_mul_f32 v123, v123, v127
v_perm_b32 v124, v126, v132, s62
v_perm_b32 v125, v126, v132, s63
v_cvt_pk_bf16_f32 v120, v120, v121
v_cvt_pk_bf16_f32 v121, v122, v123
v_perm_b32 v128, v120, v124, s60
v_perm_b32 v129, v120, v124, s61
v_perm_b32 v130, v121, v125, s60
v_perm_b32 v131, v121, v125, s61
global_store_dwordx4 v154, v[128:131], s[30:31] sc1
s_endpgm
L_A_back:
s_cmp_lg_u32 s54, 0
s_cbranch_scc1 L_A_bk1
v_dot2_f32_bf16 v116, v52, v12, 0
v_dot2_f32_bf16 v116, v53, v13, v116
v_dot2_f32_bf16 v116, v54, v14, v116
v_dot2_f32_bf16 v116, v55, v15, v116
v_dot2_f32_bf16 v117, v56, v12, 0
v_dot2_f32_bf16 v117, v57, v13, v117
v_dot2_f32_bf16 v117, v58, v14, v117
v_dot2_f32_bf16 v117, v59, v15, v117
v_dot2_f32_bf16 v118, v60, v12, 0
v_dot2_f32_bf16 v118, v61, v13, v118
v_dot2_f32_bf16 v118, v62, v14, v118
v_dot2_f32_bf16 v118, v63, v15, v118
v_dot2_f32_bf16 v119, v64, v12, 0
v_dot2_f32_bf16 v119, v65, v13, v119
v_dot2_f32_bf16 v119, v66, v14, v119
v_dot2_f32_bf16 v119, v67, v15, v119
s_nop 1
v_add_f32_dpp v116, v116, v116 row_ror:8 row_mask:0xf bank_mask:0xf
v_add_f32_dpp v117, v117, v117 row_ror:8 row_mask:0xf bank_mask:0xf
v_add_f32_dpp v118, v118, v118 row_ror:8 row_mask:0xf bank_mask:0xf
v_add_f32_dpp v119, v119, v119 row_ror:8 row_mask:0xf bank_mask:0xf
v_add_f32_dpp v116, v116, v116 row_ror:4 row_mask:0xf bank_mask:0xf
v_add_f32_dpp v117, v117, v117 row_ror:4 row_mask:0xf bank_mask:0xf
v_add_f32_dpp v118, v118, v118 row_ror:4 row_mask:0xf bank_mask:0xf
v_add_f32_dpp v119, v119, v119 row_ror:4 row_mask:0xf bank_mask:0xf
v_add_f32_dpp v116, v116, v116 row_ror:2 row_mask:0xf bank_mask:0xf
v_add_f32_dpp v117, v117, v117 row_ror:2 row_mask:0xf bank_mask:0xf
v_add_f32_dpp v118, v118, v118 row_ror:2 row_mask:0xf bank_mask:0xf
v_add_f32_dpp v119, v119, v119 row_ror:2 row_mask:0xf bank_mask:0xf
v_add_f32_dpp v116, v116, v116 row_ror:1 row_mask:0xf bank_mask:0xf
v_add_f32_dpp v117, v117, v117 row_ror:1 row_mask:0xf bank_mask:0xf
v_add_f32_dpp v118, v118, v118 row_ror:1 row_mask:0xf bank_mask:0xf
v_add_f32_dpp v119, v119, v119 row_ror:1 row_mask:0xf bank_mask:0xf
v_mul_f32 v116, v116, v144
v_mul_f32 v117, v117, v144
v_mul_f32 v118, v118, v144
v_mul_f32 v119, v119, v144
s_mov_b64 exec, s[74:75]
ds_write_b128 v165, v[116:119] offset:0
s_mov_b64 exec, -1
v_max3_f32 v166, v166, v116, v117
v_max3_f32 v166, v166, v118, v119
v_dot2_f32_bf16 v156, v68, v12, 0
v_dot2_f32_bf16 v156, v69, v13, v156
v_dot2_f32_bf16 v156, v70, v14, v156
v_dot2_f32_bf16 v156, v71, v15, v156
v_dot2_f32_bf16 v157, v72, v12, 0
v_dot2_f32_bf16 v157, v73, v13, v157
v_dot2_f32_bf16 v157, v74, v14, v157
v_dot2_f32_bf16 v157, v75, v15, v157
v_dot2_f32_bf16 v158, v76, v12, 0
v_dot2_f32_bf16 v158, v77, v13, v158
v_dot2_f32_bf16 v158, v78, v14, v158
v_dot2_f32_bf16 v158, v79, v15, v158
v_dot2_f32_bf16 v159, v80, v12, 0
v_dot2_f32_bf16 v159, v81, v13, v159
v_dot2_f32_bf16 v159, v82, v14, v159
v_dot2_f32_bf16 v159, v83, v15, v159
s_nop 1
v_add_f32_dpp v156, v156, v156 row_ror:8 row_mask:0xf bank_mask:0xf
v_add_f32_dpp v157, v157, v157 row_ror:8 row_mask:0xf bank_mask:0xf
v_add_f32_dpp v158, v158, v158 row_ror:8 row_mask:0xf bank_mask:0xf
v_add_f32_dpp v159, v159, v159 row_ror:8 row_mask:0xf bank_mask:0xf
v_add_f32_dpp v156, v156, v156 row_ror:4 row_mask:0xf bank_mask:0xf
v_add_f32_dpp v157, v157, v157 row_ror:4 row_mask:0xf bank_mask:0xf
v_add_f32_dpp v158, v158, v158 row_ror:4 row_mask:0xf bank_mask:0xf
v_add_f32_dpp v159, v159, v159 row_ror:4 row_mask:0xf bank_mask:0xf
v_add_f32_dpp v156, v156, v156 row_ror:2 row_mask:0xf bank_mask:0xf
v_add_f32_dpp v157, v157, v157 row_ror:2 row_mask:0xf bank_mask:0xf
v_add_f32_dpp v158, v158, v158 row_ror:2 row_mask:0xf bank_mask:0xf
v_add_f32_dpp v159, v159, v159 row_ror:2 row_mask:0xf bank_mask:0xf
v_add_f32_dpp v156, v156, v156 row_ror:1 row_mask:0xf bank_mask:0xf
v_add_f32_dpp v157, v157, v157 row_ror:1 row_mask:0xf bank_mask:0xf
v_add_f32_dpp v158, v158, v158 row_ror:1 row_mask:0xf bank_mask:0xf
v_add_f32_dpp v159, v159, v159 row_ror:1 row_mask:0xf bank_mask:0xf
v_mul_f32 v156, v156, v144
v_mul_f32 v157, v157, v144
v_mul_f32 v158, v158, v144
v_mul_f32 v159, v159, v144
s_mov_b64 exec, s[74:75]
ds_write_b128 v165, v[156:159] offset:64
s_mov_b64 exec, -1
v_max3_f32 v166, v166, v156, v157
v_max3_f32 v166, v166, v158, v159
s_branch L_A_backd
L_A_bk1:
v_dot2_f32_bf16 v116, v84, v12, 0
v_dot2_f32_bf16 v116, v85, v13, v116
v_dot2_f32_bf16 v116, v86, v14, v116
v_dot2_f32_bf16 v116, v87, v15, v116
v_dot2_f32_bf16 v117, v88, v12, 0
v_dot2_f32_bf16 v117, v89, v13, v117
v_dot2_f32_bf16 v117, v90, v14, v117
v_dot2_f32_bf16 v117, v91, v15, v117
v_dot2_f32_bf16 v118, v92, v12, 0
v_dot2_f32_bf16 v118, v93, v13, v118
v_dot2_f32_bf16 v118, v94, v14, v118
v_dot2_f32_bf16 v118, v95, v15, v118
v_dot2_f32_bf16 v119, v96, v12, 0
v_dot2_f32_bf16 v119, v97, v13, v119
v_dot2_f32_bf16 v119, v98, v14, v119
v_dot2_f32_bf16 v119, v99, v15, v119
s_nop 1
v_add_f32_dpp v116, v116, v116 row_ror:8 row_mask:0xf bank_mask:0xf
v_add_f32_dpp v117, v117, v117 row_ror:8 row_mask:0xf bank_mask:0xf
v_add_f32_dpp v118, v118, v118 row_ror:8 row_mask:0xf bank_mask:0xf
v_add_f32_dpp v119, v119, v119 row_ror:8 row_mask:0xf bank_mask:0xf
v_add_f32_dpp v116, v116, v116 row_ror:4 row_mask:0xf bank_mask:0xf
v_add_f32_dpp v117, v117, v117 row_ror:4 row_mask:0xf bank_mask:0xf
v_add_f32_dpp v118, v118, v118 row_ror:4 row_mask:0xf bank_mask:0xf
v_add_f32_dpp v119, v119, v119 row_ror:4 row_mask:0xf bank_mask:0xf
v_add_f32_dpp v116, v116, v116 row_ror:2 row_mask:0xf bank_mask:0xf
v_add_f32_dpp v117, v117, v117 row_ror:2 row_mask:0xf bank_mask:0xf
v_add_f32_dpp v118, v118, v118 row_ror:2 row_mask:0xf bank_mask:0xf
v_add_f32_dpp v119, v119, v119 row_ror:2 row_mask:0xf bank_mask:0xf
v_add_f32_dpp v116, v116, v116 row_ror:1 row_mask:0xf bank_mask:0xf
v_add_f32_dpp v117, v117, v117 row_ror:1 row_mask:0xf bank_mask:0xf
v_add_f32_dpp v118, v118, v118 row_ror:1 row_mask:0xf bank_mask:0xf
v_add_f32_dpp v119, v119, v119 row_ror:1 row_mask:0xf bank_mask:0xf
v_mul_f32 v116, v116, v144
v_mul_f32 v117, v117, v144
v_mul_f32 v118, v118, v144
v_mul_f32 v119, v119, v144
s_mov_b64 exec, s[74:75]
ds_write_b128 v165, v[116:119] offset:128
s_mov_b64 exec, -1
v_max3_f32 v166, v166, v116, v117
v_max3_f32 v166, v166, v118, v119
v_dot2_f32_bf16 v156, v100, v12, 0
v_dot2_f32_bf16 v156, v101, v13, v156
v_dot2_f32_bf16 v156, v102, v14, v156
v_dot2_f32_bf16 v156, v103, v15, v156
v_dot2_f32_bf16 v157, v104, v12, 0
v_dot2_f32_bf16 v157, v105, v13, v157
v_dot2_f32_bf16 v157, v106, v14, v157
v_dot2_f32_bf16 v157, v107, v15, v157
v_dot2_f32_bf16 v158, v108, v12, 0
v_dot2_f32_bf16 v158, v109, v13, v158
v_dot2_f32_bf16 v158, v110, v14, v158
v_dot2_f32_bf16 v158, v111, v15, v158
v_dot2_f32_bf16 v159, v112, v12, 0
v_dot2_f32_bf16 v159, v113, v13, v159
v_dot2_f32_bf16 v159, v114, v14, v159
v_dot2_f32_bf16 v159, v115, v15, v159
s_nop 1
v_add_f32_dpp v156, v156, v156 row_ror:8 row_mask:0xf bank_mask:0xf
v_add_f32_dpp v157, v157, v157 row_ror:8 row_mask:0xf bank_mask:0xf
v_add_f32_dpp v158, v158, v158 row_ror:8 row_mask:0xf bank_mask:0xf
v_add_f32_dpp v159, v159, v159 row_ror:8 row_mask:0xf bank_mask:0xf
v_add_f32_dpp v156, v156, v156 row_ror:4 row_mask:0xf bank_mask:0xf
v_add_f32_dpp v157, v157, v157 row_ror:4 row_mask:0xf bank_mask:0xf
v_add_f32_dpp v158, v158, v158 row_ror:4 row_mask:0xf bank_mask:0xf
v_add_f32_dpp v159, v159, v159 row_ror:4 row_mask:0xf bank_mask:0xf
v_add_f32_dpp v156, v156, v156 row_ror:2 row_mask:0xf bank_mask:0xf
v_add_f32_dpp v157, v157, v157 row_ror:2 row_mask:0xf bank_mask:0xf
v_add_f32_dpp v158, v158, v158 row_ror:2 row_mask:0xf bank_mask:0xf
v_add_f32_dpp v159, v159, v159 row_ror:2 row_mask:0xf bank_mask:0xf
v_add_f32_dpp v156, v156, v156 row_ror:1 row_mask:0xf bank_mask:0xf
v_add_f32_dpp v157, v157, v157 row_ror:1 row_mask:0xf bank_mask:0xf
v_add_f32_dpp v158, v158, v158 row_ror:1 row_mask:0xf bank_mask:0xf
v_add_f32_dpp v159, v159, v159 row_ror:1 row_mask:0xf bank_mask:0xf
v_mul_f32 v156, v156, v144
v_mul_f32 v157, v157, v144
v_mul_f32 v158, v158, v144
v_mul_f32 v159, v159, v144
s_mov_b64 exec, s[74:75]
ds_write_b128 v165, v[156:159] offset:192
s_mov_b64 exec, -1
v_max3_f32 v166, v166, v156, v157
v_max3_f32 v166, v166, v158, v159
s_branch L_A_backd
L_A_swa:
s_mov_b32 s56, 1
v_max_f32 v166, v166, v167
v_mov_b32 v167, 0xff7fffff
v_mov_b32 v160, v16
v_mov_b32 v161, v17
v_mov_b32 v162, v18
v_mov_b32 v163, v19
s_branch L_A_swda
L_A_swa2:
s_mov_b32 s56, 1
v_max_f32 v166, v166, v167
v_mov_b32 v167, 0xff7fffff
v_mov_b32 v160, v16
v_mov_b32 v161, v17
v_mov_b32 v162, v18
v_mov_b32 v163, v19
s_branch L_A_swda2
L_A_swc:
s_mov_b32 s56, 1
s_nop 3
v_add_f32_dpp v141, v141, v141 row_bcast:15 row_mask:0xa bank_mask:0xf
s_nop 1
v_add_f32_dpp v141, v141, v141 row_bcast:31 row_mask:0xc bank_mask:0xf
s_mov_b32 exec_lo, 0
s_brev_b32 exec_hi, 1
ds_write_b64 v149, v[140:141] offset:8448
s_mov_b32 exec_lo, -1
s_mov_b32 exec_hi, 0
ds_write_b128 v148, v[136:139] offset:0
s_mov_b64 exec, -1
s_waitcnt lgkmcnt(0)
v_mov_b32 v140, v167
v_mov_b32 v141, 0
v_mov_b32 v136, 0
v_mov_b32 v137, 0
v_mov_b32 v138, 0
v_mov_b32 v139, 0
s_branch L_A_swdc
L_A_swc2:
s_mov_b32 s56, 1
s_nop 3
v_add_f32_dpp v141, v141, v141 row_bcast:15 row_mask:0xa bank_mask:0xf
s_nop 1
v_add_f32_dpp v141, v141, v141 row_bcast:31 row_mask:0xc bank_mask:0xf
s_mov_b32 exec_lo, 0
s_brev_b32 exec_hi, 1
ds_write_b64 v149, v[140:141] offset:8448
s_mov_b32 exec_lo, -1
s_mov_b32 exec_hi, 0
ds_write_b128 v148, v[136:139] offset:0
s_mov_b64 exec, -1
s_waitcnt lgkmcnt(0)
v_mov_b32 v140, v167
v_mov_b32 v141, 0
v_mov_b32 v136, 0
v_mov_b32 v137, 0
v_mov_b32 v138, 0
v_mov_b32 v139, 0
s_branch L_A_swdc2
L_A_sigc:
s_mov_b32 s65, 1
s_atomic_add s65, s[52:53], 0x400 glc
s_branch L_A_sigdc
L_A_maxb:
v_max_f32_dpp v145, v145, v145 row_bcast:15 row_mask:0xa bank_mask:0xf
s_nop 1
v_max_f32_dpp v145, v145, v145 row_bcast:31 row_mask:0xc bank_mask:0xf
s_nop 0
v_readlane_b32 s62, v145, 63
s_nop 1
v_max_f32 v143, s62, v140
v_sub_f32 v142, v140, v143
v_exp_f32 v142, v142
v_mov_b32 v140, v143
v_mul_f32 v136, v136, v142
v_mul_f32 v137, v137, v142
v_mul_f32 v138, v138, v142
v_mul_f32 v139, v139, v142
v_mul_f32 v141, v141, v142
s_branch L_A_maxdb
L_A_sigb:
s_mov_b32 s65, 1
s_atomic_add s65, s[52:53], 0x400 glc
s_branch L_A_sigdb
L_roleW:
s_waitcnt lgkmcnt(0)
s_lshl_b32 s60, s32, 8
s_sub_u32 s61, 0x400000, s60
s_add_u32 s40, s18, s60
s_addc_u32 s41, s19, 0
s_and_b32 s41, s41, 0xffff
s_mov_b32 s42, s61
s_mov_b32 s43, 0x20000
s_add_u32 s44, s20, s60
s_addc_u32 s45, s21, 0
s_and_b32 s45, s45, 0xffff
s_mov_b32 s46, s61
s_mov_b32 s47, 0x20000
s_mov_b32 s48, s14
s_and_b32 s49, s15, 0xffff
s_mov_b32 s50, 0x800
s_mov_b32 s51, 0x20000
v_lshrrev_b32 v192, 3, v2
v_lshlrev_b32 v192, 10, v192
v_lshl_add_u32 v192, v3, 5, v192
s_lshl_b32 s62, s34, 7
v_add_u32 v192, s62, v192
s_mov_b32 s80, 0
buffer_load_dwordx4 v[12:15], v192, s[48:51], 0 offen
buffer_load_dwordx4 v[16:19], v192, s[48:51], 0 offen offset:16
v_lshlrev_b32 v9, 17, v3
v_lshl_add_u32 v9, v2, 4, v9
s_lshl_b32 s62, s34, 19
v_add_u32 v9, s62, v9
s_xor_b32 s62, s80, 0
buffer_load_dwordx4 v[64:67], v9, s[40:43], s62 offen nt
s_xor_b32 s62, s80, 8192
buffer_load_dwordx4 v[68:71], v9, s[40:43], s62 offen nt
s_xor_b32 s62, s80, 16384
buffer_load_dwordx4 v[72:75], v9, s[40:43], s62 offen nt
s_xor_b32 s62, s80, 24576
buffer_load_dwordx4 v[76:79], v9, s[40:43], s62 offen nt
s_xor_b32 s62, s80, 32768
buffer_load_dwordx4 v[80:83], v9, s[40:43], s62 offen nt
s_xor_b32 s62, s80, 40960
buffer_load_dwordx4 v[84:87], v9, s[40:43], s62 offen nt
s_xor_b32 s62, s80, 49152
buffer_load_dwordx4 v[88:91], v9, s[40:43], s62 offen nt
s_xor_b32 s62, s80, 57344
buffer_load_dwordx4 v[92:95], v9, s[40:43], s62 offen nt
s_xor_b32 s62, s80, 65536
buffer_load_dwordx4 v[96:99], v9, s[40:43], s62 offen nt
s_xor_b32 s62, s80, 73728
buffer_load_dwordx4 v[100:103], v9, s[40:43], s62 offen nt
s_xor_b32 s62, s80, 81920
buffer_load_dwordx4 v[104:107], v9, s[40:43], s62 offen nt
s_xor_b32 s62, s80, 90112
buffer_load_dwordx4 v[108:111], v9, s[40:43], s62 offen nt
s_xor_b32 s62, s80, 98304
buffer_load_dwordx4 v[112:115], v9, s[40:43], s62 offen nt
s_xor_b32 s62, s80, 106496
buffer_load_dwordx4 v[116:119], v9, s[40:43], s62 offen nt
s_xor_b32 s62, s80, 114688
buffer_load_dwordx4 v[120:123], v9, s[40:43], s62 offen nt
s_xor_b32 s62, s80, 122880
buffer_load_dwordx4 v[124:127], v9, s[40:43], s62 offen nt
v_mov_b32 v8, 0
s_mov_b32 s52, s30
s_and_b32 s53, s31, 0xffff
s_mov_b32 s54, 0x1000000
s_mov_b32 s55, 0x20000
s_load_dword s58, s[30:31], 0x14000
v_and_b32 v192, 1, v0
v_lshlrev_b32 v192, 4, v192
v_mov_b32 v193, 0xffff
v_lshlrev_b32 v192, v192, v193
v_bfe_u32 v193, v0, 1, 2
v_cmp_eq_u32 vcc, 0, v193
s_nop 1
v_cndmask_b32 v4, 0, v192, vcc
v_cmp_eq_u32 vcc, 1, v193
s_nop 1
v_cndmask_b32 v5, 0, v192, vcc
v_cmp_eq_u32 vcc, 2, v193
s_nop 1
v_cndmask_b32 v6, 0, v192, vcc
v_cmp_eq_u32 vcc, 3, v193
s_nop 1
v_cndmask_b32 v7, 0, v192, vcc
s_barrier
s_waitcnt vmcnt(16)
s_mov_b32 s60, 0x01000100
v_perm_b32 v192, v12, v12, s60
v_and_b32 v28, v192, v4
v_and_b32 v29, v192, v5
v_and_b32 v30, v192, v6
v_and_b32 v31, v192, v7
s_waitcnt vmcnt(15)
s_nop 0
v_mfma_f32_16x16x32_bf16 v[44:47], v[28:31], v[64:67], 0
s_xor_b32 s62, s80, 0
buffer_load_dwordx4 v[128:131], v9, s[44:47], s62 offen nt
s_mov_b32 s60, 0x03020302
v_perm_b32 v193, v12, v12, s60
v_and_b32 v32, v193, v4
v_and_b32 v33, v193, v5
v_and_b32 v34, v193, v6
v_and_b32 v35, v193, v7
s_waitcnt vmcnt(15)
s_nop 0
v_mfma_f32_16x16x32_bf16 v[44:47], v[32:35], v[68:71], v[44:47]
s_xor_b32 s62, s80, 8192
buffer_load_dwordx4 v[132:135], v9, s[44:47], s62 offen nt
s_mov_b32 s60, 0x01000100
v_perm_b32 v192, v13, v13, s60
v_and_b32 v28, v192, v4
v_and_b32 v29, v192, v5
v_and_b32 v30, v192, v6
v_and_b32 v31, v192, v7
s_waitcnt vmcnt(15)
s_nop 0
v_mfma_f32_16x16x32_bf16 v[44:47], v[28:31], v[72:75], v[44:47]
s_xor_b32 s62, s80, 16384
buffer_load_dwordx4 v[136:139], v9, s[44:47], s62 offen nt
s_mov_b32 s60, 0x03020302
v_perm_b32 v193, v13, v13, s60
v_and_b32 v32, v193, v4
v_and_b32 v33, v193, v5
v_and_b32 v34, v193, v6
v_and_b32 v35, v193, v7
s_waitcnt vmcnt(15)
s_nop 0
v_mfma_f32_16x16x32_bf16 v[44:47], v[32:35], v[76:79], v[44:47]
s_xor_b32 s62, s80, 24576
buffer_load_dwordx4 v[140:143], v9, s[44:47], s62 offen nt
s_mov_b32 s60, 0x01000100
v_perm_b32 v192, v14, v14, s60
v_and_b32 v28, v192, v4
v_and_b32 v29, v192, v5
v_and_b32 v30, v192, v6
v_and_b32 v31, v192, v7
s_waitcnt vmcnt(15)
s_nop 0
v_mfma_f32_16x16x32_bf16 v[44:47], v[28:31], v[80:83], v[44:47]
s_xor_b32 s62, s80, 32768
buffer_load_dwordx4 v[144:147], v9, s[44:47], s62 offen nt
s_mov_b32 s60, 0x03020302
v_perm_b32 v193, v14, v14, s60
v_and_b32 v32, v193, v4
v_and_b32 v33, v193, v5
v_and_b32 v34, v193, v6
v_and_b32 v35, v193, v7
s_waitcnt vmcnt(15)
s_nop 0
v_mfma_f32_16x16x32_bf16 v[44:47], v[32:35], v[84:87], v[44:47]
s_xor_b32 s62, s80, 40960
buffer_load_dwordx4 v[148:151], v9, s[44:47], s62 offen nt
s_mov_b32 s60, 0x01000100
v_perm_b32 v192, v15, v15, s60
v_and_b32 v28, v192, v4
v_and_b32 v29, v192, v5
v_and_b32 v30, v192, v6
v_and_b32 v31, v192, v7
s_waitcnt vmcnt(15)
s_nop 0
v_mfma_f32_16x16x32_bf16 v[44:47], v[28:31], v[88:91], v[44:47]
s_xor_b32 s62, s80, 49152
buffer_load_dwordx4 v[152:155], v9, s[44:47], s62 offen nt
s_mov_b32 s60, 0x03020302
v_perm_b32 v193, v15, v15, s60
v_and_b32 v32, v193, v4
v_and_b32 v33, v193, v5
v_and_b32 v34, v193, v6
v_and_b32 v35, v193, v7
s_waitcnt vmcnt(15)
s_nop 0
v_mfma_f32_16x16x32_bf16 v[44:47], v[32:35], v[92:95], v[44:47]
s_xor_b32 s62, s80, 57344
buffer_load_dwordx4 v[156:159], v9, s[44:47], s62 offen nt
s_mov_b32 s60, 0x01000100
v_perm_b32 v192, v16, v16, s60
v_and_b32 v28, v192, v4
v_and_b32 v29, v192, v5
v_and_b32 v30, v192, v6
v_and_b32 v31, v192, v7
s_waitcnt vmcnt(15)
s_nop 0
v_mfma_f32_16x16x32_bf16 v[44:47], v[28:31], v[96:99], v[44:47]
s_xor_b32 s62, s80, 65536
buffer_load_dwordx4 v[160:163], v9, s[44:47], s62 offen nt
s_mov_b32 s60, 0x03020302
v_perm_b32 v193, v16, v16, s60
v_and_b32 v32, v193, v4
v_and_b32 v33, v193, v5
v_and_b32 v34, v193, v6
v_and_b32 v35, v193, v7
s_waitcnt vmcnt(15)
s_nop 0
v_mfma_f32_16x16x32_bf16 v[44:47], v[32:35], v[100:103], v[44:47]
s_xor_b32 s62, s80, 73728
buffer_load_dwordx4 v[164:167], v9, s[44:47], s62 offen nt
s_mov_b32 s60, 0x01000100
v_perm_b32 v192, v17, v17, s60
v_and_b32 v28, v192, v4
v_and_b32 v29, v192, v5
v_and_b32 v30, v192, v6
v_and_b32 v31, v192, v7
s_waitcnt vmcnt(15)
s_nop 0
v_mfma_f32_16x16x32_bf16 v[44:47], v[28:31], v[104:107], v[44:47]
s_xor_b32 s62, s80, 81920
buffer_load_dwordx4 v[168:171], v9, s[44:47], s62 offen nt
s_mov_b32 s60, 0x03020302
v_perm_b32 v193, v17, v17, s60
v_and_b32 v32, v193, v4
v_and_b32 v33, v193, v5
v_and_b32 v34, v193, v6
v_and_b32 v35, v193, v7
s_waitcnt vmcnt(15)
s_nop 0
v_mfma_f32_16x16x32_bf16 v[44:47], v[32:35], v[108:111], v[44:47]
s_xor_b32 s62, s80, 90112
buffer_load_dwordx4 v[172:175], v9, s[44:47], s62 offen nt
s_mov_b32 s60, 0x01000100
v_perm_b32 v192, v18, v18, s60
v_and_b32 v28, v192, v4
v_and_b32 v29, v192, v5
v_and_b32 v30, v192, v6
v_and_b32 v31, v192, v7
s_waitcnt vmcnt(15)
s_nop 0
v_mfma_f32_16x16x32_bf16 v[44:47], v[28:31], v[112:115], v[44:47]
s_xor_b32 s62, s80, 98304
buffer_load_dwordx4 v[176:179], v9, s[44:47], s62 offen nt
s_mov_b32 s60, 0x03020302
v_perm_b32 v193, v18, v18, s60
v_and_b32 v32, v193, v4
v_and_b32 v33, v193, v5
v_and_b32 v34, v193, v6
v_and_b32 v35, v193, v7
s_waitcnt vmcnt(15)
s_nop 0
v_mfma_f32_16x16x32_bf16 v[44:47], v[32:35], v[116:119], v[44:47]
s_xor_b32 s62, s80, 106496
buffer_load_dwordx4 v[180:183], v9, s[44:47], s62 offen nt
s_mov_b32 s60, 0x01000100
v_perm_b32 v192, v19, v19, s60
v_and_b32 v28, v192, v4
v_and_b32 v29, v192, v5
v_and_b32 v30, v192, v6
v_and_b32 v31, v192, v7
s_waitcnt vmcnt(15)
s_nop 0
v_mfma_f32_16x16x32_bf16 v[44:47], v[28:31], v[120:123], v[44:47]
s_xor_b32 s62, s80, 114688
buffer_load_dwordx4 v[184:187], v9, s[44:47], s62 offen nt
s_mov_b32 s60, 0x03020302
v_perm_b32 v193, v19, v19, s60
v_and_b32 v32, v193, v4
v_and_b32 v33, v193, v5
v_and_b32 v34, v193, v6
v_and_b32 v35, v193, v7
s_waitcnt vmcnt(15)
s_nop 0
v_mfma_f32_16x16x32_bf16 v[44:47], v[32:35], v[124:127], v[44:47]
s_xor_b32 s62, s80, 122880
buffer_load_dwordx4 v[188:191], v9, s[44:47], s62 offen nt
v_lshrrev_b32 v192, 1, v3
v_lshlrev_b32 v192, 9, v192
v_lshl_add_u32 v192, v2, 5, v192
v_and_b32 v193, 1, v3
v_lshl_add_u32 v192, v193, 4, v192
s_lshl_b32 s63, s34, 10
v_add_u32 v192, s63, v192
s_nop 1
s_nop 5
ds_write_b128 v192, v[44:47] offset:0
s_waitcnt lgkmcnt(0)
s_barrier
s_cmp_ge_u32 s34, 4
s_cbranch_scc1 L_W_qskip
v_lshlrev_b32 v194, 2, v0
ds_read_b32 v196, v194 offset:0
ds_read_b32 v197, v194 offset:1024
ds_read_b32 v198, v194 offset:2048
ds_read_b32 v199, v194 offset:3072
ds_read_b32 v200, v194 offset:4096
ds_read_b32 v201, v194 offset:5120
ds_read_b32 v202, v194 offset:6144
ds_read_b32 v203, v194 offset:7168
s_waitcnt lgkmcnt(0)
v_add_f32 v196, v196, v197
v_add_f32 v196, v196, v198
v_add_f32 v196, v196, v199
v_add_f32 v196, v196, v200
v_add_f32 v196, v196, v201
v_add_f32 v196, v196, v202
v_add_f32 v196, v196, v203
v_cvt_pk_bf16_f32 v196, v196, v196
v_lshlrev_b32 v194, 1, v0
ds_write_b16 v194, v196 offset:8192
s_waitcnt lgkmcnt(0)
L_W_qskip:
s_barrier
v_lshlrev_b32 v194, 4, v2
ds_read_b128 v[20:23], v194 offset:8192
ds_read_b128 v[24:27], v194 offset:8448
s_xor_b32 s60, s32, 7
s_lshl_b32 s60, s60, 8
s_sub_u32 s61, 0x400000, s60
s_add_u32 s40, s22, s60
s_addc_u32 s41, s23, 0
s_and_b32 s41, s41, 0xffff
s_mov_b32 s42, s61
s_mov_b32 s43, 0x20000
s_xor_b32 s62, s80, 0
buffer_load_dwordx4 v[64:67], v9, s[40:43], s62 offen nt
s_xor_b32 s62, s80, 8192
buffer_load_dwordx4 v[68:71], v9, s[40:43], s62 offen nt
s_xor_b32 s62, s80, 16384
buffer_load_dwordx4 v[72:75], v9, s[40:43], s62 offen nt
s_xor_b32 s62, s80, 24576
buffer_load_dwordx4 v[76:79], v9, s[40:43], s62 offen nt
s_xor_b32 s62, s80, 32768
buffer_load_dwordx4 v[80:83], v9, s[40:43], s62 offen nt
s_xor_b32 s62, s80, 40960
buffer_load_dwordx4 v[84:87], v9, s[40:43], s62 offen nt
s_xor_b32 s62, s80, 49152
buffer_load_dwordx4 v[88:91], v9, s[40:43], s62 offen nt
s_xor_b32 s62, s80, 57344
buffer_load_dwordx4 v[92:95], v9, s[40:43], s62 offen nt
s_xor_b32 s62, s80, 65536
buffer_load_dwordx4 v[96:99], v9, s[40:43], s62 offen nt
s_xor_b32 s62, s80, 73728
buffer_load_dwordx4 v[100:103], v9, s[40:43], s62 offen nt
s_xor_b32 s62, s80, 81920
buffer_load_dwordx4 v[104:107], v9, s[40:43], s62 offen nt
s_xor_b32 s62, s80, 90112
buffer_load_dwordx4 v[108:111], v9, s[40:43], s62 offen nt
s_xor_b32 s62, s80, 98304
buffer_load_dwordx4 v[112:115], v9, s[40:43], s62 offen nt
s_xor_b32 s62, s80, 106496
buffer_load_dwordx4 v[116:119], v9, s[40:43], s62 offen nt
s_xor_b32 s62, s80, 114688
buffer_load_dwordx4 v[120:123], v9, s[40:43], s62 offen nt
s_xor_b32 s62, s80, 122880
buffer_load_dwordx4 v[124:127], v9, s[40:43], s62 offen nt
s_xor_b32 s60, s32, 7
s_lshl_b32 s60, s60, 17
s_mov_b32 s61, 0x20000
s_add_u32 s44, s24, s60
s_addc_u32 s45, s25, 0
s_and_b32 s45, s45, 0xffff
s_mov_b32 s46, s61
s_mov_b32 s47, 0x20000
v_lshlrev_b32 v10, 12, v3
v_lshl_add_u32 v10, v2, 4, v10
s_lshl_b32 s62, s34, 14
v_add_u32 v10, s62, v10
v_mov_b32 v200, 0
v_mov_b32 v201, 0
s_lshr_b32 s62, s80, 13
v_xor_b32 v202, s62, v2
s_waitcnt lgkmcnt(0)
s_add_u32 s58, s58, 0x9e3779b9
s_bfe_u32 s76, s58, 0x80000
s_bfe_u32 s77, s58, 0x80008
s_bfe_u32 s78, s58, 0x80010
s_bfe_u32 s79, s58, 0x80018
s_waitcnt vmcnt(30)
v_dot2_f32_bf16 v60, v128, v20, 0
v_dot2_f32_bf16 v61, v128, v24, 0
v_dot2_f32_bf16 v62, v132, v20, 0
v_dot2_f32_bf16 v63, v132, v24, 0
v_dot2_f32_bf16 v60, v129, v21, v60
v_dot2_f32_bf16 v61, v129, v25, v61
v_dot2_f32_bf16 v62, v133, v21, v62
v_dot2_f32_bf16 v63, v133, v25, v63
v_dot2_f32_bf16 v60, v130, v22, v60
v_dot2_f32_bf16 v61, v130, v26, v61
v_dot2_f32_bf16 v62, v134, v22, v62
v_dot2_f32_bf16 v63, v134, v26, v63
v_dot2_f32_bf16 v60, v131, v23, v60
v_dot2_f32_bf16 v61, v131, v27, v61
v_dot2_f32_bf16 v62, v135, v23, v62
v_dot2_f32_bf16 v63, v135, v27, v63
buffer_load_dwordx4 v[128:131], v10, s[44:47], 0 offen offset:0 nt
buffer_load_dwordx4 v[132:135], v10, s[44:47], 0 offen offset:256 nt
v_add_f32_dpp v60, v60, v60 row_ror:8 row_mask:0xf bank_mask:0xf
v_add_f32_dpp v61, v61, v61 row_ror:8 row_mask:0xf bank_mask:0xf
v_add_f32_dpp v62, v62, v62 row_ror:8 row_mask:0xf bank_mask:0xf
v_add_f32_dpp v63, v63, v63 row_ror:8 row_mask:0xf bank_mask:0xf
v_add_f32_dpp v60, v60, v60 row_ror:4 row_mask:0xf bank_mask:0xf
v_add_f32_dpp v61, v61, v61 row_ror:4 row_mask:0xf bank_mask:0xf
v_add_f32_dpp v62, v62, v62 row_ror:4 row_mask:0xf bank_mask:0xf
v_add_f32_dpp v63, v63, v63 row_ror:4 row_mask:0xf bank_mask:0xf
v_add_f32_dpp v60, v60, v60 row_ror:2 row_mask:0xf bank_mask:0xf
v_add_f32_dpp v61, v61, v61 row_ror:2 row_mask:0xf bank_mask:0xf
v_add_f32_dpp v62, v62, v62 row_ror:2 row_mask:0xf bank_mask:0xf
v_add_f32_dpp v63, v63, v63 row_ror:2 row_mask:0xf bank_mask:0xf
v_add_f32_dpp v60, v60, v60 row_ror:1 row_mask:0xf bank_mask:0xf
v_add_f32_dpp v61, v61, v61 row_ror:1 row_mask:0xf bank_mask:0xf
v_add_f32_dpp v62, v62, v62 row_ror:1 row_mask:0xf bank_mask:0xf
v_add_f32_dpp v63, v63, v63 row_ror:1 row_mask:0xf bank_mask:0xf
v_cmp_eq_u32 vcc, 0, v202
s_nop 1
v_cndmask_b32 v200, v200, v60, vcc
v_cndmask_b32 v201, v201, v61, vcc
v_cmp_eq_u32 vcc, 1, v202
s_nop 1
v_cndmask_b32 v200, v200, v62, vcc
v_cndmask_b32 v201, v201, v63, vcc
s_waitcnt vmcnt(30)
v_dot2_f32_bf16 v60, v136, v20, 0
v_dot2_f32_bf16 v61, v136, v24, 0
v_dot2_f32_bf16 v62, v140, v20, 0
v_dot2_f32_bf16 v63, v140, v24, 0
v_dot2_f32_bf16 v60, v137, v21, v60
v_dot2_f32_bf16 v61, v137, v25, v61
v_dot2_f32_bf16 v62, v141, v21, v62
v_dot2_f32_bf16 v63, v141, v25, v63
v_dot2_f32_bf16 v60, v138, v22, v60
v_dot2_f32_bf16 v61, v138, v26, v61
v_dot2_f32_bf16 v62, v142, v22, v62
v_dot2_f32_bf16 v63, v142, v26, v63
v_dot2_f32_bf16 v60, v139, v23, v60
v_dot2_f32_bf16 v61, v139, v27, v61
v_dot2_f32_bf16 v62, v143, v23, v62
v_dot2_f32_bf16 v63, v143, v27, v63
buffer_load_dwordx4 v[136:139], v10, s[44:47], 0 offen offset:512 nt
buffer_load_dwordx4 v[140:143], v10, s[44:47], 0 offen offset:768 nt
v_add_f32_dpp v60, v60, v60 row_ror:8 row_mask:0xf bank_mask:0xf
v_add_f32_dpp v61, v61, v61 row_ror:8 row_mask:0xf bank_mask:0xf
v_add_f32_dpp v62, v62, v62 row_ror:8 row_mask:0xf bank_mask:0xf
v_add_f32_dpp v63, v63, v63 row_ror:8 row_mask:0xf bank_mask:0xf
v_add_f32_dpp v60, v60, v60 row_ror:4 row_mask:0xf bank_mask:0xf
v_add_f32_dpp v61, v61, v61 row_ror:4 row_mask:0xf bank_mask:0xf
v_add_f32_dpp v62, v62, v62 row_ror:4 row_mask:0xf bank_mask:0xf
v_add_f32_dpp v63, v63, v63 row_ror:4 row_mask:0xf bank_mask:0xf
v_add_f32_dpp v60, v60, v60 row_ror:2 row_mask:0xf bank_mask:0xf
v_add_f32_dpp v61, v61, v61 row_ror:2 row_mask:0xf bank_mask:0xf
v_add_f32_dpp v62, v62, v62 row_ror:2 row_mask:0xf bank_mask:0xf
v_add_f32_dpp v63, v63, v63 row_ror:2 row_mask:0xf bank_mask:0xf
v_add_f32_dpp v60, v60, v60 row_ror:1 row_mask:0xf bank_mask:0xf
v_add_f32_dpp v61, v61, v61 row_ror:1 row_mask:0xf bank_mask:0xf
v_add_f32_dpp v62, v62, v62 row_ror:1 row_mask:0xf bank_mask:0xf
v_add_f32_dpp v63, v63, v63 row_ror:1 row_mask:0xf bank_mask:0xf
v_cmp_eq_u32 vcc, 2, v202
s_nop 1
v_cndmask_b32 v200, v200, v60, vcc
v_cndmask_b32 v201, v201, v61, vcc
v_cmp_eq_u32 vcc, 3, v202
s_nop 1
v_cndmask_b32 v200, v200, v62, vcc
v_cndmask_b32 v201, v201, v63, vcc
s_waitcnt vmcnt(30)
v_dot2_f32_bf16 v60, v144, v20, 0
v_dot2_f32_bf16 v61, v144, v24, 0
v_dot2_f32_bf16 v62, v148, v20, 0
v_dot2_f32_bf16 v63, v148, v24, 0
v_dot2_f32_bf16 v60, v145, v21, v60
v_dot2_f32_bf16 v61, v145, v25, v61
v_dot2_f32_bf16 v62, v149, v21, v62
v_dot2_f32_bf16 v63, v149, v25, v63
v_dot2_f32_bf16 v60, v146, v22, v60
v_dot2_f32_bf16 v61, v146, v26, v61
v_dot2_f32_bf16 v62, v150, v22, v62
v_dot2_f32_bf16 v63, v150, v26, v63
v_dot2_f32_bf16 v60, v147, v23, v60
v_dot2_f32_bf16 v61, v147, v27, v61
v_dot2_f32_bf16 v62, v151, v23, v62
v_dot2_f32_bf16 v63, v151, v27, v63
buffer_load_dwordx4 v[144:147], v10, s[44:47], 0 offen offset:1024 nt
buffer_load_dwordx4 v[148:151], v10, s[44:47], 0 offen offset:1280 nt
v_add_f32_dpp v60, v60, v60 row_ror:8 row_mask:0xf bank_mask:0xf
v_add_f32_dpp v61, v61, v61 row_ror:8 row_mask:0xf bank_mask:0xf
v_add_f32_dpp v62, v62, v62 row_ror:8 row_mask:0xf bank_mask:0xf
v_add_f32_dpp v63, v63, v63 row_ror:8 row_mask:0xf bank_mask:0xf
v_add_f32_dpp v60, v60, v60 row_ror:4 row_mask:0xf bank_mask:0xf
v_add_f32_dpp v61, v61, v61 row_ror:4 row_mask:0xf bank_mask:0xf
v_add_f32_dpp v62, v62, v62 row_ror:4 row_mask:0xf bank_mask:0xf
v_add_f32_dpp v63, v63, v63 row_ror:4 row_mask:0xf bank_mask:0xf
v_add_f32_dpp v60, v60, v60 row_ror:2 row_mask:0xf bank_mask:0xf
v_add_f32_dpp v61, v61, v61 row_ror:2 row_mask:0xf bank_mask:0xf
v_add_f32_dpp v62, v62, v62 row_ror:2 row_mask:0xf bank_mask:0xf
v_add_f32_dpp v63, v63, v63 row_ror:2 row_mask:0xf bank_mask:0xf
v_add_f32_dpp v60, v60, v60 row_ror:1 row_mask:0xf bank_mask:0xf
v_add_f32_dpp v61, v61, v61 row_ror:1 row_mask:0xf bank_mask:0xf
v_add_f32_dpp v62, v62, v62 row_ror:1 row_mask:0xf bank_mask:0xf
v_add_f32_dpp v63, v63, v63 row_ror:1 row_mask:0xf bank_mask:0xf
v_cmp_eq_u32 vcc, 4, v202
s_nop 1
v_cndmask_b32 v200, v200, v60, vcc
v_cndmask_b32 v201, v201, v61, vcc
v_cmp_eq_u32 vcc, 5, v202
s_nop 1
v_cndmask_b32 v200, v200, v62, vcc
v_cndmask_b32 v201, v201, v63, vcc
s_waitcnt vmcnt(30)
v_dot2_f32_bf16 v60, v152, v20, 0
v_dot2_f32_bf16 v61, v152, v24, 0
v_dot2_f32_bf16 v62, v156, v20, 0
v_dot2_f32_bf16 v63, v156, v24, 0
v_dot2_f32_bf16 v60, v153, v21, v60
v_dot2_f32_bf16 v61, v153, v25, v61
v_dot2_f32_bf16 v62, v157, v21, v62
v_dot2_f32_bf16 v63, v157, v25, v63
v_dot2_f32_bf16 v60, v154, v22, v60
v_dot2_f32_bf16 v61, v154, v26, v61
v_dot2_f32_bf16 v62, v158, v22, v62
v_dot2_f32_bf16 v63, v158, v26, v63
v_dot2_f32_bf16 v60, v155, v23, v60
v_dot2_f32_bf16 v61, v155, v27, v61
v_dot2_f32_bf16 v62, v159, v23, v62
v_dot2_f32_bf16 v63, v159, v27, v63
buffer_load_dwordx4 v[152:155], v10, s[44:47], 0 offen offset:1536 nt
buffer_load_dwordx4 v[156:159], v10, s[44:47], 0 offen offset:1792 nt
v_add_f32_dpp v60, v60, v60 row_ror:8 row_mask:0xf bank_mask:0xf
v_add_f32_dpp v61, v61, v61 row_ror:8 row_mask:0xf bank_mask:0xf
v_add_f32_dpp v62, v62, v62 row_ror:8 row_mask:0xf bank_mask:0xf
v_add_f32_dpp v63, v63, v63 row_ror:8 row_mask:0xf bank_mask:0xf
v_add_f32_dpp v60, v60, v60 row_ror:4 row_mask:0xf bank_mask:0xf
v_add_f32_dpp v61, v61, v61 row_ror:4 row_mask:0xf bank_mask:0xf
v_add_f32_dpp v62, v62, v62 row_ror:4 row_mask:0xf bank_mask:0xf
v_add_f32_dpp v63, v63, v63 row_ror:4 row_mask:0xf bank_mask:0xf
v_add_f32_dpp v60, v60, v60 row_ror:2 row_mask:0xf bank_mask:0xf
v_add_f32_dpp v61, v61, v61 row_ror:2 row_mask:0xf bank_mask:0xf
v_add_f32_dpp v62, v62, v62 row_ror:2 row_mask:0xf bank_mask:0xf
v_add_f32_dpp v63, v63, v63 row_ror:2 row_mask:0xf bank_mask:0xf
v_add_f32_dpp v60, v60, v60 row_ror:1 row_mask:0xf bank_mask:0xf
v_add_f32_dpp v61, v61, v61 row_ror:1 row_mask:0xf bank_mask:0xf
v_add_f32_dpp v62, v62, v62 row_ror:1 row_mask:0xf bank_mask:0xf
v_add_f32_dpp v63, v63, v63 row_ror:1 row_mask:0xf bank_mask:0xf
v_cmp_eq_u32 vcc, 6, v202
s_nop 1
v_cndmask_b32 v200, v200, v60, vcc
v_cndmask_b32 v201, v201, v61, vcc
v_cmp_eq_u32 vcc, 7, v202
s_nop 1
v_cndmask_b32 v200, v200, v62, vcc
v_cndmask_b32 v201, v201, v63, vcc
s_waitcnt vmcnt(30)
v_dot2_f32_bf16 v60, v160, v20, 0
v_dot2_f32_bf16 v61, v160, v24, 0
v_dot2_f32_bf16 v62, v164, v20, 0
v_dot2_f32_bf16 v63, v164, v24, 0
v_dot2_f32_bf16 v60, v161, v21, v60
v_dot2_f32_bf16 v61, v161, v25, v61
v_dot2_f32_bf16 v62, v165, v21, v62
v_dot2_f32_bf16 v63, v165, v25, v63
v_dot2_f32_bf16 v60, v162, v22, v60
v_dot2_f32_bf16 v61, v162, v26, v61
v_dot2_f32_bf16 v62, v166, v22, v62
v_dot2_f32_bf16 v63, v166, v26, v63
v_dot2_f32_bf16 v60, v163, v23, v60
v_dot2_f32_bf16 v61, v163, v27, v61
v_dot2_f32_bf16 v62, v167, v23, v62
v_dot2_f32_bf16 v63, v167, v27, v63
buffer_load_dwordx4 v[160:163], v10, s[44:47], 0 offen offset:2048 nt
buffer_load_dwordx4 v[164:167], v10, s[44:47], 0 offen offset:2304 nt
v_add_f32_dpp v60, v60, v60 row_ror:8 row_mask:0xf bank_mask:0xf
v_add_f32_dpp v61, v61, v61 row_ror:8 row_mask:0xf bank_mask:0xf
v_add_f32_dpp v62, v62, v62 row_ror:8 row_mask:0xf bank_mask:0xf
v_add_f32_dpp v63, v63, v63 row_ror:8 row_mask:0xf bank_mask:0xf
v_add_f32_dpp v60, v60, v60 row_ror:4 row_mask:0xf bank_mask:0xf
v_add_f32_dpp v61, v61, v61 row_ror:4 row_mask:0xf bank_mask:0xf
v_add_f32_dpp v62, v62, v62 row_ror:4 row_mask:0xf bank_mask:0xf
v_add_f32_dpp v63, v63, v63 row_ror:4 row_mask:0xf bank_mask:0xf
v_add_f32_dpp v60, v60, v60 row_ror:2 row_mask:0xf bank_mask:0xf
v_add_f32_dpp v61, v61, v61 row_ror:2 row_mask:0xf bank_mask:0xf
v_add_f32_dpp v62, v62, v62 row_ror:2 row_mask:0xf bank_mask:0xf
v_add_f32_dpp v63, v63, v63 row_ror:2 row_mask:0xf bank_mask:0xf
v_add_f32_dpp v60, v60, v60 row_ror:1 row_mask:0xf bank_mask:0xf
v_add_f32_dpp v61, v61, v61 row_ror:1 row_mask:0xf bank_mask:0xf
v_add_f32_dpp v62, v62, v62 row_ror:1 row_mask:0xf bank_mask:0xf
v_add_f32_dpp v63, v63, v63 row_ror:1 row_mask:0xf bank_mask:0xf
v_cmp_eq_u32 vcc, 8, v202
s_nop 1
v_cndmask_b32 v200, v200, v60, vcc
v_cndmask_b32 v201, v201, v61, vcc
v_cmp_eq_u32 vcc, 9, v202
s_nop 1
v_cndmask_b32 v200, v200, v62, vcc
v_cndmask_b32 v201, v201, v63, vcc
s_waitcnt vmcnt(30)
v_dot2_f32_bf16 v60, v168, v20, 0
v_dot2_f32_bf16 v61, v168, v24, 0
v_dot2_f32_bf16 v62, v172, v20, 0
v_dot2_f32_bf16 v63, v172, v24, 0
v_dot2_f32_bf16 v60, v169, v21, v60
v_dot2_f32_bf16 v61, v169, v25, v61
v_dot2_f32_bf16 v62, v173, v21, v62
v_dot2_f32_bf16 v63, v173, v25, v63
v_dot2_f32_bf16 v60, v170, v22, v60
v_dot2_f32_bf16 v61, v170, v26, v61
v_dot2_f32_bf16 v62, v174, v22, v62
v_dot2_f32_bf16 v63, v174, v26, v63
v_dot2_f32_bf16 v60, v171, v23, v60
v_dot2_f32_bf16 v61, v171, v27, v61
v_dot2_f32_bf16 v62, v175, v23, v62
v_dot2_f32_bf16 v63, v175, v27, v63
buffer_load_dwordx4 v[168:171], v10, s[44:47], 0 offen offset:2560 nt
buffer_load_dwordx4 v[172:175], v10, s[44:47], 0 offen offset:2816 nt
v_add_f32_dpp v60, v60, v60 row_ror:8 row_mask:0xf bank_mask:0xf
v_add_f32_dpp v61, v61, v61 row_ror:8 row_mask:0xf bank_mask:0xf
v_add_f32_dpp v62, v62, v62 row_ror:8 row_mask:0xf bank_mask:0xf
v_add_f32_dpp v63, v63, v63 row_ror:8 row_mask:0xf bank_mask:0xf
v_add_f32_dpp v60, v60, v60 row_ror:4 row_mask:0xf bank_mask:0xf
v_add_f32_dpp v61, v61, v61 row_ror:4 row_mask:0xf bank_mask:0xf
v_add_f32_dpp v62, v62, v62 row_ror:4 row_mask:0xf bank_mask:0xf
v_add_f32_dpp v63, v63, v63 row_ror:4 row_mask:0xf bank_mask:0xf
v_add_f32_dpp v60, v60, v60 row_ror:2 row_mask:0xf bank_mask:0xf
v_add_f32_dpp v61, v61, v61 row_ror:2 row_mask:0xf bank_mask:0xf
v_add_f32_dpp v62, v62, v62 row_ror:2 row_mask:0xf bank_mask:0xf
v_add_f32_dpp v63, v63, v63 row_ror:2 row_mask:0xf bank_mask:0xf
v_add_f32_dpp v60, v60, v60 row_ror:1 row_mask:0xf bank_mask:0xf
v_add_f32_dpp v61, v61, v61 row_ror:1 row_mask:0xf bank_mask:0xf
v_add_f32_dpp v62, v62, v62 row_ror:1 row_mask:0xf bank_mask:0xf
v_add_f32_dpp v63, v63, v63 row_ror:1 row_mask:0xf bank_mask:0xf
v_cmp_eq_u32 vcc, 10, v202
s_nop 1
v_cndmask_b32 v200, v200, v60, vcc
v_cndmask_b32 v201, v201, v61, vcc
v_cmp_eq_u32 vcc, 11, v202
s_nop 1
v_cndmask_b32 v200, v200, v62, vcc
v_cndmask_b32 v201, v201, v63, vcc
s_waitcnt vmcnt(30)
v_dot2_f32_bf16 v60, v176, v20, 0
v_dot2_f32_bf16 v61, v176, v24, 0
v_dot2_f32_bf16 v62, v180, v20, 0
v_dot2_f32_bf16 v63, v180, v24, 0
v_dot2_f32_bf16 v60, v177, v21, v60
v_dot2_f32_bf16 v61, v177, v25, v61
v_dot2_f32_bf16 v62, v181, v21, v62
v_dot2_f32_bf16 v63, v181, v25, v63
v_dot2_f32_bf16 v60, v178, v22, v60
v_dot2_f32_bf16 v61, v178, v26, v61
v_dot2_f32_bf16 v62, v182, v22, v62
v_dot2_f32_bf16 v63, v182, v26, v63
v_dot2_f32_bf16 v60, v179, v23, v60
v_dot2_f32_bf16 v61, v179, v27, v61
v_dot2_f32_bf16 v62, v183, v23, v62
v_dot2_f32_bf16 v63, v183, v27, v63
buffer_load_dwordx4 v[176:179], v10, s[44:47], 0 offen offset:3072 nt
buffer_load_dwordx4 v[180:183], v10, s[44:47], 0 offen offset:3328 nt
v_add_f32_dpp v60, v60, v60 row_ror:8 row_mask:0xf bank_mask:0xf
v_add_f32_dpp v61, v61, v61 row_ror:8 row_mask:0xf bank_mask:0xf
v_add_f32_dpp v62, v62, v62 row_ror:8 row_mask:0xf bank_mask:0xf
v_add_f32_dpp v63, v63, v63 row_ror:8 row_mask:0xf bank_mask:0xf
v_add_f32_dpp v60, v60, v60 row_ror:4 row_mask:0xf bank_mask:0xf
v_add_f32_dpp v61, v61, v61 row_ror:4 row_mask:0xf bank_mask:0xf
v_add_f32_dpp v62, v62, v62 row_ror:4 row_mask:0xf bank_mask:0xf
v_add_f32_dpp v63, v63, v63 row_ror:4 row_mask:0xf bank_mask:0xf
v_add_f32_dpp v60, v60, v60 row_ror:2 row_mask:0xf bank_mask:0xf
v_add_f32_dpp v61, v61, v61 row_ror:2 row_mask:0xf bank_mask:0xf
v_add_f32_dpp v62, v62, v62 row_ror:2 row_mask:0xf bank_mask:0xf
v_add_f32_dpp v63, v63, v63 row_ror:2 row_mask:0xf bank_mask:0xf
v_add_f32_dpp v60, v60, v60 row_ror:1 row_mask:0xf bank_mask:0xf
v_add_f32_dpp v61, v61, v61 row_ror:1 row_mask:0xf bank_mask:0xf
v_add_f32_dpp v62, v62, v62 row_ror:1 row_mask:0xf bank_mask:0xf
v_add_f32_dpp v63, v63, v63 row_ror:1 row_mask:0xf bank_mask:0xf
v_cmp_eq_u32 vcc, 12, v202
s_nop 1
v_cndmask_b32 v200, v200, v60, vcc
v_cndmask_b32 v201, v201, v61, vcc
v_cmp_eq_u32 vcc, 13, v202
s_nop 1
v_cndmask_b32 v200, v200, v62, vcc
v_cndmask_b32 v201, v201, v63, vcc
s_waitcnt vmcnt(30)
v_dot2_f32_bf16 v60, v184, v20, 0
v_dot2_f32_bf16 v61, v184, v24, 0
v_dot2_f32_bf16 v62, v188, v20, 0
v_dot2_f32_bf16 v63, v188, v24, 0
v_dot2_f32_bf16 v60, v185, v21, v60
v_dot2_f32_bf16 v61, v185, v25, v61
v_dot2_f32_bf16 v62, v189, v21, v62
v_dot2_f32_bf16 v63, v189, v25, v63
v_dot2_f32_bf16 v60, v186, v22, v60
v_dot2_f32_bf16 v61, v186, v26, v61
v_dot2_f32_bf16 v62, v190, v22, v62
v_dot2_f32_bf16 v63, v190, v26, v63
v_dot2_f32_bf16 v60, v187, v23, v60
v_dot2_f32_bf16 v61, v187, v27, v61
v_dot2_f32_bf16 v62, v191, v23, v62
v_dot2_f32_bf16 v63, v191, v27, v63
buffer_load_dwordx4 v[184:187], v10, s[44:47], 0 offen offset:3584 nt
buffer_load_dwordx4 v[188:191], v10, s[44:47], 0 offen offset:3840 nt
v_add_f32_dpp v60, v60, v60 row_ror:8 row_mask:0xf bank_mask:0xf
v_add_f32_dpp v61, v61, v61 row_ror:8 row_mask:0xf bank_mask:0xf
v_add_f32_dpp v62, v62, v62 row_ror:8 row_mask:0xf bank_mask:0xf
v_add_f32_dpp v63, v63, v63 row_ror:8 row_mask:0xf bank_mask:0xf
v_add_f32_dpp v60, v60, v60 row_ror:4 row_mask:0xf bank_mask:0xf
v_add_f32_dpp v61, v61, v61 row_ror:4 row_mask:0xf bank_mask:0xf
v_add_f32_dpp v62, v62, v62 row_ror:4 row_mask:0xf bank_mask:0xf
v_add_f32_dpp v63, v63, v63 row_ror:4 row_mask:0xf bank_mask:0xf
v_add_f32_dpp v60, v60, v60 row_ror:2 row_mask:0xf bank_mask:0xf
v_add_f32_dpp v61, v61, v61 row_ror:2 row_mask:0xf bank_mask:0xf
v_add_f32_dpp v62, v62, v62 row_ror:2 row_mask:0xf bank_mask:0xf
v_add_f32_dpp v63, v63, v63 row_ror:2 row_mask:0xf bank_mask:0xf
v_add_f32_dpp v60, v60, v60 row_ror:1 row_mask:0xf bank_mask:0xf
v_add_f32_dpp v61, v61, v61 row_ror:1 row_mask:0xf bank_mask:0xf
v_add_f32_dpp v62, v62, v62 row_ror:1 row_mask:0xf bank_mask:0xf
v_add_f32_dpp v63, v63, v63 row_ror:1 row_mask:0xf bank_mask:0xf
v_cmp_eq_u32 vcc, 14, v202
s_nop 1
v_cndmask_b32 v200, v200, v60, vcc
v_cndmask_b32 v201, v201, v61, vcc
v_cmp_eq_u32 vcc, 15, v202
s_nop 1
v_cndmask_b32 v200, v200, v62, vcc
v_cndmask_b32 v201, v201, v63, vcc
v_cvt_pk_bf16_f32 v200, v200, v200
v_cvt_pk_bf16_f32 v201, v201, v201
v_lshlrev_b32 v192, 1, v0
ds_write_b16 v192, v200 offset:0
ds_write_b16 v192, v201 offset:1024
s_waitcnt lgkmcnt(0)
s_barrier
s_cmp_lg_u32 s34, 0
s_cbranch_scc1 L_W_q
v_lshlrev_b32 v192, 4, v1
ds_read_b128 v[20:23], v192 offset:0
ds_read_b128 v[24:27], v192 offset:1024
s_lshl_b32 s62, s32, 10
s_add_u32 s62, s62, 0x0
s_add_u32 s63, s62, 32768
s_waitcnt lgkmcnt(0)
buffer_store_dwordx4 v[20:23], v192, s[52:55], s62 offen sc1
buffer_store_dwordx4 v[24:27], v192, s[52:55], s63 offen sc1
s_lshl_b32 s62, s32, 7
s_add_u32 s62, s62, 0x15000
v_mov_b32 v192, s62
v_mov_b32 v193, s58
s_mov_b64 exec, 1
s_waitcnt vmcnt(0)
buffer_store_dword v193, v192, s[52:55], 0 offen sc1
s_mov_b64 exec, -1
L_W_q:
s_waitcnt vmcnt(0)
s_xor_b32 s32, s32, 7
v_bfe_u32 v9, v1, 2, 3
v_lshlrev_b32 v9, 11, v9
v_and_b32 v192, 3, v1
v_lshrrev_b32 v10, 5, v1
v_lshl_add_u32 v192, v10, 2, v192
v_lshl_add_u32 v9, v192, 4, v9
s_lshr_b32 s62, s32, 4
s_and_b32 s63, s32, 15
s_lshl_b32 s60, s62, 16
s_lshl_b32 s61, s63, 7
s_add_u32 s60, s60, s61
s_add_u32 s60, s60, 0x20000
v_add_u32 v9, s60, v9
s_lshl_b32 s60, s62, 11
s_lshl_b32 s61, s63, 6
s_add_u32 s60, s60, s61
s_add_u32 s60, s60, 1024
v_lshl_add_u32 v10, v192, 3, s60
s_mov_b32 s37, 65536
s_lshr_b32 s35, s34, 2
s_and_b32 s36, s34, 3
s_branch L_W_merge
L_W_poll:
s_lshl_b32 s63, s32, 4
s_add_u32 s63, s63, 0x10000
v_lshl_add_u32 v192, v1, 9, s63
s_cmp_lg_u32 s34, 0
s_cbranch_scc1 L_wf_Wc
s_lshl_b64 exec, 1, s32
s_mov_b32 s64, 0
L_pl_Wc1:
buffer_load_dwordx4 v[196:199], v192, s[52:55], 0 offen sc1
s_add_u32 s64, s64, 1
s_waitcnt vmcnt(0)
v_xor_b32 v196, s76, v196
v_xor_b32 v197, s77, v197
v_xor_b32 v198, s78, v198
v_xor_b32 v199, s79, v199
v_or_b32 v193, v196, v197
v_or3_b32 v193, v193, v198, v199
v_and_b32 v193, 0xff, v193
v_cmp_ne_u32 vcc, 0, v193
s_nop 0
s_cmp_eq_u64 vcc, 0
s_cbranch_scc1 L_pd_Wc1
s_mov_b64 exec, vcc
s_sleep 2
s_cmp_lt_u32 s64, 65536
s_cbranch_scc1 L_pl_Wc1
L_pd_Wc1:
s_mov_b32 exec_lo, -1
s_mov_b32 exec_hi, 0
s_mov_b32 s64, 0
L_pl_Wc2:
buffer_load_dwordx4 v[196:199], v192, s[52:55], 0 offen sc1
s_add_u32 s64, s64, 1
s_waitcnt vmcnt(0)
v_xor_b32 v196, s76, v196
v_xor_b32 v197, s77, v197
v_xor_b32 v198, s78, v198
v_xor_b32 v199, s79, v199
v_or_b32 v193, v196, v197
v_or3_b32 v193, v193, v198, v199
v_and_b32 v193, 0xff, v193
v_cmp_ne_u32 vcc, 0, v193
s_nop 0
s_cmp_eq_u64 vcc, 0
s_cbranch_scc1 L_pd_Wc2
s_mov_b64 exec, vcc
s_cmp_lt_u32 s64, 65536
s_cbranch_scc1 L_pl_Wc2
L_pd_Wc2:
s_mov_b64 exec, -1
L_wf_Wc:
s_barrier
s_lshl_b32 s62, s35, 13
s_add_u32 s63, s63, s62
v_lshl_add_u32 v192, v2, 9, s63
buffer_load_dwordx4 v[196:199], v192, s[52:55], 0 offen sc1
s_lshl_b32 s62, s35, 5
s_add_u32 s62, s62, s32
s_lshl_b32 s63, s62, 14
s_add_u32 s63, s63, 0x200000
s_lshl_b32 s64, s36, 12
s_add_u32 s63, s63, s64
v_lshl_add_u32 v193, v1, 4, s63
buffer_load_dwordx4 v[200:203], v193, s[52:55], 0 offen offset:0 sc1
buffer_load_dwordx4 v[204:207], v193, s[52:55], 0 offen offset:1024 sc1
buffer_load_dwordx4 v[208:211], v193, s[52:55], 0 offen offset:2048 sc1
buffer_load_dwordx4 v[212:215], v193, s[52:55], 0 offen offset:3072 sc1
L_W_merge:
s_mov_b32 s60, 0x07060302
s_waitcnt vmcnt(4)
v_perm_b32 v194, v196, v197, s60
v_perm_b32 v195, v198, v199, s60
v_mov_b32 v196, v194
s_nop 1
v_max_f32_dpp v196, v196, v196 row_ror:8 row_mask:0xf bank_mask:0xf
s_nop 1
v_max_f32_dpp v196, v196, v196 row_ror:4 row_mask:0xf bank_mask:0xf
s_nop 1
v_max_f32_dpp v196, v196, v196 row_ror:2 row_mask:0xf bank_mask:0xf
s_nop 1
v_max_f32_dpp v196, v196, v196 row_ror:1 row_mask:0xf bank_mask:0xf
v_sub_f32 v197, v194, v196
v_exp_f32 v197, v197
s_nop 0
v_mul_f32 v195, v195, v197
s_nop 1
v_add_f32_dpp v195, v195, v195 row_ror:8 row_mask:0xf bank_mask:0xf
s_nop 1
v_add_f32_dpp v195, v195, v195 row_ror:4 row_mask:0xf bank_mask:0xf
s_nop 1
v_add_f32_dpp v195, v195, v195 row_ror:2 row_mask:0xf bank_mask:0xf
s_nop 1
v_add_f32_dpp v195, v195, v195 row_ror:1 row_mask:0xf bank_mask:0xf
v_rcp_f32 v195, v195
s_nop 0
v_mul_f32 v197, v197, v195
s_lshl_b32 s64, s36, 2
s_add_u32 s65, s64, 0
v_readlane_b32 s66, v197, s65
s_add_u32 s65, s64, 1
v_readlane_b32 s67, v197, s65
s_add_u32 s65, s64, 2
v_readlane_b32 s68, v197, s65
s_add_u32 s65, s64, 3
v_readlane_b32 s69, v197, s65
s_waitcnt vmcnt(3)
v_lshlrev_b32 v216, 16, v200
v_and_b32 v217, 0xffff0000, v200
v_lshlrev_b32 v218, 16, v201
v_and_b32 v219, 0xffff0000, v201
v_lshlrev_b32 v220, 16, v202
v_and_b32 v221, 0xffff0000, v202
v_lshlrev_b32 v222, 16, v203
v_and_b32 v223, 0xffff0000, v203
v_mul_f32 v232, s66, v216
v_mul_f32 v233, s66, v217
v_mul_f32 v234, s66, v218
v_mul_f32 v235, s66, v219
v_mul_f32 v236, s66, v220
v_mul_f32 v237, s66, v221
v_mul_f32 v238, s66, v222
v_mul_f32 v239, s66, v223
s_waitcnt vmcnt(2)
v_lshlrev_b32 v216, 16, v204
v_and_b32 v217, 0xffff0000, v204
v_lshlrev_b32 v218, 16, v205
v_and_b32 v219, 0xffff0000, v205
v_lshlrev_b32 v220, 16, v206
v_and_b32 v221, 0xffff0000, v206
v_lshlrev_b32 v222, 16, v207
v_and_b32 v223, 0xffff0000, v207
v_fma_f32 v232, v216, s67, v232
v_fma_f32 v233, v217, s67, v233
v_fma_f32 v234, v218, s67, v234
v_fma_f32 v235, v219, s67, v235
v_fma_f32 v236, v220, s67, v236
v_fma_f32 v237, v221, s67, v237
v_fma_f32 v238, v222, s67, v238
v_fma_f32 v239, v223, s67, v239
s_waitcnt vmcnt(1)
v_lshlrev_b32 v216, 16, v208
v_and_b32 v217, 0xffff0000, v208
v_lshlrev_b32 v218, 16, v209
v_and_b32 v219, 0xffff0000, v209
v_lshlrev_b32 v220, 16, v210
v_and_b32 v221, 0xffff0000, v210
v_lshlrev_b32 v222, 16, v211
v_and_b32 v223, 0xffff0000, v211
v_fma_f32 v232, v216, s68, v232
v_fma_f32 v233, v217, s68, v233
v_fma_f32 v234, v218, s68, v234
v_fma_f32 v235, v219, s68, v235
v_fma_f32 v236, v220, s68, v236
v_fma_f32 v237, v221, s68, v237
v_fma_f32 v238, v222, s68, v238
v_fma_f32 v239, v223, s68, v239
s_waitcnt vmcnt(0)
v_lshlrev_b32 v216, 16, v212
v_and_b32 v217, 0xffff0000, v212
v_lshlrev_b32 v218, 16, v213
v_and_b32 v219, 0xffff0000, v213
v_lshlrev_b32 v220, 16, v214
v_and_b32 v221, 0xffff0000, v214
v_lshlrev_b32 v222, 16, v215
v_and_b32 v223, 0xffff0000, v215
v_fma_f32 v232, v216, s69, v232
v_fma_f32 v233, v217, s69, v233
v_fma_f32 v234, v218, s69, v234
v_fma_f32 v235, v219, s69, v235
v_fma_f32 v236, v220, s69, v236
v_fma_f32 v237, v221, s69, v237
v_fma_f32 v238, v222, s69, v238
v_fma_f32 v239, v223, s69, v239
s_lshl_b32 s62, s34, 11
v_lshl_add_u32 v192, v1, 5, s62
ds_write_b128 v192, v[232:235] offset:18432
ds_write_b128 v192, v[236:239] offset:18448
s_waitcnt lgkmcnt(0)
s_barrier
v_lshrrev_b32 v192, 3, v2
v_lshlrev_b32 v192, 13, v192
v_lshl_add_u32 v192, v3, 6, v192
s_lshl_b32 s62, s34, 8
s_lshr_b32 s63, s80, 11
s_add_u32 s62, s62, s63
v_add_u32 v192, s62, v192
v_xor_b32 v193, 16, v192
v_xor_b32 v194, 32, v192
v_xor_b32 v195, 48, v192
ds_read_b128 v[200:203], v192 offset:18432
ds_read_b128 v[204:207], v193 offset:18432
ds_read_b128 v[208:211], v194 offset:18432
ds_read_b128 v[212:215], v195 offset:18432
ds_read_b128 v[216:219], v192 offset:20480
ds_read_b128 v[220:223], v193 offset:20480
ds_read_b128 v[224:227], v194 offset:20480
ds_read_b128 v[228:231], v195 offset:20480
s_waitcnt lgkmcnt(0)
v_add_f32 v200, v200, v216
v_add_f32 v201, v201, v217
v_add_f32 v202, v202, v218
v_add_f32 v203, v203, v219
v_add_f32 v204, v204, v220
v_add_f32 v205, v205, v221
v_add_f32 v206, v206, v222
v_add_f32 v207, v207, v223
v_add_f32 v208, v208, v224
v_add_f32 v209, v209, v225
v_add_f32 v210, v210, v226
v_add_f32 v211, v211, v227
v_add_f32 v212, v212, v228
v_add_f32 v213, v213, v229
v_add_f32 v214, v214, v230
v_add_f32 v215, v215, v231
ds_read_b128 v[216:219], v192 offset:22528
ds_read_b128 v[220:223], v193 offset:22528
ds_read_b128 v[224:227], v194 offset:22528
ds_read_b128 v[228:231], v195 offset:22528
s_waitcnt lgkmcnt(0)
v_add_f32 v200, v200, v216
v_add_f32 v201, v201, v217
v_add_f32 v202, v202, v218
v_add_f32 v203, v203, v219
v_add_f32 v204, v204, v220
v_add_f32 v205, v205, v221
v_add_f32 v206, v206, v222
v_add_f32 v207, v207, v223
v_add_f32 v208, v208, v224
v_add_f32 v209, v209, v225
v_add_f32 v210, v210, v226
v_add_f32 v211, v211, v227
v_add_f32 v212, v212, v228
v_add_f32 v213, v213, v229
v_add_f32 v214, v214, v230
v_add_f32 v215, v215, v231
ds_read_b128 v[216:219], v192 offset:24576
ds_read_b128 v[220:223], v193 offset:24576
ds_read_b128 v[224:227], v194 offset:24576
ds_read_b128 v[228:231], v195 offset:24576
s_waitcnt lgkmcnt(0)
v_add_f32 v200, v200, v216
v_add_f32 v201, v201, v217
v_add_f32 v202, v202, v218
v_add_f32 v203, v203, v219
v_add_f32 v204, v204, v220
v_add_f32 v205, v205, v221
v_add_f32 v206, v206, v222
v_add_f32 v207, v207, v223
v_add_f32 v208, v208, v224
v_add_f32 v209, v209, v225
v_add_f32 v210, v210, v226
v_add_f32 v211, v211, v227
v_add_f32 v212, v212, v228
v_add_f32 v213, v213, v229
v_add_f32 v214, v214, v230
v_add_f32 v215, v215, v231
v_cvt_pk_bf16_f32 v12, v200, v201
v_cvt_pk_bf16_f32 v13, v202, v203
v_cvt_pk_bf16_f32 v14, v204, v205
v_cvt_pk_bf16_f32 v15, v206, v207
v_cvt_pk_bf16_f32 v16, v208, v209
v_cvt_pk_bf16_f32 v17, v210, v211
v_cvt_pk_bf16_f32 v18, v212, v213
v_cvt_pk_bf16_f32 v19, v214, v215
s_mov_b32 s60, 0x01000100
v_perm_b32 v192, v12, v12, s60
v_and_b32 v28, v192, v4
v_and_b32 v29, v192, v5
v_and_b32 v30, v192, v6
v_and_b32 v31, v192, v7
s_waitcnt vmcnt(63)
s_nop 0
v_mfma_f32_16x16x32_bf16 v[44:47], v[28:31], v[64:67], 0
s_mov_b32 s60, 0x03020302
v_perm_b32 v193, v12, v12, s60
v_and_b32 v32, v193, v4
v_and_b32 v33, v193, v5
v_and_b32 v34, v193, v6
v_and_b32 v35, v193, v7
s_waitcnt vmcnt(63)
s_nop 0
v_mfma_f32_16x16x32_bf16 v[44:47], v[32:35], v[68:71], v[44:47]
s_mov_b32 s60, 0x01000100
v_perm_b32 v192, v13, v13, s60
v_and_b32 v28, v192, v4
v_and_b32 v29, v192, v5
v_and_b32 v30, v192, v6
v_and_b32 v31, v192, v7
s_waitcnt vmcnt(63)
s_nop 0
v_mfma_f32_16x16x32_bf16 v[44:47], v[28:31], v[72:75], v[44:47]
s_mov_b32 s60, 0x03020302
v_perm_b32 v193, v13, v13, s60
v_and_b32 v32, v193, v4
v_and_b32 v33, v193, v5
v_and_b32 v34, v193, v6
v_and_b32 v35, v193, v7
s_waitcnt vmcnt(63)
s_nop 0
v_mfma_f32_16x16x32_bf16 v[44:47], v[32:35], v[76:79], v[44:47]
s_mov_b32 s60, 0x01000100
v_perm_b32 v192, v14, v14, s60
v_and_b32 v28, v192, v4
v_and_b32 v29, v192, v5
v_and_b32 v30, v192, v6
v_and_b32 v31, v192, v7
s_waitcnt vmcnt(63)
s_nop 0
v_mfma_f32_16x16x32_bf16 v[44:47], v[28:31], v[80:83], v[44:47]
s_mov_b32 s60, 0x03020302
v_perm_b32 v193, v14, v14, s60
v_and_b32 v32, v193, v4
v_and_b32 v33, v193, v5
v_and_b32 v34, v193, v6
v_and_b32 v35, v193, v7
s_waitcnt vmcnt(63)
s_nop 0
v_mfma_f32_16x16x32_bf16 v[44:47], v[32:35], v[84:87], v[44:47]
s_mov_b32 s60, 0x01000100
v_perm_b32 v192, v15, v15, s60
v_and_b32 v28, v192, v4
v_and_b32 v29, v192, v5
v_and_b32 v30, v192, v6
v_and_b32 v31, v192, v7
s_waitcnt vmcnt(63)
s_nop 0
v_mfma_f32_16x16x32_bf16 v[44:47], v[28:31], v[88:91], v[44:47]
s_mov_b32 s60, 0x03020302
v_perm_b32 v193, v15, v15, s60
v_and_b32 v32, v193, v4
v_and_b32 v33, v193, v5
v_and_b32 v34, v193, v6
v_and_b32 v35, v193, v7
s_waitcnt vmcnt(63)
s_nop 0
v_mfma_f32_16x16x32_bf16 v[44:47], v[32:35], v[92:95], v[44:47]
s_mov_b32 s60, 0x01000100
v_perm_b32 v192, v16, v16, s60
v_and_b32 v28, v192, v4
v_and_b32 v29, v192, v5
v_and_b32 v30, v192, v6
v_and_b32 v31, v192, v7
s_waitcnt vmcnt(63)
s_nop 0
v_mfma_f32_16x16x32_bf16 v[44:47], v[28:31], v[96:99], v[44:47]
s_mov_b32 s60, 0x03020302
v_perm_b32 v193, v16, v16, s60
v_and_b32 v32, v193, v4
v_and_b32 v33, v193, v5
v_and_b32 v34, v193, v6
v_and_b32 v35, v193, v7
s_waitcnt vmcnt(63)
s_nop 0
v_mfma_f32_16x16x32_bf16 v[44:47], v[32:35], v[100:103], v[44:47]
s_mov_b32 s60, 0x01000100
v_perm_b32 v192, v17, v17, s60
v_and_b32 v28, v192, v4
v_and_b32 v29, v192, v5
v_and_b32 v30, v192, v6
v_and_b32 v31, v192, v7
s_waitcnt vmcnt(63)
s_nop 0
v_mfma_f32_16x16x32_bf16 v[44:47], v[28:31], v[104:107], v[44:47]
s_mov_b32 s60, 0x03020302
v_perm_b32 v193, v17, v17, s60
v_and_b32 v32, v193, v4
v_and_b32 v33, v193, v5
v_and_b32 v34, v193, v6
v_and_b32 v35, v193, v7
s_waitcnt vmcnt(63)
s_nop 0
v_mfma_f32_16x16x32_bf16 v[44:47], v[32:35], v[108:111], v[44:47]
s_mov_b32 s60, 0x01000100
v_perm_b32 v192, v18, v18, s60
v_and_b32 v28, v192, v4
v_and_b32 v29, v192, v5
v_and_b32 v30, v192, v6
v_and_b32 v31, v192, v7
s_waitcnt vmcnt(63)
s_nop 0
v_mfma_f32_16x16x32_bf16 v[44:47], v[28:31], v[112:115], v[44:47]
s_mov_b32 s60, 0x03020302
v_perm_b32 v193, v18, v18, s60
v_and_b32 v32, v193, v4
v_and_b32 v33, v193, v5
v_and_b32 v34, v193, v6
v_and_b32 v35, v193, v7
s_waitcnt vmcnt(63)
s_nop 0
v_mfma_f32_16x16x32_bf16 v[44:47], v[32:35], v[116:119], v[44:47]
s_mov_b32 s60, 0x01000100
v_perm_b32 v192, v19, v19, s60
v_and_b32 v28, v192, v4
v_and_b32 v29, v192, v5
v_and_b32 v30, v192, v6
v_and_b32 v31, v192, v7
s_waitcnt vmcnt(63)
s_nop 0
v_mfma_f32_16x16x32_bf16 v[44:47], v[28:31], v[120:123], v[44:47]
s_mov_b32 s60, 0x03020302
v_perm_b32 v193, v19, v19, s60
v_and_b32 v32, v193, v4
v_and_b32 v33, v193, v5
v_and_b32 v34, v193, v6
v_and_b32 v35, v193, v7
s_waitcnt vmcnt(63)
s_nop 0
v_mfma_f32_16x16x32_bf16 v[44:47], v[32:35], v[124:127], v[44:47]
v_lshrrev_b32 v192, 1, v3
v_lshlrev_b32 v192, 9, v192
v_lshl_add_u32 v192, v2, 5, v192
v_and_b32 v193, 1, v3
v_lshl_add_u32 v192, v193, 4, v192
s_lshl_b32 s63, s34, 10
v_add_u32 v192, s63, v192
s_nop 1
s_nop 5
ds_write_b128 v192, v[44:47] offset:9216
s_waitcnt lgkmcnt(0)
s_barrier
v_lshrrev_b32 v192, 3, v2
v_lshlrev_b32 v192, 9, v192
v_lshl_add_u32 v192, v3, 4, v192
s_lshl_b32 s62, s34, 6
v_add_u32 v192, s62, v192
ds_read_b128 v[200:203], v192 offset:9216
ds_read_b128 v[204:207], v192 offset:10240
ds_read_b128 v[208:211], v192 offset:11264
ds_read_b128 v[212:215], v192 offset:12288
ds_read_b128 v[216:219], v192 offset:13312
ds_read_b128 v[220:223], v192 offset:14336
ds_read_b128 v[224:227], v192 offset:15360
ds_read_b128 v[228:231], v192 offset:16384
s_waitcnt lgkmcnt(6)
v_add_f32 v200, v200, v204
v_add_f32 v201, v201, v205
v_add_f32 v202, v202, v206
v_add_f32 v203, v203, v207
s_waitcnt lgkmcnt(5)
v_add_f32 v200, v200, v208
v_add_f32 v201, v201, v209
v_add_f32 v202, v202, v210
v_add_f32 v203, v203, v211
s_waitcnt lgkmcnt(4)
v_add_f32 v200, v200, v212
v_add_f32 v201, v201, v213
v_add_f32 v202, v202, v214
v_add_f32 v203, v203, v215
s_waitcnt lgkmcnt(3)
v_add_f32 v200, v200, v216
v_add_f32 v201, v201, v217
v_add_f32 v202, v202, v218
v_add_f32 v203, v203, v219
s_waitcnt lgkmcnt(2)
v_add_f32 v200, v200, v220
v_add_f32 v201, v201, v221
v_add_f32 v202, v202, v222
v_add_f32 v203, v203, v223
s_waitcnt lgkmcnt(1)
v_add_f32 v200, v200, v224
v_add_f32 v201, v201, v225
v_add_f32 v202, v202, v226
v_add_f32 v203, v203, v227
s_waitcnt lgkmcnt(0)
v_add_f32 v200, v200, v228
v_add_f32 v201, v201, v229
v_add_f32 v202, v202, v230
v_add_f32 v203, v203, v231
v_cvt_pk_bf16_f32 v60, v200, v200
v_cvt_pk_bf16_f32 v61, v201, v201
v_cvt_pk_bf16_f32 v62, v202, v202
v_cvt_pk_bf16_f32 v63, v203, v203
v_and_b32 v28, v60, v4
v_and_b32 v29, v60, v5
v_and_b32 v30, v60, v6
v_and_b32 v31, v60, v7
v_and_b32 v32, v61, v4
v_and_b32 v33, v61, v5
v_and_b32 v34, v61, v6
v_and_b32 v35, v61, v7
v_and_b32 v36, v62, v4
v_and_b32 v37, v62, v5
v_and_b32 v38, v62, v6
v_and_b32 v39, v62, v7
v_and_b32 v40, v63, v4
v_and_b32 v41, v63, v5
v_and_b32 v42, v63, v6
v_and_b32 v43, v63, v7
v_mfma_f32_16x16x32_bf16 v[44:47], v[28:31], v[128:131], 0
v_mfma_f32_16x16x32_bf16 v[48:51], v[28:31], v[132:135], 0
v_mfma_f32_16x16x32_bf16 v[52:55], v[28:31], v[136:139], 0
v_mfma_f32_16x16x32_bf16 v[56:59], v[28:31], v[140:143], 0
v_mfma_f32_16x16x32_bf16 v[44:47], v[32:35], v[144:147], v[44:47]
v_mfma_f32_16x16x32_bf16 v[48:51], v[32:35], v[148:151], v[48:51]
v_mfma_f32_16x16x32_bf16 v[52:55], v[32:35], v[152:155], v[52:55]
v_mfma_f32_16x16x32_bf16 v[56:59], v[32:35], v[156:159], v[56:59]
v_mfma_f32_16x16x32_bf16 v[44:47], v[36:39], v[160:163], v[44:47]
v_mfma_f32_16x16x32_bf16 v[48:51], v[36:39], v[164:167], v[48:51]
v_mfma_f32_16x16x32_bf16 v[52:55], v[36:39], v[168:171], v[52:55]
v_mfma_f32_16x16x32_bf16 v[56:59], v[36:39], v[172:175], v[56:59]
v_mfma_f32_16x16x32_bf16 v[44:47], v[40:43], v[176:179], v[44:47]
v_mfma_f32_16x16x32_bf16 v[48:51], v[40:43], v[180:183], v[48:51]
v_mfma_f32_16x16x32_bf16 v[52:55], v[40:43], v[184:187], v[52:55]
v_mfma_f32_16x16x32_bf16 v[56:59], v[40:43], v[188:191], v[56:59]
v_lshrrev_b32 v192, 1, v3
v_lshlrev_b32 v192, 11, v192
v_lshl_add_u32 v192, v2, 5, v192
v_and_b32 v193, 1, v3
v_lshl_add_u32 v192, v193, 4, v192
s_lshl_b32 s63, s34, 12
v_add_u32 v192, s63, v192
s_nop 1
ds_write_b128 v192, v[44:47] offset:18432
ds_write_b128 v192, v[48:51] offset:18944
ds_write_b128 v192, v[52:55] offset:19456
s_nop 5
ds_write_b128 v192, v[56:59] offset:19968
s_waitcnt lgkmcnt(0)
s_barrier
s_cmp_ge_u32 s34, 4
s_cbranch_scc1 L_W_yskip
v_lshlrev_b32 v192, 4, v0
ds_read_b128 v[200:203], v192 offset:18432
ds_read_b128 v[204:207], v192 offset:22528
ds_read_b128 v[208:211], v192 offset:26624
ds_read_b128 v[212:215], v192 offset:30720
ds_read_b128 v[216:219], v192 offset:34816
ds_read_b128 v[220:223], v192 offset:38912
ds_read_b128 v[224:227], v192 offset:43008
ds_read_b128 v[228:231], v192 offset:47104
v_bfe_u32 v193, v0, 7, 1
v_lshlrev_b32 v193, 16, v193
v_and_b32 v194, 127, v0
v_lshl_add_u32 v193, v194, 4, v193
s_lshl_b32 s63, s32, 11
s_add_u32 s63, s63, 0x20000
v_add_u32 v193, s63, v193
v_mov_b32 v194, 0xffffff00
s_waitcnt lgkmcnt(6)
v_add_f32 v200, v200, v204
v_add_f32 v201, v201, v205
v_add_f32 v202, v202, v206
v_add_f32 v203, v203, v207
s_waitcnt lgkmcnt(5)
v_add_f32 v200, v200, v208
v_add_f32 v201, v201, v209
v_add_f32 v202, v202, v210
v_add_f32 v203, v203, v211
s_waitcnt lgkmcnt(4)
v_add_f32 v200, v200, v212
v_add_f32 v201, v201, v213
v_add_f32 v202, v202, v214
v_add_f32 v203, v203, v215
s_waitcnt lgkmcnt(3)
v_add_f32 v200, v200, v216
v_add_f32 v201, v201, v217
v_add_f32 v202, v202, v218
v_add_f32 v203, v203, v219
s_waitcnt lgkmcnt(2)
v_add_f32 v200, v200, v220
v_add_f32 v201, v201, v221
v_add_f32 v202, v202, v222
v_add_f32 v203, v203, v223
s_waitcnt lgkmcnt(1)
v_add_f32 v200, v200, v224
v_add_f32 v201, v201, v225
v_add_f32 v202, v202, v226
v_add_f32 v203, v203, v227
s_waitcnt lgkmcnt(0)
v_add_f32 v200, v200, v228
v_add_f32 v201, v201, v229
v_add_f32 v202, v202, v230
v_add_f32 v203, v203, v231
v_add_u32 v200, 0x80, v200
v_add_u32 v201, 0x80, v201
v_add_u32 v202, 0x80, v202
v_add_u32 v203, 0x80, v203
v_and_or_b32 v200, v200, v194, s76
v_and_or_b32 v201, v201, v194, s77
v_and_or_b32 v202, v202, v194, s78
v_and_or_b32 v203, v203, v194, s79
s_cmp_lg_u32 s37, 0
s_cbranch_scc1 L_W_yskip
buffer_store_dwordx4 v[200:203], v193, s[52:55], 0 offen sc1
L_W_yskip:
s_cmp_lg_u32 s34, 4
s_cbranch_scc1 L_W_fin
s_mov_b32 s64, s37
s_mov_b32 s66, 0x4000
s_mov_b32 s67, 0x8000
s_mov_b32 s65, 0xc000
buffer_load_dwordx4 v[12:15], v9, s[52:55], 0 offen sc1
buffer_load_dwordx4 v[16:19], v9, s[52:55], s66 offen sc1
buffer_load_dwordx4 v[20:23], v9, s[52:55], s67 offen sc1
buffer_load_dwordx4 v[24:27], v9, s[52:55], s65 offen sc1
L_ps_Wf:
s_waitcnt vmcnt(3)
v_xor_b32 v200, s76, v12
v_xor_b32 v201, s77, v13
v_xor_b32 v202, s78, v14
v_xor_b32 v203, s79, v15
v_or_b32 v192, v200, v201
v_or3_b32 v192, v192, v202, v203
s_waitcnt vmcnt(2)
v_xor_b32 v204, s76, v16
v_xor_b32 v205, s77, v17
v_xor_b32 v206, s78, v18
v_xor_b32 v207, s79, v19
v_or3_b32 v192, v192, v204, v205
v_or3_b32 v192, v192, v206, v207
v_add_f32 v200, v200, v204
v_add_f32 v201, v201, v205
v_add_f32 v202, v202, v206
v_add_f32 v203, v203, v207
s_waitcnt vmcnt(1)
v_xor_b32 v204, s76, v20
v_xor_b32 v205, s77, v21
v_xor_b32 v206, s78, v22
v_xor_b32 v207, s79, v23
v_or3_b32 v192, v192, v204, v205
v_or3_b32 v192, v192, v206, v207
v_add_f32 v200, v200, v204
v_add_f32 v201, v201, v205
v_add_f32 v202, v202, v206
v_add_f32 v203, v203, v207
s_waitcnt vmcnt(0)
v_xor_b32 v204, s76, v24
v_xor_b32 v205, s77, v25
v_xor_b32 v206, s78, v26
v_xor_b32 v207, s79, v27
v_or3_b32 v192, v192, v204, v205
v_or3_b32 v192, v192, v206, v207
v_add_f32 v200, v200, v204
v_add_f32 v201, v201, v205
v_add_f32 v202, v202, v206
v_add_f32 v203, v203, v207
v_and_b32 v192, 0xff, v192
v_cmp_ne_u32 vcc, 0, v192
v_add_f32_dpp v200, v200, v200 row_ror:8 row_mask:0xf bank_mask:0xf
v_add_f32_dpp v201, v201, v201 row_ror:8 row_mask:0xf bank_mask:0xf
v_add_f32_dpp v202, v202, v202 row_ror:8 row_mask:0xf bank_mask:0xf
v_add_f32_dpp v203, v203, v203 row_ror:8 row_mask:0xf bank_mask:0xf
s_cmp_eq_u64 vcc, 0
s_cbranch_scc1 L_pe_Wf
s_sleep 2
buffer_load_dwordx4 v[12:15], v9, s[52:55], 0 offen sc1
buffer_load_dwordx4 v[16:19], v9, s[52:55], s66 offen sc1
buffer_load_dwordx4 v[20:23], v9, s[52:55], s67 offen sc1
buffer_load_dwordx4 v[24:27], v9, s[52:55], s65 offen sc1
s_add_u32 s64, s64, 1
s_cmp_lt_u32 s64, 65536
s_cbranch_scc1 L_ps_Wf
L_pe_Wf:
v_add_f32_dpp v200, v200, v200 row_ror:4 row_mask:0xf bank_mask:0xf
v_add_f32_dpp v201, v201, v201 row_ror:4 row_mask:0xf bank_mask:0xf
v_add_f32_dpp v202, v202, v202 row_ror:4 row_mask:0xf bank_mask:0xf
v_add_f32_dpp v203, v203, v203 row_ror:4 row_mask:0xf bank_mask:0xf
v_mov_b32 v192, v200
v_mov_b32 v193, v201
v_mov_b32 v194, v202
v_mov_b32 v195, v203
v_permlane16_swap_b32 v200, v192
v_permlane16_swap_b32 v201, v193
v_permlane16_swap_b32 v202, v194
v_permlane16_swap_b32 v203, v195
v_add_f32 v200, v200, v192
v_add_f32 v201, v201, v193
v_add_f32 v202, v202, v194
v_add_f32 v203, v203, v195
v_cvt_pk_bf16_f32 v200, v200, v201
v_cvt_pk_bf16_f32 v201, v202, v203
s_cmp_lg_u32 s37, 0
s_cbranch_scc1 L_W_fin
s_mov_b32 exec_lo, 15
s_mov_b32 exec_hi, 15
global_store_dwordx2 v10, v[200:201], s[26:27]
s_mov_b64 exec, -1
L_W_fin:
s_cmp_eq_u32 s37, 0
s_cbranch_scc1 L_W_end
s_mov_b32 s37, 0
s_waitcnt vmcnt(0)
s_branch L_W_poll
L_W_end:
s_endpgm
L_roleC:
s_waitcnt lgkmcnt(0)
s_lshl_b32 s60, s32, 8
s_sub_u32 s61, 0x400000, s60
s_add_u32 s68, s10, s60
s_addc_u32 s69, s11, 0
s_and_b32 s69, s69, 0xffff
s_mov_b32 s70, s61
s_mov_b32 s71, 0x20000
s_mov_b32 s72, s4
s_and_b32 s73, s5, 0xffff
s_mov_b32 s74, 0x800
s_mov_b32 s75, 0x20000
v_lshrrev_b32 v240, 3, v2
v_lshlrev_b32 v240, 10, v240
v_lshl_add_u32 v240, v3, 5, v240
s_lshl_b32 s62, s34, 7
v_add_u32 v240, s62, v240
s_mov_b32 s80, 0
buffer_load_dwordx4 v[32:35], v240, s[72:75], 0 offen
buffer_load_dwordx4 v[36:39], v240, s[72:75], 0 offen offset:16
v_lshlrev_b32 v9, 17, v3
v_lshl_add_u32 v9, v2, 4, v9
s_lshl_b32 s62, s34, 19
v_add_u32 v9, s62, v9
s_xor_b32 s62, s80, 0
buffer_load_dwordx4 v[128:131], v9, s[68:71], s62 offen nt
s_xor_b32 s62, s80, 8192
buffer_load_dwordx4 v[132:135], v9, s[68:71], s62 offen nt
s_xor_b32 s62, s80, 16384
buffer_load_dwordx4 v[136:139], v9, s[68:71], s62 offen nt
s_xor_b32 s62, s80, 24576
buffer_load_dwordx4 v[140:143], v9, s[68:71], s62 offen nt
s_xor_b32 s62, s80, 32768
buffer_load_dwordx4 v[144:147], v9, s[68:71], s62 offen nt
s_xor_b32 s62, s80, 40960
buffer_load_dwordx4 v[148:151], v9, s[68:71], s62 offen nt
s_xor_b32 s62, s80, 49152
buffer_load_dwordx4 v[152:155], v9, s[68:71], s62 offen nt
s_xor_b32 s62, s80, 57344
buffer_load_dwordx4 v[156:159], v9, s[68:71], s62 offen nt
s_xor_b32 s62, s80, 65536
buffer_load_dwordx4 v[160:163], v9, s[68:71], s62 offen nt
s_xor_b32 s62, s80, 73728
buffer_load_dwordx4 v[164:167], v9, s[68:71], s62 offen nt
s_xor_b32 s62, s80, 81920
buffer_load_dwordx4 v[168:171], v9, s[68:71], s62 offen nt
s_xor_b32 s62, s80, 90112
buffer_load_dwordx4 v[172:175], v9, s[68:71], s62 offen nt
s_xor_b32 s62, s80, 98304
buffer_load_dwordx4 v[176:179], v9, s[68:71], s62 offen nt
s_xor_b32 s62, s80, 106496
buffer_load_dwordx4 v[180:183], v9, s[68:71], s62 offen nt
s_xor_b32 s62, s80, 114688
buffer_load_dwordx4 v[184:187], v9, s[68:71], s62 offen nt
s_xor_b32 s62, s80, 122880
buffer_load_dwordx4 v[188:191], v9, s[68:71], s62 offen nt
s_load_dword s58, s[30:31], 0x14000
s_mov_b32 s44, s30
s_and_b32 s45, s31, 0xffff
s_mov_b32 s46, 0x1000000
s_mov_b32 s47, 0x20000
s_cmp_lg_u32 s34, 6
s_cbranch_scc1 L_C_ctr
v_mov_b32 v192, -1
s_lshl_b32 s62, s32, 13
s_add_u32 s62, s62, 0x61800
v_lshl_add_u32 v240, v1, 7, s62
s_mov_b64 exec, 1
buffer_store_dword v192, v240, s[44:47], 0 offen sc1
buffer_store_dword v192, v240, s[44:47], 0 offen offset:1024 sc1
s_mov_b64 exec, -1
L_C_ctr:
v_and_b32 v242, 1, v0
v_lshlrev_b32 v242, 4, v242
v_mov_b32 v243, 0xffff
v_lshlrev_b32 v242, v242, v243
v_bfe_u32 v243, v0, 1, 2
v_cmp_eq_u32 vcc, 0, v243
s_nop 1
v_cndmask_b32 v4, 0, v242, vcc
v_cmp_eq_u32 vcc, 1, v243
s_nop 1
v_cndmask_b32 v5, 0, v242, vcc
v_cmp_eq_u32 vcc, 2, v243
s_nop 1
v_cndmask_b32 v6, 0, v242, vcc
v_cmp_eq_u32 vcc, 3, v243
s_nop 1
v_cndmask_b32 v7, 0, v242, vcc
v_mov_b32 v8, 0
s_lshr_b32 s35, s32, 4
s_lshr_b32 s36, s34, 1
s_and_b32 s37, s34, 1
s_lshr_b32 s60, s32, 0
s_lshl_b32 s60, s60, 19
s_mov_b32 s61, 0x80000
s_add_u32 s40, s16, s60
s_addc_u32 s41, s17, 0
s_and_b32 s41, s41, 0xffff
s_mov_b32 s42, s61
s_mov_b32 s43, 0x20000
v_lshrrev_b32 v242, 1, v3
v_lshlrev_b32 v242, 9, v242
v_lshl_add_u32 v242, v2, 5, v242
v_and_b32 v243, 1, v3
v_lshl_add_u32 v242, v243, 4, v242
s_lshl_b32 s63, s34, 10
v_add_u32 v242, s63, v242
v_add_u32 v242, 140288, v242
v_lshlrev_b32 v243, 4, v1
s_lshl_b32 s62, s32, 10
s_add_u32 s62, s62, 0x18000
v_add_u32 v244, s62, v243
v_add_u32 v243, 140288, v243
s_waitcnt vmcnt(16) lgkmcnt(0)
s_add_u32 s58, s58, 0x9e3779b9
s_bfe_u32 s76, s58, 0x80000
s_bfe_u32 s77, s58, 0x80008
s_bfe_u32 s78, s58, 0x80010
s_bfe_u32 s79, s58, 0x80018
v_mov_b32 v245, s58
s_mov_b32 s60, 0x01000100
v_perm_b32 v240, v32, v32, s60
v_and_b32 v40, v240, v4
v_and_b32 v41, v240, v5
v_and_b32 v42, v240, v6
v_and_b32 v43, v240, v7
s_waitcnt vmcnt(15)
s_nop 0
v_mfma_f32_16x16x32_bf16 v[48:51], v[40:43], v[128:131], 0
s_mov_b32 s60, 0x03020302
v_perm_b32 v241, v32, v32, s60
v_and_b32 v44, v241, v4
v_and_b32 v45, v241, v5
v_and_b32 v46, v241, v6
v_and_b32 v47, v241, v7
s_waitcnt vmcnt(14)
s_nop 0
v_mfma_f32_16x16x32_bf16 v[48:51], v[44:47], v[132:135], v[48:51]
s_mov_b32 s60, 0x01000100
v_perm_b32 v240, v33, v33, s60
v_and_b32 v40, v240, v4
v_and_b32 v41, v240, v5
v_and_b32 v42, v240, v6
v_and_b32 v43, v240, v7
s_waitcnt vmcnt(13)
s_nop 0
v_mfma_f32_16x16x32_bf16 v[48:51], v[40:43], v[136:139], v[48:51]
s_mov_b32 s60, 0x03020302
v_perm_b32 v241, v33, v33, s60
v_and_b32 v44, v241, v4
v_and_b32 v45, v241, v5
v_and_b32 v46, v241, v6
v_and_b32 v47, v241, v7
s_waitcnt vmcnt(12)
s_nop 0
v_mfma_f32_16x16x32_bf16 v[48:51], v[44:47], v[140:143], v[48:51]
s_mov_b32 s60, 0x01000100
v_perm_b32 v240, v34, v34, s60
v_and_b32 v40, v240, v4
v_and_b32 v41, v240, v5
v_and_b32 v42, v240, v6
v_and_b32 v43, v240, v7
s_waitcnt vmcnt(11)
s_nop 0
v_mfma_f32_16x16x32_bf16 v[48:51], v[40:43], v[144:147], v[48:51]
s_mov_b32 s60, 0x03020302
v_perm_b32 v241, v34, v34, s60
v_and_b32 v44, v241, v4
v_and_b32 v45, v241, v5
v_and_b32 v46, v241, v6
v_and_b32 v47, v241, v7
s_waitcnt vmcnt(10)
s_nop 0
v_mfma_f32_16x16x32_bf16 v[48:51], v[44:47], v[148:151], v[48:51]
s_mov_b32 s60, 0x01000100
v_perm_b32 v240, v35, v35, s60
v_and_b32 v40, v240, v4
v_and_b32 v41, v240, v5
v_and_b32 v42, v240, v6
v_and_b32 v43, v240, v7
s_waitcnt vmcnt(9)
s_nop 0
v_mfma_f32_16x16x32_bf16 v[48:51], v[40:43], v[152:155], v[48:51]
s_mov_b32 s60, 0x03020302
v_perm_b32 v241, v35, v35, s60
v_and_b32 v44, v241, v4
v_and_b32 v45, v241, v5
v_and_b32 v46, v241, v6
v_and_b32 v47, v241, v7
s_waitcnt vmcnt(8)
s_nop 0
v_mfma_f32_16x16x32_bf16 v[48:51], v[44:47], v[156:159], v[48:51]
s_mov_b32 s60, 0x01000100
v_perm_b32 v240, v36, v36, s60
v_and_b32 v40, v240, v4
v_and_b32 v41, v240, v5
v_and_b32 v42, v240, v6
v_and_b32 v43, v240, v7
s_waitcnt vmcnt(7)
s_nop 0
v_mfma_f32_16x16x32_bf16 v[48:51], v[40:43], v[160:163], v[48:51]
s_mov_b32 s60, 0x03020302
v_perm_b32 v241, v36, v36, s60
v_and_b32 v44, v241, v4
v_and_b32 v45, v241, v5
v_and_b32 v46, v241, v6
v_and_b32 v47, v241, v7
s_waitcnt vmcnt(6)
s_nop 0
v_mfma_f32_16x16x32_bf16 v[48:51], v[44:47], v[164:167], v[48:51]
s_mov_b32 s60, 0x01000100
v_perm_b32 v240, v37, v37, s60
v_and_b32 v40, v240, v4
v_and_b32 v41, v240, v5
v_and_b32 v42, v240, v6
v_and_b32 v43, v240, v7
s_waitcnt vmcnt(5)
s_nop 0
v_mfma_f32_16x16x32_bf16 v[48:51], v[40:43], v[168:171], v[48:51]
s_mov_b32 s60, 0x03020302
v_perm_b32 v241, v37, v37, s60
v_and_b32 v44, v241, v4
v_and_b32 v45, v241, v5
v_and_b32 v46, v241, v6
v_and_b32 v47, v241, v7
s_waitcnt vmcnt(4)
s_nop 0
v_mfma_f32_16x16x32_bf16 v[48:51], v[44:47], v[172:175], v[48:51]
s_mov_b32 s60, 0x01000100
v_perm_b32 v240, v38, v38, s60
v_and_b32 v40, v240, v4
v_and_b32 v41, v240, v5
v_and_b32 v42, v240, v6
v_and_b32 v43, v240, v7
s_waitcnt vmcnt(3)
s_nop 0
v_mfma_f32_16x16x32_bf16 v[48:51], v[40:43], v[176:179], v[48:51]
s_mov_b32 s60, 0x03020302
v_perm_b32 v241, v38, v38, s60
v_and_b32 v44, v241, v4
v_and_b32 v45, v241, v5
v_and_b32 v46, v241, v6
v_and_b32 v47, v241, v7
s_waitcnt vmcnt(2)
s_nop 0
v_mfma_f32_16x16x32_bf16 v[48:51], v[44:47], v[180:183], v[48:51]
s_mov_b32 s60, 0x01000100
v_perm_b32 v240, v39, v39, s60
v_and_b32 v40, v240, v4
v_and_b32 v41, v240, v5
v_and_b32 v42, v240, v6
v_and_b32 v43, v240, v7
s_waitcnt vmcnt(1)
s_nop 0
v_mfma_f32_16x16x32_bf16 v[48:51], v[40:43], v[184:187], v[48:51]
s_mov_b32 s60, 0x03020302
v_perm_b32 v241, v39, v39, s60
v_and_b32 v44, v241, v4
v_and_b32 v45, v241, v5
v_and_b32 v46, v241, v6
v_and_b32 v47, v241, v7
s_waitcnt vmcnt(0)
s_nop 0
v_mfma_f32_16x16x32_bf16 v[48:51], v[44:47], v[188:191], v[48:51]
s_nop 7
ds_write_b128 v242, v[48:51]
s_waitcnt lgkmcnt(0)
s_barrier
s_cmp_lg_u32 s34, 0
s_cbranch_scc1 L_C_qs
ds_read_b128 v[128:131], v243 offset:0
ds_read_b128 v[132:135], v243 offset:1024
ds_read_b128 v[136:139], v243 offset:2048
ds_read_b128 v[140:143], v243 offset:3072
ds_read_b128 v[144:147], v243 offset:4096
ds_read_b128 v[148:151], v243 offset:5120
ds_read_b128 v[152:155], v243 offset:6144
ds_read_b128 v[156:159], v243 offset:7168
s_mov_b32 s60, 0x05040100
s_mov_b32 s61, 0x07060302
s_waitcnt lgkmcnt(6)
v_add_f32 v128, v128, v132
v_add_f32 v129, v129, v133
v_add_f32 v130, v130, v134
v_add_f32 v131, v131, v135
s_waitcnt lgkmcnt(5)
v_add_f32 v128, v128, v136
v_add_f32 v129, v129, v137
v_add_f32 v130, v130, v138
v_add_f32 v131, v131, v139
s_waitcnt lgkmcnt(4)
v_add_f32 v128, v128, v140
v_add_f32 v129, v129, v141
v_add_f32 v130, v130, v142
v_add_f32 v131, v131, v143
s_waitcnt lgkmcnt(3)
v_add_f32 v128, v128, v144
v_add_f32 v129, v129, v145
v_add_f32 v130, v130, v146
v_add_f32 v131, v131, v147
s_waitcnt lgkmcnt(2)
v_add_f32 v128, v128, v148
v_add_f32 v129, v129, v149
v_add_f32 v130, v130, v150
v_add_f32 v131, v131, v151
s_waitcnt lgkmcnt(1)
v_add_f32 v128, v128, v152
v_add_f32 v129, v129, v153
v_add_f32 v130, v130, v154
v_add_f32 v131, v131, v155
s_waitcnt lgkmcnt(0)
v_add_f32 v128, v128, v156
v_add_f32 v129, v129, v157
v_add_f32 v130, v130, v158
v_add_f32 v131, v131, v159
v_cvt_pk_bf16_f32 v128, v128, v129
v_cvt_pk_bf16_f32 v129, v130, v131
v_perm_b32 v132, v128, v245, s60
v_perm_b32 v133, v128, v245, s61
v_perm_b32 v134, v129, v245, s60
v_perm_b32 v135, v129, v245, s61
buffer_store_dwordx4 v[132:135], v244, s[44:47], 0 offen sc1
L_C_qs:
v_lshlrev_b32 v9, 4, v1
s_mul_i32 s62, s34, 4096
v_add_u32 v9, s62, v9
s_mul_i32 s38, s34, 4224
s_and_b32 s54, s32, 3
s_lshl_b32 s54, s54, 17
s_mov_b32 s53, 0
s_lshl_b32 s60, s32, 17
s_mov_b32 s61, 0x20000
s_add_u32 s68, s12, s60
s_addc_u32 s69, s13, 0
s_and_b32 s69, s69, 0xffff
s_mov_b32 s70, s61
s_mov_b32 s71, 0x20000
s_add_u32 s50, s38, 5120
s_cmp_lt_u32 s53, 0x80000
s_cselect_b32 s40, s40, s68
s_cselect_b32 s41, s41, s69
s_cselect_b32 s42, s42, s70
s_cselect_b32 s54, s54, 0
s_and_b32 s49, s53, 0x70000
s_xor_b32 s49, s49, s54
s_add_u32 s51, s49, 32768
s_add_u32 s53, s53, 0x10000
s_add_u32 m0, s50, 0
s_nop 0
buffer_load_dwordx4 v9, s[40:43], s49 offen offset:0 nt lds
s_add_u32 m0, s50, 32
s_nop 0
buffer_load_dwordx4 v9, s[40:43], s49 offen offset:1024 nt lds
s_add_u32 m0, s50, 64
s_nop 0
buffer_load_dwordx4 v9, s[40:43], s49 offen offset:2048 nt lds
s_add_u32 m0, s50, 96
s_nop 0
buffer_load_dwordx4 v9, s[40:43], s49 offen offset:3072 nt lds
s_add_u32 m0, s50, 33792
s_nop 0
buffer_load_dwordx4 v9, s[40:43], s51 offen offset:0 nt lds
s_add_u32 m0, s50, 33824
s_nop 0
buffer_load_dwordx4 v9, s[40:43], s51 offen offset:1024 nt lds
s_add_u32 m0, s50, 33856
s_nop 0
buffer_load_dwordx4 v9, s[40:43], s51 offen offset:2048 nt lds
s_add_u32 m0, s50, 33888
s_nop 0
buffer_load_dwordx4 v9, s[40:43], s51 offen offset:3072 nt lds
s_add_u32 s50, s38, 72704
s_cmp_lt_u32 s53, 0x80000
s_cselect_b32 s40, s40, s68
s_cselect_b32 s41, s41, s69
s_cselect_b32 s42, s42, s70
s_cselect_b32 s54, s54, 0
s_and_b32 s49, s53, 0x70000
s_xor_b32 s49, s49, s54
s_add_u32 s51, s49, 32768
s_add_u32 s53, s53, 0x10000
s_add_u32 m0, s50, 0
s_nop 0
buffer_load_dwordx4 v9, s[40:43], s49 offen offset:0 nt lds
s_add_u32 m0, s50, 32
s_nop 0
buffer_load_dwordx4 v9, s[40:43], s49 offen offset:1024 nt lds
s_add_u32 m0, s50, 64
s_nop 0
buffer_load_dwordx4 v9, s[40:43], s49 offen offset:2048 nt lds
s_add_u32 m0, s50, 96
s_nop 0
buffer_load_dwordx4 v9, s[40:43], s49 offen offset:3072 nt lds
s_add_u32 m0, s50, 33792
s_nop 0
buffer_load_dwordx4 v9, s[40:43], s51 offen offset:0 nt lds
s_add_u32 m0, s50, 33824
s_nop 0
buffer_load_dwordx4 v9, s[40:43], s51 offen offset:1024 nt lds
s_add_u32 m0, s50, 33856
s_nop 0
buffer_load_dwordx4 v9, s[40:43], s51 offen offset:2048 nt lds
s_add_u32 m0, s50, 33888
s_nop 0
buffer_load_dwordx4 v9, s[40:43], s51 offen offset:3072 nt lds
s_cmp_lt_u32 s53, 0x80000
s_cselect_b32 s40, s40, s68
s_cselect_b32 s41, s41, s69
s_cselect_b32 s42, s42, s70
s_cselect_b32 s54, s54, 0
s_and_b32 s49, s53, 0x70000
s_xor_b32 s49, s49, s54
s_add_u32 s51, s49, 32768
s_add_u32 s53, s53, 0x10000
buffer_load_dwordx4 v[208:211], v9, s[40:43], s49 offen offset:0 nt
buffer_load_dwordx4 v[212:215], v9, s[40:43], s49 offen offset:1024 nt
buffer_load_dwordx4 v[216:219], v9, s[40:43], s49 offen offset:2048 nt
buffer_load_dwordx4 v[220:223], v9, s[40:43], s49 offen offset:3072 nt
buffer_load_dwordx4 v[224:227], v9, s[40:43], s51 offen offset:0 nt
buffer_load_dwordx4 v[228:231], v9, s[40:43], s51 offen offset:1024 nt
buffer_load_dwordx4 v[232:235], v9, s[40:43], s51 offen offset:2048 nt
buffer_load_dwordx4 v[236:239], v9, s[40:43], s51 offen offset:3072 nt
s_add_u32 s62, s38, 5120
v_lshl_add_u32 v22, v1, 4, s62
s_lshl_b32 s62, s36, 4
v_add_u32 v240, s62, v2
v_mul_u32_u24 v10, 1056, v240
v_lshl_add_u32 v10, v3, 4, v10
v_add_u32 v10, 5120, v10
v_lshrrev_b32 v240, 1, v3
v_lshlrev_b32 v240, 3, v240
v_lshrrev_b32 v241, 2, v2
v_add_u32 v240, v240, v241
v_mul_u32_u24 v11, 1056, v240
v_and_b32 v240, 1, v3
v_lshl_add_u32 v11, v240, 5, v11
v_and_b32 v240, 3, v2
v_lshl_add_u32 v11, v240, 3, v11
s_lshl_b32 s62, s34, 7
s_add_u32 s62, s62, 5120
v_add_u32 v11, s62, v11
s_lshl_b32 s62, s37, 4
v_add_u32 v240, s62, v2
v_mul_u32_u24 v12, 144, v240
v_lshl_add_u32 v12, v3, 3, v12
s_lshl_b32 s62, s36, 5
v_add_u32 v12, s62, v12
v_lshlrev_b32 v15, 4, v240
s_lshl_b32 s62, s36, 2
v_add_u32 v14, s62, v15
v_and_b32 v240, 31, v1
v_mul_u32_u24 v13, 144, v240
v_lshrrev_b32 v241, 5, v1
v_lshl_add_u32 v13, v241, 4, v13
v_lshlrev_b32 v16, 4, v240
v_mov_b32 v17, 0x3e0293ee
v_mov_b32 v18, 0xff800000
v_mov_b32 v19, 0xff800000
v_mov_b32 v20, 0
v_mov_b32 v96, 0
v_mov_b32 v97, 0
v_mov_b32 v98, 0
v_mov_b32 v99, 0
v_mov_b32 v100, 0
v_mov_b32 v101, 0
v_mov_b32 v102, 0
v_mov_b32 v103, 0
v_mov_b32 v104, 0
v_mov_b32 v105, 0
v_mov_b32 v106, 0
v_mov_b32 v107, 0
v_mov_b32 v108, 0
v_mov_b32 v109, 0
v_mov_b32 v110, 0
v_mov_b32 v111, 0
v_mov_b32 v112, 0
v_mov_b32 v113, 0
v_mov_b32 v114, 0
v_mov_b32 v115, 0
v_mov_b32 v116, 0
v_mov_b32 v117, 0
v_mov_b32 v118, 0
v_mov_b32 v119, 0
v_mov_b32 v120, 0
v_mov_b32 v121, 0
v_mov_b32 v122, 0
v_mov_b32 v123, 0
v_mov_b32 v124, 0
v_mov_b32 v125, 0
v_mov_b32 v126, 0
v_mov_b32 v127, 0
v_lshrrev_b32 v240, 5, v1
s_lshl_b32 s62, s34, 2
v_add_u32 v240, s62, v240
v_and_b32 v241, 31, v1
v_lshlrev_b32 v241, 4, v241
v_lshl_add_u32 v242, v240, 10, v241
s_lshl_b32 s62, s35, 15
s_add_u32 s62, s62, 0x0
v_add_u32 v242, s62, v242
v_mul_u32_u24 v243, 528, v240
v_add_u32 v243, v243, v241
v_add_u32 v243, 140288, v243
s_lshl_b32 s62, s37, 4
v_add_u32 v240, s62, v2
v_mul_u32_u24 v244, 528, v240
v_lshl_add_u32 v244, v3, 4, v244
v_add_u32 v244, 140288, v244
v_lshlrev_b32 v240, 7, v1
v_add_u32 v240, 0x15000, v240
s_cmp_lg_u32 s34, 0
s_cbranch_scc1 L_wf_Cq
s_lshl_b64 exec, 1, s32
s_mov_b32 s64, 0
L_pl_Cq1:
buffer_load_dword v241, v240, s[44:47], 0 offen sc1
s_add_u32 s64, s64, 1
s_waitcnt vmcnt(0)
v_cmp_ne_u32 vcc, s58, v241
s_nop 0
s_cmp_eq_u64 vcc, 0
s_cbranch_scc1 L_pd_Cq1
s_mov_b64 exec, vcc
s_sleep 2
s_cmp_lt_u32 s64, 65536
s_cbranch_scc1 L_pl_Cq1
L_pd_Cq1:
s_mov_b32 exec_lo, -1
s_mov_b32 exec_hi, 0
s_mov_b32 s64, 0
L_pl_Cq2:
buffer_load_dword v241, v240, s[44:47], 0 offen sc1
s_add_u32 s64, s64, 1
s_waitcnt vmcnt(0)
v_cmp_ne_u32 vcc, s58, v241
s_nop 0
s_cmp_eq_u64 vcc, 0
s_cbranch_scc1 L_pd_Cq2
s_mov_b64 exec, vcc
s_cmp_lt_u32 s64, 65536
s_cbranch_scc1 L_pl_Cq2
L_pd_Cq2:
s_mov_b64 exec, -1
L_wf_Cq:
s_barrier
buffer_load_dwordx4 v[128:131], v242, s[44:47], 0 offen offset:0 sc1
buffer_load_dwordx4 v[132:135], v242, s[44:47], 0 offen offset:2048 sc1
buffer_load_dwordx4 v[136:139], v242, s[44:47], 0 offen offset:512 sc1
buffer_load_dwordx4 v[140:143], v242, s[44:47], 0 offen offset:2560 sc1
s_waitcnt vmcnt(2)
ds_write_b128 v243, v[128:131] offset:0
ds_write_b128 v243, v[132:135] offset:1056
s_waitcnt lgkmcnt(0)
s_barrier
ds_read_b128 v[32:35], v244 offset:0
ds_read_b128 v[36:39], v244 offset:64
ds_read_b128 v[40:43], v244 offset:128
ds_read_b128 v[44:47], v244 offset:192
ds_read_b128 v[48:51], v244 offset:256
ds_read_b128 v[52:55], v244 offset:320
ds_read_b128 v[56:59], v244 offset:384
ds_read_b128 v[60:63], v244 offset:448
s_waitcnt vmcnt(0)
s_waitcnt lgkmcnt(0)
s_barrier
ds_write_b128 v243, v[136:139] offset:0
ds_write_b128 v243, v[140:143] offset:1056
s_waitcnt lgkmcnt(0)
s_barrier
ds_read_b128 v[64:67], v244 offset:0
ds_read_b128 v[68:71], v244 offset:64
ds_read_b128 v[72:75], v244 offset:128
ds_read_b128 v[76:79], v244 offset:192
ds_read_b128 v[80:83], v244 offset:256
ds_read_b128 v[84:87], v244 offset:320
ds_read_b128 v[88:91], v244 offset:384
ds_read_b128 v[92:95], v244 offset:448
s_mov_b32 s39, 0
s_mov_b32 s48, 0
s_waitcnt vmcnt(0)
.p2align 6
L_C_loop:
s_waitcnt lgkmcnt(0)
s_barrier
s_mov_b32 s52, 1
s_cmp_eq_u32 s39, 0
s_cselect_b32 s52, 0, s52
s_sub_u32 s50, 67584, s48
v_add_u32 v23, s50, v22
s_cmp_eq_u32 s52, 0
s_cbranch_scc1 L_C_st0
s_cmp_lt_u32 s53, 0x80000
s_cselect_b32 s40, s40, s68
s_cselect_b32 s41, s41, s69
s_cselect_b32 s42, s42, s70
s_cselect_b32 s54, s54, 0
s_and_b32 s49, s53, 0x70000
s_xor_b32 s49, s49, s54
s_add_u32 s51, s49, 32768
s_add_u32 s53, s53, 0x10000
s_waitcnt vmcnt(7)
ds_write_b128 v23, v[208:211] offset:0
buffer_load_dwordx4 v[208:211], v9, s[40:43], s49 offen offset:0 nt
s_waitcnt vmcnt(7)
ds_write_b128 v23, v[212:215] offset:1056
buffer_load_dwordx4 v[212:215], v9, s[40:43], s49 offen offset:1024 nt
s_waitcnt vmcnt(7)
ds_write_b128 v23, v[216:219] offset:2112
buffer_load_dwordx4 v[216:219], v9, s[40:43], s49 offen offset:2048 nt
s_waitcnt vmcnt(7)
ds_write_b128 v23, v[220:223] offset:3168
buffer_load_dwordx4 v[220:223], v9, s[40:43], s49 offen offset:3072 nt
s_waitcnt vmcnt(7)
ds_write_b128 v23, v[224:227] offset:33792
buffer_load_dwordx4 v[224:227], v9, s[40:43], s51 offen offset:0 nt
s_waitcnt vmcnt(7)
ds_write_b128 v23, v[228:231] offset:34848
buffer_load_dwordx4 v[228:231], v9, s[40:43], s51 offen offset:1024 nt
s_waitcnt vmcnt(7)
ds_write_b128 v23, v[232:235] offset:35904
buffer_load_dwordx4 v[232:235], v9, s[40:43], s51 offen offset:2048 nt
s_waitcnt vmcnt(7)
ds_write_b128 v23, v[236:239] offset:36960
buffer_load_dwordx4 v[236:239], v9, s[40:43], s51 offen offset:3072 nt
L_C_st0:
v_add_u32 v240, s48, v10
v_add_u32 v241, s48, v11
ds_read_b128 v[128:131], v240 offset:0
ds_read_b128 v[132:135], v240 offset:64
ds_read_b128 v[136:139], v240 offset:128
ds_read_b128 v[140:143], v240 offset:192
ds_read_b128 v[144:147], v240 offset:256
ds_read_b128 v[148:151], v240 offset:320
ds_read_b128 v[152:155], v240 offset:384
ds_read_b128 v[156:159], v240 offset:448
ds_read_b128 v[160:163], v240 offset:512
ds_read_b128 v[164:167], v240 offset:576
ds_read_b128 v[168:171], v240 offset:640
ds_read_b128 v[172:175], v240 offset:704
ds_read_b128 v[176:179], v240 offset:768
ds_read_b128 v[180:183], v240 offset:832
ds_read_b128 v[184:187], v240 offset:896
ds_read_b128 v[188:191], v240 offset:960
s_waitcnt lgkmcnt(15)
v_mfma_f32_16x16x32_bf16 v[28:31], v[128:131], v[32:35], 0
s_waitcnt lgkmcnt(14)
v_mfma_f32_16x16x32_bf16 v[28:31], v[132:135], v[36:39], v[28:31]
s_waitcnt lgkmcnt(13)
v_mfma_f32_16x16x32_bf16 v[28:31], v[136:139], v[40:43], v[28:31]
s_waitcnt lgkmcnt(12)
v_mfma_f32_16x16x32_bf16 v[28:31], v[140:143], v[44:47], v[28:31]
s_waitcnt lgkmcnt(11)
v_mfma_f32_16x16x32_bf16 v[28:31], v[144:147], v[48:51], v[28:31]
s_waitcnt lgkmcnt(10)
v_mfma_f32_16x16x32_bf16 v[28:31], v[148:151], v[52:55], v[28:31]
s_waitcnt lgkmcnt(9)
v_mfma_f32_16x16x32_bf16 v[28:31], v[152:155], v[56:59], v[28:31]
s_waitcnt lgkmcnt(8)
v_mfma_f32_16x16x32_bf16 v[28:31], v[156:159], v[60:63], v[28:31]
s_waitcnt lgkmcnt(7)
v_mfma_f32_16x16x32_bf16 v[28:31], v[160:163], v[64:67], v[28:31]
s_waitcnt lgkmcnt(6)
v_mfma_f32_16x16x32_bf16 v[28:31], v[164:167], v[68:71], v[28:31]
s_waitcnt lgkmcnt(5)
v_mfma_f32_16x16x32_bf16 v[28:31], v[168:171], v[72:75], v[28:31]
s_waitcnt lgkmcnt(4)
v_mfma_f32_16x16x32_bf16 v[28:31], v[172:175], v[76:79], v[28:31]
s_waitcnt lgkmcnt(3)
v_mfma_f32_16x16x32_bf16 v[28:31], v[176:179], v[80:83], v[28:31]
s_waitcnt lgkmcnt(2)
v_mfma_f32_16x16x32_bf16 v[28:31], v[180:183], v[84:87], v[28:31]
s_waitcnt lgkmcnt(1)
v_mfma_f32_16x16x32_bf16 v[28:31], v[184:187], v[88:91], v[28:31]
s_waitcnt lgkmcnt(0)
v_mfma_f32_16x16x32_bf16 v[28:31], v[188:191], v[92:95], v[28:31]
s_nop 7
v_mul_f32 v24, v28, v17
v_mul_f32 v25, v29, v17
v_mul_f32 v26, v30, v17
v_mul_f32 v27, v31, v17
v_max3_f32 v242, v24, v25, v26
v_max_f32 v242, v242, v27
v_mov_b32 v243, v242
s_nop 1
v_permlane16_swap_b32 v242, v243
s_nop 0
v_max_f32 v242, v242, v243
v_mov_b32 v243, v242
s_nop 1
v_permlane32_swap_b32 v242, v243
s_nop 0
v_max_f32 v242, v242, v243
s_mov_b64 exec, 0xffff
ds_write_b32 v14, v242 offset:0
s_mov_b64 exec, -1
s_waitcnt lgkmcnt(0)
s_barrier
ds_read_b128 v[192:195], v15 offset:0
ds_read_b128 v[196:199], v16 offset:0
s_waitcnt lgkmcnt(1)
v_max3_f32 v242, v192, v193, v194
v_max3_f32 v242, v242, v195, v18
v_sub_f32 v21, v18, v242
v_sub_f32 v24, v24, v242
v_sub_f32 v25, v25, v242
v_sub_f32 v26, v26, v242
v_sub_f32 v27, v27, v242
v_exp_f32 v21, v21
v_exp_f32 v24, v24
v_exp_f32 v25, v25
v_exp_f32 v26, v26
v_exp_f32 v27, v27
v_mov_b32 v18, v242
v_cvt_pk_bf16_f32 v244, v24, v25
v_cvt_pk_bf16_f32 v245, v26, v27
ds_write_b64 v12, v[244:245] offset:512
v_add_f32 v24, v24, v25
v_add_f32 v26, v26, v27
v_fma_f32 v20, v20, v21, v24
v_add_f32 v20, v20, v26
s_waitcnt lgkmcnt(1)
v_max3_f32 v242, v196, v197, v198
v_max3_f32 v242, v242, v199, v19
v_sub_f32 v21, v19, v242
v_exp_f32 v21, v21
v_mov_b32 v19, v242
v_mul_f32 v96, v96, v21
v_mul_f32 v97, v97, v21
v_mul_f32 v98, v98, v21
v_mul_f32 v99, v99, v21
v_mul_f32 v100, v100, v21
v_mul_f32 v101, v101, v21
v_mul_f32 v102, v102, v21
v_mul_f32 v103, v103, v21
v_mul_f32 v104, v104, v21
v_mul_f32 v105, v105, v21
v_mul_f32 v106, v106, v21
v_mul_f32 v107, v107, v21
v_mul_f32 v108, v108, v21
v_mul_f32 v109, v109, v21
v_mul_f32 v110, v110, v21
v_mul_f32 v111, v111, v21
v_mul_f32 v112, v112, v21
v_mul_f32 v113, v113, v21
v_mul_f32 v114, v114, v21
v_mul_f32 v115, v115, v21
v_mul_f32 v116, v116, v21
v_mul_f32 v117, v117, v21
v_mul_f32 v118, v118, v21
v_mul_f32 v119, v119, v21
v_mul_f32 v120, v120, v21
v_mul_f32 v121, v121, v21
v_mul_f32 v122, v122, v21
v_mul_f32 v123, v123, v21
v_mul_f32 v124, v124, v21
v_mul_f32 v125, v125, v21
v_mul_f32 v126, v126, v21
v_mul_f32 v127, v127, v21
s_waitcnt lgkmcnt(0)
s_barrier
ds_read_b128 v[192:195], v13 offset:512
ds_read_b128 v[196:199], v13 offset:544
ds_read_b128 v[200:203], v13 offset:576
ds_read_b128 v[204:207], v13 offset:608
ds_read_b64_tr_b16 v[128:129], v241 offset:0
ds_read_b64_tr_b16 v[130:131], v241 offset:4224
ds_read_b64_tr_b16 v[132:133], v241 offset:64
ds_read_b64_tr_b16 v[134:135], v241 offset:4288
ds_read_b64_tr_b16 v[136:137], v241 offset:16896
ds_read_b64_tr_b16 v[138:139], v241 offset:21120
ds_read_b64_tr_b16 v[140:141], v241 offset:16960
ds_read_b64_tr_b16 v[142:143], v241 offset:21184
ds_read_b64_tr_b16 v[144:145], v241 offset:33792
ds_read_b64_tr_b16 v[146:147], v241 offset:38016
ds_read_b64_tr_b16 v[148:149], v241 offset:33856
ds_read_b64_tr_b16 v[150:151], v241 offset:38080
ds_read_b64_tr_b16 v[152:153], v241 offset:50688
ds_read_b64_tr_b16 v[154:155], v241 offset:54912
ds_read_b64_tr_b16 v[156:157], v241 offset:50752
ds_read_b64_tr_b16 v[158:159], v241 offset:54976
s_waitcnt lgkmcnt(12)
v_mfma_f32_32x32x16_bf16 v[96:111], v[128:131], v[192:195], v[96:111]
v_mfma_f32_32x32x16_bf16 v[112:127], v[132:135], v[192:195], v[112:127]
s_waitcnt lgkmcnt(8)
v_mfma_f32_32x32x16_bf16 v[96:111], v[136:139], v[196:199], v[96:111]
v_mfma_f32_32x32x16_bf16 v[112:127], v[140:143], v[196:199], v[112:127]
s_waitcnt lgkmcnt(4)
v_mfma_f32_32x32x16_bf16 v[96:111], v[144:147], v[200:203], v[96:111]
v_mfma_f32_32x32x16_bf16 v[112:127], v[148:151], v[200:203], v[112:127]
s_waitcnt lgkmcnt(0)
v_mfma_f32_32x32x16_bf16 v[96:111], v[152:155], v[204:207], v[96:111]
v_mfma_f32_32x32x16_bf16 v[112:127], v[156:159], v[204:207], v[112:127]
s_sub_u32 s48, 67584, s48
s_add_u32 s39, s39, 1
s_cmp_lt_u32 s39, 8
s_cbranch_scc1 L_C_loop
v_mov_b32 v243, v20
s_nop 1
v_permlane16_swap_b32 v20, v243
s_nop 0
v_add_f32 v20, v20, v243
v_mov_b32 v243, v20
s_nop 1
v_permlane32_swap_b32 v20, v243
s_nop 0
v_add_f32 v20, v20, v243
s_barrier
s_mov_b64 exec, 0xffff
ds_write_b32 v14, v20 offset:0
s_mov_b64 exec, -1
v_and_b32 v240, 31, v1
v_mul_u32_u24 v240, 2064, v240
v_lshrrev_b32 v241, 5, v1
v_lshl_add_u32 v240, v241, 4, v240
s_lshl_b32 s62, s34, 8
s_add_u32 s62, s62, 72704
v_add_u32 v240, s62, v240
s_nop 5
ds_write_b128 v240, v[96:99] offset:0
ds_write_b128 v240, v[100:103] offset:32
ds_write_b128 v240, v[104:107] offset:64
ds_write_b128 v240, v[108:111] offset:96
ds_write_b128 v240, v[112:115] offset:128
ds_write_b128 v240, v[116:119] offset:160
ds_write_b128 v240, v[120:123] offset:192
ds_write_b128 v240, v[124:127] offset:224
s_waitcnt lgkmcnt(0)
s_barrier
s_mul_i32 s62, s34, 8256
s_add_u32 s62, s62, 72704
v_lshl_add_u32 v240, v1, 5, s62
ds_read_b128 v[128:131], v240 offset:0
ds_read_b128 v[132:135], v240 offset:16
ds_read_b128 v[136:139], v240 offset:2064
ds_read_b128 v[140:143], v240 offset:2080
ds_read_b128 v[144:147], v240 offset:4128
ds_read_b128 v[148:151], v240 offset:4144
ds_read_b128 v[152:155], v240 offset:6192
ds_read_b128 v[156:159], v240 offset:6208
ds_read_b128 v[192:195], v16 offset:0
s_lshl_b32 s62, s35, 5
s_lshl_b32 s63, s34, 2
s_add_u32 s62, s62, s63
s_lshl_b32 s62, s62, 4
s_and_b32 s63, s32, 15
s_add_u32 s62, s62, s63
s_lshl_b32 s62, s62, 10
s_add_u32 s62, s62, 0x200000
v_lshl_add_u32 v17, v1, 4, s62
s_lshl_b32 s63, s32, 9
s_add_u32 s63, s63, 0x10000
v_lshl_add_u32 v18, v1, 4, s63
v_mov_b32 v241, 0xffff0000
s_waitcnt lgkmcnt(0)
v_add_f32 v192, v192, v193
v_add_f32 v194, v194, v195
v_add_f32 v196, v192, v194
v_and_or_b32 v200, v19, v241, s76
v_lshl_or_b32 v201, v19, 16, s77
v_and_or_b32 v202, v196, v241, s78
v_lshl_or_b32 v203, v196, 16, s79
s_waitcnt vmcnt(0)
s_barrier
L_C_tail:
v_add_u32 v23, 67584, v22
ds_write_b128 v23, v[208:211] offset:0
ds_write_b128 v23, v[212:215] offset:1056
ds_write_b128 v23, v[216:219] offset:2112
ds_write_b128 v23, v[220:223] offset:3168
ds_write_b128 v23, v[224:227] offset:33792
ds_write_b128 v23, v[228:231] offset:34848
ds_write_b128 v23, v[232:235] offset:35904
ds_write_b128 v23, v[236:239] offset:36960
v_lshrrev_b32 v240, 2, v2
v_lshl_add_u32 v240, v3, 3, v240
v_mul_u32_u24 v240, 1056, v240
v_and_b32 v241, 3, v2
v_lshl_add_u32 v240, v241, 3, v240
s_lshl_b32 s62, s34, 7
s_add_u32 s62, s62, 5120
v_add_u32 v240, s62, v240
s_waitcnt lgkmcnt(0)
v_cvt_pk_bf16_f32 v224, v128, v129
v_cvt_pk_bf16_f32 v225, v130, v131
v_cvt_pk_bf16_f32 v226, v132, v133
v_cvt_pk_bf16_f32 v227, v134, v135
v_cvt_pk_bf16_f32 v228, v136, v137
v_cvt_pk_bf16_f32 v229, v138, v139
v_cvt_pk_bf16_f32 v230, v140, v141
v_cvt_pk_bf16_f32 v231, v142, v143
v_cvt_pk_bf16_f32 v232, v144, v145
v_cvt_pk_bf16_f32 v233, v146, v147
v_cvt_pk_bf16_f32 v234, v148, v149
v_cvt_pk_bf16_f32 v235, v150, v151
v_cvt_pk_bf16_f32 v236, v152, v153
v_cvt_pk_bf16_f32 v237, v154, v155
v_cvt_pk_bf16_f32 v238, v156, v157
v_cvt_pk_bf16_f32 v239, v158, v159
s_barrier
ds_read_b64_tr_b16 v[32:33], v240 offset:0
ds_read_b64_tr_b16 v[34:35], v240 offset:4224
ds_read_b64_tr_b16 v[36:37], v240 offset:32
ds_read_b64_tr_b16 v[38:39], v240 offset:4256
ds_read_b64_tr_b16 v[40:41], v240 offset:64
ds_read_b64_tr_b16 v[42:43], v240 offset:4288
ds_read_b64_tr_b16 v[44:45], v240 offset:96
ds_read_b64_tr_b16 v[46:47], v240 offset:4320
s_waitcnt lgkmcnt(0)
v_add_u32 v240, 33792, v240
ds_read_b64_tr_b16 v[48:49], v240 offset:0
ds_read_b64_tr_b16 v[50:51], v240 offset:4224
ds_read_b64_tr_b16 v[52:53], v240 offset:32
ds_read_b64_tr_b16 v[54:55], v240 offset:4256
ds_read_b64_tr_b16 v[56:57], v240 offset:64
ds_read_b64_tr_b16 v[58:59], v240 offset:4288
ds_read_b64_tr_b16 v[60:61], v240 offset:96
ds_read_b64_tr_b16 v[62:63], v240 offset:4320
s_waitcnt lgkmcnt(0)
v_add_u32 v240, 33792, v240
ds_read_b64_tr_b16 v[64:65], v240 offset:0
ds_read_b64_tr_b16 v[66:67], v240 offset:4224
ds_read_b64_tr_b16 v[68:69], v240 offset:32
ds_read_b64_tr_b16 v[70:71], v240 offset:4256
ds_read_b64_tr_b16 v[72:73], v240 offset:64
ds_read_b64_tr_b16 v[74:75], v240 offset:4288
ds_read_b64_tr_b16 v[76:77], v240 offset:96
ds_read_b64_tr_b16 v[78:79], v240 offset:4320
s_waitcnt lgkmcnt(0)
v_add_u32 v240, 33792, v240
ds_read_b64_tr_b16 v[80:81], v240 offset:0
ds_read_b64_tr_b16 v[82:83], v240 offset:4224
ds_read_b64_tr_b16 v[84:85], v240 offset:32
ds_read_b64_tr_b16 v[86:87], v240 offset:4256
ds_read_b64_tr_b16 v[88:89], v240 offset:64
ds_read_b64_tr_b16 v[90:91], v240 offset:4288
ds_read_b64_tr_b16 v[92:93], v240 offset:96
ds_read_b64_tr_b16 v[94:95], v240 offset:4320
s_waitcnt lgkmcnt(0)
v_bfe_u32 v10, v1, 2, 3
v_lshlrev_b32 v10, 11, v10
v_and_b32 v241, 3, v1
v_lshrrev_b32 v11, 5, v1
v_lshl_add_u32 v241, v11, 2, v241
v_lshl_add_u32 v10, v241, 4, v10
s_lshr_b32 s62, s32, 4
s_and_b32 s63, s32, 15
s_lshl_b32 s60, s62, 16
s_lshl_b32 s61, s63, 7
s_add_u32 s60, s60, s61
s_add_u32 s60, s60, 0x40000
v_add_u32 v10, s60, v10
s_lshl_b32 s60, s62, 11
s_lshl_b32 s61, s63, 6
s_add_u32 s60, s60, s61
s_add_u32 s60, s60, 0
v_lshl_add_u32 v11, v241, 3, s60
v_and_b32 v9, 7, v2
v_lshlrev_b32 v9, 10, v9
v_lshrrev_b32 v241, 3, v2
v_mul_u32_u24 v242, 512, v241
v_add_u32 v9, v9, v242
v_lshl_add_u32 v9, v3, 4, v9
s_lshl_b32 s62, s32, 13
s_add_u32 s62, s62, 0x60000
s_lshl_b32 s63, s34, 6
s_add_u32 s63, s63, s62
v_add_u32 v9, s63, v9
v_mul_u32_u24 v12, 272, v241
v_lshl_add_u32 v12, v3, 3, v12
s_lshl_b32 s62, s34, 5
v_add_u32 v12, s62, v12
v_and_b32 v241, 1, v2
v_mul_u32_u24 v13, 272, v241
v_lshl_add_u32 v13, v3, 4, v13
v_lshlrev_b32 v14, 16, v241
v_bfe_u32 v241, v2, 1, 2
v_lshl_add_u32 v14, v241, 6, v14
v_lshl_add_u32 v14, v3, 4, v14
s_lshl_b32 s62, s32, 11
s_lshl_b32 s63, s34, 8
s_add_u32 s62, s62, s63
s_add_u32 s62, s62, 0x40000
v_add_u32 v14, s62, v14
s_mov_b32 s82, 0xc0c0c0c
s_mov_b32 s83, 0xc0c0c0c
s_mov_b32 s84, 0x30303030
s_mov_b32 s85, 0x30303030
s_mov_b32 s86, 0xc0c0c0c0
s_mov_b32 s87, 0xc0c0c0c0
v_mov_b32 v15, 0xffffff00
s_mov_b32 s60, 0x0c0c0501
s_mov_b32 s61, 0x05010c0c
s_mov_b32 s53, 65536
s_branch L_C_merge
L_C_poll:
v_mov_b32 v96, 0
v_mov_b32 v97, 0
v_mov_b32 v98, 0x8000
v_mov_b32 v99, 0xff00
s_cmp_lg_u32 s34, 0
s_cbranch_scc1 L_Ch_d
s_lshl_b32 s62, s32, 13
s_add_u32 s62, s62, 0x61800
v_lshl_add_u32 v241, v1, 7, s62
s_mov_b64 exec, 1
s_mov_b32 s64, 0
L_pl_Ch:
buffer_load_dword v240, v241, s[44:47], 0 offen offset:1024 sc1
s_add_u32 s64, s64, 1
s_waitcnt vmcnt(0)
v_cmp_gt_i32 vcc, 0, v240
s_nop 0
s_cmp_eq_u64 vcc, 0
s_cbranch_scc1 L_pd_Ch
s_mov_b64 exec, vcc
s_sleep 2
s_cmp_lt_u32 s64, 65536
s_cbranch_scc1 L_pl_Ch
L_pd_Ch:
s_mov_b64 exec, -1
L_Ch_d:
s_barrier
s_mov_b32 s63, 0
buffer_store_dwordx4 v[224:227], v17, s[44:47], s63 offen sc1
s_mov_b32 s63, 16384
buffer_store_dwordx4 v[228:231], v17, s[44:47], s63 offen sc1
s_mov_b32 s63, 32768
buffer_store_dwordx4 v[232:235], v17, s[44:47], s63 offen sc1
s_mov_b32 s63, 49152
buffer_store_dwordx4 v[236:239], v17, s[44:47], s63 offen sc1
s_waitcnt vmcnt(0)
s_barrier
s_cmp_lg_u32 s34, 0
s_cbranch_scc1 L_C_nostat
s_mov_b32 exec_hi, 0
buffer_store_dwordx4 v[200:203], v18, s[44:47], 0 offen sc1
s_mov_b64 exec, -1
L_C_nostat:
s_cmp_lg_u32 s34, 0
s_cbranch_scc1 L_Cg_d
s_lshl_b32 s62, s32, 13
s_add_u32 s62, s62, 0x61800
v_lshl_add_u32 v241, v1, 7, s62
s_mov_b64 exec, 1
s_mov_b32 s64, 0
L_pl_Cg:
buffer_load_dword v240, v241, s[44:47], 0 offen offset:1024 sc1
s_add_u32 s64, s64, 1
s_waitcnt vmcnt(0)
v_cmp_gt_i32 vcc, 1, v240
s_nop 0
s_cmp_eq_u64 vcc, 0
s_cbranch_scc1 L_pd_Cg
s_mov_b64 exec, vcc
s_sleep 2
s_cmp_lt_u32 s64, 65536
s_cbranch_scc1 L_pl_Cg
L_pd_Cg:
s_mov_b64 exec, -1
L_Cg_d:
s_barrier
s_mov_b32 exec_lo, 0x3f3f3f3f
s_mov_b32 exec_hi, 0x3f3f3f3f
s_mov_b32 s64, 0
s_mov_b32 s66, 0x1000
s_mov_b32 s67, 0x2000
buffer_load_dwordx4 v[208:211], v9, s[44:47], 0 offen sc1
L_ps_Co:
s_waitcnt vmcnt(0)
v_xor_b32 v96, s76, v208
v_xor_b32 v97, s77, v209
v_xor_b32 v98, s78, v210
v_xor_b32 v99, s79, v211
v_or_b32 v240, v96, v97
v_or3_b32 v240, v240, v98, v99
v_and_b32 v240, 0xff, v240
v_cmp_ne_u32 vcc, 0, v240
s_cmp_eq_u64 vcc, 0
s_cbranch_scc1 L_pe_Co
buffer_load_dwordx4 v[208:211], v9, s[44:47], 0 offen sc1
s_add_u32 s64, s64, 1
s_cmp_lt_u32 s64, 65536
s_cbranch_scc1 L_ps_Co
L_pe_Co:
s_mov_b64 exec, -1
L_C_merge:
v_perm_b32 v100, v97, v96, s60
v_perm_b32 v101, v99, v98, s61
v_or_b32 v100, v100, v101
v_and_b32 v96, 0xffff0000, v96
v_and_b32 v97, 0xffff0000, v97
v_max_f32_dpp v101, v100, v100 quad_perm:[1,0,3,2] row_mask:0xf bank_mask:0xf
v_and_b32 v98, 0xffff0000, v98
v_and_b32 v99, 0xffff0000, v99
v_max_f32_dpp v101, v101, v101 quad_perm:[2,3,0,1] row_mask:0xf bank_mask:0xf
s_nop 1
v_max_f32_dpp v101, v101, v101 row_half_mirror row_mask:0xf bank_mask:0xf
v_sub_f32 v100, v100, v101
v_exp_f32 v100, v100
s_nop 0
v_mul_f32 v96, v96, v100
v_mul_f32 v97, v97, v100
v_mul_f32 v98, v98, v100
v_mul_f32 v99, v99, v100
v_add_f32_dpp v100, v100, v100 quad_perm:[1,0,3,2] row_mask:0xf bank_mask:0xf
v_add_f32_dpp v96, v96, v96 quad_perm:[1,0,3,2] row_mask:0xf bank_mask:0xf
v_add_f32_dpp v97, v97, v97 quad_perm:[1,0,3,2] row_mask:0xf bank_mask:0xf
v_add_f32_dpp v98, v98, v98 quad_perm:[1,0,3,2] row_mask:0xf bank_mask:0xf
v_add_f32_dpp v99, v99, v99 quad_perm:[1,0,3,2] row_mask:0xf bank_mask:0xf
v_add_f32_dpp v100, v100, v100 quad_perm:[2,3,0,1] row_mask:0xf bank_mask:0xf
v_add_f32_dpp v96, v96, v96 quad_perm:[2,3,0,1] row_mask:0xf bank_mask:0xf
v_add_f32_dpp v97, v97, v97 quad_perm:[2,3,0,1] row_mask:0xf bank_mask:0xf
v_add_f32_dpp v98, v98, v98 quad_perm:[2,3,0,1] row_mask:0xf bank_mask:0xf
v_add_f32_dpp v99, v99, v99 quad_perm:[2,3,0,1] row_mask:0xf bank_mask:0xf
v_add_f32_dpp v100, v100, v100 row_half_mirror row_mask:0xf bank_mask:0xf
v_add_f32_dpp v96, v96, v96 row_half_mirror row_mask:0xf bank_mask:0xf
v_add_f32_dpp v97, v97, v97 row_half_mirror row_mask:0xf bank_mask:0xf
v_add_f32_dpp v98, v98, v98 row_half_mirror row_mask:0xf bank_mask:0xf
v_add_f32_dpp v99, v99, v99 row_half_mirror row_mask:0xf bank_mask:0xf
v_rcp_f32 v100, v100
s_mov_b32 exec_lo, 0x01010101
s_mov_b32 exec_hi, 0x01010101
v_mul_f32 v96, v96, v100
v_mul_f32 v97, v97, v100
v_mul_f32 v98, v98, v100
v_mul_f32 v99, v99, v100
v_cvt_pk_bf16_f32 v96, v96, v97
v_cvt_pk_bf16_f32 v97, v98, v99
ds_write_b64 v12, v[96:97] offset:0
s_mov_b64 exec, -1
s_waitcnt lgkmcnt(0)
s_barrier
ds_read_b128 v[104:107], v13 offset:0
ds_read_b128 v[108:111], v13 offset:64
ds_read_b128 v[112:115], v13 offset:128
ds_read_b128 v[116:119], v13 offset:192
s_waitcnt lgkmcnt(3)
v_mfma_f32_16x16x32_bf16 v[128:131], v[32:35], v[104:107], 0
v_mfma_f32_16x16x32_bf16 v[132:135], v[36:39], v[104:107], 0
v_mfma_f32_16x16x32_bf16 v[136:139], v[40:43], v[104:107], 0
v_mfma_f32_16x16x32_bf16 v[140:143], v[44:47], v[104:107], 0
s_waitcnt lgkmcnt(2)
v_mfma_f32_16x16x32_bf16 v[128:131], v[48:51], v[108:111], v[128:131]
v_mfma_f32_16x16x32_bf16 v[132:135], v[52:55], v[108:111], v[132:135]
v_mfma_f32_16x16x32_bf16 v[136:139], v[56:59], v[108:111], v[136:139]
v_mfma_f32_16x16x32_bf16 v[140:143], v[60:63], v[108:111], v[140:143]
s_waitcnt lgkmcnt(1)
v_mfma_f32_16x16x32_bf16 v[128:131], v[64:67], v[112:115], v[128:131]
v_mfma_f32_16x16x32_bf16 v[132:135], v[68:71], v[112:115], v[132:135]
v_mfma_f32_16x16x32_bf16 v[136:139], v[72:75], v[112:115], v[136:139]
v_mfma_f32_16x16x32_bf16 v[140:143], v[76:79], v[112:115], v[140:143]
s_waitcnt lgkmcnt(0)
v_mfma_f32_16x16x32_bf16 v[128:131], v[80:83], v[116:119], v[128:131]
v_mfma_f32_16x16x32_bf16 v[132:135], v[84:87], v[116:119], v[132:135]
v_mfma_f32_16x16x32_bf16 v[136:139], v[88:91], v[116:119], v[136:139]
v_mfma_f32_16x16x32_bf16 v[140:143], v[92:95], v[116:119], v[140:143]
s_mov_b32 s64, s53
s_nop 4
v_cndmask_b32 v128, v128, v132, s[82:83]
v_cndmask_b32 v129, v129, v133, s[82:83]
v_cndmask_b32 v130, v130, v134, s[82:83]
v_cndmask_b32 v131, v131, v135, s[82:83]
v_cndmask_b32 v128, v128, v136, s[84:85]
v_cndmask_b32 v129, v129, v137, s[84:85]
v_cndmask_b32 v130, v130, v138, s[84:85]
v_cndmask_b32 v131, v131, v139, s[84:85]
v_cndmask_b32 v128, v128, v140, s[86:87]
v_cndmask_b32 v129, v129, v141, s[86:87]
v_cndmask_b32 v130, v130, v142, s[86:87]
v_cndmask_b32 v131, v131, v143, s[86:87]
v_add_u32 v128, 0x80, v128
v_add_u32 v129, 0x80, v129
v_add_u32 v130, 0x80, v130
v_add_u32 v131, 0x80, v131
v_and_or_b32 v128, v128, v15, s76
v_and_or_b32 v129, v129, v15, s77
v_and_or_b32 v130, v130, v15, s78
v_and_or_b32 v131, v131, v15, s79
s_cmp_lg_u32 s53, 0
s_cbranch_scc1 L_C_nost
s_mov_b32 exec_lo, 0x00ff00ff
s_mov_b32 exec_hi, 0x00ff00ff
buffer_store_dwordx4 v[128:131], v14, s[44:47], 0 offen sc1
s_mov_b64 exec, -1
L_C_nost:
s_cmp_lg_u32 s34, 4
s_cbranch_scc1 L_C_end
s_mov_b32 s66, 0x4000
s_mov_b32 s67, 0x8000
s_mov_b32 s65, 0xc000
buffer_load_dwordx4 v[144:147], v10, s[44:47], 0 offen sc1
buffer_load_dwordx4 v[148:151], v10, s[44:47], s66 offen sc1
buffer_load_dwordx4 v[152:155], v10, s[44:47], s67 offen sc1
buffer_load_dwordx4 v[156:159], v10, s[44:47], s65 offen sc1
s_sleep 6
buffer_load_dwordx4 v[160:163], v10, s[44:47], 0 offen sc1
buffer_load_dwordx4 v[164:167], v10, s[44:47], s66 offen sc1
buffer_load_dwordx4 v[168:171], v10, s[44:47], s67 offen sc1
buffer_load_dwordx4 v[172:175], v10, s[44:47], s65 offen sc1
s_sleep 6
buffer_load_dwordx4 v[176:179], v10, s[44:47], 0 offen sc1
buffer_load_dwordx4 v[180:183], v10, s[44:47], s66 offen sc1
buffer_load_dwordx4 v[184:187], v10, s[44:47], s67 offen sc1
buffer_load_dwordx4 v[188:191], v10, s[44:47], s65 offen sc1
L_ps_Cf:
s_waitcnt vmcnt(11)
v_xor_b32 v192, s76, v144
v_xor_b32 v193, s77, v145
v_xor_b32 v194, s78, v146
v_xor_b32 v195, s79, v147
v_or_b32 v240, v192, v193
v_or3_b32 v240, v240, v194, v195
s_waitcnt vmcnt(10)
v_xor_b32 v196, s76, v148
v_xor_b32 v197, s77, v149
v_xor_b32 v198, s78, v150
v_xor_b32 v199, s79, v151
v_or3_b32 v240, v240, v196, v197
v_or3_b32 v240, v240, v198, v199
v_add_f32 v192, v192, v196
v_add_f32 v193, v193, v197
v_add_f32 v194, v194, v198
v_add_f32 v195, v195, v199
s_waitcnt vmcnt(9)
v_xor_b32 v196, s76, v152
v_xor_b32 v197, s77, v153
v_xor_b32 v198, s78, v154
v_xor_b32 v199, s79, v155
v_or3_b32 v240, v240, v196, v197
v_or3_b32 v240, v240, v198, v199
v_add_f32 v192, v192, v196
v_add_f32 v193, v193, v197
v_add_f32 v194, v194, v198
v_add_f32 v195, v195, v199
s_waitcnt vmcnt(8)
v_xor_b32 v196, s76, v156
v_xor_b32 v197, s77, v157
v_xor_b32 v198, s78, v158
v_xor_b32 v199, s79, v159
v_or3_b32 v240, v240, v196, v197
v_or3_b32 v240, v240, v198, v199
v_add_f32 v192, v192, v196
v_add_f32 v193, v193, v197
v_add_f32 v194, v194, v198
v_add_f32 v195, v195, v199
v_and_b32 v240, 0xff, v240
v_cmp_ne_u32 vcc, 0, v240
v_add_f32_dpp v192, v192, v192 row_ror:8 row_mask:0xf bank_mask:0xf
v_add_f32_dpp v193, v193, v193 row_ror:8 row_mask:0xf bank_mask:0xf
v_add_f32_dpp v194, v194, v194 row_ror:8 row_mask:0xf bank_mask:0xf
v_add_f32_dpp v195, v195, v195 row_ror:8 row_mask:0xf bank_mask:0xf
s_cmp_eq_u64 vcc, 0
s_cbranch_scc1 L_pe_Cf
buffer_load_dwordx4 v[144:147], v10, s[44:47], 0 offen sc1
buffer_load_dwordx4 v[148:151], v10, s[44:47], s66 offen sc1
buffer_load_dwordx4 v[152:155], v10, s[44:47], s67 offen sc1
buffer_load_dwordx4 v[156:159], v10, s[44:47], s65 offen sc1
s_waitcnt vmcnt(11)
v_xor_b32 v192, s76, v160
v_xor_b32 v193, s77, v161
v_xor_b32 v194, s78, v162
v_xor_b32 v195, s79, v163
v_or_b32 v240, v192, v193
v_or3_b32 v240, v240, v194, v195
s_waitcnt vmcnt(10)
v_xor_b32 v196, s76, v164
v_xor_b32 v197, s77, v165
v_xor_b32 v198, s78, v166
v_xor_b32 v199, s79, v167
v_or3_b32 v240, v240, v196, v197
v_or3_b32 v240, v240, v198, v199
v_add_f32 v192, v192, v196
v_add_f32 v193, v193, v197
v_add_f32 v194, v194, v198
v_add_f32 v195, v195, v199
s_waitcnt vmcnt(9)
v_xor_b32 v196, s76, v168
v_xor_b32 v197, s77, v169
v_xor_b32 v198, s78, v170
v_xor_b32 v199, s79, v171
v_or3_b32 v240, v240, v196, v197
v_or3_b32 v240, v240, v198, v199
v_add_f32 v192, v192, v196
v_add_f32 v193, v193, v197
v_add_f32 v194, v194, v198
v_add_f32 v195, v195, v199
s_waitcnt vmcnt(8)
v_xor_b32 v196, s76, v172
v_xor_b32 v197, s77, v173
v_xor_b32 v198, s78, v174
v_xor_b32 v199, s79, v175
v_or3_b32 v240, v240, v196, v197
v_or3_b32 v240, v240, v198, v199
v_add_f32 v192, v192, v196
v_add_f32 v193, v193, v197
v_add_f32 v194, v194, v198
v_add_f32 v195, v195, v199
v_and_b32 v240, 0xff, v240
v_cmp_ne_u32 vcc, 0, v240
v_add_f32_dpp v192, v192, v192 row_ror:8 row_mask:0xf bank_mask:0xf
v_add_f32_dpp v193, v193, v193 row_ror:8 row_mask:0xf bank_mask:0xf
v_add_f32_dpp v194, v194, v194 row_ror:8 row_mask:0xf bank_mask:0xf
v_add_f32_dpp v195, v195, v195 row_ror:8 row_mask:0xf bank_mask:0xf
s_cmp_eq_u64 vcc, 0
s_cbranch_scc1 L_pe_Cf
buffer_load_dwordx4 v[160:163], v10, s[44:47], 0 offen sc1
buffer_load_dwordx4 v[164:167], v10, s[44:47], s66 offen sc1
buffer_load_dwordx4 v[168:171], v10, s[44:47], s67 offen sc1
buffer_load_dwordx4 v[172:175], v10, s[44:47], s65 offen sc1
s_waitcnt vmcnt(11)
v_xor_b32 v192, s76, v176
v_xor_b32 v193, s77, v177
v_xor_b32 v194, s78, v178
v_xor_b32 v195, s79, v179
v_or_b32 v240, v192, v193
v_or3_b32 v240, v240, v194, v195
s_waitcnt vmcnt(10)
v_xor_b32 v196, s76, v180
v_xor_b32 v197, s77, v181
v_xor_b32 v198, s78, v182
v_xor_b32 v199, s79, v183
v_or3_b32 v240, v240, v196, v197
v_or3_b32 v240, v240, v198, v199
v_add_f32 v192, v192, v196
v_add_f32 v193, v193, v197
v_add_f32 v194, v194, v198
v_add_f32 v195, v195, v199
s_waitcnt vmcnt(9)
v_xor_b32 v196, s76, v184
v_xor_b32 v197, s77, v185
v_xor_b32 v198, s78, v186
v_xor_b32 v199, s79, v187
v_or3_b32 v240, v240, v196, v197
v_or3_b32 v240, v240, v198, v199
v_add_f32 v192, v192, v196
v_add_f32 v193, v193, v197
v_add_f32 v194, v194, v198
v_add_f32 v195, v195, v199
s_waitcnt vmcnt(8)
v_xor_b32 v196, s76, v188
v_xor_b32 v197, s77, v189
v_xor_b32 v198, s78, v190
v_xor_b32 v199, s79, v191
v_or3_b32 v240, v240, v196, v197
v_or3_b32 v240, v240, v198, v199
v_add_f32 v192, v192, v196
v_add_f32 v193, v193, v197
v_add_f32 v194, v194, v198
v_add_f32 v195, v195, v199
v_and_b32 v240, 0xff, v240
v_cmp_ne_u32 vcc, 0, v240
v_add_f32_dpp v192, v192, v192 row_ror:8 row_mask:0xf bank_mask:0xf
v_add_f32_dpp v193, v193, v193 row_ror:8 row_mask:0xf bank_mask:0xf
v_add_f32_dpp v194, v194, v194 row_ror:8 row_mask:0xf bank_mask:0xf
v_add_f32_dpp v195, v195, v195 row_ror:8 row_mask:0xf bank_mask:0xf
s_cmp_eq_u64 vcc, 0
s_cbranch_scc1 L_pe_Cf
buffer_load_dwordx4 v[176:179], v10, s[44:47], 0 offen sc1
buffer_load_dwordx4 v[180:183], v10, s[44:47], s66 offen sc1
buffer_load_dwordx4 v[184:187], v10, s[44:47], s67 offen sc1
buffer_load_dwordx4 v[188:191], v10, s[44:47], s65 offen sc1
s_add_u32 s64, s64, 1
s_cmp_lt_u32 s64, 65536
s_cbranch_scc1 L_ps_Cf
L_pe_Cf:
v_add_f32_dpp v192, v192, v192 row_ror:4 row_mask:0xf bank_mask:0xf
v_add_f32_dpp v193, v193, v193 row_ror:4 row_mask:0xf bank_mask:0xf
v_add_f32_dpp v194, v194, v194 row_ror:4 row_mask:0xf bank_mask:0xf
v_add_f32_dpp v195, v195, v195 row_ror:4 row_mask:0xf bank_mask:0xf
v_mov_b32 v240, v192
v_mov_b32 v241, v193
v_mov_b32 v242, v194
v_mov_b32 v243, v195
v_permlane16_swap_b32 v192, v240
v_permlane16_swap_b32 v193, v241
v_permlane16_swap_b32 v194, v242
v_permlane16_swap_b32 v195, v243
v_add_f32 v192, v192, v240
v_add_f32 v193, v193, v241
v_add_f32 v194, v194, v242
v_add_f32 v195, v195, v243
v_cvt_pk_bf16_f32 v192, v192, v193
v_cvt_pk_bf16_f32 v193, v194, v195
s_cmp_lg_u32 s53, 0
s_cbranch_scc1 L_C_end
s_mov_b32 exec_lo, 15
s_mov_b32 exec_hi, 15
global_store_dwordx2 v11, v[192:193], s[26:27]
s_mov_b64 exec, -1
s_cmp_lg_u32 s32, 0
s_cbranch_scc1 L_C_end
v_mov_b32 v240, 0x14000
v_mov_b32 v241, s58
s_mov_b64 exec, 1
buffer_store_dword v241, v240, s[44:47], 0 offen
L_C_end:
s_cmp_lg_u32 s53, 0
s_mov_b32 s53, 0
s_cbranch_scc1 L_C_poll
s_endpgm
L_exit:
s_endpgm
.section .rodata,"a"
.p2align 6
.amdhsa_kernel concat_heads__gqa_block_cached__compressed_kv_cla__decode_kernel
  .amdhsa_next_free_vgpr 256
  .amdhsa_next_free_sgpr 102
  .amdhsa_accum_offset 256
  .amdhsa_group_segment_fixed_size 0
  .amdhsa_kernarg_size 112
  .amdhsa_user_sgpr_count 2
  .amdhsa_user_sgpr_kernarg_segment_ptr 1
  .amdhsa_system_sgpr_workgroup_id_x 1
.end_amdhsa_kernel
```

```asm
; @launch grid=(256,1,1) block=(512,1,1) lds=157696
.amdgcn_target "amdgcn-amd-amdhsa--gfx950"
.text
.globl concat_heads__gqa_block_cached__compressed_kv_cla__decode_kernel
.p2align 12
.type concat_heads__gqa_block_cached__compressed_kv_cla__decode_kernel,@function
concat_heads__gqa_block_cached__compressed_kv_cla__decode_kernel:
s_cmp_ge_u32 s2, 256
s_cbranch_scc1 L_exit
s_load_dwordx16 s[4:19], s[0:1], 0
s_load_dwordx8 s[20:27], s[0:1], 64
s_load_dwordx4 s[28:31], s[0:1], 96
v_lshrrev_b32 v8, 6, v0
s_lshr_b32 s32, s2, 3
s_mov_b32 s60, 0x54321076
s_cmp_ge_u32 s2, 64
s_cselect_b32 s60, 0x54327610, s60
s_cmp_ge_u32 s2, 128
s_cselect_b32 s60, 0x54763210, s60
s_cmp_ge_u32 s2, 192
s_cselect_b32 s60, 0x76543210, s60
s_and_b32 s61, s32, 7
s_lshl_b32 s61, s61, 2
s_lshr_b32 s33, s60, s61
s_and_b32 s33, s33, 7
s_lshl_b32 s61, s33, 2
s_lshr_b32 s61, 0x50764321, s61
s_xor_b32 s61, s61, s2
s_lshr_b32 s60, s2, 6
s_xor_b32 s61, s61, s60
s_and_b32 s61, s61, 7
s_andn2_b32 s32, s32, 7
s_or_b32 s32, s32, s61
s_and_b32 s33, s33, 7
v_readfirstlane_b32 s34, v8
v_and_b32 v1, 63, v0
v_and_b32 v2, 15, v0
v_bfe_u32 v3, v0, 4, 2
s_cmp_eq_u32 s33, 6
s_cbranch_scc1 L_roleW
s_cmp_eq_u32 s33, 7
s_cbranch_scc1 L_roleC
L_roleA:
s_mov_b32 s87, 0x20000
s_andn2_b32 s60, s32, 7
s_and_b32 s61, s2, 7
s_or_b32 s82, s60, s61
s_lshr_b32 s60, s2, 6
s_xor_b32 s82, s82, s60
s_xor_b32 s83, s82, 5
v_lshlrev_b32 v11, 4, v2
s_add_u32 s60, s33, 0x1
s_lshl3_add_u32 s60, s60, s34
s_lshl_b32 s60, s60, 17
s_lshl_b32 s61, s83, 8
s_add_u32 s60, s60, s61
s_mov_b32 s86, 0x400000
s_mov_b32 s88, s60
s_mov_b32 s81, 13
s_add_u32 s60, s33, 0xfffffffe
s_lshl3_add_u32 s60, s60, s34
s_lshl_b32 s60, s60, 17
s_lshl_b32 s61, s82, 8
s_add_u32 s60, s60, s61
s_cmp_ge_u32 s33, 3
s_cselect_b32 s86, 0x400000, s86
s_cselect_b32 s88, s60, s88
s_cselect_b32 s81, 13, s81
s_lshl_b32 s89, 4, s81
v_lshl_add_u32 v9, v3, s81, v11
s_add_u32 s60, s88, s89
s_add_u32 s61, s60, s89
s_add_u32 s62, s61, s89
s_cmp_ge_u32 s33, 3
s_waitcnt lgkmcnt(0)
s_cselect_b64 s[84:85], s[18:19], s[10:11]
s_and_b32 s85, s85, 0xffff
buffer_load_dwordx4 v[20:23], v9, s[84:87], s88 offen
buffer_load_dwordx4 v[24:27], v9, s[84:87], s60 offen
buffer_load_dwordx4 v[28:31], v9, s[84:87], s61 offen
buffer_load_dwordx4 v[32:35], v9, s[84:87], s62 offen
v_lshlrev_b32 v8, 4, v1
s_bfe_u32 s55, s32, 0x10005
s_lshl_b32 s55, s55, 26
s_lshl_b32 s35, s33, 3
s_add_u32 s35, s35, s34
s_lshr_b32 s69, s32, 4
s_mul_i32 s69, s69, 128
s_bfe_u32 s63, s35, 0x10009
s_lshl_b32 s63, s63, 26
s_xor_b32 s37, s63, s55
s_xor_b32 s63, s35, s69
s_and_b32 s63, s63, 511
s_lshl_b32 s63, s63, 12
s_or_b32 s37, s37, s63
s_lshl_b32 s62, s32, 21
s_add_u32 s40, s6, s62
s_addc_u32 s41, s7, 0
s_and_b32 s41, s41, 0xffff
s_mov_b32 s42, 0x4200000
s_mov_b32 s43, 0x20000
s_add_u32 s60, s33, 0x0
s_lshl3_add_u32 s60, s60, s34
s_lshl_b32 s60, s60, 17
s_lshl_b32 s61, s82, 8
s_add_u32 s60, s60, s61
s_mov_b64 s[84:85], s[20:21]
s_mov_b32 s86, 0x400000
s_mov_b32 s88, s60
s_mov_b32 s81, 13
s_add_u32 s60, s33, 0xfffffffc
s_lshl3_add_u32 s60, s60, s34
s_lshl_b32 s60, s60, 17
s_xor_b32 s61, s82, 7
s_lshl_b32 s61, s61, 8
s_add_u32 s60, s60, s61
s_cmp_ge_u32 s33, 4
s_cselect_b64 s[84:85], s[22:23], s[84:85]
s_cselect_b32 s86, 0x400000, s86
s_cselect_b32 s88, s60, s88
s_cselect_b32 s81, 13, s81
s_and_b32 s85, s85, 0xffff
s_lshl_b32 s89, 4, s81
v_lshl_add_u32 v10, v3, s81, v11
s_waitcnt vmcnt(3)
buffer_load_dwordx4 v[20:23], v10, s[84:87], s88 offen
s_add_u32 s88, s88, s89
s_waitcnt vmcnt(3)
buffer_load_dwordx4 v[24:27], v10, s[84:87], s88 offen
s_add_u32 s88, s88, s89
s_waitcnt vmcnt(3)
buffer_load_dwordx4 v[28:31], v10, s[84:87], s88 offen
s_add_u32 s88, s88, s89
s_waitcnt vmcnt(3)
buffer_load_dwordx4 v[32:35], v10, s[84:87], s88 offen
s_add_u32 s60, s33, 0x2
s_lshl3_add_u32 s60, s60, s34
s_lshl_b32 s60, s60, 17
s_xor_b32 s61, s82, 7
s_lshl_b32 s61, s61, 8
s_add_u32 s60, s60, s61
s_mov_b64 s[84:85], s[22:23]
s_mov_b32 s86, 0x400000
s_mov_b32 s88, s60
s_mov_b32 s81, 13
s_add_u32 s60, s33, 0xfffffffe
s_lshl3_add_u32 s60, s60, s34
s_lshl_b32 s60, s60, 12
s_xor_b32 s61, s82, 7
s_lshl_b32 s61, s61, 17
s_add_u32 s60, s60, s61
s_cmp_ge_u32 s33, 2
s_cselect_b64 s[84:85], s[24:25], s[84:85]
s_cselect_b32 s86, 0x400000, s86
s_cselect_b32 s88, s60, s88
s_cselect_b32 s81, 8, s81
s_and_b32 s85, s85, 0xffff
s_lshl_b32 s89, 4, s81
v_lshl_add_u32 v9, v3, s81, v11
s_waitcnt vmcnt(3)
buffer_load_dwordx4 v[20:23], v9, s[84:87], s88 offen
s_add_u32 s88, s88, s89
s_waitcnt vmcnt(3)
buffer_load_dwordx4 v[24:27], v9, s[84:87], s88 offen
s_add_u32 s88, s88, s89
s_waitcnt vmcnt(3)
buffer_load_dwordx4 v[28:31], v9, s[84:87], s88 offen
s_add_u32 s88, s88, s89
s_waitcnt vmcnt(3)
buffer_load_dwordx4 v[32:35], v9, s[84:87], s88 offen
s_add_u32 s60, s33, 0x2
s_lshl3_add_u32 s60, s60, s34
s_lshl_b32 s60, s60, 12
s_and_b32 s61, s83, 3
s_lshl_b32 s61, s61, 17
s_xor_b32 s60, s60, s61
s_lshl_b32 s61, s83, 19
s_add_u32 s60, s60, s61
s_mov_b64 s[84:85], s[16:17]
s_mov_b32 s86, 0x1000000
s_mov_b32 s88, s60
s_mov_b32 s81, 8
s_and_b32 s85, s85, 0xffff
s_lshl_b32 s89, 4, s81
v_lshl_add_u32 v10, v3, s81, v11
s_waitcnt vmcnt(3)
buffer_load_dwordx4 v[20:23], v10, s[84:87], s88 offen
s_add_u32 s88, s88, s89
s_waitcnt vmcnt(3)
buffer_load_dwordx4 v[24:27], v10, s[84:87], s88 offen
s_add_u32 s88, s88, s89
s_waitcnt vmcnt(3)
buffer_load_dwordx4 v[28:31], v10, s[84:87], s88 offen
s_add_u32 s88, s88, s89
s_waitcnt vmcnt(3)
buffer_load_dwordx4 v[32:35], v10, s[84:87], s88 offen
s_add_u32 s60, s33, 0x8
s_lshl3_add_u32 s60, s60, s34
s_lshl_b32 s60, s60, 12
s_and_b32 s61, s83, 3
s_lshl_b32 s61, s61, 17
s_xor_b32 s60, s60, s61
s_lshl_b32 s61, s83, 19
s_add_u32 s60, s60, s61
s_mov_b64 s[84:85], s[16:17]
s_mov_b32 s86, 0x1000000
s_mov_b32 s88, s60
s_mov_b32 s81, 8
s_and_b32 s85, s85, 0xffff
s_lshl_b32 s89, 4, s81
v_lshl_add_u32 v9, v3, s81, v11
s_waitcnt vmcnt(3)
buffer_load_dwordx4 v[20:23], v9, s[84:87], s88 offen
s_add_u32 s88, s88, s89
s_waitcnt vmcnt(3)
buffer_load_dwordx4 v[24:27], v9, s[84:87], s88 offen
s_add_u32 s88, s88, s89
s_waitcnt vmcnt(3)
buffer_load_dwordx4 v[28:31], v9, s[84:87], s88 offen
s_add_u32 s88, s88, s89
s_waitcnt vmcnt(3)
buffer_load_dwordx4 v[32:35], v9, s[84:87], s88 offen
s_add_u32 s60, s33, 0xe
s_lshl3_add_u32 s60, s60, s34
s_lshl_b32 s60, s60, 12
s_and_b32 s61, s83, 3
s_lshl_b32 s61, s61, 17
s_xor_b32 s60, s60, s61
s_lshl_b32 s61, s83, 19
s_add_u32 s60, s60, s61
s_mov_b64 s[84:85], s[16:17]
s_mov_b32 s86, 0x1000000
s_mov_b32 s88, s60
s_mov_b32 s81, 8
s_add_u32 s60, s33, 0xfffffffe
s_lshl3_add_u32 s60, s60, s34
s_lshl_b32 s60, s60, 12
s_lshl_b32 s61, s83, 17
s_add_u32 s60, s60, s61
s_cmp_ge_u32 s33, 2
s_cselect_b64 s[84:85], s[12:13], s[84:85]
s_cselect_b32 s86, 0x400000, s86
s_cselect_b32 s88, s60, s88
s_cselect_b32 s81, 8, s81
s_and_b32 s85, s85, 0xffff
s_lshl_b32 s89, 4, s81
v_lshl_add_u32 v10, v3, s81, v11
s_waitcnt vmcnt(3)
buffer_load_dwordx4 v[20:23], v10, s[84:87], s88 offen
s_add_u32 s88, s88, s89
s_waitcnt vmcnt(3)
buffer_load_dwordx4 v[24:27], v10, s[84:87], s88 offen
s_add_u32 s88, s88, s89
s_waitcnt vmcnt(3)
buffer_load_dwordx4 v[28:31], v10, s[84:87], s88 offen
s_add_u32 s88, s88, s89
s_waitcnt vmcnt(3)
buffer_load_dwordx4 v[32:35], v10, s[84:87], s88 offen
s_waitcnt vmcnt(3)
buffer_load_dwordx4 v[52:55], v8, s[40:43], s37 offen offset:0 nt
s_waitcnt vmcnt(3)
buffer_load_dwordx4 v[56:59], v8, s[40:43], s37 offen offset:1024 nt
s_waitcnt vmcnt(3)
buffer_load_dwordx4 v[60:63], v8, s[40:43], s37 offen offset:2048 nt
s_waitcnt vmcnt(3)
buffer_load_dwordx4 v[64:67], v8, s[40:43], s37 offen offset:3072 nt
s_add_u32 s44, s8, s62
s_addc_u32 s45, s9, 0
s_and_b32 s45, s45, 0xffff
s_mov_b32 s46, 0x4200000
s_mov_b32 s47, 0x20000
s_mov_b64 s[70:71], s[40:41]
s_mov_b64 s[72:73], s[44:45]
s_mov_b64 s[44:45], s[40:41]
s_mov_b32 s50, s35
s_mov_b32 s74, 0x00010001
s_mov_b32 s75, 0x00010001
s_mul_i32 s63, s34, 1216
s_add_u32 s63, s63, 8832
v_lshl_add_u32 v165, v3, 4, s63
v_add_u32 v164, 256, v165
v_mov_b32 v166, 0xff7fffff
v_mov_b32 v167, 0xff7fffff
v_and_b32 v132, 1, v0
v_lshlrev_b32 v132, 4, v132
v_mov_b32 v133, 0xffff
v_lshlrev_b32 v132, v132, v133
v_bfe_u32 v133, v0, 1, 2
v_cmp_eq_u32 vcc, 0, v133
s_nop 1
v_cndmask_b32 v4, 0, v132, vcc
v_cmp_eq_u32 vcc, 1, v133
s_nop 1
v_cndmask_b32 v5, 0, v132, vcc
v_cmp_eq_u32 vcc, 2, v133
s_nop 1
v_cndmask_b32 v6, 0, v132, vcc
v_cmp_eq_u32 vcc, 3, v133
s_nop 1
v_cndmask_b32 v7, 0, v132, vcc
s_load_dword s58, s[30:31], 0x14000
s_lshl_b32 s62, s32, 13
s_add_u32 s62, s62, 0x61800
s_mov_b32 s66, 16
s_add_u32 s52, s30, s62
s_addc_u32 s53, s31, 0
v_mov_b32 v140, 0xff7fffff
v_mov_b32 v141, 0
v_mov_b32 v136, 0
v_mov_b32 v137, 0
v_mov_b32 v138, 0
v_mov_b32 v139, 0
v_mov_b32 v144, 0x3e0293ee
s_mov_b32 s56, 0
s_mov_b32 s54, 0
s_lshr_b32 s61, s55, 17
v_lshrrev_b32 v151, 1, v3
v_lshlrev_b32 v151, 9, v151
v_xor_b32 v151, s61, v151
v_lshl_add_u32 v151, v2, 5, v151
v_and_b32 v132, 1, v3
v_lshl_add_u32 v151, v132, 4, v151
s_lshl_b32 s62, s32, 10
s_add_u32 s62, s62, 0x18000
v_add_u32 v151, s62, v151
v_lshlrev_b32 v148, 5, v2
v_lshl_add_u32 v148, v3, 4, v148
s_mul_i32 s62, s34, 1056
v_add_u32 v148, s62, v148
s_lshl_b32 s62, s34, 3
v_mov_b32 v149, s62
v_and_b32 v132, 7, v1
v_lshrrev_b32 v133, 3, v1
v_add_u32 v133, s62, v133
v_lshlrev_b32 v133, 4, v133
v_mul_u32_u24 v150, 1056, v132
v_add_u32 v150, v150, v133
v_xor_b32 v154, s61, v133
s_lshl_b32 s62, s32, 3
s_add_u32 s62, s62, s33
s_lshl_b32 s62, s62, 10
s_add_u32 s62, s62, 0x60000
v_add_u32 v154, s62, v154
s_waitcnt vmcnt(3)
s_add_u32 s35, s35, 48
s_bfe_u32 s63, s35, 0x10009
s_lshl_b32 s63, s63, 26
s_xor_b32 s37, s63, s55
s_xor_b32 s63, s35, s69
s_and_b32 s63, s63, 511
s_lshl_b32 s63, s63, 12
s_or_b32 s37, s37, s63
buffer_load_dwordx4 v[68:71], v8, s[44:47], s37 offen offset:0 nt
s_waitcnt vmcnt(3)
buffer_load_dwordx4 v[72:75], v8, s[44:47], s37 offen offset:1024 nt
s_waitcnt vmcnt(3)
buffer_load_dwordx4 v[76:79], v8, s[44:47], s37 offen offset:2048 nt
s_waitcnt vmcnt(3)
buffer_load_dwordx4 v[80:83], v8, s[44:47], s37 offen offset:3072 nt
s_waitcnt vmcnt(3)
s_add_u32 s35, s35, 48
s_bfe_u32 s63, s35, 0x10009
s_lshl_b32 s63, s63, 26
s_xor_b32 s37, s63, s55
s_xor_b32 s63, s35, s69
s_and_b32 s63, s63, 511
s_lshl_b32 s63, s63, 12
s_or_b32 s37, s37, s63
buffer_load_dwordx4 v[84:87], v8, s[40:43], s37 offen offset:0 nt
s_waitcnt vmcnt(3)
buffer_load_dwordx4 v[88:91], v8, s[40:43], s37 offen offset:1024 nt
s_waitcnt vmcnt(3)
buffer_load_dwordx4 v[92:95], v8, s[40:43], s37 offen offset:2048 nt
s_waitcnt vmcnt(3)
buffer_load_dwordx4 v[96:99], v8, s[40:43], s37 offen offset:3072 nt
s_waitcnt vmcnt(3)
s_add_u32 s35, s35, 48
s_bfe_u32 s63, s35, 0x10009
s_lshl_b32 s63, s63, 26
s_xor_b32 s37, s63, s55
s_xor_b32 s63, s35, s69
s_and_b32 s63, s63, 511
s_lshl_b32 s63, s63, 12
s_or_b32 s37, s37, s63
buffer_load_dwordx4 v[100:103], v8, s[44:47], s37 offen offset:0 nt
s_waitcnt vmcnt(3)
buffer_load_dwordx4 v[104:107], v8, s[44:47], s37 offen offset:1024 nt
s_waitcnt vmcnt(3)
buffer_load_dwordx4 v[108:111], v8, s[44:47], s37 offen offset:2048 nt
s_waitcnt vmcnt(3)
buffer_load_dwordx4 v[112:115], v8, s[44:47], s37 offen offset:3072 nt
global_load_dwordx4 v[120:123], v151, s[30:31] sc1
s_waitcnt vmcnt(4)
s_add_u32 s35, s35, 48
s_bfe_u32 s63, s35, 0x10009
s_lshl_b32 s63, s63, 26
s_xor_b32 s37, s63, s55
s_xor_b32 s63, s35, s69
s_and_b32 s63, s63, 511
s_lshl_b32 s63, s63, 12
s_or_b32 s37, s37, s63
buffer_load_dwordx4 v[20:23], v8, s[40:43], s37 offen offset:0 nt
s_waitcnt vmcnt(4)
buffer_load_dwordx4 v[24:27], v8, s[40:43], s37 offen offset:1024 nt
s_waitcnt vmcnt(4)
buffer_load_dwordx4 v[28:31], v8, s[40:43], s37 offen offset:2048 nt
s_waitcnt vmcnt(4)
buffer_load_dwordx4 v[32:35], v8, s[40:43], s37 offen offset:3072 nt
s_waitcnt lgkmcnt(0)
s_add_u32 s58, s58, 0x9e3779b9
s_bfe_u32 s76, s58, 0x80000
s_bfe_u32 s77, s58, 0x80008
s_bfe_u32 s78, s58, 0x80010
s_bfe_u32 s79, s58, 0x80018
s_mov_b32 s64, 0
s_mov_b32 s60, 0x05040100
s_mov_b32 s61, 0x07060302
s_waitcnt vmcnt(4)
L_A_qchk:
v_perm_b32 v132, v121, v120, s60
v_perm_b32 v133, v123, v122, s60
v_xor_b32 v132, s58, v132
v_xor_b32 v133, s58, v133
v_or_b32 v132, v132, v133
v_cmp_ne_u32 vcc, 0, v132
s_add_u32 s64, s64, 1
s_cmp_eq_u64 vcc, 0
s_cbranch_scc1 L_A_qok
s_cmp_ge_u32 s64, 65536
s_cbranch_scc1 L_A_qok
global_load_dwordx4 v[120:123], v151, s[30:31] sc1
s_waitcnt vmcnt(0)
s_branch L_A_qchk
L_A_qok:
v_perm_b32 v132, v121, v120, s61
v_perm_b32 v133, v123, v122, s61
v_lshlrev_b32 v134, 2, v2
ds_bpermute_b32 v12, v134, v132 offset:0
ds_bpermute_b32 v13, v134, v133 offset:0
ds_bpermute_b32 v14, v134, v132 offset:64
ds_bpermute_b32 v15, v134, v133 offset:64
ds_bpermute_b32 v16, v134, v132 offset:128
ds_bpermute_b32 v17, v134, v133 offset:128
ds_bpermute_b32 v18, v134, v132 offset:192
ds_bpermute_b32 v19, v134, v133 offset:192
s_waitcnt lgkmcnt(0)
v_mov_b32 v160, v12
v_mov_b32 v161, v13
v_mov_b32 v162, v14
v_mov_b32 v163, v15
.p2align 6
L_A_loopa:
s_cmp_lt_u32 s54, 2
s_cbranch_scc1 L_A_back
L_A_backd:
s_add_u32 s49, s35, 48
s_bfe_u32 s63, s49, 0x10009
s_lshl_b32 s63, s63, 26
s_xor_b32 s48, s63, s55
s_xor_b32 s63, s49, s69
s_and_b32 s63, s63, 511
s_lshl_b32 s63, s63, 12
s_or_b32 s48, s48, s63
s_lshr_b32 s62, s35, 9
s_cmp_lg_u32 s62, s56
s_cbranch_scc1 L_A_swa
L_A_swda:
s_waitcnt vmcnt(3)
buffer_load_dwordx4 v[36:39], v8, s[44:47], s48 offen offset:0 nt
v_dot2_f32_bf16 v116, v20, v160, 0
v_dot2_f32_bf16 v116, v21, v161, v116
v_dot2_f32_bf16 v116, v22, v162, v116
v_dot2_f32_bf16 v116, v23, v163, v116
s_nop 2
v_add_f32_dpp v116, v116, v116 row_ror:8 row_mask:0xf bank_mask:0xf
s_nop 1
v_add_f32_dpp v116, v116, v116 row_ror:4 row_mask:0xf bank_mask:0xf
s_nop 1
v_add_f32_dpp v116, v116, v116 row_ror:2 row_mask:0xf bank_mask:0xf
s_nop 1
v_add_f32_dpp v116, v116, v116 row_ror:1 row_mask:0xf bank_mask:0xf
v_mul_f32 v116, v116, v144
s_waitcnt vmcnt(3)
buffer_load_dwordx4 v[40:43], v8, s[44:47], s48 offen offset:1024 nt
v_dot2_f32_bf16 v117, v24, v160, 0
v_dot2_f32_bf16 v117, v25, v161, v117
v_dot2_f32_bf16 v117, v26, v162, v117
v_dot2_f32_bf16 v117, v27, v163, v117
s_nop 2
v_add_f32_dpp v117, v117, v117 row_ror:8 row_mask:0xf bank_mask:0xf
s_nop 1
v_add_f32_dpp v117, v117, v117 row_ror:4 row_mask:0xf bank_mask:0xf
s_nop 1
v_add_f32_dpp v117, v117, v117 row_ror:2 row_mask:0xf bank_mask:0xf
s_nop 1
v_add_f32_dpp v117, v117, v117 row_ror:1 row_mask:0xf bank_mask:0xf
v_mul_f32 v117, v117, v144
s_waitcnt vmcnt(3)
buffer_load_dwordx4 v[44:47], v8, s[44:47], s48 offen offset:2048 nt
v_dot2_f32_bf16 v118, v28, v160, 0
v_dot2_f32_bf16 v118, v29, v161, v118
v_dot2_f32_bf16 v118, v30, v162, v118
v_dot2_f32_bf16 v118, v31, v163, v118
s_nop 2
v_add_f32_dpp v118, v118, v118 row_ror:8 row_mask:0xf bank_mask:0xf
s_nop 1
v_add_f32_dpp v118, v118, v118 row_ror:4 row_mask:0xf bank_mask:0xf
s_nop 1
v_add_f32_dpp v118, v118, v118 row_ror:2 row_mask:0xf bank_mask:0xf
s_nop 1
v_add_f32_dpp v118, v118, v118 row_ror:1 row_mask:0xf bank_mask:0xf
v_mul_f32 v118, v118, v144
s_waitcnt vmcnt(3)
buffer_load_dwordx4 v[48:51], v8, s[44:47], s48 offen offset:3072 nt
v_dot2_f32_bf16 v119, v32, v160, 0
v_dot2_f32_bf16 v119, v33, v161, v119
v_dot2_f32_bf16 v119, v34, v162, v119
v_dot2_f32_bf16 v119, v35, v163, v119
s_nop 2
v_add_f32_dpp v119, v119, v119 row_ror:8 row_mask:0xf bank_mask:0xf
s_nop 1
v_add_f32_dpp v119, v119, v119 row_ror:4 row_mask:0xf bank_mask:0xf
s_nop 1
v_add_f32_dpp v119, v119, v119 row_ror:2 row_mask:0xf bank_mask:0xf
s_nop 1
v_add_f32_dpp v119, v119, v119 row_ror:1 row_mask:0xf bank_mask:0xf
v_mul_f32 v119, v119, v144
s_mov_b64 exec, s[74:75]
ds_write_b128 v164, v[116:119] offset:0
s_mov_b64 exec, -1
v_max3_f32 v167, v167, v116, v117
v_max3_f32 v167, v167, v118, v119
s_lshr_b32 s62, s49, 9
s_cmp_lg_u32 s62, s56
s_cbranch_scc1 L_A_swa2
L_A_swda2:
s_add_u32 s36, s35, 96
s_cmp_eq_u32 s54, 6
s_cselect_b32 s36, s50, s36
s_cselect_b64 s[40:41], s[72:73], s[40:41]
s_bfe_u32 s63, s36, 0x10009
s_lshl_b32 s63, s63, 26
s_xor_b32 s38, s63, s55
s_xor_b32 s63, s36, s69
s_and_b32 s63, s63, 511
s_lshl_b32 s63, s63, 12
s_or_b32 s38, s38, s63
s_waitcnt vmcnt(3)
buffer_load_dwordx4 v[20:23], v8, s[40:43], s38 offen offset:0 nt
v_dot2_f32_bf16 v156, v36, v160, 0
v_dot2_f32_bf16 v156, v37, v161, v156
v_dot2_f32_bf16 v156, v38, v162, v156
v_dot2_f32_bf16 v156, v39, v163, v156
s_nop 2
v_add_f32_dpp v156, v156, v156 row_ror:8 row_mask:0xf bank_mask:0xf
s_nop 1
v_add_f32_dpp v156, v156, v156 row_ror:4 row_mask:0xf bank_mask:0xf
s_nop 1
v_add_f32_dpp v156, v156, v156 row_ror:2 row_mask:0xf bank_mask:0xf
s_nop 1
v_add_f32_dpp v156, v156, v156 row_ror:1 row_mask:0xf bank_mask:0xf
v_mul_f32 v156, v156, v144
s_waitcnt vmcnt(3)
buffer_load_dwordx4 v[24:27], v8, s[40:43], s38 offen offset:1024 nt
v_dot2_f32_bf16 v157, v40, v160, 0
v_dot2_f32_bf16 v157, v41, v161, v157
v_dot2_f32_bf16 v157, v42, v162, v157
v_dot2_f32_bf16 v157, v43, v163, v157
s_nop 2
v_add_f32_dpp v157, v157, v157 row_ror:8 row_mask:0xf bank_mask:0xf
s_nop 1
v_add_f32_dpp v157, v157, v157 row_ror:4 row_mask:0xf bank_mask:0xf
s_nop 1
v_add_f32_dpp v157, v157, v157 row_ror:2 row_mask:0xf bank_mask:0xf
s_nop 1
v_add_f32_dpp v157, v157, v157 row_ror:1 row_mask:0xf bank_mask:0xf
v_mul_f32 v157, v157, v144
s_waitcnt vmcnt(3)
buffer_load_dwordx4 v[28:31], v8, s[40:43], s38 offen offset:2048 nt
v_dot2_f32_bf16 v158, v44, v160, 0
v_dot2_f32_bf16 v158, v45, v161, v158
v_dot2_f32_bf16 v158, v46, v162, v158
v_dot2_f32_bf16 v158, v47, v163, v158
s_nop 2
v_add_f32_dpp v158, v158, v158 row_ror:8 row_mask:0xf bank_mask:0xf
s_nop 1
v_add_f32_dpp v158, v158, v158 row_ror:4 row_mask:0xf bank_mask:0xf
s_nop 1
v_add_f32_dpp v158, v158, v158 row_ror:2 row_mask:0xf bank_mask:0xf
s_nop 1
v_add_f32_dpp v158, v158, v158 row_ror:1 row_mask:0xf bank_mask:0xf
v_mul_f32 v158, v158, v144
s_waitcnt vmcnt(3)
buffer_load_dwordx4 v[32:35], v8, s[40:43], s38 offen offset:3072 nt
v_dot2_f32_bf16 v159, v48, v160, 0
v_dot2_f32_bf16 v159, v49, v161, v159
v_dot2_f32_bf16 v159, v50, v162, v159
v_dot2_f32_bf16 v159, v51, v163, v159
s_nop 2
v_add_f32_dpp v159, v159, v159 row_ror:8 row_mask:0xf bank_mask:0xf
s_nop 1
v_add_f32_dpp v159, v159, v159 row_ror:4 row_mask:0xf bank_mask:0xf
s_nop 1
v_add_f32_dpp v159, v159, v159 row_ror:2 row_mask:0xf bank_mask:0xf
s_nop 1
v_add_f32_dpp v159, v159, v159 row_ror:1 row_mask:0xf bank_mask:0xf
v_mul_f32 v159, v159, v144
s_mov_b64 exec, s[74:75]
ds_write_b128 v164, v[156:159] offset:64
s_mov_b64 exec, -1
v_max3_f32 v167, v167, v156, v157
v_max3_f32 v167, v167, v158, v159
v_add_u32 v164, 128, v164
s_mov_b32 s35, s36
s_mov_b32 s37, s38
s_add_u32 s54, s54, 1
s_cmp_lt_u32 s54, 7
s_cbranch_scc1 L_A_loopa
s_mov_b64 s[44:45], s[72:73]
s_mov_b32 s56, 0
v_mov_b32 v164, v165
ds_read_b128 v[116:119], v165
v_mov_b32 v145, v166
s_nop 1
v_permlane16_swap_b32 v166, v145
s_nop 0
v_max_f32 v166, v166, v145
v_mov_b32 v145, v166
s_nop 1
v_permlane32_swap_b32 v166, v145
s_nop 0
v_max_f32 v166, v166, v145
v_mov_b32 v145, v167
s_nop 1
v_permlane16_swap_b32 v167, v145
s_nop 0
v_max_f32 v167, v167, v145
v_mov_b32 v145, v167
s_nop 1
v_permlane32_swap_b32 v167, v145
s_nop 0
v_max_f32 v167, v167, v145
v_mov_b32 v140, v166
.p2align 6
L_A_loopc:
s_add_u32 s49, s35, 48
s_bfe_u32 s63, s49, 0x10009
s_lshl_b32 s63, s63, 26
s_xor_b32 s48, s63, s55
s_xor_b32 s63, s49, s69
s_and_b32 s63, s63, 511
s_lshl_b32 s63, s63, 12
s_or_b32 s48, s48, s63
s_lshr_b32 s62, s35, 9
s_cmp_lg_u32 s62, s56
s_cbranch_scc1 L_A_swc
L_A_swdc:
s_waitcnt lgkmcnt(0)
s_cmp_lt_u32 s54, s66
s_cbranch_scc1 L_A_nogc
s_mov_b32 s39, 1
s_atomic_add s39, s[52:53], 0 glc
L_A_nogc:
ds_read_b128 v[156:159], v164 offset:64
v_sub_f32 v116, v116, v140
v_sub_f32 v117, v117, v140
v_sub_f32 v118, v118, v140
v_sub_f32 v119, v119, v140
v_exp_f32 v116, v116
v_exp_f32 v117, v117
v_exp_f32 v118, v118
v_exp_f32 v119, v119
v_cvt_pk_bf16_f32 v146, v116, v116
v_add_f32 v141, v141, v116
v_and_b32 v120, v146, v4
v_and_b32 v121, v146, v5
v_and_b32 v122, v146, v6
v_and_b32 v123, v146, v7
s_waitcnt vmcnt(3)
buffer_load_dwordx4 v[36:39], v8, s[44:47], s48 offen offset:0 nt
v_mfma_f32_16x16x32_bf16 v[136:139], v[120:123], v[20:23], v[136:139]
v_cvt_pk_bf16_f32 v147, v117, v117
v_add_f32 v141, v141, v117
v_and_b32 v124, v147, v4
v_and_b32 v125, v147, v5
v_and_b32 v126, v147, v6
v_and_b32 v127, v147, v7
s_waitcnt vmcnt(3)
buffer_load_dwordx4 v[40:43], v8, s[44:47], s48 offen offset:1024 nt
v_mfma_f32_16x16x32_bf16 v[136:139], v[124:127], v[24:27], v[136:139]
v_cvt_pk_bf16_f32 v146, v118, v118
v_add_f32 v141, v141, v118
v_and_b32 v128, v146, v4
v_and_b32 v129, v146, v5
v_and_b32 v130, v146, v6
v_and_b32 v131, v146, v7
s_waitcnt vmcnt(3)
buffer_load_dwordx4 v[44:47], v8, s[44:47], s48 offen offset:2048 nt
v_mfma_f32_16x16x32_bf16 v[136:139], v[128:131], v[28:31], v[136:139]
v_cvt_pk_bf16_f32 v147, v119, v119
v_add_f32 v141, v141, v119
v_and_b32 v132, v147, v4
v_and_b32 v133, v147, v5
v_and_b32 v134, v147, v6
v_and_b32 v135, v147, v7
s_waitcnt vmcnt(3)
buffer_load_dwordx4 v[48:51], v8, s[44:47], s48 offen offset:3072 nt
v_mfma_f32_16x16x32_bf16 v[136:139], v[132:135], v[32:35], v[136:139]
s_lshr_b32 s62, s49, 9
s_cmp_lg_u32 s62, s56
s_cbranch_scc1 L_A_swc2
L_A_swdc2:
s_waitcnt lgkmcnt(0)
ds_read_b128 v[116:119], v164 offset:128
v_sub_f32 v156, v156, v140
v_sub_f32 v157, v157, v140
v_sub_f32 v158, v158, v140
v_sub_f32 v159, v159, v140
v_exp_f32 v156, v156
v_exp_f32 v157, v157
v_exp_f32 v158, v158
v_exp_f32 v159, v159
v_cvt_pk_bf16_f32 v146, v156, v156
v_add_f32 v141, v141, v156
v_and_b32 v120, v146, v4
v_and_b32 v121, v146, v5
v_and_b32 v122, v146, v6
v_and_b32 v123, v146, v7
s_add_u32 s36, s35, 96
s_cmp_eq_u32 s54, 15
s_cselect_b64 s[40:41], s[70:71], s[40:41]
s_cmp_lt_u32 s54, 16
s_cbranch_scc1 L_A_notc
s_waitcnt lgkmcnt(0)
s_add_u32 s39, s39, 1
s_cmp_eq_u32 s39, 29
s_cbranch_scc1 L_A_sigc
s_cmp_eq_u32 s39, 95
s_cbranch_scc1 L_A_sigc
L_A_sigdc:
s_min_u32 s39, s39, 1024
s_add_u32 s36, s39, 912
L_A_notc:
s_bfe_u32 s63, s36, 0x10009
s_lshl_b32 s63, s63, 26
s_xor_b32 s38, s63, s55
s_xor_b32 s63, s36, s69
s_and_b32 s63, s63, 511
s_lshl_b32 s63, s63, 12
s_or_b32 s38, s38, s63
s_cmp_lt_u32 s36, 1024
s_cselect_b32 s42, s42, 0
s_waitcnt vmcnt(3)
buffer_load_dwordx4 v[20:23], v8, s[40:43], s38 offen offset:0 nt
v_mfma_f32_16x16x32_bf16 v[136:139], v[120:123], v[36:39], v[136:139]
v_cvt_pk_bf16_f32 v147, v157, v157
v_add_f32 v141, v141, v157
v_and_b32 v124, v147, v4
v_and_b32 v125, v147, v5
v_and_b32 v126, v147, v6
v_and_b32 v127, v147, v7
s_waitcnt vmcnt(3)
buffer_load_dwordx4 v[24:27], v8, s[40:43], s38 offen offset:1024 nt
v_mfma_f32_16x16x32_bf16 v[136:139], v[124:127], v[40:43], v[136:139]
v_cvt_pk_bf16_f32 v146, v158, v158
v_add_f32 v141, v141, v158
v_and_b32 v128, v146, v4
v_and_b32 v129, v146, v5
v_and_b32 v130, v146, v6
v_and_b32 v131, v146, v7
s_waitcnt vmcnt(3)
buffer_load_dwordx4 v[28:31], v8, s[40:43], s38 offen offset:2048 nt
v_mfma_f32_16x16x32_bf16 v[136:139], v[128:131], v[44:47], v[136:139]
v_cvt_pk_bf16_f32 v147, v159, v159
v_add_f32 v141, v141, v159
v_and_b32 v132, v147, v4
v_and_b32 v133, v147, v5
v_and_b32 v134, v147, v6
v_and_b32 v135, v147, v7
s_waitcnt vmcnt(3)
buffer_load_dwordx4 v[32:35], v8, s[40:43], s38 offen offset:3072 nt
v_mfma_f32_16x16x32_bf16 v[136:139], v[132:135], v[48:51], v[136:139]
v_add_u32 v164, 128, v164
s_mov_b32 s35, s36
s_mov_b32 s37, s38
s_add_u32 s54, s54, 1
s_cmp_ge_u32 s35, 1024
s_cbranch_scc1 L_A_out
s_cmp_lt_u32 s54, 16
s_cbranch_scc1 L_A_loopc
s_waitcnt lgkmcnt(0)
.p2align 6
L_A_loopb:
s_cmp_lt_u32 s54, s66
s_cbranch_scc1 L_A_nogb
s_mov_b32 s39, 1
s_atomic_add s39, s[52:53], 0 glc
L_A_nogb:
s_waitcnt vmcnt(3)
buffer_load_dwordx4 v[36:39], v8, s[44:47], s37 offen offset:0 nt
v_dot2_f32_bf16 v116, v20, v160, 0
v_dot2_f32_bf16 v116, v21, v161, v116
v_dot2_f32_bf16 v116, v22, v162, v116
v_dot2_f32_bf16 v116, v23, v163, v116
s_nop 2
v_add_f32_dpp v116, v116, v116 row_ror:8 row_mask:0xf bank_mask:0xf
s_nop 1
v_add_f32_dpp v116, v116, v116 row_ror:4 row_mask:0xf bank_mask:0xf
s_nop 1
v_add_f32_dpp v116, v116, v116 row_ror:2 row_mask:0xf bank_mask:0xf
s_nop 1
v_add_f32_dpp v116, v116, v116 row_ror:1 row_mask:0xf bank_mask:0xf
v_mul_f32 v116, v116, v144
s_waitcnt vmcnt(3)
buffer_load_dwordx4 v[40:43], v8, s[44:47], s37 offen offset:1024 nt
v_dot2_f32_bf16 v117, v24, v160, 0
v_dot2_f32_bf16 v117, v25, v161, v117
v_dot2_f32_bf16 v117, v26, v162, v117
v_dot2_f32_bf16 v117, v27, v163, v117
s_nop 2
v_add_f32_dpp v117, v117, v117 row_ror:8 row_mask:0xf bank_mask:0xf
s_nop 1
v_add_f32_dpp v117, v117, v117 row_ror:4 row_mask:0xf bank_mask:0xf
s_nop 1
v_add_f32_dpp v117, v117, v117 row_ror:2 row_mask:0xf bank_mask:0xf
s_nop 1
v_add_f32_dpp v117, v117, v117 row_ror:1 row_mask:0xf bank_mask:0xf
v_mul_f32 v117, v117, v144
s_waitcnt vmcnt(3)
buffer_load_dwordx4 v[44:47], v8, s[44:47], s37 offen offset:2048 nt
v_dot2_f32_bf16 v118, v28, v160, 0
v_dot2_f32_bf16 v118, v29, v161, v118
v_dot2_f32_bf16 v118, v30, v162, v118
v_dot2_f32_bf16 v118, v31, v163, v118
s_nop 2
v_add_f32_dpp v118, v118, v118 row_ror:8 row_mask:0xf bank_mask:0xf
s_nop 1
v_add_f32_dpp v118, v118, v118 row_ror:4 row_mask:0xf bank_mask:0xf
s_nop 1
v_add_f32_dpp v118, v118, v118 row_ror:2 row_mask:0xf bank_mask:0xf
s_nop 1
v_add_f32_dpp v118, v118, v118 row_ror:1 row_mask:0xf bank_mask:0xf
v_mul_f32 v118, v118, v144
s_waitcnt vmcnt(3)
buffer_load_dwordx4 v[48:51], v8, s[44:47], s37 offen offset:3072 nt
v_dot2_f32_bf16 v119, v32, v160, 0
v_dot2_f32_bf16 v119, v33, v161, v119
v_dot2_f32_bf16 v119, v34, v162, v119
v_dot2_f32_bf16 v119, v35, v163, v119
s_nop 2
v_add_f32_dpp v119, v119, v119 row_ror:8 row_mask:0xf bank_mask:0xf
s_nop 1
v_add_f32_dpp v119, v119, v119 row_ror:4 row_mask:0xf bank_mask:0xf
s_nop 1
v_add_f32_dpp v119, v119, v119 row_ror:2 row_mask:0xf bank_mask:0xf
s_nop 1
v_add_f32_dpp v119, v119, v119 row_ror:1 row_mask:0xf bank_mask:0xf
v_mul_f32 v119, v119, v144
v_max3_f32 v145, v116, v117, v118
v_max_f32 v145, v145, v119
v_cmp_gt_f32 vcc, v145, v140
s_nop 0
s_cmp_lg_u64 vcc, 0
s_cbranch_scc1 L_A_maxb
L_A_maxdb:
v_sub_f32 v116, v116, v140
v_sub_f32 v117, v117, v140
v_sub_f32 v118, v118, v140
v_sub_f32 v119, v119, v140
v_exp_f32 v116, v116
v_exp_f32 v117, v117
v_exp_f32 v118, v118
v_exp_f32 v119, v119
v_cvt_pk_bf16_f32 v146, v116, v116
v_add_f32 v141, v141, v116
v_and_b32 v120, v146, v4
v_and_b32 v121, v146, v5
v_and_b32 v122, v146, v6
v_and_b32 v123, v146, v7
s_add_u32 s36, s35, 48
s_cmp_lt_u32 s54, 16
s_cbranch_scc1 L_A_notb
s_waitcnt lgkmcnt(0)
s_add_u32 s39, s39, 1
s_cmp_eq_u32 s39, 29
s_cbranch_scc1 L_A_sigb
s_cmp_eq_u32 s39, 95
s_cbranch_scc1 L_A_sigb
L_A_sigdb:
s_min_u32 s39, s39, 1024
s_add_u32 s36, s39, 912
L_A_notb:
s_bfe_u32 s63, s36, 0x10009
s_lshl_b32 s63, s63, 26
s_xor_b32 s38, s63, s55
s_xor_b32 s63, s36, s69
s_and_b32 s63, s63, 511
s_lshl_b32 s63, s63, 12
s_or_b32 s38, s38, s63
s_cmp_lt_u32 s36, 1024
s_cselect_b32 s42, s42, 0
s_waitcnt vmcnt(3)
buffer_load_dwordx4 v[20:23], v8, s[40:43], s38 offen offset:0 nt
v_mfma_f32_16x16x32_bf16 v[136:139], v[120:123], v[36:39], v[136:139]
v_cvt_pk_bf16_f32 v147, v117, v117
v_add_f32 v141, v141, v117
v_and_b32 v124, v147, v4
v_and_b32 v125, v147, v5
v_and_b32 v126, v147, v6
v_and_b32 v127, v147, v7
s_waitcnt vmcnt(3)
buffer_load_dwordx4 v[24:27], v8, s[40:43], s38 offen offset:1024 nt
v_mfma_f32_16x16x32_bf16 v[136:139], v[124:127], v[40:43], v[136:139]
v_cvt_pk_bf16_f32 v146, v118, v118
v_add_f32 v141, v141, v118
v_and_b32 v128, v146, v4
v_and_b32 v129, v146, v5
v_and_b32 v130, v146, v6
v_and_b32 v131, v146, v7
s_waitcnt vmcnt(3)
buffer_load_dwordx4 v[28:31], v8, s[40:43], s38 offen offset:2048 nt
v_mfma_f32_16x16x32_bf16 v[136:139], v[128:131], v[44:47], v[136:139]
v_cvt_pk_bf16_f32 v147, v119, v119
v_add_f32 v141, v141, v119
v_and_b32 v132, v147, v4
v_and_b32 v133, v147, v5
v_and_b32 v134, v147, v6
v_and_b32 v135, v147, v7
s_waitcnt vmcnt(3)
buffer_load_dwordx4 v[32:35], v8, s[40:43], s38 offen offset:3072 nt
v_mfma_f32_16x16x32_bf16 v[136:139], v[132:135], v[48:51], v[136:139]
s_mov_b32 s35, s36
s_mov_b32 s37, s38
s_add_u32 s54, s54, 1
s_cmp_lt_u32 s35, 1024
s_cbranch_scc1 L_A_loopb
L_A_out:
v_add_f32_dpp v141, v141, v141 row_bcast:15 row_mask:0xa bank_mask:0xf
s_nop 1
v_add_f32_dpp v141, v141, v141 row_bcast:31 row_mask:0xc bank_mask:0xf
s_mov_b32 exec_lo, 0
s_brev_b32 exec_hi, 1
ds_write_b64 v149, v[140:141] offset:8512
s_mov_b32 exec_lo, -1
s_mov_b32 exec_hi, 0
ds_write_b128 v148, v[136:139] offset:512
s_mov_b64 exec, -1
v_and_b32 v133, 7, v1
s_lshr_b32 s62, s34, 2
s_lshl_b32 s62, s62, 6
v_lshl_add_u32 v133, v133, 3, s62
v_mov_b32 v132, s58
s_mov_b32 s62, 0x05010400
s_mov_b32 s63, 0x07030602
s_mov_b32 s68, 0x01010101
s_mov_b32 s69, 0x01010101
s_waitcnt lgkmcnt(0)
s_barrier
L_A_nobar:
ds_read_b64 v[124:125], v133 offset:8448
ds_read_b128 v[120:123], v150 offset:0
s_waitcnt lgkmcnt(1)
v_max_f32_dpp v126, v124, v124 quad_perm:[1,0,3,2] row_mask:0xf bank_mask:0xf
s_nop 1
v_max_f32_dpp v126, v126, v126 quad_perm:[2,3,0,1] row_mask:0xf bank_mask:0xf
s_nop 1
v_max_f32_dpp v126, v126, v126 row_half_mirror row_mask:0xf bank_mask:0xf
v_sub_f32 v124, v124, v126
v_exp_f32 v124, v124
s_waitcnt lgkmcnt(0)
v_mul_f32 v127, v125, v124
v_mul_f32 v120, v120, v124
v_mul_f32 v121, v121, v124
v_mul_f32 v122, v122, v124
v_mul_f32 v123, v123, v124
v_add_f32_dpp v127, v127, v127 quad_perm:[1,0,3,2] row_mask:0xf bank_mask:0xf
v_add_f32_dpp v120, v120, v120 quad_perm:[1,0,3,2] row_mask:0xf bank_mask:0xf
v_add_f32_dpp v121, v121, v121 quad_perm:[1,0,3,2] row_mask:0xf bank_mask:0xf
v_add_f32_dpp v122, v122, v122 quad_perm:[1,0,3,2] row_mask:0xf bank_mask:0xf
v_add_f32_dpp v123, v123, v123 quad_perm:[1,0,3,2] row_mask:0xf bank_mask:0xf
v_add_f32_dpp v127, v127, v127 quad_perm:[2,3,0,1] row_mask:0xf bank_mask:0xf
v_add_f32_dpp v120, v120, v120 quad_perm:[2,3,0,1] row_mask:0xf bank_mask:0xf
v_add_f32_dpp v121, v121, v121 quad_perm:[2,3,0,1] row_mask:0xf bank_mask:0xf
v_add_f32_dpp v122, v122, v122 quad_perm:[2,3,0,1] row_mask:0xf bank_mask:0xf
v_add_f32_dpp v123, v123, v123 quad_perm:[2,3,0,1] row_mask:0xf bank_mask:0xf
v_add_f32_dpp v127, v127, v127 row_half_mirror row_mask:0xf bank_mask:0xf
v_add_f32_dpp v120, v120, v120 row_half_mirror row_mask:0xf bank_mask:0xf
v_add_f32_dpp v121, v121, v121 row_half_mirror row_mask:0xf bank_mask:0xf
v_add_f32_dpp v122, v122, v122 row_half_mirror row_mask:0xf bank_mask:0xf
v_add_f32_dpp v123, v123, v123 row_half_mirror row_mask:0xf bank_mask:0xf
v_max_f32 v127, 0x00800000, v127
v_log_f32 v124, v127
v_rcp_f32 v127, v127
s_mov_b64 exec, s[68:69]
v_add_f32 v126, v126, v124
v_mul_f32 v120, v120, v127
v_mul_f32 v121, v121, v127
v_mul_f32 v122, v122, v127
v_mul_f32 v123, v123, v127
v_perm_b32 v124, v126, v132, s62
v_perm_b32 v125, v126, v132, s63
v_cvt_pk_bf16_f32 v120, v120, v121
v_cvt_pk_bf16_f32 v121, v122, v123
v_perm_b32 v128, v120, v124, s60
v_perm_b32 v129, v120, v124, s61
v_perm_b32 v130, v121, v125, s60
v_perm_b32 v131, v121, v125, s61
global_store_dwordx4 v154, v[128:131], s[30:31] sc1
s_endpgm
L_A_back:
s_cmp_lg_u32 s54, 0
s_cbranch_scc1 L_A_bk1
v_dot2_f32_bf16 v116, v52, v12, 0
v_dot2_f32_bf16 v116, v53, v13, v116
v_dot2_f32_bf16 v116, v54, v14, v116
v_dot2_f32_bf16 v116, v55, v15, v116
v_dot2_f32_bf16 v117, v56, v12, 0
v_dot2_f32_bf16 v117, v57, v13, v117
v_dot2_f32_bf16 v117, v58, v14, v117
v_dot2_f32_bf16 v117, v59, v15, v117
v_dot2_f32_bf16 v118, v60, v12, 0
v_dot2_f32_bf16 v118, v61, v13, v118
v_dot2_f32_bf16 v118, v62, v14, v118
v_dot2_f32_bf16 v118, v63, v15, v118
v_dot2_f32_bf16 v119, v64, v12, 0
v_dot2_f32_bf16 v119, v65, v13, v119
v_dot2_f32_bf16 v119, v66, v14, v119
v_dot2_f32_bf16 v119, v67, v15, v119
s_nop 1
v_add_f32_dpp v116, v116, v116 row_ror:8 row_mask:0xf bank_mask:0xf
v_add_f32_dpp v117, v117, v117 row_ror:8 row_mask:0xf bank_mask:0xf
v_add_f32_dpp v118, v118, v118 row_ror:8 row_mask:0xf bank_mask:0xf
v_add_f32_dpp v119, v119, v119 row_ror:8 row_mask:0xf bank_mask:0xf
v_add_f32_dpp v116, v116, v116 row_ror:4 row_mask:0xf bank_mask:0xf
v_add_f32_dpp v117, v117, v117 row_ror:4 row_mask:0xf bank_mask:0xf
v_add_f32_dpp v118, v118, v118 row_ror:4 row_mask:0xf bank_mask:0xf
v_add_f32_dpp v119, v119, v119 row_ror:4 row_mask:0xf bank_mask:0xf
v_add_f32_dpp v116, v116, v116 row_ror:2 row_mask:0xf bank_mask:0xf
v_add_f32_dpp v117, v117, v117 row_ror:2 row_mask:0xf bank_mask:0xf
v_add_f32_dpp v118, v118, v118 row_ror:2 row_mask:0xf bank_mask:0xf
v_add_f32_dpp v119, v119, v119 row_ror:2 row_mask:0xf bank_mask:0xf
v_add_f32_dpp v116, v116, v116 row_ror:1 row_mask:0xf bank_mask:0xf
v_add_f32_dpp v117, v117, v117 row_ror:1 row_mask:0xf bank_mask:0xf
v_add_f32_dpp v118, v118, v118 row_ror:1 row_mask:0xf bank_mask:0xf
v_add_f32_dpp v119, v119, v119 row_ror:1 row_mask:0xf bank_mask:0xf
v_mul_f32 v116, v116, v144
v_mul_f32 v117, v117, v144
v_mul_f32 v118, v118, v144
v_mul_f32 v119, v119, v144
s_mov_b64 exec, s[74:75]
ds_write_b128 v165, v[116:119] offset:0
s_mov_b64 exec, -1
v_max3_f32 v166, v166, v116, v117
v_max3_f32 v166, v166, v118, v119
v_dot2_f32_bf16 v156, v68, v12, 0
v_dot2_f32_bf16 v156, v69, v13, v156
v_dot2_f32_bf16 v156, v70, v14, v156
v_dot2_f32_bf16 v156, v71, v15, v156
v_dot2_f32_bf16 v157, v72, v12, 0
v_dot2_f32_bf16 v157, v73, v13, v157
v_dot2_f32_bf16 v157, v74, v14, v157
v_dot2_f32_bf16 v157, v75, v15, v157
v_dot2_f32_bf16 v158, v76, v12, 0
v_dot2_f32_bf16 v158, v77, v13, v158
v_dot2_f32_bf16 v158, v78, v14, v158
v_dot2_f32_bf16 v158, v79, v15, v158
v_dot2_f32_bf16 v159, v80, v12, 0
v_dot2_f32_bf16 v159, v81, v13, v159
v_dot2_f32_bf16 v159, v82, v14, v159
v_dot2_f32_bf16 v159, v83, v15, v159
s_nop 1
v_add_f32_dpp v156, v156, v156 row_ror:8 row_mask:0xf bank_mask:0xf
v_add_f32_dpp v157, v157, v157 row_ror:8 row_mask:0xf bank_mask:0xf
v_add_f32_dpp v158, v158, v158 row_ror:8 row_mask:0xf bank_mask:0xf
v_add_f32_dpp v159, v159, v159 row_ror:8 row_mask:0xf bank_mask:0xf
v_add_f32_dpp v156, v156, v156 row_ror:4 row_mask:0xf bank_mask:0xf
v_add_f32_dpp v157, v157, v157 row_ror:4 row_mask:0xf bank_mask:0xf
v_add_f32_dpp v158, v158, v158 row_ror:4 row_mask:0xf bank_mask:0xf
v_add_f32_dpp v159, v159, v159 row_ror:4 row_mask:0xf bank_mask:0xf
v_add_f32_dpp v156, v156, v156 row_ror:2 row_mask:0xf bank_mask:0xf
v_add_f32_dpp v157, v157, v157 row_ror:2 row_mask:0xf bank_mask:0xf
v_add_f32_dpp v158, v158, v158 row_ror:2 row_mask:0xf bank_mask:0xf
v_add_f32_dpp v159, v159, v159 row_ror:2 row_mask:0xf bank_mask:0xf
v_add_f32_dpp v156, v156, v156 row_ror:1 row_mask:0xf bank_mask:0xf
v_add_f32_dpp v157, v157, v157 row_ror:1 row_mask:0xf bank_mask:0xf
v_add_f32_dpp v158, v158, v158 row_ror:1 row_mask:0xf bank_mask:0xf
v_add_f32_dpp v159, v159, v159 row_ror:1 row_mask:0xf bank_mask:0xf
v_mul_f32 v156, v156, v144
v_mul_f32 v157, v157, v144
v_mul_f32 v158, v158, v144
v_mul_f32 v159, v159, v144
s_mov_b64 exec, s[74:75]
ds_write_b128 v165, v[156:159] offset:64
s_mov_b64 exec, -1
v_max3_f32 v166, v166, v156, v157
v_max3_f32 v166, v166, v158, v159
s_branch L_A_backd
L_A_bk1:
v_dot2_f32_bf16 v116, v84, v12, 0
v_dot2_f32_bf16 v116, v85, v13, v116
v_dot2_f32_bf16 v116, v86, v14, v116
v_dot2_f32_bf16 v116, v87, v15, v116
v_dot2_f32_bf16 v117, v88, v12, 0
v_dot2_f32_bf16 v117, v89, v13, v117
v_dot2_f32_bf16 v117, v90, v14, v117
v_dot2_f32_bf16 v117, v91, v15, v117
v_dot2_f32_bf16 v118, v92, v12, 0
v_dot2_f32_bf16 v118, v93, v13, v118
v_dot2_f32_bf16 v118, v94, v14, v118
v_dot2_f32_bf16 v118, v95, v15, v118
v_dot2_f32_bf16 v119, v96, v12, 0
v_dot2_f32_bf16 v119, v97, v13, v119
v_dot2_f32_bf16 v119, v98, v14, v119
v_dot2_f32_bf16 v119, v99, v15, v119
s_nop 1
v_add_f32_dpp v116, v116, v116 row_ror:8 row_mask:0xf bank_mask:0xf
v_add_f32_dpp v117, v117, v117 row_ror:8 row_mask:0xf bank_mask:0xf
v_add_f32_dpp v118, v118, v118 row_ror:8 row_mask:0xf bank_mask:0xf
v_add_f32_dpp v119, v119, v119 row_ror:8 row_mask:0xf bank_mask:0xf
v_add_f32_dpp v116, v116, v116 row_ror:4 row_mask:0xf bank_mask:0xf
v_add_f32_dpp v117, v117, v117 row_ror:4 row_mask:0xf bank_mask:0xf
v_add_f32_dpp v118, v118, v118 row_ror:4 row_mask:0xf bank_mask:0xf
v_add_f32_dpp v119, v119, v119 row_ror:4 row_mask:0xf bank_mask:0xf
v_add_f32_dpp v116, v116, v116 row_ror:2 row_mask:0xf bank_mask:0xf
v_add_f32_dpp v117, v117, v117 row_ror:2 row_mask:0xf bank_mask:0xf
v_add_f32_dpp v118, v118, v118 row_ror:2 row_mask:0xf bank_mask:0xf
v_add_f32_dpp v119, v119, v119 row_ror:2 row_mask:0xf bank_mask:0xf
v_add_f32_dpp v116, v116, v116 row_ror:1 row_mask:0xf bank_mask:0xf
v_add_f32_dpp v117, v117, v117 row_ror:1 row_mask:0xf bank_mask:0xf
v_add_f32_dpp v118, v118, v118 row_ror:1 row_mask:0xf bank_mask:0xf
v_add_f32_dpp v119, v119, v119 row_ror:1 row_mask:0xf bank_mask:0xf
v_mul_f32 v116, v116, v144
v_mul_f32 v117, v117, v144
v_mul_f32 v118, v118, v144
v_mul_f32 v119, v119, v144
s_mov_b64 exec, s[74:75]
ds_write_b128 v165, v[116:119] offset:128
s_mov_b64 exec, -1
v_max3_f32 v166, v166, v116, v117
v_max3_f32 v166, v166, v118, v119
v_dot2_f32_bf16 v156, v100, v12, 0
v_dot2_f32_bf16 v156, v101, v13, v156
v_dot2_f32_bf16 v156, v102, v14, v156
v_dot2_f32_bf16 v156, v103, v15, v156
v_dot2_f32_bf16 v157, v104, v12, 0
v_dot2_f32_bf16 v157, v105, v13, v157
v_dot2_f32_bf16 v157, v106, v14, v157
v_dot2_f32_bf16 v157, v107, v15, v157
v_dot2_f32_bf16 v158, v108, v12, 0
v_dot2_f32_bf16 v158, v109, v13, v158
v_dot2_f32_bf16 v158, v110, v14, v158
v_dot2_f32_bf16 v158, v111, v15, v158
v_dot2_f32_bf16 v159, v112, v12, 0
v_dot2_f32_bf16 v159, v113, v13, v159
v_dot2_f32_bf16 v159, v114, v14, v159
v_dot2_f32_bf16 v159, v115, v15, v159
s_nop 1
v_add_f32_dpp v156, v156, v156 row_ror:8 row_mask:0xf bank_mask:0xf
v_add_f32_dpp v157, v157, v157 row_ror:8 row_mask:0xf bank_mask:0xf
v_add_f32_dpp v158, v158, v158 row_ror:8 row_mask:0xf bank_mask:0xf
v_add_f32_dpp v159, v159, v159 row_ror:8 row_mask:0xf bank_mask:0xf
v_add_f32_dpp v156, v156, v156 row_ror:4 row_mask:0xf bank_mask:0xf
v_add_f32_dpp v157, v157, v157 row_ror:4 row_mask:0xf bank_mask:0xf
v_add_f32_dpp v158, v158, v158 row_ror:4 row_mask:0xf bank_mask:0xf
v_add_f32_dpp v159, v159, v159 row_ror:4 row_mask:0xf bank_mask:0xf
v_add_f32_dpp v156, v156, v156 row_ror:2 row_mask:0xf bank_mask:0xf
v_add_f32_dpp v157, v157, v157 row_ror:2 row_mask:0xf bank_mask:0xf
v_add_f32_dpp v158, v158, v158 row_ror:2 row_mask:0xf bank_mask:0xf
v_add_f32_dpp v159, v159, v159 row_ror:2 row_mask:0xf bank_mask:0xf
v_add_f32_dpp v156, v156, v156 row_ror:1 row_mask:0xf bank_mask:0xf
v_add_f32_dpp v157, v157, v157 row_ror:1 row_mask:0xf bank_mask:0xf
v_add_f32_dpp v158, v158, v158 row_ror:1 row_mask:0xf bank_mask:0xf
v_add_f32_dpp v159, v159, v159 row_ror:1 row_mask:0xf bank_mask:0xf
v_mul_f32 v156, v156, v144
v_mul_f32 v157, v157, v144
v_mul_f32 v158, v158, v144
v_mul_f32 v159, v159, v144
s_mov_b64 exec, s[74:75]
ds_write_b128 v165, v[156:159] offset:192
s_mov_b64 exec, -1
v_max3_f32 v166, v166, v156, v157
v_max3_f32 v166, v166, v158, v159
s_branch L_A_backd
L_A_swa:
s_mov_b32 s56, 1
v_max_f32 v166, v166, v167
v_mov_b32 v167, 0xff7fffff
v_mov_b32 v160, v16
v_mov_b32 v161, v17
v_mov_b32 v162, v18
v_mov_b32 v163, v19
s_branch L_A_swda
L_A_swa2:
s_mov_b32 s56, 1
v_max_f32 v166, v166, v167
v_mov_b32 v167, 0xff7fffff
v_mov_b32 v160, v16
v_mov_b32 v161, v17
v_mov_b32 v162, v18
v_mov_b32 v163, v19
s_branch L_A_swda2
L_A_swc:
s_mov_b32 s56, 1
s_nop 3
v_add_f32_dpp v141, v141, v141 row_bcast:15 row_mask:0xa bank_mask:0xf
s_nop 1
v_add_f32_dpp v141, v141, v141 row_bcast:31 row_mask:0xc bank_mask:0xf
s_mov_b32 exec_lo, 0
s_brev_b32 exec_hi, 1
ds_write_b64 v149, v[140:141] offset:8448
s_mov_b32 exec_lo, -1
s_mov_b32 exec_hi, 0
ds_write_b128 v148, v[136:139] offset:0
s_mov_b64 exec, -1
s_waitcnt lgkmcnt(0)
v_mov_b32 v140, v167
v_mov_b32 v141, 0
v_mov_b32 v136, 0
v_mov_b32 v137, 0
v_mov_b32 v138, 0
v_mov_b32 v139, 0
s_branch L_A_swdc
L_A_swc2:
s_mov_b32 s56, 1
s_nop 3
v_add_f32_dpp v141, v141, v141 row_bcast:15 row_mask:0xa bank_mask:0xf
s_nop 1
v_add_f32_dpp v141, v141, v141 row_bcast:31 row_mask:0xc bank_mask:0xf
s_mov_b32 exec_lo, 0
s_brev_b32 exec_hi, 1
ds_write_b64 v149, v[140:141] offset:8448
s_mov_b32 exec_lo, -1
s_mov_b32 exec_hi, 0
ds_write_b128 v148, v[136:139] offset:0
s_mov_b64 exec, -1
s_waitcnt lgkmcnt(0)
v_mov_b32 v140, v167
v_mov_b32 v141, 0
v_mov_b32 v136, 0
v_mov_b32 v137, 0
v_mov_b32 v138, 0
v_mov_b32 v139, 0
s_branch L_A_swdc2
L_A_sigc:
s_mov_b32 s65, 1
s_atomic_add s65, s[52:53], 0x400 glc
s_branch L_A_sigdc
L_A_maxb:
v_max_f32_dpp v145, v145, v145 row_bcast:15 row_mask:0xa bank_mask:0xf
s_nop 1
v_max_f32_dpp v145, v145, v145 row_bcast:31 row_mask:0xc bank_mask:0xf
s_nop 0
v_readlane_b32 s62, v145, 63
s_nop 1
v_max_f32 v143, s62, v140
v_sub_f32 v142, v140, v143
v_exp_f32 v142, v142
v_mov_b32 v140, v143
v_mul_f32 v136, v136, v142
v_mul_f32 v137, v137, v142
v_mul_f32 v138, v138, v142
v_mul_f32 v139, v139, v142
v_mul_f32 v141, v141, v142
s_branch L_A_maxdb
L_A_sigb:
s_mov_b32 s65, 1
s_atomic_add s65, s[52:53], 0x400 glc
s_branch L_A_sigdb
L_roleW:
s_waitcnt lgkmcnt(0)
s_lshl_b32 s60, s32, 8
s_sub_u32 s61, 0x400000, s60
s_add_u32 s40, s18, s60
s_addc_u32 s41, s19, 0
s_and_b32 s41, s41, 0xffff
s_mov_b32 s42, s61
s_mov_b32 s43, 0x20000
s_add_u32 s44, s20, s60
s_addc_u32 s45, s21, 0
s_and_b32 s45, s45, 0xffff
s_mov_b32 s46, s61
s_mov_b32 s47, 0x20000
s_mov_b32 s48, s14
s_and_b32 s49, s15, 0xffff
s_mov_b32 s50, 0x800
s_mov_b32 s51, 0x20000
v_lshrrev_b32 v192, 3, v2
v_lshlrev_b32 v192, 10, v192
v_lshl_add_u32 v192, v3, 5, v192
s_lshl_b32 s62, s34, 7
v_add_u32 v192, s62, v192
s_mov_b32 s80, 0
buffer_load_dwordx4 v[12:15], v192, s[48:51], 0 offen
buffer_load_dwordx4 v[16:19], v192, s[48:51], 0 offen offset:16
v_lshlrev_b32 v9, 17, v3
v_lshl_add_u32 v9, v2, 4, v9
s_lshl_b32 s62, s34, 19
v_add_u32 v9, s62, v9
s_xor_b32 s62, s80, 0
buffer_load_dwordx4 v[64:67], v9, s[40:43], s62 offen nt
s_xor_b32 s62, s80, 8192
buffer_load_dwordx4 v[68:71], v9, s[40:43], s62 offen nt
s_xor_b32 s62, s80, 16384
buffer_load_dwordx4 v[72:75], v9, s[40:43], s62 offen nt
s_xor_b32 s62, s80, 24576
buffer_load_dwordx4 v[76:79], v9, s[40:43], s62 offen nt
s_xor_b32 s62, s80, 32768
buffer_load_dwordx4 v[80:83], v9, s[40:43], s62 offen nt
s_xor_b32 s62, s80, 40960
buffer_load_dwordx4 v[84:87], v9, s[40:43], s62 offen nt
s_xor_b32 s62, s80, 49152
buffer_load_dwordx4 v[88:91], v9, s[40:43], s62 offen nt
s_xor_b32 s62, s80, 57344
buffer_load_dwordx4 v[92:95], v9, s[40:43], s62 offen nt
s_xor_b32 s62, s80, 65536
buffer_load_dwordx4 v[96:99], v9, s[40:43], s62 offen nt
s_xor_b32 s62, s80, 73728
buffer_load_dwordx4 v[100:103], v9, s[40:43], s62 offen nt
s_xor_b32 s62, s80, 81920
buffer_load_dwordx4 v[104:107], v9, s[40:43], s62 offen nt
s_xor_b32 s62, s80, 90112
buffer_load_dwordx4 v[108:111], v9, s[40:43], s62 offen nt
s_xor_b32 s62, s80, 98304
buffer_load_dwordx4 v[112:115], v9, s[40:43], s62 offen nt
s_xor_b32 s62, s80, 106496
buffer_load_dwordx4 v[116:119], v9, s[40:43], s62 offen nt
s_xor_b32 s62, s80, 114688
buffer_load_dwordx4 v[120:123], v9, s[40:43], s62 offen nt
s_xor_b32 s62, s80, 122880
buffer_load_dwordx4 v[124:127], v9, s[40:43], s62 offen nt
v_mov_b32 v8, 0
s_mov_b32 s52, s30
s_and_b32 s53, s31, 0xffff
s_mov_b32 s54, 0x1000000
s_mov_b32 s55, 0x20000
s_load_dword s58, s[30:31], 0x14000
v_and_b32 v192, 1, v0
v_lshlrev_b32 v192, 4, v192
v_mov_b32 v193, 0xffff
v_lshlrev_b32 v192, v192, v193
v_bfe_u32 v193, v0, 1, 2
v_cmp_eq_u32 vcc, 0, v193
s_nop 1
v_cndmask_b32 v4, 0, v192, vcc
v_cmp_eq_u32 vcc, 1, v193
s_nop 1
v_cndmask_b32 v5, 0, v192, vcc
v_cmp_eq_u32 vcc, 2, v193
s_nop 1
v_cndmask_b32 v6, 0, v192, vcc
v_cmp_eq_u32 vcc, 3, v193
s_nop 1
v_cndmask_b32 v7, 0, v192, vcc
s_barrier
s_waitcnt vmcnt(16)
s_mov_b32 s60, 0x01000100
v_perm_b32 v192, v12, v12, s60
v_and_b32 v28, v192, v4
v_and_b32 v29, v192, v5
v_and_b32 v30, v192, v6
v_and_b32 v31, v192, v7
s_waitcnt vmcnt(15)
s_nop 0
v_mfma_f32_16x16x32_bf16 v[44:47], v[28:31], v[64:67], 0
s_xor_b32 s62, s80, 0
buffer_load_dwordx4 v[128:131], v9, s[44:47], s62 offen nt
s_mov_b32 s60, 0x03020302
v_perm_b32 v193, v12, v12, s60
v_and_b32 v32, v193, v4
v_and_b32 v33, v193, v5
v_and_b32 v34, v193, v6
v_and_b32 v35, v193, v7
s_waitcnt vmcnt(15)
s_nop 0
v_mfma_f32_16x16x32_bf16 v[44:47], v[32:35], v[68:71], v[44:47]
s_xor_b32 s62, s80, 8192
buffer_load_dwordx4 v[132:135], v9, s[44:47], s62 offen nt
s_mov_b32 s60, 0x01000100
v_perm_b32 v192, v13, v13, s60
v_and_b32 v28, v192, v4
v_and_b32 v29, v192, v5
v_and_b32 v30, v192, v6
v_and_b32 v31, v192, v7
s_waitcnt vmcnt(15)
s_nop 0
v_mfma_f32_16x16x32_bf16 v[44:47], v[28:31], v[72:75], v[44:47]
s_xor_b32 s62, s80, 16384
buffer_load_dwordx4 v[136:139], v9, s[44:47], s62 offen nt
s_mov_b32 s60, 0x03020302
v_perm_b32 v193, v13, v13, s60
v_and_b32 v32, v193, v4
v_and_b32 v33, v193, v5
v_and_b32 v34, v193, v6
v_and_b32 v35, v193, v7
s_waitcnt vmcnt(15)
s_nop 0
v_mfma_f32_16x16x32_bf16 v[44:47], v[32:35], v[76:79], v[44:47]
s_xor_b32 s62, s80, 24576
buffer_load_dwordx4 v[140:143], v9, s[44:47], s62 offen nt
s_mov_b32 s60, 0x01000100
v_perm_b32 v192, v14, v14, s60
v_and_b32 v28, v192, v4
v_and_b32 v29, v192, v5
v_and_b32 v30, v192, v6
v_and_b32 v31, v192, v7
s_waitcnt vmcnt(15)
s_nop 0
v_mfma_f32_16x16x32_bf16 v[44:47], v[28:31], v[80:83], v[44:47]
s_xor_b32 s62, s80, 32768
buffer_load_dwordx4 v[144:147], v9, s[44:47], s62 offen nt
s_mov_b32 s60, 0x03020302
v_perm_b32 v193, v14, v14, s60
v_and_b32 v32, v193, v4
v_and_b32 v33, v193, v5
v_and_b32 v34, v193, v6
v_and_b32 v35, v193, v7
s_waitcnt vmcnt(15)
s_nop 0
v_mfma_f32_16x16x32_bf16 v[44:47], v[32:35], v[84:87], v[44:47]
s_xor_b32 s62, s80, 40960
buffer_load_dwordx4 v[148:151], v9, s[44:47], s62 offen nt
s_mov_b32 s60, 0x01000100
v_perm_b32 v192, v15, v15, s60
v_and_b32 v28, v192, v4
v_and_b32 v29, v192, v5
v_and_b32 v30, v192, v6
v_and_b32 v31, v192, v7
s_waitcnt vmcnt(15)
s_nop 0
v_mfma_f32_16x16x32_bf16 v[44:47], v[28:31], v[88:91], v[44:47]
s_xor_b32 s62, s80, 49152
buffer_load_dwordx4 v[152:155], v9, s[44:47], s62 offen nt
s_mov_b32 s60, 0x03020302
v_perm_b32 v193, v15, v15, s60
v_and_b32 v32, v193, v4
v_and_b32 v33, v193, v5
v_and_b32 v34, v193, v6
v_and_b32 v35, v193, v7
s_waitcnt vmcnt(15)
s_nop 0
v_mfma_f32_16x16x32_bf16 v[44:47], v[32:35], v[92:95], v[44:47]
s_xor_b32 s62, s80, 57344
buffer_load_dwordx4 v[156:159], v9, s[44:47], s62 offen nt
s_mov_b32 s60, 0x01000100
v_perm_b32 v192, v16, v16, s60
v_and_b32 v28, v192, v4
v_and_b32 v29, v192, v5
v_and_b32 v30, v192, v6
v_and_b32 v31, v192, v7
s_waitcnt vmcnt(15)
s_nop 0
v_mfma_f32_16x16x32_bf16 v[44:47], v[28:31], v[96:99], v[44:47]
s_xor_b32 s62, s80, 65536
buffer_load_dwordx4 v[160:163], v9, s[44:47], s62 offen nt
s_mov_b32 s60, 0x03020302
v_perm_b32 v193, v16, v16, s60
v_and_b32 v32, v193, v4
v_and_b32 v33, v193, v5
v_and_b32 v34, v193, v6
v_and_b32 v35, v193, v7
s_waitcnt vmcnt(15)
s_nop 0
v_mfma_f32_16x16x32_bf16 v[44:47], v[32:35], v[100:103], v[44:47]
s_xor_b32 s62, s80, 73728
buffer_load_dwordx4 v[164:167], v9, s[44:47], s62 offen nt
s_mov_b32 s60, 0x01000100
v_perm_b32 v192, v17, v17, s60
v_and_b32 v28, v192, v4
v_and_b32 v29, v192, v5
v_and_b32 v30, v192, v6
v_and_b32 v31, v192, v7
s_waitcnt vmcnt(15)
s_nop 0
v_mfma_f32_16x16x32_bf16 v[44:47], v[28:31], v[104:107], v[44:47]
s_xor_b32 s62, s80, 81920
buffer_load_dwordx4 v[168:171], v9, s[44:47], s62 offen nt
s_mov_b32 s60, 0x03020302
v_perm_b32 v193, v17, v17, s60
v_and_b32 v32, v193, v4
v_and_b32 v33, v193, v5
v_and_b32 v34, v193, v6
v_and_b32 v35, v193, v7
s_waitcnt vmcnt(15)
s_nop 0
v_mfma_f32_16x16x32_bf16 v[44:47], v[32:35], v[108:111], v[44:47]
s_xor_b32 s62, s80, 90112
buffer_load_dwordx4 v[172:175], v9, s[44:47], s62 offen nt
s_mov_b32 s60, 0x01000100
v_perm_b32 v192, v18, v18, s60
v_and_b32 v28, v192, v4
v_and_b32 v29, v192, v5
v_and_b32 v30, v192, v6
v_and_b32 v31, v192, v7
s_waitcnt vmcnt(15)
s_nop 0
v_mfma_f32_16x16x32_bf16 v[44:47], v[28:31], v[112:115], v[44:47]
s_xor_b32 s62, s80, 98304
buffer_load_dwordx4 v[176:179], v9, s[44:47], s62 offen nt
s_mov_b32 s60, 0x03020302
v_perm_b32 v193, v18, v18, s60
v_and_b32 v32, v193, v4
v_and_b32 v33, v193, v5
v_and_b32 v34, v193, v6
v_and_b32 v35, v193, v7
s_waitcnt vmcnt(15)
s_nop 0
v_mfma_f32_16x16x32_bf16 v[44:47], v[32:35], v[116:119], v[44:47]
s_xor_b32 s62, s80, 106496
buffer_load_dwordx4 v[180:183], v9, s[44:47], s62 offen nt
s_mov_b32 s60, 0x01000100
v_perm_b32 v192, v19, v19, s60
v_and_b32 v28, v192, v4
v_and_b32 v29, v192, v5
v_and_b32 v30, v192, v6
v_and_b32 v31, v192, v7
s_waitcnt vmcnt(15)
s_nop 0
v_mfma_f32_16x16x32_bf16 v[44:47], v[28:31], v[120:123], v[44:47]
s_xor_b32 s62, s80, 114688
buffer_load_dwordx4 v[184:187], v9, s[44:47], s62 offen nt
s_mov_b32 s60, 0x03020302
v_perm_b32 v193, v19, v19, s60
v_and_b32 v32, v193, v4
v_and_b32 v33, v193, v5
v_and_b32 v34, v193, v6
v_and_b32 v35, v193, v7
s_waitcnt vmcnt(15)
s_nop 0
v_mfma_f32_16x16x32_bf16 v[44:47], v[32:35], v[124:127], v[44:47]
s_xor_b32 s62, s80, 122880
buffer_load_dwordx4 v[188:191], v9, s[44:47], s62 offen nt
v_lshrrev_b32 v192, 1, v3
v_lshlrev_b32 v192, 9, v192
v_lshl_add_u32 v192, v2, 5, v192
v_and_b32 v193, 1, v3
v_lshl_add_u32 v192, v193, 4, v192
s_lshl_b32 s63, s34, 10
v_add_u32 v192, s63, v192
s_nop 1
s_nop 5
ds_write_b128 v192, v[44:47] offset:0
s_waitcnt lgkmcnt(0)
s_barrier
s_cmp_ge_u32 s34, 4
s_cbranch_scc1 L_W_qskip
v_lshlrev_b32 v194, 2, v0
ds_read_b32 v196, v194 offset:0
ds_read_b32 v197, v194 offset:1024
ds_read_b32 v198, v194 offset:2048
ds_read_b32 v199, v194 offset:3072
ds_read_b32 v200, v194 offset:4096
ds_read_b32 v201, v194 offset:5120
ds_read_b32 v202, v194 offset:6144
ds_read_b32 v203, v194 offset:7168
s_waitcnt lgkmcnt(0)
v_add_f32 v196, v196, v197
v_add_f32 v196, v196, v198
v_add_f32 v196, v196, v199
v_add_f32 v196, v196, v200
v_add_f32 v196, v196, v201
v_add_f32 v196, v196, v202
v_add_f32 v196, v196, v203
v_cvt_pk_bf16_f32 v196, v196, v196
v_lshlrev_b32 v194, 1, v0
ds_write_b16 v194, v196 offset:8192
s_waitcnt lgkmcnt(0)
L_W_qskip:
s_barrier
v_lshlrev_b32 v194, 4, v2
ds_read_b128 v[20:23], v194 offset:8192
ds_read_b128 v[24:27], v194 offset:8448
s_xor_b32 s60, s32, 7
s_lshl_b32 s60, s60, 8
s_sub_u32 s61, 0x400000, s60
s_add_u32 s40, s22, s60
s_addc_u32 s41, s23, 0
s_and_b32 s41, s41, 0xffff
s_mov_b32 s42, s61
s_mov_b32 s43, 0x20000
s_xor_b32 s62, s80, 0
buffer_load_dwordx4 v[64:67], v9, s[40:43], s62 offen nt
s_xor_b32 s62, s80, 8192
buffer_load_dwordx4 v[68:71], v9, s[40:43], s62 offen nt
s_xor_b32 s62, s80, 16384
buffer_load_dwordx4 v[72:75], v9, s[40:43], s62 offen nt
s_xor_b32 s62, s80, 24576
buffer_load_dwordx4 v[76:79], v9, s[40:43], s62 offen nt
s_xor_b32 s62, s80, 32768
buffer_load_dwordx4 v[80:83], v9, s[40:43], s62 offen nt
s_xor_b32 s62, s80, 40960
buffer_load_dwordx4 v[84:87], v9, s[40:43], s62 offen nt
s_xor_b32 s62, s80, 49152
buffer_load_dwordx4 v[88:91], v9, s[40:43], s62 offen nt
s_xor_b32 s62, s80, 57344
buffer_load_dwordx4 v[92:95], v9, s[40:43], s62 offen nt
s_xor_b32 s62, s80, 65536
buffer_load_dwordx4 v[96:99], v9, s[40:43], s62 offen nt
s_xor_b32 s62, s80, 73728
buffer_load_dwordx4 v[100:103], v9, s[40:43], s62 offen nt
s_xor_b32 s62, s80, 81920
buffer_load_dwordx4 v[104:107], v9, s[40:43], s62 offen nt
s_xor_b32 s62, s80, 90112
buffer_load_dwordx4 v[108:111], v9, s[40:43], s62 offen nt
s_xor_b32 s62, s80, 98304
buffer_load_dwordx4 v[112:115], v9, s[40:43], s62 offen nt
s_xor_b32 s62, s80, 106496
buffer_load_dwordx4 v[116:119], v9, s[40:43], s62 offen nt
s_xor_b32 s62, s80, 114688
buffer_load_dwordx4 v[120:123], v9, s[40:43], s62 offen nt
s_xor_b32 s62, s80, 122880
buffer_load_dwordx4 v[124:127], v9, s[40:43], s62 offen nt
s_xor_b32 s60, s32, 7
s_lshl_b32 s60, s60, 17
s_mov_b32 s61, 0x20000
s_add_u32 s44, s24, s60
s_addc_u32 s45, s25, 0
s_and_b32 s45, s45, 0xffff
s_mov_b32 s46, s61
s_mov_b32 s47, 0x20000
v_lshlrev_b32 v10, 12, v3
v_lshl_add_u32 v10, v2, 4, v10
s_lshl_b32 s62, s34, 14
v_add_u32 v10, s62, v10
v_mov_b32 v200, 0
v_mov_b32 v201, 0
s_lshr_b32 s62, s80, 13
v_xor_b32 v202, s62, v2
s_waitcnt lgkmcnt(0)
s_add_u32 s58, s58, 0x9e3779b9
s_bfe_u32 s76, s58, 0x80000
s_bfe_u32 s77, s58, 0x80008
s_bfe_u32 s78, s58, 0x80010
s_bfe_u32 s79, s58, 0x80018
s_waitcnt vmcnt(30)
v_dot2_f32_bf16 v60, v128, v20, 0
v_dot2_f32_bf16 v61, v128, v24, 0
v_dot2_f32_bf16 v62, v132, v20, 0
v_dot2_f32_bf16 v63, v132, v24, 0
v_dot2_f32_bf16 v60, v129, v21, v60
v_dot2_f32_bf16 v61, v129, v25, v61
v_dot2_f32_bf16 v62, v133, v21, v62
v_dot2_f32_bf16 v63, v133, v25, v63
v_dot2_f32_bf16 v60, v130, v22, v60
v_dot2_f32_bf16 v61, v130, v26, v61
v_dot2_f32_bf16 v62, v134, v22, v62
v_dot2_f32_bf16 v63, v134, v26, v63
v_dot2_f32_bf16 v60, v131, v23, v60
v_dot2_f32_bf16 v61, v131, v27, v61
v_dot2_f32_bf16 v62, v135, v23, v62
v_dot2_f32_bf16 v63, v135, v27, v63
buffer_load_dwordx4 v[128:131], v10, s[44:47], 0 offen offset:0 nt
buffer_load_dwordx4 v[132:135], v10, s[44:47], 0 offen offset:256 nt
v_add_f32_dpp v60, v60, v60 row_ror:8 row_mask:0xf bank_mask:0xf
v_add_f32_dpp v61, v61, v61 row_ror:8 row_mask:0xf bank_mask:0xf
v_add_f32_dpp v62, v62, v62 row_ror:8 row_mask:0xf bank_mask:0xf
v_add_f32_dpp v63, v63, v63 row_ror:8 row_mask:0xf bank_mask:0xf
v_add_f32_dpp v60, v60, v60 row_ror:4 row_mask:0xf bank_mask:0xf
v_add_f32_dpp v61, v61, v61 row_ror:4 row_mask:0xf bank_mask:0xf
v_add_f32_dpp v62, v62, v62 row_ror:4 row_mask:0xf bank_mask:0xf
v_add_f32_dpp v63, v63, v63 row_ror:4 row_mask:0xf bank_mask:0xf
v_add_f32_dpp v60, v60, v60 row_ror:2 row_mask:0xf bank_mask:0xf
v_add_f32_dpp v61, v61, v61 row_ror:2 row_mask:0xf bank_mask:0xf
v_add_f32_dpp v62, v62, v62 row_ror:2 row_mask:0xf bank_mask:0xf
v_add_f32_dpp v63, v63, v63 row_ror:2 row_mask:0xf bank_mask:0xf
v_add_f32_dpp v60, v60, v60 row_ror:1 row_mask:0xf bank_mask:0xf
v_add_f32_dpp v61, v61, v61 row_ror:1 row_mask:0xf bank_mask:0xf
v_add_f32_dpp v62, v62, v62 row_ror:1 row_mask:0xf bank_mask:0xf
v_add_f32_dpp v63, v63, v63 row_ror:1 row_mask:0xf bank_mask:0xf
v_cmp_eq_u32 vcc, 0, v202
s_nop 1
v_cndmask_b32 v200, v200, v60, vcc
v_cndmask_b32 v201, v201, v61, vcc
v_cmp_eq_u32 vcc, 1, v202
s_nop 1
v_cndmask_b32 v200, v200, v62, vcc
v_cndmask_b32 v201, v201, v63, vcc
s_waitcnt vmcnt(30)
v_dot2_f32_bf16 v60, v136, v20, 0
v_dot2_f32_bf16 v61, v136, v24, 0
v_dot2_f32_bf16 v62, v140, v20, 0
v_dot2_f32_bf16 v63, v140, v24, 0
v_dot2_f32_bf16 v60, v137, v21, v60
v_dot2_f32_bf16 v61, v137, v25, v61
v_dot2_f32_bf16 v62, v141, v21, v62
v_dot2_f32_bf16 v63, v141, v25, v63
v_dot2_f32_bf16 v60, v138, v22, v60
v_dot2_f32_bf16 v61, v138, v26, v61
v_dot2_f32_bf16 v62, v142, v22, v62
v_dot2_f32_bf16 v63, v142, v26, v63
v_dot2_f32_bf16 v60, v139, v23, v60
v_dot2_f32_bf16 v61, v139, v27, v61
v_dot2_f32_bf16 v62, v143, v23, v62
v_dot2_f32_bf16 v63, v143, v27, v63
buffer_load_dwordx4 v[136:139], v10, s[44:47], 0 offen offset:512 nt
buffer_load_dwordx4 v[140:143], v10, s[44:47], 0 offen offset:768 nt
v_add_f32_dpp v60, v60, v60 row_ror:8 row_mask:0xf bank_mask:0xf
v_add_f32_dpp v61, v61, v61 row_ror:8 row_mask:0xf bank_mask:0xf
v_add_f32_dpp v62, v62, v62 row_ror:8 row_mask:0xf bank_mask:0xf
v_add_f32_dpp v63, v63, v63 row_ror:8 row_mask:0xf bank_mask:0xf
v_add_f32_dpp v60, v60, v60 row_ror:4 row_mask:0xf bank_mask:0xf
v_add_f32_dpp v61, v61, v61 row_ror:4 row_mask:0xf bank_mask:0xf
v_add_f32_dpp v62, v62, v62 row_ror:4 row_mask:0xf bank_mask:0xf
v_add_f32_dpp v63, v63, v63 row_ror:4 row_mask:0xf bank_mask:0xf
v_add_f32_dpp v60, v60, v60 row_ror:2 row_mask:0xf bank_mask:0xf
v_add_f32_dpp v61, v61, v61 row_ror:2 row_mask:0xf bank_mask:0xf
v_add_f32_dpp v62, v62, v62 row_ror:2 row_mask:0xf bank_mask:0xf
v_add_f32_dpp v63, v63, v63 row_ror:2 row_mask:0xf bank_mask:0xf
v_add_f32_dpp v60, v60, v60 row_ror:1 row_mask:0xf bank_mask:0xf
v_add_f32_dpp v61, v61, v61 row_ror:1 row_mask:0xf bank_mask:0xf
v_add_f32_dpp v62, v62, v62 row_ror:1 row_mask:0xf bank_mask:0xf
v_add_f32_dpp v63, v63, v63 row_ror:1 row_mask:0xf bank_mask:0xf
v_cmp_eq_u32 vcc, 2, v202
s_nop 1
v_cndmask_b32 v200, v200, v60, vcc
v_cndmask_b32 v201, v201, v61, vcc
v_cmp_eq_u32 vcc, 3, v202
s_nop 1
v_cndmask_b32 v200, v200, v62, vcc
v_cndmask_b32 v201, v201, v63, vcc
s_waitcnt vmcnt(30)
v_dot2_f32_bf16 v60, v144, v20, 0
v_dot2_f32_bf16 v61, v144, v24, 0
v_dot2_f32_bf16 v62, v148, v20, 0
v_dot2_f32_bf16 v63, v148, v24, 0
v_dot2_f32_bf16 v60, v145, v21, v60
v_dot2_f32_bf16 v61, v145, v25, v61
v_dot2_f32_bf16 v62, v149, v21, v62
v_dot2_f32_bf16 v63, v149, v25, v63
v_dot2_f32_bf16 v60, v146, v22, v60
v_dot2_f32_bf16 v61, v146, v26, v61
v_dot2_f32_bf16 v62, v150, v22, v62
v_dot2_f32_bf16 v63, v150, v26, v63
v_dot2_f32_bf16 v60, v147, v23, v60
v_dot2_f32_bf16 v61, v147, v27, v61
v_dot2_f32_bf16 v62, v151, v23, v62
v_dot2_f32_bf16 v63, v151, v27, v63
buffer_load_dwordx4 v[144:147], v10, s[44:47], 0 offen offset:1024 nt
buffer_load_dwordx4 v[148:151], v10, s[44:47], 0 offen offset:1280 nt
v_add_f32_dpp v60, v60, v60 row_ror:8 row_mask:0xf bank_mask:0xf
v_add_f32_dpp v61, v61, v61 row_ror:8 row_mask:0xf bank_mask:0xf
v_add_f32_dpp v62, v62, v62 row_ror:8 row_mask:0xf bank_mask:0xf
v_add_f32_dpp v63, v63, v63 row_ror:8 row_mask:0xf bank_mask:0xf
v_add_f32_dpp v60, v60, v60 row_ror:4 row_mask:0xf bank_mask:0xf
v_add_f32_dpp v61, v61, v61 row_ror:4 row_mask:0xf bank_mask:0xf
v_add_f32_dpp v62, v62, v62 row_ror:4 row_mask:0xf bank_mask:0xf
v_add_f32_dpp v63, v63, v63 row_ror:4 row_mask:0xf bank_mask:0xf
v_add_f32_dpp v60, v60, v60 row_ror:2 row_mask:0xf bank_mask:0xf
v_add_f32_dpp v61, v61, v61 row_ror:2 row_mask:0xf bank_mask:0xf
v_add_f32_dpp v62, v62, v62 row_ror:2 row_mask:0xf bank_mask:0xf
v_add_f32_dpp v63, v63, v63 row_ror:2 row_mask:0xf bank_mask:0xf
v_add_f32_dpp v60, v60, v60 row_ror:1 row_mask:0xf bank_mask:0xf
v_add_f32_dpp v61, v61, v61 row_ror:1 row_mask:0xf bank_mask:0xf
v_add_f32_dpp v62, v62, v62 row_ror:1 row_mask:0xf bank_mask:0xf
v_add_f32_dpp v63, v63, v63 row_ror:1 row_mask:0xf bank_mask:0xf
v_cmp_eq_u32 vcc, 4, v202
s_nop 1
v_cndmask_b32 v200, v200, v60, vcc
v_cndmask_b32 v201, v201, v61, vcc
v_cmp_eq_u32 vcc, 5, v202
s_nop 1
v_cndmask_b32 v200, v200, v62, vcc
v_cndmask_b32 v201, v201, v63, vcc
s_waitcnt vmcnt(30)
v_dot2_f32_bf16 v60, v152, v20, 0
v_dot2_f32_bf16 v61, v152, v24, 0
v_dot2_f32_bf16 v62, v156, v20, 0
v_dot2_f32_bf16 v63, v156, v24, 0
v_dot2_f32_bf16 v60, v153, v21, v60
v_dot2_f32_bf16 v61, v153, v25, v61
v_dot2_f32_bf16 v62, v157, v21, v62
v_dot2_f32_bf16 v63, v157, v25, v63
v_dot2_f32_bf16 v60, v154, v22, v60
v_dot2_f32_bf16 v61, v154, v26, v61
v_dot2_f32_bf16 v62, v158, v22, v62
v_dot2_f32_bf16 v63, v158, v26, v63
v_dot2_f32_bf16 v60, v155, v23, v60
v_dot2_f32_bf16 v61, v155, v27, v61
v_dot2_f32_bf16 v62, v159, v23, v62
v_dot2_f32_bf16 v63, v159, v27, v63
buffer_load_dwordx4 v[152:155], v10, s[44:47], 0 offen offset:1536 nt
buffer_load_dwordx4 v[156:159], v10, s[44:47], 0 offen offset:1792 nt
v_add_f32_dpp v60, v60, v60 row_ror:8 row_mask:0xf bank_mask:0xf
v_add_f32_dpp v61, v61, v61 row_ror:8 row_mask:0xf bank_mask:0xf
v_add_f32_dpp v62, v62, v62 row_ror:8 row_mask:0xf bank_mask:0xf
v_add_f32_dpp v63, v63, v63 row_ror:8 row_mask:0xf bank_mask:0xf
v_add_f32_dpp v60, v60, v60 row_ror:4 row_mask:0xf bank_mask:0xf
v_add_f32_dpp v61, v61, v61 row_ror:4 row_mask:0xf bank_mask:0xf
v_add_f32_dpp v62, v62, v62 row_ror:4 row_mask:0xf bank_mask:0xf
v_add_f32_dpp v63, v63, v63 row_ror:4 row_mask:0xf bank_mask:0xf
v_add_f32_dpp v60, v60, v60 row_ror:2 row_mask:0xf bank_mask:0xf
v_add_f32_dpp v61, v61, v61 row_ror:2 row_mask:0xf bank_mask:0xf
v_add_f32_dpp v62, v62, v62 row_ror:2 row_mask:0xf bank_mask:0xf
v_add_f32_dpp v63, v63, v63 row_ror:2 row_mask:0xf bank_mask:0xf
v_add_f32_dpp v60, v60, v60 row_ror:1 row_mask:0xf bank_mask:0xf
v_add_f32_dpp v61, v61, v61 row_ror:1 row_mask:0xf bank_mask:0xf
v_add_f32_dpp v62, v62, v62 row_ror:1 row_mask:0xf bank_mask:0xf
v_add_f32_dpp v63, v63, v63 row_ror:1 row_mask:0xf bank_mask:0xf
v_cmp_eq_u32 vcc, 6, v202
s_nop 1
v_cndmask_b32 v200, v200, v60, vcc
v_cndmask_b32 v201, v201, v61, vcc
v_cmp_eq_u32 vcc, 7, v202
s_nop 1
v_cndmask_b32 v200, v200, v62, vcc
v_cndmask_b32 v201, v201, v63, vcc
s_waitcnt vmcnt(30)
v_dot2_f32_bf16 v60, v160, v20, 0
v_dot2_f32_bf16 v61, v160, v24, 0
v_dot2_f32_bf16 v62, v164, v20, 0
v_dot2_f32_bf16 v63, v164, v24, 0
v_dot2_f32_bf16 v60, v161, v21, v60
v_dot2_f32_bf16 v61, v161, v25, v61
v_dot2_f32_bf16 v62, v165, v21, v62
v_dot2_f32_bf16 v63, v165, v25, v63
v_dot2_f32_bf16 v60, v162, v22, v60
v_dot2_f32_bf16 v61, v162, v26, v61
v_dot2_f32_bf16 v62, v166, v22, v62
v_dot2_f32_bf16 v63, v166, v26, v63
v_dot2_f32_bf16 v60, v163, v23, v60
v_dot2_f32_bf16 v61, v163, v27, v61
v_dot2_f32_bf16 v62, v167, v23, v62
v_dot2_f32_bf16 v63, v167, v27, v63
buffer_load_dwordx4 v[160:163], v10, s[44:47], 0 offen offset:2048 nt
buffer_load_dwordx4 v[164:167], v10, s[44:47], 0 offen offset:2304 nt
v_add_f32_dpp v60, v60, v60 row_ror:8 row_mask:0xf bank_mask:0xf
v_add_f32_dpp v61, v61, v61 row_ror:8 row_mask:0xf bank_mask:0xf
v_add_f32_dpp v62, v62, v62 row_ror:8 row_mask:0xf bank_mask:0xf
v_add_f32_dpp v63, v63, v63 row_ror:8 row_mask:0xf bank_mask:0xf
v_add_f32_dpp v60, v60, v60 row_ror:4 row_mask:0xf bank_mask:0xf
v_add_f32_dpp v61, v61, v61 row_ror:4 row_mask:0xf bank_mask:0xf
v_add_f32_dpp v62, v62, v62 row_ror:4 row_mask:0xf bank_mask:0xf
v_add_f32_dpp v63, v63, v63 row_ror:4 row_mask:0xf bank_mask:0xf
v_add_f32_dpp v60, v60, v60 row_ror:2 row_mask:0xf bank_mask:0xf
v_add_f32_dpp v61, v61, v61 row_ror:2 row_mask:0xf bank_mask:0xf
v_add_f32_dpp v62, v62, v62 row_ror:2 row_mask:0xf bank_mask:0xf
v_add_f32_dpp v63, v63, v63 row_ror:2 row_mask:0xf bank_mask:0xf
v_add_f32_dpp v60, v60, v60 row_ror:1 row_mask:0xf bank_mask:0xf
v_add_f32_dpp v61, v61, v61 row_ror:1 row_mask:0xf bank_mask:0xf
v_add_f32_dpp v62, v62, v62 row_ror:1 row_mask:0xf bank_mask:0xf
v_add_f32_dpp v63, v63, v63 row_ror:1 row_mask:0xf bank_mask:0xf
v_cmp_eq_u32 vcc, 8, v202
s_nop 1
v_cndmask_b32 v200, v200, v60, vcc
v_cndmask_b32 v201, v201, v61, vcc
v_cmp_eq_u32 vcc, 9, v202
s_nop 1
v_cndmask_b32 v200, v200, v62, vcc
v_cndmask_b32 v201, v201, v63, vcc
s_waitcnt vmcnt(30)
v_dot2_f32_bf16 v60, v168, v20, 0
v_dot2_f32_bf16 v61, v168, v24, 0
v_dot2_f32_bf16 v62, v172, v20, 0
v_dot2_f32_bf16 v63, v172, v24, 0
v_dot2_f32_bf16 v60, v169, v21, v60
v_dot2_f32_bf16 v61, v169, v25, v61
v_dot2_f32_bf16 v62, v173, v21, v62
v_dot2_f32_bf16 v63, v173, v25, v63
v_dot2_f32_bf16 v60, v170, v22, v60
v_dot2_f32_bf16 v61, v170, v26, v61
v_dot2_f32_bf16 v62, v174, v22, v62
v_dot2_f32_bf16 v63, v174, v26, v63
v_dot2_f32_bf16 v60, v171, v23, v60
v_dot2_f32_bf16 v61, v171, v27, v61
v_dot2_f32_bf16 v62, v175, v23, v62
v_dot2_f32_bf16 v63, v175, v27, v63
buffer_load_dwordx4 v[168:171], v10, s[44:47], 0 offen offset:2560 nt
buffer_load_dwordx4 v[172:175], v10, s[44:47], 0 offen offset:2816 nt
v_add_f32_dpp v60, v60, v60 row_ror:8 row_mask:0xf bank_mask:0xf
v_add_f32_dpp v61, v61, v61 row_ror:8 row_mask:0xf bank_mask:0xf
v_add_f32_dpp v62, v62, v62 row_ror:8 row_mask:0xf bank_mask:0xf
v_add_f32_dpp v63, v63, v63 row_ror:8 row_mask:0xf bank_mask:0xf
v_add_f32_dpp v60, v60, v60 row_ror:4 row_mask:0xf bank_mask:0xf
v_add_f32_dpp v61, v61, v61 row_ror:4 row_mask:0xf bank_mask:0xf
v_add_f32_dpp v62, v62, v62 row_ror:4 row_mask:0xf bank_mask:0xf
v_add_f32_dpp v63, v63, v63 row_ror:4 row_mask:0xf bank_mask:0xf
v_add_f32_dpp v60, v60, v60 row_ror:2 row_mask:0xf bank_mask:0xf
v_add_f32_dpp v61, v61, v61 row_ror:2 row_mask:0xf bank_mask:0xf
v_add_f32_dpp v62, v62, v62 row_ror:2 row_mask:0xf bank_mask:0xf
v_add_f32_dpp v63, v63, v63 row_ror:2 row_mask:0xf bank_mask:0xf
v_add_f32_dpp v60, v60, v60 row_ror:1 row_mask:0xf bank_mask:0xf
v_add_f32_dpp v61, v61, v61 row_ror:1 row_mask:0xf bank_mask:0xf
v_add_f32_dpp v62, v62, v62 row_ror:1 row_mask:0xf bank_mask:0xf
v_add_f32_dpp v63, v63, v63 row_ror:1 row_mask:0xf bank_mask:0xf
v_cmp_eq_u32 vcc, 10, v202
s_nop 1
v_cndmask_b32 v200, v200, v60, vcc
v_cndmask_b32 v201, v201, v61, vcc
v_cmp_eq_u32 vcc, 11, v202
s_nop 1
v_cndmask_b32 v200, v200, v62, vcc
v_cndmask_b32 v201, v201, v63, vcc
s_waitcnt vmcnt(30)
v_dot2_f32_bf16 v60, v176, v20, 0
v_dot2_f32_bf16 v61, v176, v24, 0
v_dot2_f32_bf16 v62, v180, v20, 0
v_dot2_f32_bf16 v63, v180, v24, 0
v_dot2_f32_bf16 v60, v177, v21, v60
v_dot2_f32_bf16 v61, v177, v25, v61
v_dot2_f32_bf16 v62, v181, v21, v62
v_dot2_f32_bf16 v63, v181, v25, v63
v_dot2_f32_bf16 v60, v178, v22, v60
v_dot2_f32_bf16 v61, v178, v26, v61
v_dot2_f32_bf16 v62, v182, v22, v62
v_dot2_f32_bf16 v63, v182, v26, v63
v_dot2_f32_bf16 v60, v179, v23, v60
v_dot2_f32_bf16 v61, v179, v27, v61
v_dot2_f32_bf16 v62, v183, v23, v62
v_dot2_f32_bf16 v63, v183, v27, v63
buffer_load_dwordx4 v[176:179], v10, s[44:47], 0 offen offset:3072 nt
buffer_load_dwordx4 v[180:183], v10, s[44:47], 0 offen offset:3328 nt
v_add_f32_dpp v60, v60, v60 row_ror:8 row_mask:0xf bank_mask:0xf
v_add_f32_dpp v61, v61, v61 row_ror:8 row_mask:0xf bank_mask:0xf
v_add_f32_dpp v62, v62, v62 row_ror:8 row_mask:0xf bank_mask:0xf
v_add_f32_dpp v63, v63, v63 row_ror:8 row_mask:0xf bank_mask:0xf
v_add_f32_dpp v60, v60, v60 row_ror:4 row_mask:0xf bank_mask:0xf
v_add_f32_dpp v61, v61, v61 row_ror:4 row_mask:0xf bank_mask:0xf
v_add_f32_dpp v62, v62, v62 row_ror:4 row_mask:0xf bank_mask:0xf
v_add_f32_dpp v63, v63, v63 row_ror:4 row_mask:0xf bank_mask:0xf
v_add_f32_dpp v60, v60, v60 row_ror:2 row_mask:0xf bank_mask:0xf
v_add_f32_dpp v61, v61, v61 row_ror:2 row_mask:0xf bank_mask:0xf
v_add_f32_dpp v62, v62, v62 row_ror:2 row_mask:0xf bank_mask:0xf
v_add_f32_dpp v63, v63, v63 row_ror:2 row_mask:0xf bank_mask:0xf
v_add_f32_dpp v60, v60, v60 row_ror:1 row_mask:0xf bank_mask:0xf
v_add_f32_dpp v61, v61, v61 row_ror:1 row_mask:0xf bank_mask:0xf
v_add_f32_dpp v62, v62, v62 row_ror:1 row_mask:0xf bank_mask:0xf
v_add_f32_dpp v63, v63, v63 row_ror:1 row_mask:0xf bank_mask:0xf
v_cmp_eq_u32 vcc, 12, v202
s_nop 1
v_cndmask_b32 v200, v200, v60, vcc
v_cndmask_b32 v201, v201, v61, vcc
v_cmp_eq_u32 vcc, 13, v202
s_nop 1
v_cndmask_b32 v200, v200, v62, vcc
v_cndmask_b32 v201, v201, v63, vcc
s_waitcnt vmcnt(30)
v_dot2_f32_bf16 v60, v184, v20, 0
v_dot2_f32_bf16 v61, v184, v24, 0
v_dot2_f32_bf16 v62, v188, v20, 0
v_dot2_f32_bf16 v63, v188, v24, 0
v_dot2_f32_bf16 v60, v185, v21, v60
v_dot2_f32_bf16 v61, v185, v25, v61
v_dot2_f32_bf16 v62, v189, v21, v62
v_dot2_f32_bf16 v63, v189, v25, v63
v_dot2_f32_bf16 v60, v186, v22, v60
v_dot2_f32_bf16 v61, v186, v26, v61
v_dot2_f32_bf16 v62, v190, v22, v62
v_dot2_f32_bf16 v63, v190, v26, v63
v_dot2_f32_bf16 v60, v187, v23, v60
v_dot2_f32_bf16 v61, v187, v27, v61
v_dot2_f32_bf16 v62, v191, v23, v62
v_dot2_f32_bf16 v63, v191, v27, v63
buffer_load_dwordx4 v[184:187], v10, s[44:47], 0 offen offset:3584 nt
buffer_load_dwordx4 v[188:191], v10, s[44:47], 0 offen offset:3840 nt
v_add_f32_dpp v60, v60, v60 row_ror:8 row_mask:0xf bank_mask:0xf
v_add_f32_dpp v61, v61, v61 row_ror:8 row_mask:0xf bank_mask:0xf
v_add_f32_dpp v62, v62, v62 row_ror:8 row_mask:0xf bank_mask:0xf
v_add_f32_dpp v63, v63, v63 row_ror:8 row_mask:0xf bank_mask:0xf
v_add_f32_dpp v60, v60, v60 row_ror:4 row_mask:0xf bank_mask:0xf
v_add_f32_dpp v61, v61, v61 row_ror:4 row_mask:0xf bank_mask:0xf
v_add_f32_dpp v62, v62, v62 row_ror:4 row_mask:0xf bank_mask:0xf
v_add_f32_dpp v63, v63, v63 row_ror:4 row_mask:0xf bank_mask:0xf
v_add_f32_dpp v60, v60, v60 row_ror:2 row_mask:0xf bank_mask:0xf
v_add_f32_dpp v61, v61, v61 row_ror:2 row_mask:0xf bank_mask:0xf
v_add_f32_dpp v62, v62, v62 row_ror:2 row_mask:0xf bank_mask:0xf
v_add_f32_dpp v63, v63, v63 row_ror:2 row_mask:0xf bank_mask:0xf
v_add_f32_dpp v60, v60, v60 row_ror:1 row_mask:0xf bank_mask:0xf
v_add_f32_dpp v61, v61, v61 row_ror:1 row_mask:0xf bank_mask:0xf
v_add_f32_dpp v62, v62, v62 row_ror:1 row_mask:0xf bank_mask:0xf
v_add_f32_dpp v63, v63, v63 row_ror:1 row_mask:0xf bank_mask:0xf
v_cmp_eq_u32 vcc, 14, v202
s_nop 1
v_cndmask_b32 v200, v200, v60, vcc
v_cndmask_b32 v201, v201, v61, vcc
v_cmp_eq_u32 vcc, 15, v202
s_nop 1
v_cndmask_b32 v200, v200, v62, vcc
v_cndmask_b32 v201, v201, v63, vcc
v_cvt_pk_bf16_f32 v200, v200, v200
v_cvt_pk_bf16_f32 v201, v201, v201
v_lshlrev_b32 v192, 1, v0
ds_write_b16 v192, v200 offset:0
ds_write_b16 v192, v201 offset:1024
s_waitcnt lgkmcnt(0)
s_barrier
s_cmp_lg_u32 s34, 0
s_cbranch_scc1 L_W_q
v_lshlrev_b32 v192, 4, v1
ds_read_b128 v[20:23], v192 offset:0
ds_read_b128 v[24:27], v192 offset:1024
s_lshl_b32 s62, s32, 10
s_add_u32 s62, s62, 0x0
s_add_u32 s63, s62, 32768
s_waitcnt lgkmcnt(0)
buffer_store_dwordx4 v[20:23], v192, s[52:55], s62 offen sc1
buffer_store_dwordx4 v[24:27], v192, s[52:55], s63 offen sc1
s_lshl_b32 s62, s32, 7
s_add_u32 s62, s62, 0x15000
v_mov_b32 v192, s62
v_mov_b32 v193, s58
s_mov_b64 exec, 1
s_waitcnt vmcnt(0)
buffer_store_dword v193, v192, s[52:55], 0 offen sc1
s_mov_b64 exec, -1
L_W_q:
s_waitcnt vmcnt(0)
s_xor_b32 s32, s32, 7
v_bfe_u32 v9, v1, 2, 3
v_lshlrev_b32 v9, 11, v9
v_and_b32 v192, 3, v1
v_lshrrev_b32 v10, 5, v1
v_lshl_add_u32 v192, v10, 2, v192
v_lshl_add_u32 v9, v192, 4, v9
s_lshr_b32 s62, s32, 4
s_and_b32 s63, s32, 15
s_lshl_b32 s60, s62, 16
s_lshl_b32 s61, s63, 7
s_add_u32 s60, s60, s61
s_add_u32 s60, s60, 0x20000
v_add_u32 v9, s60, v9
s_lshl_b32 s60, s62, 11
s_lshl_b32 s61, s63, 6
s_add_u32 s60, s60, s61
s_add_u32 s60, s60, 1024
v_lshl_add_u32 v10, v192, 3, s60
s_mov_b32 s37, 65536
s_lshr_b32 s35, s34, 2
s_and_b32 s36, s34, 3
s_branch L_W_merge
L_W_poll:
s_lshl_b32 s63, s32, 4
s_add_u32 s63, s63, 0x10000
v_lshl_add_u32 v192, v1, 9, s63
s_cmp_lg_u32 s34, 0
s_cbranch_scc1 L_wf_Wc
s_lshl_b64 exec, 1, s32
s_mov_b32 s64, 0
L_pl_Wc1:
buffer_load_dwordx4 v[196:199], v192, s[52:55], 0 offen sc1
s_add_u32 s64, s64, 1
s_waitcnt vmcnt(0)
v_xor_b32 v196, s76, v196
v_xor_b32 v197, s77, v197
v_xor_b32 v198, s78, v198
v_xor_b32 v199, s79, v199
v_or_b32 v193, v196, v197
v_or3_b32 v193, v193, v198, v199
v_and_b32 v193, 0xff, v193
v_cmp_ne_u32 vcc, 0, v193
s_nop 0
s_cmp_eq_u64 vcc, 0
s_cbranch_scc1 L_pd_Wc1
s_mov_b64 exec, vcc
s_sleep 2
s_cmp_lt_u32 s64, 65536
s_cbranch_scc1 L_pl_Wc1
L_pd_Wc1:
s_mov_b32 exec_lo, -1
s_mov_b32 exec_hi, 0
s_mov_b32 s64, 0
L_pl_Wc2:
buffer_load_dwordx4 v[196:199], v192, s[52:55], 0 offen sc1
s_add_u32 s64, s64, 1
s_waitcnt vmcnt(0)
v_xor_b32 v196, s76, v196
v_xor_b32 v197, s77, v197
v_xor_b32 v198, s78, v198
v_xor_b32 v199, s79, v199
v_or_b32 v193, v196, v197
v_or3_b32 v193, v193, v198, v199
v_and_b32 v193, 0xff, v193
v_cmp_ne_u32 vcc, 0, v193
s_nop 0
s_cmp_eq_u64 vcc, 0
s_cbranch_scc1 L_pd_Wc2
s_mov_b64 exec, vcc
s_cmp_lt_u32 s64, 65536
s_cbranch_scc1 L_pl_Wc2
L_pd_Wc2:
s_mov_b64 exec, -1
L_wf_Wc:
s_barrier
s_lshl_b32 s62, s35, 13
s_add_u32 s63, s63, s62
v_lshl_add_u32 v192, v2, 9, s63
buffer_load_dwordx4 v[196:199], v192, s[52:55], 0 offen sc1
s_lshl_b32 s62, s35, 5
s_add_u32 s62, s62, s32
s_lshl_b32 s63, s62, 14
s_add_u32 s63, s63, 0x200000
s_lshl_b32 s64, s36, 12
s_add_u32 s63, s63, s64
v_lshl_add_u32 v193, v1, 4, s63
buffer_load_dwordx4 v[200:203], v193, s[52:55], 0 offen offset:0 sc1
buffer_load_dwordx4 v[204:207], v193, s[52:55], 0 offen offset:1024 sc1
buffer_load_dwordx4 v[208:211], v193, s[52:55], 0 offen offset:2048 sc1
buffer_load_dwordx4 v[212:215], v193, s[52:55], 0 offen offset:3072 sc1
L_W_merge:
s_mov_b32 s60, 0x07060302
s_waitcnt vmcnt(4)
v_perm_b32 v194, v196, v197, s60
v_perm_b32 v195, v198, v199, s60
v_mov_b32 v196, v194
s_nop 1
v_max_f32_dpp v196, v196, v196 row_ror:8 row_mask:0xf bank_mask:0xf
s_nop 1
v_max_f32_dpp v196, v196, v196 row_ror:4 row_mask:0xf bank_mask:0xf
s_nop 1
v_max_f32_dpp v196, v196, v196 row_ror:2 row_mask:0xf bank_mask:0xf
s_nop 1
v_max_f32_dpp v196, v196, v196 row_ror:1 row_mask:0xf bank_mask:0xf
v_sub_f32 v197, v194, v196
v_exp_f32 v197, v197
s_nop 0
v_mul_f32 v195, v195, v197
s_nop 1
v_add_f32_dpp v195, v195, v195 row_ror:8 row_mask:0xf bank_mask:0xf
s_nop 1
v_add_f32_dpp v195, v195, v195 row_ror:4 row_mask:0xf bank_mask:0xf
s_nop 1
v_add_f32_dpp v195, v195, v195 row_ror:2 row_mask:0xf bank_mask:0xf
s_nop 1
v_add_f32_dpp v195, v195, v195 row_ror:1 row_mask:0xf bank_mask:0xf
v_rcp_f32 v195, v195
s_nop 0
v_mul_f32 v197, v197, v195
s_lshl_b32 s64, s36, 2
s_add_u32 s65, s64, 0
v_readlane_b32 s66, v197, s65
s_add_u32 s65, s64, 1
v_readlane_b32 s67, v197, s65
s_add_u32 s65, s64, 2
v_readlane_b32 s68, v197, s65
s_add_u32 s65, s64, 3
v_readlane_b32 s69, v197, s65
s_waitcnt vmcnt(3)
v_lshlrev_b32 v216, 16, v200
v_and_b32 v217, 0xffff0000, v200
v_lshlrev_b32 v218, 16, v201
v_and_b32 v219, 0xffff0000, v201
v_lshlrev_b32 v220, 16, v202
v_and_b32 v221, 0xffff0000, v202
v_lshlrev_b32 v222, 16, v203
v_and_b32 v223, 0xffff0000, v203
v_mul_f32 v232, s66, v216
v_mul_f32 v233, s66, v217
v_mul_f32 v234, s66, v218
v_mul_f32 v235, s66, v219
v_mul_f32 v236, s66, v220
v_mul_f32 v237, s66, v221
v_mul_f32 v238, s66, v222
v_mul_f32 v239, s66, v223
s_waitcnt vmcnt(2)
v_lshlrev_b32 v216, 16, v204
v_and_b32 v217, 0xffff0000, v204
v_lshlrev_b32 v218, 16, v205
v_and_b32 v219, 0xffff0000, v205
v_lshlrev_b32 v220, 16, v206
v_and_b32 v221, 0xffff0000, v206
v_lshlrev_b32 v222, 16, v207
v_and_b32 v223, 0xffff0000, v207
v_fma_f32 v232, v216, s67, v232
v_fma_f32 v233, v217, s67, v233
v_fma_f32 v234, v218, s67, v234
v_fma_f32 v235, v219, s67, v235
v_fma_f32 v236, v220, s67, v236
v_fma_f32 v237, v221, s67, v237
v_fma_f32 v238, v222, s67, v238
v_fma_f32 v239, v223, s67, v239
s_waitcnt vmcnt(1)
v_lshlrev_b32 v216, 16, v208
v_and_b32 v217, 0xffff0000, v208
v_lshlrev_b32 v218, 16, v209
v_and_b32 v219, 0xffff0000, v209
v_lshlrev_b32 v220, 16, v210
v_and_b32 v221, 0xffff0000, v210
v_lshlrev_b32 v222, 16, v211
v_and_b32 v223, 0xffff0000, v211
v_fma_f32 v232, v216, s68, v232
v_fma_f32 v233, v217, s68, v233
v_fma_f32 v234, v218, s68, v234
v_fma_f32 v235, v219, s68, v235
v_fma_f32 v236, v220, s68, v236
v_fma_f32 v237, v221, s68, v237
v_fma_f32 v238, v222, s68, v238
v_fma_f32 v239, v223, s68, v239
s_waitcnt vmcnt(0)
v_lshlrev_b32 v216, 16, v212
v_and_b32 v217, 0xffff0000, v212
v_lshlrev_b32 v218, 16, v213
v_and_b32 v219, 0xffff0000, v213
v_lshlrev_b32 v220, 16, v214
v_and_b32 v221, 0xffff0000, v214
v_lshlrev_b32 v222, 16, v215
v_and_b32 v223, 0xffff0000, v215
v_fma_f32 v232, v216, s69, v232
v_fma_f32 v233, v217, s69, v233
v_fma_f32 v234, v218, s69, v234
v_fma_f32 v235, v219, s69, v235
v_fma_f32 v236, v220, s69, v236
v_fma_f32 v237, v221, s69, v237
v_fma_f32 v238, v222, s69, v238
v_fma_f32 v239, v223, s69, v239
s_lshl_b32 s62, s34, 11
v_lshl_add_u32 v192, v1, 5, s62
ds_write_b128 v192, v[232:235] offset:18432
ds_write_b128 v192, v[236:239] offset:18448
s_waitcnt lgkmcnt(0)
s_barrier
v_lshrrev_b32 v192, 3, v2
v_lshlrev_b32 v192, 13, v192
v_lshl_add_u32 v192, v3, 6, v192
s_lshl_b32 s62, s34, 8
s_lshr_b32 s63, s80, 11
s_add_u32 s62, s62, s63
v_add_u32 v192, s62, v192
v_xor_b32 v193, 16, v192
v_xor_b32 v194, 32, v192
v_xor_b32 v195, 48, v192
ds_read_b128 v[200:203], v192 offset:18432
ds_read_b128 v[204:207], v193 offset:18432
ds_read_b128 v[208:211], v194 offset:18432
ds_read_b128 v[212:215], v195 offset:18432
ds_read_b128 v[216:219], v192 offset:20480
ds_read_b128 v[220:223], v193 offset:20480
ds_read_b128 v[224:227], v194 offset:20480
ds_read_b128 v[228:231], v195 offset:20480
s_waitcnt lgkmcnt(0)
v_add_f32 v200, v200, v216
v_add_f32 v201, v201, v217
v_add_f32 v202, v202, v218
v_add_f32 v203, v203, v219
v_add_f32 v204, v204, v220
v_add_f32 v205, v205, v221
v_add_f32 v206, v206, v222
v_add_f32 v207, v207, v223
v_add_f32 v208, v208, v224
v_add_f32 v209, v209, v225
v_add_f32 v210, v210, v226
v_add_f32 v211, v211, v227
v_add_f32 v212, v212, v228
v_add_f32 v213, v213, v229
v_add_f32 v214, v214, v230
v_add_f32 v215, v215, v231
ds_read_b128 v[216:219], v192 offset:22528
ds_read_b128 v[220:223], v193 offset:22528
ds_read_b128 v[224:227], v194 offset:22528
ds_read_b128 v[228:231], v195 offset:22528
s_waitcnt lgkmcnt(0)
v_add_f32 v200, v200, v216
v_add_f32 v201, v201, v217
v_add_f32 v202, v202, v218
v_add_f32 v203, v203, v219
v_add_f32 v204, v204, v220
v_add_f32 v205, v205, v221
v_add_f32 v206, v206, v222
v_add_f32 v207, v207, v223
v_add_f32 v208, v208, v224
v_add_f32 v209, v209, v225
v_add_f32 v210, v210, v226
v_add_f32 v211, v211, v227
v_add_f32 v212, v212, v228
v_add_f32 v213, v213, v229
v_add_f32 v214, v214, v230
v_add_f32 v215, v215, v231
ds_read_b128 v[216:219], v192 offset:24576
ds_read_b128 v[220:223], v193 offset:24576
ds_read_b128 v[224:227], v194 offset:24576
ds_read_b128 v[228:231], v195 offset:24576
s_waitcnt lgkmcnt(0)
v_add_f32 v200, v200, v216
v_add_f32 v201, v201, v217
v_add_f32 v202, v202, v218
v_add_f32 v203, v203, v219
v_add_f32 v204, v204, v220
v_add_f32 v205, v205, v221
v_add_f32 v206, v206, v222
v_add_f32 v207, v207, v223
v_add_f32 v208, v208, v224
v_add_f32 v209, v209, v225
v_add_f32 v210, v210, v226
v_add_f32 v211, v211, v227
v_add_f32 v212, v212, v228
v_add_f32 v213, v213, v229
v_add_f32 v214, v214, v230
v_add_f32 v215, v215, v231
v_cvt_pk_bf16_f32 v12, v200, v201
v_cvt_pk_bf16_f32 v13, v202, v203
v_cvt_pk_bf16_f32 v14, v204, v205
v_cvt_pk_bf16_f32 v15, v206, v207
v_cvt_pk_bf16_f32 v16, v208, v209
v_cvt_pk_bf16_f32 v17, v210, v211
v_cvt_pk_bf16_f32 v18, v212, v213
v_cvt_pk_bf16_f32 v19, v214, v215
s_mov_b32 s60, 0x01000100
v_perm_b32 v192, v12, v12, s60
v_and_b32 v28, v192, v4
v_and_b32 v29, v192, v5
v_and_b32 v30, v192, v6
v_and_b32 v31, v192, v7
s_waitcnt vmcnt(63)
s_nop 0
v_mfma_f32_16x16x32_bf16 v[44:47], v[28:31], v[64:67], 0
s_mov_b32 s60, 0x03020302
v_perm_b32 v193, v12, v12, s60
v_and_b32 v32, v193, v4
v_and_b32 v33, v193, v5
v_and_b32 v34, v193, v6
v_and_b32 v35, v193, v7
s_waitcnt vmcnt(63)
s_nop 0
v_mfma_f32_16x16x32_bf16 v[44:47], v[32:35], v[68:71], v[44:47]
s_mov_b32 s60, 0x01000100
v_perm_b32 v192, v13, v13, s60
v_and_b32 v28, v192, v4
v_and_b32 v29, v192, v5
v_and_b32 v30, v192, v6
v_and_b32 v31, v192, v7
s_waitcnt vmcnt(63)
s_nop 0
v_mfma_f32_16x16x32_bf16 v[44:47], v[28:31], v[72:75], v[44:47]
s_mov_b32 s60, 0x03020302
v_perm_b32 v193, v13, v13, s60
v_and_b32 v32, v193, v4
v_and_b32 v33, v193, v5
v_and_b32 v34, v193, v6
v_and_b32 v35, v193, v7
s_waitcnt vmcnt(63)
s_nop 0
v_mfma_f32_16x16x32_bf16 v[44:47], v[32:35], v[76:79], v[44:47]
s_mov_b32 s60, 0x01000100
v_perm_b32 v192, v14, v14, s60
v_and_b32 v28, v192, v4
v_and_b32 v29, v192, v5
v_and_b32 v30, v192, v6
v_and_b32 v31, v192, v7
s_waitcnt vmcnt(63)
s_nop 0
v_mfma_f32_16x16x32_bf16 v[44:47], v[28:31], v[80:83], v[44:47]
s_mov_b32 s60, 0x03020302
v_perm_b32 v193, v14, v14, s60
v_and_b32 v32, v193, v4
v_and_b32 v33, v193, v5
v_and_b32 v34, v193, v6
v_and_b32 v35, v193, v7
s_waitcnt vmcnt(63)
s_nop 0
v_mfma_f32_16x16x32_bf16 v[44:47], v[32:35], v[84:87], v[44:47]
s_mov_b32 s60, 0x01000100
v_perm_b32 v192, v15, v15, s60
v_and_b32 v28, v192, v4
v_and_b32 v29, v192, v5
v_and_b32 v30, v192, v6
v_and_b32 v31, v192, v7
s_waitcnt vmcnt(63)
s_nop 0
v_mfma_f32_16x16x32_bf16 v[44:47], v[28:31], v[88:91], v[44:47]
s_mov_b32 s60, 0x03020302
v_perm_b32 v193, v15, v15, s60
v_and_b32 v32, v193, v4
v_and_b32 v33, v193, v5
v_and_b32 v34, v193, v6
v_and_b32 v35, v193, v7
s_waitcnt vmcnt(63)
s_nop 0
v_mfma_f32_16x16x32_bf16 v[44:47], v[32:35], v[92:95], v[44:47]
s_mov_b32 s60, 0x01000100
v_perm_b32 v192, v16, v16, s60
v_and_b32 v28, v192, v4
v_and_b32 v29, v192, v5
v_and_b32 v30, v192, v6
v_and_b32 v31, v192, v7
s_waitcnt vmcnt(63)
s_nop 0
v_mfma_f32_16x16x32_bf16 v[44:47], v[28:31], v[96:99], v[44:47]
s_mov_b32 s60, 0x03020302
v_perm_b32 v193, v16, v16, s60
v_and_b32 v32, v193, v4
v_and_b32 v33, v193, v5
v_and_b32 v34, v193, v6
v_and_b32 v35, v193, v7
s_waitcnt vmcnt(63)
s_nop 0
v_mfma_f32_16x16x32_bf16 v[44:47], v[32:35], v[100:103], v[44:47]
s_mov_b32 s60, 0x01000100
v_perm_b32 v192, v17, v17, s60
v_and_b32 v28, v192, v4
v_and_b32 v29, v192, v5
v_and_b32 v30, v192, v6
v_and_b32 v31, v192, v7
s_waitcnt vmcnt(63)
s_nop 0
v_mfma_f32_16x16x32_bf16 v[44:47], v[28:31], v[104:107], v[44:47]
s_mov_b32 s60, 0x03020302
v_perm_b32 v193, v17, v17, s60
v_and_b32 v32, v193, v4
v_and_b32 v33, v193, v5
v_and_b32 v34, v193, v6
v_and_b32 v35, v193, v7
s_waitcnt vmcnt(63)
s_nop 0
v_mfma_f32_16x16x32_bf16 v[44:47], v[32:35], v[108:111], v[44:47]
s_mov_b32 s60, 0x01000100
v_perm_b32 v192, v18, v18, s60
v_and_b32 v28, v192, v4
v_and_b32 v29, v192, v5
v_and_b32 v30, v192, v6
v_and_b32 v31, v192, v7
s_waitcnt vmcnt(63)
s_nop 0
v_mfma_f32_16x16x32_bf16 v[44:47], v[28:31], v[112:115], v[44:47]
s_mov_b32 s60, 0x03020302
v_perm_b32 v193, v18, v18, s60
v_and_b32 v32, v193, v4
v_and_b32 v33, v193, v5
v_and_b32 v34, v193, v6
v_and_b32 v35, v193, v7
s_waitcnt vmcnt(63)
s_nop 0
v_mfma_f32_16x16x32_bf16 v[44:47], v[32:35], v[116:119], v[44:47]
s_mov_b32 s60, 0x01000100
v_perm_b32 v192, v19, v19, s60
v_and_b32 v28, v192, v4
v_and_b32 v29, v192, v5
v_and_b32 v30, v192, v6
v_and_b32 v31, v192, v7
s_waitcnt vmcnt(63)
s_nop 0
v_mfma_f32_16x16x32_bf16 v[44:47], v[28:31], v[120:123], v[44:47]
s_mov_b32 s60, 0x03020302
v_perm_b32 v193, v19, v19, s60
v_and_b32 v32, v193, v4
v_and_b32 v33, v193, v5
v_and_b32 v34, v193, v6
v_and_b32 v35, v193, v7
s_waitcnt vmcnt(63)
s_nop 0
v_mfma_f32_16x16x32_bf16 v[44:47], v[32:35], v[124:127], v[44:47]
v_lshrrev_b32 v192, 1, v3
v_lshlrev_b32 v192, 9, v192
v_lshl_add_u32 v192, v2, 5, v192
v_and_b32 v193, 1, v3
v_lshl_add_u32 v192, v193, 4, v192
s_lshl_b32 s63, s34, 10
v_add_u32 v192, s63, v192
s_nop 1
s_nop 5
ds_write_b128 v192, v[44:47] offset:9216
s_waitcnt lgkmcnt(0)
s_barrier
v_lshrrev_b32 v192, 3, v2
v_lshlrev_b32 v192, 9, v192
v_lshl_add_u32 v192, v3, 4, v192
s_lshl_b32 s62, s34, 6
v_add_u32 v192, s62, v192
ds_read_b128 v[200:203], v192 offset:9216
ds_read_b128 v[204:207], v192 offset:10240
ds_read_b128 v[208:211], v192 offset:11264
ds_read_b128 v[212:215], v192 offset:12288
ds_read_b128 v[216:219], v192 offset:13312
ds_read_b128 v[220:223], v192 offset:14336
ds_read_b128 v[224:227], v192 offset:15360
ds_read_b128 v[228:231], v192 offset:16384
s_waitcnt lgkmcnt(6)
v_add_f32 v200, v200, v204
v_add_f32 v201, v201, v205
v_add_f32 v202, v202, v206
v_add_f32 v203, v203, v207
s_waitcnt lgkmcnt(5)
v_add_f32 v200, v200, v208
v_add_f32 v201, v201, v209
v_add_f32 v202, v202, v210
v_add_f32 v203, v203, v211
s_waitcnt lgkmcnt(4)
v_add_f32 v200, v200, v212
v_add_f32 v201, v201, v213
v_add_f32 v202, v202, v214
v_add_f32 v203, v203, v215
s_waitcnt lgkmcnt(3)
v_add_f32 v200, v200, v216
v_add_f32 v201, v201, v217
v_add_f32 v202, v202, v218
v_add_f32 v203, v203, v219
s_waitcnt lgkmcnt(2)
v_add_f32 v200, v200, v220
v_add_f32 v201, v201, v221
v_add_f32 v202, v202, v222
v_add_f32 v203, v203, v223
s_waitcnt lgkmcnt(1)
v_add_f32 v200, v200, v224
v_add_f32 v201, v201, v225
v_add_f32 v202, v202, v226
v_add_f32 v203, v203, v227
s_waitcnt lgkmcnt(0)
v_add_f32 v200, v200, v228
v_add_f32 v201, v201, v229
v_add_f32 v202, v202, v230
v_add_f32 v203, v203, v231
v_cvt_pk_bf16_f32 v60, v200, v200
v_cvt_pk_bf16_f32 v61, v201, v201
v_cvt_pk_bf16_f32 v62, v202, v202
v_cvt_pk_bf16_f32 v63, v203, v203
v_and_b32 v28, v60, v4
v_and_b32 v29, v60, v5
v_and_b32 v30, v60, v6
v_and_b32 v31, v60, v7
v_and_b32 v32, v61, v4
v_and_b32 v33, v61, v5
v_and_b32 v34, v61, v6
v_and_b32 v35, v61, v7
v_and_b32 v36, v62, v4
v_and_b32 v37, v62, v5
v_and_b32 v38, v62, v6
v_and_b32 v39, v62, v7
v_and_b32 v40, v63, v4
v_and_b32 v41, v63, v5
v_and_b32 v42, v63, v6
v_and_b32 v43, v63, v7
v_mfma_f32_16x16x32_bf16 v[44:47], v[28:31], v[128:131], 0
v_mfma_f32_16x16x32_bf16 v[48:51], v[28:31], v[132:135], 0
v_mfma_f32_16x16x32_bf16 v[52:55], v[28:31], v[136:139], 0
v_mfma_f32_16x16x32_bf16 v[56:59], v[28:31], v[140:143], 0
v_mfma_f32_16x16x32_bf16 v[44:47], v[32:35], v[144:147], v[44:47]
v_mfma_f32_16x16x32_bf16 v[48:51], v[32:35], v[148:151], v[48:51]
v_mfma_f32_16x16x32_bf16 v[52:55], v[32:35], v[152:155], v[52:55]
v_mfma_f32_16x16x32_bf16 v[56:59], v[32:35], v[156:159], v[56:59]
v_mfma_f32_16x16x32_bf16 v[44:47], v[36:39], v[160:163], v[44:47]
v_mfma_f32_16x16x32_bf16 v[48:51], v[36:39], v[164:167], v[48:51]
v_mfma_f32_16x16x32_bf16 v[52:55], v[36:39], v[168:171], v[52:55]
v_mfma_f32_16x16x32_bf16 v[56:59], v[36:39], v[172:175], v[56:59]
v_mfma_f32_16x16x32_bf16 v[44:47], v[40:43], v[176:179], v[44:47]
v_mfma_f32_16x16x32_bf16 v[48:51], v[40:43], v[180:183], v[48:51]
v_mfma_f32_16x16x32_bf16 v[52:55], v[40:43], v[184:187], v[52:55]
v_mfma_f32_16x16x32_bf16 v[56:59], v[40:43], v[188:191], v[56:59]
v_lshrrev_b32 v192, 1, v3
v_lshlrev_b32 v192, 11, v192
v_lshl_add_u32 v192, v2, 5, v192
v_and_b32 v193, 1, v3
v_lshl_add_u32 v192, v193, 4, v192
s_lshl_b32 s63, s34, 12
v_add_u32 v192, s63, v192
s_nop 1
ds_write_b128 v192, v[44:47] offset:18432
ds_write_b128 v192, v[48:51] offset:18944
ds_write_b128 v192, v[52:55] offset:19456
s_nop 5
ds_write_b128 v192, v[56:59] offset:19968
s_waitcnt lgkmcnt(0)
s_barrier
s_cmp_ge_u32 s34, 4
s_cbranch_scc1 L_W_yskip
v_lshlrev_b32 v192, 4, v0
ds_read_b128 v[200:203], v192 offset:18432
ds_read_b128 v[204:207], v192 offset:22528
ds_read_b128 v[208:211], v192 offset:26624
ds_read_b128 v[212:215], v192 offset:30720
ds_read_b128 v[216:219], v192 offset:34816
ds_read_b128 v[220:223], v192 offset:38912
ds_read_b128 v[224:227], v192 offset:43008
ds_read_b128 v[228:231], v192 offset:47104
v_bfe_u32 v193, v0, 7, 1
v_lshlrev_b32 v193, 16, v193
v_and_b32 v194, 127, v0
v_lshl_add_u32 v193, v194, 4, v193
s_lshl_b32 s63, s32, 11
s_add_u32 s63, s63, 0x20000
v_add_u32 v193, s63, v193
v_mov_b32 v194, 0xffffff00
s_waitcnt lgkmcnt(6)
v_add_f32 v200, v200, v204
v_add_f32 v201, v201, v205
v_add_f32 v202, v202, v206
v_add_f32 v203, v203, v207
s_waitcnt lgkmcnt(5)
v_add_f32 v200, v200, v208
v_add_f32 v201, v201, v209
v_add_f32 v202, v202, v210
v_add_f32 v203, v203, v211
s_waitcnt lgkmcnt(4)
v_add_f32 v200, v200, v212
v_add_f32 v201, v201, v213
v_add_f32 v202, v202, v214
v_add_f32 v203, v203, v215
s_waitcnt lgkmcnt(3)
v_add_f32 v200, v200, v216
v_add_f32 v201, v201, v217
v_add_f32 v202, v202, v218
v_add_f32 v203, v203, v219
s_waitcnt lgkmcnt(2)
v_add_f32 v200, v200, v220
v_add_f32 v201, v201, v221
v_add_f32 v202, v202, v222
v_add_f32 v203, v203, v223
s_waitcnt lgkmcnt(1)
v_add_f32 v200, v200, v224
v_add_f32 v201, v201, v225
v_add_f32 v202, v202, v226
v_add_f32 v203, v203, v227
s_waitcnt lgkmcnt(0)
v_add_f32 v200, v200, v228
v_add_f32 v201, v201, v229
v_add_f32 v202, v202, v230
v_add_f32 v203, v203, v231
v_add_u32 v200, 0x80, v200
v_add_u32 v201, 0x80, v201
v_add_u32 v202, 0x80, v202
v_add_u32 v203, 0x80, v203
v_and_or_b32 v200, v200, v194, s76
v_and_or_b32 v201, v201, v194, s77
v_and_or_b32 v202, v202, v194, s78
v_and_or_b32 v203, v203, v194, s79
s_cmp_lg_u32 s37, 0
s_cbranch_scc1 L_W_yskip
buffer_store_dwordx4 v[200:203], v193, s[52:55], 0 offen sc1
L_W_yskip:
s_cmp_lg_u32 s34, 4
s_cbranch_scc1 L_W_fin
s_mov_b32 s64, s37
s_mov_b32 s66, 0x4000
s_mov_b32 s67, 0x8000
s_mov_b32 s65, 0xc000
buffer_load_dwordx4 v[12:15], v9, s[52:55], 0 offen sc1
buffer_load_dwordx4 v[16:19], v9, s[52:55], s66 offen sc1
buffer_load_dwordx4 v[20:23], v9, s[52:55], s67 offen sc1
buffer_load_dwordx4 v[24:27], v9, s[52:55], s65 offen sc1
L_ps_Wf:
s_waitcnt vmcnt(3)
v_xor_b32 v200, s76, v12
v_xor_b32 v201, s77, v13
v_xor_b32 v202, s78, v14
v_xor_b32 v203, s79, v15
v_or_b32 v192, v200, v201
v_or3_b32 v192, v192, v202, v203
s_waitcnt vmcnt(2)
v_xor_b32 v204, s76, v16
v_xor_b32 v205, s77, v17
v_xor_b32 v206, s78, v18
v_xor_b32 v207, s79, v19
v_or3_b32 v192, v192, v204, v205
v_or3_b32 v192, v192, v206, v207
v_add_f32 v200, v200, v204
v_add_f32 v201, v201, v205
v_add_f32 v202, v202, v206
v_add_f32 v203, v203, v207
s_waitcnt vmcnt(1)
v_xor_b32 v204, s76, v20
v_xor_b32 v205, s77, v21
v_xor_b32 v206, s78, v22
v_xor_b32 v207, s79, v23
v_or3_b32 v192, v192, v204, v205
v_or3_b32 v192, v192, v206, v207
v_add_f32 v200, v200, v204
v_add_f32 v201, v201, v205
v_add_f32 v202, v202, v206
v_add_f32 v203, v203, v207
s_waitcnt vmcnt(0)
v_xor_b32 v204, s76, v24
v_xor_b32 v205, s77, v25
v_xor_b32 v206, s78, v26
v_xor_b32 v207, s79, v27
v_or3_b32 v192, v192, v204, v205
v_or3_b32 v192, v192, v206, v207
v_add_f32 v200, v200, v204
v_add_f32 v201, v201, v205
v_add_f32 v202, v202, v206
v_add_f32 v203, v203, v207
v_and_b32 v192, 0xff, v192
v_cmp_ne_u32 vcc, 0, v192
v_add_f32_dpp v200, v200, v200 row_ror:8 row_mask:0xf bank_mask:0xf
v_add_f32_dpp v201, v201, v201 row_ror:8 row_mask:0xf bank_mask:0xf
v_add_f32_dpp v202, v202, v202 row_ror:8 row_mask:0xf bank_mask:0xf
v_add_f32_dpp v203, v203, v203 row_ror:8 row_mask:0xf bank_mask:0xf
s_cmp_eq_u64 vcc, 0
s_cbranch_scc1 L_pe_Wf
s_sleep 2
buffer_load_dwordx4 v[12:15], v9, s[52:55], 0 offen sc1
buffer_load_dwordx4 v[16:19], v9, s[52:55], s66 offen sc1
buffer_load_dwordx4 v[20:23], v9, s[52:55], s67 offen sc1
buffer_load_dwordx4 v[24:27], v9, s[52:55], s65 offen sc1
s_add_u32 s64, s64, 1
s_cmp_lt_u32 s64, 65536
s_cbranch_scc1 L_ps_Wf
L_pe_Wf:
v_add_f32_dpp v200, v200, v200 row_ror:4 row_mask:0xf bank_mask:0xf
v_add_f32_dpp v201, v201, v201 row_ror:4 row_mask:0xf bank_mask:0xf
v_add_f32_dpp v202, v202, v202 row_ror:4 row_mask:0xf bank_mask:0xf
v_add_f32_dpp v203, v203, v203 row_ror:4 row_mask:0xf bank_mask:0xf
v_mov_b32 v192, v200
v_mov_b32 v193, v201
v_mov_b32 v194, v202
v_mov_b32 v195, v203
v_permlane16_swap_b32 v200, v192
v_permlane16_swap_b32 v201, v193
v_permlane16_swap_b32 v202, v194
v_permlane16_swap_b32 v203, v195
v_add_f32 v200, v200, v192
v_add_f32 v201, v201, v193
v_add_f32 v202, v202, v194
v_add_f32 v203, v203, v195
v_cvt_pk_bf16_f32 v200, v200, v201
v_cvt_pk_bf16_f32 v201, v202, v203
s_cmp_lg_u32 s37, 0
s_cbranch_scc1 L_W_fin
s_mov_b32 exec_lo, 15
s_mov_b32 exec_hi, 15
global_store_dwordx2 v10, v[200:201], s[26:27]
s_mov_b64 exec, -1
L_W_fin:
s_cmp_eq_u32 s37, 0
s_cbranch_scc1 L_W_end
s_mov_b32 s37, 0
s_waitcnt vmcnt(0)
s_branch L_W_poll
L_W_end:
s_endpgm
L_roleC:
s_waitcnt lgkmcnt(0)
s_lshl_b32 s60, s32, 8
s_sub_u32 s61, 0x400000, s60
s_add_u32 s68, s10, s60
s_addc_u32 s69, s11, 0
s_and_b32 s69, s69, 0xffff
s_mov_b32 s70, s61
s_mov_b32 s71, 0x20000
s_mov_b32 s72, s4
s_and_b32 s73, s5, 0xffff
s_mov_b32 s74, 0x800
s_mov_b32 s75, 0x20000
v_lshrrev_b32 v240, 3, v2
v_lshlrev_b32 v240, 10, v240
v_lshl_add_u32 v240, v3, 5, v240
s_lshl_b32 s62, s34, 7
v_add_u32 v240, s62, v240
s_mov_b32 s80, 0
buffer_load_dwordx4 v[32:35], v240, s[72:75], 0 offen
buffer_load_dwordx4 v[36:39], v240, s[72:75], 0 offen offset:16
v_lshlrev_b32 v9, 17, v3
v_lshl_add_u32 v9, v2, 4, v9
s_lshl_b32 s62, s34, 19
v_add_u32 v9, s62, v9
s_xor_b32 s62, s80, 0
buffer_load_dwordx4 v[128:131], v9, s[68:71], s62 offen nt
s_xor_b32 s62, s80, 8192
buffer_load_dwordx4 v[132:135], v9, s[68:71], s62 offen nt
s_xor_b32 s62, s80, 16384
buffer_load_dwordx4 v[136:139], v9, s[68:71], s62 offen nt
s_xor_b32 s62, s80, 24576
buffer_load_dwordx4 v[140:143], v9, s[68:71], s62 offen nt
s_xor_b32 s62, s80, 32768
buffer_load_dwordx4 v[144:147], v9, s[68:71], s62 offen nt
s_xor_b32 s62, s80, 40960
buffer_load_dwordx4 v[148:151], v9, s[68:71], s62 offen nt
s_xor_b32 s62, s80, 49152
buffer_load_dwordx4 v[152:155], v9, s[68:71], s62 offen nt
s_xor_b32 s62, s80, 57344
buffer_load_dwordx4 v[156:159], v9, s[68:71], s62 offen nt
s_xor_b32 s62, s80, 65536
buffer_load_dwordx4 v[160:163], v9, s[68:71], s62 offen nt
s_xor_b32 s62, s80, 73728
buffer_load_dwordx4 v[164:167], v9, s[68:71], s62 offen nt
s_xor_b32 s62, s80, 81920
buffer_load_dwordx4 v[168:171], v9, s[68:71], s62 offen nt
s_xor_b32 s62, s80, 90112
buffer_load_dwordx4 v[172:175], v9, s[68:71], s62 offen nt
s_xor_b32 s62, s80, 98304
buffer_load_dwordx4 v[176:179], v9, s[68:71], s62 offen nt
s_xor_b32 s62, s80, 106496
buffer_load_dwordx4 v[180:183], v9, s[68:71], s62 offen nt
s_xor_b32 s62, s80, 114688
buffer_load_dwordx4 v[184:187], v9, s[68:71], s62 offen nt
s_xor_b32 s62, s80, 122880
buffer_load_dwordx4 v[188:191], v9, s[68:71], s62 offen nt
s_load_dword s58, s[30:31], 0x14000
s_mov_b32 s44, s30
s_and_b32 s45, s31, 0xffff
s_mov_b32 s46, 0x1000000
s_mov_b32 s47, 0x20000
s_cmp_lg_u32 s34, 6
s_cbranch_scc1 L_C_ctr
v_mov_b32 v192, -1
s_lshl_b32 s62, s32, 13
s_add_u32 s62, s62, 0x61800
v_lshl_add_u32 v240, v1, 7, s62
s_mov_b64 exec, 1
buffer_store_dword v192, v240, s[44:47], 0 offen sc1
buffer_store_dword v192, v240, s[44:47], 0 offen offset:1024 sc1
s_mov_b64 exec, -1
L_C_ctr:
v_and_b32 v242, 1, v0
v_lshlrev_b32 v242, 4, v242
v_mov_b32 v243, 0xffff
v_lshlrev_b32 v242, v242, v243
v_bfe_u32 v243, v0, 1, 2
v_cmp_eq_u32 vcc, 0, v243
s_nop 1
v_cndmask_b32 v4, 0, v242, vcc
v_cmp_eq_u32 vcc, 1, v243
s_nop 1
v_cndmask_b32 v5, 0, v242, vcc
v_cmp_eq_u32 vcc, 2, v243
s_nop 1
v_cndmask_b32 v6, 0, v242, vcc
v_cmp_eq_u32 vcc, 3, v243
s_nop 1
v_cndmask_b32 v7, 0, v242, vcc
v_mov_b32 v8, 0
s_lshr_b32 s35, s32, 4
s_lshr_b32 s36, s34, 1
s_and_b32 s37, s34, 1
s_lshr_b32 s60, s32, 0
s_lshl_b32 s60, s60, 19
s_mov_b32 s61, 0x80000
s_add_u32 s40, s16, s60
s_addc_u32 s41, s17, 0
s_and_b32 s41, s41, 0xffff
s_mov_b32 s42, s61
s_mov_b32 s43, 0x20000
v_lshrrev_b32 v242, 1, v3
v_lshlrev_b32 v242, 9, v242
v_lshl_add_u32 v242, v2, 5, v242
v_and_b32 v243, 1, v3
v_lshl_add_u32 v242, v243, 4, v242
s_lshl_b32 s63, s34, 10
v_add_u32 v242, s63, v242
v_add_u32 v242, 140288, v242
v_lshlrev_b32 v243, 4, v1
s_lshl_b32 s62, s32, 10
s_add_u32 s62, s62, 0x18000
v_add_u32 v244, s62, v243
v_add_u32 v243, 140288, v243
s_waitcnt vmcnt(16) lgkmcnt(0)
s_add_u32 s58, s58, 0x9e3779b9
s_bfe_u32 s76, s58, 0x80000
s_bfe_u32 s77, s58, 0x80008
s_bfe_u32 s78, s58, 0x80010
s_bfe_u32 s79, s58, 0x80018
v_mov_b32 v245, s58
s_mov_b32 s60, 0x01000100
v_perm_b32 v240, v32, v32, s60
v_and_b32 v40, v240, v4
v_and_b32 v41, v240, v5
v_and_b32 v42, v240, v6
v_and_b32 v43, v240, v7
s_waitcnt vmcnt(15)
s_nop 0
v_mfma_f32_16x16x32_bf16 v[48:51], v[40:43], v[128:131], 0
s_mov_b32 s60, 0x03020302
v_perm_b32 v241, v32, v32, s60
v_and_b32 v44, v241, v4
v_and_b32 v45, v241, v5
v_and_b32 v46, v241, v6
v_and_b32 v47, v241, v7
s_waitcnt vmcnt(14)
s_nop 0
v_mfma_f32_16x16x32_bf16 v[48:51], v[44:47], v[132:135], v[48:51]
s_mov_b32 s60, 0x01000100
v_perm_b32 v240, v33, v33, s60
v_and_b32 v40, v240, v4
v_and_b32 v41, v240, v5
v_and_b32 v42, v240, v6
v_and_b32 v43, v240, v7
s_waitcnt vmcnt(13)
s_nop 0
v_mfma_f32_16x16x32_bf16 v[48:51], v[40:43], v[136:139], v[48:51]
s_mov_b32 s60, 0x03020302
v_perm_b32 v241, v33, v33, s60
v_and_b32 v44, v241, v4
v_and_b32 v45, v241, v5
v_and_b32 v46, v241, v6
v_and_b32 v47, v241, v7
s_waitcnt vmcnt(12)
s_nop 0
v_mfma_f32_16x16x32_bf16 v[48:51], v[44:47], v[140:143], v[48:51]
s_mov_b32 s60, 0x01000100
v_perm_b32 v240, v34, v34, s60
v_and_b32 v40, v240, v4
v_and_b32 v41, v240, v5
v_and_b32 v42, v240, v6
v_and_b32 v43, v240, v7
s_waitcnt vmcnt(11)
s_nop 0
v_mfma_f32_16x16x32_bf16 v[48:51], v[40:43], v[144:147], v[48:51]
s_mov_b32 s60, 0x03020302
v_perm_b32 v241, v34, v34, s60
v_and_b32 v44, v241, v4
v_and_b32 v45, v241, v5
v_and_b32 v46, v241, v6
v_and_b32 v47, v241, v7
s_waitcnt vmcnt(10)
s_nop 0
v_mfma_f32_16x16x32_bf16 v[48:51], v[44:47], v[148:151], v[48:51]
s_mov_b32 s60, 0x01000100
v_perm_b32 v240, v35, v35, s60
v_and_b32 v40, v240, v4
v_and_b32 v41, v240, v5
v_and_b32 v42, v240, v6
v_and_b32 v43, v240, v7
s_waitcnt vmcnt(9)
s_nop 0
v_mfma_f32_16x16x32_bf16 v[48:51], v[40:43], v[152:155], v[48:51]
s_mov_b32 s60, 0x03020302
v_perm_b32 v241, v35, v35, s60
v_and_b32 v44, v241, v4
v_and_b32 v45, v241, v5
v_and_b32 v46, v241, v6
v_and_b32 v47, v241, v7
s_waitcnt vmcnt(8)
s_nop 0
v_mfma_f32_16x16x32_bf16 v[48:51], v[44:47], v[156:159], v[48:51]
s_mov_b32 s60, 0x01000100
v_perm_b32 v240, v36, v36, s60
v_and_b32 v40, v240, v4
v_and_b32 v41, v240, v5
v_and_b32 v42, v240, v6
v_and_b32 v43, v240, v7
s_waitcnt vmcnt(7)
s_nop 0
v_mfma_f32_16x16x32_bf16 v[48:51], v[40:43], v[160:163], v[48:51]
s_mov_b32 s60, 0x03020302
v_perm_b32 v241, v36, v36, s60
v_and_b32 v44, v241, v4
v_and_b32 v45, v241, v5
v_and_b32 v46, v241, v6
v_and_b32 v47, v241, v7
s_waitcnt vmcnt(6)
s_nop 0
v_mfma_f32_16x16x32_bf16 v[48:51], v[44:47], v[164:167], v[48:51]
s_mov_b32 s60, 0x01000100
v_perm_b32 v240, v37, v37, s60
v_and_b32 v40, v240, v4
v_and_b32 v41, v240, v5
v_and_b32 v42, v240, v6
v_and_b32 v43, v240, v7
s_waitcnt vmcnt(5)
s_nop 0
v_mfma_f32_16x16x32_bf16 v[48:51], v[40:43], v[168:171], v[48:51]
s_mov_b32 s60, 0x03020302
v_perm_b32 v241, v37, v37, s60
v_and_b32 v44, v241, v4
v_and_b32 v45, v241, v5
v_and_b32 v46, v241, v6
v_and_b32 v47, v241, v7
s_waitcnt vmcnt(4)
s_nop 0
v_mfma_f32_16x16x32_bf16 v[48:51], v[44:47], v[172:175], v[48:51]
s_mov_b32 s60, 0x01000100
v_perm_b32 v240, v38, v38, s60
v_and_b32 v40, v240, v4
v_and_b32 v41, v240, v5
v_and_b32 v42, v240, v6
v_and_b32 v43, v240, v7
s_waitcnt vmcnt(3)
s_nop 0
v_mfma_f32_16x16x32_bf16 v[48:51], v[40:43], v[176:179], v[48:51]
s_mov_b32 s60, 0x03020302
v_perm_b32 v241, v38, v38, s60
v_and_b32 v44, v241, v4
v_and_b32 v45, v241, v5
v_and_b32 v46, v241, v6
v_and_b32 v47, v241, v7
s_waitcnt vmcnt(2)
s_nop 0
v_mfma_f32_16x16x32_bf16 v[48:51], v[44:47], v[180:183], v[48:51]
s_mov_b32 s60, 0x01000100
v_perm_b32 v240, v39, v39, s60
v_and_b32 v40, v240, v4
v_and_b32 v41, v240, v5
v_and_b32 v42, v240, v6
v_and_b32 v43, v240, v7
s_waitcnt vmcnt(1)
s_nop 0
v_mfma_f32_16x16x32_bf16 v[48:51], v[40:43], v[184:187], v[48:51]
s_mov_b32 s60, 0x03020302
v_perm_b32 v241, v39, v39, s60
v_and_b32 v44, v241, v4
v_and_b32 v45, v241, v5
v_and_b32 v46, v241, v6
v_and_b32 v47, v241, v7
s_waitcnt vmcnt(0)
s_nop 0
v_mfma_f32_16x16x32_bf16 v[48:51], v[44:47], v[188:191], v[48:51]
s_nop 7
ds_write_b128 v242, v[48:51]
s_waitcnt lgkmcnt(0)
s_barrier
s_cmp_lg_u32 s34, 0
s_cbranch_scc1 L_C_qs
ds_read_b128 v[128:131], v243 offset:0
ds_read_b128 v[132:135], v243 offset:1024
ds_read_b128 v[136:139], v243 offset:2048
ds_read_b128 v[140:143], v243 offset:3072
ds_read_b128 v[144:147], v243 offset:4096
ds_read_b128 v[148:151], v243 offset:5120
ds_read_b128 v[152:155], v243 offset:6144
ds_read_b128 v[156:159], v243 offset:7168
s_mov_b32 s60, 0x05040100
s_mov_b32 s61, 0x07060302
s_waitcnt lgkmcnt(6)
v_add_f32 v128, v128, v132
v_add_f32 v129, v129, v133
v_add_f32 v130, v130, v134
v_add_f32 v131, v131, v135
s_waitcnt lgkmcnt(5)
v_add_f32 v128, v128, v136
v_add_f32 v129, v129, v137
v_add_f32 v130, v130, v138
v_add_f32 v131, v131, v139
s_waitcnt lgkmcnt(4)
v_add_f32 v128, v128, v140
v_add_f32 v129, v129, v141
v_add_f32 v130, v130, v142
v_add_f32 v131, v131, v143
s_waitcnt lgkmcnt(3)
v_add_f32 v128, v128, v144
v_add_f32 v129, v129, v145
v_add_f32 v130, v130, v146
v_add_f32 v131, v131, v147
s_waitcnt lgkmcnt(2)
v_add_f32 v128, v128, v148
v_add_f32 v129, v129, v149
v_add_f32 v130, v130, v150
v_add_f32 v131, v131, v151
s_waitcnt lgkmcnt(1)
v_add_f32 v128, v128, v152
v_add_f32 v129, v129, v153
v_add_f32 v130, v130, v154
v_add_f32 v131, v131, v155
s_waitcnt lgkmcnt(0)
v_add_f32 v128, v128, v156
v_add_f32 v129, v129, v157
v_add_f32 v130, v130, v158
v_add_f32 v131, v131, v159
v_cvt_pk_bf16_f32 v128, v128, v129
v_cvt_pk_bf16_f32 v129, v130, v131
v_perm_b32 v132, v128, v245, s60
v_perm_b32 v133, v128, v245, s61
v_perm_b32 v134, v129, v245, s60
v_perm_b32 v135, v129, v245, s61
buffer_store_dwordx4 v[132:135], v244, s[44:47], 0 offen sc1
L_C_qs:
v_lshlrev_b32 v9, 4, v1
s_mul_i32 s62, s34, 4096
v_add_u32 v9, s62, v9
s_mul_i32 s38, s34, 4224
s_and_b32 s54, s32, 3
s_lshl_b32 s54, s54, 17
s_mov_b32 s53, 0
s_lshl_b32 s60, s32, 17
s_mov_b32 s61, 0x20000
s_add_u32 s68, s12, s60
s_addc_u32 s69, s13, 0
s_and_b32 s69, s69, 0xffff
s_mov_b32 s70, s61
s_mov_b32 s71, 0x20000
s_add_u32 s50, s38, 5120
s_cmp_lt_u32 s53, 0x80000
s_cselect_b32 s40, s40, s68
s_cselect_b32 s41, s41, s69
s_cselect_b32 s42, s42, s70
s_cselect_b32 s54, s54, 0
s_and_b32 s49, s53, 0x70000
s_xor_b32 s49, s49, s54
s_add_u32 s51, s49, 32768
s_add_u32 s53, s53, 0x10000
s_add_u32 m0, s50, 0
s_nop 0
buffer_load_dwordx4 v9, s[40:43], s49 offen offset:0 nt lds
s_add_u32 m0, s50, 32
s_nop 0
buffer_load_dwordx4 v9, s[40:43], s49 offen offset:1024 nt lds
s_add_u32 m0, s50, 64
s_nop 0
buffer_load_dwordx4 v9, s[40:43], s49 offen offset:2048 nt lds
s_add_u32 m0, s50, 96
s_nop 0
buffer_load_dwordx4 v9, s[40:43], s49 offen offset:3072 nt lds
s_add_u32 m0, s50, 33792
s_nop 0
buffer_load_dwordx4 v9, s[40:43], s51 offen offset:0 nt lds
s_add_u32 m0, s50, 33824
s_nop 0
buffer_load_dwordx4 v9, s[40:43], s51 offen offset:1024 nt lds
s_add_u32 m0, s50, 33856
s_nop 0
buffer_load_dwordx4 v9, s[40:43], s51 offen offset:2048 nt lds
s_add_u32 m0, s50, 33888
s_nop 0
buffer_load_dwordx4 v9, s[40:43], s51 offen offset:3072 nt lds
s_add_u32 s50, s38, 72704
s_cmp_lt_u32 s53, 0x80000
s_cselect_b32 s40, s40, s68
s_cselect_b32 s41, s41, s69
s_cselect_b32 s42, s42, s70
s_cselect_b32 s54, s54, 0
s_and_b32 s49, s53, 0x70000
s_xor_b32 s49, s49, s54
s_add_u32 s51, s49, 32768
s_add_u32 s53, s53, 0x10000
s_add_u32 m0, s50, 0
s_nop 0
buffer_load_dwordx4 v9, s[40:43], s49 offen offset:0 nt lds
s_add_u32 m0, s50, 32
s_nop 0
buffer_load_dwordx4 v9, s[40:43], s49 offen offset:1024 nt lds
s_add_u32 m0, s50, 64
s_nop 0
buffer_load_dwordx4 v9, s[40:43], s49 offen offset:2048 nt lds
s_add_u32 m0, s50, 96
s_nop 0
buffer_load_dwordx4 v9, s[40:43], s49 offen offset:3072 nt lds
s_add_u32 m0, s50, 33792
s_nop 0
buffer_load_dwordx4 v9, s[40:43], s51 offen offset:0 nt lds
s_add_u32 m0, s50, 33824
s_nop 0
buffer_load_dwordx4 v9, s[40:43], s51 offen offset:1024 nt lds
s_add_u32 m0, s50, 33856
s_nop 0
buffer_load_dwordx4 v9, s[40:43], s51 offen offset:2048 nt lds
s_add_u32 m0, s50, 33888
s_nop 0
buffer_load_dwordx4 v9, s[40:43], s51 offen offset:3072 nt lds
s_cmp_lt_u32 s53, 0x80000
s_cselect_b32 s40, s40, s68
s_cselect_b32 s41, s41, s69
s_cselect_b32 s42, s42, s70
s_cselect_b32 s54, s54, 0
s_and_b32 s49, s53, 0x70000
s_xor_b32 s49, s49, s54
s_add_u32 s51, s49, 32768
s_add_u32 s53, s53, 0x10000
buffer_load_dwordx4 v[208:211], v9, s[40:43], s49 offen offset:0 nt
buffer_load_dwordx4 v[212:215], v9, s[40:43], s49 offen offset:1024 nt
buffer_load_dwordx4 v[216:219], v9, s[40:43], s49 offen offset:2048 nt
buffer_load_dwordx4 v[220:223], v9, s[40:43], s49 offen offset:3072 nt
buffer_load_dwordx4 v[224:227], v9, s[40:43], s51 offen offset:0 nt
buffer_load_dwordx4 v[228:231], v9, s[40:43], s51 offen offset:1024 nt
buffer_load_dwordx4 v[232:235], v9, s[40:43], s51 offen offset:2048 nt
buffer_load_dwordx4 v[236:239], v9, s[40:43], s51 offen offset:3072 nt
s_add_u32 s62, s38, 5120
v_lshl_add_u32 v22, v1, 4, s62
s_lshl_b32 s62, s36, 4
v_add_u32 v240, s62, v2
v_mul_u32_u24 v10, 1056, v240
v_lshl_add_u32 v10, v3, 4, v10
v_add_u32 v10, 5120, v10
v_lshrrev_b32 v240, 1, v3
v_lshlrev_b32 v240, 3, v240
v_lshrrev_b32 v241, 2, v2
v_add_u32 v240, v240, v241
v_mul_u32_u24 v11, 1056, v240
v_and_b32 v240, 1, v3
v_lshl_add_u32 v11, v240, 5, v11
v_and_b32 v240, 3, v2
v_lshl_add_u32 v11, v240, 3, v11
s_lshl_b32 s62, s34, 7
s_add_u32 s62, s62, 5120
v_add_u32 v11, s62, v11
s_lshl_b32 s62, s37, 4
v_add_u32 v240, s62, v2
v_mul_u32_u24 v12, 144, v240
v_lshl_add_u32 v12, v3, 3, v12
s_lshl_b32 s62, s36, 5
v_add_u32 v12, s62, v12
v_lshlrev_b32 v15, 4, v240
s_lshl_b32 s62, s36, 2
v_add_u32 v14, s62, v15
v_and_b32 v240, 31, v1
v_mul_u32_u24 v13, 144, v240
v_lshrrev_b32 v241, 5, v1
v_lshl_add_u32 v13, v241, 4, v13
v_lshlrev_b32 v16, 4, v240
v_mov_b32 v17, 0x3e0293ee
v_mov_b32 v18, 0xff800000
v_mov_b32 v19, 0xff800000
v_mov_b32 v20, 0
v_mov_b32 v96, 0
v_mov_b32 v97, 0
v_mov_b32 v98, 0
v_mov_b32 v99, 0
v_mov_b32 v100, 0
v_mov_b32 v101, 0
v_mov_b32 v102, 0
v_mov_b32 v103, 0
v_mov_b32 v104, 0
v_mov_b32 v105, 0
v_mov_b32 v106, 0
v_mov_b32 v107, 0
v_mov_b32 v108, 0
v_mov_b32 v109, 0
v_mov_b32 v110, 0
v_mov_b32 v111, 0
v_mov_b32 v112, 0
v_mov_b32 v113, 0
v_mov_b32 v114, 0
v_mov_b32 v115, 0
v_mov_b32 v116, 0
v_mov_b32 v117, 0
v_mov_b32 v118, 0
v_mov_b32 v119, 0
v_mov_b32 v120, 0
v_mov_b32 v121, 0
v_mov_b32 v122, 0
v_mov_b32 v123, 0
v_mov_b32 v124, 0
v_mov_b32 v125, 0
v_mov_b32 v126, 0
v_mov_b32 v127, 0
v_lshrrev_b32 v240, 5, v1
s_lshl_b32 s62, s34, 2
v_add_u32 v240, s62, v240
v_and_b32 v241, 31, v1
v_lshlrev_b32 v241, 4, v241
v_lshl_add_u32 v242, v240, 10, v241
s_lshl_b32 s62, s35, 15
s_add_u32 s62, s62, 0x0
v_add_u32 v242, s62, v242
v_mul_u32_u24 v243, 528, v240
v_add_u32 v243, v243, v241
v_add_u32 v243, 140288, v243
s_lshl_b32 s62, s37, 4
v_add_u32 v240, s62, v2
v_mul_u32_u24 v244, 528, v240
v_lshl_add_u32 v244, v3, 4, v244
v_add_u32 v244, 140288, v244
v_lshlrev_b32 v240, 7, v1
v_add_u32 v240, 0x15000, v240
s_cmp_lg_u32 s34, 0
s_cbranch_scc1 L_wf_Cq
s_lshl_b64 exec, 1, s32
s_mov_b32 s64, 0
L_pl_Cq1:
buffer_load_dword v241, v240, s[44:47], 0 offen sc1
s_add_u32 s64, s64, 1
s_waitcnt vmcnt(0)
v_cmp_ne_u32 vcc, s58, v241
s_nop 0
s_cmp_eq_u64 vcc, 0
s_cbranch_scc1 L_pd_Cq1
s_mov_b64 exec, vcc
s_sleep 2
s_cmp_lt_u32 s64, 65536
s_cbranch_scc1 L_pl_Cq1
L_pd_Cq1:
s_mov_b32 exec_lo, -1
s_mov_b32 exec_hi, 0
s_mov_b32 s64, 0
L_pl_Cq2:
buffer_load_dword v241, v240, s[44:47], 0 offen sc1
s_add_u32 s64, s64, 1
s_waitcnt vmcnt(0)
v_cmp_ne_u32 vcc, s58, v241
s_nop 0
s_cmp_eq_u64 vcc, 0
s_cbranch_scc1 L_pd_Cq2
s_mov_b64 exec, vcc
s_cmp_lt_u32 s64, 65536
s_cbranch_scc1 L_pl_Cq2
L_pd_Cq2:
s_mov_b64 exec, -1
L_wf_Cq:
s_barrier
buffer_load_dwordx4 v[128:131], v242, s[44:47], 0 offen offset:0 sc1
buffer_load_dwordx4 v[132:135], v242, s[44:47], 0 offen offset:2048 sc1
buffer_load_dwordx4 v[136:139], v242, s[44:47], 0 offen offset:512 sc1
buffer_load_dwordx4 v[140:143], v242, s[44:47], 0 offen offset:2560 sc1
s_waitcnt vmcnt(2)
ds_write_b128 v243, v[128:131] offset:0
ds_write_b128 v243, v[132:135] offset:1056
s_waitcnt lgkmcnt(0)
s_barrier
ds_read_b128 v[32:35], v244 offset:0
ds_read_b128 v[36:39], v244 offset:64
ds_read_b128 v[40:43], v244 offset:128
ds_read_b128 v[44:47], v244 offset:192
ds_read_b128 v[48:51], v244 offset:256
ds_read_b128 v[52:55], v244 offset:320
ds_read_b128 v[56:59], v244 offset:384
ds_read_b128 v[60:63], v244 offset:448
s_waitcnt vmcnt(0)
s_waitcnt lgkmcnt(0)
s_barrier
ds_write_b128 v243, v[136:139] offset:0
ds_write_b128 v243, v[140:143] offset:1056
s_waitcnt lgkmcnt(0)
s_barrier
ds_read_b128 v[64:67], v244 offset:0
ds_read_b128 v[68:71], v244 offset:64
ds_read_b128 v[72:75], v244 offset:128
ds_read_b128 v[76:79], v244 offset:192
ds_read_b128 v[80:83], v244 offset:256
ds_read_b128 v[84:87], v244 offset:320
ds_read_b128 v[88:91], v244 offset:384
ds_read_b128 v[92:95], v244 offset:448
s_mov_b32 s39, 0
s_mov_b32 s48, 0
s_waitcnt vmcnt(0)
.p2align 6
L_C_loop:
s_waitcnt lgkmcnt(0)
s_barrier
s_mov_b32 s52, 1
s_cmp_eq_u32 s39, 0
s_cselect_b32 s52, 0, s52
s_sub_u32 s50, 67584, s48
v_add_u32 v23, s50, v22
s_cmp_eq_u32 s52, 0
s_cbranch_scc1 L_C_st0
s_cmp_lt_u32 s53, 0x80000
s_cselect_b32 s40, s40, s68
s_cselect_b32 s41, s41, s69
s_cselect_b32 s42, s42, s70
s_cselect_b32 s54, s54, 0
s_and_b32 s49, s53, 0x70000
s_xor_b32 s49, s49, s54
s_add_u32 s51, s49, 32768
s_add_u32 s53, s53, 0x10000
s_waitcnt vmcnt(7)
ds_write_b128 v23, v[208:211] offset:0
buffer_load_dwordx4 v[208:211], v9, s[40:43], s49 offen offset:0 nt
s_waitcnt vmcnt(7)
ds_write_b128 v23, v[212:215] offset:1056
buffer_load_dwordx4 v[212:215], v9, s[40:43], s49 offen offset:1024 nt
s_waitcnt vmcnt(7)
ds_write_b128 v23, v[216:219] offset:2112
buffer_load_dwordx4 v[216:219], v9, s[40:43], s49 offen offset:2048 nt
s_waitcnt vmcnt(7)
ds_write_b128 v23, v[220:223] offset:3168
buffer_load_dwordx4 v[220:223], v9, s[40:43], s49 offen offset:3072 nt
s_waitcnt vmcnt(7)
ds_write_b128 v23, v[224:227] offset:33792
buffer_load_dwordx4 v[224:227], v9, s[40:43], s51 offen offset:0 nt
s_waitcnt vmcnt(7)
ds_write_b128 v23, v[228:231] offset:34848
buffer_load_dwordx4 v[228:231], v9, s[40:43], s51 offen offset:1024 nt
s_waitcnt vmcnt(7)
ds_write_b128 v23, v[232:235] offset:35904
buffer_load_dwordx4 v[232:235], v9, s[40:43], s51 offen offset:2048 nt
s_waitcnt vmcnt(7)
ds_write_b128 v23, v[236:239] offset:36960
buffer_load_dwordx4 v[236:239], v9, s[40:43], s51 offen offset:3072 nt
L_C_st0:
v_add_u32 v240, s48, v10
v_add_u32 v241, s48, v11
ds_read_b128 v[128:131], v240 offset:0
ds_read_b128 v[132:135], v240 offset:64
ds_read_b128 v[136:139], v240 offset:128
ds_read_b128 v[140:143], v240 offset:192
ds_read_b128 v[144:147], v240 offset:256
ds_read_b128 v[148:151], v240 offset:320
ds_read_b128 v[152:155], v240 offset:384
ds_read_b128 v[156:159], v240 offset:448
ds_read_b128 v[160:163], v240 offset:512
ds_read_b128 v[164:167], v240 offset:576
ds_read_b128 v[168:171], v240 offset:640
ds_read_b128 v[172:175], v240 offset:704
ds_read_b128 v[176:179], v240 offset:768
ds_read_b128 v[180:183], v240 offset:832
ds_read_b128 v[184:187], v240 offset:896
ds_read_b128 v[188:191], v240 offset:960
s_waitcnt lgkmcnt(15)
v_mfma_f32_16x16x32_bf16 v[28:31], v[128:131], v[32:35], 0
s_waitcnt lgkmcnt(14)
v_mfma_f32_16x16x32_bf16 v[28:31], v[132:135], v[36:39], v[28:31]
s_waitcnt lgkmcnt(13)
v_mfma_f32_16x16x32_bf16 v[28:31], v[136:139], v[40:43], v[28:31]
s_waitcnt lgkmcnt(12)
v_mfma_f32_16x16x32_bf16 v[28:31], v[140:143], v[44:47], v[28:31]
s_waitcnt lgkmcnt(11)
v_mfma_f32_16x16x32_bf16 v[28:31], v[144:147], v[48:51], v[28:31]
s_waitcnt lgkmcnt(10)
v_mfma_f32_16x16x32_bf16 v[28:31], v[148:151], v[52:55], v[28:31]
s_waitcnt lgkmcnt(9)
v_mfma_f32_16x16x32_bf16 v[28:31], v[152:155], v[56:59], v[28:31]
s_waitcnt lgkmcnt(8)
v_mfma_f32_16x16x32_bf16 v[28:31], v[156:159], v[60:63], v[28:31]
s_waitcnt lgkmcnt(7)
v_mfma_f32_16x16x32_bf16 v[28:31], v[160:163], v[64:67], v[28:31]
s_waitcnt lgkmcnt(6)
v_mfma_f32_16x16x32_bf16 v[28:31], v[164:167], v[68:71], v[28:31]
s_waitcnt lgkmcnt(5)
v_mfma_f32_16x16x32_bf16 v[28:31], v[168:171], v[72:75], v[28:31]
s_waitcnt lgkmcnt(4)
v_mfma_f32_16x16x32_bf16 v[28:31], v[172:175], v[76:79], v[28:31]
s_waitcnt lgkmcnt(3)
v_mfma_f32_16x16x32_bf16 v[28:31], v[176:179], v[80:83], v[28:31]
s_waitcnt lgkmcnt(2)
v_mfma_f32_16x16x32_bf16 v[28:31], v[180:183], v[84:87], v[28:31]
s_waitcnt lgkmcnt(1)
v_mfma_f32_16x16x32_bf16 v[28:31], v[184:187], v[88:91], v[28:31]
s_waitcnt lgkmcnt(0)
v_mfma_f32_16x16x32_bf16 v[28:31], v[188:191], v[92:95], v[28:31]
s_nop 7
v_mul_f32 v24, v28, v17
v_mul_f32 v25, v29, v17
v_mul_f32 v26, v30, v17
v_mul_f32 v27, v31, v17
v_max3_f32 v242, v24, v25, v26
v_max_f32 v242, v242, v27
v_mov_b32 v243, v242
s_nop 1
v_permlane16_swap_b32 v242, v243
s_nop 0
v_max_f32 v242, v242, v243
v_mov_b32 v243, v242
s_nop 1
v_permlane32_swap_b32 v242, v243
s_nop 0
v_max_f32 v242, v242, v243
s_mov_b64 exec, 0xffff
ds_write_b32 v14, v242 offset:0
s_mov_b64 exec, -1
s_waitcnt lgkmcnt(0)
s_barrier
ds_read_b128 v[192:195], v15 offset:0
ds_read_b128 v[196:199], v16 offset:0
s_waitcnt lgkmcnt(1)
v_max3_f32 v242, v192, v193, v194
v_max3_f32 v242, v242, v195, v18
v_sub_f32 v21, v18, v242
v_sub_f32 v24, v24, v242
v_sub_f32 v25, v25, v242
v_sub_f32 v26, v26, v242
v_sub_f32 v27, v27, v242
v_exp_f32 v21, v21
v_exp_f32 v24, v24
v_exp_f32 v25, v25
v_exp_f32 v26, v26
v_exp_f32 v27, v27
v_mov_b32 v18, v242
v_cvt_pk_bf16_f32 v244, v24, v25
v_cvt_pk_bf16_f32 v245, v26, v27
ds_write_b64 v12, v[244:245] offset:512
v_add_f32 v24, v24, v25
v_add_f32 v26, v26, v27
v_fma_f32 v20, v20, v21, v24
v_add_f32 v20, v20, v26
s_waitcnt lgkmcnt(1)
v_max3_f32 v242, v196, v197, v198
v_max3_f32 v242, v242, v199, v19
v_sub_f32 v21, v19, v242
v_exp_f32 v21, v21
v_mov_b32 v19, v242
v_mul_f32 v96, v96, v21
v_mul_f32 v97, v97, v21
v_mul_f32 v98, v98, v21
v_mul_f32 v99, v99, v21
v_mul_f32 v100, v100, v21
v_mul_f32 v101, v101, v21
v_mul_f32 v102, v102, v21
v_mul_f32 v103, v103, v21
v_mul_f32 v104, v104, v21
v_mul_f32 v105, v105, v21
v_mul_f32 v106, v106, v21
v_mul_f32 v107, v107, v21
v_mul_f32 v108, v108, v21
v_mul_f32 v109, v109, v21
v_mul_f32 v110, v110, v21
v_mul_f32 v111, v111, v21
v_mul_f32 v112, v112, v21
v_mul_f32 v113, v113, v21
v_mul_f32 v114, v114, v21
v_mul_f32 v115, v115, v21
v_mul_f32 v116, v116, v21
v_mul_f32 v117, v117, v21
v_mul_f32 v118, v118, v21
v_mul_f32 v119, v119, v21
v_mul_f32 v120, v120, v21
v_mul_f32 v121, v121, v21
v_mul_f32 v122, v122, v21
v_mul_f32 v123, v123, v21
v_mul_f32 v124, v124, v21
v_mul_f32 v125, v125, v21
v_mul_f32 v126, v126, v21
v_mul_f32 v127, v127, v21
s_waitcnt lgkmcnt(0)
s_barrier
ds_read_b128 v[192:195], v13 offset:512
ds_read_b128 v[196:199], v13 offset:544
ds_read_b128 v[200:203], v13 offset:576
ds_read_b128 v[204:207], v13 offset:608
ds_read_b64_tr_b16 v[128:129], v241 offset:0
ds_read_b64_tr_b16 v[130:131], v241 offset:4224
ds_read_b64_tr_b16 v[132:133], v241 offset:64
ds_read_b64_tr_b16 v[134:135], v241 offset:4288
ds_read_b64_tr_b16 v[136:137], v241 offset:16896
ds_read_b64_tr_b16 v[138:139], v241 offset:21120
ds_read_b64_tr_b16 v[140:141], v241 offset:16960
ds_read_b64_tr_b16 v[142:143], v241 offset:21184
ds_read_b64_tr_b16 v[144:145], v241 offset:33792
ds_read_b64_tr_b16 v[146:147], v241 offset:38016
ds_read_b64_tr_b16 v[148:149], v241 offset:33856
ds_read_b64_tr_b16 v[150:151], v241 offset:38080
ds_read_b64_tr_b16 v[152:153], v241 offset:50688
ds_read_b64_tr_b16 v[154:155], v241 offset:54912
ds_read_b64_tr_b16 v[156:157], v241 offset:50752
ds_read_b64_tr_b16 v[158:159], v241 offset:54976
s_waitcnt lgkmcnt(12)
v_mfma_f32_32x32x16_bf16 v[96:111], v[128:131], v[192:195], v[96:111]
v_mfma_f32_32x32x16_bf16 v[112:127], v[132:135], v[192:195], v[112:127]
s_waitcnt lgkmcnt(8)
v_mfma_f32_32x32x16_bf16 v[96:111], v[136:139], v[196:199], v[96:111]
v_mfma_f32_32x32x16_bf16 v[112:127], v[140:143], v[196:199], v[112:127]
s_waitcnt lgkmcnt(4)
v_mfma_f32_32x32x16_bf16 v[96:111], v[144:147], v[200:203], v[96:111]
v_mfma_f32_32x32x16_bf16 v[112:127], v[148:151], v[200:203], v[112:127]
s_waitcnt lgkmcnt(0)
v_mfma_f32_32x32x16_bf16 v[96:111], v[152:155], v[204:207], v[96:111]
v_mfma_f32_32x32x16_bf16 v[112:127], v[156:159], v[204:207], v[112:127]
s_sub_u32 s48, 67584, s48
s_add_u32 s39, s39, 1
s_cmp_lt_u32 s39, 8
s_cbranch_scc1 L_C_loop
v_mov_b32 v243, v20
s_nop 1
v_permlane16_swap_b32 v20, v243
s_nop 0
v_add_f32 v20, v20, v243
v_mov_b32 v243, v20
s_nop 1
v_permlane32_swap_b32 v20, v243
s_nop 0
v_add_f32 v20, v20, v243
s_barrier
s_mov_b64 exec, 0xffff
ds_write_b32 v14, v20 offset:0
s_mov_b64 exec, -1
v_and_b32 v240, 31, v1
v_mul_u32_u24 v240, 2064, v240
v_lshrrev_b32 v241, 5, v1
v_lshl_add_u32 v240, v241, 4, v240
s_lshl_b32 s62, s34, 8
s_add_u32 s62, s62, 72704
v_add_u32 v240, s62, v240
s_nop 5
ds_write_b128 v240, v[96:99] offset:0
ds_write_b128 v240, v[100:103] offset:32
ds_write_b128 v240, v[104:107] offset:64
ds_write_b128 v240, v[108:111] offset:96
ds_write_b128 v240, v[112:115] offset:128
ds_write_b128 v240, v[116:119] offset:160
ds_write_b128 v240, v[120:123] offset:192
ds_write_b128 v240, v[124:127] offset:224
s_waitcnt lgkmcnt(0)
s_barrier
s_mul_i32 s62, s34, 8256
s_add_u32 s62, s62, 72704
v_lshl_add_u32 v240, v1, 5, s62
ds_read_b128 v[128:131], v240 offset:0
ds_read_b128 v[132:135], v240 offset:16
ds_read_b128 v[136:139], v240 offset:2064
ds_read_b128 v[140:143], v240 offset:2080
ds_read_b128 v[144:147], v240 offset:4128
ds_read_b128 v[148:151], v240 offset:4144
ds_read_b128 v[152:155], v240 offset:6192
ds_read_b128 v[156:159], v240 offset:6208
ds_read_b128 v[192:195], v16 offset:0
s_lshl_b32 s62, s35, 5
s_lshl_b32 s63, s34, 2
s_add_u32 s62, s62, s63
s_lshl_b32 s62, s62, 4
s_and_b32 s63, s32, 15
s_add_u32 s62, s62, s63
s_lshl_b32 s62, s62, 10
s_add_u32 s62, s62, 0x200000
v_lshl_add_u32 v17, v1, 4, s62
s_lshl_b32 s63, s32, 9
s_add_u32 s63, s63, 0x10000
v_lshl_add_u32 v18, v1, 4, s63
v_mov_b32 v241, 0xffff0000
s_waitcnt lgkmcnt(0)
v_add_f32 v192, v192, v193
v_add_f32 v194, v194, v195
v_add_f32 v196, v192, v194
v_and_or_b32 v200, v19, v241, s76
v_lshl_or_b32 v201, v19, 16, s77
v_and_or_b32 v202, v196, v241, s78
v_lshl_or_b32 v203, v196, 16, s79
s_waitcnt vmcnt(0)
s_barrier
L_C_tail:
v_add_u32 v23, 67584, v22
ds_write_b128 v23, v[208:211] offset:0
ds_write_b128 v23, v[212:215] offset:1056
ds_write_b128 v23, v[216:219] offset:2112
ds_write_b128 v23, v[220:223] offset:3168
ds_write_b128 v23, v[224:227] offset:33792
ds_write_b128 v23, v[228:231] offset:34848
ds_write_b128 v23, v[232:235] offset:35904
ds_write_b128 v23, v[236:239] offset:36960
v_lshrrev_b32 v240, 2, v2
v_lshl_add_u32 v240, v3, 3, v240
v_mul_u32_u24 v240, 1056, v240
v_and_b32 v241, 3, v2
v_lshl_add_u32 v240, v241, 3, v240
s_lshl_b32 s62, s34, 7
s_add_u32 s62, s62, 5120
v_add_u32 v240, s62, v240
s_waitcnt lgkmcnt(0)
v_cvt_pk_bf16_f32 v224, v128, v129
v_cvt_pk_bf16_f32 v225, v130, v131
v_cvt_pk_bf16_f32 v226, v132, v133
v_cvt_pk_bf16_f32 v227, v134, v135
v_cvt_pk_bf16_f32 v228, v136, v137
v_cvt_pk_bf16_f32 v229, v138, v139
v_cvt_pk_bf16_f32 v230, v140, v141
v_cvt_pk_bf16_f32 v231, v142, v143
v_cvt_pk_bf16_f32 v232, v144, v145
v_cvt_pk_bf16_f32 v233, v146, v147
v_cvt_pk_bf16_f32 v234, v148, v149
v_cvt_pk_bf16_f32 v235, v150, v151
v_cvt_pk_bf16_f32 v236, v152, v153
v_cvt_pk_bf16_f32 v237, v154, v155
v_cvt_pk_bf16_f32 v238, v156, v157
v_cvt_pk_bf16_f32 v239, v158, v159
s_barrier
ds_read_b64_tr_b16 v[32:33], v240 offset:0
ds_read_b64_tr_b16 v[34:35], v240 offset:4224
ds_read_b64_tr_b16 v[36:37], v240 offset:32
ds_read_b64_tr_b16 v[38:39], v240 offset:4256
ds_read_b64_tr_b16 v[40:41], v240 offset:64
ds_read_b64_tr_b16 v[42:43], v240 offset:4288
ds_read_b64_tr_b16 v[44:45], v240 offset:96
ds_read_b64_tr_b16 v[46:47], v240 offset:4320
s_waitcnt lgkmcnt(0)
v_add_u32 v240, 33792, v240
ds_read_b64_tr_b16 v[48:49], v240 offset:0
ds_read_b64_tr_b16 v[50:51], v240 offset:4224
ds_read_b64_tr_b16 v[52:53], v240 offset:32
ds_read_b64_tr_b16 v[54:55], v240 offset:4256
ds_read_b64_tr_b16 v[56:57], v240 offset:64
ds_read_b64_tr_b16 v[58:59], v240 offset:4288
ds_read_b64_tr_b16 v[60:61], v240 offset:96
ds_read_b64_tr_b16 v[62:63], v240 offset:4320
s_waitcnt lgkmcnt(0)
v_add_u32 v240, 33792, v240
ds_read_b64_tr_b16 v[64:65], v240 offset:0
ds_read_b64_tr_b16 v[66:67], v240 offset:4224
ds_read_b64_tr_b16 v[68:69], v240 offset:32
ds_read_b64_tr_b16 v[70:71], v240 offset:4256
ds_read_b64_tr_b16 v[72:73], v240 offset:64
ds_read_b64_tr_b16 v[74:75], v240 offset:4288
ds_read_b64_tr_b16 v[76:77], v240 offset:96
ds_read_b64_tr_b16 v[78:79], v240 offset:4320
s_waitcnt lgkmcnt(0)
v_add_u32 v240, 33792, v240
ds_read_b64_tr_b16 v[80:81], v240 offset:0
ds_read_b64_tr_b16 v[82:83], v240 offset:4224
ds_read_b64_tr_b16 v[84:85], v240 offset:32
ds_read_b64_tr_b16 v[86:87], v240 offset:4256
ds_read_b64_tr_b16 v[88:89], v240 offset:64
ds_read_b64_tr_b16 v[90:91], v240 offset:4288
ds_read_b64_tr_b16 v[92:93], v240 offset:96
ds_read_b64_tr_b16 v[94:95], v240 offset:4320
s_waitcnt lgkmcnt(0)
v_bfe_u32 v10, v1, 2, 3
v_lshlrev_b32 v10, 11, v10
v_and_b32 v241, 3, v1
v_lshrrev_b32 v11, 5, v1
v_lshl_add_u32 v241, v11, 2, v241
v_lshl_add_u32 v10, v241, 4, v10
s_lshr_b32 s62, s32, 4
s_and_b32 s63, s32, 15
s_lshl_b32 s60, s62, 16
s_lshl_b32 s61, s63, 7
s_add_u32 s60, s60, s61
s_add_u32 s60, s60, 0x40000
v_add_u32 v10, s60, v10
s_lshl_b32 s60, s62, 11
s_lshl_b32 s61, s63, 6
s_add_u32 s60, s60, s61
s_add_u32 s60, s60, 0
v_lshl_add_u32 v11, v241, 3, s60
v_and_b32 v9, 7, v2
v_lshlrev_b32 v9, 10, v9
v_lshrrev_b32 v241, 3, v2
v_mul_u32_u24 v242, 512, v241
v_add_u32 v9, v9, v242
v_lshl_add_u32 v9, v3, 4, v9
s_lshl_b32 s62, s32, 13
s_add_u32 s62, s62, 0x60000
s_lshl_b32 s63, s34, 6
s_add_u32 s63, s63, s62
v_add_u32 v9, s63, v9
v_mul_u32_u24 v12, 272, v241
v_lshl_add_u32 v12, v3, 3, v12
s_lshl_b32 s62, s34, 5
v_add_u32 v12, s62, v12
v_and_b32 v241, 1, v2
v_mul_u32_u24 v13, 272, v241
v_lshl_add_u32 v13, v3, 4, v13
v_lshlrev_b32 v14, 16, v241
v_bfe_u32 v241, v2, 1, 2
v_lshl_add_u32 v14, v241, 6, v14
v_lshl_add_u32 v14, v3, 4, v14
s_lshl_b32 s62, s32, 11
s_lshl_b32 s63, s34, 8
s_add_u32 s62, s62, s63
s_add_u32 s62, s62, 0x40000
v_add_u32 v14, s62, v14
s_mov_b32 s82, 0xc0c0c0c
s_mov_b32 s83, 0xc0c0c0c
s_mov_b32 s84, 0x30303030
s_mov_b32 s85, 0x30303030
s_mov_b32 s86, 0xc0c0c0c0
s_mov_b32 s87, 0xc0c0c0c0
v_mov_b32 v15, 0xffffff00
s_mov_b32 s60, 0x0c0c0501
s_mov_b32 s61, 0x05010c0c
s_mov_b32 s53, 65536
s_branch L_C_merge
L_C_poll:
v_mov_b32 v96, 0
v_mov_b32 v97, 0
v_mov_b32 v98, 0x8000
v_mov_b32 v99, 0xff00
s_cmp_lg_u32 s34, 0
s_cbranch_scc1 L_Ch_d
s_lshl_b32 s62, s32, 13
s_add_u32 s62, s62, 0x61800
v_lshl_add_u32 v241, v1, 7, s62
s_mov_b64 exec, 1
s_mov_b32 s64, 0
L_pl_Ch:
buffer_load_dword v240, v241, s[44:47], 0 offen offset:1024 sc1
s_add_u32 s64, s64, 1
s_waitcnt vmcnt(0)
v_cmp_gt_i32 vcc, 0, v240
s_nop 0
s_cmp_eq_u64 vcc, 0
s_cbranch_scc1 L_pd_Ch
s_mov_b64 exec, vcc
s_sleep 2
s_cmp_lt_u32 s64, 65536
s_cbranch_scc1 L_pl_Ch
L_pd_Ch:
s_mov_b64 exec, -1
L_Ch_d:
s_barrier
s_mov_b32 s63, 0
buffer_store_dwordx4 v[224:227], v17, s[44:47], s63 offen sc1
s_mov_b32 s63, 16384
buffer_store_dwordx4 v[228:231], v17, s[44:47], s63 offen sc1
s_mov_b32 s63, 32768
buffer_store_dwordx4 v[232:235], v17, s[44:47], s63 offen sc1
s_mov_b32 s63, 49152
buffer_store_dwordx4 v[236:239], v17, s[44:47], s63 offen sc1
s_waitcnt vmcnt(0)
s_barrier
s_cmp_lg_u32 s34, 0
s_cbranch_scc1 L_C_nostat
s_mov_b32 exec_hi, 0
buffer_store_dwordx4 v[200:203], v18, s[44:47], 0 offen sc1
s_mov_b64 exec, -1
L_C_nostat:
s_cmp_lg_u32 s34, 0
s_cbranch_scc1 L_Cg_d
s_lshl_b32 s62, s32, 13
s_add_u32 s62, s62, 0x61800
v_lshl_add_u32 v241, v1, 7, s62
s_mov_b64 exec, 1
s_mov_b32 s64, 0
L_pl_Cg:
buffer_load_dword v240, v241, s[44:47], 0 offen offset:1024 sc1
s_add_u32 s64, s64, 1
s_waitcnt vmcnt(0)
v_cmp_gt_i32 vcc, 1, v240
s_nop 0
s_cmp_eq_u64 vcc, 0
s_cbranch_scc1 L_pd_Cg
s_mov_b64 exec, vcc
s_sleep 2
s_cmp_lt_u32 s64, 65536
s_cbranch_scc1 L_pl_Cg
L_pd_Cg:
s_mov_b64 exec, -1
L_Cg_d:
s_barrier
s_mov_b32 exec_lo, 0x3f3f3f3f
s_mov_b32 exec_hi, 0x3f3f3f3f
s_mov_b32 s64, 0
s_mov_b32 s66, 0x1000
s_mov_b32 s67, 0x2000
buffer_load_dwordx4 v[208:211], v9, s[44:47], 0 offen sc1
L_ps_Co:
s_waitcnt vmcnt(0)
v_xor_b32 v96, s76, v208
v_xor_b32 v97, s77, v209
v_xor_b32 v98, s78, v210
v_xor_b32 v99, s79, v211
v_or_b32 v240, v96, v97
v_or3_b32 v240, v240, v98, v99
v_and_b32 v240, 0xff, v240
v_cmp_ne_u32 vcc, 0, v240
s_cmp_eq_u64 vcc, 0
s_cbranch_scc1 L_pe_Co
buffer_load_dwordx4 v[208:211], v9, s[44:47], 0 offen sc1
s_add_u32 s64, s64, 1
s_cmp_lt_u32 s64, 65536
s_cbranch_scc1 L_ps_Co
L_pe_Co:
s_mov_b64 exec, -1
L_C_merge:
v_perm_b32 v100, v97, v96, s60
v_perm_b32 v101, v99, v98, s61
v_or_b32 v100, v100, v101
v_and_b32 v96, 0xffff0000, v96
v_and_b32 v97, 0xffff0000, v97
v_max_f32_dpp v101, v100, v100 quad_perm:[1,0,3,2] row_mask:0xf bank_mask:0xf
v_and_b32 v98, 0xffff0000, v98
v_and_b32 v99, 0xffff0000, v99
v_max_f32_dpp v101, v101, v101 quad_perm:[2,3,0,1] row_mask:0xf bank_mask:0xf
s_nop 1
v_max_f32_dpp v101, v101, v101 row_half_mirror row_mask:0xf bank_mask:0xf
v_sub_f32 v100, v100, v101
v_exp_f32 v100, v100
s_nop 0
v_mul_f32 v96, v96, v100
v_mul_f32 v97, v97, v100
v_mul_f32 v98, v98, v100
v_mul_f32 v99, v99, v100
v_add_f32_dpp v100, v100, v100 quad_perm:[1,0,3,2] row_mask:0xf bank_mask:0xf
v_add_f32_dpp v96, v96, v96 quad_perm:[1,0,3,2] row_mask:0xf bank_mask:0xf
v_add_f32_dpp v97, v97, v97 quad_perm:[1,0,3,2] row_mask:0xf bank_mask:0xf
v_add_f32_dpp v98, v98, v98 quad_perm:[1,0,3,2] row_mask:0xf bank_mask:0xf
v_add_f32_dpp v99, v99, v99 quad_perm:[1,0,3,2] row_mask:0xf bank_mask:0xf
v_add_f32_dpp v100, v100, v100 quad_perm:[2,3,0,1] row_mask:0xf bank_mask:0xf
v_add_f32_dpp v96, v96, v96 quad_perm:[2,3,0,1] row_mask:0xf bank_mask:0xf
v_add_f32_dpp v97, v97, v97 quad_perm:[2,3,0,1] row_mask:0xf bank_mask:0xf
v_add_f32_dpp v98, v98, v98 quad_perm:[2,3,0,1] row_mask:0xf bank_mask:0xf
v_add_f32_dpp v99, v99, v99 quad_perm:[2,3,0,1] row_mask:0xf bank_mask:0xf
v_add_f32_dpp v100, v100, v100 row_half_mirror row_mask:0xf bank_mask:0xf
v_add_f32_dpp v96, v96, v96 row_half_mirror row_mask:0xf bank_mask:0xf
v_add_f32_dpp v97, v97, v97 row_half_mirror row_mask:0xf bank_mask:0xf
v_add_f32_dpp v98, v98, v98 row_half_mirror row_mask:0xf bank_mask:0xf
v_add_f32_dpp v99, v99, v99 row_half_mirror row_mask:0xf bank_mask:0xf
v_rcp_f32 v100, v100
s_mov_b32 exec_lo, 0x01010101
s_mov_b32 exec_hi, 0x01010101
v_mul_f32 v96, v96, v100
v_mul_f32 v97, v97, v100
v_mul_f32 v98, v98, v100
v_mul_f32 v99, v99, v100
v_cvt_pk_bf16_f32 v96, v96, v97
v_cvt_pk_bf16_f32 v97, v98, v99
ds_write_b64 v12, v[96:97] offset:0
s_mov_b64 exec, -1
s_waitcnt lgkmcnt(0)
s_barrier
ds_read_b128 v[104:107], v13 offset:0
ds_read_b128 v[108:111], v13 offset:64
ds_read_b128 v[112:115], v13 offset:128
ds_read_b128 v[116:119], v13 offset:192
s_waitcnt lgkmcnt(3)
v_mfma_f32_16x16x32_bf16 v[128:131], v[32:35], v[104:107], 0
v_mfma_f32_16x16x32_bf16 v[132:135], v[36:39], v[104:107], 0
v_mfma_f32_16x16x32_bf16 v[136:139], v[40:43], v[104:107], 0
v_mfma_f32_16x16x32_bf16 v[140:143], v[44:47], v[104:107], 0
s_waitcnt lgkmcnt(2)
v_mfma_f32_16x16x32_bf16 v[128:131], v[48:51], v[108:111], v[128:131]
v_mfma_f32_16x16x32_bf16 v[132:135], v[52:55], v[108:111], v[132:135]
v_mfma_f32_16x16x32_bf16 v[136:139], v[56:59], v[108:111], v[136:139]
v_mfma_f32_16x16x32_bf16 v[140:143], v[60:63], v[108:111], v[140:143]
s_waitcnt lgkmcnt(1)
v_mfma_f32_16x16x32_bf16 v[128:131], v[64:67], v[112:115], v[128:131]
v_mfma_f32_16x16x32_bf16 v[132:135], v[68:71], v[112:115], v[132:135]
v_mfma_f32_16x16x32_bf16 v[136:139], v[72:75], v[112:115], v[136:139]
v_mfma_f32_16x16x32_bf16 v[140:143], v[76:79], v[112:115], v[140:143]
s_waitcnt lgkmcnt(0)
v_mfma_f32_16x16x32_bf16 v[128:131], v[80:83], v[116:119], v[128:131]
v_mfma_f32_16x16x32_bf16 v[132:135], v[84:87], v[116:119], v[132:135]
v_mfma_f32_16x16x32_bf16 v[136:139], v[88:91], v[116:119], v[136:139]
v_mfma_f32_16x16x32_bf16 v[140:143], v[92:95], v[116:119], v[140:143]
s_mov_b32 s64, s53
s_nop 4
v_cndmask_b32 v128, v128, v132, s[82:83]
v_cndmask_b32 v129, v129, v133, s[82:83]
v_cndmask_b32 v130, v130, v134, s[82:83]
v_cndmask_b32 v131, v131, v135, s[82:83]
v_cndmask_b32 v128, v128, v136, s[84:85]
v_cndmask_b32 v129, v129, v137, s[84:85]
v_cndmask_b32 v130, v130, v138, s[84:85]
v_cndmask_b32 v131, v131, v139, s[84:85]
v_cndmask_b32 v128, v128, v140, s[86:87]
v_cndmask_b32 v129, v129, v141, s[86:87]
v_cndmask_b32 v130, v130, v142, s[86:87]
v_cndmask_b32 v131, v131, v143, s[86:87]
v_add_u32 v128, 0x80, v128
v_add_u32 v129, 0x80, v129
v_add_u32 v130, 0x80, v130
v_add_u32 v131, 0x80, v131
v_and_or_b32 v128, v128, v15, s76
v_and_or_b32 v129, v129, v15, s77
v_and_or_b32 v130, v130, v15, s78
v_and_or_b32 v131, v131, v15, s79
s_cmp_lg_u32 s53, 0
s_cbranch_scc1 L_C_nost
s_mov_b32 exec_lo, 0x00ff00ff
s_mov_b32 exec_hi, 0x00ff00ff
buffer_store_dwordx4 v[128:131], v14, s[44:47], 0 offen sc1
s_mov_b64 exec, -1
L_C_nost:
s_cmp_lg_u32 s34, 4
s_cbranch_scc1 L_C_end
s_mov_b32 s66, 0x4000
s_mov_b32 s67, 0x8000
s_mov_b32 s65, 0xc000
buffer_load_dwordx4 v[144:147], v10, s[44:47], 0 offen sc1
buffer_load_dwordx4 v[148:151], v10, s[44:47], s66 offen sc1
buffer_load_dwordx4 v[152:155], v10, s[44:47], s67 offen sc1
buffer_load_dwordx4 v[156:159], v10, s[44:47], s65 offen sc1
s_sleep 6
buffer_load_dwordx4 v[160:163], v10, s[44:47], 0 offen sc1
buffer_load_dwordx4 v[164:167], v10, s[44:47], s66 offen sc1
buffer_load_dwordx4 v[168:171], v10, s[44:47], s67 offen sc1
buffer_load_dwordx4 v[172:175], v10, s[44:47], s65 offen sc1
s_sleep 6
buffer_load_dwordx4 v[176:179], v10, s[44:47], 0 offen sc1
buffer_load_dwordx4 v[180:183], v10, s[44:47], s66 offen sc1
buffer_load_dwordx4 v[184:187], v10, s[44:47], s67 offen sc1
buffer_load_dwordx4 v[188:191], v10, s[44:47], s65 offen sc1
L_ps_Cf:
s_waitcnt vmcnt(11)
v_xor_b32 v192, s76, v144
v_xor_b32 v193, s77, v145
v_xor_b32 v194, s78, v146
v_xor_b32 v195, s79, v147
v_or_b32 v240, v192, v193
v_or3_b32 v240, v240, v194, v195
s_waitcnt vmcnt(10)
v_xor_b32 v196, s76, v148
v_xor_b32 v197, s77, v149
v_xor_b32 v198, s78, v150
v_xor_b32 v199, s79, v151
v_or3_b32 v240, v240, v196, v197
v_or3_b32 v240, v240, v198, v199
v_add_f32 v192, v192, v196
v_add_f32 v193, v193, v197
v_add_f32 v194, v194, v198
v_add_f32 v195, v195, v199
s_waitcnt vmcnt(9)
v_xor_b32 v196, s76, v152
v_xor_b32 v197, s77, v153
v_xor_b32 v198, s78, v154
v_xor_b32 v199, s79, v155
v_or3_b32 v240, v240, v196, v197
v_or3_b32 v240, v240, v198, v199
v_add_f32 v192, v192, v196
v_add_f32 v193, v193, v197
v_add_f32 v194, v194, v198
v_add_f32 v195, v195, v199
s_waitcnt vmcnt(8)
v_xor_b32 v196, s76, v156
v_xor_b32 v197, s77, v157
v_xor_b32 v198, s78, v158
v_xor_b32 v199, s79, v159
v_or3_b32 v240, v240, v196, v197
v_or3_b32 v240, v240, v198, v199
v_add_f32 v192, v192, v196
v_add_f32 v193, v193, v197
v_add_f32 v194, v194, v198
v_add_f32 v195, v195, v199
v_and_b32 v240, 0xff, v240
v_cmp_ne_u32 vcc, 0, v240
v_add_f32_dpp v192, v192, v192 row_ror:8 row_mask:0xf bank_mask:0xf
v_add_f32_dpp v193, v193, v193 row_ror:8 row_mask:0xf bank_mask:0xf
v_add_f32_dpp v194, v194, v194 row_ror:8 row_mask:0xf bank_mask:0xf
v_add_f32_dpp v195, v195, v195 row_ror:8 row_mask:0xf bank_mask:0xf
s_cmp_eq_u64 vcc, 0
s_cbranch_scc1 L_pe_Cf
buffer_load_dwordx4 v[144:147], v10, s[44:47], 0 offen sc1
buffer_load_dwordx4 v[148:151], v10, s[44:47], s66 offen sc1
buffer_load_dwordx4 v[152:155], v10, s[44:47], s67 offen sc1
buffer_load_dwordx4 v[156:159], v10, s[44:47], s65 offen sc1
s_waitcnt vmcnt(11)
v_xor_b32 v192, s76, v160
v_xor_b32 v193, s77, v161
v_xor_b32 v194, s78, v162
v_xor_b32 v195, s79, v163
v_or_b32 v240, v192, v193
v_or3_b32 v240, v240, v194, v195
s_waitcnt vmcnt(10)
v_xor_b32 v196, s76, v164
v_xor_b32 v197, s77, v165
v_xor_b32 v198, s78, v166
v_xor_b32 v199, s79, v167
v_or3_b32 v240, v240, v196, v197
v_or3_b32 v240, v240, v198, v199
v_add_f32 v192, v192, v196
v_add_f32 v193, v193, v197
v_add_f32 v194, v194, v198
v_add_f32 v195, v195, v199
s_waitcnt vmcnt(9)
v_xor_b32 v196, s76, v168
v_xor_b32 v197, s77, v169
v_xor_b32 v198, s78, v170
v_xor_b32 v199, s79, v171
v_or3_b32 v240, v240, v196, v197
v_or3_b32 v240, v240, v198, v199
v_add_f32 v192, v192, v196
v_add_f32 v193, v193, v197
v_add_f32 v194, v194, v198
v_add_f32 v195, v195, v199
s_waitcnt vmcnt(8)
v_xor_b32 v196, s76, v172
v_xor_b32 v197, s77, v173
v_xor_b32 v198, s78, v174
v_xor_b32 v199, s79, v175
v_or3_b32 v240, v240, v196, v197
v_or3_b32 v240, v240, v198, v199
v_add_f32 v192, v192, v196
v_add_f32 v193, v193, v197
v_add_f32 v194, v194, v198
v_add_f32 v195, v195, v199
v_and_b32 v240, 0xff, v240
v_cmp_ne_u32 vcc, 0, v240
v_add_f32_dpp v192, v192, v192 row_ror:8 row_mask:0xf bank_mask:0xf
v_add_f32_dpp v193, v193, v193 row_ror:8 row_mask:0xf bank_mask:0xf
v_add_f32_dpp v194, v194, v194 row_ror:8 row_mask:0xf bank_mask:0xf
v_add_f32_dpp v195, v195, v195 row_ror:8 row_mask:0xf bank_mask:0xf
s_cmp_eq_u64 vcc, 0
s_cbranch_scc1 L_pe_Cf
buffer_load_dwordx4 v[160:163], v10, s[44:47], 0 offen sc1
buffer_load_dwordx4 v[164:167], v10, s[44:47], s66 offen sc1
buffer_load_dwordx4 v[168:171], v10, s[44:47], s67 offen sc1
buffer_load_dwordx4 v[172:175], v10, s[44:47], s65 offen sc1
s_waitcnt vmcnt(11)
v_xor_b32 v192, s76, v176
v_xor_b32 v193, s77, v177
v_xor_b32 v194, s78, v178
v_xor_b32 v195, s79, v179
v_or_b32 v240, v192, v193
v_or3_b32 v240, v240, v194, v195
s_waitcnt vmcnt(10)
v_xor_b32 v196, s76, v180
v_xor_b32 v197, s77, v181
v_xor_b32 v198, s78, v182
v_xor_b32 v199, s79, v183
v_or3_b32 v240, v240, v196, v197
v_or3_b32 v240, v240, v198, v199
v_add_f32 v192, v192, v196
v_add_f32 v193, v193, v197
v_add_f32 v194, v194, v198
v_add_f32 v195, v195, v199
s_waitcnt vmcnt(9)
v_xor_b32 v196, s76, v184
v_xor_b32 v197, s77, v185
v_xor_b32 v198, s78, v186
v_xor_b32 v199, s79, v187
v_or3_b32 v240, v240, v196, v197
v_or3_b32 v240, v240, v198, v199
v_add_f32 v192, v192, v196
v_add_f32 v193, v193, v197
v_add_f32 v194, v194, v198
v_add_f32 v195, v195, v199
s_waitcnt vmcnt(8)
v_xor_b32 v196, s76, v188
v_xor_b32 v197, s77, v189
v_xor_b32 v198, s78, v190
v_xor_b32 v199, s79, v191
v_or3_b32 v240, v240, v196, v197
v_or3_b32 v240, v240, v198, v199
v_add_f32 v192, v192, v196
v_add_f32 v193, v193, v197
v_add_f32 v194, v194, v198
v_add_f32 v195, v195, v199
v_and_b32 v240, 0xff, v240
v_cmp_ne_u32 vcc, 0, v240
v_add_f32_dpp v192, v192, v192 row_ror:8 row_mask:0xf bank_mask:0xf
v_add_f32_dpp v193, v193, v193 row_ror:8 row_mask:0xf bank_mask:0xf
v_add_f32_dpp v194, v194, v194 row_ror:8 row_mask:0xf bank_mask:0xf
v_add_f32_dpp v195, v195, v195 row_ror:8 row_mask:0xf bank_mask:0xf
s_cmp_eq_u64 vcc, 0
s_cbranch_scc1 L_pe_Cf
buffer_load_dwordx4 v[176:179], v10, s[44:47], 0 offen sc1
buffer_load_dwordx4 v[180:183], v10, s[44:47], s66 offen sc1
buffer_load_dwordx4 v[184:187], v10, s[44:47], s67 offen sc1
buffer_load_dwordx4 v[188:191], v10, s[44:47], s65 offen sc1
s_add_u32 s64, s64, 1
s_cmp_lt_u32 s64, 65536
s_cbranch_scc1 L_ps_Cf
L_pe_Cf:
v_add_f32_dpp v192, v192, v192 row_ror:4 row_mask:0xf bank_mask:0xf
v_add_f32_dpp v193, v193, v193 row_ror:4 row_mask:0xf bank_mask:0xf
v_add_f32_dpp v194, v194, v194 row_ror:4 row_mask:0xf bank_mask:0xf
v_add_f32_dpp v195, v195, v195 row_ror:4 row_mask:0xf bank_mask:0xf
v_mov_b32 v240, v192
v_mov_b32 v241, v193
v_mov_b32 v242, v194
v_mov_b32 v243, v195
v_permlane16_swap_b32 v192, v240
v_permlane16_swap_b32 v193, v241
v_permlane16_swap_b32 v194, v242
v_permlane16_swap_b32 v195, v243
v_add_f32 v192, v192, v240
v_add_f32 v193, v193, v241
v_add_f32 v194, v194, v242
v_add_f32 v195, v195, v243
v_cvt_pk_bf16_f32 v192, v192, v193
v_cvt_pk_bf16_f32 v193, v194, v195
s_cmp_lg_u32 s53, 0
s_cbranch_scc1 L_C_end
s_mov_b32 exec_lo, 15
s_mov_b32 exec_hi, 15
global_store_dwordx2 v11, v[192:193], s[26:27]
s_mov_b64 exec, -1
s_cmp_lg_u32 s32, 0
s_cbranch_scc1 L_C_end
v_mov_b32 v240, 0x14000
v_mov_b32 v241, s58
s_mov_b64 exec, 1
buffer_store_dword v241, v240, s[44:47], 0 offen
L_C_end:
s_cmp_lg_u32 s53, 0
s_mov_b32 s53, 0
s_cbranch_scc1 L_C_poll
s_endpgm
L_exit:
s_endpgm
.section .rodata,"a"
.p2align 6
.amdhsa_kernel concat_heads__gqa_block_cached__compressed_kv_cla__decode_kernel
  .amdhsa_next_free_vgpr 256
  .amdhsa_next_free_sgpr 102
  .amdhsa_accum_offset 256
  .amdhsa_group_segment_fixed_size 0
  .amdhsa_kernarg_size 112
  .amdhsa_user_sgpr_count 2
  .amdhsa_user_sgpr_kernarg_segment_ptr 1
  .amdhsa_system_sgpr_workgroup_id_x 1
.end_amdhsa_kernel
```
